```python
import torch

def _softmax(x, axis=-1):
    return torch.softmax(x, dim=axis)

def _gelu(x):
    return torch.nn.functional.gelu(x, approximate='tanh')

def _silu(x):
    return torch.nn.functional.silu(x)

def _sigmoid(x):
    return torch.sigmoid(x)

def _layernorm(x, axis=-1, eps=1e-05):
    m = x.mean(dim=axis, keepdim=True)
    v = x.var(dim=axis, keepdim=True, unbiased=False)
    return (x - m) / torch.sqrt(v + eps)

def _scatter_add(tgt, idx, src, axis=0):
    return tgt.clone().index_add_(axis, idx, src)

def _segment_sum(src, seg, n):
    out = torch.zeros((n,) + src.shape[1:], dtype=src.dtype)
    return out.index_add_(0, seg, src)

def _pad(x, pw):
    flat = tuple((v for pair in reversed(pw) for v in pair))
    return torch.nn.functional.pad(x, flat)
kernel_name = 'concat_heads__sliding_local_dilated__memory_aug_recurrent_mem_tr__prompt'

def setup_inputs():

    _w = lambda a: (lambda t: t.to(torch.bfloat16) if t.is_floating_point() else t)(torch.as_tensor(a))

    def _A_setup():
        B, S, D = (1, 2048, 640)
        return {'x': _w((lambda *s: torch.randn(*s, dtype=torch.bfloat16) * 0.2)(B, S, D)), 'wqkv': _w((lambda *s: torch.randn(*s, dtype=torch.bfloat16) * 0.2)(D, 3 * D)), 'wo': _w((lambda *s: torch.randn(*s, dtype=torch.bfloat16) * 0.05)(D, D))}
    _A_in = _A_setup()

    def _B_setup():
        B, S, Dm = (1, 2048, 640)
        H, Dh = (32, 192)
        M, seg = (8, 32)
        seg = min(seg, S)
        S = S // seg * seg
        return {'x': _w((lambda *s: torch.randn(*s, dtype=torch.bfloat16) * 0.05)(B, S, Dm)), 'mem0': _w((lambda *s: torch.randn(*s, dtype=torch.bfloat16) * 1.6)(B, M, Dm)), 'Wq': _w((lambda *s: torch.randn(*s, dtype=torch.bfloat16) * 0.8)(Dm, H, Dh) * Dm ** (-0.5)), 'Wk': _w((lambda *s: torch.randn(*s, dtype=torch.bfloat16) * 0.8)(Dm, H, Dh) * Dm ** (-0.5)), 'Wv': _w((lambda *s: torch.randn(*s, dtype=torch.bfloat16) * 1.6)(Dm, H, Dh) * Dm ** (-0.5)), 'Wo': _w((lambda *s: torch.randn(*s, dtype=torch.bfloat16) * 1.6)(H, Dh, Dm) * (H * Dh) ** (-0.5)), 'seg_len': seg}
    _B_in = _B_setup()
    return {'A_x': _A_in['x'], 'A_wqkv': _A_in['wqkv'], 'A_wo': _A_in['wo'], 'B_x': _B_in['x'], 'B_mem0': _B_in['mem0'], 'B_Wq': _B_in['Wq'], 'B_Wk': _B_in['Wk'], 'B_Wv': _B_in['Wv'], 'B_Wo': _B_in['Wo'], 'B_seg_len': _B_in['seg_len']}

def reference(A_x, A_wqkv, A_wo, B_x, B_mem0, B_Wq, B_Wk, B_Wv, B_Wo, B_seg_len):

    def _A_ref(x, wqkv, wo):
        B, S, D = x.shape
        H = 32
        Dh = D // H
        W, dil = (8, 2)
        qkv = (lambda x, *d: x.permute(*d))((x @ wqkv).reshape(B, S, 3, H, Dh), 2, 0, 3, 1, 4)
        q, k, v = (qkv[0], qkv[1], qkv[2])
        scale = Dh ** (-0.5)
        pos = torch.arange(S)
        off = torch.arange(W) * dil
        idx = pos[:, None] - off[None, :]
        mask = idx >= 0
        idx_c = torch.where(mask, idx, 0).reshape(-1)
        kg = k[:, :, idx_c, :].reshape(B, H, S, W, Dh)
        vg = v[:, :, idx_c, :].reshape(B, H, S, W, Dh)
        logits = torch.einsum('bhsd,bhswd->bhsw', q, kg) * scale
        logits = torch.where(mask[None, None, :, :], logits, -1000000000.0)
        attn = _softmax(logits, axis=-1)
        o = torch.einsum('bhsw,bhswd->bhsd', attn, vg)
        return (lambda x, *d: x.permute(*d))(o, 0, 2, 1, 3).reshape(B, S, D) @ wo

    def _B_ref(x, mem0, Wq, Wk, Wv, Wo, seg_len):
        B, S, Dm = x.shape
        H, Dh = (Wq.shape[1], Wq.shape[2])
        M = mem0.shape[1]
        scale = Dh ** (-0.5)
        n_seg = S // seg_len
        L = M + seg_len
        idx = torch.arange(L)
        mask = (idx[:, None] < M) | (idx[:, None] >= idx[None, :])
        mem = mem0
        outs = []
        for s in range(n_seg):
            xs = x[:, s * seg_len:(s + 1) * seg_len, :].clone()
            h = torch.concatenate([mem, xs], axis=1)
            q = torch.einsum('btd,dhe->bhte', h, Wq)
            k = torch.einsum('btd,dhe->bhte', h, Wk)
            v = torch.einsum('btd,dhe->bhte', h, Wv)
            scores = torch.einsum('bhqe,bhke->bhqk', q, k) * scale
            scores = torch.where(mask[None, None], scores, -1000000000.0)
            p = _softmax(scores, axis=-1)
            o = torch.einsum('bhqk,bhke->bhqe', p, v)
            o = torch.einsum('bhte,hed->btd', o, Wo)
            mem = o[:, :M, :].clone()
            outs.append(o[:, M:, :])
        return torch.concatenate(outs, axis=1)
    a = _A_ref(A_x, A_wqkv, A_wo)
    b = _B_ref(B_x, B_mem0, B_Wq, B_Wk, B_Wv, B_Wo, B_seg_len)
    return torch.concatenate([a, b], axis=-1)
```

```asm
; @launch kernel=init_kernel grid=(256,1,1) block=(256,1,1) lds=0
; @launch kernel=concat_heads__sliding_local_dilated__memory_aug_recurrent_mem_tr__prompt_kernel grid=(256,1,1) block=(256,1,1) lds=163840
.amdgcn_target "amdgcn-amd-amdhsa--gfx950"
.text
.globl init_kernel
.p2align 8
.type init_kernel,@function
init_kernel:
  s_cmp_ge_u32 s2, 256
  s_cbranch_scc1 L_init_end
  s_load_dwordx2 s[40:41], s[0:1], 96
  s_waitcnt lgkmcnt(0)
  s_add_u32 s8, s40, 0x1fffff
  s_addc_u32 s9, s41, 0
  s_and_b32 s8, s8, 0xffe00000
  s_mov_b32 s10, 266338304
  s_mov_b32 s11, 0x20000
  s_mul_i32 s3, s2, 12288
  v_lshlrev_b32 v1, 4, v0
  v_add_u32 v1, s3, v1
  v_cmp_gt_u32 vcc, 2883584, v1
  s_nop 1
  v_cndmask_b32 v4, 0, -1, vcc
  v_mov_b32 v5, v4
  v_mov_b32 v6, v4
  v_mov_b32 v7, v4
  buffer_store_dwordx4 v[4:7], v1, s[8:11], 0 offen sc1
  v_add_u32 v1, 4096, v1
  v_cmp_gt_u32 vcc, 2883584, v1
  s_nop 1
  v_cndmask_b32 v8, 0, -1, vcc
  v_mov_b32 v9, v8
  v_mov_b32 v10, v8
  v_mov_b32 v11, v8
  buffer_store_dwordx4 v[8:11], v1, s[8:11], 0 offen sc1
  v_add_u32 v1, 4096, v1
  v_cmp_gt_u32 vcc, 2883584, v1
  s_nop 1
  v_cndmask_b32 v12, 0, -1, vcc
  v_mov_b32 v13, v12
  v_mov_b32 v14, v12
  v_mov_b32 v15, v12
  buffer_store_dwordx4 v[12:15], v1, s[8:11], 0 offen sc1
  v_add_u32 v1, 4096, v1
  s_waitcnt vmcnt(0)
L_init_end:
  s_endpgm
.globl concat_heads__sliding_local_dilated__memory_aug_recurrent_mem_tr__prompt_kernel
.p2align 8
.type concat_heads__sliding_local_dilated__memory_aug_recurrent_mem_tr__prompt_kernel,@function
concat_heads__sliding_local_dilated__memory_aug_recurrent_mem_tr__prompt_kernel:
  s_cmp_ge_u32 s2, 256
  s_cbranch_scc1 L_end
  s_load_dwordx16 s[16:31], s[0:1], 0
  s_load_dwordx8 s[32:39], s[0:1], 64
  s_load_dwordx2 s[40:41], s[0:1], 96
  v_lshrrev_b32 v1, 6, v0
  v_and_b32 v0, 63, v0
  v_readfirstlane_b32 s42, v1
  s_getreg_b32 s43, hwreg(HW_REG_XCC_ID)
  s_and_b32 s43, s43, 7
  s_lshl_b32 s51, s42, 10
  s_waitcnt lgkmcnt(0)
  s_add_u32 s8, s40, 0x1fffff
  s_addc_u32 s9, s41, 0
  s_and_b32 s8, s8, 0xffe00000
  s_mov_b32 s10, 266338304
  s_mov_b32 s11, 0x20000
  s_mov_b32 s4, s38
  s_mov_b32 s5, s39
  s_mov_b32 s6, 256
  s_mov_b32 s7, 0x20000
  s_mov_b32 s12, s22
  s_mov_b32 s13, s23
  s_mov_b32 s14, 2621440
  s_mov_b32 s15, 0x20000
  s_cmp_lg_u32 s42, 0
  s_cbranch_scc1 L_role_wait
  s_mov_b32 s47, 0
L_role_try:
  s_lshl_b32 s46, s43, 7
  s_add_u32 s46, s46, 3015680
  v_mov_b32 v1, s46
  v_mov_b32 v2, 1
  s_mov_b64 exec, 1
  buffer_atomic_add v2, v1, s[8:11], 0 offen sc0 sc1
  s_waitcnt vmcnt(0)
  s_mov_b64 exec, -1
  v_readfirstlane_b32 s44, v2
  s_nop 0
  s_cmp_lt_u32 s44, 32
  s_cbranch_scc1 L_role_got
  s_add_u32 s43, s43, 1
  s_and_b32 s43, s43, 7
  s_add_u32 s47, s47, 1
  s_cmp_lt_u32 s47, 8
  s_cbranch_scc1 L_role_try
  s_mov_b32 s43, 0
  s_mov_b32 s44, 32
L_role_got:
  s_lshl_b32 s46, s43, 8
  s_or_b32 s46, s46, s44
  v_mov_b32 v1, 0
  v_mov_b32 v2, s46
  ds_write_b32 v1, v2
  s_waitcnt lgkmcnt(0)
L_role_wait:
  s_barrier
  v_mov_b32 v1, 0
  ds_read_b32 v2, v1
  s_waitcnt lgkmcnt(0)
  v_readfirstlane_b32 s46, v2
  s_barrier
  s_lshr_b32 s43, s46, 8
  s_and_b32 s43, s43, 7
  s_and_b32 s44, s46, 63
  s_and_b32 s46, s44, 7
  s_lshl_b32 s46, s46, 2
  s_and_b32 s47, s43, 3
  s_add_u32 s45, s46, s47
  s_cmp_ge_u32 s44, 32
  s_cbranch_scc1 L_end
  s_cmp_lt_u32 s43, 4
  s_cbranch_scc1 L_recur
  s_cmp_ge_u32 s44, 24
  s_cbranch_scc1 L_uw
  s_lshr_b32 s48, s44, 3
  s_cmp_eq_u32 s48, 0
  s_cselect_b32 s4, s26, s28
  s_cselect_b32 s5, s27, s29
  s_cmp_eq_u32 s48, 2
  s_cselect_b32 s4, s30, s4
  s_cselect_b32 s5, s31, s5
  s_mov_b32 s6, 7864320
  s_mul_i32 s60, s45, 384
  s_mov_b32 s61, 0
  s_mov_b32 s62, 64
  s_mul_i32 s63, s48, 25165824
  s_mul_i32 s46, s45, 786432
  s_add_u32 s63, s63, s46
  s_add_u32 s63, s63, 8388608
  s_lshl_b32 s64, s48, 14
  s_lshl_b32 s46, s45, 7
  s_add_u32 s64, s64, s46
  s_add_u32 s64, s64, 2899968
  v_lshrrev_b32 v10, 3, v0
  v_lshrrev_b32 v11, 2, v10
  v_lshlrev_b32 v11, 3, v11
  v_and_b32 v1, 3, v10
  v_add_u32 v1, v1, v11
  s_and_b32 s46, s42, 1
  s_lshl_b32 s46, s46, 2
  s_lshr_b32 s47, s42, 1
  s_lshl_b32 s47, s47, 4
  s_add_u32 s46, s46, s47
  v_add_u32 v1, s46, v1
  v_mul_u32_u24 v1, 12288, v1
  v_lshrrev_b32 v10, 1, v10
  v_bfe_u32 v11, v0, 1, 2
  v_xor_b32 v10, v10, v11
  v_lshlrev_b32 v10, 5, v10
  v_and_b32 v11, 1, v0
  v_lshlrev_b32 v11, 4, v11
  v_add3_u32 v1, v1, v10, v11
  v_lshrrev_b32 v10, 5, v0
  v_lshlrev_b32 v2, 11, v10
  v_bfe_u32 v10, v0, 2, 3
  v_lshl_add_u32 v2, v10, 7, v2
  v_lshrrev_b32 v10, 1, v10
  v_xor_b32 v10, s42, v10
  v_lshl_add_u32 v2, v10, 5, v2
  v_and_b32 v10, 3, v0
  v_lshl_add_u32 v2, v10, 3, v2
  v_add_u32 v3, 0x10000, v2
  v_add_u32 v4, 0x20000, v2
  v_lshrrev_b32 v10, 3, v0
  s_lshl_b32 s46, s42, 3
  v_add_u32 v10, s46, v10
  v_mul_u32_u24 v5, 1280, v10
  v_bfe_u32 v10, v10, 1, 3
  v_and_b32 v11, 7, v0
  v_xor_b32 v10, v10, v11
  v_lshl_add_u32 v5, v10, 4, v5
  v_and_b32 v10, 15, v0
  v_lshlrev_b32 v6, 7, v10
  v_lshrrev_b32 v10, 1, v10
  v_lshrrev_b32 v11, 4, v0
  v_xor_b32 v10, v10, v11
  v_lshl_add_u32 v6, v10, 4, v6
  v_add_u32 v6, 122880, v6
  v_xor_b32 v7, 64, v6
  v_and_b32 v10, 15, v0
  v_lshlrev_b32 v8, 4, v10
  v_bfe_u32 v10, v0, 4, 1
  v_mul_u32_u24 v10, 6144, v10
  v_lshrrev_b32 v11, 5, v0
  v_lshlrev_b32 v11, 8, v11
  v_add3_u32 v8, v8, v10, v11
  s_lshl_b32 s46, s42, 9
  v_add_u32 v8, s46, v8
  v_mov_b32 v9, s64
  s_mov_b32 s52, s61
  s_mul_i32 s53, s52, 40960
  s_add_u32 s54, s51, 122880
  s_add_u32 m0, s54, 0
  s_nop 0
  buffer_load_dwordx4 v5, s[12:15], s53 offen offset:0 lds
  s_add_u32 m0, s54, 3968
  s_nop 0
  buffer_load_dwordx4 v5, s[12:15], s53 offen offset:128 lds
  s_add_u32 m0, s54, 7936
  s_nop 0
  buffer_load_dwordx4 v5, s[12:15], s53 offen offset:256 lds
  s_add_u32 m0, s54, 11904
  s_nop 0
  buffer_load_dwordx4 v5, s[12:15], s53 offen offset:384 lds
  s_add_u32 m0, s54, 15872
  s_nop 0
  buffer_load_dwordx4 v5, s[12:15], s53 offen offset:512 lds
  s_add_u32 m0, s54, 19840
  s_nop 0
  buffer_load_dwordx4 v5, s[12:15], s53 offen offset:640 lds
  s_add_u32 m0, s54, 23808
  s_nop 0
  buffer_load_dwordx4 v5, s[12:15], s53 offen offset:768 lds
  s_add_u32 m0, s54, 27776
  s_nop 0
  buffer_load_dwordx4 v5, s[12:15], s53 offen offset:896 lds
  s_add_u32 m0, s54, 31744
  s_nop 0
  buffer_load_dwordx4 v5, s[12:15], s53 offen offset:1024 lds
  s_add_u32 m0, s54, 35712
  s_nop 0
  buffer_load_dwordx4 v5, s[12:15], s53 offen offset:1152 lds
  s_add_u32 m0, s51, 0
  s_add_u32 s46, s60, 0
  buffer_load_dwordx4 v1, s[4:7], s46 offen lds
  s_add_u32 m0, s51, 4096
  s_add_u32 s46, s60, 128
  buffer_load_dwordx4 v1, s[4:7], s46 offen lds
  s_add_u32 m0, s51, 8192
  s_add_u32 s46, s60, 256
  buffer_load_dwordx4 v1, s[4:7], s46 offen lds
  s_add_u32 m0, s51, 12288
  s_add_u32 s46, s60, 393216
  buffer_load_dwordx4 v1, s[4:7], s46 offen lds
  s_add_u32 m0, s51, 16384
  s_add_u32 s46, s60, 393344
  buffer_load_dwordx4 v1, s[4:7], s46 offen lds
  s_add_u32 m0, s51, 20480
  s_add_u32 s46, s60, 393472
  buffer_load_dwordx4 v1, s[4:7], s46 offen lds
  s_add_u32 m0, s51, 24576
  s_add_u32 s46, s60, 786432
  buffer_load_dwordx4 v1, s[4:7], s46 offen lds
  s_add_u32 m0, s51, 28672
  s_add_u32 s46, s60, 786560
  buffer_load_dwordx4 v1, s[4:7], s46 offen lds
  s_add_u32 m0, s51, 32768
  s_add_u32 s46, s60, 786688
  buffer_load_dwordx4 v1, s[4:7], s46 offen lds
  s_add_u32 m0, s51, 36864
  s_add_u32 s46, s60, 1179648
  buffer_load_dwordx4 v1, s[4:7], s46 offen lds
  s_add_u32 m0, s51, 40960
  s_add_u32 s46, s60, 1179776
  buffer_load_dwordx4 v1, s[4:7], s46 offen lds
  s_add_u32 m0, s51, 45056
  s_add_u32 s46, s60, 1179904
  buffer_load_dwordx4 v1, s[4:7], s46 offen lds
  s_add_u32 m0, s51, 49152
  s_add_u32 s46, s60, 1572864
  buffer_load_dwordx4 v1, s[4:7], s46 offen lds
  s_add_u32 m0, s51, 53248
  s_add_u32 s46, s60, 1572992
  buffer_load_dwordx4 v1, s[4:7], s46 offen lds
  s_add_u32 m0, s51, 57344
  s_add_u32 s46, s60, 1573120
  buffer_load_dwordx4 v1, s[4:7], s46 offen lds
  s_add_u32 m0, s51, 61440
  s_add_u32 s46, s60, 1966080
  buffer_load_dwordx4 v1, s[4:7], s46 offen lds
  s_add_u32 m0, s51, 65536
  s_add_u32 s46, s60, 1966208
  buffer_load_dwordx4 v1, s[4:7], s46 offen lds
  s_add_u32 m0, s51, 69632
  s_add_u32 s46, s60, 1966336
  buffer_load_dwordx4 v1, s[4:7], s46 offen lds
  s_add_u32 m0, s51, 73728
  s_add_u32 s46, s60, 2359296
  buffer_load_dwordx4 v1, s[4:7], s46 offen lds
  s_add_u32 m0, s51, 77824
  s_add_u32 s46, s60, 2359424
  buffer_load_dwordx4 v1, s[4:7], s46 offen lds
  s_add_u32 m0, s51, 81920
  s_add_u32 s46, s60, 2359552
  buffer_load_dwordx4 v1, s[4:7], s46 offen lds
  s_add_u32 m0, s51, 86016
  s_add_u32 s46, s60, 2752512
  buffer_load_dwordx4 v1, s[4:7], s46 offen lds
  s_add_u32 m0, s51, 90112
  s_add_u32 s46, s60, 2752640
  buffer_load_dwordx4 v1, s[4:7], s46 offen lds
  s_add_u32 m0, s51, 94208
  s_add_u32 s46, s60, 2752768
  buffer_load_dwordx4 v1, s[4:7], s46 offen lds
  s_waitcnt vmcnt(18)
  s_barrier
  s_add_u32 m0, s51, 98304
  s_add_u32 s46, s60, 3145728
  buffer_load_dwordx4 v1, s[4:7], s46 offen lds
  s_add_u32 m0, s51, 102400
  s_add_u32 s46, s60, 3145856
  buffer_load_dwordx4 v1, s[4:7], s46 offen lds
  s_add_u32 m0, s51, 106496
  s_add_u32 s46, s60, 3145984
  buffer_load_dwordx4 v1, s[4:7], s46 offen lds
  s_add_u32 m0, s51, 110592
  s_add_u32 s46, s60, 3538944
  buffer_load_dwordx4 v1, s[4:7], s46 offen lds
  s_add_u32 m0, s51, 114688
  s_add_u32 s46, s60, 3539072
  buffer_load_dwordx4 v1, s[4:7], s46 offen lds
  s_add_u32 m0, s51, 118784
  s_add_u32 s46, s60, 3539200
  buffer_load_dwordx4 v1, s[4:7], s46 offen lds
  ds_read_b64_tr_b16 a[0:1], v2 offset:0
  ds_read_b64_tr_b16 a[2:3], v2 offset:1024
  ds_read_b64_tr_b16 a[4:5], v2 offset:4096
  ds_read_b64_tr_b16 a[6:7], v2 offset:5120
  ds_read_b64_tr_b16 a[8:9], v2 offset:8192
  ds_read_b64_tr_b16 a[10:11], v2 offset:9216
  ds_read_b64_tr_b16 a[12:13], v2 offset:12288
  ds_read_b64_tr_b16 a[14:15], v2 offset:13312
  ds_read_b64_tr_b16 a[16:17], v2 offset:16384
  ds_read_b64_tr_b16 a[18:19], v2 offset:17408
  ds_read_b64_tr_b16 a[20:21], v2 offset:20480
  ds_read_b64_tr_b16 a[22:23], v2 offset:21504
  s_waitcnt lgkmcnt(0)
  s_waitcnt vmcnt(18)
  s_barrier
  s_add_u32 m0, s51, 0
  s_add_u32 s46, s60, 3932160
  buffer_load_dwordx4 v1, s[4:7], s46 offen lds
  s_add_u32 m0, s51, 4096
  s_add_u32 s46, s60, 3932288
  buffer_load_dwordx4 v1, s[4:7], s46 offen lds
  s_add_u32 m0, s51, 8192
  s_add_u32 s46, s60, 3932416
  buffer_load_dwordx4 v1, s[4:7], s46 offen lds
  s_add_u32 m0, s51, 12288
  s_add_u32 s46, s60, 4325376
  buffer_load_dwordx4 v1, s[4:7], s46 offen lds
  s_add_u32 m0, s51, 16384
  s_add_u32 s46, s60, 4325504
  buffer_load_dwordx4 v1, s[4:7], s46 offen lds
  s_add_u32 m0, s51, 20480
  s_add_u32 s46, s60, 4325632
  buffer_load_dwordx4 v1, s[4:7], s46 offen lds
  ds_read_b64_tr_b16 a[24:25], v2 offset:24576
  ds_read_b64_tr_b16 a[26:27], v2 offset:25600
  ds_read_b64_tr_b16 a[28:29], v2 offset:28672
  ds_read_b64_tr_b16 a[30:31], v2 offset:29696
  ds_read_b64_tr_b16 a[32:33], v2 offset:32768
  ds_read_b64_tr_b16 a[34:35], v2 offset:33792
  ds_read_b64_tr_b16 a[36:37], v2 offset:36864
  ds_read_b64_tr_b16 a[38:39], v2 offset:37888
  ds_read_b64_tr_b16 a[40:41], v2 offset:40960
  ds_read_b64_tr_b16 a[42:43], v2 offset:41984
  ds_read_b64_tr_b16 a[44:45], v2 offset:45056
  ds_read_b64_tr_b16 a[46:47], v2 offset:46080
  s_waitcnt lgkmcnt(0)
  s_waitcnt vmcnt(18)
  s_barrier
  s_add_u32 m0, s51, 24576
  s_add_u32 s46, s60, 4718592
  buffer_load_dwordx4 v1, s[4:7], s46 offen lds
  s_add_u32 m0, s51, 28672
  s_add_u32 s46, s60, 4718720
  buffer_load_dwordx4 v1, s[4:7], s46 offen lds
  s_add_u32 m0, s51, 32768
  s_add_u32 s46, s60, 4718848
  buffer_load_dwordx4 v1, s[4:7], s46 offen lds
  s_add_u32 m0, s51, 36864
  s_add_u32 s46, s60, 5111808
  buffer_load_dwordx4 v1, s[4:7], s46 offen lds
  s_add_u32 m0, s51, 40960
  s_add_u32 s46, s60, 5111936
  buffer_load_dwordx4 v1, s[4:7], s46 offen lds
  s_add_u32 m0, s51, 45056
  s_add_u32 s46, s60, 5112064
  buffer_load_dwordx4 v1, s[4:7], s46 offen lds
  ds_read_b64_tr_b16 a[48:49], v2 offset:49152
  ds_read_b64_tr_b16 a[50:51], v2 offset:50176
  ds_read_b64_tr_b16 a[52:53], v2 offset:53248
  ds_read_b64_tr_b16 a[54:55], v2 offset:54272
  ds_read_b64_tr_b16 a[56:57], v2 offset:57344
  ds_read_b64_tr_b16 a[58:59], v2 offset:58368
  ds_read_b64_tr_b16 a[60:61], v2 offset:61440
  ds_read_b64_tr_b16 a[62:63], v2 offset:62464
  ds_read_b64_tr_b16 a[64:65], v3 offset:0
  ds_read_b64_tr_b16 a[66:67], v3 offset:1024
  ds_read_b64_tr_b16 a[68:69], v3 offset:4096
  ds_read_b64_tr_b16 a[70:71], v3 offset:5120
  s_waitcnt lgkmcnt(0)
  s_waitcnt vmcnt(18)
  s_barrier
  s_add_u32 m0, s51, 49152
  s_add_u32 s46, s60, 5505024
  buffer_load_dwordx4 v1, s[4:7], s46 offen lds
  s_add_u32 m0, s51, 53248
  s_add_u32 s46, s60, 5505152
  buffer_load_dwordx4 v1, s[4:7], s46 offen lds
  s_add_u32 m0, s51, 57344
  s_add_u32 s46, s60, 5505280
  buffer_load_dwordx4 v1, s[4:7], s46 offen lds
  s_add_u32 m0, s51, 61440
  s_add_u32 s46, s60, 5898240
  buffer_load_dwordx4 v1, s[4:7], s46 offen lds
  s_add_u32 m0, s51, 65536
  s_add_u32 s46, s60, 5898368
  buffer_load_dwordx4 v1, s[4:7], s46 offen lds
  s_add_u32 m0, s51, 69632
  s_add_u32 s46, s60, 5898496
  buffer_load_dwordx4 v1, s[4:7], s46 offen lds
  ds_read_b64_tr_b16 a[72:73], v3 offset:8192
  ds_read_b64_tr_b16 a[74:75], v3 offset:9216
  ds_read_b64_tr_b16 a[76:77], v3 offset:12288
  ds_read_b64_tr_b16 a[78:79], v3 offset:13312
  ds_read_b64_tr_b16 a[80:81], v3 offset:16384
  ds_read_b64_tr_b16 a[82:83], v3 offset:17408
  ds_read_b64_tr_b16 a[84:85], v3 offset:20480
  ds_read_b64_tr_b16 a[86:87], v3 offset:21504
  ds_read_b64_tr_b16 a[88:89], v3 offset:24576
  ds_read_b64_tr_b16 a[90:91], v3 offset:25600
  ds_read_b64_tr_b16 a[92:93], v3 offset:28672
  ds_read_b64_tr_b16 a[94:95], v3 offset:29696
  s_waitcnt lgkmcnt(0)
  s_waitcnt vmcnt(18)
  s_barrier
  s_add_u32 m0, s51, 73728
  s_add_u32 s46, s60, 6291456
  buffer_load_dwordx4 v1, s[4:7], s46 offen lds
  s_add_u32 m0, s51, 77824
  s_add_u32 s46, s60, 6291584
  buffer_load_dwordx4 v1, s[4:7], s46 offen lds
  s_add_u32 m0, s51, 81920
  s_add_u32 s46, s60, 6291712
  buffer_load_dwordx4 v1, s[4:7], s46 offen lds
  s_add_u32 m0, s51, 86016
  s_add_u32 s46, s60, 6684672
  buffer_load_dwordx4 v1, s[4:7], s46 offen lds
  s_add_u32 m0, s51, 90112
  s_add_u32 s46, s60, 6684800
  buffer_load_dwordx4 v1, s[4:7], s46 offen lds
  s_add_u32 m0, s51, 94208
  s_add_u32 s46, s60, 6684928
  buffer_load_dwordx4 v1, s[4:7], s46 offen lds
  ds_read_b64_tr_b16 a[96:97], v3 offset:32768
  ds_read_b64_tr_b16 a[98:99], v3 offset:33792
  ds_read_b64_tr_b16 a[100:101], v3 offset:36864
  ds_read_b64_tr_b16 a[102:103], v3 offset:37888
  ds_read_b64_tr_b16 a[104:105], v3 offset:40960
  ds_read_b64_tr_b16 a[106:107], v3 offset:41984
  ds_read_b64_tr_b16 a[108:109], v3 offset:45056
  ds_read_b64_tr_b16 a[110:111], v3 offset:46080
  ds_read_b64_tr_b16 a[112:113], v3 offset:49152
  ds_read_b64_tr_b16 a[114:115], v3 offset:50176
  ds_read_b64_tr_b16 a[116:117], v3 offset:53248
  ds_read_b64_tr_b16 a[118:119], v3 offset:54272
  s_waitcnt lgkmcnt(0)
  s_waitcnt vmcnt(18)
  s_barrier
  s_add_u32 m0, s51, 98304
  s_add_u32 s46, s60, 7077888
  buffer_load_dwordx4 v1, s[4:7], s46 offen lds
  s_add_u32 m0, s51, 102400
  s_add_u32 s46, s60, 7078016
  buffer_load_dwordx4 v1, s[4:7], s46 offen lds
  s_add_u32 m0, s51, 106496
  s_add_u32 s46, s60, 7078144
  buffer_load_dwordx4 v1, s[4:7], s46 offen lds
  s_add_u32 m0, s51, 110592
  s_add_u32 s46, s60, 7471104
  buffer_load_dwordx4 v1, s[4:7], s46 offen lds
  s_add_u32 m0, s51, 114688
  s_add_u32 s46, s60, 7471232
  buffer_load_dwordx4 v1, s[4:7], s46 offen lds
  s_add_u32 m0, s51, 118784
  s_add_u32 s46, s60, 7471360
  buffer_load_dwordx4 v1, s[4:7], s46 offen lds
  ds_read_b64_tr_b16 a[120:121], v2 offset:0
  ds_read_b64_tr_b16 a[122:123], v2 offset:1024
  ds_read_b64_tr_b16 a[124:125], v2 offset:4096
  ds_read_b64_tr_b16 a[126:127], v2 offset:5120
  ds_read_b64_tr_b16 a[128:129], v2 offset:8192
  ds_read_b64_tr_b16 a[130:131], v2 offset:9216
  ds_read_b64_tr_b16 a[132:133], v2 offset:12288
  ds_read_b64_tr_b16 a[134:135], v2 offset:13312
  ds_read_b64_tr_b16 a[136:137], v2 offset:16384
  ds_read_b64_tr_b16 a[138:139], v2 offset:17408
  ds_read_b64_tr_b16 a[140:141], v2 offset:20480
  ds_read_b64_tr_b16 a[142:143], v2 offset:21504
  s_waitcnt lgkmcnt(0)
  s_waitcnt vmcnt(18)
  s_barrier
  ds_read_b64_tr_b16 a[144:145], v2 offset:24576
  ds_read_b64_tr_b16 a[146:147], v2 offset:25600
  ds_read_b64_tr_b16 a[148:149], v2 offset:28672
  ds_read_b64_tr_b16 a[150:151], v2 offset:29696
  ds_read_b64_tr_b16 a[152:153], v2 offset:32768
  ds_read_b64_tr_b16 a[154:155], v2 offset:33792
  ds_read_b64_tr_b16 a[156:157], v2 offset:36864
  ds_read_b64_tr_b16 a[158:159], v2 offset:37888
  ds_read_b64_tr_b16 a[160:161], v2 offset:40960
  ds_read_b64_tr_b16 a[162:163], v2 offset:41984
  ds_read_b64_tr_b16 a[164:165], v2 offset:45056
  ds_read_b64_tr_b16 a[166:167], v2 offset:46080
  s_waitcnt lgkmcnt(0)
  s_waitcnt vmcnt(12)
  s_barrier
  ds_read_b64_tr_b16 a[168:169], v2 offset:49152
  ds_read_b64_tr_b16 a[170:171], v2 offset:50176
  ds_read_b64_tr_b16 a[172:173], v2 offset:53248
  ds_read_b64_tr_b16 a[174:175], v2 offset:54272
  ds_read_b64_tr_b16 a[176:177], v2 offset:57344
  ds_read_b64_tr_b16 a[178:179], v2 offset:58368
  ds_read_b64_tr_b16 a[180:181], v2 offset:61440
  ds_read_b64_tr_b16 a[182:183], v2 offset:62464
  ds_read_b64_tr_b16 a[184:185], v3 offset:0
  ds_read_b64_tr_b16 a[186:187], v3 offset:1024
  ds_read_b64_tr_b16 a[188:189], v3 offset:4096
  ds_read_b64_tr_b16 a[190:191], v3 offset:5120
  s_waitcnt lgkmcnt(0)
  s_waitcnt vmcnt(6)
  s_barrier
  ds_read_b64_tr_b16 a[192:193], v3 offset:8192
  ds_read_b64_tr_b16 a[194:195], v3 offset:9216
  ds_read_b64_tr_b16 a[196:197], v3 offset:12288
  ds_read_b64_tr_b16 a[198:199], v3 offset:13312
  ds_read_b64_tr_b16 a[200:201], v3 offset:16384
  ds_read_b64_tr_b16 a[202:203], v3 offset:17408
  ds_read_b64_tr_b16 a[204:205], v3 offset:20480
  ds_read_b64_tr_b16 a[206:207], v3 offset:21504
  ds_read_b64_tr_b16 a[208:209], v3 offset:24576
  ds_read_b64_tr_b16 a[210:211], v3 offset:25600
  ds_read_b64_tr_b16 a[212:213], v3 offset:28672
  ds_read_b64_tr_b16 a[214:215], v3 offset:29696
  s_waitcnt lgkmcnt(0)
  s_waitcnt vmcnt(0)
  s_barrier
  ds_read_b64_tr_b16 a[216:217], v3 offset:32768
  ds_read_b64_tr_b16 a[218:219], v3 offset:33792
  ds_read_b64_tr_b16 a[220:221], v3 offset:36864
  ds_read_b64_tr_b16 a[222:223], v3 offset:37888
  ds_read_b64_tr_b16 a[224:225], v3 offset:40960
  ds_read_b64_tr_b16 a[226:227], v3 offset:41984
  ds_read_b64_tr_b16 a[228:229], v3 offset:45056
  ds_read_b64_tr_b16 a[230:231], v3 offset:46080
  ds_read_b64_tr_b16 a[232:233], v3 offset:49152
  ds_read_b64_tr_b16 a[234:235], v3 offset:50176
  ds_read_b64_tr_b16 a[236:237], v3 offset:53248
  ds_read_b64_tr_b16 a[238:239], v3 offset:54272
  s_waitcnt lgkmcnt(0)
  s_barrier
pj_loop_1:
  s_add_u32 s57, s52, 1
  s_xor_b32 s54, s54, 122880
  s_add_u32 s53, s53, 40960
  ds_read_b128 v[16:19], v6 offset:0
  ds_read_b128 v[20:23], v6 offset:2048
  ds_read_b128 v[24:27], v7 offset:0
  ds_read_b128 v[28:31], v7 offset:2048
  ds_read_b128 v[32:35], v6 offset:4096
  s_waitcnt lgkmcnt(4)
  v_mfma_f32_16x16x32_bf16 v[40:43], a[0:3], v[16:19], 0
  s_add_u32 m0, s54, 0
  v_mfma_f32_16x16x32_bf16 v[48:51], a[4:7], v[16:19], 0
  buffer_load_dwordx4 v5, s[12:15], s53 offen offset:0 lds
  v_mfma_f32_16x16x32_bf16 v[56:59], a[8:11], v[16:19], 0
  ds_read_b128 v[36:39], v6 offset:6144
  s_waitcnt lgkmcnt(4)
  v_mfma_f32_16x16x32_bf16 v[44:47], a[0:3], v[20:23], 0
  v_mfma_f32_16x16x32_bf16 v[52:55], a[4:7], v[20:23], 0
  v_mfma_f32_16x16x32_bf16 v[60:63], a[8:11], v[20:23], 0
  ds_read_b128 v[16:19], v7 offset:4096
  s_waitcnt lgkmcnt(4)
  v_mfma_f32_16x16x32_bf16 v[40:43], a[12:15], v[24:27], v[40:43]
  s_add_u32 m0, s54, 3968
  v_mfma_f32_16x16x32_bf16 v[48:51], a[16:19], v[24:27], v[48:51]
  buffer_load_dwordx4 v5, s[12:15], s53 offen offset:128 lds
  v_mfma_f32_16x16x32_bf16 v[56:59], a[20:23], v[24:27], v[56:59]
  ds_read_b128 v[20:23], v7 offset:6144
  s_waitcnt lgkmcnt(4)
  v_mfma_f32_16x16x32_bf16 v[44:47], a[12:15], v[28:31], v[44:47]
  v_mfma_f32_16x16x32_bf16 v[52:55], a[16:19], v[28:31], v[52:55]
  v_mfma_f32_16x16x32_bf16 v[60:63], a[20:23], v[28:31], v[60:63]
  ds_read_b128 v[24:27], v6 offset:8192
  s_waitcnt lgkmcnt(4)
  v_mfma_f32_16x16x32_bf16 v[40:43], a[24:27], v[32:35], v[40:43]
  s_add_u32 m0, s54, 7936
  v_mfma_f32_16x16x32_bf16 v[48:51], a[28:31], v[32:35], v[48:51]
  buffer_load_dwordx4 v5, s[12:15], s53 offen offset:256 lds
  v_mfma_f32_16x16x32_bf16 v[56:59], a[32:35], v[32:35], v[56:59]
  ds_read_b128 v[28:31], v6 offset:10240
  s_waitcnt lgkmcnt(4)
  v_mfma_f32_16x16x32_bf16 v[44:47], a[24:27], v[36:39], v[44:47]
  v_mfma_f32_16x16x32_bf16 v[52:55], a[28:31], v[36:39], v[52:55]
  v_mfma_f32_16x16x32_bf16 v[60:63], a[32:35], v[36:39], v[60:63]
  ds_read_b128 v[32:35], v7 offset:8192
  s_waitcnt lgkmcnt(4)
  v_mfma_f32_16x16x32_bf16 v[40:43], a[36:39], v[16:19], v[40:43]
  s_add_u32 m0, s54, 11904
  v_mfma_f32_16x16x32_bf16 v[48:51], a[40:43], v[16:19], v[48:51]
  buffer_load_dwordx4 v5, s[12:15], s53 offen offset:384 lds
  v_mfma_f32_16x16x32_bf16 v[56:59], a[44:47], v[16:19], v[56:59]
  ds_read_b128 v[36:39], v7 offset:10240
  s_waitcnt lgkmcnt(4)
  v_mfma_f32_16x16x32_bf16 v[44:47], a[36:39], v[20:23], v[44:47]
  v_mfma_f32_16x16x32_bf16 v[52:55], a[40:43], v[20:23], v[52:55]
  v_mfma_f32_16x16x32_bf16 v[60:63], a[44:47], v[20:23], v[60:63]
  ds_read_b128 v[16:19], v6 offset:12288
  s_waitcnt lgkmcnt(4)
  v_mfma_f32_16x16x32_bf16 v[40:43], a[48:51], v[24:27], v[40:43]
  s_add_u32 m0, s54, 15872
  v_mfma_f32_16x16x32_bf16 v[48:51], a[52:55], v[24:27], v[48:51]
  buffer_load_dwordx4 v5, s[12:15], s53 offen offset:512 lds
  v_mfma_f32_16x16x32_bf16 v[56:59], a[56:59], v[24:27], v[56:59]
  ds_read_b128 v[20:23], v6 offset:14336
  s_waitcnt lgkmcnt(4)
  v_mfma_f32_16x16x32_bf16 v[44:47], a[48:51], v[28:31], v[44:47]
  v_mfma_f32_16x16x32_bf16 v[52:55], a[52:55], v[28:31], v[52:55]
  v_mfma_f32_16x16x32_bf16 v[60:63], a[56:59], v[28:31], v[60:63]
  ds_read_b128 v[24:27], v7 offset:12288
  s_waitcnt lgkmcnt(4)
  v_mfma_f32_16x16x32_bf16 v[40:43], a[60:63], v[32:35], v[40:43]
  s_add_u32 m0, s54, 19840
  v_mfma_f32_16x16x32_bf16 v[48:51], a[64:67], v[32:35], v[48:51]
  buffer_load_dwordx4 v5, s[12:15], s53 offen offset:640 lds
  v_mfma_f32_16x16x32_bf16 v[56:59], a[68:71], v[32:35], v[56:59]
  ds_read_b128 v[28:31], v7 offset:14336
  s_waitcnt lgkmcnt(4)
  v_mfma_f32_16x16x32_bf16 v[44:47], a[60:63], v[36:39], v[44:47]
  v_mfma_f32_16x16x32_bf16 v[52:55], a[64:67], v[36:39], v[52:55]
  v_mfma_f32_16x16x32_bf16 v[60:63], a[68:71], v[36:39], v[60:63]
  ds_read_b128 v[32:35], v6 offset:16384
  s_waitcnt lgkmcnt(4)
  v_mfma_f32_16x16x32_bf16 v[40:43], a[72:75], v[16:19], v[40:43]
  s_add_u32 m0, s54, 23808
  v_mfma_f32_16x16x32_bf16 v[48:51], a[76:79], v[16:19], v[48:51]
  buffer_load_dwordx4 v5, s[12:15], s53 offen offset:768 lds
  v_mfma_f32_16x16x32_bf16 v[56:59], a[80:83], v[16:19], v[56:59]
  ds_read_b128 v[36:39], v6 offset:18432
  s_waitcnt lgkmcnt(4)
  v_mfma_f32_16x16x32_bf16 v[44:47], a[72:75], v[20:23], v[44:47]
  v_mfma_f32_16x16x32_bf16 v[52:55], a[76:79], v[20:23], v[52:55]
  v_mfma_f32_16x16x32_bf16 v[60:63], a[80:83], v[20:23], v[60:63]
  ds_read_b128 v[16:19], v7 offset:16384
  s_waitcnt lgkmcnt(4)
  v_mfma_f32_16x16x32_bf16 v[40:43], a[84:87], v[24:27], v[40:43]
  s_add_u32 m0, s54, 27776
  v_mfma_f32_16x16x32_bf16 v[48:51], a[88:91], v[24:27], v[48:51]
  buffer_load_dwordx4 v5, s[12:15], s53 offen offset:896 lds
  v_mfma_f32_16x16x32_bf16 v[56:59], a[92:95], v[24:27], v[56:59]
  ds_read_b128 v[20:23], v7 offset:18432
  s_waitcnt lgkmcnt(4)
  v_mfma_f32_16x16x32_bf16 v[44:47], a[84:87], v[28:31], v[44:47]
  v_mfma_f32_16x16x32_bf16 v[52:55], a[88:91], v[28:31], v[52:55]
  v_mfma_f32_16x16x32_bf16 v[60:63], a[92:95], v[28:31], v[60:63]
  ds_read_b128 v[24:27], v6 offset:20480
  s_waitcnt lgkmcnt(4)
  v_mfma_f32_16x16x32_bf16 v[40:43], a[96:99], v[32:35], v[40:43]
  s_add_u32 m0, s54, 31744
  v_mfma_f32_16x16x32_bf16 v[48:51], a[100:103], v[32:35], v[48:51]
  buffer_load_dwordx4 v5, s[12:15], s53 offen offset:1024 lds
  v_mfma_f32_16x16x32_bf16 v[56:59], a[104:107], v[32:35], v[56:59]
  ds_read_b128 v[28:31], v6 offset:22528
  s_waitcnt lgkmcnt(4)
  v_mfma_f32_16x16x32_bf16 v[44:47], a[96:99], v[36:39], v[44:47]
  v_mfma_f32_16x16x32_bf16 v[52:55], a[100:103], v[36:39], v[52:55]
  v_mfma_f32_16x16x32_bf16 v[60:63], a[104:107], v[36:39], v[60:63]
  ds_read_b128 v[32:35], v7 offset:20480
  s_waitcnt lgkmcnt(4)
  v_mfma_f32_16x16x32_bf16 v[40:43], a[108:111], v[16:19], v[40:43]
  s_add_u32 m0, s54, 35712
  v_mfma_f32_16x16x32_bf16 v[48:51], a[112:115], v[16:19], v[48:51]
  buffer_load_dwordx4 v5, s[12:15], s53 offen offset:1152 lds
  v_mfma_f32_16x16x32_bf16 v[56:59], a[116:119], v[16:19], v[56:59]
  ds_read_b128 v[36:39], v7 offset:22528
  s_waitcnt lgkmcnt(4)
  v_mfma_f32_16x16x32_bf16 v[44:47], a[108:111], v[20:23], v[44:47]
  v_mfma_f32_16x16x32_bf16 v[52:55], a[112:115], v[20:23], v[52:55]
  v_mfma_f32_16x16x32_bf16 v[60:63], a[116:119], v[20:23], v[60:63]
  ds_read_b128 v[16:19], v6 offset:24576
  s_waitcnt lgkmcnt(4)
  v_mfma_f32_16x16x32_bf16 v[40:43], a[120:123], v[24:27], v[40:43]
  v_mfma_f32_16x16x32_bf16 v[48:51], a[124:127], v[24:27], v[48:51]
  v_mfma_f32_16x16x32_bf16 v[56:59], a[128:131], v[24:27], v[56:59]
  ds_read_b128 v[20:23], v6 offset:26624
  s_waitcnt lgkmcnt(4)
  v_mfma_f32_16x16x32_bf16 v[44:47], a[120:123], v[28:31], v[44:47]
  v_mfma_f32_16x16x32_bf16 v[52:55], a[124:127], v[28:31], v[52:55]
  v_mfma_f32_16x16x32_bf16 v[60:63], a[128:131], v[28:31], v[60:63]
  ds_read_b128 v[24:27], v7 offset:24576
  s_waitcnt lgkmcnt(4)
  v_mfma_f32_16x16x32_bf16 v[40:43], a[132:135], v[32:35], v[40:43]
  v_mfma_f32_16x16x32_bf16 v[48:51], a[136:139], v[32:35], v[48:51]
  v_mfma_f32_16x16x32_bf16 v[56:59], a[140:143], v[32:35], v[56:59]
  ds_read_b128 v[28:31], v7 offset:26624
  s_waitcnt lgkmcnt(4)
  v_mfma_f32_16x16x32_bf16 v[44:47], a[132:135], v[36:39], v[44:47]
  v_mfma_f32_16x16x32_bf16 v[52:55], a[136:139], v[36:39], v[52:55]
  v_mfma_f32_16x16x32_bf16 v[60:63], a[140:143], v[36:39], v[60:63]
  ds_read_b128 v[32:35], v6 offset:28672
  s_waitcnt lgkmcnt(4)
  v_mfma_f32_16x16x32_bf16 v[40:43], a[144:147], v[16:19], v[40:43]
  v_mfma_f32_16x16x32_bf16 v[48:51], a[148:151], v[16:19], v[48:51]
  v_mfma_f32_16x16x32_bf16 v[56:59], a[152:155], v[16:19], v[56:59]
  ds_read_b128 v[36:39], v6 offset:30720
  s_waitcnt lgkmcnt(4)
  v_mfma_f32_16x16x32_bf16 v[44:47], a[144:147], v[20:23], v[44:47]
  v_mfma_f32_16x16x32_bf16 v[52:55], a[148:151], v[20:23], v[52:55]
  v_mfma_f32_16x16x32_bf16 v[60:63], a[152:155], v[20:23], v[60:63]
  ds_read_b128 v[16:19], v7 offset:28672
  s_waitcnt lgkmcnt(4)
  v_mfma_f32_16x16x32_bf16 v[40:43], a[156:159], v[24:27], v[40:43]
  v_mfma_f32_16x16x32_bf16 v[48:51], a[160:163], v[24:27], v[48:51]
  v_mfma_f32_16x16x32_bf16 v[56:59], a[164:167], v[24:27], v[56:59]
  ds_read_b128 v[20:23], v7 offset:30720
  s_waitcnt lgkmcnt(4)
  v_mfma_f32_16x16x32_bf16 v[44:47], a[156:159], v[28:31], v[44:47]
  v_mfma_f32_16x16x32_bf16 v[52:55], a[160:163], v[28:31], v[52:55]
  v_mfma_f32_16x16x32_bf16 v[60:63], a[164:167], v[28:31], v[60:63]
  ds_read_b128 v[24:27], v6 offset:32768
  s_waitcnt lgkmcnt(4)
  v_mfma_f32_16x16x32_bf16 v[40:43], a[168:171], v[32:35], v[40:43]
  v_mfma_f32_16x16x32_bf16 v[48:51], a[172:175], v[32:35], v[48:51]
  v_mfma_f32_16x16x32_bf16 v[56:59], a[176:179], v[32:35], v[56:59]
  ds_read_b128 v[28:31], v6 offset:34816
  s_waitcnt lgkmcnt(4)
  v_mfma_f32_16x16x32_bf16 v[44:47], a[168:171], v[36:39], v[44:47]
  v_mfma_f32_16x16x32_bf16 v[52:55], a[172:175], v[36:39], v[52:55]
  v_mfma_f32_16x16x32_bf16 v[60:63], a[176:179], v[36:39], v[60:63]
  ds_read_b128 v[32:35], v7 offset:32768
  s_waitcnt lgkmcnt(4)
  v_mfma_f32_16x16x32_bf16 v[40:43], a[180:183], v[16:19], v[40:43]
  v_mfma_f32_16x16x32_bf16 v[48:51], a[184:187], v[16:19], v[48:51]
  v_mfma_f32_16x16x32_bf16 v[56:59], a[188:191], v[16:19], v[56:59]
  ds_read_b128 v[36:39], v7 offset:34816
  s_waitcnt lgkmcnt(4)
  v_mfma_f32_16x16x32_bf16 v[44:47], a[180:183], v[20:23], v[44:47]
  v_mfma_f32_16x16x32_bf16 v[52:55], a[184:187], v[20:23], v[52:55]
  v_mfma_f32_16x16x32_bf16 v[60:63], a[188:191], v[20:23], v[60:63]
  ds_read_b128 v[16:19], v6 offset:36864
  s_waitcnt lgkmcnt(4)
  v_mfma_f32_16x16x32_bf16 v[40:43], a[192:195], v[24:27], v[40:43]
  v_mfma_f32_16x16x32_bf16 v[48:51], a[196:199], v[24:27], v[48:51]
  v_mfma_f32_16x16x32_bf16 v[56:59], a[200:203], v[24:27], v[56:59]
  ds_read_b128 v[20:23], v6 offset:38912
  s_waitcnt lgkmcnt(4)
  v_mfma_f32_16x16x32_bf16 v[44:47], a[192:195], v[28:31], v[44:47]
  v_mfma_f32_16x16x32_bf16 v[52:55], a[196:199], v[28:31], v[52:55]
  v_mfma_f32_16x16x32_bf16 v[60:63], a[200:203], v[28:31], v[60:63]
  ds_read_b128 v[24:27], v7 offset:36864
  s_waitcnt lgkmcnt(4)
  v_mfma_f32_16x16x32_bf16 v[40:43], a[204:207], v[32:35], v[40:43]
  v_mfma_f32_16x16x32_bf16 v[48:51], a[208:211], v[32:35], v[48:51]
  v_mfma_f32_16x16x32_bf16 v[56:59], a[212:215], v[32:35], v[56:59]
  ds_read_b128 v[28:31], v7 offset:38912
  s_waitcnt lgkmcnt(4)
  v_mfma_f32_16x16x32_bf16 v[44:47], a[204:207], v[36:39], v[44:47]
  v_mfma_f32_16x16x32_bf16 v[52:55], a[208:211], v[36:39], v[52:55]
  v_mfma_f32_16x16x32_bf16 v[60:63], a[212:215], v[36:39], v[60:63]
  s_waitcnt lgkmcnt(3)
  v_mfma_f32_16x16x32_bf16 v[40:43], a[216:219], v[16:19], v[40:43]
  v_mfma_f32_16x16x32_bf16 v[48:51], a[220:223], v[16:19], v[48:51]
  v_mfma_f32_16x16x32_bf16 v[56:59], a[224:227], v[16:19], v[56:59]
  s_waitcnt lgkmcnt(2)
  v_mfma_f32_16x16x32_bf16 v[44:47], a[216:219], v[20:23], v[44:47]
  v_mfma_f32_16x16x32_bf16 v[52:55], a[220:223], v[20:23], v[52:55]
  v_mfma_f32_16x16x32_bf16 v[60:63], a[224:227], v[20:23], v[60:63]
  s_waitcnt lgkmcnt(1)
  v_mfma_f32_16x16x32_bf16 v[40:43], a[228:231], v[24:27], v[40:43]
  v_mfma_f32_16x16x32_bf16 v[48:51], a[232:235], v[24:27], v[48:51]
  v_mfma_f32_16x16x32_bf16 v[56:59], a[236:239], v[24:27], v[56:59]
  s_waitcnt lgkmcnt(0)
  v_mfma_f32_16x16x32_bf16 v[44:47], a[228:231], v[28:31], v[44:47]
  v_mfma_f32_16x16x32_bf16 v[52:55], a[232:235], v[28:31], v[52:55]
  v_mfma_f32_16x16x32_bf16 v[60:63], a[236:239], v[28:31], v[60:63]
  s_waitcnt vmcnt(0)
  s_barrier
  v_xor_b32 v6, 122880, v6
  v_xor_b32 v7, 122880, v7
  s_mul_i32 s55, s52, 12288
  s_add_u32 s55, s55, s63
  s_add_u32 s56, s55, 4096
  s_cmp_lg_u32 s42, 0
  s_cbranch_scc1 pj_noflag_3
  s_cmp_eq_u32 s52, s61
  s_cbranch_scc1 pj_noflag_3
  v_mov_b32 v10, s52
  s_mov_b64 exec, 1
  buffer_store_dword v10, v9, s[8:11], 0 offen sc1
  s_mov_b64 exec, -1
pj_noflag_3:
  v_cvt_pk_bf16_f32 v64, v40, v41
  v_cvt_pk_bf16_f32 v65, v42, v43
  v_cvt_pk_bf16_f32 v66, v44, v45
  v_cvt_pk_bf16_f32 v67, v46, v47
  v_cvt_pk_bf16_f32 v68, v48, v49
  v_cvt_pk_bf16_f32 v69, v50, v51
  v_cvt_pk_bf16_f32 v70, v52, v53
  v_cvt_pk_bf16_f32 v71, v54, v55
  v_cvt_pk_bf16_f32 v72, v56, v57
  v_cvt_pk_bf16_f32 v73, v58, v59
  v_cvt_pk_bf16_f32 v74, v60, v61
  v_cvt_pk_bf16_f32 v75, v62, v63
  v_permlane16_swap_b32 v64, v66
  v_permlane16_swap_b32 v65, v67
  buffer_store_dwordx4 v[64:67], v8, s[8:11], s55 offen offset:0 sc1
  v_permlane16_swap_b32 v68, v70
  v_permlane16_swap_b32 v69, v71
  buffer_store_dwordx4 v[68:71], v8, s[8:11], s55 offen offset:2048 sc1
  v_permlane16_swap_b32 v72, v74
  v_permlane16_swap_b32 v73, v75
  buffer_store_dwordx4 v[72:75], v8, s[8:11], s56 offen offset:0 sc1
  s_cmp_lg_u32 s52, s61
  s_cbranch_scc1 pj_noeag_4
  s_waitcnt vmcnt(0)
  s_barrier
  s_cmp_lg_u32 s42, 0
  s_cbranch_scc1 pj_noeag_4
  v_mov_b32 v10, s57
  s_mov_b64 exec, 1
  buffer_store_dword v10, v9, s[8:11], 0 offen sc1
  s_mov_b64 exec, -1
pj_noeag_4:
  s_mov_b32 s52, s57
  s_cmp_lt_u32 s52, s62
  s_cbranch_scc1 pj_loop_1
  s_waitcnt vmcnt(0)
  s_barrier
  s_cmp_lg_u32 s42, 0
  s_cbranch_scc1 pj_fin_5
  v_mov_b32 v10, s52
  s_mov_b64 exec, 1
  buffer_store_dword v10, v9, s[8:11], 0 offen sc1
  s_mov_b64 exec, -1
pj_fin_5:
  s_branch L_parta
L_uw:
  s_mov_b32 s4, s32
  s_mov_b32 s5, s33
  s_mov_b32 s6, 7864320
  s_mov_b32 s7, 0x20000
  v_lshrrev_b32 v8, 3, v0
  v_lshrrev_b32 v9, 2, v8
  v_lshlrev_b32 v9, 3, v9
  v_and_b32 v1, 3, v8
  v_add_u32 v1, v1, v9
  s_and_b32 s46, s42, 1
  s_lshl_b32 s46, s46, 2
  s_lshr_b32 s47, s42, 1
  s_lshl_b32 s47, s47, 4
  s_add_u32 s46, s46, s47
  v_add_u32 v1, s46, v1
  v_mul_u32_u24 v1, 1280, v1
  v_lshrrev_b32 v8, 1, v8
  v_bfe_u32 v9, v0, 1, 2
  v_xor_b32 v8, v8, v9
  v_lshlrev_b32 v8, 5, v8
  v_and_b32 v9, 1, v0
  v_lshlrev_b32 v9, 4, v9
  v_add3_u32 v1, v1, v8, v9
  v_lshrrev_b32 v8, 5, v0
  v_lshlrev_b32 v2, 11, v8
  v_bfe_u32 v8, v0, 2, 3
  v_lshl_add_u32 v2, v8, 7, v2
  v_lshrrev_b32 v8, 1, v8
  v_xor_b32 v8, s42, v8
  v_lshl_add_u32 v2, v8, 5, v2
  v_and_b32 v8, 3, v0
  v_lshl_add_u32 v2, v8, 3, v2
  v_add_u32 v3, 0x10000, v2
  v_add_u32 v4, 0x20000, v2
  s_mul_i32 s53, s45, 245760
  v_lshlrev_b32 v5, 4, v0
  s_lshl_b32 s46, s45, 7
  s_add_u32 s47, s46, 2932736
  v_mov_b32 v6, s47
  s_lshl_b32 s47, s42, 2
  s_add_u32 s46, s46, s47
  s_add_u32 s46, s46, 2949120
  v_mov_b32 v7, s46
  s_mul_i32 s54, s45, 786432
  s_add_u32 s54, s54, 58720256
  s_lshl_b32 s55, s45, 10
  s_lshl_b32 s46, s42, 15
  s_add_u32 s55, s55, s46
  s_add_u32 s55, s55, 83886080
  s_mov_b32 s52, 0
  s_mov_b32 s56, 0
  s_add_u32 m0, s51, 0
  s_add_u32 s46, s53, 0
  buffer_load_dwordx4 v1, s[4:7], s46 offen lds
  s_add_u32 m0, s51, 4096
  s_add_u32 s46, s53, 128
  buffer_load_dwordx4 v1, s[4:7], s46 offen lds
  s_add_u32 m0, s51, 8192
  s_add_u32 s46, s53, 256
  buffer_load_dwordx4 v1, s[4:7], s46 offen lds
  s_add_u32 m0, s51, 12288
  s_add_u32 s46, s53, 384
  buffer_load_dwordx4 v1, s[4:7], s46 offen lds
  s_add_u32 m0, s51, 16384
  s_add_u32 s46, s53, 512
  buffer_load_dwordx4 v1, s[4:7], s46 offen lds
  s_add_u32 m0, s51, 20480
  s_add_u32 s46, s53, 640
  buffer_load_dwordx4 v1, s[4:7], s46 offen lds
  s_add_u32 m0, s51, 24576
  s_add_u32 s46, s53, 768
  buffer_load_dwordx4 v1, s[4:7], s46 offen lds
  s_add_u32 m0, s51, 28672
  s_add_u32 s46, s53, 896
  buffer_load_dwordx4 v1, s[4:7], s46 offen lds
  s_add_u32 m0, s51, 32768
  s_add_u32 s46, s53, 1024
  buffer_load_dwordx4 v1, s[4:7], s46 offen lds
  s_add_u32 m0, s51, 36864
  s_add_u32 s46, s53, 1152
  buffer_load_dwordx4 v1, s[4:7], s46 offen lds
  s_add_u32 m0, s51, 40960
  s_add_u32 s46, s53, 40960
  buffer_load_dwordx4 v1, s[4:7], s46 offen lds
  s_add_u32 m0, s51, 45056
  s_add_u32 s46, s53, 41088
  buffer_load_dwordx4 v1, s[4:7], s46 offen lds
  s_add_u32 m0, s51, 49152
  s_add_u32 s46, s53, 41216
  buffer_load_dwordx4 v1, s[4:7], s46 offen lds
  s_add_u32 m0, s51, 53248
  s_add_u32 s46, s53, 41344
  buffer_load_dwordx4 v1, s[4:7], s46 offen lds
  s_add_u32 m0, s51, 57344
  s_add_u32 s46, s53, 41472
  buffer_load_dwordx4 v1, s[4:7], s46 offen lds
  s_add_u32 m0, s51, 61440
  s_add_u32 s46, s53, 41600
  buffer_load_dwordx4 v1, s[4:7], s46 offen lds
  s_add_u32 m0, s51, 65536
  s_add_u32 s46, s53, 41728
  buffer_load_dwordx4 v1, s[4:7], s46 offen lds
  s_add_u32 m0, s51, 69632
  s_add_u32 s46, s53, 41856
  buffer_load_dwordx4 v1, s[4:7], s46 offen lds
  s_add_u32 m0, s51, 73728
  s_add_u32 s46, s53, 41984
  buffer_load_dwordx4 v1, s[4:7], s46 offen lds
  s_add_u32 m0, s51, 77824
  s_add_u32 s46, s53, 42112
  buffer_load_dwordx4 v1, s[4:7], s46 offen lds
  s_add_u32 m0, s51, 81920
  s_add_u32 s46, s53, 81920
  buffer_load_dwordx4 v1, s[4:7], s46 offen lds
  s_add_u32 m0, s51, 86016
  s_add_u32 s46, s53, 82048
  buffer_load_dwordx4 v1, s[4:7], s46 offen lds
  s_add_u32 m0, s51, 90112
  s_add_u32 s46, s53, 82176
  buffer_load_dwordx4 v1, s[4:7], s46 offen lds
  s_add_u32 m0, s51, 94208
  s_add_u32 s46, s53, 82304
  buffer_load_dwordx4 v1, s[4:7], s46 offen lds
  s_add_u32 m0, s51, 98304
  s_add_u32 s46, s53, 82432
  buffer_load_dwordx4 v1, s[4:7], s46 offen lds
  s_add_u32 m0, s51, 102400
  s_add_u32 s46, s53, 82560
  buffer_load_dwordx4 v1, s[4:7], s46 offen lds
  s_add_u32 m0, s51, 106496
  s_add_u32 s46, s53, 82688
  buffer_load_dwordx4 v1, s[4:7], s46 offen lds
  s_add_u32 m0, s51, 110592
  s_add_u32 s46, s53, 82816
  buffer_load_dwordx4 v1, s[4:7], s46 offen lds
  s_add_u32 m0, s51, 114688
  s_add_u32 s46, s53, 82944
  buffer_load_dwordx4 v1, s[4:7], s46 offen lds
  s_add_u32 m0, s51, 118784
  s_add_u32 s46, s53, 83072
  buffer_load_dwordx4 v1, s[4:7], s46 offen lds
  s_waitcnt vmcnt(24)
  s_barrier
  s_add_u32 m0, s51, 122880
  s_add_u32 s46, s53, 122880
  buffer_load_dwordx4 v1, s[4:7], s46 offen lds
  s_add_u32 m0, s51, 126976
  s_add_u32 s46, s53, 123008
  buffer_load_dwordx4 v1, s[4:7], s46 offen lds
  s_add_u32 m0, s51, 131072
  s_add_u32 s46, s53, 123136
  buffer_load_dwordx4 v1, s[4:7], s46 offen lds
  s_add_u32 m0, s51, 135168
  s_add_u32 s46, s53, 123264
  buffer_load_dwordx4 v1, s[4:7], s46 offen lds
  s_add_u32 m0, s51, 139264
  s_add_u32 s46, s53, 123392
  buffer_load_dwordx4 v1, s[4:7], s46 offen lds
  s_add_u32 m0, s51, 143360
  s_add_u32 s46, s53, 123520
  buffer_load_dwordx4 v1, s[4:7], s46 offen lds
  ds_read_b64_tr_b16 a[0:1], v2 offset:0
  ds_read_b64_tr_b16 a[2:3], v2 offset:1024
  ds_read_b64_tr_b16 a[24:25], v2 offset:4096
  ds_read_b64_tr_b16 a[26:27], v2 offset:5120
  ds_read_b64_tr_b16 a[48:49], v2 offset:8192
  ds_read_b64_tr_b16 a[50:51], v2 offset:9216
  ds_read_b64_tr_b16 a[72:73], v2 offset:12288
  ds_read_b64_tr_b16 a[74:75], v2 offset:13312
  ds_read_b64_tr_b16 a[96:97], v2 offset:16384
  ds_read_b64_tr_b16 a[98:99], v2 offset:17408
  ds_read_b64_tr_b16 a[120:121], v2 offset:20480
  ds_read_b64_tr_b16 a[122:123], v2 offset:21504
  s_waitcnt lgkmcnt(0)
  s_waitcnt vmcnt(24)
  s_barrier
  s_add_u32 m0, s51, 0
  s_add_u32 s46, s53, 123648
  buffer_load_dwordx4 v1, s[4:7], s46 offen lds
  s_add_u32 m0, s51, 4096
  s_add_u32 s46, s53, 123776
  buffer_load_dwordx4 v1, s[4:7], s46 offen lds
  s_add_u32 m0, s51, 8192
  s_add_u32 s46, s53, 123904
  buffer_load_dwordx4 v1, s[4:7], s46 offen lds
  s_add_u32 m0, s51, 12288
  s_add_u32 s46, s53, 124032
  buffer_load_dwordx4 v1, s[4:7], s46 offen lds
  s_add_u32 m0, s51, 16384
  s_add_u32 s46, s53, 163840
  buffer_load_dwordx4 v1, s[4:7], s46 offen lds
  s_add_u32 m0, s51, 20480
  s_add_u32 s46, s53, 163968
  buffer_load_dwordx4 v1, s[4:7], s46 offen lds
  ds_read_b64_tr_b16 a[144:145], v2 offset:24576
  ds_read_b64_tr_b16 a[146:147], v2 offset:25600
  ds_read_b64_tr_b16 a[168:169], v2 offset:28672
  ds_read_b64_tr_b16 a[170:171], v2 offset:29696
  ds_read_b64_tr_b16 a[192:193], v2 offset:32768
  ds_read_b64_tr_b16 a[194:195], v2 offset:33792
  ds_read_b64_tr_b16 a[216:217], v2 offset:36864
  ds_read_b64_tr_b16 a[218:219], v2 offset:37888
  ds_read_b64_tr_b16 a[4:5], v2 offset:40960
  ds_read_b64_tr_b16 a[6:7], v2 offset:41984
  ds_read_b64_tr_b16 a[28:29], v2 offset:45056
  ds_read_b64_tr_b16 a[30:31], v2 offset:46080
  s_waitcnt lgkmcnt(0)
  s_waitcnt vmcnt(24)
  s_barrier
  s_add_u32 m0, s51, 24576
  s_add_u32 s46, s53, 164096
  buffer_load_dwordx4 v1, s[4:7], s46 offen lds
  s_add_u32 m0, s51, 28672
  s_add_u32 s46, s53, 164224
  buffer_load_dwordx4 v1, s[4:7], s46 offen lds
  s_add_u32 m0, s51, 32768
  s_add_u32 s46, s53, 164352
  buffer_load_dwordx4 v1, s[4:7], s46 offen lds
  s_add_u32 m0, s51, 36864
  s_add_u32 s46, s53, 164480
  buffer_load_dwordx4 v1, s[4:7], s46 offen lds
  s_add_u32 m0, s51, 40960
  s_add_u32 s46, s53, 164608
  buffer_load_dwordx4 v1, s[4:7], s46 offen lds
  s_add_u32 m0, s51, 45056
  s_add_u32 s46, s53, 164736
  buffer_load_dwordx4 v1, s[4:7], s46 offen lds
  ds_read_b64_tr_b16 a[52:53], v2 offset:49152
  ds_read_b64_tr_b16 a[54:55], v2 offset:50176
  ds_read_b64_tr_b16 a[76:77], v2 offset:53248
  ds_read_b64_tr_b16 a[78:79], v2 offset:54272
  ds_read_b64_tr_b16 a[100:101], v2 offset:57344
  ds_read_b64_tr_b16 a[102:103], v2 offset:58368
  ds_read_b64_tr_b16 a[124:125], v2 offset:61440
  ds_read_b64_tr_b16 a[126:127], v2 offset:62464
  ds_read_b64_tr_b16 a[148:149], v3 offset:0
  ds_read_b64_tr_b16 a[150:151], v3 offset:1024
  ds_read_b64_tr_b16 a[172:173], v3 offset:4096
  ds_read_b64_tr_b16 a[174:175], v3 offset:5120
  s_waitcnt lgkmcnt(0)
  s_waitcnt vmcnt(24)
  s_barrier
  s_add_u32 m0, s51, 49152
  s_add_u32 s46, s53, 164864
  buffer_load_dwordx4 v1, s[4:7], s46 offen lds
  s_add_u32 m0, s51, 53248
  s_add_u32 s46, s53, 164992
  buffer_load_dwordx4 v1, s[4:7], s46 offen lds
  s_add_u32 m0, s51, 57344
  s_add_u32 s46, s53, 204800
  buffer_load_dwordx4 v1, s[4:7], s46 offen lds
  s_add_u32 m0, s51, 61440
  s_add_u32 s46, s53, 204928
  buffer_load_dwordx4 v1, s[4:7], s46 offen lds
  s_add_u32 m0, s51, 65536
  s_add_u32 s46, s53, 205056
  buffer_load_dwordx4 v1, s[4:7], s46 offen lds
  s_add_u32 m0, s51, 69632
  s_add_u32 s46, s53, 205184
  buffer_load_dwordx4 v1, s[4:7], s46 offen lds
  ds_read_b64_tr_b16 a[196:197], v3 offset:8192
  ds_read_b64_tr_b16 a[198:199], v3 offset:9216
  ds_read_b64_tr_b16 a[220:221], v3 offset:12288
  ds_read_b64_tr_b16 a[222:223], v3 offset:13312
  ds_read_b64_tr_b16 a[8:9], v3 offset:16384
  ds_read_b64_tr_b16 a[10:11], v3 offset:17408
  ds_read_b64_tr_b16 a[32:33], v3 offset:20480
  ds_read_b64_tr_b16 a[34:35], v3 offset:21504
  ds_read_b64_tr_b16 a[56:57], v3 offset:24576
  ds_read_b64_tr_b16 a[58:59], v3 offset:25600
  ds_read_b64_tr_b16 a[80:81], v3 offset:28672
  ds_read_b64_tr_b16 a[82:83], v3 offset:29696
  s_waitcnt lgkmcnt(0)
  s_waitcnt vmcnt(24)
  s_barrier
  s_add_u32 m0, s51, 73728
  s_add_u32 s46, s53, 205312
  buffer_load_dwordx4 v1, s[4:7], s46 offen lds
  s_add_u32 m0, s51, 77824
  s_add_u32 s46, s53, 205440
  buffer_load_dwordx4 v1, s[4:7], s46 offen lds
  s_add_u32 m0, s51, 81920
  s_add_u32 s46, s53, 205568
  buffer_load_dwordx4 v1, s[4:7], s46 offen lds
  s_add_u32 m0, s51, 86016
  s_add_u32 s46, s53, 205696
  buffer_load_dwordx4 v1, s[4:7], s46 offen lds
  s_add_u32 m0, s51, 90112
  s_add_u32 s46, s53, 205824
  buffer_load_dwordx4 v1, s[4:7], s46 offen lds
  s_add_u32 m0, s51, 94208
  s_add_u32 s46, s53, 205952
  buffer_load_dwordx4 v1, s[4:7], s46 offen lds
  ds_read_b64_tr_b16 a[104:105], v3 offset:32768
  ds_read_b64_tr_b16 a[106:107], v3 offset:33792
  ds_read_b64_tr_b16 a[128:129], v3 offset:36864
  ds_read_b64_tr_b16 a[130:131], v3 offset:37888
  ds_read_b64_tr_b16 a[152:153], v3 offset:40960
  ds_read_b64_tr_b16 a[154:155], v3 offset:41984
  ds_read_b64_tr_b16 a[176:177], v3 offset:45056
  ds_read_b64_tr_b16 a[178:179], v3 offset:46080
  ds_read_b64_tr_b16 a[200:201], v3 offset:49152
  ds_read_b64_tr_b16 a[202:203], v3 offset:50176
  ds_read_b64_tr_b16 a[224:225], v3 offset:53248
  ds_read_b64_tr_b16 a[226:227], v3 offset:54272
  s_waitcnt lgkmcnt(0)
  s_waitcnt vmcnt(24)
  s_barrier
  ds_read_b64_tr_b16 a[12:13], v3 offset:57344
  ds_read_b64_tr_b16 a[14:15], v3 offset:58368
  ds_read_b64_tr_b16 a[36:37], v3 offset:61440
  ds_read_b64_tr_b16 a[38:39], v3 offset:62464
  ds_read_b64_tr_b16 a[60:61], v4 offset:0
  ds_read_b64_tr_b16 a[62:63], v4 offset:1024
  ds_read_b64_tr_b16 a[84:85], v4 offset:4096
  ds_read_b64_tr_b16 a[86:87], v4 offset:5120
  ds_read_b64_tr_b16 a[108:109], v4 offset:8192
  ds_read_b64_tr_b16 a[110:111], v4 offset:9216
  ds_read_b64_tr_b16 a[132:133], v4 offset:12288
  ds_read_b64_tr_b16 a[134:135], v4 offset:13312
  s_waitcnt lgkmcnt(0)
  s_waitcnt vmcnt(18)
  s_barrier
  ds_read_b64_tr_b16 a[156:157], v2 offset:0
  ds_read_b64_tr_b16 a[158:159], v2 offset:1024
  ds_read_b64_tr_b16 a[180:181], v2 offset:4096
  ds_read_b64_tr_b16 a[182:183], v2 offset:5120
  ds_read_b64_tr_b16 a[204:205], v2 offset:8192
  ds_read_b64_tr_b16 a[206:207], v2 offset:9216
  ds_read_b64_tr_b16 a[228:229], v2 offset:12288
  ds_read_b64_tr_b16 a[230:231], v2 offset:13312
  ds_read_b64_tr_b16 a[16:17], v2 offset:16384
  ds_read_b64_tr_b16 a[18:19], v2 offset:17408
  ds_read_b64_tr_b16 a[40:41], v2 offset:20480
  ds_read_b64_tr_b16 a[42:43], v2 offset:21504
  s_waitcnt lgkmcnt(0)
  s_waitcnt vmcnt(12)
  s_barrier
  ds_read_b64_tr_b16 a[64:65], v2 offset:24576
  ds_read_b64_tr_b16 a[66:67], v2 offset:25600
  ds_read_b64_tr_b16 a[88:89], v2 offset:28672
  ds_read_b64_tr_b16 a[90:91], v2 offset:29696
  ds_read_b64_tr_b16 a[112:113], v2 offset:32768
  ds_read_b64_tr_b16 a[114:115], v2 offset:33792
  ds_read_b64_tr_b16 a[136:137], v2 offset:36864
  ds_read_b64_tr_b16 a[138:139], v2 offset:37888
  ds_read_b64_tr_b16 a[160:161], v2 offset:40960
  ds_read_b64_tr_b16 a[162:163], v2 offset:41984
  ds_read_b64_tr_b16 a[184:185], v2 offset:45056
  ds_read_b64_tr_b16 a[186:187], v2 offset:46080
  s_waitcnt lgkmcnt(0)
  s_waitcnt vmcnt(6)
  s_barrier
  ds_read_b64_tr_b16 a[208:209], v2 offset:49152
  ds_read_b64_tr_b16 a[210:211], v2 offset:50176
  ds_read_b64_tr_b16 a[232:233], v2 offset:53248
  ds_read_b64_tr_b16 a[234:235], v2 offset:54272
  ds_read_b64_tr_b16 a[20:21], v2 offset:57344
  ds_read_b64_tr_b16 a[22:23], v2 offset:58368
  ds_read_b64_tr_b16 a[44:45], v2 offset:61440
  ds_read_b64_tr_b16 a[46:47], v2 offset:62464
  ds_read_b64_tr_b16 a[68:69], v3 offset:0
  ds_read_b64_tr_b16 a[70:71], v3 offset:1024
  ds_read_b64_tr_b16 a[92:93], v3 offset:4096
  ds_read_b64_tr_b16 a[94:95], v3 offset:5120
  s_waitcnt lgkmcnt(0)
  s_waitcnt vmcnt(0)
  s_barrier
  ds_read_b64_tr_b16 a[116:117], v3 offset:8192
  ds_read_b64_tr_b16 a[118:119], v3 offset:9216
  ds_read_b64_tr_b16 a[140:141], v3 offset:12288
  ds_read_b64_tr_b16 a[142:143], v3 offset:13312
  ds_read_b64_tr_b16 a[164:165], v3 offset:16384
  ds_read_b64_tr_b16 a[166:167], v3 offset:17408
  ds_read_b64_tr_b16 a[188:189], v3 offset:20480
  ds_read_b64_tr_b16 a[190:191], v3 offset:21504
  ds_read_b64_tr_b16 a[212:213], v3 offset:24576
  ds_read_b64_tr_b16 a[214:215], v3 offset:25600
  ds_read_b64_tr_b16 a[236:237], v3 offset:28672
  ds_read_b64_tr_b16 a[238:239], v3 offset:29696
  s_waitcnt lgkmcnt(0)
  s_barrier
  s_mov_b32 s57, 1
  s_cmp_ge_u32 s56, s57
  s_cbranch_scc1 wf_done_6
  s_mov_b32 s50, 0
wf_loop_7:
  buffer_load_dword v8, v6, s[8:11], 0 offen sc1
  s_add_u32 s50, s50, 1
  s_cmp_gt_u32 s50, 2097152
  s_cbranch_scc1 L_fail
  s_waitcnt vmcnt(0)
  v_readfirstlane_b32 s56, v8
  s_nop 0
  s_cmp_lt_u32 s56, s57
  s_cbranch_scc1 wf_loop_7
wf_done_6:
  s_add_u32 s46, s54, 0
  buffer_load_dwordx4 v[16:19], v5, s[8:11], s46 offen offset:0 sc1
  buffer_load_dwordx4 v[20:23], v5, s[8:11], s46 offen offset:1024 sc1
  buffer_load_dwordx4 v[24:27], v5, s[8:11], s46 offen offset:2048 sc1
  buffer_load_dwordx4 v[28:31], v5, s[8:11], s46 offen offset:3072 sc1
  s_add_u32 s46, s54, 4096
  buffer_load_dwordx4 v[32:35], v5, s[8:11], s46 offen offset:0 sc1
  buffer_load_dwordx4 v[36:39], v5, s[8:11], s46 offen offset:1024 sc1
  buffer_load_dwordx4 v[40:43], v5, s[8:11], s46 offen offset:2048 sc1
  buffer_load_dwordx4 v[44:47], v5, s[8:11], s46 offen offset:3072 sc1
  s_add_u32 s46, s54, 8192
  buffer_load_dwordx4 v[48:51], v5, s[8:11], s46 offen offset:0 sc1
  buffer_load_dwordx4 v[52:55], v5, s[8:11], s46 offen offset:1024 sc1
  buffer_load_dwordx4 v[56:59], v5, s[8:11], s46 offen offset:2048 sc1
  buffer_load_dwordx4 v[60:63], v5, s[8:11], s46 offen offset:3072 sc1
  s_add_u32 s54, s54, 12288
  s_waitcnt vmcnt(0)
u_loop_8:
  s_add_u32 s57, s52, 2
  s_cmp_gt_u32 s57, 64
  s_cbranch_scc1 u_nold_9
  s_cmp_eq_u32 s52, 0
  s_cbranch_scc1 u_nold_9
  s_cmp_ge_u32 s56, s57
  s_cbranch_scc1 wf_done_12
  s_mov_b32 s50, 0
wf_loop_13:
  buffer_load_dword v8, v6, s[8:11], 0 offen sc1
  s_add_u32 s50, s50, 1
  s_cmp_gt_u32 s50, 2097152
  s_cbranch_scc1 L_fail
  s_waitcnt vmcnt(0)
  v_readfirstlane_b32 s56, v8
  s_nop 0
  s_cmp_lt_u32 s56, s57
  s_cbranch_scc1 wf_loop_13
wf_done_12:
  s_add_u32 s46, s54, 0
  buffer_load_dwordx4 v[64:67], v5, s[8:11], s46 offen offset:0 sc1
  buffer_load_dwordx4 v[68:71], v5, s[8:11], s46 offen offset:1024 sc1
  buffer_load_dwordx4 v[72:75], v5, s[8:11], s46 offen offset:2048 sc1
  buffer_load_dwordx4 v[76:79], v5, s[8:11], s46 offen offset:3072 sc1
  s_add_u32 s46, s54, 4096
  buffer_load_dwordx4 v[80:83], v5, s[8:11], s46 offen offset:0 sc1
  buffer_load_dwordx4 v[84:87], v5, s[8:11], s46 offen offset:1024 sc1
  buffer_load_dwordx4 v[88:91], v5, s[8:11], s46 offen offset:2048 sc1
  buffer_load_dwordx4 v[92:95], v5, s[8:11], s46 offen offset:3072 sc1
  s_add_u32 s46, s54, 8192
  buffer_load_dwordx4 v[96:99], v5, s[8:11], s46 offen offset:0 sc1
  buffer_load_dwordx4 v[100:103], v5, s[8:11], s46 offen offset:1024 sc1
  buffer_load_dwordx4 v[104:107], v5, s[8:11], s46 offen offset:2048 sc1
  buffer_load_dwordx4 v[108:111], v5, s[8:11], s46 offen offset:3072 sc1
  s_add_u32 s54, s54, 12288
u_nold_9:
  v_mfma_f32_16x16x32_bf16 v[112:115], v[16:19], a[0:3], 0
  v_mfma_f32_16x16x32_bf16 v[116:119], v[40:43], a[0:3], 0
  v_mfma_f32_16x16x32_bf16 v[112:115], v[20:23], a[4:7], v[112:115]
  v_mfma_f32_16x16x32_bf16 v[116:119], v[44:47], a[4:7], v[116:119]
  v_mfma_f32_16x16x32_bf16 v[112:115], v[24:27], a[8:11], v[112:115]
  v_mfma_f32_16x16x32_bf16 v[116:119], v[48:51], a[8:11], v[116:119]
  v_mfma_f32_16x16x32_bf16 v[112:115], v[28:31], a[12:15], v[112:115]
  v_mfma_f32_16x16x32_bf16 v[116:119], v[52:55], a[12:15], v[116:119]
  v_mfma_f32_16x16x32_bf16 v[112:115], v[32:35], a[16:19], v[112:115]
  v_mfma_f32_16x16x32_bf16 v[116:119], v[56:59], a[16:19], v[116:119]
  v_mfma_f32_16x16x32_bf16 v[112:115], v[36:39], a[20:23], v[112:115]
  v_mfma_f32_16x16x32_bf16 v[116:119], v[60:63], a[20:23], v[116:119]
  v_mfma_f32_16x16x32_bf16 v[120:123], v[16:19], a[24:27], 0
  v_mfma_f32_16x16x32_bf16 v[124:127], v[40:43], a[24:27], 0
  v_mfma_f32_16x16x32_bf16 v[120:123], v[20:23], a[28:31], v[120:123]
  v_mfma_f32_16x16x32_bf16 v[124:127], v[44:47], a[28:31], v[124:127]
  v_mfma_f32_16x16x32_bf16 v[120:123], v[24:27], a[32:35], v[120:123]
  v_mfma_f32_16x16x32_bf16 v[124:127], v[48:51], a[32:35], v[124:127]
  v_mfma_f32_16x16x32_bf16 v[120:123], v[28:31], a[36:39], v[120:123]
  v_mfma_f32_16x16x32_bf16 v[124:127], v[52:55], a[36:39], v[124:127]
  v_cvt_pk_bf16_f32 v136, v112, v113
  v_cvt_pk_bf16_f32 v137, v114, v115
  v_mfma_f32_16x16x32_bf16 v[120:123], v[32:35], a[40:43], v[120:123]
  v_cvt_pk_bf16_f32 v138, v116, v117
  v_cvt_pk_bf16_f32 v139, v118, v119
  v_mfma_f32_16x16x32_bf16 v[124:127], v[56:59], a[40:43], v[124:127]
  s_add_u32 s58, s55, 0
  buffer_store_dwordx4 v[136:139], v5, s[8:11], s58 offen sc1
  v_mfma_f32_16x16x32_bf16 v[120:123], v[36:39], a[44:47], v[120:123]
  v_mfma_f32_16x16x32_bf16 v[124:127], v[60:63], a[44:47], v[124:127]
  v_mfma_f32_16x16x32_bf16 v[128:131], v[16:19], a[48:51], 0
  v_mfma_f32_16x16x32_bf16 v[132:135], v[40:43], a[48:51], 0
  v_mfma_f32_16x16x32_bf16 v[128:131], v[20:23], a[52:55], v[128:131]
  v_mfma_f32_16x16x32_bf16 v[132:135], v[44:47], a[52:55], v[132:135]
  v_mfma_f32_16x16x32_bf16 v[128:131], v[24:27], a[56:59], v[128:131]
  v_mfma_f32_16x16x32_bf16 v[132:135], v[48:51], a[56:59], v[132:135]
  v_mfma_f32_16x16x32_bf16 v[128:131], v[28:31], a[60:63], v[128:131]
  v_mfma_f32_16x16x32_bf16 v[132:135], v[52:55], a[60:63], v[132:135]
  v_cvt_pk_bf16_f32 v140, v120, v121
  v_cvt_pk_bf16_f32 v141, v122, v123
  v_mfma_f32_16x16x32_bf16 v[128:131], v[32:35], a[64:67], v[128:131]
  v_cvt_pk_bf16_f32 v142, v124, v125
  v_cvt_pk_bf16_f32 v143, v126, v127
  v_mfma_f32_16x16x32_bf16 v[132:135], v[56:59], a[64:67], v[132:135]
  s_add_u32 s58, s55, 131072
  buffer_store_dwordx4 v[140:143], v5, s[8:11], s58 offen sc1
  v_mfma_f32_16x16x32_bf16 v[128:131], v[36:39], a[68:71], v[128:131]
  v_mfma_f32_16x16x32_bf16 v[132:135], v[60:63], a[68:71], v[132:135]
  v_mfma_f32_16x16x32_bf16 v[112:115], v[16:19], a[72:75], 0
  v_mfma_f32_16x16x32_bf16 v[116:119], v[40:43], a[72:75], 0
  v_mfma_f32_16x16x32_bf16 v[112:115], v[20:23], a[76:79], v[112:115]
  v_mfma_f32_16x16x32_bf16 v[116:119], v[44:47], a[76:79], v[116:119]
  v_mfma_f32_16x16x32_bf16 v[112:115], v[24:27], a[80:83], v[112:115]
  v_mfma_f32_16x16x32_bf16 v[116:119], v[48:51], a[80:83], v[116:119]
  v_mfma_f32_16x16x32_bf16 v[112:115], v[28:31], a[84:87], v[112:115]
  v_mfma_f32_16x16x32_bf16 v[116:119], v[52:55], a[84:87], v[116:119]
  v_cvt_pk_bf16_f32 v144, v128, v129
  v_cvt_pk_bf16_f32 v145, v130, v131
  v_mfma_f32_16x16x32_bf16 v[112:115], v[32:35], a[88:91], v[112:115]
  v_cvt_pk_bf16_f32 v146, v132, v133
  v_cvt_pk_bf16_f32 v147, v134, v135
  v_mfma_f32_16x16x32_bf16 v[116:119], v[56:59], a[88:91], v[116:119]
  s_add_u32 s58, s55, 262144
  buffer_store_dwordx4 v[144:147], v5, s[8:11], s58 offen sc1
  v_mfma_f32_16x16x32_bf16 v[112:115], v[36:39], a[92:95], v[112:115]
  v_mfma_f32_16x16x32_bf16 v[116:119], v[60:63], a[92:95], v[116:119]
  v_mfma_f32_16x16x32_bf16 v[120:123], v[16:19], a[96:99], 0
  v_mfma_f32_16x16x32_bf16 v[124:127], v[40:43], a[96:99], 0
  v_mfma_f32_16x16x32_bf16 v[120:123], v[20:23], a[100:103], v[120:123]
  v_mfma_f32_16x16x32_bf16 v[124:127], v[44:47], a[100:103], v[124:127]
  v_mfma_f32_16x16x32_bf16 v[120:123], v[24:27], a[104:107], v[120:123]
  v_mfma_f32_16x16x32_bf16 v[124:127], v[48:51], a[104:107], v[124:127]
  v_mfma_f32_16x16x32_bf16 v[120:123], v[28:31], a[108:111], v[120:123]
  v_mfma_f32_16x16x32_bf16 v[124:127], v[52:55], a[108:111], v[124:127]
  v_cvt_pk_bf16_f32 v136, v112, v113
  v_cvt_pk_bf16_f32 v137, v114, v115
  v_mfma_f32_16x16x32_bf16 v[120:123], v[32:35], a[112:115], v[120:123]
  v_cvt_pk_bf16_f32 v138, v116, v117
  v_cvt_pk_bf16_f32 v139, v118, v119
  v_mfma_f32_16x16x32_bf16 v[124:127], v[56:59], a[112:115], v[124:127]
  s_add_u32 s58, s55, 393216
  buffer_store_dwordx4 v[136:139], v5, s[8:11], s58 offen sc1
  v_mfma_f32_16x16x32_bf16 v[120:123], v[36:39], a[116:119], v[120:123]
  v_mfma_f32_16x16x32_bf16 v[124:127], v[60:63], a[116:119], v[124:127]
  v_mfma_f32_16x16x32_bf16 v[128:131], v[16:19], a[120:123], 0
  v_mfma_f32_16x16x32_bf16 v[132:135], v[40:43], a[120:123], 0
  v_mfma_f32_16x16x32_bf16 v[128:131], v[20:23], a[124:127], v[128:131]
  v_mfma_f32_16x16x32_bf16 v[132:135], v[44:47], a[124:127], v[132:135]
  v_mfma_f32_16x16x32_bf16 v[128:131], v[24:27], a[128:131], v[128:131]
  v_mfma_f32_16x16x32_bf16 v[132:135], v[48:51], a[128:131], v[132:135]
  v_mfma_f32_16x16x32_bf16 v[128:131], v[28:31], a[132:135], v[128:131]
  v_mfma_f32_16x16x32_bf16 v[132:135], v[52:55], a[132:135], v[132:135]
  v_cvt_pk_bf16_f32 v140, v120, v121
  v_cvt_pk_bf16_f32 v141, v122, v123
  v_mfma_f32_16x16x32_bf16 v[128:131], v[32:35], a[136:139], v[128:131]
  v_cvt_pk_bf16_f32 v142, v124, v125
  v_cvt_pk_bf16_f32 v143, v126, v127
  v_mfma_f32_16x16x32_bf16 v[132:135], v[56:59], a[136:139], v[132:135]
  s_add_u32 s58, s55, 524288
  buffer_store_dwordx4 v[140:143], v5, s[8:11], s58 offen sc1
  v_mfma_f32_16x16x32_bf16 v[128:131], v[36:39], a[140:143], v[128:131]
  v_mfma_f32_16x16x32_bf16 v[132:135], v[60:63], a[140:143], v[132:135]
  v_mfma_f32_16x16x32_bf16 v[112:115], v[16:19], a[144:147], 0
  v_mfma_f32_16x16x32_bf16 v[116:119], v[40:43], a[144:147], 0
  v_mfma_f32_16x16x32_bf16 v[112:115], v[20:23], a[148:151], v[112:115]
  v_mfma_f32_16x16x32_bf16 v[116:119], v[44:47], a[148:151], v[116:119]
  v_mfma_f32_16x16x32_bf16 v[112:115], v[24:27], a[152:155], v[112:115]
  v_mfma_f32_16x16x32_bf16 v[116:119], v[48:51], a[152:155], v[116:119]
  v_mfma_f32_16x16x32_bf16 v[112:115], v[28:31], a[156:159], v[112:115]
  v_mfma_f32_16x16x32_bf16 v[116:119], v[52:55], a[156:159], v[116:119]
  v_cvt_pk_bf16_f32 v144, v128, v129
  v_cvt_pk_bf16_f32 v145, v130, v131
  v_mfma_f32_16x16x32_bf16 v[112:115], v[32:35], a[160:163], v[112:115]
  v_cvt_pk_bf16_f32 v146, v132, v133
  v_cvt_pk_bf16_f32 v147, v134, v135
  v_mfma_f32_16x16x32_bf16 v[116:119], v[56:59], a[160:163], v[116:119]
  s_add_u32 s58, s55, 655360
  buffer_store_dwordx4 v[144:147], v5, s[8:11], s58 offen sc1
  v_mfma_f32_16x16x32_bf16 v[112:115], v[36:39], a[164:167], v[112:115]
  v_mfma_f32_16x16x32_bf16 v[116:119], v[60:63], a[164:167], v[116:119]
  v_mfma_f32_16x16x32_bf16 v[120:123], v[16:19], a[168:171], 0
  v_mfma_f32_16x16x32_bf16 v[124:127], v[40:43], a[168:171], 0
  v_mfma_f32_16x16x32_bf16 v[120:123], v[20:23], a[172:175], v[120:123]
  v_mfma_f32_16x16x32_bf16 v[124:127], v[44:47], a[172:175], v[124:127]
  v_mfma_f32_16x16x32_bf16 v[120:123], v[24:27], a[176:179], v[120:123]
  v_mfma_f32_16x16x32_bf16 v[124:127], v[48:51], a[176:179], v[124:127]
  v_mfma_f32_16x16x32_bf16 v[120:123], v[28:31], a[180:183], v[120:123]
  v_mfma_f32_16x16x32_bf16 v[124:127], v[52:55], a[180:183], v[124:127]
  v_cvt_pk_bf16_f32 v136, v112, v113
  v_cvt_pk_bf16_f32 v137, v114, v115
  v_mfma_f32_16x16x32_bf16 v[120:123], v[32:35], a[184:187], v[120:123]
  v_cvt_pk_bf16_f32 v138, v116, v117
  v_cvt_pk_bf16_f32 v139, v118, v119
  v_mfma_f32_16x16x32_bf16 v[124:127], v[56:59], a[184:187], v[124:127]
  s_add_u32 s58, s55, 786432
  buffer_store_dwordx4 v[136:139], v5, s[8:11], s58 offen sc1
  v_mfma_f32_16x16x32_bf16 v[120:123], v[36:39], a[188:191], v[120:123]
  v_mfma_f32_16x16x32_bf16 v[124:127], v[60:63], a[188:191], v[124:127]
  v_mfma_f32_16x16x32_bf16 v[128:131], v[16:19], a[192:195], 0
  v_mfma_f32_16x16x32_bf16 v[132:135], v[40:43], a[192:195], 0
  v_mfma_f32_16x16x32_bf16 v[128:131], v[20:23], a[196:199], v[128:131]
  v_mfma_f32_16x16x32_bf16 v[132:135], v[44:47], a[196:199], v[132:135]
  v_mfma_f32_16x16x32_bf16 v[128:131], v[24:27], a[200:203], v[128:131]
  v_mfma_f32_16x16x32_bf16 v[132:135], v[48:51], a[200:203], v[132:135]
  v_mfma_f32_16x16x32_bf16 v[128:131], v[28:31], a[204:207], v[128:131]
  v_mfma_f32_16x16x32_bf16 v[132:135], v[52:55], a[204:207], v[132:135]
  v_cvt_pk_bf16_f32 v140, v120, v121
  v_cvt_pk_bf16_f32 v141, v122, v123
  v_mfma_f32_16x16x32_bf16 v[128:131], v[32:35], a[208:211], v[128:131]
  v_cvt_pk_bf16_f32 v142, v124, v125
  v_cvt_pk_bf16_f32 v143, v126, v127
  v_mfma_f32_16x16x32_bf16 v[132:135], v[56:59], a[208:211], v[132:135]
  s_add_u32 s58, s55, 917504
  buffer_store_dwordx4 v[140:143], v5, s[8:11], s58 offen sc1
  v_mfma_f32_16x16x32_bf16 v[128:131], v[36:39], a[212:215], v[128:131]
  v_mfma_f32_16x16x32_bf16 v[132:135], v[60:63], a[212:215], v[132:135]
  v_mfma_f32_16x16x32_bf16 v[112:115], v[16:19], a[216:219], 0
  v_mfma_f32_16x16x32_bf16 v[116:119], v[40:43], a[216:219], 0
  v_mfma_f32_16x16x32_bf16 v[112:115], v[20:23], a[220:223], v[112:115]
  v_mfma_f32_16x16x32_bf16 v[116:119], v[44:47], a[220:223], v[116:119]
  v_mfma_f32_16x16x32_bf16 v[112:115], v[24:27], a[224:227], v[112:115]
  v_mfma_f32_16x16x32_bf16 v[116:119], v[48:51], a[224:227], v[116:119]
  v_mfma_f32_16x16x32_bf16 v[112:115], v[28:31], a[228:231], v[112:115]
  v_mfma_f32_16x16x32_bf16 v[116:119], v[52:55], a[228:231], v[116:119]
  v_cvt_pk_bf16_f32 v144, v128, v129
  v_cvt_pk_bf16_f32 v145, v130, v131
  v_mfma_f32_16x16x32_bf16 v[112:115], v[32:35], a[232:235], v[112:115]
  v_cvt_pk_bf16_f32 v146, v132, v133
  v_cvt_pk_bf16_f32 v147, v134, v135
  v_mfma_f32_16x16x32_bf16 v[116:119], v[56:59], a[232:235], v[116:119]
  s_add_u32 s58, s55, 1048576
  buffer_store_dwordx4 v[144:147], v5, s[8:11], s58 offen sc1
  v_mfma_f32_16x16x32_bf16 v[112:115], v[36:39], a[236:239], v[112:115]
  v_mfma_f32_16x16x32_bf16 v[116:119], v[60:63], a[236:239], v[116:119]
  s_nop 6
  v_cvt_pk_bf16_f32 v136, v112, v113
  v_cvt_pk_bf16_f32 v137, v114, v115
  v_cvt_pk_bf16_f32 v138, v116, v117
  v_cvt_pk_bf16_f32 v139, v118, v119
  s_add_u32 s58, s55, 1179648
  buffer_store_dwordx4 v[136:139], v5, s[8:11], s58 offen sc1
  s_add_u32 s55, s55, 1310720
  s_cmp_lg_u32 s52, 0
  s_cbranch_scc1 u_noeag_10
  s_cmp_ge_u32 s56, s57
  s_cbranch_scc1 wf_done_14
  s_mov_b32 s50, 0
wf_loop_15:
  buffer_load_dword v8, v6, s[8:11], 0 offen sc1
  s_add_u32 s50, s50, 1
  s_cmp_gt_u32 s50, 2097152
  s_cbranch_scc1 L_fail
  s_waitcnt vmcnt(0)
  v_readfirstlane_b32 s56, v8
  s_nop 0
  s_cmp_lt_u32 s56, s57
  s_cbranch_scc1 wf_loop_15
wf_done_14:
  s_add_u32 s46, s54, 0
  buffer_load_dwordx4 v[64:67], v5, s[8:11], s46 offen offset:0 sc1
  buffer_load_dwordx4 v[68:71], v5, s[8:11], s46 offen offset:1024 sc1
  buffer_load_dwordx4 v[72:75], v5, s[8:11], s46 offen offset:2048 sc1
  buffer_load_dwordx4 v[76:79], v5, s[8:11], s46 offen offset:3072 sc1
  s_add_u32 s46, s54, 4096
  buffer_load_dwordx4 v[80:83], v5, s[8:11], s46 offen offset:0 sc1
  buffer_load_dwordx4 v[84:87], v5, s[8:11], s46 offen offset:1024 sc1
  buffer_load_dwordx4 v[88:91], v5, s[8:11], s46 offen offset:2048 sc1
  buffer_load_dwordx4 v[92:95], v5, s[8:11], s46 offen offset:3072 sc1
  s_add_u32 s46, s54, 8192
  buffer_load_dwordx4 v[96:99], v5, s[8:11], s46 offen offset:0 sc1
  buffer_load_dwordx4 v[100:103], v5, s[8:11], s46 offen offset:1024 sc1
  buffer_load_dwordx4 v[104:107], v5, s[8:11], s46 offen offset:2048 sc1
  buffer_load_dwordx4 v[108:111], v5, s[8:11], s46 offen offset:3072 sc1
  s_add_u32 s54, s54, 12288
  s_waitcnt vmcnt(0)
  s_mov_b32 s47, 1
  v_mov_b32 v8, s47
  s_mov_b64 exec, 1
  buffer_store_dword v8, v7, s[8:11], 0 offen sc1
  s_mov_b64 exec, -1
  s_branch u_nofl_11
u_noeag_10:
  s_waitcnt vmcnt(10)
  v_mov_b32 v8, s52
  s_mov_b64 exec, 1
  buffer_store_dword v8, v7, s[8:11], 0 offen sc1
  s_mov_b64 exec, -1
u_nofl_11:
  s_add_u32 s52, s52, 1
  s_add_u32 s57, s52, 2
  s_cmp_gt_u32 s57, 64
  s_cbranch_scc1 u_nold_16
  s_cmp_ge_u32 s56, s57
  s_cbranch_scc1 wf_done_19
  s_mov_b32 s50, 0
wf_loop_20:
  buffer_load_dword v8, v6, s[8:11], 0 offen sc1
  s_add_u32 s50, s50, 1
  s_cmp_gt_u32 s50, 2097152
  s_cbranch_scc1 L_fail
  s_waitcnt vmcnt(0)
  v_readfirstlane_b32 s56, v8
  s_nop 0
  s_cmp_lt_u32 s56, s57
  s_cbranch_scc1 wf_loop_20
wf_done_19:
  s_add_u32 s46, s54, 0
  buffer_load_dwordx4 v[16:19], v5, s[8:11], s46 offen offset:0 sc1
  buffer_load_dwordx4 v[20:23], v5, s[8:11], s46 offen offset:1024 sc1
  buffer_load_dwordx4 v[24:27], v5, s[8:11], s46 offen offset:2048 sc1
  buffer_load_dwordx4 v[28:31], v5, s[8:11], s46 offen offset:3072 sc1
  s_add_u32 s46, s54, 4096
  buffer_load_dwordx4 v[32:35], v5, s[8:11], s46 offen offset:0 sc1
  buffer_load_dwordx4 v[36:39], v5, s[8:11], s46 offen offset:1024 sc1
  buffer_load_dwordx4 v[40:43], v5, s[8:11], s46 offen offset:2048 sc1
  buffer_load_dwordx4 v[44:47], v5, s[8:11], s46 offen offset:3072 sc1
  s_add_u32 s46, s54, 8192
  buffer_load_dwordx4 v[48:51], v5, s[8:11], s46 offen offset:0 sc1
  buffer_load_dwordx4 v[52:55], v5, s[8:11], s46 offen offset:1024 sc1
  buffer_load_dwordx4 v[56:59], v5, s[8:11], s46 offen offset:2048 sc1
  buffer_load_dwordx4 v[60:63], v5, s[8:11], s46 offen offset:3072 sc1
  s_add_u32 s54, s54, 12288
u_nold_16:
  v_mfma_f32_16x16x32_bf16 v[112:115], v[64:67], a[0:3], 0
  v_mfma_f32_16x16x32_bf16 v[116:119], v[88:91], a[0:3], 0
  v_mfma_f32_16x16x32_bf16 v[112:115], v[68:71], a[4:7], v[112:115]
  v_mfma_f32_16x16x32_bf16 v[116:119], v[92:95], a[4:7], v[116:119]
  v_mfma_f32_16x16x32_bf16 v[112:115], v[72:75], a[8:11], v[112:115]
  v_mfma_f32_16x16x32_bf16 v[116:119], v[96:99], a[8:11], v[116:119]
  v_mfma_f32_16x16x32_bf16 v[112:115], v[76:79], a[12:15], v[112:115]
  v_mfma_f32_16x16x32_bf16 v[116:119], v[100:103], a[12:15], v[116:119]
  v_mfma_f32_16x16x32_bf16 v[112:115], v[80:83], a[16:19], v[112:115]
  v_mfma_f32_16x16x32_bf16 v[116:119], v[104:107], a[16:19], v[116:119]
  v_mfma_f32_16x16x32_bf16 v[112:115], v[84:87], a[20:23], v[112:115]
  v_mfma_f32_16x16x32_bf16 v[116:119], v[108:111], a[20:23], v[116:119]
  v_mfma_f32_16x16x32_bf16 v[120:123], v[64:67], a[24:27], 0
  v_mfma_f32_16x16x32_bf16 v[124:127], v[88:91], a[24:27], 0
  v_mfma_f32_16x16x32_bf16 v[120:123], v[68:71], a[28:31], v[120:123]
  v_mfma_f32_16x16x32_bf16 v[124:127], v[92:95], a[28:31], v[124:127]
  v_mfma_f32_16x16x32_bf16 v[120:123], v[72:75], a[32:35], v[120:123]
  v_mfma_f32_16x16x32_bf16 v[124:127], v[96:99], a[32:35], v[124:127]
  v_mfma_f32_16x16x32_bf16 v[120:123], v[76:79], a[36:39], v[120:123]
  v_mfma_f32_16x16x32_bf16 v[124:127], v[100:103], a[36:39], v[124:127]
  v_cvt_pk_bf16_f32 v136, v112, v113
  v_cvt_pk_bf16_f32 v137, v114, v115
  v_mfma_f32_16x16x32_bf16 v[120:123], v[80:83], a[40:43], v[120:123]
  v_cvt_pk_bf16_f32 v138, v116, v117
  v_cvt_pk_bf16_f32 v139, v118, v119
  v_mfma_f32_16x16x32_bf16 v[124:127], v[104:107], a[40:43], v[124:127]
  s_add_u32 s58, s55, 0
  buffer_store_dwordx4 v[136:139], v5, s[8:11], s58 offen sc1
  v_mfma_f32_16x16x32_bf16 v[120:123], v[84:87], a[44:47], v[120:123]
  v_mfma_f32_16x16x32_bf16 v[124:127], v[108:111], a[44:47], v[124:127]
  v_mfma_f32_16x16x32_bf16 v[128:131], v[64:67], a[48:51], 0
  v_mfma_f32_16x16x32_bf16 v[132:135], v[88:91], a[48:51], 0
  v_mfma_f32_16x16x32_bf16 v[128:131], v[68:71], a[52:55], v[128:131]
  v_mfma_f32_16x16x32_bf16 v[132:135], v[92:95], a[52:55], v[132:135]
  v_mfma_f32_16x16x32_bf16 v[128:131], v[72:75], a[56:59], v[128:131]
  v_mfma_f32_16x16x32_bf16 v[132:135], v[96:99], a[56:59], v[132:135]
  v_mfma_f32_16x16x32_bf16 v[128:131], v[76:79], a[60:63], v[128:131]
  v_mfma_f32_16x16x32_bf16 v[132:135], v[100:103], a[60:63], v[132:135]
  v_cvt_pk_bf16_f32 v140, v120, v121
  v_cvt_pk_bf16_f32 v141, v122, v123
  v_mfma_f32_16x16x32_bf16 v[128:131], v[80:83], a[64:67], v[128:131]
  v_cvt_pk_bf16_f32 v142, v124, v125
  v_cvt_pk_bf16_f32 v143, v126, v127
  v_mfma_f32_16x16x32_bf16 v[132:135], v[104:107], a[64:67], v[132:135]
  s_add_u32 s58, s55, 131072
  buffer_store_dwordx4 v[140:143], v5, s[8:11], s58 offen sc1
  v_mfma_f32_16x16x32_bf16 v[128:131], v[84:87], a[68:71], v[128:131]
  v_mfma_f32_16x16x32_bf16 v[132:135], v[108:111], a[68:71], v[132:135]
  v_mfma_f32_16x16x32_bf16 v[112:115], v[64:67], a[72:75], 0
  v_mfma_f32_16x16x32_bf16 v[116:119], v[88:91], a[72:75], 0
  v_mfma_f32_16x16x32_bf16 v[112:115], v[68:71], a[76:79], v[112:115]
  v_mfma_f32_16x16x32_bf16 v[116:119], v[92:95], a[76:79], v[116:119]
  v_mfma_f32_16x16x32_bf16 v[112:115], v[72:75], a[80:83], v[112:115]
  v_mfma_f32_16x16x32_bf16 v[116:119], v[96:99], a[80:83], v[116:119]
  v_mfma_f32_16x16x32_bf16 v[112:115], v[76:79], a[84:87], v[112:115]
  v_mfma_f32_16x16x32_bf16 v[116:119], v[100:103], a[84:87], v[116:119]
  v_cvt_pk_bf16_f32 v144, v128, v129
  v_cvt_pk_bf16_f32 v145, v130, v131
  v_mfma_f32_16x16x32_bf16 v[112:115], v[80:83], a[88:91], v[112:115]
  v_cvt_pk_bf16_f32 v146, v132, v133
  v_cvt_pk_bf16_f32 v147, v134, v135
  v_mfma_f32_16x16x32_bf16 v[116:119], v[104:107], a[88:91], v[116:119]
  s_add_u32 s58, s55, 262144
  buffer_store_dwordx4 v[144:147], v5, s[8:11], s58 offen sc1
  v_mfma_f32_16x16x32_bf16 v[112:115], v[84:87], a[92:95], v[112:115]
  v_mfma_f32_16x16x32_bf16 v[116:119], v[108:111], a[92:95], v[116:119]
  v_mfma_f32_16x16x32_bf16 v[120:123], v[64:67], a[96:99], 0
  v_mfma_f32_16x16x32_bf16 v[124:127], v[88:91], a[96:99], 0
  v_mfma_f32_16x16x32_bf16 v[120:123], v[68:71], a[100:103], v[120:123]
  v_mfma_f32_16x16x32_bf16 v[124:127], v[92:95], a[100:103], v[124:127]
  v_mfma_f32_16x16x32_bf16 v[120:123], v[72:75], a[104:107], v[120:123]
  v_mfma_f32_16x16x32_bf16 v[124:127], v[96:99], a[104:107], v[124:127]
  v_mfma_f32_16x16x32_bf16 v[120:123], v[76:79], a[108:111], v[120:123]
  v_mfma_f32_16x16x32_bf16 v[124:127], v[100:103], a[108:111], v[124:127]
  v_cvt_pk_bf16_f32 v136, v112, v113
  v_cvt_pk_bf16_f32 v137, v114, v115
  v_mfma_f32_16x16x32_bf16 v[120:123], v[80:83], a[112:115], v[120:123]
  v_cvt_pk_bf16_f32 v138, v116, v117
  v_cvt_pk_bf16_f32 v139, v118, v119
  v_mfma_f32_16x16x32_bf16 v[124:127], v[104:107], a[112:115], v[124:127]
  s_add_u32 s58, s55, 393216
  buffer_store_dwordx4 v[136:139], v5, s[8:11], s58 offen sc1
  v_mfma_f32_16x16x32_bf16 v[120:123], v[84:87], a[116:119], v[120:123]
  v_mfma_f32_16x16x32_bf16 v[124:127], v[108:111], a[116:119], v[124:127]
  v_mfma_f32_16x16x32_bf16 v[128:131], v[64:67], a[120:123], 0
  v_mfma_f32_16x16x32_bf16 v[132:135], v[88:91], a[120:123], 0
  v_mfma_f32_16x16x32_bf16 v[128:131], v[68:71], a[124:127], v[128:131]
  v_mfma_f32_16x16x32_bf16 v[132:135], v[92:95], a[124:127], v[132:135]
  v_mfma_f32_16x16x32_bf16 v[128:131], v[72:75], a[128:131], v[128:131]
  v_mfma_f32_16x16x32_bf16 v[132:135], v[96:99], a[128:131], v[132:135]
  v_mfma_f32_16x16x32_bf16 v[128:131], v[76:79], a[132:135], v[128:131]
  v_mfma_f32_16x16x32_bf16 v[132:135], v[100:103], a[132:135], v[132:135]
  v_cvt_pk_bf16_f32 v140, v120, v121
  v_cvt_pk_bf16_f32 v141, v122, v123
  v_mfma_f32_16x16x32_bf16 v[128:131], v[80:83], a[136:139], v[128:131]
  v_cvt_pk_bf16_f32 v142, v124, v125
  v_cvt_pk_bf16_f32 v143, v126, v127
  v_mfma_f32_16x16x32_bf16 v[132:135], v[104:107], a[136:139], v[132:135]
  s_add_u32 s58, s55, 524288
  buffer_store_dwordx4 v[140:143], v5, s[8:11], s58 offen sc1
  v_mfma_f32_16x16x32_bf16 v[128:131], v[84:87], a[140:143], v[128:131]
  v_mfma_f32_16x16x32_bf16 v[132:135], v[108:111], a[140:143], v[132:135]
  v_mfma_f32_16x16x32_bf16 v[112:115], v[64:67], a[144:147], 0
  v_mfma_f32_16x16x32_bf16 v[116:119], v[88:91], a[144:147], 0
  v_mfma_f32_16x16x32_bf16 v[112:115], v[68:71], a[148:151], v[112:115]
  v_mfma_f32_16x16x32_bf16 v[116:119], v[92:95], a[148:151], v[116:119]
  v_mfma_f32_16x16x32_bf16 v[112:115], v[72:75], a[152:155], v[112:115]
  v_mfma_f32_16x16x32_bf16 v[116:119], v[96:99], a[152:155], v[116:119]
  v_mfma_f32_16x16x32_bf16 v[112:115], v[76:79], a[156:159], v[112:115]
  v_mfma_f32_16x16x32_bf16 v[116:119], v[100:103], a[156:159], v[116:119]
  v_cvt_pk_bf16_f32 v144, v128, v129
  v_cvt_pk_bf16_f32 v145, v130, v131
  v_mfma_f32_16x16x32_bf16 v[112:115], v[80:83], a[160:163], v[112:115]
  v_cvt_pk_bf16_f32 v146, v132, v133
  v_cvt_pk_bf16_f32 v147, v134, v135
  v_mfma_f32_16x16x32_bf16 v[116:119], v[104:107], a[160:163], v[116:119]
  s_add_u32 s58, s55, 655360
  buffer_store_dwordx4 v[144:147], v5, s[8:11], s58 offen sc1
  v_mfma_f32_16x16x32_bf16 v[112:115], v[84:87], a[164:167], v[112:115]
  v_mfma_f32_16x16x32_bf16 v[116:119], v[108:111], a[164:167], v[116:119]
  v_mfma_f32_16x16x32_bf16 v[120:123], v[64:67], a[168:171], 0
  v_mfma_f32_16x16x32_bf16 v[124:127], v[88:91], a[168:171], 0
  v_mfma_f32_16x16x32_bf16 v[120:123], v[68:71], a[172:175], v[120:123]
  v_mfma_f32_16x16x32_bf16 v[124:127], v[92:95], a[172:175], v[124:127]
  v_mfma_f32_16x16x32_bf16 v[120:123], v[72:75], a[176:179], v[120:123]
  v_mfma_f32_16x16x32_bf16 v[124:127], v[96:99], a[176:179], v[124:127]
  v_mfma_f32_16x16x32_bf16 v[120:123], v[76:79], a[180:183], v[120:123]
  v_mfma_f32_16x16x32_bf16 v[124:127], v[100:103], a[180:183], v[124:127]
  v_cvt_pk_bf16_f32 v136, v112, v113
  v_cvt_pk_bf16_f32 v137, v114, v115
  v_mfma_f32_16x16x32_bf16 v[120:123], v[80:83], a[184:187], v[120:123]
  v_cvt_pk_bf16_f32 v138, v116, v117
  v_cvt_pk_bf16_f32 v139, v118, v119
  v_mfma_f32_16x16x32_bf16 v[124:127], v[104:107], a[184:187], v[124:127]
  s_add_u32 s58, s55, 786432
  buffer_store_dwordx4 v[136:139], v5, s[8:11], s58 offen sc1
  v_mfma_f32_16x16x32_bf16 v[120:123], v[84:87], a[188:191], v[120:123]
  v_mfma_f32_16x16x32_bf16 v[124:127], v[108:111], a[188:191], v[124:127]
  v_mfma_f32_16x16x32_bf16 v[128:131], v[64:67], a[192:195], 0
  v_mfma_f32_16x16x32_bf16 v[132:135], v[88:91], a[192:195], 0
  v_mfma_f32_16x16x32_bf16 v[128:131], v[68:71], a[196:199], v[128:131]
  v_mfma_f32_16x16x32_bf16 v[132:135], v[92:95], a[196:199], v[132:135]
  v_mfma_f32_16x16x32_bf16 v[128:131], v[72:75], a[200:203], v[128:131]
  v_mfma_f32_16x16x32_bf16 v[132:135], v[96:99], a[200:203], v[132:135]
  v_mfma_f32_16x16x32_bf16 v[128:131], v[76:79], a[204:207], v[128:131]
  v_mfma_f32_16x16x32_bf16 v[132:135], v[100:103], a[204:207], v[132:135]
  v_cvt_pk_bf16_f32 v140, v120, v121
  v_cvt_pk_bf16_f32 v141, v122, v123
  v_mfma_f32_16x16x32_bf16 v[128:131], v[80:83], a[208:211], v[128:131]
  v_cvt_pk_bf16_f32 v142, v124, v125
  v_cvt_pk_bf16_f32 v143, v126, v127
  v_mfma_f32_16x16x32_bf16 v[132:135], v[104:107], a[208:211], v[132:135]
  s_add_u32 s58, s55, 917504
  buffer_store_dwordx4 v[140:143], v5, s[8:11], s58 offen sc1
  v_mfma_f32_16x16x32_bf16 v[128:131], v[84:87], a[212:215], v[128:131]
  v_mfma_f32_16x16x32_bf16 v[132:135], v[108:111], a[212:215], v[132:135]
  v_mfma_f32_16x16x32_bf16 v[112:115], v[64:67], a[216:219], 0
  v_mfma_f32_16x16x32_bf16 v[116:119], v[88:91], a[216:219], 0
  v_mfma_f32_16x16x32_bf16 v[112:115], v[68:71], a[220:223], v[112:115]
  v_mfma_f32_16x16x32_bf16 v[116:119], v[92:95], a[220:223], v[116:119]
  v_mfma_f32_16x16x32_bf16 v[112:115], v[72:75], a[224:227], v[112:115]
  v_mfma_f32_16x16x32_bf16 v[116:119], v[96:99], a[224:227], v[116:119]
  v_mfma_f32_16x16x32_bf16 v[112:115], v[76:79], a[228:231], v[112:115]
  v_mfma_f32_16x16x32_bf16 v[116:119], v[100:103], a[228:231], v[116:119]
  v_cvt_pk_bf16_f32 v144, v128, v129
  v_cvt_pk_bf16_f32 v145, v130, v131
  v_mfma_f32_16x16x32_bf16 v[112:115], v[80:83], a[232:235], v[112:115]
  v_cvt_pk_bf16_f32 v146, v132, v133
  v_cvt_pk_bf16_f32 v147, v134, v135
  v_mfma_f32_16x16x32_bf16 v[116:119], v[104:107], a[232:235], v[116:119]
  s_add_u32 s58, s55, 1048576
  buffer_store_dwordx4 v[144:147], v5, s[8:11], s58 offen sc1
  v_mfma_f32_16x16x32_bf16 v[112:115], v[84:87], a[236:239], v[112:115]
  v_mfma_f32_16x16x32_bf16 v[116:119], v[108:111], a[236:239], v[116:119]
  s_nop 6
  v_cvt_pk_bf16_f32 v136, v112, v113
  v_cvt_pk_bf16_f32 v137, v114, v115
  v_cvt_pk_bf16_f32 v138, v116, v117
  v_cvt_pk_bf16_f32 v139, v118, v119
  s_add_u32 s58, s55, 1179648
  buffer_store_dwordx4 v[136:139], v5, s[8:11], s58 offen sc1
  s_add_u32 s55, s55, 1310720
  s_waitcnt vmcnt(10)
  v_mov_b32 v8, s52
  s_mov_b64 exec, 1
  buffer_store_dword v8, v7, s[8:11], 0 offen sc1
  s_mov_b64 exec, -1
u_nofl_18:
  s_add_u32 s52, s52, 1
  s_cmp_lt_u32 s52, 64
  s_cbranch_scc1 u_loop_8
  s_waitcnt vmcnt(0)
  v_mov_b32 v8, s52
  s_mov_b64 exec, 1
  buffer_store_dword v8, v7, s[8:11], 0 offen sc1
  s_mov_b64 exec, -1
L_parta:
  s_endpgm
L_recur:
  s_or_b32 s67, s44, s42
  s_cmp_lt_u32 s44, 8
  s_cbranch_scc1 L_score
  s_cmp_lt_u32 s44, 16
  s_cbranch_scc1 L_value
  s_cmp_lt_u32 s44, 26
  s_cbranch_scc1 L_owner
  s_cmp_lt_u32 s44, 30
  s_cbranch_scc1 L_xowner
  s_cmp_lt_u32 s44, 31
  s_cbranch_scc1 L_end
  s_cmp_lg_u32 s42, 0
  s_cbranch_scc1 L_end
  s_cmp_ge_u32 s43, 2
  s_cbranch_scc1 L_end
  s_mul_i32 s62, s43, 1114112
  s_add_u32 s62, s62, 1966080
  v_mov_b32 v1, 0
  s_mov_b64 exec, 1
  buffer_load_dword v2, v1, s[8:11], s62 offen offset:3968 sc1
  s_mov_b32 s63, -1
  s_mov_b32 s64, -1
  s_add_u32 s65, s62, 8192
  s_waitcnt vmcnt(0)
  s_memtime s[72:73]
  s_waitcnt lgkmcnt(0)
  buffer_load_dword v2, v1, s[8:11], s62 offen offset:0 sc1
  s_waitcnt vmcnt(0)
  s_memtime s[74:75]
  s_waitcnt lgkmcnt(0)
  s_sub_u32 s46, s74, s72
  s_min_u32 s63, s63, s46
  s_memtime s[72:73]
  s_waitcnt lgkmcnt(0)
  buffer_load_dword v2, v1, s[8:11], s65 offen offset:0 sc1
  s_waitcnt vmcnt(0)
  s_memtime s[74:75]
  s_waitcnt lgkmcnt(0)
  s_sub_u32 s46, s74, s72
  s_min_u32 s64, s64, s46
  s_memtime s[72:73]
  s_waitcnt lgkmcnt(0)
  buffer_load_dword v2, v1, s[8:11], s62 offen offset:768 sc1
  s_waitcnt vmcnt(0)
  s_memtime s[74:75]
  s_waitcnt lgkmcnt(0)
  s_sub_u32 s46, s74, s72
  s_min_u32 s63, s63, s46
  s_memtime s[72:73]
  s_waitcnt lgkmcnt(0)
  buffer_load_dword v2, v1, s[8:11], s65 offen offset:768 sc1
  s_waitcnt vmcnt(0)
  s_memtime s[74:75]
  s_waitcnt lgkmcnt(0)
  s_sub_u32 s46, s74, s72
  s_min_u32 s64, s64, s46
  s_memtime s[72:73]
  s_waitcnt lgkmcnt(0)
  buffer_load_dword v2, v1, s[8:11], s62 offen offset:1536 sc1
  s_waitcnt vmcnt(0)
  s_memtime s[74:75]
  s_waitcnt lgkmcnt(0)
  s_sub_u32 s46, s74, s72
  s_min_u32 s63, s63, s46
  s_memtime s[72:73]
  s_waitcnt lgkmcnt(0)
  buffer_load_dword v2, v1, s[8:11], s65 offen offset:1536 sc1
  s_waitcnt vmcnt(0)
  s_memtime s[74:75]
  s_waitcnt lgkmcnt(0)
  s_sub_u32 s46, s74, s72
  s_min_u32 s64, s64, s46
  s_memtime s[72:73]
  s_waitcnt lgkmcnt(0)
  buffer_load_dword v2, v1, s[8:11], s62 offen offset:2304 sc1
  s_waitcnt vmcnt(0)
  s_memtime s[74:75]
  s_waitcnt lgkmcnt(0)
  s_sub_u32 s46, s74, s72
  s_min_u32 s63, s63, s46
  s_memtime s[72:73]
  s_waitcnt lgkmcnt(0)
  buffer_load_dword v2, v1, s[8:11], s65 offen offset:2304 sc1
  s_waitcnt vmcnt(0)
  s_memtime s[74:75]
  s_waitcnt lgkmcnt(0)
  s_sub_u32 s46, s74, s72
  s_min_u32 s64, s64, s46
  s_cmp_lt_u32 s64, s63
  s_cselect_b32 s46, 8193, 1
  s_lshl_b32 s47, s43, 7
  s_add_u32 s47, s47, 3014656
  v_mov_b32 v1, s47
  v_mov_b32 v2, s46
  buffer_store_dword v2, v1, s[8:11], 0 offen sc1
  s_waitcnt vmcnt(0)
  s_endpgm
L_score:
  s_mov_b32 s4, s26
  s_mov_b32 s5, s27
  s_mov_b32 s6, 7864320
  s_mov_b32 s7, 0x20000
  s_mov_b32 s12, s28
  s_mov_b32 s13, s29
  s_mov_b32 s14, 7864320
  s_mov_b32 s15, 0x20000
  v_lshrrev_b32 v136, 3, v0
  v_lshrrev_b32 v137, 2, v136
  v_lshlrev_b32 v137, 3, v137
  v_and_b32 v64, 3, v136
  v_add_u32 v64, v64, v137
  s_and_b32 s46, s42, 1
  s_lshl_b32 s46, s46, 2
  s_lshr_b32 s47, s42, 1
  s_lshl_b32 s47, s47, 4
  s_add_u32 s46, s46, s47
  v_add_u32 v64, s46, v64
  v_mul_u32_u24 v64, 12288, v64
  v_lshrrev_b32 v136, 1, v136
  v_bfe_u32 v137, v0, 1, 2
  v_xor_b32 v136, v136, v137
  v_lshlrev_b32 v136, 5, v136
  v_and_b32 v137, 1, v0
  v_lshlrev_b32 v137, 4, v137
  v_add3_u32 v64, v64, v136, v137
  v_lshrrev_b32 v136, 5, v0
  v_lshlrev_b32 v65, 11, v136
  v_bfe_u32 v136, v0, 2, 3
  v_lshl_add_u32 v65, v136, 7, v65
  v_lshrrev_b32 v136, 1, v136
  v_xor_b32 v136, s42, v136
  v_lshl_add_u32 v65, v136, 5, v65
  v_and_b32 v136, 3, v0
  v_lshl_add_u32 v65, v136, 3, v65
  v_add_u32 v66, 0x10000, v65
  v_add_u32 v67, 0x20000, v65
  v_lshlrev_b32 v1, 4, v0
  v_add_u32 v2, s51, v1
  v_add_u32 v3, 0x10000, v2
  s_mul_i32 s62, s45, 384
  s_add_u32 m0, s51, 73728
  s_add_u32 s46, s62, 0
  buffer_load_dwordx4 v64, s[4:7], s46 offen lds
  s_add_u32 m0, s51, 77824
  s_add_u32 s46, s62, 393216
  buffer_load_dwordx4 v64, s[4:7], s46 offen lds
  s_add_u32 m0, s51, 81920
  s_add_u32 s46, s62, 128
  buffer_load_dwordx4 v64, s[4:7], s46 offen lds
  s_add_u32 m0, s51, 86016
  s_add_u32 s46, s62, 393344
  buffer_load_dwordx4 v64, s[4:7], s46 offen lds
  s_add_u32 m0, s51, 90112
  s_add_u32 s46, s62, 256
  buffer_load_dwordx4 v64, s[4:7], s46 offen lds
  s_add_u32 m0, s51, 94208
  s_add_u32 s46, s62, 393472
  buffer_load_dwordx4 v64, s[4:7], s46 offen lds
  s_add_u32 m0, s51, 98304
  s_add_u32 s46, s62, 0
  buffer_load_dwordx4 v64, s[12:15], s46 offen lds
  s_add_u32 m0, s51, 102400
  s_add_u32 s46, s62, 393216
  buffer_load_dwordx4 v64, s[12:15], s46 offen lds
  s_add_u32 m0, s51, 106496
  s_add_u32 s46, s62, 128
  buffer_load_dwordx4 v64, s[12:15], s46 offen lds
  s_add_u32 m0, s51, 110592
  s_add_u32 s46, s62, 393344
  buffer_load_dwordx4 v64, s[12:15], s46 offen lds
  s_add_u32 m0, s51, 114688
  s_add_u32 s46, s62, 256
  buffer_load_dwordx4 v64, s[12:15], s46 offen lds
  s_add_u32 m0, s51, 118784
  s_add_u32 s46, s62, 393472
  buffer_load_dwordx4 v64, s[12:15], s46 offen lds
  s_add_u32 m0, s51, 122880
  s_add_u32 s46, s62, 786432
  buffer_load_dwordx4 v64, s[4:7], s46 offen lds
  s_add_u32 m0, s51, 126976
  s_add_u32 s46, s62, 1179648
  buffer_load_dwordx4 v64, s[4:7], s46 offen lds
  s_add_u32 m0, s51, 131072
  s_add_u32 s46, s62, 786560
  buffer_load_dwordx4 v64, s[4:7], s46 offen lds
  s_add_u32 m0, s51, 135168
  s_add_u32 s46, s62, 1179776
  buffer_load_dwordx4 v64, s[4:7], s46 offen lds
  s_add_u32 m0, s51, 139264
  s_add_u32 s46, s62, 786688
  buffer_load_dwordx4 v64, s[4:7], s46 offen lds
  s_add_u32 m0, s51, 143360
  s_add_u32 s46, s62, 1179904
  buffer_load_dwordx4 v64, s[4:7], s46 offen lds
  s_add_u32 m0, s51, 0
  s_add_u32 s46, s62, 786432
  buffer_load_dwordx4 v64, s[12:15], s46 offen lds
  s_add_u32 m0, s51, 4096
  s_add_u32 s46, s62, 1179648
  buffer_load_dwordx4 v64, s[12:15], s46 offen lds
  s_add_u32 m0, s51, 8192
  s_add_u32 s46, s62, 786560
  buffer_load_dwordx4 v64, s[12:15], s46 offen lds
  s_add_u32 m0, s51, 12288
  s_add_u32 s46, s62, 1179776
  buffer_load_dwordx4 v64, s[12:15], s46 offen lds
  s_add_u32 m0, s51, 16384
  s_add_u32 s46, s62, 786688
  buffer_load_dwordx4 v64, s[12:15], s46 offen lds
  s_add_u32 m0, s51, 20480
  s_add_u32 s46, s62, 1179904
  buffer_load_dwordx4 v64, s[12:15], s46 offen lds
  s_add_u32 m0, s51, 24576
  s_add_u32 s46, s62, 1572864
  buffer_load_dwordx4 v64, s[12:15], s46 offen lds
  s_add_u32 m0, s51, 28672
  s_add_u32 s46, s62, 1966080
  buffer_load_dwordx4 v64, s[12:15], s46 offen lds
  s_add_u32 m0, s51, 32768
  s_add_u32 s46, s62, 1572992
  buffer_load_dwordx4 v64, s[12:15], s46 offen lds
  s_add_u32 m0, s51, 36864
  s_add_u32 s46, s62, 1966208
  buffer_load_dwordx4 v64, s[12:15], s46 offen lds
  s_add_u32 m0, s51, 40960
  s_add_u32 s46, s62, 1573120
  buffer_load_dwordx4 v64, s[12:15], s46 offen lds
  s_add_u32 m0, s51, 45056
  s_add_u32 s46, s62, 1966336
  buffer_load_dwordx4 v64, s[12:15], s46 offen lds
  s_waitcnt vmcnt(24)
  s_barrier
  s_add_u32 m0, s51, 49152
  s_add_u32 s46, s62, 2359296
  buffer_load_dwordx4 v64, s[4:7], s46 offen lds
  s_add_u32 m0, s51, 53248
  s_add_u32 s46, s62, 2752512
  buffer_load_dwordx4 v64, s[4:7], s46 offen lds
  s_add_u32 m0, s51, 57344
  s_add_u32 s46, s62, 2359424
  buffer_load_dwordx4 v64, s[4:7], s46 offen lds
  s_add_u32 m0, s51, 61440
  s_add_u32 s46, s62, 2752640
  buffer_load_dwordx4 v64, s[4:7], s46 offen lds
  s_add_u32 m0, s51, 65536
  s_add_u32 s46, s62, 2359552
  buffer_load_dwordx4 v64, s[4:7], s46 offen lds
  s_add_u32 m0, s51, 69632
  s_add_u32 s46, s62, 2752768
  buffer_load_dwordx4 v64, s[4:7], s46 offen lds
  ds_read_b64_tr_b16 a[0:1], v66 offset:8192
  ds_read_b64_tr_b16 a[2:3], v66 offset:9216
  ds_read_b64_tr_b16 a[4:5], v66 offset:12288
  ds_read_b64_tr_b16 a[6:7], v66 offset:13312
  ds_read_b64_tr_b16 a[8:9], v66 offset:16384
  ds_read_b64_tr_b16 a[10:11], v66 offset:17408
  ds_read_b64_tr_b16 a[12:13], v66 offset:20480
  ds_read_b64_tr_b16 a[14:15], v66 offset:21504
  ds_read_b64_tr_b16 a[16:17], v66 offset:24576
  ds_read_b64_tr_b16 a[18:19], v66 offset:25600
  ds_read_b64_tr_b16 a[20:21], v66 offset:28672
  ds_read_b64_tr_b16 a[22:23], v66 offset:29696
  s_waitcnt lgkmcnt(0)
  s_waitcnt vmcnt(24)
  s_barrier
  s_add_u32 m0, s51, 73728
  s_add_u32 s46, s62, 2359296
  buffer_load_dwordx4 v64, s[12:15], s46 offen lds
  s_add_u32 m0, s51, 77824
  s_add_u32 s46, s62, 2752512
  buffer_load_dwordx4 v64, s[12:15], s46 offen lds
  s_add_u32 m0, s51, 81920
  s_add_u32 s46, s62, 2359424
  buffer_load_dwordx4 v64, s[12:15], s46 offen lds
  s_add_u32 m0, s51, 86016
  s_add_u32 s46, s62, 2752640
  buffer_load_dwordx4 v64, s[12:15], s46 offen lds
  s_add_u32 m0, s51, 90112
  s_add_u32 s46, s62, 2359552
  buffer_load_dwordx4 v64, s[12:15], s46 offen lds
  s_add_u32 m0, s51, 94208
  s_add_u32 s46, s62, 2752768
  buffer_load_dwordx4 v64, s[12:15], s46 offen lds
  ds_read_b64_tr_b16 a[24:25], v66 offset:32768
  ds_read_b64_tr_b16 a[26:27], v66 offset:33792
  ds_read_b64_tr_b16 a[28:29], v66 offset:36864
  ds_read_b64_tr_b16 a[30:31], v66 offset:37888
  ds_read_b64_tr_b16 a[32:33], v66 offset:40960
  ds_read_b64_tr_b16 a[34:35], v66 offset:41984
  ds_read_b64_tr_b16 a[36:37], v66 offset:45056
  ds_read_b64_tr_b16 a[38:39], v66 offset:46080
  ds_read_b64_tr_b16 a[40:41], v66 offset:49152
  ds_read_b64_tr_b16 a[42:43], v66 offset:50176
  ds_read_b64_tr_b16 a[44:45], v66 offset:53248
  ds_read_b64_tr_b16 a[46:47], v66 offset:54272
  s_waitcnt lgkmcnt(0)
  s_waitcnt vmcnt(24)
  s_barrier
  s_add_u32 m0, s51, 98304
  s_add_u32 s46, s62, 3145728
  buffer_load_dwordx4 v64, s[4:7], s46 offen lds
  s_add_u32 m0, s51, 102400
  s_add_u32 s46, s62, 3538944
  buffer_load_dwordx4 v64, s[4:7], s46 offen lds
  s_add_u32 m0, s51, 106496
  s_add_u32 s46, s62, 3145856
  buffer_load_dwordx4 v64, s[4:7], s46 offen lds
  s_add_u32 m0, s51, 110592
  s_add_u32 s46, s62, 3539072
  buffer_load_dwordx4 v64, s[4:7], s46 offen lds
  s_add_u32 m0, s51, 114688
  s_add_u32 s46, s62, 3145984
  buffer_load_dwordx4 v64, s[4:7], s46 offen lds
  s_add_u32 m0, s51, 118784
  s_add_u32 s46, s62, 3539200
  buffer_load_dwordx4 v64, s[4:7], s46 offen lds
  ds_read_b64_tr_b16 a[48:49], v66 offset:57344
  ds_read_b64_tr_b16 a[50:51], v66 offset:58368
  ds_read_b64_tr_b16 a[52:53], v66 offset:61440
  ds_read_b64_tr_b16 a[54:55], v66 offset:62464
  ds_read_b64_tr_b16 a[56:57], v67 offset:0
  ds_read_b64_tr_b16 a[58:59], v67 offset:1024
  ds_read_b64_tr_b16 a[60:61], v67 offset:4096
  ds_read_b64_tr_b16 a[62:63], v67 offset:5120
  ds_read_b64_tr_b16 a[64:65], v67 offset:8192
  ds_read_b64_tr_b16 a[66:67], v67 offset:9216
  ds_read_b64_tr_b16 a[68:69], v67 offset:12288
  ds_read_b64_tr_b16 a[70:71], v67 offset:13312
  s_waitcnt lgkmcnt(0)
  s_waitcnt vmcnt(24)
  s_barrier
  s_add_u32 m0, s51, 122880
  s_add_u32 s46, s62, 3932160
  buffer_load_dwordx4 v64, s[12:15], s46 offen lds
  s_add_u32 m0, s51, 126976
  s_add_u32 s46, s62, 4325376
  buffer_load_dwordx4 v64, s[12:15], s46 offen lds
  s_add_u32 m0, s51, 131072
  s_add_u32 s46, s62, 3932288
  buffer_load_dwordx4 v64, s[12:15], s46 offen lds
  s_add_u32 m0, s51, 135168
  s_add_u32 s46, s62, 4325504
  buffer_load_dwordx4 v64, s[12:15], s46 offen lds
  s_add_u32 m0, s51, 139264
  s_add_u32 s46, s62, 3932416
  buffer_load_dwordx4 v64, s[12:15], s46 offen lds
  s_add_u32 m0, s51, 143360
  s_add_u32 s46, s62, 4325632
  buffer_load_dwordx4 v64, s[12:15], s46 offen lds
  ds_read_b64_tr_b16 a[72:73], v65 offset:0
  ds_read_b64_tr_b16 a[74:75], v65 offset:1024
  ds_read_b64_tr_b16 a[76:77], v65 offset:4096
  ds_read_b64_tr_b16 a[78:79], v65 offset:5120
  ds_read_b64_tr_b16 a[80:81], v65 offset:8192
  ds_read_b64_tr_b16 a[82:83], v65 offset:9216
  ds_read_b64_tr_b16 a[84:85], v65 offset:12288
  ds_read_b64_tr_b16 a[86:87], v65 offset:13312
  ds_read_b64_tr_b16 a[88:89], v65 offset:16384
  ds_read_b64_tr_b16 a[90:91], v65 offset:17408
  ds_read_b64_tr_b16 a[92:93], v65 offset:20480
  ds_read_b64_tr_b16 a[94:95], v65 offset:21504
  s_waitcnt lgkmcnt(0)
  s_waitcnt vmcnt(24)
  s_barrier
  s_add_u32 m0, s51, 0
  s_add_u32 s46, s62, 4718592
  buffer_load_dwordx4 v64, s[4:7], s46 offen lds
  s_add_u32 m0, s51, 4096
  s_add_u32 s46, s62, 5111808
  buffer_load_dwordx4 v64, s[4:7], s46 offen lds
  s_add_u32 m0, s51, 8192
  s_add_u32 s46, s62, 4718720
  buffer_load_dwordx4 v64, s[4:7], s46 offen lds
  s_add_u32 m0, s51, 12288
  s_add_u32 s46, s62, 5111936
  buffer_load_dwordx4 v64, s[4:7], s46 offen lds
  s_add_u32 m0, s51, 16384
  s_add_u32 s46, s62, 4718848
  buffer_load_dwordx4 v64, s[4:7], s46 offen lds
  s_add_u32 m0, s51, 20480
  s_add_u32 s46, s62, 5112064
  buffer_load_dwordx4 v64, s[4:7], s46 offen lds
  ds_read_b64_tr_b16 a[96:97], v65 offset:24576
  ds_read_b64_tr_b16 a[98:99], v65 offset:25600
  ds_read_b64_tr_b16 a[100:101], v65 offset:28672
  ds_read_b64_tr_b16 a[102:103], v65 offset:29696
  ds_read_b64_tr_b16 a[104:105], v65 offset:32768
  ds_read_b64_tr_b16 a[106:107], v65 offset:33792
  ds_read_b64_tr_b16 a[108:109], v65 offset:36864
  ds_read_b64_tr_b16 a[110:111], v65 offset:37888
  ds_read_b64_tr_b16 a[112:113], v65 offset:40960
  ds_read_b64_tr_b16 a[114:115], v65 offset:41984
  ds_read_b64_tr_b16 a[116:117], v65 offset:45056
  ds_read_b64_tr_b16 a[118:119], v65 offset:46080
  s_waitcnt lgkmcnt(0)
  s_waitcnt vmcnt(24)
  s_barrier
  s_add_u32 m0, s51, 24576
  s_add_u32 s46, s62, 4718592
  buffer_load_dwordx4 v64, s[12:15], s46 offen lds
  s_add_u32 m0, s51, 28672
  s_add_u32 s46, s62, 5111808
  buffer_load_dwordx4 v64, s[12:15], s46 offen lds
  s_add_u32 m0, s51, 32768
  s_add_u32 s46, s62, 4718720
  buffer_load_dwordx4 v64, s[12:15], s46 offen lds
  s_add_u32 m0, s51, 36864
  s_add_u32 s46, s62, 5111936
  buffer_load_dwordx4 v64, s[12:15], s46 offen lds
  s_add_u32 m0, s51, 40960
  s_add_u32 s46, s62, 4718848
  buffer_load_dwordx4 v64, s[12:15], s46 offen lds
  s_add_u32 m0, s51, 45056
  s_add_u32 s46, s62, 5112064
  buffer_load_dwordx4 v64, s[12:15], s46 offen lds
  ds_read_b64_tr_b16 a[120:121], v65 offset:49152
  ds_read_b64_tr_b16 a[122:123], v65 offset:50176
  ds_read_b64_tr_b16 a[124:125], v65 offset:53248
  ds_read_b64_tr_b16 a[126:127], v65 offset:54272
  ds_read_b64_tr_b16 a[128:129], v65 offset:57344
  ds_read_b64_tr_b16 a[130:131], v65 offset:58368
  ds_read_b64_tr_b16 a[132:133], v65 offset:61440
  ds_read_b64_tr_b16 a[134:135], v65 offset:62464
  ds_read_b64_tr_b16 a[136:137], v66 offset:0
  ds_read_b64_tr_b16 a[138:139], v66 offset:1024
  ds_read_b64_tr_b16 a[140:141], v66 offset:4096
  ds_read_b64_tr_b16 a[142:143], v66 offset:5120
  s_waitcnt lgkmcnt(0)
  s_waitcnt vmcnt(24)
  s_barrier
  s_add_u32 m0, s51, 49152
  s_add_u32 s46, s62, 5505024
  buffer_load_dwordx4 v64, s[4:7], s46 offen lds
  s_add_u32 m0, s51, 53248
  s_add_u32 s46, s62, 5898240
  buffer_load_dwordx4 v64, s[4:7], s46 offen lds
  s_add_u32 m0, s51, 57344
  s_add_u32 s46, s62, 5505152
  buffer_load_dwordx4 v64, s[4:7], s46 offen lds
  s_add_u32 m0, s51, 61440
  s_add_u32 s46, s62, 5898368
  buffer_load_dwordx4 v64, s[4:7], s46 offen lds
  s_add_u32 m0, s51, 65536
  s_add_u32 s46, s62, 5505280
  buffer_load_dwordx4 v64, s[4:7], s46 offen lds
  s_add_u32 m0, s51, 69632
  s_add_u32 s46, s62, 5898496
  buffer_load_dwordx4 v64, s[4:7], s46 offen lds
  ds_read_b64_tr_b16 a[144:145], v66 offset:8192
  ds_read_b64_tr_b16 a[146:147], v66 offset:9216
  ds_read_b64_tr_b16 a[148:149], v66 offset:12288
  ds_read_b64_tr_b16 a[150:151], v66 offset:13312
  ds_read_b64_tr_b16 a[152:153], v66 offset:16384
  ds_read_b64_tr_b16 a[154:155], v66 offset:17408
  ds_read_b64_tr_b16 a[156:157], v66 offset:20480
  ds_read_b64_tr_b16 a[158:159], v66 offset:21504
  ds_read_b64_tr_b16 a[160:161], v66 offset:24576
  ds_read_b64_tr_b16 a[162:163], v66 offset:25600
  ds_read_b64_tr_b16 a[164:165], v66 offset:28672
  ds_read_b64_tr_b16 a[166:167], v66 offset:29696
  s_waitcnt lgkmcnt(0)
  s_waitcnt vmcnt(24)
  s_barrier
  s_add_u32 m0, s51, 73728
  s_add_u32 s46, s62, 6291456
  buffer_load_dwordx4 v64, s[12:15], s46 offen lds
  s_add_u32 m0, s51, 77824
  s_add_u32 s46, s62, 6684672
  buffer_load_dwordx4 v64, s[12:15], s46 offen lds
  s_add_u32 m0, s51, 81920
  s_add_u32 s46, s62, 6291584
  buffer_load_dwordx4 v64, s[12:15], s46 offen lds
  s_add_u32 m0, s51, 86016
  s_add_u32 s46, s62, 6684800
  buffer_load_dwordx4 v64, s[12:15], s46 offen lds
  s_add_u32 m0, s51, 90112
  s_add_u32 s46, s62, 6291712
  buffer_load_dwordx4 v64, s[12:15], s46 offen lds
  s_add_u32 m0, s51, 94208
  s_add_u32 s46, s62, 6684928
  buffer_load_dwordx4 v64, s[12:15], s46 offen lds
  ds_read_b64_tr_b16 a[168:169], v66 offset:32768
  ds_read_b64_tr_b16 a[170:171], v66 offset:33792
  ds_read_b64_tr_b16 a[172:173], v66 offset:36864
  ds_read_b64_tr_b16 a[174:175], v66 offset:37888
  ds_read_b64_tr_b16 a[176:177], v66 offset:40960
  ds_read_b64_tr_b16 a[178:179], v66 offset:41984
  ds_read_b64_tr_b16 a[180:181], v66 offset:45056
  ds_read_b64_tr_b16 a[182:183], v66 offset:46080
  ds_read_b64_tr_b16 a[184:185], v66 offset:49152
  ds_read_b64_tr_b16 a[186:187], v66 offset:50176
  ds_read_b64_tr_b16 a[188:189], v66 offset:53248
  ds_read_b64_tr_b16 a[190:191], v66 offset:54272
  s_waitcnt lgkmcnt(0)
  s_waitcnt vmcnt(24)
  s_barrier
  s_add_u32 m0, s51, 98304
  s_add_u32 s46, s62, 7077888
  buffer_load_dwordx4 v64, s[4:7], s46 offen lds
  s_add_u32 m0, s51, 102400
  s_add_u32 s46, s62, 7471104
  buffer_load_dwordx4 v64, s[4:7], s46 offen lds
  s_add_u32 m0, s51, 106496
  s_add_u32 s46, s62, 7078016
  buffer_load_dwordx4 v64, s[4:7], s46 offen lds
  s_add_u32 m0, s51, 110592
  s_add_u32 s46, s62, 7471232
  buffer_load_dwordx4 v64, s[4:7], s46 offen lds
  s_add_u32 m0, s51, 114688
  s_add_u32 s46, s62, 7078144
  buffer_load_dwordx4 v64, s[4:7], s46 offen lds
  s_add_u32 m0, s51, 118784
  s_add_u32 s46, s62, 7471360
  buffer_load_dwordx4 v64, s[4:7], s46 offen lds
  ds_read_b64_tr_b16 a[192:193], v66 offset:57344
  ds_read_b64_tr_b16 a[194:195], v66 offset:58368
  ds_read_b64_tr_b16 a[196:197], v66 offset:61440
  ds_read_b64_tr_b16 a[198:199], v66 offset:62464
  ds_read_b64_tr_b16 a[200:201], v67 offset:0
  ds_read_b64_tr_b16 a[202:203], v67 offset:1024
  ds_read_b64_tr_b16 a[204:205], v67 offset:4096
  ds_read_b64_tr_b16 a[206:207], v67 offset:5120
  ds_read_b64_tr_b16 a[208:209], v67 offset:8192
  ds_read_b64_tr_b16 a[210:211], v67 offset:9216
  ds_read_b64_tr_b16 a[212:213], v67 offset:12288
  ds_read_b64_tr_b16 a[214:215], v67 offset:13312
  s_waitcnt lgkmcnt(0)
  s_waitcnt vmcnt(24)
  s_barrier
  s_add_u32 m0, s51, 122880
  s_add_u32 s46, s62, 7077888
  buffer_load_dwordx4 v64, s[12:15], s46 offen lds
  s_add_u32 m0, s51, 126976
  s_add_u32 s46, s62, 7471104
  buffer_load_dwordx4 v64, s[12:15], s46 offen lds
  s_add_u32 m0, s51, 131072
  s_add_u32 s46, s62, 7078016
  buffer_load_dwordx4 v64, s[12:15], s46 offen lds
  s_add_u32 m0, s51, 135168
  s_add_u32 s46, s62, 7471232
  buffer_load_dwordx4 v64, s[12:15], s46 offen lds
  s_add_u32 m0, s51, 139264
  s_add_u32 s46, s62, 7078144
  buffer_load_dwordx4 v64, s[12:15], s46 offen lds
  s_add_u32 m0, s51, 143360
  s_add_u32 s46, s62, 7471360
  buffer_load_dwordx4 v64, s[12:15], s46 offen lds
  ds_read_b64_tr_b16 a[216:217], v65 offset:0
  ds_read_b64_tr_b16 a[218:219], v65 offset:1024
  ds_read_b64_tr_b16 a[220:221], v65 offset:4096
  ds_read_b64_tr_b16 a[222:223], v65 offset:5120
  ds_read_b64_tr_b16 a[224:225], v65 offset:8192
  ds_read_b64_tr_b16 a[226:227], v65 offset:9216
  ds_read_b64_tr_b16 a[228:229], v65 offset:12288
  ds_read_b64_tr_b16 a[230:231], v65 offset:13312
  ds_read_b64_tr_b16 a[232:233], v65 offset:16384
  ds_read_b64_tr_b16 a[234:235], v65 offset:17408
  ds_read_b64_tr_b16 a[236:237], v65 offset:20480
  ds_read_b64_tr_b16 a[238:239], v65 offset:21504
  s_waitcnt lgkmcnt(0)
  s_waitcnt vmcnt(24)
  s_barrier
  s_add_u32 m0, s51, 0
  s_add_u32 s46, s62, 1572864
  buffer_load_dwordx4 v64, s[4:7], s46 offen lds
  s_add_u32 m0, s51, 4096
  s_add_u32 s46, s62, 1966080
  buffer_load_dwordx4 v64, s[4:7], s46 offen lds
  s_add_u32 m0, s51, 8192
  s_add_u32 s46, s62, 1572992
  buffer_load_dwordx4 v64, s[4:7], s46 offen lds
  s_add_u32 m0, s51, 12288
  s_add_u32 s46, s62, 1966208
  buffer_load_dwordx4 v64, s[4:7], s46 offen lds
  s_add_u32 m0, s51, 16384
  s_add_u32 s46, s62, 1573120
  buffer_load_dwordx4 v64, s[4:7], s46 offen lds
  s_add_u32 m0, s51, 20480
  s_add_u32 s46, s62, 1966336
  buffer_load_dwordx4 v64, s[4:7], s46 offen lds
  ds_read_b64_tr_b16 a[240:241], v65 offset:24576
  ds_read_b64_tr_b16 a[242:243], v65 offset:25600
  ds_read_b64_tr_b16 a[244:245], v65 offset:28672
  ds_read_b64_tr_b16 a[246:247], v65 offset:29696
  ds_read_b64_tr_b16 a[248:249], v65 offset:32768
  ds_read_b64_tr_b16 a[250:251], v65 offset:33792
  ds_read_b64_tr_b16 a[252:253], v65 offset:36864
  ds_read_b64_tr_b16 a[254:255], v65 offset:37888
  ds_read_b64_tr_b16 v[152:153], v65 offset:40960
  ds_read_b64_tr_b16 v[154:155], v65 offset:41984
  ds_read_b64_tr_b16 v[156:157], v65 offset:45056
  ds_read_b64_tr_b16 v[158:159], v65 offset:46080
  s_waitcnt lgkmcnt(0)
  s_waitcnt vmcnt(24)
  s_barrier
  s_add_u32 m0, s51, 24576
  s_add_u32 s46, s62, 3145728
  buffer_load_dwordx4 v64, s[12:15], s46 offen lds
  s_add_u32 m0, s51, 28672
  s_add_u32 s46, s62, 3538944
  buffer_load_dwordx4 v64, s[12:15], s46 offen lds
  s_add_u32 m0, s51, 32768
  s_add_u32 s46, s62, 3145856
  buffer_load_dwordx4 v64, s[12:15], s46 offen lds
  s_add_u32 m0, s51, 36864
  s_add_u32 s46, s62, 3539072
  buffer_load_dwordx4 v64, s[12:15], s46 offen lds
  s_add_u32 m0, s51, 40960
  s_add_u32 s46, s62, 3145984
  buffer_load_dwordx4 v64, s[12:15], s46 offen lds
  s_add_u32 m0, s51, 45056
  s_add_u32 s46, s62, 3539200
  buffer_load_dwordx4 v64, s[12:15], s46 offen lds
  ds_read_b64_tr_b16 v[160:161], v65 offset:49152
  ds_read_b64_tr_b16 v[162:163], v65 offset:50176
  ds_read_b64_tr_b16 v[164:165], v65 offset:53248
  ds_read_b64_tr_b16 v[166:167], v65 offset:54272
  ds_read_b64_tr_b16 v[168:169], v65 offset:57344
  ds_read_b64_tr_b16 v[170:171], v65 offset:58368
  ds_read_b64_tr_b16 v[172:173], v65 offset:61440
  ds_read_b64_tr_b16 v[174:175], v65 offset:62464
  ds_read_b64_tr_b16 v[176:177], v66 offset:0
  ds_read_b64_tr_b16 v[178:179], v66 offset:1024
  ds_read_b64_tr_b16 v[180:181], v66 offset:4096
  ds_read_b64_tr_b16 v[182:183], v66 offset:5120
  s_waitcnt lgkmcnt(0)
  s_waitcnt vmcnt(24)
  s_barrier
  s_add_u32 m0, s51, 49152
  s_add_u32 s46, s62, 3932160
  buffer_load_dwordx4 v64, s[4:7], s46 offen lds
  s_add_u32 m0, s51, 53248
  s_add_u32 s46, s62, 4325376
  buffer_load_dwordx4 v64, s[4:7], s46 offen lds
  s_add_u32 m0, s51, 57344
  s_add_u32 s46, s62, 3932288
  buffer_load_dwordx4 v64, s[4:7], s46 offen lds
  s_add_u32 m0, s51, 61440
  s_add_u32 s46, s62, 4325504
  buffer_load_dwordx4 v64, s[4:7], s46 offen lds
  s_add_u32 m0, s51, 65536
  s_add_u32 s46, s62, 3932416
  buffer_load_dwordx4 v64, s[4:7], s46 offen lds
  s_add_u32 m0, s51, 69632
  s_add_u32 s46, s62, 4325632
  buffer_load_dwordx4 v64, s[4:7], s46 offen lds
  ds_read_b64_tr_b16 v[184:185], v66 offset:8192
  ds_read_b64_tr_b16 v[186:187], v66 offset:9216
  ds_read_b64_tr_b16 v[188:189], v66 offset:12288
  ds_read_b64_tr_b16 v[190:191], v66 offset:13312
  ds_read_b64_tr_b16 v[192:193], v66 offset:16384
  ds_read_b64_tr_b16 v[194:195], v66 offset:17408
  ds_read_b64_tr_b16 v[196:197], v66 offset:20480
  ds_read_b64_tr_b16 v[198:199], v66 offset:21504
  ds_read_b64_tr_b16 v[200:201], v66 offset:24576
  ds_read_b64_tr_b16 v[202:203], v66 offset:25600
  ds_read_b64_tr_b16 v[204:205], v66 offset:28672
  ds_read_b64_tr_b16 v[206:207], v66 offset:29696
  s_waitcnt lgkmcnt(0)
  s_waitcnt vmcnt(24)
  s_barrier
  s_add_u32 m0, s51, 73728
  s_add_u32 s46, s62, 5505024
  buffer_load_dwordx4 v64, s[12:15], s46 offen lds
  s_add_u32 m0, s51, 77824
  s_add_u32 s46, s62, 5898240
  buffer_load_dwordx4 v64, s[12:15], s46 offen lds
  s_add_u32 m0, s51, 81920
  s_add_u32 s46, s62, 5505152
  buffer_load_dwordx4 v64, s[12:15], s46 offen lds
  s_add_u32 m0, s51, 86016
  s_add_u32 s46, s62, 5898368
  buffer_load_dwordx4 v64, s[12:15], s46 offen lds
  s_add_u32 m0, s51, 90112
  s_add_u32 s46, s62, 5505280
  buffer_load_dwordx4 v64, s[12:15], s46 offen lds
  s_add_u32 m0, s51, 94208
  s_add_u32 s46, s62, 5898496
  buffer_load_dwordx4 v64, s[12:15], s46 offen lds
  ds_read_b64_tr_b16 v[208:209], v66 offset:32768
  ds_read_b64_tr_b16 v[210:211], v66 offset:33792
  ds_read_b64_tr_b16 v[212:213], v66 offset:36864
  ds_read_b64_tr_b16 v[214:215], v66 offset:37888
  ds_read_b64_tr_b16 v[216:217], v66 offset:40960
  ds_read_b64_tr_b16 v[218:219], v66 offset:41984
  ds_read_b64_tr_b16 v[220:221], v66 offset:45056
  ds_read_b64_tr_b16 v[222:223], v66 offset:46080
  ds_read_b64_tr_b16 v[224:225], v66 offset:49152
  ds_read_b64_tr_b16 v[226:227], v66 offset:50176
  ds_read_b64_tr_b16 v[228:229], v66 offset:53248
  ds_read_b64_tr_b16 v[230:231], v66 offset:54272
  s_waitcnt lgkmcnt(0)
  s_waitcnt vmcnt(24)
  s_barrier
  s_add_u32 m0, s51, 98304
  s_add_u32 s46, s62, 6291456
  buffer_load_dwordx4 v64, s[4:7], s46 offen lds
  s_add_u32 m0, s51, 102400
  s_add_u32 s46, s62, 6684672
  buffer_load_dwordx4 v64, s[4:7], s46 offen lds
  s_add_u32 m0, s51, 106496
  s_add_u32 s46, s62, 6291584
  buffer_load_dwordx4 v64, s[4:7], s46 offen lds
  s_add_u32 m0, s51, 110592
  s_add_u32 s46, s62, 6684800
  buffer_load_dwordx4 v64, s[4:7], s46 offen lds
  s_add_u32 m0, s51, 114688
  s_add_u32 s46, s62, 6291712
  buffer_load_dwordx4 v64, s[4:7], s46 offen lds
  s_add_u32 m0, s51, 118784
  s_add_u32 s46, s62, 6684928
  buffer_load_dwordx4 v64, s[4:7], s46 offen lds
  ds_read_b64_tr_b16 v[232:233], v66 offset:57344
  ds_read_b64_tr_b16 v[234:235], v66 offset:58368
  ds_read_b64_tr_b16 v[236:237], v66 offset:61440
  ds_read_b64_tr_b16 v[238:239], v66 offset:62464
  ds_read_b64_tr_b16 v[240:241], v67 offset:0
  ds_read_b64_tr_b16 v[242:243], v67 offset:1024
  ds_read_b64_tr_b16 v[244:245], v67 offset:4096
  ds_read_b64_tr_b16 v[246:247], v67 offset:5120
  ds_read_b64_tr_b16 v[248:249], v67 offset:8192
  ds_read_b64_tr_b16 v[250:251], v67 offset:9216
  ds_read_b64_tr_b16 v[252:253], v67 offset:12288
  ds_read_b64_tr_b16 v[254:255], v67 offset:13312
  s_waitcnt lgkmcnt(0)
  s_waitcnt vmcnt(24)
  s_barrier
  ds_read_b64_tr_b16 v[40:41], v65 offset:0
  ds_read_b64_tr_b16 v[42:43], v65 offset:1024
  ds_read_b64_tr_b16 v[44:45], v65 offset:4096
  ds_read_b64_tr_b16 v[46:47], v65 offset:5120
  ds_read_b64_tr_b16 v[48:49], v65 offset:8192
  ds_read_b64_tr_b16 v[50:51], v65 offset:9216
  ds_read_b64_tr_b16 v[52:53], v65 offset:12288
  ds_read_b64_tr_b16 v[54:55], v65 offset:13312
  ds_read_b64_tr_b16 v[56:57], v65 offset:16384
  ds_read_b64_tr_b16 v[58:59], v65 offset:17408
  ds_read_b64_tr_b16 v[60:61], v65 offset:20480
  ds_read_b64_tr_b16 v[62:63], v65 offset:21504
  s_waitcnt lgkmcnt(0)
  s_waitcnt vmcnt(18)
  s_barrier
  ds_write_b128 v2, v[40:43] offset:0
  ds_write_b128 v2, v[44:47] offset:4096
  ds_write_b128 v2, v[48:51] offset:8192
  ds_write_b128 v2, v[52:55] offset:12288
  ds_write_b128 v2, v[56:59] offset:16384
  ds_write_b128 v2, v[60:63] offset:20480
  ds_read_b64_tr_b16 v[16:17], v65 offset:24576
  ds_read_b64_tr_b16 v[18:19], v65 offset:25600
  ds_read_b64_tr_b16 v[20:21], v65 offset:28672
  ds_read_b64_tr_b16 v[22:23], v65 offset:29696
  ds_read_b64_tr_b16 v[24:25], v65 offset:32768
  ds_read_b64_tr_b16 v[26:27], v65 offset:33792
  ds_read_b64_tr_b16 v[28:29], v65 offset:36864
  ds_read_b64_tr_b16 v[30:31], v65 offset:37888
  ds_read_b64_tr_b16 v[32:33], v65 offset:40960
  ds_read_b64_tr_b16 v[34:35], v65 offset:41984
  ds_read_b64_tr_b16 v[36:37], v65 offset:45056
  ds_read_b64_tr_b16 v[38:39], v65 offset:46080
  s_waitcnt lgkmcnt(0)
  s_waitcnt vmcnt(12)
  s_barrier
  ds_write_b128 v2, v[16:19] offset:24576
  ds_write_b128 v2, v[20:23] offset:28672
  ds_write_b128 v2, v[24:27] offset:32768
  ds_write_b128 v2, v[28:31] offset:36864
  ds_write_b128 v2, v[32:35] offset:40960
  ds_write_b128 v2, v[36:39] offset:45056
  ds_read_b64_tr_b16 v[40:41], v65 offset:49152
  ds_read_b64_tr_b16 v[42:43], v65 offset:50176
  ds_read_b64_tr_b16 v[44:45], v65 offset:53248
  ds_read_b64_tr_b16 v[46:47], v65 offset:54272
  ds_read_b64_tr_b16 v[48:49], v65 offset:57344
  ds_read_b64_tr_b16 v[50:51], v65 offset:58368
  ds_read_b64_tr_b16 v[52:53], v65 offset:61440
  ds_read_b64_tr_b16 v[54:55], v65 offset:62464
  ds_read_b64_tr_b16 v[56:57], v66 offset:0
  ds_read_b64_tr_b16 v[58:59], v66 offset:1024
  ds_read_b64_tr_b16 v[60:61], v66 offset:4096
  ds_read_b64_tr_b16 v[62:63], v66 offset:5120
  s_waitcnt lgkmcnt(0)
  s_waitcnt vmcnt(6)
  s_barrier
  ds_write_b128 v2, v[40:43] offset:49152
  ds_write_b128 v2, v[44:47] offset:53248
  ds_write_b128 v2, v[48:51] offset:57344
  ds_write_b128 v2, v[52:55] offset:61440
  ds_write_b128 v3, v[56:59] offset:0
  ds_write_b128 v3, v[60:63] offset:4096
  ds_read_b64_tr_b16 v[16:17], v66 offset:8192
  ds_read_b64_tr_b16 v[18:19], v66 offset:9216
  ds_read_b64_tr_b16 v[20:21], v66 offset:12288
  ds_read_b64_tr_b16 v[22:23], v66 offset:13312
  ds_read_b64_tr_b16 v[24:25], v66 offset:16384
  ds_read_b64_tr_b16 v[26:27], v66 offset:17408
  ds_read_b64_tr_b16 v[28:29], v66 offset:20480
  ds_read_b64_tr_b16 v[30:31], v66 offset:21504
  ds_read_b64_tr_b16 v[32:33], v66 offset:24576
  ds_read_b64_tr_b16 v[34:35], v66 offset:25600
  ds_read_b64_tr_b16 v[36:37], v66 offset:28672
  ds_read_b64_tr_b16 v[38:39], v66 offset:29696
  s_waitcnt lgkmcnt(0)
  s_waitcnt vmcnt(0)
  s_barrier
  ds_write_b128 v3, v[16:19] offset:8192
  ds_write_b128 v3, v[20:23] offset:12288
  ds_write_b128 v3, v[24:27] offset:16384
  ds_write_b128 v3, v[28:31] offset:20480
  ds_write_b128 v3, v[32:35] offset:24576
  ds_write_b128 v3, v[36:39] offset:28672
  ds_read_b64_tr_b16 v[40:41], v66 offset:32768
  ds_read_b64_tr_b16 v[42:43], v66 offset:33792
  ds_read_b64_tr_b16 v[44:45], v66 offset:36864
  ds_read_b64_tr_b16 v[46:47], v66 offset:37888
  ds_read_b64_tr_b16 v[48:49], v66 offset:40960
  ds_read_b64_tr_b16 v[50:51], v66 offset:41984
  ds_read_b64_tr_b16 v[52:53], v66 offset:45056
  ds_read_b64_tr_b16 v[54:55], v66 offset:46080
  ds_read_b64_tr_b16 v[56:57], v66 offset:49152
  ds_read_b64_tr_b16 v[58:59], v66 offset:50176
  ds_read_b64_tr_b16 v[60:61], v66 offset:53248
  ds_read_b64_tr_b16 v[62:63], v66 offset:54272
  s_waitcnt lgkmcnt(0)
  s_barrier
  ds_write_b128 v3, v[40:43] offset:32768
  ds_write_b128 v3, v[44:47] offset:36864
  ds_write_b128 v3, v[48:51] offset:40960
  ds_write_b128 v3, v[52:55] offset:45056
  ds_write_b128 v3, v[56:59] offset:49152
  ds_write_b128 v3, v[60:63] offset:53248
  s_waitcnt lgkmcnt(0)
  v_and_b32 v138, 1, v0
  v_lshlrev_b32 v138, 7, v138
  v_add_u32 v138, 3014656, v138
  s_mov_b32 s50, 0
pol_21:
  buffer_load_dword v136, v138, s[8:11], 0 offen sc1
  s_add_u32 s50, s50, 1
  s_cmp_gt_u32 s50, 2097152
  s_cbranch_scc1 L_fail
  s_waitcnt vmcnt(0)
  v_cmp_eq_u32 vcc, 0, v136
  s_cbranch_vccnz pol_21
  v_readlane_b32 s54, v136, 0
  v_readlane_b32 s55, v136, 1
  s_and_b32 s54, s54, 0x2000
  s_and_b32 s55, s55, 0x2000
  s_mov_b32 s68, 0xfffffffe
  v_and_b32 v136, 3, v0
  s_lshl_b32 s46, s43, 9
  s_add_u32 s46, s46, s55
  s_add_u32 s46, s46, 2883584
  v_lshl_add_u32 v10, v136, 7, s46
  s_lshl_b32 s46, s43, 7
  s_add_u32 s46, s46, s55
  s_add_u32 s46, s46, 2885632
  v_lshl_add_u32 v11, v136, 9, s46
  v_mov_b32 v7, 0x44444444
  v_mov_b32 v136, 0xeeeeeeee
  v_and_b32 v137, 8, v0
  v_cmp_ne_u32 vcc, 0, v137
  s_nop 1
  v_cndmask_b32 v7, v7, v136, vcc
  s_mov_b32 s69, 1037384597
  s_mov_b32 s70, 3494803967
  v_and_b32 v136, 15, v0
  v_lshrrev_b32 v137, 1, v136
  v_and_b32 v137, 4, v137
  v_xor_b32 v137, v137, v136
  v_lshlrev_b32 v4, 5, v137
  v_lshrrev_b32 v137, 2, v136
  v_lshrrev_b32 v138, 4, v0
  v_xor_b32 v137, v137, v138
  v_lshl_add_u32 v4, v137, 3, v4
  s_lshl_b32 s46, s42, 9
  s_add_u32 s46, s46, 147456
  v_add_u32 v4, s46, v4
  v_lshlrev_b32 v5, 8, v138
  v_and_b32 v137, 1, v138
  v_lshl_add_u32 v5, v137, 7, v5
  v_lshlrev_b32 v137, 1, v137
  v_and_b32 v139, 3, v0
  v_xor_b32 v137, v137, v139
  v_lshl_add_u32 v5, v137, 3, v5
  v_bfe_u32 v137, v0, 2, 2
  v_lshl_add_u32 v5, v137, 5, v5
  v_xor_b32 v6, 0x88, v5
  v_add_u32 v5, 147456, v5
  v_add_u32 v6, 147456, v6
  v_add_u32 v13, 122880, v1
  s_lshl_b32 s46, s42, 16
  s_add_u32 s46, s46, s55
  s_add_u32 s46, s46, 2097152
  s_lshr_b32 s47, s45, 4
  s_add_u32 s47, s47, 1
  s_lshl_b32 s47, s47, 14
  s_and_b32 s48, s45, 15
  s_lshl_b32 s48, s48, 9
  s_add_u32 s47, s47, s48
  s_add_u32 s47, s47, s46
  v_lshrrev_b32 v137, 1, v138
  v_and_b32 v139, 1, v138
  v_lshl_add_u32 v8, v137, 4, v136
  v_lshlrev_b32 v8, 4, v8
  v_lshl_add_u32 v8, v139, 3, v8
  v_add_u32 v8, s47, v8
  s_lshl_b32 s47, s45, 7
  s_add_u32 s47, s47, s46
  s_add_u32 s47, s47, 51200
  v_lshl_add_u32 v9, v137, 3, v136
  v_lshlrev_b32 v9, 3, v9
  v_lshl_add_u32 v9, v139, 2, v9
  v_add_u32 v9, s47, v9
  v_mov_b32 v140, 2146435072
  v_cmp_lt_u32 vcc, 7, v136
  s_nop 1
  v_cndmask_b32 v9, v9, v140, vcc
  v_lshlrev_b32 v14, 4, v136
  v_lshl_add_u32 v14, v139, 3, v14
  v_lshl_add_u32 v14, v137, 2, v14
  s_mul_i32 s47, s45, 768
  s_sub_u32 s47, 32768, s47
  v_add_u32 v14, s47, v14
  s_lshl_b32 s47, s42, 4
  v_add_u32 v136, s47, v136
  v_lshlrev_b32 v138, 2, v138
  v_sub_u32 v136, v136, v138
  v_cmp_gt_i32 s[72:73], 0, v136
  v_cmp_gt_i32 s[74:75], 1, v136
  v_cmp_gt_i32 s[76:77], 2, v136
  v_cmp_gt_i32 s[78:79], 3, v136
  v_cmp_gt_i32 s[80:81], 16, v136
  v_cmp_gt_i32 s[82:83], 17, v136
  v_cmp_gt_i32 s[84:85], 18, v136
  v_cmp_gt_i32 s[86:87], 19, v136
  s_lshl_b32 s46, s45, 7
  s_lshl_b32 s47, s42, 2
  s_add_u32 s47, s47, s46
  s_add_u32 s47, s47, 2981888
  v_mov_b32 v15, s47
  s_cmp_lg_u32 s42, 2
  s_cbranch_scc1 sc_fl
  v_and_b32 v15, 1, v0
  v_lshlrev_b32 v15, 14, v15
  s_add_u32 s46, s46, 2899968
  v_add_u32 v15, s46, v15
sc_fl:
  s_mul_i32 s63, s45, 786432
  s_add_u32 s63, s63, 8388608
  s_lshl_b32 s64, s45, 10
  s_mul_i32 s46, s42, 40960
  s_add_u32 s64, s64, s46
  s_add_u32 s64, s64, 188743680
  s_mov_b32 s61, 0
  s_mov_b32 s52, 0
  s_mov_b32 s58, 0
  s_mov_b32 s65, 524288
  s_mov_b32 s100, 0
sc_loop:
  s_add_u32 s53, s52, 1
  s_cmp_lg_u32 s42, 2
  s_cbranch_scc1 sc_nodma
  s_cmp_ge_u32 s61, s53
  s_cbranch_scc1 wf_done_22
  s_mov_b32 s50, 0
wf_loop_23:
  buffer_load_dword v136, v15, s[8:11], 0 offen sc1
  s_add_u32 s50, s50, 1
  s_cmp_gt_u32 s50, 2097152
  s_cbranch_scc1 L_fail
  s_waitcnt vmcnt(0)
  v_min_u32_dpp v136, v136, v136 row_ror:8 row_mask:0xf bank_mask:0xf
  s_nop 1
  v_min_u32_dpp v136, v136, v136 row_ror:4 row_mask:0xf bank_mask:0xf
  s_nop 1
  v_min_u32_dpp v136, v136, v136 row_ror:2 row_mask:0xf bank_mask:0xf
  s_nop 1
  v_min_u32_dpp v136, v136, v136 row_ror:1 row_mask:0xf bank_mask:0xf
  v_mov_b32 v137, v136
  s_nop 1
  v_permlane16_swap_b32 v137, v136
  v_min_u32 v136, v136, v137
  v_mov_b32 v137, v136
  s_nop 1
  v_permlane32_swap_b32 v137, v136
  v_min_u32 v136, v136, v137
  s_nop 0
  v_readfirstlane_b32 s61, v136
  s_nop 0
  s_cmp_lt_u32 s61, s53
  s_cbranch_scc1 wf_loop_23
wf_done_22:
  s_mov_b32 m0, 122880
  s_add_u32 s46, s63, 25165824
  buffer_load_dwordx4 v1, s[8:11], s46 offen offset:0 sc1 lds
  buffer_load_dwordx4 v1, s[8:11], s46 offen offset:1024 sc1 lds
  buffer_load_dwordx4 v1, s[8:11], s46 offen offset:2048 sc1 lds
  buffer_load_dwordx4 v1, s[8:11], s46 offen offset:3072 sc1 lds
  s_mov_b32 m0, 126976
  s_add_u32 s46, s63, 25169920
  buffer_load_dwordx4 v1, s[8:11], s46 offen offset:0 sc1 lds
  buffer_load_dwordx4 v1, s[8:11], s46 offen offset:1024 sc1 lds
  buffer_load_dwordx4 v1, s[8:11], s46 offen offset:2048 sc1 lds
  buffer_load_dwordx4 v1, s[8:11], s46 offen offset:3072 sc1 lds
  s_mov_b32 m0, 131072
  s_add_u32 s46, s63, 25174016
  buffer_load_dwordx4 v1, s[8:11], s46 offen offset:0 sc1 lds
  buffer_load_dwordx4 v1, s[8:11], s46 offen offset:1024 sc1 lds
  buffer_load_dwordx4 v1, s[8:11], s46 offen offset:2048 sc1 lds
  buffer_load_dwordx4 v1, s[8:11], s46 offen offset:3072 sc1 lds
  s_mov_b32 m0, 135168
  s_add_u32 s46, s63, 0
  buffer_load_dwordx4 v1, s[8:11], s46 offen offset:0 sc1 lds
  buffer_load_dwordx4 v1, s[8:11], s46 offen offset:1024 sc1 lds
  buffer_load_dwordx4 v1, s[8:11], s46 offen offset:2048 sc1 lds
  buffer_load_dwordx4 v1, s[8:11], s46 offen offset:3072 sc1 lds
  s_mov_b32 m0, 139264
  s_add_u32 s46, s63, 4096
  buffer_load_dwordx4 v1, s[8:11], s46 offen offset:0 sc1 lds
  buffer_load_dwordx4 v1, s[8:11], s46 offen offset:1024 sc1 lds
  buffer_load_dwordx4 v1, s[8:11], s46 offen offset:2048 sc1 lds
  buffer_load_dwordx4 v1, s[8:11], s46 offen offset:3072 sc1 lds
  s_mov_b32 m0, 143360
  s_add_u32 s46, s63, 8192
  buffer_load_dwordx4 v1, s[8:11], s46 offen offset:0 sc1 lds
  buffer_load_dwordx4 v1, s[8:11], s46 offen offset:1024 sc1 lds
  buffer_load_dwordx4 v1, s[8:11], s46 offen offset:2048 sc1 lds
  buffer_load_dwordx4 v1, s[8:11], s46 offen offset:3072 sc1 lds
sc_nodma:
  s_add_u32 s63, s63, 12288
  s_lshl_b32 s56, s58, 2
  s_add_u32 s56, s56, s43
  s_lshl_b32 s56, s56, 16
  s_add_u32 s56, s56, s55
  s_add_u32 s56, s56, 2097152
  s_add_u32 s59, s56, 4096
  s_add_u32 s57, s56, 49152
  s_lshl_b32 s66, s58, 18
  ds_read_b128 v[56:59], v2 offset:0
  ds_read_b128 v[60:63], v2 offset:4096
  ds_read_b128 v[64:67], v2 offset:8192
  ds_read_b128 v[68:71], v2 offset:12288
  ds_read_b128 v[72:75], v2 offset:16384
  ds_read_b128 v[76:79], v2 offset:20480
  ds_read_b128 v[80:83], v2 offset:24576
  ds_read_b128 v[84:87], v2 offset:28672
  v_mov_b32 v88, 0
  v_mov_b32 v89, 0
  v_mov_b32 v90, 0
  v_mov_b32 v91, 0
  v_mov_b32 v92, 0
  v_mov_b32 v93, 0
  v_mov_b32 v94, 0
  v_mov_b32 v95, 0
  v_mov_b32 v96, 0
  v_mov_b32 v97, 0
  v_mov_b32 v98, 0
  v_mov_b32 v99, 0
  v_mov_b32 v100, 0
  v_mov_b32 v101, 0
  v_mov_b32 v102, 0
  v_mov_b32 v103, 0
  v_mov_b32 v104, 0
  v_mov_b32 v105, 0
  v_mov_b32 v106, 0
  v_mov_b32 v107, 0
  v_mov_b32 v108, 0
  v_mov_b32 v109, 0
  v_mov_b32 v110, 0
  v_mov_b32 v111, 0
  s_cmp_lg_u32 s42, 3
  s_cbranch_scc1 sc_nobell
  s_mov_b32 s50, 0
  s_mov_b64 exec, 15
  buffer_load_dword v112, v10, s[8:11], 0 offen sc1
  s_nop 11
  buffer_load_dword v113, v10, s[8:11], 0 offen sc1
  s_nop 11
  buffer_load_dword v114, v10, s[8:11], 0 offen sc1
  s_nop 11
  buffer_load_dword v115, v10, s[8:11], 0 offen sc1
  s_nop 11
  buffer_load_dword v116, v10, s[8:11], 0 offen sc1
  s_nop 11
  buffer_load_dword v117, v10, s[8:11], 0 offen sc1
  s_nop 11
  buffer_load_dword v118, v10, s[8:11], 0 offen sc1
  s_nop 11
  buffer_load_dword v119, v10, s[8:11], 0 offen sc1
  s_nop 11
  buffer_load_dword v120, v10, s[8:11], 0 offen sc1
  s_nop 11
bell_24:
  buffer_load_dword v121, v10, s[8:11], 0 offen sc1
  s_waitcnt vmcnt(9)
  v_cmp_gt_u32 vcc, s53, v112
  s_cbranch_vccz bell_x_25
  s_nop 7
  buffer_load_dword v112, v10, s[8:11], 0 offen sc1
  s_waitcnt vmcnt(9)
  v_cmp_gt_u32 vcc, s53, v113
  s_cbranch_vccz bell_x_25
  s_nop 7
  buffer_load_dword v113, v10, s[8:11], 0 offen sc1
  s_waitcnt vmcnt(9)
  v_cmp_gt_u32 vcc, s53, v114
  s_cbranch_vccz bell_x_25
  s_nop 7
  buffer_load_dword v114, v10, s[8:11], 0 offen sc1
  s_waitcnt vmcnt(9)
  v_cmp_gt_u32 vcc, s53, v115
  s_cbranch_vccz bell_x_25
  s_nop 7
  buffer_load_dword v115, v10, s[8:11], 0 offen sc1
  s_waitcnt vmcnt(9)
  v_cmp_gt_u32 vcc, s53, v116
  s_cbranch_vccz bell_x_25
  s_nop 7
  buffer_load_dword v116, v10, s[8:11], 0 offen sc1
  s_waitcnt vmcnt(9)
  v_cmp_gt_u32 vcc, s53, v117
  s_cbranch_vccz bell_x_25
  s_nop 7
  buffer_load_dword v117, v10, s[8:11], 0 offen sc1
  s_waitcnt vmcnt(9)
  v_cmp_gt_u32 vcc, s53, v118
  s_cbranch_vccz bell_x_25
  s_nop 7
  buffer_load_dword v118, v10, s[8:11], 0 offen sc1
  s_waitcnt vmcnt(9)
  v_cmp_gt_u32 vcc, s53, v119
  s_cbranch_vccz bell_x_25
  s_nop 7
  buffer_load_dword v119, v10, s[8:11], 0 offen sc1
  s_waitcnt vmcnt(9)
  v_cmp_gt_u32 vcc, s53, v120
  s_cbranch_vccz bell_x_25
  s_nop 7
  buffer_load_dword v120, v10, s[8:11], 0 offen sc1
  s_waitcnt vmcnt(9)
  v_cmp_gt_u32 vcc, s53, v121
  s_cbranch_vccz bell_x_25
  s_add_u32 s50, s50, 1
  s_cmp_gt_u32 s50, 2097152
  s_cbranch_scc1 L_fail
  s_branch bell_24
bell_x_25:
  s_mov_b64 exec, -1
sc_nobell:
  s_waitcnt lgkmcnt(0)
  s_barrier
  buffer_load_dwordx4 v[16:19], v1, s[8:11], s56 offen offset:0 sc1
  s_barrier
  buffer_load_dwordx4 v[20:23], v1, s[8:11], s56 offen offset:1024 sc1
  s_barrier
  buffer_load_dwordx4 v[24:27], v1, s[8:11], s56 offen offset:2048 sc1
  s_barrier
  buffer_load_dwordx4 v[28:31], v1, s[8:11], s56 offen offset:3072 sc1
  s_barrier
  buffer_load_dwordx4 v[32:35], v1, s[8:11], s59 offen offset:0 sc1
  s_barrier
  buffer_load_dwordx4 v[36:39], v1, s[8:11], s59 offen offset:1024 sc1
  s_barrier
  buffer_load_dwordx4 v[40:43], v1, s[8:11], s59 offen offset:2048 sc1
sc_go_26:
  s_waitcnt vmcnt(6)
  v_smfmac_f32_16x16x64_bf16 v[88:91], v[16:19], a[0:7], v7
  v_max3_u32 v12, v16, v17, v18
  v_max3_u32 v12, v18, v19, v12
  v_smfmac_f32_16x16x64_bf16 v[92:95], v[16:19], a[8:15], v7
  v_smfmac_f32_16x16x64_bf16 v[96:99], v[16:19], a[16:23], v7
  v_smfmac_f32_16x16x64_bf16 v[100:103], v[16:19], a[24:31], v7
  buffer_load_dwordx4 v[44:47], v1, s[8:11], s59 offen offset:3072 sc1
  s_waitcnt vmcnt(6)
  v_smfmac_f32_16x16x64_bf16 v[88:91], v[20:23], a[48:55], v7
  v_max3_u32 v12, v20, v21, v12
  v_max3_u32 v12, v22, v23, v12
  v_smfmac_f32_16x16x64_bf16 v[92:95], v[20:23], a[56:63], v7
  v_smfmac_f32_16x16x64_bf16 v[96:99], v[20:23], a[64:71], v7
  v_smfmac_f32_16x16x64_bf16 v[100:103], v[20:23], a[72:79], v7
  buffer_load_dwordx4 v[48:51], v1, s[8:11], s57 offen offset:0 sc1
  s_waitcnt vmcnt(6)
  v_smfmac_f32_16x16x64_bf16 v[88:91], v[24:27], v[56:63], v7
  v_max3_u32 v12, v24, v25, v12
  v_max3_u32 v12, v26, v27, v12
  v_smfmac_f32_16x16x64_bf16 v[92:95], v[24:27], v[64:71], v7
  v_smfmac_f32_16x16x64_bf16 v[96:99], v[24:27], v[72:79], v7
  v_smfmac_f32_16x16x64_bf16 v[100:103], v[24:27], a[96:103], v7
  buffer_load_dwordx4 v[52:55], v1, s[8:11], s57 offen offset:1024 sc1
  s_waitcnt vmcnt(6)
  v_smfmac_f32_16x16x64_bf16 v[88:91], v[28:31], a[120:127], v7
  v_max3_u32 v12, v28, v29, v12
  v_max3_u32 v12, v30, v31, v12
  ds_read_b128 v[56:59], v2 offset:49152
  ds_read_b128 v[60:63], v2 offset:53248
  v_smfmac_f32_16x16x64_bf16 v[92:95], v[28:31], a[128:135], v7
  ds_read_b128 v[64:67], v2 offset:57344
  ds_read_b128 v[68:71], v2 offset:61440
  v_smfmac_f32_16x16x64_bf16 v[96:99], v[28:31], a[136:143], v7
  ds_read_b128 v[72:75], v3 offset:0
  ds_read_b128 v[76:79], v3 offset:4096
  v_smfmac_f32_16x16x64_bf16 v[100:103], v[28:31], a[144:151], v7
  s_waitcnt vmcnt(5)
  v_smfmac_f32_16x16x64_bf16 v[88:91], v[32:35], a[168:175], v7
  v_max3_u32 v12, v32, v33, v12
  v_max3_u32 v12, v34, v35, v12
  v_smfmac_f32_16x16x64_bf16 v[92:95], v[32:35], a[176:183], v7
  v_smfmac_f32_16x16x64_bf16 v[96:99], v[32:35], a[184:191], v7
  v_smfmac_f32_16x16x64_bf16 v[100:103], v[32:35], v[80:87], v7
  ds_read_b128 v[80:83], v3 offset:8192
  ds_read_b128 v[84:87], v3 offset:12288
  s_waitcnt vmcnt(4)
  s_waitcnt lgkmcnt(2)
  v_smfmac_f32_16x16x64_bf16 v[88:91], v[36:39], v[56:63], v7
  v_max3_u32 v12, v36, v37, v12
  v_max3_u32 v12, v38, v39, v12
  v_smfmac_f32_16x16x64_bf16 v[92:95], v[36:39], v[64:71], v7
  v_smfmac_f32_16x16x64_bf16 v[96:99], v[36:39], v[72:79], v7
  v_smfmac_f32_16x16x64_bf16 v[100:103], v[36:39], a[192:199], v7
  s_waitcnt vmcnt(3)
  v_smfmac_f32_16x16x64_bf16 v[88:91], v[40:43], a[216:223], v7
  v_max3_u32 v12, v40, v41, v12
  v_max3_u32 v12, v42, v43, v12
  ds_read_b128 v[56:59], v3 offset:32768
  ds_read_b128 v[60:63], v3 offset:36864
  v_smfmac_f32_16x16x64_bf16 v[92:95], v[40:43], a[224:231], v7
  ds_read_b128 v[64:67], v3 offset:40960
  ds_read_b128 v[68:71], v3 offset:45056
  v_smfmac_f32_16x16x64_bf16 v[96:99], v[40:43], a[232:239], v7
  ds_read_b128 v[72:75], v3 offset:49152
  ds_read_b128 v[76:79], v3 offset:53248
  v_smfmac_f32_16x16x64_bf16 v[100:103], v[40:43], a[240:247], v7
  s_waitcnt vmcnt(2)
  s_waitcnt lgkmcnt(6)
  v_smfmac_f32_16x16x64_bf16 v[88:91], v[44:47], v[160:167], v7
  v_max3_u32 v12, v44, v45, v12
  v_max3_u32 v12, v46, v47, v12
  v_smfmac_f32_16x16x64_bf16 v[92:95], v[44:47], v[168:175], v7
  v_smfmac_f32_16x16x64_bf16 v[96:99], v[44:47], v[176:183], v7
  v_smfmac_f32_16x16x64_bf16 v[100:103], v[44:47], v[80:87], v7
  ds_read_b128 v[80:83], v2 offset:32768
  ds_read_b128 v[84:87], v2 offset:36864
  s_waitcnt vmcnt(1)
  s_waitcnt lgkmcnt(2)
  v_smfmac_f32_16x16x64_bf16 v[88:91], v[48:51], v[56:63], v7
  v_max3_u32 v12, v48, v49, v12
  v_max3_u32 v12, v50, v51, v12
  v_smfmac_f32_16x16x64_bf16 v[92:95], v[48:51], v[64:71], v7
  v_smfmac_f32_16x16x64_bf16 v[96:99], v[48:51], v[72:79], v7
  v_smfmac_f32_16x16x64_bf16 v[100:103], v[48:51], v[184:191], v7
  s_waitcnt vmcnt(0)
  v_smfmac_f32_16x16x64_bf16 v[88:91], v[52:55], v[208:215], v7
  v_max3_u32 v12, v52, v53, v12
  v_max3_u32 v12, v54, v55, v12
  ds_read_b128 v[56:59], v3 offset:16384
  ds_read_b128 v[60:63], v3 offset:20480
  v_smfmac_f32_16x16x64_bf16 v[92:95], v[52:55], v[216:223], v7
  ds_read_b128 v[64:67], v2 offset:40960
  ds_read_b128 v[68:71], v2 offset:45056
  v_smfmac_f32_16x16x64_bf16 v[96:99], v[52:55], v[224:231], v7
  ds_read_b128 v[72:75], v3 offset:24576
  ds_read_b128 v[76:79], v3 offset:28672
  v_smfmac_f32_16x16x64_bf16 v[100:103], v[52:55], v[232:239], v7
  v_cmp_eq_u32 vcc, -1, v12
  s_cbranch_vccnz sc_redo_27
sc_ok_28:
  v_smfmac_f32_16x16x64_bf16 v[104:107], v[16:19], a[32:39], v7
  v_smfmac_f32_16x16x64_bf16 v[104:107], v[20:23], a[80:87], v7
  v_cvt_pk_bf16_f32 v136, v88, v89
  v_cvt_pk_bf16_f32 v137, v90, v91
  v_smfmac_f32_16x16x64_bf16 v[104:107], v[24:27], a[104:111], v7
  ds_write_b64 v4, v[136:137] offset:0
  v_cvt_pk_bf16_f32 v138, v92, v93
  v_smfmac_f32_16x16x64_bf16 v[104:107], v[28:31], a[152:159], v7
  v_cvt_pk_bf16_f32 v139, v94, v95
  ds_write_b64 v4, v[138:139] offset:2048
  v_smfmac_f32_16x16x64_bf16 v[104:107], v[36:39], a[200:207], v7
  v_cvt_pk_bf16_f32 v140, v96, v97
  v_cvt_pk_bf16_f32 v141, v98, v99
  v_smfmac_f32_16x16x64_bf16 v[104:107], v[40:43], a[248:255], v7
  ds_write_b64 v4, v[140:141] offset:4096
  v_cvt_pk_bf16_f32 v142, v100, v101
  v_smfmac_f32_16x16x64_bf16 v[104:107], v[48:51], v[192:199], v7
  v_cvt_pk_bf16_f32 v143, v102, v103
  ds_write_b64 v4, v[142:143] offset:6144
  v_smfmac_f32_16x16x64_bf16 v[104:107], v[52:55], v[240:247], v7
  s_waitcnt lgkmcnt(1)
  s_barrier
  v_smfmac_f32_16x16x64_bf16 v[104:107], v[32:35], v[80:87], v7
  ds_read_b64_tr_b16 v[112:113], v5 offset:0
  ds_read_b64_tr_b16 v[114:115], v6 offset:0
  v_smfmac_f32_16x16x64_bf16 v[104:107], v[44:47], v[56:63], v7
  ds_read_b64_tr_b16 v[116:117], v5 offset:1024
  ds_read_b64_tr_b16 v[118:119], v6 offset:1024
  v_smfmac_f32_16x16x64_bf16 v[108:111], v[32:35], v[64:71], v7
  ds_read_b64_tr_b16 v[120:121], v5 offset:2048
  ds_read_b64_tr_b16 v[122:123], v6 offset:2048
  v_smfmac_f32_16x16x64_bf16 v[108:111], v[44:47], v[72:79], v7
  ds_read_b64_tr_b16 v[124:125], v5 offset:3072
  ds_read_b64_tr_b16 v[126:127], v6 offset:3072
  v_smfmac_f32_16x16x64_bf16 v[108:111], v[16:19], a[40:47], v7
  ds_read_b64_tr_b16 v[128:129], v5 offset:4096
  ds_read_b64_tr_b16 v[130:131], v6 offset:4096
  v_smfmac_f32_16x16x64_bf16 v[108:111], v[20:23], a[88:95], v7
  ds_read_b64_tr_b16 v[132:133], v5 offset:5120
  ds_read_b64_tr_b16 v[134:135], v6 offset:5120
  v_smfmac_f32_16x16x64_bf16 v[108:111], v[24:27], a[112:119], v7
  v_cvt_pk_bf16_f32 v136, v104, v105
  v_cvt_pk_bf16_f32 v137, v106, v107
  s_cmp_lg_u32 s67, 0
  s_cbranch_scc1 sc_noring
  v_mov_b32 v144, s53
  s_mov_b64 exec, 15
  buffer_store_dword v144, v11, s[8:11], 0 offen sc1
  s_mov_b64 exec, -1
sc_noring:
  v_smfmac_f32_16x16x64_bf16 v[108:111], v[28:31], a[160:167], v7
  ds_write_b64 v4, v[136:137] offset:8192
  ds_read_b128 v[56:59], v13 offset:0
  v_smfmac_f32_16x16x64_bf16 v[108:111], v[36:39], a[208:215], v7
  ds_read_b128 v[60:63], v13 offset:6144
  ds_read_b128 v[64:67], v13 offset:1024
  v_smfmac_f32_16x16x64_bf16 v[108:111], v[40:43], v[152:159], v7
  ds_read_b128 v[68:71], v13 offset:7168
  ds_read_b128 v[72:75], v13 offset:2048
  v_smfmac_f32_16x16x64_bf16 v[108:111], v[48:51], v[200:207], v7
  ds_read_b128 v[76:79], v13 offset:8192
  ds_read_b128 v[80:83], v13 offset:3072
  v_smfmac_f32_16x16x64_bf16 v[108:111], v[52:55], v[248:255], v7
  ds_read_b128 v[84:87], v13 offset:9216
  s_waitcnt lgkmcnt(0)
  v_mfma_f32_16x16x32_bf16 v[88:91], v[56:59], v[112:115], 0
  v_mfma_f32_16x16x32_bf16 v[92:95], v[60:63], v[112:115], 0
  v_mfma_f32_16x16x32_bf16 v[88:91], v[64:67], v[116:119], v[88:91]
  v_mfma_f32_16x16x32_bf16 v[92:95], v[68:71], v[116:119], v[92:95]
  ds_read_b128 v[56:59], v13 offset:4096
  ds_read_b128 v[60:63], v13 offset:10240
  ds_read_b128 v[64:67], v13 offset:5120
  ds_read_b128 v[68:71], v13 offset:11264
  v_cvt_pk_bf16_f32 v138, v108, v109
  v_cvt_pk_bf16_f32 v139, v110, v111
  ds_write_b64 v4, v[138:139] offset:10240
  v_mfma_f32_16x16x32_bf16 v[88:91], v[72:75], v[120:123], v[88:91]
  v_mfma_f32_16x16x32_bf16 v[92:95], v[76:79], v[120:123], v[92:95]
  v_mfma_f32_16x16x32_bf16 v[88:91], v[80:83], v[124:127], v[88:91]
  s_waitcnt lgkmcnt(0)
  s_barrier
  ds_read_b64_tr_b16 v[16:17], v5 offset:6144
  ds_read_b64_tr_b16 v[18:19], v6 offset:6144
  v_mfma_f32_16x16x32_bf16 v[92:95], v[84:87], v[124:127], v[92:95]
  ds_read_b64_tr_b16 v[20:21], v5 offset:7168
  ds_read_b64_tr_b16 v[22:23], v6 offset:7168
  v_mfma_f32_16x16x32_bf16 v[88:91], v[56:59], v[128:131], v[88:91]
  ds_read_b64_tr_b16 v[24:25], v5 offset:8192
  ds_read_b64_tr_b16 v[26:27], v6 offset:8192
  v_mfma_f32_16x16x32_bf16 v[92:95], v[60:63], v[128:131], v[92:95]
  ds_read_b64_tr_b16 v[28:29], v5 offset:9216
  ds_read_b64_tr_b16 v[30:31], v6 offset:9216
  v_mfma_f32_16x16x32_bf16 v[88:91], v[64:67], v[132:135], v[88:91]
  ds_read_b64_tr_b16 v[32:33], v5 offset:10240
  ds_read_b64_tr_b16 v[34:35], v6 offset:10240
  v_mfma_f32_16x16x32_bf16 v[92:95], v[68:71], v[132:135], v[92:95]
  ds_read_b64_tr_b16 v[36:37], v5 offset:11264
  ds_read_b64_tr_b16 v[38:39], v6 offset:11264
  s_waitcnt lgkmcnt(10)
  v_mfma_f32_16x16x32_bf16 v[96:99], v[16:19], v[112:115], 0
  s_waitcnt lgkmcnt(8)
  v_mfma_f32_16x16x32_bf16 v[96:99], v[20:23], v[116:119], v[96:99]
  s_waitcnt lgkmcnt(6)
  v_mfma_f32_16x16x32_bf16 v[96:99], v[24:27], v[120:123], v[96:99]
  s_waitcnt lgkmcnt(4)
  v_mfma_f32_16x16x32_bf16 v[96:99], v[28:31], v[124:127], v[96:99]
  s_waitcnt lgkmcnt(2)
  v_mfma_f32_16x16x32_bf16 v[96:99], v[32:35], v[128:131], v[96:99]
  v_add_f32_dpp v136, v88, v88 row_ror:8 row_mask:0xf bank_mask:3
  v_add_f32_dpp v137, v89, v89 row_ror:8 row_mask:0xf bank_mask:3
  s_waitcnt lgkmcnt(0)
  v_mfma_f32_16x16x32_bf16 v[96:99], v[36:39], v[132:135], v[96:99]
  v_add_f32_dpp v138, v92, v92 row_ror:8 row_mask:0xf bank_mask:3
  v_add_f32_dpp v139, v93, v93 row_ror:8 row_mask:0xf bank_mask:3
  v_add_f32_dpp v136, v90, v90 row_ror:8 row_mask:0xf bank_mask:12
  v_add_f32_dpp v137, v91, v91 row_ror:8 row_mask:0xf bank_mask:12
  v_add_f32_dpp v138, v94, v94 row_ror:8 row_mask:0xf bank_mask:12
  v_add_f32_dpp v139, v95, v95 row_ror:8 row_mask:0xf bank_mask:12
  v_max3_f32 v142, v136, v137, v138
  v_max_f32 v142, v142, v139
  v_permlane32_swap_b32 v96, v98
  v_permlane32_swap_b32 v97, v99
  v_max_f32_dpp v142, v142, v142 row_ror:8 row_mask:0xf bank_mask:0xf
  v_add_f32 v140, v96, v98
  v_add_f32 v141, v97, v99
  s_nop 0
  v_add_f32_dpp v140, v140, v140 row_ror:8 row_mask:0xf bank_mask:0xf
  v_add_f32_dpp v141, v141, v141 row_ror:8 row_mask:0xf bank_mask:0xf
  v_max3_f32 v142, v142, v140, v141
  v_mov_b32 v143, v142
  s_nop 1
  v_permlane16_swap_b32 v143, v142
  v_max_f32 v142, v142, v143
  v_mov_b32 v143, v142
  s_nop 1
  v_permlane32_swap_b32 v143, v142
  v_max_f32 v142, v142, v143
  v_mul_f32 v142, s69, v142
  v_fma_f32 v136, v136, s69, -v142
  v_fma_f32 v137, v137, s69, -v142
  v_fma_f32 v138, v138, s69, -v142
  v_fma_f32 v139, v139, s69, -v142
  v_fma_f32 v140, v140, s69, -v142
  v_fma_f32 v141, v141, s69, -v142
  v_exp_f32 v136, v136
  v_exp_f32 v137, v137
  v_exp_f32 v138, v138
  v_exp_f32 v139, v139
  v_exp_f32 v140, v140
  v_exp_f32 v141, v141
  v_add_f32 v142, v136, v137
  v_add_f32 v143, v138, v139
  v_add_f32 v142, v142, v143
  v_add_f32 v143, v140, v141
  s_nop 0
  v_add_f32_dpp v142, v142, v142 row_ror:8 row_mask:0xf bank_mask:0xf
  v_add_f32 v142, v142, v143
  v_mov_b32 v143, v142
  s_nop 1
  v_permlane16_swap_b32 v143, v142
  v_add_f32 v142, v142, v143
  v_mov_b32 v143, v142
  s_nop 1
  v_permlane32_swap_b32 v143, v142
  v_add_f32 v142, v142, v143
  v_rcp_f32 v142, v142
  s_nop 0
  v_mul_f32 v136, v136, v142
  v_mul_f32 v137, v137, v142
  v_mul_f32 v138, v138, v142
  v_mul_f32 v139, v139, v142
  v_mul_f32 v140, v140, v142
  v_mul_f32 v141, v141, v142
  v_cvt_pk_bf16_f32 v146, v136, v137
  v_cvt_pk_bf16_f32 v147, v138, v139
  v_cvt_pk_bf16_f32 v148, v140, v141
  v_min_u32 v146, s68, v146
  v_min_u32 v147, s68, v147
  v_min_u32 v148, s68, v148
  buffer_store_dwordx2 v[146:147], v8, s[8:11], s66 offen sc1
  buffer_store_dword v148, v9, s[8:11], s66 offen sc1
  v_mov_b32 v150, -1
  v_mov_b32 v151, -1
  buffer_store_dwordx2 v[150:151], v8, s[8:11], s65 offen sc1
  buffer_store_dword v150, v9, s[8:11], s65 offen sc1
  s_mov_b32 s65, s66
  s_cmp_ge_u32 s42, 2
  s_cbranch_scc1 sc_nox
  v_mov_b32 v136, s52
  s_mov_b64 exec, 1
  buffer_store_dword v136, v15, s[8:11], 0 offen sc1
  s_mov_b64 exec, -1
  s_mul_i32 s46, s42, 6144
  s_add_u32 s46, s46, 12288
  v_add_u32 v136, s46, v13
  ds_read_b128 v[112:115], v136 offset:0
  ds_read_b128 v[116:119], v136 offset:1024
  ds_read_b128 v[120:123], v136 offset:2048
  ds_read_b128 v[124:127], v136 offset:3072
  ds_read_b128 v[128:131], v136 offset:4096
  ds_read_b128 v[132:135], v136 offset:5120
  ds_read_b128 v[56:59], v13 offset:0
  ds_read_b128 v[60:63], v13 offset:6144
  ds_read_b128 v[64:67], v13 offset:1024
  ds_read_b128 v[68:71], v13 offset:7168
  ds_read_b128 v[72:75], v13 offset:2048
  ds_read_b128 v[76:79], v13 offset:8192
  ds_read_b128 v[80:83], v13 offset:3072
  ds_read_b128 v[84:87], v13 offset:9216
  s_waitcnt lgkmcnt(8)
  v_mfma_f32_16x16x32_bf16 v[96:99], v[16:19], v[112:115], 0
  v_mfma_f32_16x16x32_bf16 v[96:99], v[20:23], v[116:119], v[96:99]
  v_mfma_f32_16x16x32_bf16 v[96:99], v[24:27], v[120:123], v[96:99]
  v_mfma_f32_16x16x32_bf16 v[96:99], v[28:31], v[124:127], v[96:99]
  v_mfma_f32_16x16x32_bf16 v[96:99], v[32:35], v[128:131], v[96:99]
  v_mfma_f32_16x16x32_bf16 v[96:99], v[36:39], v[132:135], v[96:99]
  s_waitcnt lgkmcnt(0)
  v_mfma_f32_16x16x32_bf16 v[88:91], v[56:59], v[112:115], 0
  ds_read_b128 v[56:59], v13 offset:4096
  v_mfma_f32_16x16x32_bf16 v[92:95], v[60:63], v[112:115], 0
  ds_read_b128 v[60:63], v13 offset:10240
  v_mfma_f32_16x16x32_bf16 v[88:91], v[64:67], v[116:119], v[88:91]
  ds_read_b128 v[64:67], v13 offset:5120
  v_mfma_f32_16x16x32_bf16 v[92:95], v[68:71], v[116:119], v[92:95]
  ds_read_b128 v[68:71], v13 offset:11264
  v_mfma_f32_16x16x32_bf16 v[88:91], v[72:75], v[120:123], v[88:91]
  v_mfma_f32_16x16x32_bf16 v[92:95], v[76:79], v[120:123], v[92:95]
  v_mfma_f32_16x16x32_bf16 v[88:91], v[80:83], v[124:127], v[88:91]
  v_mfma_f32_16x16x32_bf16 v[92:95], v[84:87], v[124:127], v[92:95]
  s_waitcnt lgkmcnt(0)
  s_barrier
  v_mfma_f32_16x16x32_bf16 v[88:91], v[56:59], v[128:131], v[88:91]
  v_mfma_f32_16x16x32_bf16 v[92:95], v[60:63], v[128:131], v[92:95]
  v_mfma_f32_16x16x32_bf16 v[88:91], v[64:67], v[132:135], v[88:91]
  v_mfma_f32_16x16x32_bf16 v[92:95], v[68:71], v[132:135], v[92:95]
  v_permlane32_swap_b32 v96, v98
  v_permlane32_swap_b32 v97, v99
  v_add_f32 v96, v96, v98
  v_add_f32 v97, v97, v99
  v_mov_b32 v143, s70
  s_nop 1
  v_cndmask_b32 v88, v88, v143, s[72:73]
  v_cndmask_b32 v89, v89, v143, s[74:75]
  v_cndmask_b32 v90, v90, v143, s[76:77]
  v_cndmask_b32 v91, v91, v143, s[78:79]
  v_cndmask_b32 v92, v92, v143, s[80:81]
  v_cndmask_b32 v93, v93, v143, s[82:83]
  v_cndmask_b32 v94, v94, v143, s[84:85]
  v_cndmask_b32 v95, v95, v143, s[86:87]
  v_max_f32 v142, v88, v89
  v_max3_f32 v142, v142, v90, v91
  v_max3_f32 v142, v142, v92, v93
  v_max3_f32 v142, v142, v94, v95
  v_max3_f32 v142, v142, v96, v97
  v_mov_b32 v143, v142
  s_nop 1
  v_permlane16_swap_b32 v143, v142
  v_max_f32 v142, v142, v143
  v_mov_b32 v143, v142
  s_nop 1
  v_permlane32_swap_b32 v143, v142
  v_max_f32 v142, v142, v143
  v_mul_f32 v142, s69, v142
  v_fma_f32 v88, v88, s69, -v142
  v_fma_f32 v89, v89, s69, -v142
  v_fma_f32 v90, v90, s69, -v142
  v_fma_f32 v91, v91, s69, -v142
  v_fma_f32 v92, v92, s69, -v142
  v_fma_f32 v93, v93, s69, -v142
  v_fma_f32 v94, v94, s69, -v142
  v_fma_f32 v95, v95, s69, -v142
  v_fma_f32 v96, v96, s69, -v142
  v_fma_f32 v97, v97, s69, -v142
  v_exp_f32 v88, v88
  v_exp_f32 v89, v89
  v_exp_f32 v90, v90
  v_exp_f32 v91, v91
  v_exp_f32 v92, v92
  v_exp_f32 v93, v93
  v_exp_f32 v94, v94
  v_exp_f32 v95, v95
  v_exp_f32 v96, v96
  v_exp_f32 v97, v97
  v_add_f32 v142, v88, v89
  v_add_f32 v142, v142, v90
  v_add_f32 v142, v142, v91
  v_add_f32 v142, v142, v92
  v_add_f32 v142, v142, v93
  v_add_f32 v142, v142, v94
  v_add_f32 v142, v142, v95
  v_add_f32 v142, v142, v96
  v_add_f32 v142, v142, v97
  v_mov_b32 v143, v142
  s_nop 1
  v_permlane16_swap_b32 v143, v142
  v_add_f32 v142, v142, v143
  v_mov_b32 v143, v142
  s_nop 1
  v_permlane32_swap_b32 v143, v142
  v_add_f32 v142, v142, v143
  v_rcp_f32 v142, v142
  s_nop 0
  v_mul_f32 v88, v88, v142
  v_mul_f32 v89, v89, v142
  v_mul_f32 v90, v90, v142
  v_mul_f32 v91, v91, v142
  v_mul_f32 v92, v92, v142
  v_mul_f32 v93, v93, v142
  v_mul_f32 v94, v94, v142
  v_mul_f32 v95, v95, v142
  v_mul_f32 v96, v96, v142
  v_mul_f32 v97, v97, v142
  v_cvt_pk_bf16_f32 v144, v88, v89
  v_cvt_pk_bf16_f32 v145, v90, v91
  v_cvt_pk_bf16_f32 v146, v92, v93
  v_cvt_pk_bf16_f32 v147, v94, v95
  v_cvt_pk_bf16_f32 v148, v96, v97
  buffer_store_dwordx4 v[144:147], v1, s[8:11], s64 offen sc1
  buffer_store_dword v148, v14, s[8:11], s64 offen sc1
  s_add_u32 s64, s64, 81920
  s_branch sc_join
sc_nox:
  s_barrier
sc_join:
  s_add_u32 s58, s58, 1
  s_cmp_eq_u32 s58, 3
  s_cselect_b32 s58, 0, s58
  s_mov_b32 s52, s53
  s_cmp_lt_u32 s52, 64
  s_cbranch_scc1 sc_loop
  s_waitcnt vmcnt(0)
  s_cmp_ge_u32 s42, 2
  s_cbranch_scc1 sc_fin
  v_mov_b32 v136, s52
  s_mov_b64 exec, 1
  buffer_store_dword v136, v15, s[8:11], 0 offen sc1
  s_mov_b64 exec, -1
sc_fin:
  s_endpgm
sc_redo_27:
  s_mov_b32 s50, 0
  s_waitcnt lgkmcnt(0)
sc_poll_29:
  buffer_load_dwordx4 v[16:19], v1, s[8:11], s56 offen offset:0 sc1
  buffer_load_dwordx4 v[20:23], v1, s[8:11], s56 offen offset:1024 sc1
  buffer_load_dwordx4 v[24:27], v1, s[8:11], s56 offen offset:2048 sc1
  buffer_load_dwordx4 v[28:31], v1, s[8:11], s56 offen offset:3072 sc1
  buffer_load_dwordx4 v[32:35], v1, s[8:11], s59 offen offset:0 sc1
  buffer_load_dwordx4 v[36:39], v1, s[8:11], s59 offen offset:1024 sc1
  buffer_load_dwordx4 v[40:43], v1, s[8:11], s59 offen offset:2048 sc1
  buffer_load_dwordx4 v[44:47], v1, s[8:11], s59 offen offset:3072 sc1
  buffer_load_dwordx4 v[48:51], v1, s[8:11], s57 offen offset:0 sc1
  buffer_load_dwordx4 v[52:55], v1, s[8:11], s57 offen offset:1024 sc1
  s_add_u32 s50, s50, 1
  s_cmp_gt_u32 s50, 2097152
  s_cbranch_scc1 L_fail
  s_waitcnt vmcnt(0)
  v_max_u32 v12, v16, v17
  v_max3_u32 v12, v18, v19, v12
  v_max3_u32 v12, v20, v21, v12
  v_max3_u32 v12, v22, v23, v12
  v_max3_u32 v12, v24, v25, v12
  v_max3_u32 v12, v26, v27, v12
  v_max3_u32 v12, v28, v29, v12
  v_max3_u32 v12, v30, v31, v12
  v_max3_u32 v12, v32, v33, v12
  v_max3_u32 v12, v34, v35, v12
  v_max3_u32 v12, v36, v37, v12
  v_max3_u32 v12, v38, v39, v12
  v_max3_u32 v12, v40, v41, v12
  v_max3_u32 v12, v42, v43, v12
  v_max3_u32 v12, v44, v45, v12
  v_max3_u32 v12, v46, v47, v12
  v_max3_u32 v12, v48, v49, v12
  v_max3_u32 v12, v50, v51, v12
  v_max3_u32 v12, v52, v53, v12
  v_max3_u32 v12, v54, v55, v12
  v_cmp_eq_u32 vcc, -1, v12
  s_cbranch_vccnz sc_poll_29
  ds_read_b128 v[56:59], v2 offset:0
  ds_read_b128 v[60:63], v2 offset:4096
  ds_read_b128 v[64:67], v2 offset:8192
  ds_read_b128 v[68:71], v2 offset:12288
  ds_read_b128 v[72:75], v2 offset:16384
  ds_read_b128 v[76:79], v2 offset:20480
  ds_read_b128 v[80:83], v2 offset:24576
  ds_read_b128 v[84:87], v2 offset:28672
  v_mov_b32 v88, 0
  v_mov_b32 v89, 0
  v_mov_b32 v90, 0
  v_mov_b32 v91, 0
  v_mov_b32 v92, 0
  v_mov_b32 v93, 0
  v_mov_b32 v94, 0
  v_mov_b32 v95, 0
  v_mov_b32 v96, 0
  v_mov_b32 v97, 0
  v_mov_b32 v98, 0
  v_mov_b32 v99, 0
  v_mov_b32 v100, 0
  v_mov_b32 v101, 0
  v_mov_b32 v102, 0
  v_mov_b32 v103, 0
  v_mov_b32 v104, 0
  v_mov_b32 v105, 0
  v_mov_b32 v106, 0
  v_mov_b32 v107, 0
  v_mov_b32 v108, 0
  v_mov_b32 v109, 0
  v_mov_b32 v110, 0
  v_mov_b32 v111, 0
  s_waitcnt lgkmcnt(0)
  s_branch sc_go_26
L_value:
  s_mov_b32 s4, s30
  s_mov_b32 s5, s31
  s_mov_b32 s6, 7864320
  s_mov_b32 s7, 0x20000
  s_mov_b32 s12, s32
  s_mov_b32 s13, s33
  s_mov_b32 s14, 7864320
  s_mov_b32 s15, 0x20000
  v_lshrrev_b32 v148, 3, v0
  v_lshrrev_b32 v149, 2, v148
  v_lshlrev_b32 v149, 3, v149
  v_and_b32 v64, 3, v148
  v_add_u32 v64, v64, v149
  s_and_b32 s46, s42, 1
  s_lshl_b32 s46, s46, 2
  s_lshr_b32 s47, s42, 1
  s_lshl_b32 s47, s47, 4
  s_add_u32 s46, s46, s47
  v_add_u32 v64, s46, v64
  v_mul_u32_u24 v64, 12288, v64
  v_lshrrev_b32 v148, 1, v148
  v_bfe_u32 v149, v0, 1, 2
  v_xor_b32 v148, v148, v149
  v_lshlrev_b32 v148, 5, v148
  v_and_b32 v149, 1, v0
  v_lshlrev_b32 v149, 4, v149
  v_add3_u32 v64, v64, v148, v149
  v_lshrrev_b32 v148, 3, v0
  v_lshrrev_b32 v149, 2, v148
  v_lshlrev_b32 v149, 3, v149
  v_and_b32 v65, 3, v148
  v_add_u32 v65, v65, v149
  s_and_b32 s46, s42, 1
  s_lshl_b32 s46, s46, 2
  s_lshr_b32 s47, s42, 1
  s_lshl_b32 s47, s47, 4
  s_add_u32 s46, s46, s47
  v_add_u32 v65, s46, v65
  v_mul_u32_u24 v65, 1280, v65
  v_lshrrev_b32 v148, 1, v148
  v_bfe_u32 v149, v0, 1, 2
  v_xor_b32 v148, v148, v149
  v_lshlrev_b32 v148, 5, v148
  v_and_b32 v149, 1, v0
  v_lshlrev_b32 v149, 4, v149
  v_add3_u32 v65, v65, v148, v149
  v_lshrrev_b32 v148, 5, v0
  v_lshlrev_b32 v66, 11, v148
  v_bfe_u32 v148, v0, 2, 3
  v_lshl_add_u32 v66, v148, 7, v66
  v_lshrrev_b32 v148, 1, v148
  v_xor_b32 v148, s42, v148
  v_lshl_add_u32 v66, v148, 5, v66
  v_and_b32 v148, 3, v0
  v_lshl_add_u32 v66, v148, 3, v66
  v_add_u32 v67, 0x10000, v66
  v_add_u32 v68, 0x20000, v66
  v_lshlrev_b32 v1, 4, v0
  v_add_u32 v2, s51, v1
  v_add_u32 v3, 0x10000, v2
  s_mul_i32 s62, s45, 384
  s_mul_i32 s63, s45, 245760
  s_add_u32 m0, s51, 73728
  s_add_u32 s46, s63, 0
  buffer_load_dwordx4 v65, s[12:15], s46 offen lds
  s_add_u32 m0, s51, 77824
  s_add_u32 s46, s63, 128
  buffer_load_dwordx4 v65, s[12:15], s46 offen lds
  s_add_u32 m0, s51, 81920
  s_add_u32 s46, s63, 256
  buffer_load_dwordx4 v65, s[12:15], s46 offen lds
  s_add_u32 m0, s51, 86016
  s_add_u32 s46, s63, 384
  buffer_load_dwordx4 v65, s[12:15], s46 offen lds
  s_add_u32 m0, s51, 90112
  s_add_u32 s46, s63, 512
  buffer_load_dwordx4 v65, s[12:15], s46 offen lds
  s_add_u32 m0, s51, 94208
  s_add_u32 s46, s63, 640
  buffer_load_dwordx4 v65, s[12:15], s46 offen lds
  s_add_u32 m0, s51, 98304
  s_add_u32 s46, s63, 768
  buffer_load_dwordx4 v65, s[12:15], s46 offen lds
  s_add_u32 m0, s51, 102400
  s_add_u32 s46, s63, 896
  buffer_load_dwordx4 v65, s[12:15], s46 offen lds
  s_add_u32 m0, s51, 106496
  s_add_u32 s46, s63, 1024
  buffer_load_dwordx4 v65, s[12:15], s46 offen lds
  s_add_u32 m0, s51, 110592
  s_add_u32 s46, s63, 1152
  buffer_load_dwordx4 v65, s[12:15], s46 offen lds
  s_add_u32 m0, s51, 114688
  s_add_u32 s46, s63, 40960
  buffer_load_dwordx4 v65, s[12:15], s46 offen lds
  s_add_u32 m0, s51, 118784
  s_add_u32 s46, s63, 41088
  buffer_load_dwordx4 v65, s[12:15], s46 offen lds
  s_add_u32 m0, s51, 122880
  s_add_u32 s46, s63, 41216
  buffer_load_dwordx4 v65, s[12:15], s46 offen lds
  s_add_u32 m0, s51, 126976
  s_add_u32 s46, s63, 41344
  buffer_load_dwordx4 v65, s[12:15], s46 offen lds
  s_add_u32 m0, s51, 131072
  s_add_u32 s46, s63, 41472
  buffer_load_dwordx4 v65, s[12:15], s46 offen lds
  s_add_u32 m0, s51, 135168
  s_add_u32 s46, s63, 41600
  buffer_load_dwordx4 v65, s[12:15], s46 offen lds
  s_add_u32 m0, s51, 139264
  s_add_u32 s46, s63, 41728
  buffer_load_dwordx4 v65, s[12:15], s46 offen lds
  s_add_u32 m0, s51, 143360
  s_add_u32 s46, s63, 41856
  buffer_load_dwordx4 v65, s[12:15], s46 offen lds
  s_add_u32 m0, s51, 0
  s_add_u32 s46, s63, 41984
  buffer_load_dwordx4 v65, s[12:15], s46 offen lds
  s_add_u32 m0, s51, 4096
  s_add_u32 s46, s63, 42112
  buffer_load_dwordx4 v65, s[12:15], s46 offen lds
  s_add_u32 m0, s51, 8192
  s_add_u32 s46, s63, 81920
  buffer_load_dwordx4 v65, s[12:15], s46 offen lds
  s_add_u32 m0, s51, 12288
  s_add_u32 s46, s63, 82048
  buffer_load_dwordx4 v65, s[12:15], s46 offen lds
  s_add_u32 m0, s51, 16384
  s_add_u32 s46, s63, 82176
  buffer_load_dwordx4 v65, s[12:15], s46 offen lds
  s_add_u32 m0, s51, 20480
  s_add_u32 s46, s63, 82304
  buffer_load_dwordx4 v65, s[12:15], s46 offen lds
  s_add_u32 m0, s51, 24576
  s_add_u32 s46, s63, 82432
  buffer_load_dwordx4 v65, s[12:15], s46 offen lds
  s_add_u32 m0, s51, 28672
  s_add_u32 s46, s63, 82560
  buffer_load_dwordx4 v65, s[12:15], s46 offen lds
  s_add_u32 m0, s51, 32768
  s_add_u32 s46, s63, 82688
  buffer_load_dwordx4 v65, s[12:15], s46 offen lds
  s_add_u32 m0, s51, 36864
  s_add_u32 s46, s63, 82816
  buffer_load_dwordx4 v65, s[12:15], s46 offen lds
  s_add_u32 m0, s51, 40960
  s_add_u32 s46, s63, 82944
  buffer_load_dwordx4 v65, s[12:15], s46 offen lds
  s_add_u32 m0, s51, 45056
  s_add_u32 s46, s63, 83072
  buffer_load_dwordx4 v65, s[12:15], s46 offen lds
  s_waitcnt vmcnt(24)
  s_barrier
  s_add_u32 m0, s51, 49152
  s_add_u32 s46, s63, 122880
  buffer_load_dwordx4 v65, s[12:15], s46 offen lds
  s_add_u32 m0, s51, 53248
  s_add_u32 s46, s63, 123008
  buffer_load_dwordx4 v65, s[12:15], s46 offen lds
  s_add_u32 m0, s51, 57344
  s_add_u32 s46, s63, 123136
  buffer_load_dwordx4 v65, s[12:15], s46 offen lds
  s_add_u32 m0, s51, 61440
  s_add_u32 s46, s63, 123264
  buffer_load_dwordx4 v65, s[12:15], s46 offen lds
  s_add_u32 m0, s51, 65536
  s_add_u32 s46, s63, 123392
  buffer_load_dwordx4 v65, s[12:15], s46 offen lds
  s_add_u32 m0, s51, 69632
  s_add_u32 s46, s63, 123520
  buffer_load_dwordx4 v65, s[12:15], s46 offen lds
  ds_read_b64_tr_b16 a[0:1], v67 offset:8192
  ds_read_b64_tr_b16 a[2:3], v67 offset:9216
  ds_read_b64_tr_b16 a[24:25], v67 offset:12288
  ds_read_b64_tr_b16 a[26:27], v67 offset:13312
  ds_read_b64_tr_b16 a[48:49], v67 offset:16384
  ds_read_b64_tr_b16 a[50:51], v67 offset:17408
  ds_read_b64_tr_b16 a[72:73], v67 offset:20480
  ds_read_b64_tr_b16 a[74:75], v67 offset:21504
  ds_read_b64_tr_b16 a[96:97], v67 offset:24576
  ds_read_b64_tr_b16 a[98:99], v67 offset:25600
  ds_read_b64_tr_b16 a[120:121], v67 offset:28672
  ds_read_b64_tr_b16 a[122:123], v67 offset:29696
  s_waitcnt lgkmcnt(0)
  s_waitcnt vmcnt(24)
  s_barrier
  s_add_u32 m0, s51, 73728
  s_add_u32 s46, s63, 123648
  buffer_load_dwordx4 v65, s[12:15], s46 offen lds
  s_add_u32 m0, s51, 77824
  s_add_u32 s46, s63, 123776
  buffer_load_dwordx4 v65, s[12:15], s46 offen lds
  s_add_u32 m0, s51, 81920
  s_add_u32 s46, s63, 123904
  buffer_load_dwordx4 v65, s[12:15], s46 offen lds
  s_add_u32 m0, s51, 86016
  s_add_u32 s46, s63, 124032
  buffer_load_dwordx4 v65, s[12:15], s46 offen lds
  s_add_u32 m0, s51, 90112
  s_add_u32 s46, s63, 163840
  buffer_load_dwordx4 v65, s[12:15], s46 offen lds
  s_add_u32 m0, s51, 94208
  s_add_u32 s46, s63, 163968
  buffer_load_dwordx4 v65, s[12:15], s46 offen lds
  ds_read_b64_tr_b16 a[144:145], v67 offset:32768
  ds_read_b64_tr_b16 a[146:147], v67 offset:33792
  ds_read_b64_tr_b16 a[168:169], v67 offset:36864
  ds_read_b64_tr_b16 a[170:171], v67 offset:37888
  ds_read_b64_tr_b16 a[192:193], v67 offset:40960
  ds_read_b64_tr_b16 a[194:195], v67 offset:41984
  ds_read_b64_tr_b16 a[216:217], v67 offset:45056
  ds_read_b64_tr_b16 a[218:219], v67 offset:46080
  ds_read_b64_tr_b16 a[4:5], v67 offset:49152
  ds_read_b64_tr_b16 a[6:7], v67 offset:50176
  ds_read_b64_tr_b16 a[28:29], v67 offset:53248
  ds_read_b64_tr_b16 a[30:31], v67 offset:54272
  s_waitcnt lgkmcnt(0)
  s_waitcnt vmcnt(24)
  s_barrier
  s_add_u32 m0, s51, 98304
  s_add_u32 s46, s63, 164096
  buffer_load_dwordx4 v65, s[12:15], s46 offen lds
  s_add_u32 m0, s51, 102400
  s_add_u32 s46, s63, 164224
  buffer_load_dwordx4 v65, s[12:15], s46 offen lds
  s_add_u32 m0, s51, 106496
  s_add_u32 s46, s63, 164352
  buffer_load_dwordx4 v65, s[12:15], s46 offen lds
  s_add_u32 m0, s51, 110592
  s_add_u32 s46, s63, 164480
  buffer_load_dwordx4 v65, s[12:15], s46 offen lds
  s_add_u32 m0, s51, 114688
  s_add_u32 s46, s63, 164608
  buffer_load_dwordx4 v65, s[12:15], s46 offen lds
  s_add_u32 m0, s51, 118784
  s_add_u32 s46, s63, 164736
  buffer_load_dwordx4 v65, s[12:15], s46 offen lds
  ds_read_b64_tr_b16 a[52:53], v67 offset:57344
  ds_read_b64_tr_b16 a[54:55], v67 offset:58368
  ds_read_b64_tr_b16 a[76:77], v67 offset:61440
  ds_read_b64_tr_b16 a[78:79], v67 offset:62464
  ds_read_b64_tr_b16 a[100:101], v68 offset:0
  ds_read_b64_tr_b16 a[102:103], v68 offset:1024
  ds_read_b64_tr_b16 a[124:125], v68 offset:4096
  ds_read_b64_tr_b16 a[126:127], v68 offset:5120
  ds_read_b64_tr_b16 a[148:149], v68 offset:8192
  ds_read_b64_tr_b16 a[150:151], v68 offset:9216
  ds_read_b64_tr_b16 a[172:173], v68 offset:12288
  ds_read_b64_tr_b16 a[174:175], v68 offset:13312
  s_waitcnt lgkmcnt(0)
  s_waitcnt vmcnt(24)
  s_barrier
  s_add_u32 m0, s51, 122880
  s_add_u32 s46, s63, 164864
  buffer_load_dwordx4 v65, s[12:15], s46 offen lds
  s_add_u32 m0, s51, 126976
  s_add_u32 s46, s63, 164992
  buffer_load_dwordx4 v65, s[12:15], s46 offen lds
  s_add_u32 m0, s51, 131072
  s_add_u32 s46, s63, 204800
  buffer_load_dwordx4 v65, s[12:15], s46 offen lds
  s_add_u32 m0, s51, 135168
  s_add_u32 s46, s63, 204928
  buffer_load_dwordx4 v65, s[12:15], s46 offen lds
  s_add_u32 m0, s51, 139264
  s_add_u32 s46, s63, 205056
  buffer_load_dwordx4 v65, s[12:15], s46 offen lds
  s_add_u32 m0, s51, 143360
  s_add_u32 s46, s63, 205184
  buffer_load_dwordx4 v65, s[12:15], s46 offen lds
  ds_read_b64_tr_b16 a[196:197], v66 offset:0
  ds_read_b64_tr_b16 a[198:199], v66 offset:1024
  ds_read_b64_tr_b16 a[220:221], v66 offset:4096
  ds_read_b64_tr_b16 a[222:223], v66 offset:5120
  ds_read_b64_tr_b16 a[8:9], v66 offset:8192
  ds_read_b64_tr_b16 a[10:11], v66 offset:9216
  ds_read_b64_tr_b16 a[32:33], v66 offset:12288
  ds_read_b64_tr_b16 a[34:35], v66 offset:13312
  ds_read_b64_tr_b16 a[56:57], v66 offset:16384
  ds_read_b64_tr_b16 a[58:59], v66 offset:17408
  ds_read_b64_tr_b16 a[80:81], v66 offset:20480
  ds_read_b64_tr_b16 a[82:83], v66 offset:21504
  s_waitcnt lgkmcnt(0)
  s_waitcnt vmcnt(24)
  s_barrier
  s_add_u32 m0, s51, 0
  s_add_u32 s46, s63, 205312
  buffer_load_dwordx4 v65, s[12:15], s46 offen lds
  s_add_u32 m0, s51, 4096
  s_add_u32 s46, s63, 205440
  buffer_load_dwordx4 v65, s[12:15], s46 offen lds
  s_add_u32 m0, s51, 8192
  s_add_u32 s46, s63, 205568
  buffer_load_dwordx4 v65, s[12:15], s46 offen lds
  s_add_u32 m0, s51, 12288
  s_add_u32 s46, s63, 205696
  buffer_load_dwordx4 v65, s[12:15], s46 offen lds
  s_add_u32 m0, s51, 16384
  s_add_u32 s46, s63, 205824
  buffer_load_dwordx4 v65, s[12:15], s46 offen lds
  s_add_u32 m0, s51, 20480
  s_add_u32 s46, s63, 205952
  buffer_load_dwordx4 v65, s[12:15], s46 offen lds
  ds_read_b64_tr_b16 a[104:105], v66 offset:24576
  ds_read_b64_tr_b16 a[106:107], v66 offset:25600
  ds_read_b64_tr_b16 a[128:129], v66 offset:28672
  ds_read_b64_tr_b16 a[130:131], v66 offset:29696
  ds_read_b64_tr_b16 a[152:153], v66 offset:32768
  ds_read_b64_tr_b16 a[154:155], v66 offset:33792
  ds_read_b64_tr_b16 a[176:177], v66 offset:36864
  ds_read_b64_tr_b16 a[178:179], v66 offset:37888
  ds_read_b64_tr_b16 a[200:201], v66 offset:40960
  ds_read_b64_tr_b16 a[202:203], v66 offset:41984
  ds_read_b64_tr_b16 a[224:225], v66 offset:45056
  ds_read_b64_tr_b16 a[226:227], v66 offset:46080
  s_waitcnt lgkmcnt(0)
  s_waitcnt vmcnt(24)
  s_barrier
  s_add_u32 m0, s51, 24576
  s_add_u32 s46, s62, 0
  buffer_load_dwordx4 v64, s[4:7], s46 offen lds
  s_add_u32 m0, s51, 28672
  s_add_u32 s46, s62, 393216
  buffer_load_dwordx4 v64, s[4:7], s46 offen lds
  s_add_u32 m0, s51, 32768
  s_add_u32 s46, s62, 128
  buffer_load_dwordx4 v64, s[4:7], s46 offen lds
  s_add_u32 m0, s51, 36864
  s_add_u32 s46, s62, 393344
  buffer_load_dwordx4 v64, s[4:7], s46 offen lds
  s_add_u32 m0, s51, 40960
  s_add_u32 s46, s62, 256
  buffer_load_dwordx4 v64, s[4:7], s46 offen lds
  s_add_u32 m0, s51, 45056
  s_add_u32 s46, s62, 393472
  buffer_load_dwordx4 v64, s[4:7], s46 offen lds
  ds_read_b64_tr_b16 a[12:13], v66 offset:49152
  ds_read_b64_tr_b16 a[14:15], v66 offset:50176
  ds_read_b64_tr_b16 a[36:37], v66 offset:53248
  ds_read_b64_tr_b16 a[38:39], v66 offset:54272
  ds_read_b64_tr_b16 a[60:61], v66 offset:57344
  ds_read_b64_tr_b16 a[62:63], v66 offset:58368
  ds_read_b64_tr_b16 a[84:85], v66 offset:61440
  ds_read_b64_tr_b16 a[86:87], v66 offset:62464
  ds_read_b64_tr_b16 a[108:109], v67 offset:0
  ds_read_b64_tr_b16 a[110:111], v67 offset:1024
  ds_read_b64_tr_b16 a[132:133], v67 offset:4096
  ds_read_b64_tr_b16 a[134:135], v67 offset:5120
  s_waitcnt lgkmcnt(0)
  s_waitcnt vmcnt(24)
  s_barrier
  s_add_u32 m0, s51, 49152
  s_add_u32 s46, s62, 1572864
  buffer_load_dwordx4 v64, s[4:7], s46 offen lds
  s_add_u32 m0, s51, 53248
  s_add_u32 s46, s62, 1966080
  buffer_load_dwordx4 v64, s[4:7], s46 offen lds
  s_add_u32 m0, s51, 57344
  s_add_u32 s46, s62, 1572992
  buffer_load_dwordx4 v64, s[4:7], s46 offen lds
  s_add_u32 m0, s51, 61440
  s_add_u32 s46, s62, 1966208
  buffer_load_dwordx4 v64, s[4:7], s46 offen lds
  s_add_u32 m0, s51, 65536
  s_add_u32 s46, s62, 1573120
  buffer_load_dwordx4 v64, s[4:7], s46 offen lds
  s_add_u32 m0, s51, 69632
  s_add_u32 s46, s62, 1966336
  buffer_load_dwordx4 v64, s[4:7], s46 offen lds
  ds_read_b64_tr_b16 a[156:157], v67 offset:8192
  ds_read_b64_tr_b16 a[158:159], v67 offset:9216
  ds_read_b64_tr_b16 a[180:181], v67 offset:12288
  ds_read_b64_tr_b16 a[182:183], v67 offset:13312
  ds_read_b64_tr_b16 a[204:205], v67 offset:16384
  ds_read_b64_tr_b16 a[206:207], v67 offset:17408
  ds_read_b64_tr_b16 a[228:229], v67 offset:20480
  ds_read_b64_tr_b16 a[230:231], v67 offset:21504
  ds_read_b64_tr_b16 a[16:17], v67 offset:24576
  ds_read_b64_tr_b16 a[18:19], v67 offset:25600
  ds_read_b64_tr_b16 a[40:41], v67 offset:28672
  ds_read_b64_tr_b16 a[42:43], v67 offset:29696
  s_waitcnt lgkmcnt(0)
  s_waitcnt vmcnt(24)
  s_barrier
  s_add_u32 m0, s51, 73728
  s_add_u32 s46, s62, 3145728
  buffer_load_dwordx4 v64, s[4:7], s46 offen lds
  s_add_u32 m0, s51, 77824
  s_add_u32 s46, s62, 3538944
  buffer_load_dwordx4 v64, s[4:7], s46 offen lds
  s_add_u32 m0, s51, 81920
  s_add_u32 s46, s62, 3145856
  buffer_load_dwordx4 v64, s[4:7], s46 offen lds
  s_add_u32 m0, s51, 86016
  s_add_u32 s46, s62, 3539072
  buffer_load_dwordx4 v64, s[4:7], s46 offen lds
  s_add_u32 m0, s51, 90112
  s_add_u32 s46, s62, 3145984
  buffer_load_dwordx4 v64, s[4:7], s46 offen lds
  s_add_u32 m0, s51, 94208
  s_add_u32 s46, s62, 3539200
  buffer_load_dwordx4 v64, s[4:7], s46 offen lds
  ds_read_b64_tr_b16 a[64:65], v67 offset:32768
  ds_read_b64_tr_b16 a[66:67], v67 offset:33792
  ds_read_b64_tr_b16 a[88:89], v67 offset:36864
  ds_read_b64_tr_b16 a[90:91], v67 offset:37888
  ds_read_b64_tr_b16 a[112:113], v67 offset:40960
  ds_read_b64_tr_b16 a[114:115], v67 offset:41984
  ds_read_b64_tr_b16 a[136:137], v67 offset:45056
  ds_read_b64_tr_b16 a[138:139], v67 offset:46080
  ds_read_b64_tr_b16 a[160:161], v67 offset:49152
  ds_read_b64_tr_b16 a[162:163], v67 offset:50176
  ds_read_b64_tr_b16 a[184:185], v67 offset:53248
  ds_read_b64_tr_b16 a[186:187], v67 offset:54272
  s_waitcnt lgkmcnt(0)
  s_waitcnt vmcnt(24)
  s_barrier
  s_add_u32 m0, s51, 98304
  s_add_u32 s46, s62, 4718592
  buffer_load_dwordx4 v64, s[4:7], s46 offen lds
  s_add_u32 m0, s51, 102400
  s_add_u32 s46, s62, 5111808
  buffer_load_dwordx4 v64, s[4:7], s46 offen lds
  s_add_u32 m0, s51, 106496
  s_add_u32 s46, s62, 4718720
  buffer_load_dwordx4 v64, s[4:7], s46 offen lds
  s_add_u32 m0, s51, 110592
  s_add_u32 s46, s62, 5111936
  buffer_load_dwordx4 v64, s[4:7], s46 offen lds
  s_add_u32 m0, s51, 114688
  s_add_u32 s46, s62, 4718848
  buffer_load_dwordx4 v64, s[4:7], s46 offen lds
  s_add_u32 m0, s51, 118784
  s_add_u32 s46, s62, 5112064
  buffer_load_dwordx4 v64, s[4:7], s46 offen lds
  ds_read_b64_tr_b16 a[208:209], v67 offset:57344
  ds_read_b64_tr_b16 a[210:211], v67 offset:58368
  ds_read_b64_tr_b16 a[232:233], v67 offset:61440
  ds_read_b64_tr_b16 a[234:235], v67 offset:62464
  ds_read_b64_tr_b16 a[20:21], v68 offset:0
  ds_read_b64_tr_b16 a[22:23], v68 offset:1024
  ds_read_b64_tr_b16 a[44:45], v68 offset:4096
  ds_read_b64_tr_b16 a[46:47], v68 offset:5120
  ds_read_b64_tr_b16 a[68:69], v68 offset:8192
  ds_read_b64_tr_b16 a[70:71], v68 offset:9216
  ds_read_b64_tr_b16 a[92:93], v68 offset:12288
  ds_read_b64_tr_b16 a[94:95], v68 offset:13312
  s_waitcnt lgkmcnt(0)
  s_waitcnt vmcnt(24)
  s_barrier
  s_add_u32 m0, s51, 122880
  s_add_u32 s46, s62, 6291456
  buffer_load_dwordx4 v64, s[4:7], s46 offen lds
  s_add_u32 m0, s51, 126976
  s_add_u32 s46, s62, 6684672
  buffer_load_dwordx4 v64, s[4:7], s46 offen lds
  s_add_u32 m0, s51, 131072
  s_add_u32 s46, s62, 6291584
  buffer_load_dwordx4 v64, s[4:7], s46 offen lds
  s_add_u32 m0, s51, 135168
  s_add_u32 s46, s62, 6684800
  buffer_load_dwordx4 v64, s[4:7], s46 offen lds
  s_add_u32 m0, s51, 139264
  s_add_u32 s46, s62, 6291712
  buffer_load_dwordx4 v64, s[4:7], s46 offen lds
  s_add_u32 m0, s51, 143360
  s_add_u32 s46, s62, 6684928
  buffer_load_dwordx4 v64, s[4:7], s46 offen lds
  ds_read_b64_tr_b16 a[116:117], v66 offset:0
  ds_read_b64_tr_b16 a[118:119], v66 offset:1024
  ds_read_b64_tr_b16 a[140:141], v66 offset:4096
  ds_read_b64_tr_b16 a[142:143], v66 offset:5120
  ds_read_b64_tr_b16 a[164:165], v66 offset:8192
  ds_read_b64_tr_b16 a[166:167], v66 offset:9216
  ds_read_b64_tr_b16 a[188:189], v66 offset:12288
  ds_read_b64_tr_b16 a[190:191], v66 offset:13312
  ds_read_b64_tr_b16 a[212:213], v66 offset:16384
  ds_read_b64_tr_b16 a[214:215], v66 offset:17408
  ds_read_b64_tr_b16 a[236:237], v66 offset:20480
  ds_read_b64_tr_b16 a[238:239], v66 offset:21504
  s_waitcnt lgkmcnt(0)
  s_waitcnt vmcnt(24)
  s_barrier
  s_add_u32 m0, s51, 0
  s_add_u32 s46, s62, 786432
  buffer_load_dwordx4 v64, s[4:7], s46 offen lds
  s_add_u32 m0, s51, 4096
  s_add_u32 s46, s62, 1179648
  buffer_load_dwordx4 v64, s[4:7], s46 offen lds
  s_add_u32 m0, s51, 8192
  s_add_u32 s46, s62, 786560
  buffer_load_dwordx4 v64, s[4:7], s46 offen lds
  s_add_u32 m0, s51, 12288
  s_add_u32 s46, s62, 1179776
  buffer_load_dwordx4 v64, s[4:7], s46 offen lds
  s_add_u32 m0, s51, 16384
  s_add_u32 s46, s62, 786688
  buffer_load_dwordx4 v64, s[4:7], s46 offen lds
  s_add_u32 m0, s51, 20480
  s_add_u32 s46, s62, 1179904
  buffer_load_dwordx4 v64, s[4:7], s46 offen lds
  ds_read_b64_tr_b16 a[240:241], v66 offset:24576
  ds_read_b64_tr_b16 a[242:243], v66 offset:25600
  ds_read_b64_tr_b16 a[244:245], v66 offset:28672
  ds_read_b64_tr_b16 a[246:247], v66 offset:29696
  ds_read_b64_tr_b16 a[248:249], v66 offset:32768
  ds_read_b64_tr_b16 a[250:251], v66 offset:33792
  ds_read_b64_tr_b16 a[252:253], v66 offset:36864
  ds_read_b64_tr_b16 a[254:255], v66 offset:37888
  ds_read_b64_tr_b16 v[152:153], v66 offset:40960
  ds_read_b64_tr_b16 v[154:155], v66 offset:41984
  ds_read_b64_tr_b16 v[156:157], v66 offset:45056
  ds_read_b64_tr_b16 v[158:159], v66 offset:46080
  s_waitcnt lgkmcnt(0)
  s_waitcnt vmcnt(24)
  s_barrier
  s_add_u32 m0, s51, 24576
  s_add_u32 s46, s62, 2359296
  buffer_load_dwordx4 v64, s[4:7], s46 offen lds
  s_add_u32 m0, s51, 28672
  s_add_u32 s46, s62, 2752512
  buffer_load_dwordx4 v64, s[4:7], s46 offen lds
  s_add_u32 m0, s51, 32768
  s_add_u32 s46, s62, 2359424
  buffer_load_dwordx4 v64, s[4:7], s46 offen lds
  s_add_u32 m0, s51, 36864
  s_add_u32 s46, s62, 2752640
  buffer_load_dwordx4 v64, s[4:7], s46 offen lds
  s_add_u32 m0, s51, 40960
  s_add_u32 s46, s62, 2359552
  buffer_load_dwordx4 v64, s[4:7], s46 offen lds
  s_add_u32 m0, s51, 45056
  s_add_u32 s46, s62, 2752768
  buffer_load_dwordx4 v64, s[4:7], s46 offen lds
  ds_read_b64_tr_b16 v[160:161], v66 offset:49152
  ds_read_b64_tr_b16 v[162:163], v66 offset:50176
  ds_read_b64_tr_b16 v[164:165], v66 offset:53248
  ds_read_b64_tr_b16 v[166:167], v66 offset:54272
  ds_read_b64_tr_b16 v[168:169], v66 offset:57344
  ds_read_b64_tr_b16 v[170:171], v66 offset:58368
  ds_read_b64_tr_b16 v[172:173], v66 offset:61440
  ds_read_b64_tr_b16 v[174:175], v66 offset:62464
  ds_read_b64_tr_b16 v[176:177], v67 offset:0
  ds_read_b64_tr_b16 v[178:179], v67 offset:1024
  ds_read_b64_tr_b16 v[180:181], v67 offset:4096
  ds_read_b64_tr_b16 v[182:183], v67 offset:5120
  s_waitcnt lgkmcnt(0)
  s_waitcnt vmcnt(24)
  s_barrier
  s_add_u32 m0, s51, 49152
  s_add_u32 s46, s62, 3932160
  buffer_load_dwordx4 v64, s[4:7], s46 offen lds
  s_add_u32 m0, s51, 53248
  s_add_u32 s46, s62, 4325376
  buffer_load_dwordx4 v64, s[4:7], s46 offen lds
  s_add_u32 m0, s51, 57344
  s_add_u32 s46, s62, 3932288
  buffer_load_dwordx4 v64, s[4:7], s46 offen lds
  s_add_u32 m0, s51, 61440
  s_add_u32 s46, s62, 4325504
  buffer_load_dwordx4 v64, s[4:7], s46 offen lds
  s_add_u32 m0, s51, 65536
  s_add_u32 s46, s62, 3932416
  buffer_load_dwordx4 v64, s[4:7], s46 offen lds
  s_add_u32 m0, s51, 69632
  s_add_u32 s46, s62, 4325632
  buffer_load_dwordx4 v64, s[4:7], s46 offen lds
  ds_read_b64_tr_b16 v[184:185], v67 offset:8192
  ds_read_b64_tr_b16 v[186:187], v67 offset:9216
  ds_read_b64_tr_b16 v[188:189], v67 offset:12288
  ds_read_b64_tr_b16 v[190:191], v67 offset:13312
  ds_read_b64_tr_b16 v[192:193], v67 offset:16384
  ds_read_b64_tr_b16 v[194:195], v67 offset:17408
  ds_read_b64_tr_b16 v[196:197], v67 offset:20480
  ds_read_b64_tr_b16 v[198:199], v67 offset:21504
  ds_read_b64_tr_b16 v[200:201], v67 offset:24576
  ds_read_b64_tr_b16 v[202:203], v67 offset:25600
  ds_read_b64_tr_b16 v[204:205], v67 offset:28672
  ds_read_b64_tr_b16 v[206:207], v67 offset:29696
  s_waitcnt lgkmcnt(0)
  s_waitcnt vmcnt(24)
  s_barrier
  s_add_u32 m0, s51, 73728
  s_add_u32 s46, s62, 5505024
  buffer_load_dwordx4 v64, s[4:7], s46 offen lds
  s_add_u32 m0, s51, 77824
  s_add_u32 s46, s62, 5898240
  buffer_load_dwordx4 v64, s[4:7], s46 offen lds
  s_add_u32 m0, s51, 81920
  s_add_u32 s46, s62, 5505152
  buffer_load_dwordx4 v64, s[4:7], s46 offen lds
  s_add_u32 m0, s51, 86016
  s_add_u32 s46, s62, 5898368
  buffer_load_dwordx4 v64, s[4:7], s46 offen lds
  s_add_u32 m0, s51, 90112
  s_add_u32 s46, s62, 5505280
  buffer_load_dwordx4 v64, s[4:7], s46 offen lds
  s_add_u32 m0, s51, 94208
  s_add_u32 s46, s62, 5898496
  buffer_load_dwordx4 v64, s[4:7], s46 offen lds
  ds_read_b64_tr_b16 v[208:209], v67 offset:32768
  ds_read_b64_tr_b16 v[210:211], v67 offset:33792
  ds_read_b64_tr_b16 v[212:213], v67 offset:36864
  ds_read_b64_tr_b16 v[214:215], v67 offset:37888
  ds_read_b64_tr_b16 v[216:217], v67 offset:40960
  ds_read_b64_tr_b16 v[218:219], v67 offset:41984
  ds_read_b64_tr_b16 v[220:221], v67 offset:45056
  ds_read_b64_tr_b16 v[222:223], v67 offset:46080
  ds_read_b64_tr_b16 v[224:225], v67 offset:49152
  ds_read_b64_tr_b16 v[226:227], v67 offset:50176
  ds_read_b64_tr_b16 v[228:229], v67 offset:53248
  ds_read_b64_tr_b16 v[230:231], v67 offset:54272
  s_waitcnt lgkmcnt(0)
  s_waitcnt vmcnt(24)
  s_barrier
  s_add_u32 m0, s51, 98304
  s_add_u32 s46, s62, 7077888
  buffer_load_dwordx4 v64, s[4:7], s46 offen lds
  s_add_u32 m0, s51, 102400
  s_add_u32 s46, s62, 7471104
  buffer_load_dwordx4 v64, s[4:7], s46 offen lds
  s_add_u32 m0, s51, 106496
  s_add_u32 s46, s62, 7078016
  buffer_load_dwordx4 v64, s[4:7], s46 offen lds
  s_add_u32 m0, s51, 110592
  s_add_u32 s46, s62, 7471232
  buffer_load_dwordx4 v64, s[4:7], s46 offen lds
  s_add_u32 m0, s51, 114688
  s_add_u32 s46, s62, 7078144
  buffer_load_dwordx4 v64, s[4:7], s46 offen lds
  s_add_u32 m0, s51, 118784
  s_add_u32 s46, s62, 7471360
  buffer_load_dwordx4 v64, s[4:7], s46 offen lds
  ds_read_b64_tr_b16 v[232:233], v67 offset:57344
  ds_read_b64_tr_b16 v[234:235], v67 offset:58368
  ds_read_b64_tr_b16 v[236:237], v67 offset:61440
  ds_read_b64_tr_b16 v[238:239], v67 offset:62464
  ds_read_b64_tr_b16 v[240:241], v68 offset:0
  ds_read_b64_tr_b16 v[242:243], v68 offset:1024
  ds_read_b64_tr_b16 v[244:245], v68 offset:4096
  ds_read_b64_tr_b16 v[246:247], v68 offset:5120
  ds_read_b64_tr_b16 v[248:249], v68 offset:8192
  ds_read_b64_tr_b16 v[250:251], v68 offset:9216
  ds_read_b64_tr_b16 v[252:253], v68 offset:12288
  ds_read_b64_tr_b16 v[254:255], v68 offset:13312
  s_waitcnt lgkmcnt(0)
  s_waitcnt vmcnt(24)
  s_barrier
  ds_read_b64_tr_b16 v[40:41], v66 offset:0
  ds_read_b64_tr_b16 v[42:43], v66 offset:1024
  ds_read_b64_tr_b16 v[44:45], v66 offset:4096
  ds_read_b64_tr_b16 v[46:47], v66 offset:5120
  ds_read_b64_tr_b16 v[48:49], v66 offset:8192
  ds_read_b64_tr_b16 v[50:51], v66 offset:9216
  ds_read_b64_tr_b16 v[52:53], v66 offset:12288
  ds_read_b64_tr_b16 v[54:55], v66 offset:13312
  ds_read_b64_tr_b16 v[56:57], v66 offset:16384
  ds_read_b64_tr_b16 v[58:59], v66 offset:17408
  ds_read_b64_tr_b16 v[60:61], v66 offset:20480
  ds_read_b64_tr_b16 v[62:63], v66 offset:21504
  s_waitcnt lgkmcnt(0)
  s_waitcnt vmcnt(18)
  s_barrier
  ds_write_b128 v2, v[40:43] offset:0
  ds_write_b128 v2, v[44:47] offset:4096
  ds_write_b128 v2, v[48:51] offset:8192
  ds_write_b128 v2, v[52:55] offset:12288
  ds_write_b128 v2, v[56:59] offset:16384
  ds_write_b128 v2, v[60:63] offset:20480
  ds_read_b64_tr_b16 v[16:17], v66 offset:24576
  ds_read_b64_tr_b16 v[18:19], v66 offset:25600
  ds_read_b64_tr_b16 v[20:21], v66 offset:28672
  ds_read_b64_tr_b16 v[22:23], v66 offset:29696
  ds_read_b64_tr_b16 v[24:25], v66 offset:32768
  ds_read_b64_tr_b16 v[26:27], v66 offset:33792
  ds_read_b64_tr_b16 v[28:29], v66 offset:36864
  ds_read_b64_tr_b16 v[30:31], v66 offset:37888
  ds_read_b64_tr_b16 v[32:33], v66 offset:40960
  ds_read_b64_tr_b16 v[34:35], v66 offset:41984
  ds_read_b64_tr_b16 v[36:37], v66 offset:45056
  ds_read_b64_tr_b16 v[38:39], v66 offset:46080
  s_waitcnt lgkmcnt(0)
  s_waitcnt vmcnt(12)
  s_barrier
  ds_write_b128 v2, v[16:19] offset:24576
  ds_write_b128 v2, v[20:23] offset:28672
  ds_write_b128 v2, v[24:27] offset:32768
  ds_write_b128 v2, v[28:31] offset:36864
  ds_write_b128 v2, v[32:35] offset:40960
  ds_write_b128 v2, v[36:39] offset:45056
  ds_read_b64_tr_b16 v[40:41], v66 offset:49152
  ds_read_b64_tr_b16 v[42:43], v66 offset:50176
  ds_read_b64_tr_b16 v[44:45], v66 offset:53248
  ds_read_b64_tr_b16 v[46:47], v66 offset:54272
  ds_read_b64_tr_b16 v[48:49], v66 offset:57344
  ds_read_b64_tr_b16 v[50:51], v66 offset:58368
  ds_read_b64_tr_b16 v[52:53], v66 offset:61440
  ds_read_b64_tr_b16 v[54:55], v66 offset:62464
  ds_read_b64_tr_b16 v[56:57], v67 offset:0
  ds_read_b64_tr_b16 v[58:59], v67 offset:1024
  ds_read_b64_tr_b16 v[60:61], v67 offset:4096
  ds_read_b64_tr_b16 v[62:63], v67 offset:5120
  s_waitcnt lgkmcnt(0)
  s_waitcnt vmcnt(6)
  s_barrier
  ds_write_b128 v2, v[40:43] offset:49152
  ds_write_b128 v2, v[44:47] offset:53248
  ds_write_b128 v2, v[48:51] offset:57344
  ds_write_b128 v2, v[52:55] offset:61440
  ds_write_b128 v3, v[56:59] offset:0
  ds_write_b128 v3, v[60:63] offset:4096
  ds_read_b64_tr_b16 v[16:17], v67 offset:8192
  ds_read_b64_tr_b16 v[18:19], v67 offset:9216
  ds_read_b64_tr_b16 v[20:21], v67 offset:12288
  ds_read_b64_tr_b16 v[22:23], v67 offset:13312
  ds_read_b64_tr_b16 v[24:25], v67 offset:16384
  ds_read_b64_tr_b16 v[26:27], v67 offset:17408
  ds_read_b64_tr_b16 v[28:29], v67 offset:20480
  ds_read_b64_tr_b16 v[30:31], v67 offset:21504
  ds_read_b64_tr_b16 v[32:33], v67 offset:24576
  ds_read_b64_tr_b16 v[34:35], v67 offset:25600
  ds_read_b64_tr_b16 v[36:37], v67 offset:28672
  ds_read_b64_tr_b16 v[38:39], v67 offset:29696
  s_waitcnt lgkmcnt(0)
  s_waitcnt vmcnt(0)
  s_barrier
  ds_write_b128 v3, v[16:19] offset:8192
  ds_write_b128 v3, v[20:23] offset:12288
  ds_write_b128 v3, v[24:27] offset:16384
  ds_write_b128 v3, v[28:31] offset:20480
  ds_write_b128 v3, v[32:35] offset:24576
  ds_write_b128 v3, v[36:39] offset:28672
  ds_read_b64_tr_b16 v[40:41], v67 offset:32768
  ds_read_b64_tr_b16 v[42:43], v67 offset:33792
  ds_read_b64_tr_b16 v[44:45], v67 offset:36864
  ds_read_b64_tr_b16 v[46:47], v67 offset:37888
  ds_read_b64_tr_b16 v[48:49], v67 offset:40960
  ds_read_b64_tr_b16 v[50:51], v67 offset:41984
  ds_read_b64_tr_b16 v[52:53], v67 offset:45056
  ds_read_b64_tr_b16 v[54:55], v67 offset:46080
  ds_read_b64_tr_b16 v[56:57], v67 offset:49152
  ds_read_b64_tr_b16 v[58:59], v67 offset:50176
  ds_read_b64_tr_b16 v[60:61], v67 offset:53248
  ds_read_b64_tr_b16 v[62:63], v67 offset:54272
  s_waitcnt lgkmcnt(0)
  s_barrier
  ds_write_b128 v3, v[40:43] offset:32768
  ds_write_b128 v3, v[44:47] offset:36864
  ds_write_b128 v3, v[48:51] offset:40960
  ds_write_b128 v3, v[52:55] offset:45056
  ds_write_b128 v3, v[56:59] offset:49152
  ds_write_b128 v3, v[60:63] offset:53248
  s_waitcnt lgkmcnt(0)
  v_and_b32 v150, 1, v0
  v_lshlrev_b32 v150, 7, v150
  v_add_u32 v150, 3014656, v150
  s_mov_b32 s50, 0
pol_30:
  buffer_load_dword v148, v150, s[8:11], 0 offen sc1
  s_add_u32 s50, s50, 1
  s_cmp_gt_u32 s50, 2097152
  s_cbranch_scc1 L_fail
  s_waitcnt vmcnt(0)
  v_cmp_eq_u32 vcc, 0, v148
  s_cbranch_vccnz pol_30
  v_readlane_b32 s54, v148, 0
  v_readlane_b32 s55, v148, 1
  s_and_b32 s54, s54, 0x2000
  s_and_b32 s55, s55, 0x2000
  s_mov_b32 s68, 0xfffffffe
  v_and_b32 v148, 3, v0
  s_lshl_b32 s46, s43, 9
  s_add_u32 s46, s46, s55
  s_add_u32 s46, s46, 2883584
  v_lshl_add_u32 v10, v148, 7, s46
  v_mov_b32 v7, 0x44444444
  v_mov_b32 v148, 0xeeeeeeee
  v_and_b32 v149, 8, v0
  v_cmp_ne_u32 vcc, 0, v149
  s_nop 1
  v_cndmask_b32 v7, v7, v148, vcc
  v_and_b32 v148, 15, v0
  v_bfe_u32 v149, v0, 4, 1
  v_lshrrev_b32 v150, 5, v0
  v_lshlrev_b32 v8, 4, v148
  v_lshl_add_u32 v8, v149, 3, v8
  v_lshl_add_u32 v4, v150, 2, v8
  s_and_b32 s46, s42, 1
  s_lshl_b32 s46, s46, 7
  v_xor_b32 v4, s46, v4
  s_lshl_b32 s46, s42, 8
  s_add_u32 s46, s46, 122880
  v_add_u32 v4, s46, v4
  s_lshl_b32 s46, s45, 8
  s_lshl_b32 s47, s42, 13
  s_add_u32 s47, s47, s46
  v_lshl_add_u32 v9, v150, 15, v8
  v_add_u32 v9, s47, v9
  s_lshl_b32 s47, s42, 14
  s_add_u32 s47, s47, s46
  s_add_u32 s47, s47, s54
  v_lshl_add_u32 v8, v150, 16, v8
  v_add_u32 v8, s47, v8
  v_lshrrev_b32 v148, 4, v0
  v_lshlrev_b32 v5, 8, v148
  v_lshl_add_u32 v5, v149, 7, v5
  v_bfe_u32 v148, v0, 3, 1
  v_lshl_add_u32 v5, v148, 6, v5
  v_bfe_u32 v148, v0, 1, 1
  v_lshl_add_u32 v5, v148, 5, v5
  v_bfe_u32 v148, v0, 2, 1
  v_lshl_add_u32 v5, v148, 4, v5
  v_and_b32 v148, 1, v0
  v_lshl_add_u32 v5, v148, 3, v5
  v_xor_b32 v6, 0x80, v5
  v_add_u32 v5, 122880, v5
  v_add_u32 v6, 122880, v6
  s_lshl_b32 s46, s45, 7
  s_lshl_b32 s47, s42, 2
  s_add_u32 s47, s47, s46
  s_add_u32 s47, s47, 2965504
  v_mov_b32 v15, s47
  s_mov_b32 s64, 167772160
  s_mov_b32 s52, 0
  s_mov_b32 s58, 0
  s_mov_b32 s65, 1310720
  s_mov_b32 s100, 0
va_loop:
  s_add_u32 s53, s52, 1
  s_lshl_b32 s56, s58, 2
  s_add_u32 s56, s56, s43
  s_lshl_b32 s56, s56, 16
  s_add_u32 s56, s56, s55
  s_add_u32 s56, s56, 2097152
  s_add_u32 s59, s56, 4096
  s_add_u32 s57, s56, 49152
  s_mul_i32 s66, s58, 655360
  ds_read_b128 v[56:59], v2 offset:0
  ds_read_b128 v[60:63], v2 offset:4096
  ds_read_b128 v[64:67], v2 offset:8192
  ds_read_b128 v[68:71], v2 offset:12288
  ds_read_b128 v[72:75], v2 offset:16384
  ds_read_b128 v[76:79], v2 offset:20480
  ds_read_b128 v[80:83], v2 offset:24576
  ds_read_b128 v[84:87], v2 offset:28672
  ds_read_b128 v[88:91], v2 offset:32768
  ds_read_b128 v[92:95], v2 offset:36864
  ds_read_b128 v[96:99], v2 offset:40960
  ds_read_b128 v[100:103], v2 offset:45056
  v_mov_b32 v104, 0
  v_mov_b32 v105, 0
  v_mov_b32 v106, 0
  v_mov_b32 v107, 0
  v_mov_b32 v108, 0
  v_mov_b32 v109, 0
  v_mov_b32 v110, 0
  v_mov_b32 v111, 0
  v_mov_b32 v112, 0
  v_mov_b32 v113, 0
  v_mov_b32 v114, 0
  v_mov_b32 v115, 0
  s_cmp_lg_u32 s42, 3
  s_cbranch_scc1 va_nobell
  s_mov_b32 s50, 0
  s_mov_b64 exec, 15
  buffer_load_dword v116, v10, s[8:11], 0 offen sc1
  s_nop 11
  buffer_load_dword v117, v10, s[8:11], 0 offen sc1
  s_nop 11
  buffer_load_dword v118, v10, s[8:11], 0 offen sc1
  s_nop 11
  buffer_load_dword v119, v10, s[8:11], 0 offen sc1
  s_nop 11
  buffer_load_dword v120, v10, s[8:11], 0 offen sc1
  s_nop 11
  buffer_load_dword v121, v10, s[8:11], 0 offen sc1
  s_nop 11
  buffer_load_dword v122, v10, s[8:11], 0 offen sc1
  s_nop 11
  buffer_load_dword v123, v10, s[8:11], 0 offen sc1
  s_nop 11
  buffer_load_dword v124, v10, s[8:11], 0 offen sc1
  s_nop 11
bell_31:
  buffer_load_dword v125, v10, s[8:11], 0 offen sc1
  s_waitcnt vmcnt(9)
  v_cmp_gt_u32 vcc, s53, v116
  s_cbranch_vccz bell_x_32
  s_nop 7
  buffer_load_dword v116, v10, s[8:11], 0 offen sc1
  s_waitcnt vmcnt(9)
  v_cmp_gt_u32 vcc, s53, v117
  s_cbranch_vccz bell_x_32
  s_nop 7
  buffer_load_dword v117, v10, s[8:11], 0 offen sc1
  s_waitcnt vmcnt(9)
  v_cmp_gt_u32 vcc, s53, v118
  s_cbranch_vccz bell_x_32
  s_nop 7
  buffer_load_dword v118, v10, s[8:11], 0 offen sc1
  s_waitcnt vmcnt(9)
  v_cmp_gt_u32 vcc, s53, v119
  s_cbranch_vccz bell_x_32
  s_nop 7
  buffer_load_dword v119, v10, s[8:11], 0 offen sc1
  s_waitcnt vmcnt(9)
  v_cmp_gt_u32 vcc, s53, v120
  s_cbranch_vccz bell_x_32
  s_nop 7
  buffer_load_dword v120, v10, s[8:11], 0 offen sc1
  s_waitcnt vmcnt(9)
  v_cmp_gt_u32 vcc, s53, v121
  s_cbranch_vccz bell_x_32
  s_nop 7
  buffer_load_dword v121, v10, s[8:11], 0 offen sc1
  s_waitcnt vmcnt(9)
  v_cmp_gt_u32 vcc, s53, v122
  s_cbranch_vccz bell_x_32
  s_nop 7
  buffer_load_dword v122, v10, s[8:11], 0 offen sc1
  s_waitcnt vmcnt(9)
  v_cmp_gt_u32 vcc, s53, v123
  s_cbranch_vccz bell_x_32
  s_nop 7
  buffer_load_dword v123, v10, s[8:11], 0 offen sc1
  s_waitcnt vmcnt(9)
  v_cmp_gt_u32 vcc, s53, v124
  s_cbranch_vccz bell_x_32
  s_nop 7
  buffer_load_dword v124, v10, s[8:11], 0 offen sc1
  s_waitcnt vmcnt(9)
  v_cmp_gt_u32 vcc, s53, v125
  s_cbranch_vccz bell_x_32
  s_add_u32 s50, s50, 1
  s_cmp_gt_u32 s50, 2097152
  s_cbranch_scc1 L_fail
  s_branch bell_31
bell_x_32:
  s_mov_b64 exec, -1
va_nobell:
  s_waitcnt lgkmcnt(0)
  s_barrier
  buffer_load_dwordx4 v[16:19], v1, s[8:11], s56 offen offset:0 sc1
  s_barrier
  buffer_load_dwordx4 v[20:23], v1, s[8:11], s56 offen offset:1024 sc1
  s_barrier
  buffer_load_dwordx4 v[24:27], v1, s[8:11], s56 offen offset:2048 sc1
  s_barrier
  buffer_load_dwordx4 v[28:31], v1, s[8:11], s56 offen offset:3072 sc1
  s_barrier
  buffer_load_dwordx4 v[32:35], v1, s[8:11], s59 offen offset:0 sc1
  s_barrier
  buffer_load_dwordx4 v[36:39], v1, s[8:11], s59 offen offset:1024 sc1
  s_barrier
  buffer_load_dwordx4 v[40:43], v1, s[8:11], s59 offen offset:2048 sc1
va_go_33:
  s_waitcnt vmcnt(6)
  v_smfmac_f32_16x16x64_bf16 v[104:107], v[16:19], a[240:247], v7
  v_max3_u32 v12, v16, v17, v18
  v_max3_u32 v12, v18, v19, v12
  v_smfmac_f32_16x16x64_bf16 v[108:111], v[16:19], a[248:255], v7
  v_smfmac_f32_16x16x64_bf16 v[112:115], v[16:19], v[152:159], v7
  buffer_load_dwordx4 v[44:47], v1, s[8:11], s59 offen offset:3072 sc1
  s_waitcnt vmcnt(6)
  v_smfmac_f32_16x16x64_bf16 v[104:107], v[20:23], v[56:63], v7
  v_max3_u32 v12, v20, v21, v12
  v_max3_u32 v12, v22, v23, v12
  v_smfmac_f32_16x16x64_bf16 v[108:111], v[20:23], v[64:71], v7
  v_smfmac_f32_16x16x64_bf16 v[112:115], v[20:23], v[72:79], v7
  v_mov_b32 v16, 0
  v_mov_b32 v17, 0
  v_mov_b32 v18, 0
  v_mov_b32 v19, 0
  v_mov_b32 v20, 0
  v_mov_b32 v21, 0
  v_mov_b32 v22, 0
  v_mov_b32 v23, 0
  buffer_load_dwordx4 v[48:51], v1, s[8:11], s57 offen offset:0 sc1
  s_waitcnt vmcnt(6)
  v_smfmac_f32_16x16x64_bf16 v[104:107], v[24:27], v[160:167], v7
  v_max3_u32 v12, v24, v25, v12
  v_max3_u32 v12, v26, v27, v12
  ds_read_b128 v[56:59], v2 offset:49152
  ds_read_b128 v[60:63], v2 offset:53248
  v_smfmac_f32_16x16x64_bf16 v[108:111], v[24:27], v[168:175], v7
  ds_read_b128 v[64:67], v2 offset:57344
  ds_read_b128 v[68:71], v2 offset:61440
  v_smfmac_f32_16x16x64_bf16 v[112:115], v[24:27], v[176:183], v7
  ds_read_b128 v[72:75], v3 offset:0
  ds_read_b128 v[76:79], v3 offset:4096
  buffer_load_dwordx4 v[52:55], v1, s[8:11], s57 offen offset:1024 sc1
  s_waitcnt vmcnt(6)
  v_smfmac_f32_16x16x64_bf16 v[104:107], v[28:31], v[80:87], v7
  v_max3_u32 v12, v28, v29, v12
  v_max3_u32 v12, v30, v31, v12
  v_smfmac_f32_16x16x64_bf16 v[108:111], v[28:31], v[88:95], v7
  v_smfmac_f32_16x16x64_bf16 v[112:115], v[28:31], v[96:103], v7
  v_mov_b32 v24, 0
  v_mov_b32 v25, 0
  v_mov_b32 v26, 0
  v_mov_b32 v27, 0
  v_mov_b32 v28, 0
  v_mov_b32 v29, 0
  v_mov_b32 v30, 0
  v_mov_b32 v31, 0
  s_waitcnt vmcnt(5)
  v_smfmac_f32_16x16x64_bf16 v[104:107], v[32:35], v[184:191], v7
  v_max3_u32 v12, v32, v33, v12
  v_max3_u32 v12, v34, v35, v12
  ds_read_b128 v[80:83], v3 offset:8192
  ds_read_b128 v[84:87], v3 offset:12288
  v_smfmac_f32_16x16x64_bf16 v[108:111], v[32:35], v[192:199], v7
  ds_read_b128 v[88:91], v3 offset:16384
  ds_read_b128 v[92:95], v3 offset:20480
  v_smfmac_f32_16x16x64_bf16 v[112:115], v[32:35], v[200:207], v7
  ds_read_b128 v[96:99], v3 offset:24576
  ds_read_b128 v[100:103], v3 offset:28672
  s_waitcnt vmcnt(4)
  s_waitcnt lgkmcnt(6)
  v_smfmac_f32_16x16x64_bf16 v[104:107], v[36:39], v[56:63], v7
  v_max3_u32 v12, v36, v37, v12
  v_max3_u32 v12, v38, v39, v12
  v_smfmac_f32_16x16x64_bf16 v[108:111], v[36:39], v[64:71], v7
  v_smfmac_f32_16x16x64_bf16 v[112:115], v[36:39], v[72:79], v7
  v_mov_b32 v32, 0
  v_mov_b32 v33, 0
  v_mov_b32 v34, 0
  v_mov_b32 v35, 0
  v_mov_b32 v36, 0
  v_mov_b32 v37, 0
  v_mov_b32 v38, 0
  v_mov_b32 v39, 0
  s_waitcnt vmcnt(3)
  v_smfmac_f32_16x16x64_bf16 v[104:107], v[40:43], v[208:215], v7
  v_max3_u32 v12, v40, v41, v12
  v_max3_u32 v12, v42, v43, v12
  ds_read_b128 v[56:59], v3 offset:32768
  ds_read_b128 v[60:63], v3 offset:36864
  v_smfmac_f32_16x16x64_bf16 v[108:111], v[40:43], v[216:223], v7
  ds_read_b128 v[64:67], v3 offset:40960
  ds_read_b128 v[68:71], v3 offset:45056
  v_smfmac_f32_16x16x64_bf16 v[112:115], v[40:43], v[224:231], v7
  ds_read_b128 v[72:75], v3 offset:49152
  ds_read_b128 v[76:79], v3 offset:53248
  s_waitcnt vmcnt(2)
  s_waitcnt lgkmcnt(6)
  v_smfmac_f32_16x16x64_bf16 v[104:107], v[44:47], v[80:87], v7
  v_max3_u32 v12, v44, v45, v12
  v_max3_u32 v12, v46, v47, v12
  v_smfmac_f32_16x16x64_bf16 v[108:111], v[44:47], v[88:95], v7
  v_smfmac_f32_16x16x64_bf16 v[112:115], v[44:47], v[96:103], v7
  v_mov_b32 v40, 0
  v_mov_b32 v41, 0
  v_mov_b32 v42, 0
  v_mov_b32 v43, 0
  v_mov_b32 v44, 0
  v_mov_b32 v45, 0
  v_mov_b32 v46, 0
  v_mov_b32 v47, 0
  s_waitcnt vmcnt(1)
  v_smfmac_f32_16x16x64_bf16 v[104:107], v[48:51], v[232:239], v7
  v_max3_u32 v12, v48, v49, v12
  v_max3_u32 v12, v50, v51, v12
  v_smfmac_f32_16x16x64_bf16 v[108:111], v[48:51], v[240:247], v7
  v_smfmac_f32_16x16x64_bf16 v[112:115], v[48:51], v[248:255], v7
  s_waitcnt vmcnt(0)
  s_waitcnt lgkmcnt(0)
  v_smfmac_f32_16x16x64_bf16 v[104:107], v[52:55], v[56:63], v7
  v_max3_u32 v12, v52, v53, v12
  v_max3_u32 v12, v54, v55, v12
  v_smfmac_f32_16x16x64_bf16 v[108:111], v[52:55], v[64:71], v7
  v_smfmac_f32_16x16x64_bf16 v[112:115], v[52:55], v[72:79], v7
  v_mov_b32 v48, 0
  v_mov_b32 v49, 0
  v_mov_b32 v50, 0
  v_mov_b32 v51, 0
  v_cmp_eq_u32 vcc, -1, v12
  s_cbranch_vccnz va_redo_34
va_ok_35:
  v_permlane32_swap_b32 v104, v106
  v_permlane32_swap_b32 v105, v107
  v_add_f32 v104, v104, v106
  v_add_f32 v105, v105, v107
  v_cvt_pk_bf16_f32 v104, v104, v105
  ds_write_b32 v4, v104 offset:0
  v_permlane32_swap_b32 v108, v110
  v_permlane32_swap_b32 v109, v111
  v_add_f32 v108, v108, v110
  v_add_f32 v109, v109, v111
  v_cvt_pk_bf16_f32 v108, v108, v109
  ds_write_b32 v4, v108 offset:1024
  v_permlane32_swap_b32 v112, v114
  v_permlane32_swap_b32 v113, v115
  v_add_f32 v112, v112, v114
  v_add_f32 v113, v113, v115
  v_cvt_pk_bf16_f32 v112, v112, v113
  ds_write_b32 v4, v112 offset:2048
  v_mov_b32 v52, 0
  v_mov_b32 v53, 0
  v_mov_b32 v54, 0
  v_mov_b32 v55, 0
  s_waitcnt lgkmcnt(0)
  s_barrier
  ds_read_b64_tr_b16 v[116:117], v5 offset:0
  ds_read_b64_tr_b16 v[118:119], v6 offset:0
  ds_read_b64_tr_b16 v[120:121], v5 offset:1024
  ds_read_b64_tr_b16 v[122:123], v6 offset:1024
  ds_read_b64_tr_b16 v[124:125], v5 offset:2048
  ds_read_b64_tr_b16 v[126:127], v6 offset:2048
  s_waitcnt lgkmcnt(4)
  v_smfmac_f32_16x16x64_bf16 v[16:19], v[116:119], a[0:7], v7
  v_smfmac_f32_16x16x64_bf16 v[20:23], v[116:119], a[24:31], v7
  s_waitcnt lgkmcnt(2)
  v_smfmac_f32_16x16x64_bf16 v[16:19], v[120:123], a[8:15], v7
  v_smfmac_f32_16x16x64_bf16 v[20:23], v[120:123], a[32:39], v7
  s_waitcnt lgkmcnt(0)
  v_smfmac_f32_16x16x64_bf16 v[16:19], v[124:127], a[16:23], v7
  v_smfmac_f32_16x16x64_bf16 v[20:23], v[124:127], a[40:47], v7
  v_smfmac_f32_16x16x64_bf16 v[24:27], v[116:119], a[48:55], v7
  v_smfmac_f32_16x16x64_bf16 v[28:31], v[116:119], a[72:79], v7
  v_smfmac_f32_16x16x64_bf16 v[24:27], v[120:123], a[56:63], v7
  s_nop 4
  v_permlane32_swap_b32 v16, v20
  v_permlane32_swap_b32 v17, v21
  v_permlane32_swap_b32 v18, v22
  v_smfmac_f32_16x16x64_bf16 v[28:31], v[120:123], a[80:87], v7
  v_permlane32_swap_b32 v19, v23
  v_add_f32 v16, v16, v20
  v_add_f32 v17, v17, v21
  v_smfmac_f32_16x16x64_bf16 v[24:27], v[124:127], a[64:71], v7
  v_add_f32 v18, v18, v22
  v_add_f32 v19, v19, v23
  v_smfmac_f32_16x16x64_bf16 v[28:31], v[124:127], a[88:95], v7
  v_cvt_pk_bf16_f32 v128, v16, v17
  v_cvt_pk_bf16_f32 v129, v18, v19
  v_smfmac_f32_16x16x64_bf16 v[32:35], v[116:119], a[96:103], v7
  v_min_u32 v128, s68, v128
  v_min_u32 v129, s68, v129
  v_smfmac_f32_16x16x64_bf16 v[36:39], v[116:119], a[120:127], v7
  s_add_u32 s46, s66, 0
  buffer_store_dwordx2 v[128:129], v8, s[8:11], s46 offen sc1
  v_smfmac_f32_16x16x64_bf16 v[32:35], v[120:123], a[104:111], v7
  v_permlane32_swap_b32 v24, v28
  v_permlane32_swap_b32 v25, v29
  v_permlane32_swap_b32 v26, v30
  v_smfmac_f32_16x16x64_bf16 v[36:39], v[120:123], a[128:135], v7
  v_permlane32_swap_b32 v27, v31
  v_add_f32 v24, v24, v28
  v_add_f32 v25, v25, v29
  v_smfmac_f32_16x16x64_bf16 v[32:35], v[124:127], a[112:119], v7
  v_add_f32 v26, v26, v30
  v_add_f32 v27, v27, v31
  v_smfmac_f32_16x16x64_bf16 v[36:39], v[124:127], a[136:143], v7
  v_cvt_pk_bf16_f32 v130, v24, v25
  v_cvt_pk_bf16_f32 v131, v26, v27
  v_smfmac_f32_16x16x64_bf16 v[40:43], v[116:119], a[144:151], v7
  v_min_u32 v130, s68, v130
  v_min_u32 v131, s68, v131
  v_smfmac_f32_16x16x64_bf16 v[44:47], v[116:119], a[168:175], v7
  s_add_u32 s46, s66, 131072
  buffer_store_dwordx2 v[130:131], v8, s[8:11], s46 offen sc1
  v_smfmac_f32_16x16x64_bf16 v[40:43], v[120:123], a[152:159], v7
  v_permlane32_swap_b32 v32, v36
  v_permlane32_swap_b32 v33, v37
  v_permlane32_swap_b32 v34, v38
  v_smfmac_f32_16x16x64_bf16 v[44:47], v[120:123], a[176:183], v7
  v_permlane32_swap_b32 v35, v39
  v_add_f32 v32, v32, v36
  v_add_f32 v33, v33, v37
  v_smfmac_f32_16x16x64_bf16 v[40:43], v[124:127], a[160:167], v7
  v_add_f32 v34, v34, v38
  v_add_f32 v35, v35, v39
  v_smfmac_f32_16x16x64_bf16 v[44:47], v[124:127], a[184:191], v7
  v_cvt_pk_bf16_f32 v132, v32, v33
  v_cvt_pk_bf16_f32 v133, v34, v35
  v_smfmac_f32_16x16x64_bf16 v[48:51], v[116:119], a[192:199], v7
  v_min_u32 v132, s68, v132
  v_min_u32 v133, s68, v133
  v_smfmac_f32_16x16x64_bf16 v[52:55], v[116:119], a[216:223], v7
  s_add_u32 s46, s66, 262144
  buffer_store_dwordx2 v[132:133], v8, s[8:11], s46 offen sc1
  v_smfmac_f32_16x16x64_bf16 v[48:51], v[120:123], a[200:207], v7
  v_permlane32_swap_b32 v40, v44
  v_permlane32_swap_b32 v41, v45
  v_permlane32_swap_b32 v42, v46
  v_smfmac_f32_16x16x64_bf16 v[52:55], v[120:123], a[224:231], v7
  v_permlane32_swap_b32 v43, v47
  v_add_f32 v40, v40, v44
  v_add_f32 v41, v41, v45
  v_smfmac_f32_16x16x64_bf16 v[48:51], v[124:127], a[208:215], v7
  v_add_f32 v42, v42, v46
  v_add_f32 v43, v43, v47
  v_smfmac_f32_16x16x64_bf16 v[52:55], v[124:127], a[232:239], v7
  v_cvt_pk_bf16_f32 v134, v40, v41
  v_cvt_pk_bf16_f32 v135, v42, v43
  v_min_u32 v134, s68, v134
  v_min_u32 v135, s68, v135
  s_add_u32 s46, s66, 393216
  buffer_store_dwordx2 v[134:135], v8, s[8:11], s46 offen sc1
  s_nop 1
  v_permlane32_swap_b32 v48, v52
  v_permlane32_swap_b32 v49, v53
  v_permlane32_swap_b32 v50, v54
  v_permlane32_swap_b32 v51, v55
  v_add_f32 v48, v48, v52
  v_add_f32 v49, v49, v53
  v_add_f32 v50, v50, v54
  v_add_f32 v51, v51, v55
  v_cvt_pk_bf16_f32 v136, v48, v49
  v_cvt_pk_bf16_f32 v137, v50, v51
  v_min_u32 v136, s68, v136
  v_min_u32 v137, s68, v137
  s_add_u32 s46, s66, 524288
  buffer_store_dwordx2 v[136:137], v8, s[8:11], s46 offen sc1
  v_mov_b32 v148, s52
  s_mov_b64 exec, 1
  buffer_store_dword v148, v15, s[8:11], 0 offen sc1
  s_mov_b64 exec, -1
  s_add_u32 s46, s64, 0
  buffer_store_dwordx2 v[128:129], v9, s[8:11], s46 offen sc1
  s_add_u32 s46, s64, 65536
  buffer_store_dwordx2 v[130:131], v9, s[8:11], s46 offen sc1
  s_add_u32 s46, s64, 131072
  buffer_store_dwordx2 v[132:133], v9, s[8:11], s46 offen sc1
  s_add_u32 s46, s64, 196608
  buffer_store_dwordx2 v[134:135], v9, s[8:11], s46 offen sc1
  s_add_u32 s46, s64, 262144
  buffer_store_dwordx2 v[136:137], v9, s[8:11], s46 offen sc1
  v_mov_b32 v150, -1
  v_mov_b32 v151, -1
  s_add_u32 s46, s65, 0
  buffer_store_dwordx2 v[150:151], v8, s[8:11], s46 offen sc1
  s_add_u32 s46, s65, 131072
  buffer_store_dwordx2 v[150:151], v8, s[8:11], s46 offen sc1
  s_add_u32 s46, s65, 262144
  buffer_store_dwordx2 v[150:151], v8, s[8:11], s46 offen sc1
  s_add_u32 s46, s65, 393216
  buffer_store_dwordx2 v[150:151], v8, s[8:11], s46 offen sc1
  s_add_u32 s46, s65, 524288
  buffer_store_dwordx2 v[150:151], v8, s[8:11], s46 offen sc1
  s_mov_b32 s65, s66
  s_add_u32 s64, s64, 327680
  s_add_u32 s58, s58, 1
  s_cmp_eq_u32 s58, 3
  s_cselect_b32 s58, 0, s58
  s_mov_b32 s52, s53
  s_cmp_lt_u32 s52, 64
  s_cbranch_scc1 va_loop
  s_waitcnt vmcnt(0)
  v_mov_b32 v148, s52
  s_mov_b64 exec, 1
  buffer_store_dword v148, v15, s[8:11], 0 offen sc1
  s_mov_b64 exec, -1
  s_endpgm
va_redo_34:
  s_mov_b32 s50, 0
  s_waitcnt lgkmcnt(0)
va_poll_36:
  buffer_load_dwordx4 v[16:19], v1, s[8:11], s56 offen offset:0 sc1
  buffer_load_dwordx4 v[20:23], v1, s[8:11], s56 offen offset:1024 sc1
  buffer_load_dwordx4 v[24:27], v1, s[8:11], s56 offen offset:2048 sc1
  buffer_load_dwordx4 v[28:31], v1, s[8:11], s56 offen offset:3072 sc1
  buffer_load_dwordx4 v[32:35], v1, s[8:11], s59 offen offset:0 sc1
  buffer_load_dwordx4 v[36:39], v1, s[8:11], s59 offen offset:1024 sc1
  buffer_load_dwordx4 v[40:43], v1, s[8:11], s59 offen offset:2048 sc1
  buffer_load_dwordx4 v[44:47], v1, s[8:11], s59 offen offset:3072 sc1
  buffer_load_dwordx4 v[48:51], v1, s[8:11], s57 offen offset:0 sc1
  buffer_load_dwordx4 v[52:55], v1, s[8:11], s57 offen offset:1024 sc1
  s_add_u32 s50, s50, 1
  s_cmp_gt_u32 s50, 2097152
  s_cbranch_scc1 L_fail
  s_waitcnt vmcnt(0)
  v_max_u32 v12, v16, v17
  v_max3_u32 v12, v18, v19, v12
  v_max3_u32 v12, v20, v21, v12
  v_max3_u32 v12, v22, v23, v12
  v_max3_u32 v12, v24, v25, v12
  v_max3_u32 v12, v26, v27, v12
  v_max3_u32 v12, v28, v29, v12
  v_max3_u32 v12, v30, v31, v12
  v_max3_u32 v12, v32, v33, v12
  v_max3_u32 v12, v34, v35, v12
  v_max3_u32 v12, v36, v37, v12
  v_max3_u32 v12, v38, v39, v12
  v_max3_u32 v12, v40, v41, v12
  v_max3_u32 v12, v42, v43, v12
  v_max3_u32 v12, v44, v45, v12
  v_max3_u32 v12, v46, v47, v12
  v_max3_u32 v12, v48, v49, v12
  v_max3_u32 v12, v50, v51, v12
  v_max3_u32 v12, v52, v53, v12
  v_max3_u32 v12, v54, v55, v12
  v_cmp_eq_u32 vcc, -1, v12
  s_cbranch_vccnz va_poll_36
  ds_read_b128 v[56:59], v2 offset:0
  ds_read_b128 v[60:63], v2 offset:4096
  ds_read_b128 v[64:67], v2 offset:8192
  ds_read_b128 v[68:71], v2 offset:12288
  ds_read_b128 v[72:75], v2 offset:16384
  ds_read_b128 v[76:79], v2 offset:20480
  ds_read_b128 v[80:83], v2 offset:24576
  ds_read_b128 v[84:87], v2 offset:28672
  ds_read_b128 v[88:91], v2 offset:32768
  ds_read_b128 v[92:95], v2 offset:36864
  ds_read_b128 v[96:99], v2 offset:40960
  ds_read_b128 v[100:103], v2 offset:45056
  v_mov_b32 v104, 0
  v_mov_b32 v105, 0
  v_mov_b32 v106, 0
  v_mov_b32 v107, 0
  v_mov_b32 v108, 0
  v_mov_b32 v109, 0
  v_mov_b32 v110, 0
  v_mov_b32 v111, 0
  v_mov_b32 v112, 0
  v_mov_b32 v113, 0
  v_mov_b32 v114, 0
  v_mov_b32 v115, 0
  s_waitcnt lgkmcnt(0)
  s_branch va_go_33
L_owner:
  s_cmp_lg_u32 s42, 0
  s_cbranch_scc1 L_end
  s_mul_i32 s62, s43, 10
  s_add_u32 s62, s62, s44
  s_sub_u32 s62, s62, 16
  s_mov_b32 s12, s24
  s_mov_b32 s13, s25
  s_mov_b32 s14, 10240
  s_mov_b32 s15, 0x20000
  v_and_b32 v12, 1, v0
  v_lshlrev_b32 v12, 7, v12
  v_add_u32 v12, 3014656, v12
  s_mov_b32 s50, 0
pol_37:
  buffer_load_dword v10, v12, s[8:11], 0 offen sc1
  s_add_u32 s50, s50, 1
  s_cmp_gt_u32 s50, 2097152
  s_cbranch_scc1 L_fail
  s_waitcnt vmcnt(0)
  v_cmp_eq_u32 vcc, 0, v10
  s_cbranch_vccnz pol_37
  v_readlane_b32 s54, v10, 0
  v_readlane_b32 s55, v10, 1
  s_and_b32 s54, s54, 0x2000
  s_and_b32 s55, s55, 0x2000
  s_mov_b32 s68, 0xfffffffe
  v_and_b32 v10, 3, v0
  s_lshl_b32 s46, s43, 9
  s_add_u32 s46, s46, s55
  s_add_u32 s46, s46, 2885632
  v_lshl_add_u32 v6, v10, 7, s46
  s_lshl_b32 s46, s43, 7
  s_add_u32 s46, s46, s55
  s_add_u32 s46, s46, 2883584
  v_lshl_add_u32 v7, v10, 9, s46
  v_mov_b32 v5, 0x44444444
  v_mov_b32 v10, 0xeeeeeeee
  v_and_b32 v11, 8, v0
  v_cmp_ne_u32 vcc, 0, v11
  s_nop 1
  v_cndmask_b32 v5, v5, v10, vcc
  v_lshlrev_b32 v1, 4, v0
  v_and_b32 v10, 15, v0
  v_lshrrev_b32 v11, 4, v0
  v_lshlrev_b32 v2, 3, v10
  v_lshl_add_u32 v2, v11, 8, v2
  v_and_b32 v12, 1, v11
  v_lshlrev_b32 v12, 2, v12
  v_lshrrev_b32 v13, 1, v11
  v_add_u32 v12, v12, v13
  v_and_b32 v13, 1, v10
  v_lshl_add_u32 v12, v13, 1, v12
  v_mov_b32 v4, 0x05040100
  v_mov_b32 v14, 0x03020706
  v_cmp_eq_u32 vcc, 1, v13
  s_nop 1
  v_cndmask_b32 v4, v4, v14, vcc
  v_bfe_u32 v13, v10, 1, 1
  v_lshl_add_u32 v3, v13, 3, v12
  v_lshlrev_b32 v3, 4, v3
  v_lshrrev_b32 v13, 2, v10
  v_lshl_add_u32 v3, v13, 2, v3
  s_lshl_b32 s46, s62, 8
  s_cmp_ge_u32 s62, 32
  s_cselect_b32 s47, 40960, 0
  s_add_u32 s46, s46, s47
  s_add_u32 s46, s46, s55
  s_add_u32 s46, s46, 2097152
  v_add_u32 v3, s46, v3
  v_mul_u32_u24 v12, 1280, v12
  v_and_b32 v13, 14, v10
  v_lshl_add_u32 v12, v13, 1, v12
  s_lshl_b32 s46, s62, 5
  buffer_load_dword v15, v12, s[12:15], s46 offen
  v_and_b32 v9, 31, v0
  v_lshlrev_b32 v9, 7, v9
  s_and_b32 s46, s62, 3
  s_lshl_b32 s46, s46, 2
  s_add_u32 s46, s46, 2949120
  v_add_u32 v9, s46, v9
  s_lshl_b32 s63, s62, 15
  s_add_u32 s63, s63, 83886080
  s_sub_u32 s67, s44, 16
  s_mov_b32 s61, 0
  s_mov_b32 s52, 0
  s_mov_b32 s58, 0
  s_mov_b32 s100, 0
  s_waitcnt vmcnt(0)
  v_min_u32 v15, s68, v15
  s_mov_b32 s46, 0
  buffer_store_dword v15, v3, s[8:11], s46 offen sc1
  s_mov_b32 s46, 65536
  buffer_store_dword v15, v3, s[8:11], s46 offen sc1
  s_mov_b32 s46, 131072
  buffer_store_dword v15, v3, s[8:11], s46 offen sc1
  s_mov_b32 s46, 196608
  buffer_store_dword v15, v3, s[8:11], s46 offen sc1
  s_mov_b32 s53, 1
  s_cmp_lg_u32 s67, 0
  s_cbranch_scc1 ow_r0
  v_mov_b32 v16, s53
  s_mov_b64 exec, 15
  buffer_store_dword v16, v7, s[8:11], 0 offen sc1
  s_mov_b64 exec, -1
ow_r0:
ow_loop:
  s_add_u32 s53, s52, 1
  s_cmp_ge_u32 s61, s53
  s_cbranch_scc1 wf_done_38
  s_mov_b32 s50, 0
wf_loop_39:
  buffer_load_dword v10, v9, s[8:11], 0 offen sc1
  s_add_u32 s50, s50, 1
  s_cmp_gt_u32 s50, 2097152
  s_cbranch_scc1 L_fail
  s_waitcnt vmcnt(0)
  v_min_u32_dpp v10, v10, v10 row_ror:8 row_mask:0xf bank_mask:0xf
  s_nop 1
  v_min_u32_dpp v10, v10, v10 row_ror:4 row_mask:0xf bank_mask:0xf
  s_nop 1
  v_min_u32_dpp v10, v10, v10 row_ror:2 row_mask:0xf bank_mask:0xf
  s_nop 1
  v_min_u32_dpp v10, v10, v10 row_ror:1 row_mask:0xf bank_mask:0xf
  v_mov_b32 v11, v10
  s_nop 1
  v_permlane16_swap_b32 v11, v10
  v_min_u32 v10, v10, v11
  v_mov_b32 v11, v10
  s_nop 1
  v_permlane32_swap_b32 v11, v10
  v_min_u32 v10, v10, v11
  s_nop 0
  v_readfirstlane_b32 s61, v10
  s_nop 0
  s_cmp_lt_u32 s61, s53
  s_cbranch_scc1 wf_loop_39
wf_done_38:
  s_add_u32 s46, s63, 0
  buffer_load_dwordx4 a[0:3], v1, s[8:11], s46 offen offset:0 sc1
  buffer_load_dwordx4 a[4:7], v1, s[8:11], s46 offen offset:1024 sc1
  buffer_load_dwordx4 a[8:11], v1, s[8:11], s46 offen offset:2048 sc1
  buffer_load_dwordx4 a[12:15], v1, s[8:11], s46 offen offset:3072 sc1
  s_add_u32 s46, s63, 4096
  buffer_load_dwordx4 a[16:19], v1, s[8:11], s46 offen offset:0 sc1
  buffer_load_dwordx4 a[20:23], v1, s[8:11], s46 offen offset:1024 sc1
  buffer_load_dwordx4 a[24:27], v1, s[8:11], s46 offen offset:2048 sc1
  buffer_load_dwordx4 a[28:31], v1, s[8:11], s46 offen offset:3072 sc1
  s_add_u32 s46, s63, 8192
  buffer_load_dwordx4 a[32:35], v1, s[8:11], s46 offen offset:0 sc1
  buffer_load_dwordx4 a[36:39], v1, s[8:11], s46 offen offset:1024 sc1
  buffer_load_dwordx4 a[40:43], v1, s[8:11], s46 offen offset:2048 sc1
  buffer_load_dwordx4 a[44:47], v1, s[8:11], s46 offen offset:3072 sc1
  s_add_u32 s46, s63, 12288
  buffer_load_dwordx4 a[48:51], v1, s[8:11], s46 offen offset:0 sc1
  buffer_load_dwordx4 a[52:55], v1, s[8:11], s46 offen offset:1024 sc1
  buffer_load_dwordx4 a[56:59], v1, s[8:11], s46 offen offset:2048 sc1
  buffer_load_dwordx4 a[60:63], v1, s[8:11], s46 offen offset:3072 sc1
  s_add_u32 s46, s63, 16384
  buffer_load_dwordx4 a[64:67], v1, s[8:11], s46 offen offset:0 sc1
  buffer_load_dwordx4 a[68:71], v1, s[8:11], s46 offen offset:1024 sc1
  buffer_load_dwordx4 a[72:75], v1, s[8:11], s46 offen offset:2048 sc1
  buffer_load_dwordx4 a[76:79], v1, s[8:11], s46 offen offset:3072 sc1
  s_add_u32 s46, s63, 20480
  buffer_load_dwordx4 a[80:83], v1, s[8:11], s46 offen offset:0 sc1
  buffer_load_dwordx4 a[84:87], v1, s[8:11], s46 offen offset:1024 sc1
  buffer_load_dwordx4 a[88:91], v1, s[8:11], s46 offen offset:2048 sc1
  buffer_load_dwordx4 a[92:95], v1, s[8:11], s46 offen offset:3072 sc1
  s_add_u32 s46, s63, 24576
  buffer_load_dwordx4 a[96:99], v1, s[8:11], s46 offen offset:0 sc1
  buffer_load_dwordx4 a[100:103], v1, s[8:11], s46 offen offset:1024 sc1
  buffer_load_dwordx4 a[104:107], v1, s[8:11], s46 offen offset:2048 sc1
  buffer_load_dwordx4 a[108:111], v1, s[8:11], s46 offen offset:3072 sc1
  s_add_u32 s46, s63, 28672
  buffer_load_dwordx4 a[112:115], v1, s[8:11], s46 offen offset:0 sc1
  buffer_load_dwordx4 a[116:119], v1, s[8:11], s46 offen offset:1024 sc1
  buffer_load_dwordx4 a[120:123], v1, s[8:11], s46 offen offset:2048 sc1
  buffer_load_dwordx4 a[124:127], v1, s[8:11], s46 offen offset:3072 sc1
  s_add_u32 s63, s63, 1310720
  s_lshl_b32 s56, s58, 2
  s_add_u32 s56, s56, s43
  s_lshl_b32 s56, s56, 16
  s_add_u32 s56, s56, s55
  s_add_u32 s56, s56, 2097152
  s_add_u32 s66, s58, 1
  s_cmp_eq_u32 s66, 3
  s_cselect_b32 s66, 0, s66
  s_mul_i32 s72, s58, 655360
  s_lshl_b32 s46, s62, 14
  s_add_u32 s72, s72, s46
  s_add_u32 s72, s72, s54
  s_add_u32 s73, s72, 4096
  s_add_u32 s74, s56, 16384
  s_add_u32 s75, s56, 20480
  s_add_u32 s76, s56, 32768
  s_add_u32 s77, s56, 36864
  s_add_u32 s78, s56, 51200
  s_lshl_b32 s80, s66, 18
  s_add_u32 s81, s80, 65536
  s_add_u32 s82, s80, 131072
  s_add_u32 s83, s80, 196608
  s_add_u32 s64, s52, 2
  v_mov_b32 v20, 0
  v_mov_b32 v21, 0
  v_mov_b32 v22, 0
  v_mov_b32 v23, 0
  s_waitcnt vmcnt(0)
  s_mov_b32 s50, 0
  s_mov_b64 exec, 15
  buffer_load_dword v136, v6, s[8:11], 0 offen sc1
  s_nop 11
  buffer_load_dword v137, v6, s[8:11], 0 offen sc1
  s_nop 11
  buffer_load_dword v138, v6, s[8:11], 0 offen sc1
  s_nop 11
  buffer_load_dword v139, v6, s[8:11], 0 offen sc1
  s_nop 11
  buffer_load_dword v140, v6, s[8:11], 0 offen sc1
  s_nop 11
  buffer_load_dword v141, v6, s[8:11], 0 offen sc1
  s_nop 11
  buffer_load_dword v142, v6, s[8:11], 0 offen sc1
  s_nop 11
  buffer_load_dword v143, v6, s[8:11], 0 offen sc1
  s_nop 11
  buffer_load_dword v144, v6, s[8:11], 0 offen sc1
  s_nop 11
bell_40:
  buffer_load_dword v145, v6, s[8:11], 0 offen sc1
  s_waitcnt vmcnt(9)
  v_cmp_gt_u32 vcc, s53, v136
  s_cbranch_vccz bell_x_41
  s_nop 7
  buffer_load_dword v136, v6, s[8:11], 0 offen sc1
  s_waitcnt vmcnt(9)
  v_cmp_gt_u32 vcc, s53, v137
  s_cbranch_vccz bell_x_41
  s_nop 7
  buffer_load_dword v137, v6, s[8:11], 0 offen sc1
  s_waitcnt vmcnt(9)
  v_cmp_gt_u32 vcc, s53, v138
  s_cbranch_vccz bell_x_41
  s_nop 7
  buffer_load_dword v138, v6, s[8:11], 0 offen sc1
  s_waitcnt vmcnt(9)
  v_cmp_gt_u32 vcc, s53, v139
  s_cbranch_vccz bell_x_41
  s_nop 7
  buffer_load_dword v139, v6, s[8:11], 0 offen sc1
  s_waitcnt vmcnt(9)
  v_cmp_gt_u32 vcc, s53, v140
  s_cbranch_vccz bell_x_41
  s_nop 7
  buffer_load_dword v140, v6, s[8:11], 0 offen sc1
  s_waitcnt vmcnt(9)
  v_cmp_gt_u32 vcc, s53, v141
  s_cbranch_vccz bell_x_41
  s_nop 7
  buffer_load_dword v141, v6, s[8:11], 0 offen sc1
  s_waitcnt vmcnt(9)
  v_cmp_gt_u32 vcc, s53, v142
  s_cbranch_vccz bell_x_41
  s_nop 7
  buffer_load_dword v142, v6, s[8:11], 0 offen sc1
  s_waitcnt vmcnt(9)
  v_cmp_gt_u32 vcc, s53, v143
  s_cbranch_vccz bell_x_41
  s_nop 7
  buffer_load_dword v143, v6, s[8:11], 0 offen sc1
  s_waitcnt vmcnt(9)
  v_cmp_gt_u32 vcc, s53, v144
  s_cbranch_vccz bell_x_41
  s_nop 7
  buffer_load_dword v144, v6, s[8:11], 0 offen sc1
  s_waitcnt vmcnt(9)
  v_cmp_gt_u32 vcc, s53, v145
  s_cbranch_vccz bell_x_41
  s_add_u32 s50, s50, 1
  s_cmp_gt_u32 s50, 2097152
  s_cbranch_scc1 L_fail
  s_branch bell_40
bell_x_41:
  s_mov_b64 exec, -1
  buffer_load_dwordx4 v[24:27], v1, s[8:11], s72 offen offset:0 sc1
  buffer_load_dwordx4 v[28:31], v1, s[8:11], s72 offen offset:1024 sc1
  buffer_load_dwordx4 v[32:35], v1, s[8:11], s72 offen offset:2048 sc1
  buffer_load_dwordx4 v[36:39], v1, s[8:11], s72 offen offset:3072 sc1
  buffer_load_dwordx4 v[40:43], v1, s[8:11], s73 offen offset:0 sc1
  buffer_load_dwordx4 v[44:47], v1, s[8:11], s73 offen offset:1024 sc1
  buffer_load_dwordx4 v[48:51], v1, s[8:11], s73 offen offset:2048 sc1
  buffer_load_dwordx4 v[52:55], v1, s[8:11], s73 offen offset:3072 sc1
  buffer_load_dwordx2 v[56:57], v2, s[8:11], s78 offen offset:0 sc1
  buffer_load_dwordx2 v[58:59], v2, s[8:11], s78 offen offset:128 sc1
  buffer_load_dwordx2 v[60:61], v2, s[8:11], s78 offen offset:1024 sc1
  buffer_load_dwordx2 v[62:63], v2, s[8:11], s78 offen offset:1152 sc1
  buffer_load_dwordx2 v[64:65], v2, s[8:11], s78 offen offset:2048 sc1
  buffer_load_dwordx2 v[66:67], v2, s[8:11], s78 offen offset:2176 sc1
  buffer_load_dwordx2 v[68:69], v2, s[8:11], s78 offen offset:3072 sc1
  buffer_load_dwordx2 v[70:71], v2, s[8:11], s78 offen offset:3200 sc1
  buffer_load_dwordx4 v[72:75], v1, s[8:11], s74 offen offset:0 sc1
  buffer_load_dwordx4 v[76:79], v1, s[8:11], s74 offen offset:1024 sc1
  buffer_load_dwordx4 v[80:83], v1, s[8:11], s74 offen offset:2048 sc1
  buffer_load_dwordx4 v[84:87], v1, s[8:11], s74 offen offset:3072 sc1
  buffer_load_dwordx4 v[88:91], v1, s[8:11], s75 offen offset:0 sc1
  buffer_load_dwordx4 v[92:95], v1, s[8:11], s75 offen offset:1024 sc1
  buffer_load_dwordx4 v[96:99], v1, s[8:11], s75 offen offset:2048 sc1
  buffer_load_dwordx4 v[100:103], v1, s[8:11], s75 offen offset:3072 sc1
  buffer_load_dwordx4 v[104:107], v1, s[8:11], s76 offen offset:0 sc1
  buffer_load_dwordx4 v[108:111], v1, s[8:11], s76 offen offset:1024 sc1
  buffer_load_dwordx4 v[112:115], v1, s[8:11], s76 offen offset:2048 sc1
  buffer_load_dwordx4 v[116:119], v1, s[8:11], s76 offen offset:3072 sc1
  buffer_load_dwordx4 v[120:123], v1, s[8:11], s77 offen offset:0 sc1
  buffer_load_dwordx4 v[124:127], v1, s[8:11], s77 offen offset:1024 sc1
  buffer_load_dwordx4 v[128:131], v1, s[8:11], s77 offen offset:2048 sc1
  buffer_load_dwordx4 v[132:135], v1, s[8:11], s77 offen offset:3072 sc1
  v_mov_b32 v16, s64
  v_mov_b32 v17, 2146435072
  s_cmp_eq_u32 s67, 0
  s_cselect_b64 vcc, 15, 0
  v_cndmask_b32 v17, v17, v7, vcc
  buffer_store_dword v16, v17, s[8:11], 0 offen sc1
  s_waitcnt vmcnt(32)
  v_max3_u32 v8, v24, v25, v26
  v_max3_u32 v8, v26, v27, v8
  s_waitcnt vmcnt(31)
  v_max3_u32 v8, v28, v29, v8
  v_max3_u32 v8, v30, v31, v8
  s_waitcnt vmcnt(30)
  v_max3_u32 v8, v32, v33, v8
  v_max3_u32 v8, v34, v35, v8
  s_waitcnt vmcnt(29)
  v_max3_u32 v8, v36, v37, v8
  v_max3_u32 v8, v38, v39, v8
  s_waitcnt vmcnt(28)
  v_max3_u32 v8, v40, v41, v8
  v_max3_u32 v8, v42, v43, v8
  s_waitcnt vmcnt(27)
  v_max3_u32 v8, v44, v45, v8
  v_max3_u32 v8, v46, v47, v8
  s_waitcnt vmcnt(26)
  v_max3_u32 v8, v48, v49, v8
  v_max3_u32 v8, v50, v51, v8
  s_waitcnt vmcnt(25)
  v_max3_u32 v8, v52, v53, v8
  v_max3_u32 v8, v54, v55, v8
ow_go:
  s_waitcnt vmcnt(23)
  v_smfmac_f32_16x16x64_bf16 v[20:23], v[56:59], v[24:31], v5
  v_max3_u32 v8, v56, v57, v8
  v_max3_u32 v8, v58, v59, v8
  s_waitcnt vmcnt(21)
  v_smfmac_f32_16x16x64_bf16 v[20:23], v[60:63], v[32:39], v5
  v_max3_u32 v8, v60, v61, v8
  v_max3_u32 v8, v62, v63, v8
  s_waitcnt vmcnt(19)
  v_smfmac_f32_16x16x64_bf16 v[20:23], v[64:67], v[40:47], v5
  v_max3_u32 v8, v64, v65, v8
  v_max3_u32 v8, v66, v67, v8
  s_waitcnt vmcnt(17)
  v_smfmac_f32_16x16x64_bf16 v[20:23], v[68:71], v[48:55], v5
  v_max3_u32 v8, v68, v69, v8
  v_max3_u32 v8, v70, v71, v8
  s_waitcnt vmcnt(16)
  v_smfmac_f32_16x16x64_bf16 v[20:23], v[72:75], a[0:7], v5
  v_max3_u32 v8, v72, v73, v8
  v_max3_u32 v8, v74, v75, v8
  s_waitcnt vmcnt(15)
  v_smfmac_f32_16x16x64_bf16 v[20:23], v[76:79], a[8:15], v5
  v_max3_u32 v8, v76, v77, v8
  v_max3_u32 v8, v78, v79, v8
  s_waitcnt vmcnt(14)
  v_smfmac_f32_16x16x64_bf16 v[20:23], v[80:83], a[16:23], v5
  v_max3_u32 v8, v80, v81, v8
  v_max3_u32 v8, v82, v83, v8
  s_waitcnt vmcnt(13)
  v_smfmac_f32_16x16x64_bf16 v[20:23], v[84:87], a[24:31], v5
  v_max3_u32 v8, v84, v85, v8
  v_max3_u32 v8, v86, v87, v8
  s_waitcnt vmcnt(12)
  v_smfmac_f32_16x16x64_bf16 v[20:23], v[88:91], a[32:39], v5
  v_max3_u32 v8, v88, v89, v8
  v_max3_u32 v8, v90, v91, v8
  s_waitcnt vmcnt(11)
  v_smfmac_f32_16x16x64_bf16 v[20:23], v[92:95], a[40:47], v5
  v_max3_u32 v8, v92, v93, v8
  v_max3_u32 v8, v94, v95, v8
  s_waitcnt vmcnt(10)
  v_smfmac_f32_16x16x64_bf16 v[20:23], v[96:99], a[48:55], v5
  v_max3_u32 v8, v96, v97, v8
  v_max3_u32 v8, v98, v99, v8
  s_waitcnt vmcnt(9)
  v_smfmac_f32_16x16x64_bf16 v[20:23], v[100:103], a[56:63], v5
  v_max3_u32 v8, v100, v101, v8
  v_max3_u32 v8, v102, v103, v8
  s_waitcnt vmcnt(8)
  v_smfmac_f32_16x16x64_bf16 v[20:23], v[104:107], a[64:71], v5
  v_max3_u32 v8, v104, v105, v8
  v_max3_u32 v8, v106, v107, v8
  s_waitcnt vmcnt(7)
  v_smfmac_f32_16x16x64_bf16 v[20:23], v[108:111], a[72:79], v5
  v_max3_u32 v8, v108, v109, v8
  v_max3_u32 v8, v110, v111, v8
  s_waitcnt vmcnt(6)
  v_smfmac_f32_16x16x64_bf16 v[20:23], v[112:115], a[80:87], v5
  v_max3_u32 v8, v112, v113, v8
  v_max3_u32 v8, v114, v115, v8
  s_waitcnt vmcnt(5)
  v_smfmac_f32_16x16x64_bf16 v[20:23], v[116:119], a[88:95], v5
  v_max3_u32 v8, v116, v117, v8
  v_max3_u32 v8, v118, v119, v8
  s_waitcnt vmcnt(4)
  v_smfmac_f32_16x16x64_bf16 v[20:23], v[120:123], a[96:103], v5
  v_max3_u32 v8, v120, v121, v8
  v_max3_u32 v8, v122, v123, v8
  s_waitcnt vmcnt(3)
  v_smfmac_f32_16x16x64_bf16 v[20:23], v[124:127], a[104:111], v5
  v_max3_u32 v8, v124, v125, v8
  v_max3_u32 v8, v126, v127, v8
  s_waitcnt vmcnt(2)
  v_smfmac_f32_16x16x64_bf16 v[20:23], v[128:131], a[112:119], v5
  v_max3_u32 v8, v128, v129, v8
  v_max3_u32 v8, v130, v131, v8
  s_waitcnt vmcnt(1)
  v_smfmac_f32_16x16x64_bf16 v[20:23], v[132:135], a[120:127], v5
  v_max3_u32 v8, v132, v133, v8
  v_max3_u32 v8, v134, v135, v8
  v_cmp_eq_u32 vcc, -1, v8
  s_cbranch_vccnz ow_redo
  s_nop 3
  v_permlane32_swap_b32 v20, v21
  v_permlane32_swap_b32 v22, v23
  v_add_f32 v20, v20, v21
  v_add_f32 v22, v22, v23
  v_cvt_pk_bf16_f32 v10, v20, v22
  s_nop 1
  v_mov_b32_dpp v11, v10 quad_perm:[1,0,3,2] row_mask:0xf bank_mask:0xf
  v_perm_b32 v10, v11, v10, v4
  v_min_u32 v10, s68, v10
  buffer_store_dword v10, v3, s[8:11], s80 offen sc1
  buffer_store_dword v10, v3, s[8:11], s81 offen sc1
  buffer_store_dword v10, v3, s[8:11], s82 offen sc1
  buffer_store_dword v10, v3, s[8:11], s83 offen sc1
  v_mov_b32 v11, -1
  s_lshl_b32 s47, s58, 18
  s_add_u32 s46, s47, 0
  buffer_store_dword v11, v3, s[8:11], s46 offen sc1
  s_add_u32 s46, s47, 65536
  buffer_store_dword v11, v3, s[8:11], s46 offen sc1
  s_add_u32 s46, s47, 131072
  buffer_store_dword v11, v3, s[8:11], s46 offen sc1
  s_add_u32 s46, s47, 196608
  buffer_store_dword v11, v3, s[8:11], s46 offen sc1
  s_mov_b32 s58, s66
  s_mov_b32 s52, s53
  s_cmp_lt_u32 s52, 63
  s_cbranch_scc1 ow_loop
  s_endpgm
ow_redo:
  s_mov_b32 s50, 0
ow_poll:
  buffer_load_dwordx4 v[24:27], v1, s[8:11], s72 offen offset:0 sc1
  buffer_load_dwordx4 v[28:31], v1, s[8:11], s72 offen offset:1024 sc1
  buffer_load_dwordx4 v[32:35], v1, s[8:11], s72 offen offset:2048 sc1
  buffer_load_dwordx4 v[36:39], v1, s[8:11], s72 offen offset:3072 sc1
  buffer_load_dwordx4 v[40:43], v1, s[8:11], s73 offen offset:0 sc1
  buffer_load_dwordx4 v[44:47], v1, s[8:11], s73 offen offset:1024 sc1
  buffer_load_dwordx4 v[48:51], v1, s[8:11], s73 offen offset:2048 sc1
  buffer_load_dwordx4 v[52:55], v1, s[8:11], s73 offen offset:3072 sc1
  buffer_load_dwordx2 v[56:57], v2, s[8:11], s78 offen offset:0 sc1
  buffer_load_dwordx2 v[58:59], v2, s[8:11], s78 offen offset:128 sc1
  buffer_load_dwordx2 v[60:61], v2, s[8:11], s78 offen offset:1024 sc1
  buffer_load_dwordx2 v[62:63], v2, s[8:11], s78 offen offset:1152 sc1
  buffer_load_dwordx2 v[64:65], v2, s[8:11], s78 offen offset:2048 sc1
  buffer_load_dwordx2 v[66:67], v2, s[8:11], s78 offen offset:2176 sc1
  buffer_load_dwordx2 v[68:69], v2, s[8:11], s78 offen offset:3072 sc1
  buffer_load_dwordx2 v[70:71], v2, s[8:11], s78 offen offset:3200 sc1
  buffer_load_dwordx4 v[72:75], v1, s[8:11], s74 offen offset:0 sc1
  buffer_load_dwordx4 v[76:79], v1, s[8:11], s74 offen offset:1024 sc1
  buffer_load_dwordx4 v[80:83], v1, s[8:11], s74 offen offset:2048 sc1
  buffer_load_dwordx4 v[84:87], v1, s[8:11], s74 offen offset:3072 sc1
  buffer_load_dwordx4 v[88:91], v1, s[8:11], s75 offen offset:0 sc1
  buffer_load_dwordx4 v[92:95], v1, s[8:11], s75 offen offset:1024 sc1
  buffer_load_dwordx4 v[96:99], v1, s[8:11], s75 offen offset:2048 sc1
  buffer_load_dwordx4 v[100:103], v1, s[8:11], s75 offen offset:3072 sc1
  buffer_load_dwordx4 v[104:107], v1, s[8:11], s76 offen offset:0 sc1
  buffer_load_dwordx4 v[108:111], v1, s[8:11], s76 offen offset:1024 sc1
  buffer_load_dwordx4 v[112:115], v1, s[8:11], s76 offen offset:2048 sc1
  buffer_load_dwordx4 v[116:119], v1, s[8:11], s76 offen offset:3072 sc1
  buffer_load_dwordx4 v[120:123], v1, s[8:11], s77 offen offset:0 sc1
  buffer_load_dwordx4 v[124:127], v1, s[8:11], s77 offen offset:1024 sc1
  buffer_load_dwordx4 v[128:131], v1, s[8:11], s77 offen offset:2048 sc1
  buffer_load_dwordx4 v[132:135], v1, s[8:11], s77 offen offset:3072 sc1
  s_add_u32 s50, s50, 1
  s_cmp_gt_u32 s50, 2097152
  s_cbranch_scc1 L_fail
  s_waitcnt vmcnt(0)
  v_max_u32 v8, v24, v25
  v_max3_u32 v8, v26, v27, v8
  v_max3_u32 v8, v28, v29, v8
  v_max3_u32 v8, v30, v31, v8
  v_max3_u32 v8, v32, v33, v8
  v_max3_u32 v8, v34, v35, v8
  v_max3_u32 v8, v36, v37, v8
  v_max3_u32 v8, v38, v39, v8
  v_max3_u32 v8, v40, v41, v8
  v_max3_u32 v8, v42, v43, v8
  v_max3_u32 v8, v44, v45, v8
  v_max3_u32 v8, v46, v47, v8
  v_max3_u32 v8, v48, v49, v8
  v_max3_u32 v8, v50, v51, v8
  v_max3_u32 v8, v52, v53, v8
  v_max3_u32 v8, v54, v55, v8
  v_max3_u32 v8, v56, v57, v8
  v_max3_u32 v8, v58, v59, v8
  v_max3_u32 v8, v60, v61, v8
  v_max3_u32 v8, v62, v63, v8
  v_max3_u32 v8, v64, v65, v8
  v_max3_u32 v8, v66, v67, v8
  v_max3_u32 v8, v68, v69, v8
  v_max3_u32 v8, v70, v71, v8
  v_max3_u32 v8, v72, v73, v8
  v_max3_u32 v8, v74, v75, v8
  v_max3_u32 v8, v76, v77, v8
  v_max3_u32 v8, v78, v79, v8
  v_max3_u32 v8, v80, v81, v8
  v_max3_u32 v8, v82, v83, v8
  v_max3_u32 v8, v84, v85, v8
  v_max3_u32 v8, v86, v87, v8
  v_max3_u32 v8, v88, v89, v8
  v_max3_u32 v8, v90, v91, v8
  v_max3_u32 v8, v92, v93, v8
  v_max3_u32 v8, v94, v95, v8
  v_max3_u32 v8, v96, v97, v8
  v_max3_u32 v8, v98, v99, v8
  v_max3_u32 v8, v100, v101, v8
  v_max3_u32 v8, v102, v103, v8
  v_max3_u32 v8, v104, v105, v8
  v_max3_u32 v8, v106, v107, v8
  v_max3_u32 v8, v108, v109, v8
  v_max3_u32 v8, v110, v111, v8
  v_max3_u32 v8, v112, v113, v8
  v_max3_u32 v8, v114, v115, v8
  v_max3_u32 v8, v116, v117, v8
  v_max3_u32 v8, v118, v119, v8
  v_max3_u32 v8, v120, v121, v8
  v_max3_u32 v8, v122, v123, v8
  v_max3_u32 v8, v124, v125, v8
  v_max3_u32 v8, v126, v127, v8
  v_max3_u32 v8, v128, v129, v8
  v_max3_u32 v8, v130, v131, v8
  v_max3_u32 v8, v132, v133, v8
  v_max3_u32 v8, v134, v135, v8
  v_cmp_eq_u32 vcc, -1, v8
  s_cbranch_vccnz ow_poll
  v_mov_b32 v20, 0
  v_mov_b32 v21, 0
  v_mov_b32 v22, 0
  v_mov_b32 v23, 0
  s_branch ow_go
L_xowner:
  s_mov_b32 s12, s36
  s_mov_b32 s13, s37
  s_mov_b32 s14, 5242880
  s_mov_b32 s15, 0x20000
  s_sub_u32 s48, s44, 26
  s_and_b32 s46, s48, 1
  s_mul_i32 s46, s46, 5
  s_mul_i32 s62, s43, 10
  s_add_u32 s62, s62, s46
  s_lshr_b32 s52, s48, 1
  v_lshlrev_b32 v1, 4, v0
  v_and_b32 v10, 7, v0
  v_lshlrev_b32 v10, 7, v10
  v_add_u32 v10, s51, v10
  v_bfe_u32 v11, v0, 3, 2
  v_lshl_add_u32 v2, v11, 2, v10
  v_add_u32 v3, 2965504, v2
  v_add_u32 v2, 2949120, v2
  v_bfe_u32 v11, v0, 3, 1
  v_lshl_add_u32 v4, v11, 2, v10
  v_add_u32 v4, 2981888, v4
  v_cmp_lt_u32 vcc, 31, v0
  s_nop 1
  v_cndmask_b32 v3, v3, v4, vcc
  s_mul_i32 s46, s42, 10240
  v_add_u32 v5, s46, v1
  v_add_u32 v6, s51, v1
  s_lshl_b32 s63, s62, 15
  s_lshl_b32 s46, s42, 13
  s_add_u32 s63, s63, s46
  s_mul_i32 s47, s52, 1310720
  s_add_u32 s63, s63, s47
  s_add_u32 s63, s63, 83886080
  s_mul_i32 s65, s52, 81920
  s_add_u32 s65, s65, 188743680
  s_lshl_b32 s64, s62, 13
  s_lshl_b32 s46, s42, 11
  s_add_u32 s64, s64, s46
  s_mul_i32 s47, s52, 327680
  s_add_u32 s64, s64, s47
  s_add_u32 s64, s64, 167772160
  s_mul_i32 s66, s52, 81920
  v_and_b32 v10, 15, v0
  v_mul_u32_u24 v10, 2560, v10
  v_lshrrev_b32 v11, 4, v0
  v_lshl_add_u32 v10, v11, 3, v10
  s_add_u32 s46, s42, 0
  s_cmp_ge_u32 s46, 5
  s_cselect_b32 s47, 40800, 0
  s_add_u32 s48, s46, s62
  s_lshl_b32 s48, s48, 5
  s_add_u32 s47, s47, s48
  s_add_u32 s47, s47, 1280
  s_cmp_ge_u32 s46, 10
  s_cselect_b32 s47, 2146435072, s47
  v_add_u32 v7, s47, v10
  s_add_u32 s46, s42, 4
  s_cmp_ge_u32 s46, 5
  s_cselect_b32 s47, 40800, 0
  s_add_u32 s48, s46, s62
  s_lshl_b32 s48, s48, 5
  s_add_u32 s47, s47, s48
  s_add_u32 s47, s47, 1280
  s_cmp_ge_u32 s46, 10
  s_cselect_b32 s47, 2146435072, s47
  v_add_u32 v8, s47, v10
  s_add_u32 s46, s42, 8
  s_cmp_ge_u32 s46, 5
  s_cselect_b32 s47, 40800, 0
  s_add_u32 s48, s46, s62
  s_lshl_b32 s48, s48, 5
  s_add_u32 s47, s47, s48
  s_add_u32 s47, s47, 1280
  s_cmp_ge_u32 s46, 10
  s_cselect_b32 s47, 2146435072, s47
  v_add_u32 v9, s47, v10
  s_mov_b32 s60, 0
  s_mov_b32 s61, 0
xo_loop:
  s_add_u32 s53, s52, 1
  s_cmp_ge_u32 s60, s53
  s_cbranch_scc1 wf_done_42
  s_mov_b32 s50, 0
wf_loop_43:
  buffer_load_dword v10, v2, s[8:11], 0 offen sc1
  s_add_u32 s50, s50, 1
  s_cmp_gt_u32 s50, 2097152
  s_cbranch_scc1 L_fail
  s_waitcnt vmcnt(0)
  v_min_u32_dpp v10, v10, v10 row_ror:8 row_mask:0xf bank_mask:0xf
  s_nop 1
  v_min_u32_dpp v10, v10, v10 row_ror:4 row_mask:0xf bank_mask:0xf
  s_nop 1
  v_min_u32_dpp v10, v10, v10 row_ror:2 row_mask:0xf bank_mask:0xf
  s_nop 1
  v_min_u32_dpp v10, v10, v10 row_ror:1 row_mask:0xf bank_mask:0xf
  v_mov_b32 v11, v10
  s_nop 1
  v_permlane16_swap_b32 v11, v10
  v_min_u32 v10, v10, v11
  v_mov_b32 v11, v10
  s_nop 1
  v_permlane32_swap_b32 v11, v10
  v_min_u32 v10, v10, v11
  s_nop 0
  v_readfirstlane_b32 s60, v10
  s_nop 0
  s_cmp_lt_u32 s60, s53
  s_cbranch_scc1 wf_loop_43
wf_done_42:
  s_add_u32 s46, s63, 0
  buffer_load_dwordx4 a[0:3], v1, s[8:11], s46 offen offset:0 sc1
  buffer_load_dwordx4 a[4:7], v1, s[8:11], s46 offen offset:1024 sc1
  buffer_load_dwordx4 a[8:11], v1, s[8:11], s46 offen offset:2048 sc1
  buffer_load_dwordx4 a[12:15], v1, s[8:11], s46 offen offset:3072 sc1
  s_add_u32 s46, s63, 4096
  buffer_load_dwordx4 a[16:19], v1, s[8:11], s46 offen offset:0 sc1
  buffer_load_dwordx4 a[20:23], v1, s[8:11], s46 offen offset:1024 sc1
  buffer_load_dwordx4 a[24:27], v1, s[8:11], s46 offen offset:2048 sc1
  buffer_load_dwordx4 a[28:31], v1, s[8:11], s46 offen offset:3072 sc1
  s_add_u32 s46, s63, 32768
  buffer_load_dwordx4 a[32:35], v1, s[8:11], s46 offen offset:0 sc1
  buffer_load_dwordx4 a[36:39], v1, s[8:11], s46 offen offset:1024 sc1
  buffer_load_dwordx4 a[40:43], v1, s[8:11], s46 offen offset:2048 sc1
  buffer_load_dwordx4 a[44:47], v1, s[8:11], s46 offen offset:3072 sc1
  s_add_u32 s46, s63, 36864
  buffer_load_dwordx4 a[48:51], v1, s[8:11], s46 offen offset:0 sc1
  buffer_load_dwordx4 a[52:55], v1, s[8:11], s46 offen offset:1024 sc1
  buffer_load_dwordx4 a[56:59], v1, s[8:11], s46 offen offset:2048 sc1
  buffer_load_dwordx4 a[60:63], v1, s[8:11], s46 offen offset:3072 sc1
  s_add_u32 s46, s63, 65536
  buffer_load_dwordx4 a[64:67], v1, s[8:11], s46 offen offset:0 sc1
  buffer_load_dwordx4 a[68:71], v1, s[8:11], s46 offen offset:1024 sc1
  buffer_load_dwordx4 a[72:75], v1, s[8:11], s46 offen offset:2048 sc1
  buffer_load_dwordx4 a[76:79], v1, s[8:11], s46 offen offset:3072 sc1
  s_add_u32 s46, s63, 69632
  buffer_load_dwordx4 a[80:83], v1, s[8:11], s46 offen offset:0 sc1
  buffer_load_dwordx4 a[84:87], v1, s[8:11], s46 offen offset:1024 sc1
  buffer_load_dwordx4 a[88:91], v1, s[8:11], s46 offen offset:2048 sc1
  buffer_load_dwordx4 a[92:95], v1, s[8:11], s46 offen offset:3072 sc1
  s_add_u32 s46, s63, 98304
  buffer_load_dwordx4 a[96:99], v1, s[8:11], s46 offen offset:0 sc1
  buffer_load_dwordx4 a[100:103], v1, s[8:11], s46 offen offset:1024 sc1
  buffer_load_dwordx4 a[104:107], v1, s[8:11], s46 offen offset:2048 sc1
  buffer_load_dwordx4 a[108:111], v1, s[8:11], s46 offen offset:3072 sc1
  s_add_u32 s46, s63, 102400
  buffer_load_dwordx4 a[112:115], v1, s[8:11], s46 offen offset:0 sc1
  buffer_load_dwordx4 a[116:119], v1, s[8:11], s46 offen offset:1024 sc1
  buffer_load_dwordx4 a[120:123], v1, s[8:11], s46 offen offset:2048 sc1
  buffer_load_dwordx4 a[124:127], v1, s[8:11], s46 offen offset:3072 sc1
  s_add_u32 s46, s63, 131072
  buffer_load_dwordx4 a[128:131], v1, s[8:11], s46 offen offset:0 sc1
  buffer_load_dwordx4 a[132:135], v1, s[8:11], s46 offen offset:1024 sc1
  buffer_load_dwordx4 a[136:139], v1, s[8:11], s46 offen offset:2048 sc1
  buffer_load_dwordx4 a[140:143], v1, s[8:11], s46 offen offset:3072 sc1
  s_add_u32 s46, s63, 135168
  buffer_load_dwordx4 a[144:147], v1, s[8:11], s46 offen offset:0 sc1
  buffer_load_dwordx4 a[148:151], v1, s[8:11], s46 offen offset:1024 sc1
  buffer_load_dwordx4 a[152:155], v1, s[8:11], s46 offen offset:2048 sc1
  buffer_load_dwordx4 a[156:159], v1, s[8:11], s46 offen offset:3072 sc1
  s_waitcnt vmcnt(24)
  s_cmp_ge_u32 s61, s53
  s_cbranch_scc1 wf_done_44
  s_mov_b32 s50, 0
wf_loop_45:
  buffer_load_dword v10, v3, s[8:11], 0 offen sc1
  s_add_u32 s50, s50, 1
  s_cmp_gt_u32 s50, 2097152
  s_cbranch_scc1 L_fail
  s_waitcnt vmcnt(0)
  v_min_u32_dpp v10, v10, v10 row_ror:8 row_mask:0xf bank_mask:0xf
  s_nop 1
  v_min_u32_dpp v10, v10, v10 row_ror:4 row_mask:0xf bank_mask:0xf
  s_nop 1
  v_min_u32_dpp v10, v10, v10 row_ror:2 row_mask:0xf bank_mask:0xf
  s_nop 1
  v_min_u32_dpp v10, v10, v10 row_ror:1 row_mask:0xf bank_mask:0xf
  v_mov_b32 v11, v10
  s_nop 1
  v_permlane16_swap_b32 v11, v10
  v_min_u32 v10, v10, v11
  v_mov_b32 v11, v10
  s_nop 1
  v_permlane32_swap_b32 v11, v10
  v_min_u32 v10, v10, v11
  s_nop 0
  v_readfirstlane_b32 s61, v10
  s_nop 0
  s_cmp_lt_u32 s61, s53
  s_cbranch_scc1 wf_loop_45
wf_done_44:
  s_lshl_b32 s47, s42, 13
  s_add_u32 s47, s47, s65
  s_lshl_b32 s48, s42, 11
  s_add_u32 s48, s48, s65
  s_add_u32 s46, s47, 0
  buffer_load_dwordx4 v[56:59], v1, s[8:11], s46 offen sc1
  s_add_u32 s46, s47, 40960
  buffer_load_dwordx4 v[60:63], v1, s[8:11], s46 offen sc1
  s_add_u32 s46, s47, 1024
  buffer_load_dwordx4 v[64:67], v1, s[8:11], s46 offen sc1
  s_add_u32 s46, s47, 41984
  buffer_load_dwordx4 v[68:71], v1, s[8:11], s46 offen sc1
  s_add_u32 s46, s47, 2048
  buffer_load_dwordx4 v[72:75], v1, s[8:11], s46 offen sc1
  s_add_u32 s46, s47, 43008
  buffer_load_dwordx4 v[76:79], v1, s[8:11], s46 offen sc1
  s_add_u32 s46, s47, 3072
  buffer_load_dwordx4 v[80:83], v1, s[8:11], s46 offen sc1
  s_add_u32 s46, s47, 44032
  buffer_load_dwordx4 v[84:87], v1, s[8:11], s46 offen sc1
  s_add_u32 s46, s47, 4096
  buffer_load_dwordx4 v[88:91], v1, s[8:11], s46 offen sc1
  s_add_u32 s46, s47, 45056
  buffer_load_dwordx4 v[92:95], v1, s[8:11], s46 offen sc1
  s_add_u32 s46, s47, 5120
  buffer_load_dwordx4 v[96:99], v1, s[8:11], s46 offen sc1
  s_add_u32 s46, s47, 46080
  buffer_load_dwordx4 v[100:103], v1, s[8:11], s46 offen sc1
  s_add_u32 s46, s47, 6144
  buffer_load_dwordx4 v[104:107], v1, s[8:11], s46 offen sc1
  s_add_u32 s46, s47, 47104
  buffer_load_dwordx4 v[108:111], v1, s[8:11], s46 offen sc1
  s_add_u32 s46, s47, 7168
  buffer_load_dwordx4 v[112:115], v1, s[8:11], s46 offen sc1
  s_add_u32 s46, s47, 48128
  buffer_load_dwordx4 v[116:119], v1, s[8:11], s46 offen sc1
  s_add_u32 s46, s48, 32768
  buffer_load_dwordx4 v[120:123], v1, s[8:11], s46 offen sc1
  s_add_u32 s46, s48, 73728
  buffer_load_dwordx4 v[124:127], v1, s[8:11], s46 offen sc1
  s_add_u32 s46, s48, 33792
  buffer_load_dwordx4 v[128:131], v1, s[8:11], s46 offen sc1
  s_add_u32 s46, s48, 74752
  buffer_load_dwordx4 v[132:135], v1, s[8:11], s46 offen sc1
  s_add_u32 s46, s64, 0
  buffer_load_dwordx4 v[16:19], v1, s[8:11], s46 offen offset:0 sc1
  buffer_load_dwordx4 v[20:23], v1, s[8:11], s46 offen offset:1024 sc1
  s_add_u32 s46, s64, 8192
  buffer_load_dwordx4 v[24:27], v1, s[8:11], s46 offen offset:0 sc1
  buffer_load_dwordx4 v[28:31], v1, s[8:11], s46 offen offset:1024 sc1
  s_add_u32 s46, s64, 16384
  buffer_load_dwordx4 v[32:35], v1, s[8:11], s46 offen offset:0 sc1
  buffer_load_dwordx4 v[36:39], v1, s[8:11], s46 offen offset:1024 sc1
  s_add_u32 s46, s64, 24576
  buffer_load_dwordx4 v[40:43], v1, s[8:11], s46 offen offset:0 sc1
  buffer_load_dwordx4 v[44:47], v1, s[8:11], s46 offen offset:1024 sc1
  s_add_u32 s46, s64, 32768
  buffer_load_dwordx4 v[48:51], v1, s[8:11], s46 offen offset:0 sc1
  buffer_load_dwordx4 v[52:55], v1, s[8:11], s46 offen offset:1024 sc1
  s_waitcnt vmcnt(29)
  v_mfma_f32_16x16x32_bf16 v[136:139], a[0:3], v[56:59], 0
  v_mfma_f32_16x16x32_bf16 v[140:143], a[32:35], v[56:59], 0
  v_mfma_f32_16x16x32_bf16 v[144:147], a[64:67], v[56:59], 0
  v_mfma_f32_16x16x32_bf16 v[148:151], a[96:99], v[56:59], 0
  v_mfma_f32_16x16x32_bf16 v[152:155], a[128:131], v[56:59], 0
  s_waitcnt vmcnt(28)
  v_mfma_f32_16x16x32_bf16 v[156:159], a[0:3], v[60:63], 0
  v_mfma_f32_16x16x32_bf16 v[160:163], a[32:35], v[60:63], 0
  v_mfma_f32_16x16x32_bf16 v[164:167], a[64:67], v[60:63], 0
  v_mfma_f32_16x16x32_bf16 v[168:171], a[96:99], v[60:63], 0
  v_mfma_f32_16x16x32_bf16 v[172:175], a[128:131], v[60:63], 0
  s_waitcnt vmcnt(27)
  v_mfma_f32_16x16x32_bf16 v[136:139], a[4:7], v[64:67], v[136:139]
  v_mfma_f32_16x16x32_bf16 v[140:143], a[36:39], v[64:67], v[140:143]
  v_mfma_f32_16x16x32_bf16 v[144:147], a[68:71], v[64:67], v[144:147]
  v_mfma_f32_16x16x32_bf16 v[148:151], a[100:103], v[64:67], v[148:151]
  v_mfma_f32_16x16x32_bf16 v[152:155], a[132:135], v[64:67], v[152:155]
  s_waitcnt vmcnt(26)
  v_mfma_f32_16x16x32_bf16 v[156:159], a[4:7], v[68:71], v[156:159]
  v_mfma_f32_16x16x32_bf16 v[160:163], a[36:39], v[68:71], v[160:163]
  v_mfma_f32_16x16x32_bf16 v[164:167], a[68:71], v[68:71], v[164:167]
  v_mfma_f32_16x16x32_bf16 v[168:171], a[100:103], v[68:71], v[168:171]
  v_mfma_f32_16x16x32_bf16 v[172:175], a[132:135], v[68:71], v[172:175]
  s_waitcnt vmcnt(25)
  v_mfma_f32_16x16x32_bf16 v[136:139], a[8:11], v[72:75], v[136:139]
  v_mfma_f32_16x16x32_bf16 v[140:143], a[40:43], v[72:75], v[140:143]
  v_mfma_f32_16x16x32_bf16 v[144:147], a[72:75], v[72:75], v[144:147]
  v_mfma_f32_16x16x32_bf16 v[148:151], a[104:107], v[72:75], v[148:151]
  v_mfma_f32_16x16x32_bf16 v[152:155], a[136:139], v[72:75], v[152:155]
  s_waitcnt vmcnt(24)
  v_mfma_f32_16x16x32_bf16 v[156:159], a[8:11], v[76:79], v[156:159]
  v_mfma_f32_16x16x32_bf16 v[160:163], a[40:43], v[76:79], v[160:163]
  v_mfma_f32_16x16x32_bf16 v[164:167], a[72:75], v[76:79], v[164:167]
  v_mfma_f32_16x16x32_bf16 v[168:171], a[104:107], v[76:79], v[168:171]
  v_mfma_f32_16x16x32_bf16 v[172:175], a[136:139], v[76:79], v[172:175]
  s_waitcnt vmcnt(23)
  v_mfma_f32_16x16x32_bf16 v[136:139], a[12:15], v[80:83], v[136:139]
  v_mfma_f32_16x16x32_bf16 v[140:143], a[44:47], v[80:83], v[140:143]
  v_mfma_f32_16x16x32_bf16 v[144:147], a[76:79], v[80:83], v[144:147]
  v_mfma_f32_16x16x32_bf16 v[148:151], a[108:111], v[80:83], v[148:151]
  v_mfma_f32_16x16x32_bf16 v[152:155], a[140:143], v[80:83], v[152:155]
  s_waitcnt vmcnt(22)
  v_mfma_f32_16x16x32_bf16 v[156:159], a[12:15], v[84:87], v[156:159]
  v_mfma_f32_16x16x32_bf16 v[160:163], a[44:47], v[84:87], v[160:163]
  v_mfma_f32_16x16x32_bf16 v[164:167], a[76:79], v[84:87], v[164:167]
  v_mfma_f32_16x16x32_bf16 v[168:171], a[108:111], v[84:87], v[168:171]
  v_mfma_f32_16x16x32_bf16 v[172:175], a[140:143], v[84:87], v[172:175]
  s_waitcnt vmcnt(21)
  v_mfma_f32_16x16x32_bf16 v[136:139], a[16:19], v[88:91], v[136:139]
  v_mfma_f32_16x16x32_bf16 v[140:143], a[48:51], v[88:91], v[140:143]
  v_mfma_f32_16x16x32_bf16 v[144:147], a[80:83], v[88:91], v[144:147]
  v_mfma_f32_16x16x32_bf16 v[148:151], a[112:115], v[88:91], v[148:151]
  v_mfma_f32_16x16x32_bf16 v[152:155], a[144:147], v[88:91], v[152:155]
  s_waitcnt vmcnt(20)
  v_mfma_f32_16x16x32_bf16 v[156:159], a[16:19], v[92:95], v[156:159]
  v_mfma_f32_16x16x32_bf16 v[160:163], a[48:51], v[92:95], v[160:163]
  v_mfma_f32_16x16x32_bf16 v[164:167], a[80:83], v[92:95], v[164:167]
  v_mfma_f32_16x16x32_bf16 v[168:171], a[112:115], v[92:95], v[168:171]
  v_mfma_f32_16x16x32_bf16 v[172:175], a[144:147], v[92:95], v[172:175]
  s_waitcnt vmcnt(19)
  v_mfma_f32_16x16x32_bf16 v[136:139], a[20:23], v[96:99], v[136:139]
  v_mfma_f32_16x16x32_bf16 v[140:143], a[52:55], v[96:99], v[140:143]
  v_mfma_f32_16x16x32_bf16 v[144:147], a[84:87], v[96:99], v[144:147]
  v_mfma_f32_16x16x32_bf16 v[148:151], a[116:119], v[96:99], v[148:151]
  v_mfma_f32_16x16x32_bf16 v[152:155], a[148:151], v[96:99], v[152:155]
  s_waitcnt vmcnt(18)
  v_mfma_f32_16x16x32_bf16 v[156:159], a[20:23], v[100:103], v[156:159]
  v_mfma_f32_16x16x32_bf16 v[160:163], a[52:55], v[100:103], v[160:163]
  v_mfma_f32_16x16x32_bf16 v[164:167], a[84:87], v[100:103], v[164:167]
  v_mfma_f32_16x16x32_bf16 v[168:171], a[116:119], v[100:103], v[168:171]
  v_mfma_f32_16x16x32_bf16 v[172:175], a[148:151], v[100:103], v[172:175]
  s_waitcnt vmcnt(17)
  v_mfma_f32_16x16x32_bf16 v[136:139], a[24:27], v[104:107], v[136:139]
  v_mfma_f32_16x16x32_bf16 v[140:143], a[56:59], v[104:107], v[140:143]
  v_mfma_f32_16x16x32_bf16 v[144:147], a[88:91], v[104:107], v[144:147]
  v_mfma_f32_16x16x32_bf16 v[148:151], a[120:123], v[104:107], v[148:151]
  v_mfma_f32_16x16x32_bf16 v[152:155], a[152:155], v[104:107], v[152:155]
  s_waitcnt vmcnt(16)
  v_mfma_f32_16x16x32_bf16 v[156:159], a[24:27], v[108:111], v[156:159]
  v_mfma_f32_16x16x32_bf16 v[160:163], a[56:59], v[108:111], v[160:163]
  v_mfma_f32_16x16x32_bf16 v[164:167], a[88:91], v[108:111], v[164:167]
  v_mfma_f32_16x16x32_bf16 v[168:171], a[120:123], v[108:111], v[168:171]
  v_mfma_f32_16x16x32_bf16 v[172:175], a[152:155], v[108:111], v[172:175]
  s_waitcnt vmcnt(15)
  v_mfma_f32_16x16x32_bf16 v[136:139], a[28:31], v[112:115], v[136:139]
  v_mfma_f32_16x16x32_bf16 v[140:143], a[60:63], v[112:115], v[140:143]
  v_mfma_f32_16x16x32_bf16 v[144:147], a[92:95], v[112:115], v[144:147]
  v_mfma_f32_16x16x32_bf16 v[148:151], a[124:127], v[112:115], v[148:151]
  v_mfma_f32_16x16x32_bf16 v[152:155], a[156:159], v[112:115], v[152:155]
  s_waitcnt vmcnt(14)
  v_mfma_f32_16x16x32_bf16 v[156:159], a[28:31], v[116:119], v[156:159]
  v_mfma_f32_16x16x32_bf16 v[160:163], a[60:63], v[116:119], v[160:163]
  v_mfma_f32_16x16x32_bf16 v[164:167], a[92:95], v[116:119], v[164:167]
  v_mfma_f32_16x16x32_bf16 v[168:171], a[124:127], v[116:119], v[168:171]
  v_mfma_f32_16x16x32_bf16 v[172:175], a[156:159], v[116:119], v[172:175]
  s_waitcnt vmcnt(8)
  v_mfma_f32_16x16x32_bf16 v[136:139], v[16:19], v[120:123], v[136:139]
  v_mfma_f32_16x16x32_bf16 v[156:159], v[16:19], v[124:127], v[156:159]
  v_mfma_f32_16x16x32_bf16 v[136:139], v[20:23], v[128:131], v[136:139]
  v_mfma_f32_16x16x32_bf16 v[156:159], v[20:23], v[132:135], v[156:159]
  s_waitcnt vmcnt(6)
  v_mfma_f32_16x16x32_bf16 v[140:143], v[24:27], v[120:123], v[140:143]
  v_mfma_f32_16x16x32_bf16 v[160:163], v[24:27], v[124:127], v[160:163]
  v_mfma_f32_16x16x32_bf16 v[140:143], v[28:31], v[128:131], v[140:143]
  v_mfma_f32_16x16x32_bf16 v[160:163], v[28:31], v[132:135], v[160:163]
  s_waitcnt vmcnt(4)
  v_mfma_f32_16x16x32_bf16 v[144:147], v[32:35], v[120:123], v[144:147]
  v_mfma_f32_16x16x32_bf16 v[164:167], v[32:35], v[124:127], v[164:167]
  v_mfma_f32_16x16x32_bf16 v[144:147], v[36:39], v[128:131], v[144:147]
  v_mfma_f32_16x16x32_bf16 v[164:167], v[36:39], v[132:135], v[164:167]
  s_waitcnt vmcnt(2)
  v_mfma_f32_16x16x32_bf16 v[148:151], v[40:43], v[120:123], v[148:151]
  v_mfma_f32_16x16x32_bf16 v[168:171], v[40:43], v[124:127], v[168:171]
  v_mfma_f32_16x16x32_bf16 v[148:151], v[44:47], v[128:131], v[148:151]
  v_mfma_f32_16x16x32_bf16 v[168:171], v[44:47], v[132:135], v[168:171]
  s_waitcnt vmcnt(0)
  v_mfma_f32_16x16x32_bf16 v[152:155], v[48:51], v[120:123], v[152:155]
  v_mfma_f32_16x16x32_bf16 v[172:175], v[48:51], v[124:127], v[172:175]
  v_mfma_f32_16x16x32_bf16 v[152:155], v[52:55], v[128:131], v[152:155]
  v_mfma_f32_16x16x32_bf16 v[172:175], v[52:55], v[132:135], v[172:175]
  s_barrier
  ds_write_b128 v5, v[136:139] offset:0
  ds_write_b128 v5, v[140:143] offset:1024
  ds_write_b128 v5, v[144:147] offset:2048
  ds_write_b128 v5, v[148:151] offset:3072
  s_nop 1
  ds_write_b128 v5, v[152:155] offset:4096
  ds_write_b128 v5, v[156:159] offset:5120
  ds_write_b128 v5, v[160:163] offset:6144
  ds_write_b128 v5, v[164:167] offset:7168
  ds_write_b128 v5, v[168:171] offset:8192
  ds_write_b128 v5, v[172:175] offset:9216
  s_waitcnt lgkmcnt(0)
  s_barrier
  ds_read_b128 v[176:179], v6 offset:0
  ds_read_b128 v[180:183], v6 offset:10240
  ds_read_b128 v[184:187], v6 offset:20480
  ds_read_b128 v[188:191], v6 offset:30720
  ds_read_b128 v[192:195], v6 offset:4096
  ds_read_b128 v[196:199], v6 offset:14336
  ds_read_b128 v[200:203], v6 offset:24576
  ds_read_b128 v[204:207], v6 offset:34816
  ds_read_b128 v[208:211], v6 offset:8192
  ds_read_b128 v[212:215], v6 offset:18432
  ds_read_b128 v[216:219], v6 offset:28672
  ds_read_b128 v[220:223], v6 offset:38912
  s_waitcnt lgkmcnt(8)
  v_add_f32 v176, v176, v180
  v_add_f32 v184, v184, v188
  v_add_f32 v176, v176, v184
  v_add_f32 v177, v177, v181
  v_add_f32 v185, v185, v189
  v_add_f32 v177, v177, v185
  v_add_f32 v178, v178, v182
  v_add_f32 v186, v186, v190
  v_add_f32 v178, v178, v186
  v_add_f32 v179, v179, v183
  v_add_f32 v187, v187, v191
  v_add_f32 v179, v179, v187
  v_cvt_pk_bf16_f32 v176, v176, v177
  v_cvt_pk_bf16_f32 v177, v178, v179
  buffer_store_dwordx2 v[176:177], v7, s[12:15], s66 offen
  s_waitcnt lgkmcnt(4)
  v_add_f32 v192, v192, v196
  v_add_f32 v200, v200, v204
  v_add_f32 v192, v192, v200
  v_add_f32 v193, v193, v197
  v_add_f32 v201, v201, v205
  v_add_f32 v193, v193, v201
  v_add_f32 v194, v194, v198
  v_add_f32 v202, v202, v206
  v_add_f32 v194, v194, v202
  v_add_f32 v195, v195, v199
  v_add_f32 v203, v203, v207
  v_add_f32 v195, v195, v203
  v_cvt_pk_bf16_f32 v192, v192, v193
  v_cvt_pk_bf16_f32 v193, v194, v195
  buffer_store_dwordx2 v[192:193], v8, s[12:15], s66 offen
  s_waitcnt lgkmcnt(0)
  v_add_f32 v208, v208, v212
  v_add_f32 v216, v216, v220
  v_add_f32 v208, v208, v216
  v_add_f32 v209, v209, v213
  v_add_f32 v217, v217, v221
  v_add_f32 v209, v209, v217
  v_add_f32 v210, v210, v214
  v_add_f32 v218, v218, v222
  v_add_f32 v210, v210, v218
  v_add_f32 v211, v211, v215
  v_add_f32 v219, v219, v223
  v_add_f32 v211, v211, v219
  v_cvt_pk_bf16_f32 v208, v208, v209
  v_cvt_pk_bf16_f32 v209, v210, v211
  buffer_store_dwordx2 v[208:209], v9, s[12:15], s66 offen
  s_add_u32 s63, s63, 2621440
  s_add_u32 s64, s64, 655360
  s_add_u32 s65, s65, 163840
  s_add_u32 s66, s66, 163840
  s_add_u32 s52, s52, 2
  s_cmp_lt_u32 s52, 64
  s_cbranch_scc1 xo_loop
  s_endpgm
L_end:
  s_endpgm
L_fail:
  s_mov_b32 s4, s38
  s_mov_b32 s5, s39
  s_mov_b32 s6, 256
  s_mov_b32 s7, 0x20000
  s_lshl_b32 s46, s43, 8
  s_or_b32 s46, s46, s44
  s_or_b32 s46, s46, 0x10000
  v_mov_b32 v1, 32
  v_mov_b32 v2, s46
  s_mov_b64 exec, 1
  buffer_store_dword v2, v1, s[4:7], 0 offen sc1
  s_waitcnt vmcnt(0)
  s_endpgm
.section .rodata,"a"
.p2align 6
.amdhsa_kernel init_kernel
  .amdhsa_next_free_vgpr 32
  .amdhsa_next_free_sgpr 102
  .amdhsa_accum_offset 32
  .amdhsa_group_segment_fixed_size 0
  .amdhsa_kernarg_size 104
  .amdhsa_user_sgpr_count 2
  .amdhsa_user_sgpr_kernarg_segment_ptr 1
  .amdhsa_system_sgpr_workgroup_id_x 1
.end_amdhsa_kernel
.section .rodata,"a"
.p2align 6
.amdhsa_kernel concat_heads__sliding_local_dilated__memory_aug_recurrent_mem_tr__prompt_kernel
  .amdhsa_next_free_vgpr 512
  .amdhsa_next_free_sgpr 102
  .amdhsa_accum_offset 256
  .amdhsa_group_segment_fixed_size 0
  .amdhsa_kernarg_size 104
  .amdhsa_user_sgpr_count 2
  .amdhsa_user_sgpr_kernarg_segment_ptr 1
  .amdhsa_system_sgpr_workgroup_id_x 1
.end_amdhsa_kernel
```

```asm
; @launch kernel=init_kernel grid=(256,1,1) block=(256,1,1) lds=0
; @launch kernel=concat_heads__sliding_local_dilated__memory_aug_recurrent_mem_tr__prompt_kernel grid=(256,1,1) block=(256,1,1) lds=163840
.amdgcn_target "amdgcn-amd-amdhsa--gfx950"
.text
.globl init_kernel
.p2align 8
.type init_kernel,@function
init_kernel:
  s_cmp_ge_u32 s2, 256
  s_cbranch_scc1 L_init_end
  s_load_dwordx2 s[40:41], s[0:1], 96
  s_waitcnt lgkmcnt(0)
  s_add_u32 s8, s40, 0x1fffff
  s_addc_u32 s9, s41, 0
  s_and_b32 s8, s8, 0xffe00000
  s_mov_b32 s10, 266338304
  s_mov_b32 s11, 0x20000
  s_mul_i32 s3, s2, 12288
  v_lshlrev_b32 v1, 4, v0
  v_add_u32 v1, s3, v1
  v_cmp_gt_u32 vcc, 2883584, v1
  s_nop 1
  v_cndmask_b32 v4, 0, -1, vcc
  v_mov_b32 v5, v4
  v_mov_b32 v6, v4
  v_mov_b32 v7, v4
  buffer_store_dwordx4 v[4:7], v1, s[8:11], 0 offen sc1
  v_add_u32 v1, 4096, v1
  v_cmp_gt_u32 vcc, 2883584, v1
  s_nop 1
  v_cndmask_b32 v8, 0, -1, vcc
  v_mov_b32 v9, v8
  v_mov_b32 v10, v8
  v_mov_b32 v11, v8
  buffer_store_dwordx4 v[8:11], v1, s[8:11], 0 offen sc1
  v_add_u32 v1, 4096, v1
  v_cmp_gt_u32 vcc, 2883584, v1
  s_nop 1
  v_cndmask_b32 v12, 0, -1, vcc
  v_mov_b32 v13, v12
  v_mov_b32 v14, v12
  v_mov_b32 v15, v12
  buffer_store_dwordx4 v[12:15], v1, s[8:11], 0 offen sc1
  v_add_u32 v1, 4096, v1
  s_waitcnt vmcnt(0)
L_init_end:
  s_endpgm
.globl concat_heads__sliding_local_dilated__memory_aug_recurrent_mem_tr__prompt_kernel
.p2align 8
.type concat_heads__sliding_local_dilated__memory_aug_recurrent_mem_tr__prompt_kernel,@function
concat_heads__sliding_local_dilated__memory_aug_recurrent_mem_tr__prompt_kernel:
  s_cmp_ge_u32 s2, 256
  s_cbranch_scc1 L_end
  s_load_dwordx16 s[16:31], s[0:1], 0
  s_load_dwordx8 s[32:39], s[0:1], 64
  s_load_dwordx2 s[40:41], s[0:1], 96
  v_lshrrev_b32 v1, 6, v0
  v_and_b32 v0, 63, v0
  v_readfirstlane_b32 s42, v1
  s_getreg_b32 s43, hwreg(HW_REG_XCC_ID)
  s_and_b32 s43, s43, 7
  s_lshl_b32 s51, s42, 10
  s_waitcnt lgkmcnt(0)
  s_add_u32 s8, s40, 0x1fffff
  s_addc_u32 s9, s41, 0
  s_and_b32 s8, s8, 0xffe00000
  s_mov_b32 s10, 266338304
  s_mov_b32 s11, 0x20000
  s_mov_b32 s4, s38
  s_mov_b32 s5, s39
  s_mov_b32 s6, 256
  s_mov_b32 s7, 0x20000
  s_mov_b32 s12, s22
  s_mov_b32 s13, s23
  s_mov_b32 s14, 2621440
  s_mov_b32 s15, 0x20000
  s_cmp_lg_u32 s42, 0
  s_cbranch_scc1 L_role_wait
  s_mov_b32 s47, 0
L_role_try:
  s_lshl_b32 s46, s43, 7
  s_add_u32 s46, s46, 3015680
  v_mov_b32 v1, s46
  v_mov_b32 v2, 1
  s_mov_b64 exec, 1
  buffer_atomic_add v2, v1, s[8:11], 0 offen sc0 sc1
  s_waitcnt vmcnt(0)
  s_mov_b64 exec, -1
  v_readfirstlane_b32 s44, v2
  s_nop 0
  s_cmp_lt_u32 s44, 32
  s_cbranch_scc1 L_role_got
  s_add_u32 s43, s43, 1
  s_and_b32 s43, s43, 7
  s_add_u32 s47, s47, 1
  s_cmp_lt_u32 s47, 8
  s_cbranch_scc1 L_role_try
  s_mov_b32 s43, 0
  s_mov_b32 s44, 32
L_role_got:
  s_lshl_b32 s46, s43, 8
  s_or_b32 s46, s46, s44
  v_mov_b32 v1, 0
  v_mov_b32 v2, s46
  ds_write_b32 v1, v2
  s_waitcnt lgkmcnt(0)
L_role_wait:
  s_barrier
  v_mov_b32 v1, 0
  ds_read_b32 v2, v1
  s_waitcnt lgkmcnt(0)
  v_readfirstlane_b32 s46, v2
  s_barrier
  s_lshr_b32 s43, s46, 8
  s_and_b32 s43, s43, 7
  s_and_b32 s44, s46, 63
  s_and_b32 s46, s44, 7
  s_lshl_b32 s46, s46, 2
  s_and_b32 s47, s43, 3
  s_add_u32 s45, s46, s47
  s_cmp_ge_u32 s44, 32
  s_cbranch_scc1 L_end
  s_cmp_lt_u32 s43, 4
  s_cbranch_scc1 L_recur
  s_cmp_ge_u32 s44, 24
  s_cbranch_scc1 L_uw
  s_lshr_b32 s48, s44, 3
  s_cmp_eq_u32 s48, 0
  s_cselect_b32 s4, s26, s28
  s_cselect_b32 s5, s27, s29
  s_cmp_eq_u32 s48, 2
  s_cselect_b32 s4, s30, s4
  s_cselect_b32 s5, s31, s5
  s_mov_b32 s6, 7864320
  s_mul_i32 s60, s45, 384
  s_mov_b32 s61, 0
  s_mov_b32 s62, 64
  s_mul_i32 s63, s48, 25165824
  s_mul_i32 s46, s45, 786432
  s_add_u32 s63, s63, s46
  s_add_u32 s63, s63, 8388608
  s_lshl_b32 s64, s48, 14
  s_lshl_b32 s46, s45, 7
  s_add_u32 s64, s64, s46
  s_add_u32 s64, s64, 2899968
  v_lshrrev_b32 v10, 3, v0
  v_lshrrev_b32 v11, 2, v10
  v_lshlrev_b32 v11, 3, v11
  v_and_b32 v1, 3, v10
  v_add_u32 v1, v1, v11
  s_and_b32 s46, s42, 1
  s_lshl_b32 s46, s46, 2
  s_lshr_b32 s47, s42, 1
  s_lshl_b32 s47, s47, 4
  s_add_u32 s46, s46, s47
  v_add_u32 v1, s46, v1
  v_mul_u32_u24 v1, 12288, v1
  v_lshrrev_b32 v10, 1, v10
  v_bfe_u32 v11, v0, 1, 2
  v_xor_b32 v10, v10, v11
  v_lshlrev_b32 v10, 5, v10
  v_and_b32 v11, 1, v0
  v_lshlrev_b32 v11, 4, v11
  v_add3_u32 v1, v1, v10, v11
  v_lshrrev_b32 v10, 5, v0
  v_lshlrev_b32 v2, 11, v10
  v_bfe_u32 v10, v0, 2, 3
  v_lshl_add_u32 v2, v10, 7, v2
  v_lshrrev_b32 v10, 1, v10
  v_xor_b32 v10, s42, v10
  v_lshl_add_u32 v2, v10, 5, v2
  v_and_b32 v10, 3, v0
  v_lshl_add_u32 v2, v10, 3, v2
  v_add_u32 v3, 0x10000, v2
  v_add_u32 v4, 0x20000, v2
  v_lshrrev_b32 v10, 3, v0
  s_lshl_b32 s46, s42, 3
  v_add_u32 v10, s46, v10
  v_mul_u32_u24 v5, 1280, v10
  v_bfe_u32 v10, v10, 1, 3
  v_and_b32 v11, 7, v0
  v_xor_b32 v10, v10, v11
  v_lshl_add_u32 v5, v10, 4, v5
  v_and_b32 v10, 15, v0
  v_lshlrev_b32 v6, 7, v10
  v_lshrrev_b32 v10, 1, v10
  v_lshrrev_b32 v11, 4, v0
  v_xor_b32 v10, v10, v11
  v_lshl_add_u32 v6, v10, 4, v6
  v_add_u32 v6, 122880, v6
  v_xor_b32 v7, 64, v6
  v_and_b32 v10, 15, v0
  v_lshlrev_b32 v8, 4, v10
  v_bfe_u32 v10, v0, 4, 1
  v_mul_u32_u24 v10, 6144, v10
  v_lshrrev_b32 v11, 5, v0
  v_lshlrev_b32 v11, 8, v11
  v_add3_u32 v8, v8, v10, v11
  s_lshl_b32 s46, s42, 9
  v_add_u32 v8, s46, v8
  v_mov_b32 v9, s64
  s_mov_b32 s52, s61
  s_mul_i32 s53, s52, 40960
  s_add_u32 s54, s51, 122880
  s_add_u32 m0, s54, 0
  s_nop 0
  buffer_load_dwordx4 v5, s[12:15], s53 offen offset:0 lds
  s_add_u32 m0, s54, 3968
  s_nop 0
  buffer_load_dwordx4 v5, s[12:15], s53 offen offset:128 lds
  s_add_u32 m0, s54, 7936
  s_nop 0
  buffer_load_dwordx4 v5, s[12:15], s53 offen offset:256 lds
  s_add_u32 m0, s54, 11904
  s_nop 0
  buffer_load_dwordx4 v5, s[12:15], s53 offen offset:384 lds
  s_add_u32 m0, s54, 15872
  s_nop 0
  buffer_load_dwordx4 v5, s[12:15], s53 offen offset:512 lds
  s_add_u32 m0, s54, 19840
  s_nop 0
  buffer_load_dwordx4 v5, s[12:15], s53 offen offset:640 lds
  s_add_u32 m0, s54, 23808
  s_nop 0
  buffer_load_dwordx4 v5, s[12:15], s53 offen offset:768 lds
  s_add_u32 m0, s54, 27776
  s_nop 0
  buffer_load_dwordx4 v5, s[12:15], s53 offen offset:896 lds
  s_add_u32 m0, s54, 31744
  s_nop 0
  buffer_load_dwordx4 v5, s[12:15], s53 offen offset:1024 lds
  s_add_u32 m0, s54, 35712
  s_nop 0
  buffer_load_dwordx4 v5, s[12:15], s53 offen offset:1152 lds
  s_add_u32 m0, s51, 0
  s_add_u32 s46, s60, 0
  buffer_load_dwordx4 v1, s[4:7], s46 offen lds
  s_add_u32 m0, s51, 4096
  s_add_u32 s46, s60, 128
  buffer_load_dwordx4 v1, s[4:7], s46 offen lds
  s_add_u32 m0, s51, 8192
  s_add_u32 s46, s60, 256
  buffer_load_dwordx4 v1, s[4:7], s46 offen lds
  s_add_u32 m0, s51, 12288
  s_add_u32 s46, s60, 393216
  buffer_load_dwordx4 v1, s[4:7], s46 offen lds
  s_add_u32 m0, s51, 16384
  s_add_u32 s46, s60, 393344
  buffer_load_dwordx4 v1, s[4:7], s46 offen lds
  s_add_u32 m0, s51, 20480
  s_add_u32 s46, s60, 393472
  buffer_load_dwordx4 v1, s[4:7], s46 offen lds
  s_add_u32 m0, s51, 24576
  s_add_u32 s46, s60, 786432
  buffer_load_dwordx4 v1, s[4:7], s46 offen lds
  s_add_u32 m0, s51, 28672
  s_add_u32 s46, s60, 786560
  buffer_load_dwordx4 v1, s[4:7], s46 offen lds
  s_add_u32 m0, s51, 32768
  s_add_u32 s46, s60, 786688
  buffer_load_dwordx4 v1, s[4:7], s46 offen lds
  s_add_u32 m0, s51, 36864
  s_add_u32 s46, s60, 1179648
  buffer_load_dwordx4 v1, s[4:7], s46 offen lds
  s_add_u32 m0, s51, 40960
  s_add_u32 s46, s60, 1179776
  buffer_load_dwordx4 v1, s[4:7], s46 offen lds
  s_add_u32 m0, s51, 45056
  s_add_u32 s46, s60, 1179904
  buffer_load_dwordx4 v1, s[4:7], s46 offen lds
  s_add_u32 m0, s51, 49152
  s_add_u32 s46, s60, 1572864
  buffer_load_dwordx4 v1, s[4:7], s46 offen lds
  s_add_u32 m0, s51, 53248
  s_add_u32 s46, s60, 1572992
  buffer_load_dwordx4 v1, s[4:7], s46 offen lds
  s_add_u32 m0, s51, 57344
  s_add_u32 s46, s60, 1573120
  buffer_load_dwordx4 v1, s[4:7], s46 offen lds
  s_add_u32 m0, s51, 61440
  s_add_u32 s46, s60, 1966080
  buffer_load_dwordx4 v1, s[4:7], s46 offen lds
  s_add_u32 m0, s51, 65536
  s_add_u32 s46, s60, 1966208
  buffer_load_dwordx4 v1, s[4:7], s46 offen lds
  s_add_u32 m0, s51, 69632
  s_add_u32 s46, s60, 1966336
  buffer_load_dwordx4 v1, s[4:7], s46 offen lds
  s_add_u32 m0, s51, 73728
  s_add_u32 s46, s60, 2359296
  buffer_load_dwordx4 v1, s[4:7], s46 offen lds
  s_add_u32 m0, s51, 77824
  s_add_u32 s46, s60, 2359424
  buffer_load_dwordx4 v1, s[4:7], s46 offen lds
  s_add_u32 m0, s51, 81920
  s_add_u32 s46, s60, 2359552
  buffer_load_dwordx4 v1, s[4:7], s46 offen lds
  s_add_u32 m0, s51, 86016
  s_add_u32 s46, s60, 2752512
  buffer_load_dwordx4 v1, s[4:7], s46 offen lds
  s_add_u32 m0, s51, 90112
  s_add_u32 s46, s60, 2752640
  buffer_load_dwordx4 v1, s[4:7], s46 offen lds
  s_add_u32 m0, s51, 94208
  s_add_u32 s46, s60, 2752768
  buffer_load_dwordx4 v1, s[4:7], s46 offen lds
  s_waitcnt vmcnt(18)
  s_barrier
  s_add_u32 m0, s51, 98304
  s_add_u32 s46, s60, 3145728
  buffer_load_dwordx4 v1, s[4:7], s46 offen lds
  s_add_u32 m0, s51, 102400
  s_add_u32 s46, s60, 3145856
  buffer_load_dwordx4 v1, s[4:7], s46 offen lds
  s_add_u32 m0, s51, 106496
  s_add_u32 s46, s60, 3145984
  buffer_load_dwordx4 v1, s[4:7], s46 offen lds
  s_add_u32 m0, s51, 110592
  s_add_u32 s46, s60, 3538944
  buffer_load_dwordx4 v1, s[4:7], s46 offen lds
  s_add_u32 m0, s51, 114688
  s_add_u32 s46, s60, 3539072
  buffer_load_dwordx4 v1, s[4:7], s46 offen lds
  s_add_u32 m0, s51, 118784
  s_add_u32 s46, s60, 3539200
  buffer_load_dwordx4 v1, s[4:7], s46 offen lds
  ds_read_b64_tr_b16 a[0:1], v2 offset:0
  ds_read_b64_tr_b16 a[2:3], v2 offset:1024
  ds_read_b64_tr_b16 a[4:5], v2 offset:4096
  ds_read_b64_tr_b16 a[6:7], v2 offset:5120
  ds_read_b64_tr_b16 a[8:9], v2 offset:8192
  ds_read_b64_tr_b16 a[10:11], v2 offset:9216
  ds_read_b64_tr_b16 a[12:13], v2 offset:12288
  ds_read_b64_tr_b16 a[14:15], v2 offset:13312
  ds_read_b64_tr_b16 a[16:17], v2 offset:16384
  ds_read_b64_tr_b16 a[18:19], v2 offset:17408
  ds_read_b64_tr_b16 a[20:21], v2 offset:20480
  ds_read_b64_tr_b16 a[22:23], v2 offset:21504
  s_waitcnt lgkmcnt(0)
  s_waitcnt vmcnt(18)
  s_barrier
  s_add_u32 m0, s51, 0
  s_add_u32 s46, s60, 3932160
  buffer_load_dwordx4 v1, s[4:7], s46 offen lds
  s_add_u32 m0, s51, 4096
  s_add_u32 s46, s60, 3932288
  buffer_load_dwordx4 v1, s[4:7], s46 offen lds
  s_add_u32 m0, s51, 8192
  s_add_u32 s46, s60, 3932416
  buffer_load_dwordx4 v1, s[4:7], s46 offen lds
  s_add_u32 m0, s51, 12288
  s_add_u32 s46, s60, 4325376
  buffer_load_dwordx4 v1, s[4:7], s46 offen lds
  s_add_u32 m0, s51, 16384
  s_add_u32 s46, s60, 4325504
  buffer_load_dwordx4 v1, s[4:7], s46 offen lds
  s_add_u32 m0, s51, 20480
  s_add_u32 s46, s60, 4325632
  buffer_load_dwordx4 v1, s[4:7], s46 offen lds
  ds_read_b64_tr_b16 a[24:25], v2 offset:24576
  ds_read_b64_tr_b16 a[26:27], v2 offset:25600
  ds_read_b64_tr_b16 a[28:29], v2 offset:28672
  ds_read_b64_tr_b16 a[30:31], v2 offset:29696
  ds_read_b64_tr_b16 a[32:33], v2 offset:32768
  ds_read_b64_tr_b16 a[34:35], v2 offset:33792
  ds_read_b64_tr_b16 a[36:37], v2 offset:36864
  ds_read_b64_tr_b16 a[38:39], v2 offset:37888
  ds_read_b64_tr_b16 a[40:41], v2 offset:40960
  ds_read_b64_tr_b16 a[42:43], v2 offset:41984
  ds_read_b64_tr_b16 a[44:45], v2 offset:45056
  ds_read_b64_tr_b16 a[46:47], v2 offset:46080
  s_waitcnt lgkmcnt(0)
  s_waitcnt vmcnt(18)
  s_barrier
  s_add_u32 m0, s51, 24576
  s_add_u32 s46, s60, 4718592
  buffer_load_dwordx4 v1, s[4:7], s46 offen lds
  s_add_u32 m0, s51, 28672
  s_add_u32 s46, s60, 4718720
  buffer_load_dwordx4 v1, s[4:7], s46 offen lds
  s_add_u32 m0, s51, 32768
  s_add_u32 s46, s60, 4718848
  buffer_load_dwordx4 v1, s[4:7], s46 offen lds
  s_add_u32 m0, s51, 36864
  s_add_u32 s46, s60, 5111808
  buffer_load_dwordx4 v1, s[4:7], s46 offen lds
  s_add_u32 m0, s51, 40960
  s_add_u32 s46, s60, 5111936
  buffer_load_dwordx4 v1, s[4:7], s46 offen lds
  s_add_u32 m0, s51, 45056
  s_add_u32 s46, s60, 5112064
  buffer_load_dwordx4 v1, s[4:7], s46 offen lds
  ds_read_b64_tr_b16 a[48:49], v2 offset:49152
  ds_read_b64_tr_b16 a[50:51], v2 offset:50176
  ds_read_b64_tr_b16 a[52:53], v2 offset:53248
  ds_read_b64_tr_b16 a[54:55], v2 offset:54272
  ds_read_b64_tr_b16 a[56:57], v2 offset:57344
  ds_read_b64_tr_b16 a[58:59], v2 offset:58368
  ds_read_b64_tr_b16 a[60:61], v2 offset:61440
  ds_read_b64_tr_b16 a[62:63], v2 offset:62464
  ds_read_b64_tr_b16 a[64:65], v3 offset:0
  ds_read_b64_tr_b16 a[66:67], v3 offset:1024
  ds_read_b64_tr_b16 a[68:69], v3 offset:4096
  ds_read_b64_tr_b16 a[70:71], v3 offset:5120
  s_waitcnt lgkmcnt(0)
  s_waitcnt vmcnt(18)
  s_barrier
  s_add_u32 m0, s51, 49152
  s_add_u32 s46, s60, 5505024
  buffer_load_dwordx4 v1, s[4:7], s46 offen lds
  s_add_u32 m0, s51, 53248
  s_add_u32 s46, s60, 5505152
  buffer_load_dwordx4 v1, s[4:7], s46 offen lds
  s_add_u32 m0, s51, 57344
  s_add_u32 s46, s60, 5505280
  buffer_load_dwordx4 v1, s[4:7], s46 offen lds
  s_add_u32 m0, s51, 61440
  s_add_u32 s46, s60, 5898240
  buffer_load_dwordx4 v1, s[4:7], s46 offen lds
  s_add_u32 m0, s51, 65536
  s_add_u32 s46, s60, 5898368
  buffer_load_dwordx4 v1, s[4:7], s46 offen lds
  s_add_u32 m0, s51, 69632
  s_add_u32 s46, s60, 5898496
  buffer_load_dwordx4 v1, s[4:7], s46 offen lds
  ds_read_b64_tr_b16 a[72:73], v3 offset:8192
  ds_read_b64_tr_b16 a[74:75], v3 offset:9216
  ds_read_b64_tr_b16 a[76:77], v3 offset:12288
  ds_read_b64_tr_b16 a[78:79], v3 offset:13312
  ds_read_b64_tr_b16 a[80:81], v3 offset:16384
  ds_read_b64_tr_b16 a[82:83], v3 offset:17408
  ds_read_b64_tr_b16 a[84:85], v3 offset:20480
  ds_read_b64_tr_b16 a[86:87], v3 offset:21504
  ds_read_b64_tr_b16 a[88:89], v3 offset:24576
  ds_read_b64_tr_b16 a[90:91], v3 offset:25600
  ds_read_b64_tr_b16 a[92:93], v3 offset:28672
  ds_read_b64_tr_b16 a[94:95], v3 offset:29696
  s_waitcnt lgkmcnt(0)
  s_waitcnt vmcnt(18)
  s_barrier
  s_add_u32 m0, s51, 73728
  s_add_u32 s46, s60, 6291456
  buffer_load_dwordx4 v1, s[4:7], s46 offen lds
  s_add_u32 m0, s51, 77824
  s_add_u32 s46, s60, 6291584
  buffer_load_dwordx4 v1, s[4:7], s46 offen lds
  s_add_u32 m0, s51, 81920
  s_add_u32 s46, s60, 6291712
  buffer_load_dwordx4 v1, s[4:7], s46 offen lds
  s_add_u32 m0, s51, 86016
  s_add_u32 s46, s60, 6684672
  buffer_load_dwordx4 v1, s[4:7], s46 offen lds
  s_add_u32 m0, s51, 90112
  s_add_u32 s46, s60, 6684800
  buffer_load_dwordx4 v1, s[4:7], s46 offen lds
  s_add_u32 m0, s51, 94208
  s_add_u32 s46, s60, 6684928
  buffer_load_dwordx4 v1, s[4:7], s46 offen lds
  ds_read_b64_tr_b16 a[96:97], v3 offset:32768
  ds_read_b64_tr_b16 a[98:99], v3 offset:33792
  ds_read_b64_tr_b16 a[100:101], v3 offset:36864
  ds_read_b64_tr_b16 a[102:103], v3 offset:37888
  ds_read_b64_tr_b16 a[104:105], v3 offset:40960
  ds_read_b64_tr_b16 a[106:107], v3 offset:41984
  ds_read_b64_tr_b16 a[108:109], v3 offset:45056
  ds_read_b64_tr_b16 a[110:111], v3 offset:46080
  ds_read_b64_tr_b16 a[112:113], v3 offset:49152
  ds_read_b64_tr_b16 a[114:115], v3 offset:50176
  ds_read_b64_tr_b16 a[116:117], v3 offset:53248
  ds_read_b64_tr_b16 a[118:119], v3 offset:54272
  s_waitcnt lgkmcnt(0)
  s_waitcnt vmcnt(18)
  s_barrier
  s_add_u32 m0, s51, 98304
  s_add_u32 s46, s60, 7077888
  buffer_load_dwordx4 v1, s[4:7], s46 offen lds
  s_add_u32 m0, s51, 102400
  s_add_u32 s46, s60, 7078016
  buffer_load_dwordx4 v1, s[4:7], s46 offen lds
  s_add_u32 m0, s51, 106496
  s_add_u32 s46, s60, 7078144
  buffer_load_dwordx4 v1, s[4:7], s46 offen lds
  s_add_u32 m0, s51, 110592
  s_add_u32 s46, s60, 7471104
  buffer_load_dwordx4 v1, s[4:7], s46 offen lds
  s_add_u32 m0, s51, 114688
  s_add_u32 s46, s60, 7471232
  buffer_load_dwordx4 v1, s[4:7], s46 offen lds
  s_add_u32 m0, s51, 118784
  s_add_u32 s46, s60, 7471360
  buffer_load_dwordx4 v1, s[4:7], s46 offen lds
  ds_read_b64_tr_b16 a[120:121], v2 offset:0
  ds_read_b64_tr_b16 a[122:123], v2 offset:1024
  ds_read_b64_tr_b16 a[124:125], v2 offset:4096
  ds_read_b64_tr_b16 a[126:127], v2 offset:5120
  ds_read_b64_tr_b16 a[128:129], v2 offset:8192
  ds_read_b64_tr_b16 a[130:131], v2 offset:9216
  ds_read_b64_tr_b16 a[132:133], v2 offset:12288
  ds_read_b64_tr_b16 a[134:135], v2 offset:13312
  ds_read_b64_tr_b16 a[136:137], v2 offset:16384
  ds_read_b64_tr_b16 a[138:139], v2 offset:17408
  ds_read_b64_tr_b16 a[140:141], v2 offset:20480
  ds_read_b64_tr_b16 a[142:143], v2 offset:21504
  s_waitcnt lgkmcnt(0)
  s_waitcnt vmcnt(18)
  s_barrier
  ds_read_b64_tr_b16 a[144:145], v2 offset:24576
  ds_read_b64_tr_b16 a[146:147], v2 offset:25600
  ds_read_b64_tr_b16 a[148:149], v2 offset:28672
  ds_read_b64_tr_b16 a[150:151], v2 offset:29696
  ds_read_b64_tr_b16 a[152:153], v2 offset:32768
  ds_read_b64_tr_b16 a[154:155], v2 offset:33792
  ds_read_b64_tr_b16 a[156:157], v2 offset:36864
  ds_read_b64_tr_b16 a[158:159], v2 offset:37888
  ds_read_b64_tr_b16 a[160:161], v2 offset:40960
  ds_read_b64_tr_b16 a[162:163], v2 offset:41984
  ds_read_b64_tr_b16 a[164:165], v2 offset:45056
  ds_read_b64_tr_b16 a[166:167], v2 offset:46080
  s_waitcnt lgkmcnt(0)
  s_waitcnt vmcnt(12)
  s_barrier
  ds_read_b64_tr_b16 a[168:169], v2 offset:49152
  ds_read_b64_tr_b16 a[170:171], v2 offset:50176
  ds_read_b64_tr_b16 a[172:173], v2 offset:53248
  ds_read_b64_tr_b16 a[174:175], v2 offset:54272
  ds_read_b64_tr_b16 a[176:177], v2 offset:57344
  ds_read_b64_tr_b16 a[178:179], v2 offset:58368
  ds_read_b64_tr_b16 a[180:181], v2 offset:61440
  ds_read_b64_tr_b16 a[182:183], v2 offset:62464
  ds_read_b64_tr_b16 a[184:185], v3 offset:0
  ds_read_b64_tr_b16 a[186:187], v3 offset:1024
  ds_read_b64_tr_b16 a[188:189], v3 offset:4096
  ds_read_b64_tr_b16 a[190:191], v3 offset:5120
  s_waitcnt lgkmcnt(0)
  s_waitcnt vmcnt(6)
  s_barrier
  ds_read_b64_tr_b16 a[192:193], v3 offset:8192
  ds_read_b64_tr_b16 a[194:195], v3 offset:9216
  ds_read_b64_tr_b16 a[196:197], v3 offset:12288
  ds_read_b64_tr_b16 a[198:199], v3 offset:13312
  ds_read_b64_tr_b16 a[200:201], v3 offset:16384
  ds_read_b64_tr_b16 a[202:203], v3 offset:17408
  ds_read_b64_tr_b16 a[204:205], v3 offset:20480
  ds_read_b64_tr_b16 a[206:207], v3 offset:21504
  ds_read_b64_tr_b16 a[208:209], v3 offset:24576
  ds_read_b64_tr_b16 a[210:211], v3 offset:25600
  ds_read_b64_tr_b16 a[212:213], v3 offset:28672
  ds_read_b64_tr_b16 a[214:215], v3 offset:29696
  s_waitcnt lgkmcnt(0)
  s_waitcnt vmcnt(0)
  s_barrier
  ds_read_b64_tr_b16 a[216:217], v3 offset:32768
  ds_read_b64_tr_b16 a[218:219], v3 offset:33792
  ds_read_b64_tr_b16 a[220:221], v3 offset:36864
  ds_read_b64_tr_b16 a[222:223], v3 offset:37888
  ds_read_b64_tr_b16 a[224:225], v3 offset:40960
  ds_read_b64_tr_b16 a[226:227], v3 offset:41984
  ds_read_b64_tr_b16 a[228:229], v3 offset:45056
  ds_read_b64_tr_b16 a[230:231], v3 offset:46080
  ds_read_b64_tr_b16 a[232:233], v3 offset:49152
  ds_read_b64_tr_b16 a[234:235], v3 offset:50176
  ds_read_b64_tr_b16 a[236:237], v3 offset:53248
  ds_read_b64_tr_b16 a[238:239], v3 offset:54272
  s_waitcnt lgkmcnt(0)
  s_barrier
pj_loop_1:
  s_add_u32 s57, s52, 1
  s_xor_b32 s54, s54, 122880
  s_add_u32 s53, s53, 40960
  ds_read_b128 v[16:19], v6 offset:0
  ds_read_b128 v[20:23], v6 offset:2048
  ds_read_b128 v[24:27], v7 offset:0
  ds_read_b128 v[28:31], v7 offset:2048
  ds_read_b128 v[32:35], v6 offset:4096
  s_waitcnt lgkmcnt(4)
  v_mfma_f32_16x16x32_bf16 v[40:43], a[0:3], v[16:19], 0
  s_add_u32 m0, s54, 0
  v_mfma_f32_16x16x32_bf16 v[48:51], a[4:7], v[16:19], 0
  buffer_load_dwordx4 v5, s[12:15], s53 offen offset:0 lds
  v_mfma_f32_16x16x32_bf16 v[56:59], a[8:11], v[16:19], 0
  ds_read_b128 v[36:39], v6 offset:6144
  s_waitcnt lgkmcnt(4)
  v_mfma_f32_16x16x32_bf16 v[44:47], a[0:3], v[20:23], 0
  v_mfma_f32_16x16x32_bf16 v[52:55], a[4:7], v[20:23], 0
  v_mfma_f32_16x16x32_bf16 v[60:63], a[8:11], v[20:23], 0
  ds_read_b128 v[16:19], v7 offset:4096
  s_waitcnt lgkmcnt(4)
  v_mfma_f32_16x16x32_bf16 v[40:43], a[12:15], v[24:27], v[40:43]
  s_add_u32 m0, s54, 3968
  v_mfma_f32_16x16x32_bf16 v[48:51], a[16:19], v[24:27], v[48:51]
  buffer_load_dwordx4 v5, s[12:15], s53 offen offset:128 lds
  v_mfma_f32_16x16x32_bf16 v[56:59], a[20:23], v[24:27], v[56:59]
  ds_read_b128 v[20:23], v7 offset:6144
  s_waitcnt lgkmcnt(4)
  v_mfma_f32_16x16x32_bf16 v[44:47], a[12:15], v[28:31], v[44:47]
  v_mfma_f32_16x16x32_bf16 v[52:55], a[16:19], v[28:31], v[52:55]
  v_mfma_f32_16x16x32_bf16 v[60:63], a[20:23], v[28:31], v[60:63]
  ds_read_b128 v[24:27], v6 offset:8192
  s_waitcnt lgkmcnt(4)
  v_mfma_f32_16x16x32_bf16 v[40:43], a[24:27], v[32:35], v[40:43]
  s_add_u32 m0, s54, 7936
  v_mfma_f32_16x16x32_bf16 v[48:51], a[28:31], v[32:35], v[48:51]
  buffer_load_dwordx4 v5, s[12:15], s53 offen offset:256 lds
  v_mfma_f32_16x16x32_bf16 v[56:59], a[32:35], v[32:35], v[56:59]
  ds_read_b128 v[28:31], v6 offset:10240
  s_waitcnt lgkmcnt(4)
  v_mfma_f32_16x16x32_bf16 v[44:47], a[24:27], v[36:39], v[44:47]
  v_mfma_f32_16x16x32_bf16 v[52:55], a[28:31], v[36:39], v[52:55]
  v_mfma_f32_16x16x32_bf16 v[60:63], a[32:35], v[36:39], v[60:63]
  ds_read_b128 v[32:35], v7 offset:8192
  s_waitcnt lgkmcnt(4)
  v_mfma_f32_16x16x32_bf16 v[40:43], a[36:39], v[16:19], v[40:43]
  s_add_u32 m0, s54, 11904
  v_mfma_f32_16x16x32_bf16 v[48:51], a[40:43], v[16:19], v[48:51]
  buffer_load_dwordx4 v5, s[12:15], s53 offen offset:384 lds
  v_mfma_f32_16x16x32_bf16 v[56:59], a[44:47], v[16:19], v[56:59]
  ds_read_b128 v[36:39], v7 offset:10240
  s_waitcnt lgkmcnt(4)
  v_mfma_f32_16x16x32_bf16 v[44:47], a[36:39], v[20:23], v[44:47]
  v_mfma_f32_16x16x32_bf16 v[52:55], a[40:43], v[20:23], v[52:55]
  v_mfma_f32_16x16x32_bf16 v[60:63], a[44:47], v[20:23], v[60:63]
  ds_read_b128 v[16:19], v6 offset:12288
  s_waitcnt lgkmcnt(4)
  v_mfma_f32_16x16x32_bf16 v[40:43], a[48:51], v[24:27], v[40:43]
  s_add_u32 m0, s54, 15872
  v_mfma_f32_16x16x32_bf16 v[48:51], a[52:55], v[24:27], v[48:51]
  buffer_load_dwordx4 v5, s[12:15], s53 offen offset:512 lds
  v_mfma_f32_16x16x32_bf16 v[56:59], a[56:59], v[24:27], v[56:59]
  ds_read_b128 v[20:23], v6 offset:14336
  s_waitcnt lgkmcnt(4)
  v_mfma_f32_16x16x32_bf16 v[44:47], a[48:51], v[28:31], v[44:47]
  v_mfma_f32_16x16x32_bf16 v[52:55], a[52:55], v[28:31], v[52:55]
  v_mfma_f32_16x16x32_bf16 v[60:63], a[56:59], v[28:31], v[60:63]
  ds_read_b128 v[24:27], v7 offset:12288
  s_waitcnt lgkmcnt(4)
  v_mfma_f32_16x16x32_bf16 v[40:43], a[60:63], v[32:35], v[40:43]
  s_add_u32 m0, s54, 19840
  v_mfma_f32_16x16x32_bf16 v[48:51], a[64:67], v[32:35], v[48:51]
  buffer_load_dwordx4 v5, s[12:15], s53 offen offset:640 lds
  v_mfma_f32_16x16x32_bf16 v[56:59], a[68:71], v[32:35], v[56:59]
  ds_read_b128 v[28:31], v7 offset:14336
  s_waitcnt lgkmcnt(4)
  v_mfma_f32_16x16x32_bf16 v[44:47], a[60:63], v[36:39], v[44:47]
  v_mfma_f32_16x16x32_bf16 v[52:55], a[64:67], v[36:39], v[52:55]
  v_mfma_f32_16x16x32_bf16 v[60:63], a[68:71], v[36:39], v[60:63]
  ds_read_b128 v[32:35], v6 offset:16384
  s_waitcnt lgkmcnt(4)
  v_mfma_f32_16x16x32_bf16 v[40:43], a[72:75], v[16:19], v[40:43]
  s_add_u32 m0, s54, 23808
  v_mfma_f32_16x16x32_bf16 v[48:51], a[76:79], v[16:19], v[48:51]
  buffer_load_dwordx4 v5, s[12:15], s53 offen offset:768 lds
  v_mfma_f32_16x16x32_bf16 v[56:59], a[80:83], v[16:19], v[56:59]
  ds_read_b128 v[36:39], v6 offset:18432
  s_waitcnt lgkmcnt(4)
  v_mfma_f32_16x16x32_bf16 v[44:47], a[72:75], v[20:23], v[44:47]
  v_mfma_f32_16x16x32_bf16 v[52:55], a[76:79], v[20:23], v[52:55]
  v_mfma_f32_16x16x32_bf16 v[60:63], a[80:83], v[20:23], v[60:63]
  ds_read_b128 v[16:19], v7 offset:16384
  s_waitcnt lgkmcnt(4)
  v_mfma_f32_16x16x32_bf16 v[40:43], a[84:87], v[24:27], v[40:43]
  s_add_u32 m0, s54, 27776
  v_mfma_f32_16x16x32_bf16 v[48:51], a[88:91], v[24:27], v[48:51]
  buffer_load_dwordx4 v5, s[12:15], s53 offen offset:896 lds
  v_mfma_f32_16x16x32_bf16 v[56:59], a[92:95], v[24:27], v[56:59]
  ds_read_b128 v[20:23], v7 offset:18432
  s_waitcnt lgkmcnt(4)
  v_mfma_f32_16x16x32_bf16 v[44:47], a[84:87], v[28:31], v[44:47]
  v_mfma_f32_16x16x32_bf16 v[52:55], a[88:91], v[28:31], v[52:55]
  v_mfma_f32_16x16x32_bf16 v[60:63], a[92:95], v[28:31], v[60:63]
  ds_read_b128 v[24:27], v6 offset:20480
  s_waitcnt lgkmcnt(4)
  v_mfma_f32_16x16x32_bf16 v[40:43], a[96:99], v[32:35], v[40:43]
  s_add_u32 m0, s54, 31744
  v_mfma_f32_16x16x32_bf16 v[48:51], a[100:103], v[32:35], v[48:51]
  buffer_load_dwordx4 v5, s[12:15], s53 offen offset:1024 lds
  v_mfma_f32_16x16x32_bf16 v[56:59], a[104:107], v[32:35], v[56:59]
  ds_read_b128 v[28:31], v6 offset:22528
  s_waitcnt lgkmcnt(4)
  v_mfma_f32_16x16x32_bf16 v[44:47], a[96:99], v[36:39], v[44:47]
  v_mfma_f32_16x16x32_bf16 v[52:55], a[100:103], v[36:39], v[52:55]
  v_mfma_f32_16x16x32_bf16 v[60:63], a[104:107], v[36:39], v[60:63]
  ds_read_b128 v[32:35], v7 offset:20480
  s_waitcnt lgkmcnt(4)
  v_mfma_f32_16x16x32_bf16 v[40:43], a[108:111], v[16:19], v[40:43]
  s_add_u32 m0, s54, 35712
  v_mfma_f32_16x16x32_bf16 v[48:51], a[112:115], v[16:19], v[48:51]
  buffer_load_dwordx4 v5, s[12:15], s53 offen offset:1152 lds
  v_mfma_f32_16x16x32_bf16 v[56:59], a[116:119], v[16:19], v[56:59]
  ds_read_b128 v[36:39], v7 offset:22528
  s_waitcnt lgkmcnt(4)
  v_mfma_f32_16x16x32_bf16 v[44:47], a[108:111], v[20:23], v[44:47]
  v_mfma_f32_16x16x32_bf16 v[52:55], a[112:115], v[20:23], v[52:55]
  v_mfma_f32_16x16x32_bf16 v[60:63], a[116:119], v[20:23], v[60:63]
  ds_read_b128 v[16:19], v6 offset:24576
  s_waitcnt lgkmcnt(4)
  v_mfma_f32_16x16x32_bf16 v[40:43], a[120:123], v[24:27], v[40:43]
  v_mfma_f32_16x16x32_bf16 v[48:51], a[124:127], v[24:27], v[48:51]
  v_mfma_f32_16x16x32_bf16 v[56:59], a[128:131], v[24:27], v[56:59]
  ds_read_b128 v[20:23], v6 offset:26624
  s_waitcnt lgkmcnt(4)
  v_mfma_f32_16x16x32_bf16 v[44:47], a[120:123], v[28:31], v[44:47]
  v_mfma_f32_16x16x32_bf16 v[52:55], a[124:127], v[28:31], v[52:55]
  v_mfma_f32_16x16x32_bf16 v[60:63], a[128:131], v[28:31], v[60:63]
  ds_read_b128 v[24:27], v7 offset:24576
  s_waitcnt lgkmcnt(4)
  v_mfma_f32_16x16x32_bf16 v[40:43], a[132:135], v[32:35], v[40:43]
  v_mfma_f32_16x16x32_bf16 v[48:51], a[136:139], v[32:35], v[48:51]
  v_mfma_f32_16x16x32_bf16 v[56:59], a[140:143], v[32:35], v[56:59]
  ds_read_b128 v[28:31], v7 offset:26624
  s_waitcnt lgkmcnt(4)
  v_mfma_f32_16x16x32_bf16 v[44:47], a[132:135], v[36:39], v[44:47]
  v_mfma_f32_16x16x32_bf16 v[52:55], a[136:139], v[36:39], v[52:55]
  v_mfma_f32_16x16x32_bf16 v[60:63], a[140:143], v[36:39], v[60:63]
  ds_read_b128 v[32:35], v6 offset:28672
  s_waitcnt lgkmcnt(4)
  v_mfma_f32_16x16x32_bf16 v[40:43], a[144:147], v[16:19], v[40:43]
  v_mfma_f32_16x16x32_bf16 v[48:51], a[148:151], v[16:19], v[48:51]
  v_mfma_f32_16x16x32_bf16 v[56:59], a[152:155], v[16:19], v[56:59]
  ds_read_b128 v[36:39], v6 offset:30720
  s_waitcnt lgkmcnt(4)
  v_mfma_f32_16x16x32_bf16 v[44:47], a[144:147], v[20:23], v[44:47]
  v_mfma_f32_16x16x32_bf16 v[52:55], a[148:151], v[20:23], v[52:55]
  v_mfma_f32_16x16x32_bf16 v[60:63], a[152:155], v[20:23], v[60:63]
  ds_read_b128 v[16:19], v7 offset:28672
  s_waitcnt lgkmcnt(4)
  v_mfma_f32_16x16x32_bf16 v[40:43], a[156:159], v[24:27], v[40:43]
  v_mfma_f32_16x16x32_bf16 v[48:51], a[160:163], v[24:27], v[48:51]
  v_mfma_f32_16x16x32_bf16 v[56:59], a[164:167], v[24:27], v[56:59]
  ds_read_b128 v[20:23], v7 offset:30720
  s_waitcnt lgkmcnt(4)
  v_mfma_f32_16x16x32_bf16 v[44:47], a[156:159], v[28:31], v[44:47]
  v_mfma_f32_16x16x32_bf16 v[52:55], a[160:163], v[28:31], v[52:55]
  v_mfma_f32_16x16x32_bf16 v[60:63], a[164:167], v[28:31], v[60:63]
  ds_read_b128 v[24:27], v6 offset:32768
  s_waitcnt lgkmcnt(4)
  v_mfma_f32_16x16x32_bf16 v[40:43], a[168:171], v[32:35], v[40:43]
  v_mfma_f32_16x16x32_bf16 v[48:51], a[172:175], v[32:35], v[48:51]
  v_mfma_f32_16x16x32_bf16 v[56:59], a[176:179], v[32:35], v[56:59]
  ds_read_b128 v[28:31], v6 offset:34816
  s_waitcnt lgkmcnt(4)
  v_mfma_f32_16x16x32_bf16 v[44:47], a[168:171], v[36:39], v[44:47]
  v_mfma_f32_16x16x32_bf16 v[52:55], a[172:175], v[36:39], v[52:55]
  v_mfma_f32_16x16x32_bf16 v[60:63], a[176:179], v[36:39], v[60:63]
  ds_read_b128 v[32:35], v7 offset:32768
  s_waitcnt lgkmcnt(4)
  v_mfma_f32_16x16x32_bf16 v[40:43], a[180:183], v[16:19], v[40:43]
  v_mfma_f32_16x16x32_bf16 v[48:51], a[184:187], v[16:19], v[48:51]
  v_mfma_f32_16x16x32_bf16 v[56:59], a[188:191], v[16:19], v[56:59]
  ds_read_b128 v[36:39], v7 offset:34816
  s_waitcnt lgkmcnt(4)
  v_mfma_f32_16x16x32_bf16 v[44:47], a[180:183], v[20:23], v[44:47]
  v_mfma_f32_16x16x32_bf16 v[52:55], a[184:187], v[20:23], v[52:55]
  v_mfma_f32_16x16x32_bf16 v[60:63], a[188:191], v[20:23], v[60:63]
  ds_read_b128 v[16:19], v6 offset:36864
  s_waitcnt lgkmcnt(4)
  v_mfma_f32_16x16x32_bf16 v[40:43], a[192:195], v[24:27], v[40:43]
  v_mfma_f32_16x16x32_bf16 v[48:51], a[196:199], v[24:27], v[48:51]
  v_mfma_f32_16x16x32_bf16 v[56:59], a[200:203], v[24:27], v[56:59]
  ds_read_b128 v[20:23], v6 offset:38912
  s_waitcnt lgkmcnt(4)
  v_mfma_f32_16x16x32_bf16 v[44:47], a[192:195], v[28:31], v[44:47]
  v_mfma_f32_16x16x32_bf16 v[52:55], a[196:199], v[28:31], v[52:55]
  v_mfma_f32_16x16x32_bf16 v[60:63], a[200:203], v[28:31], v[60:63]
  ds_read_b128 v[24:27], v7 offset:36864
  s_waitcnt lgkmcnt(4)
  v_mfma_f32_16x16x32_bf16 v[40:43], a[204:207], v[32:35], v[40:43]
  v_mfma_f32_16x16x32_bf16 v[48:51], a[208:211], v[32:35], v[48:51]
  v_mfma_f32_16x16x32_bf16 v[56:59], a[212:215], v[32:35], v[56:59]
  ds_read_b128 v[28:31], v7 offset:38912
  s_waitcnt lgkmcnt(4)
  v_mfma_f32_16x16x32_bf16 v[44:47], a[204:207], v[36:39], v[44:47]
  v_mfma_f32_16x16x32_bf16 v[52:55], a[208:211], v[36:39], v[52:55]
  v_mfma_f32_16x16x32_bf16 v[60:63], a[212:215], v[36:39], v[60:63]
  s_waitcnt lgkmcnt(3)
  v_mfma_f32_16x16x32_bf16 v[40:43], a[216:219], v[16:19], v[40:43]
  v_mfma_f32_16x16x32_bf16 v[48:51], a[220:223], v[16:19], v[48:51]
  v_mfma_f32_16x16x32_bf16 v[56:59], a[224:227], v[16:19], v[56:59]
  s_waitcnt lgkmcnt(2)
  v_mfma_f32_16x16x32_bf16 v[44:47], a[216:219], v[20:23], v[44:47]
  v_mfma_f32_16x16x32_bf16 v[52:55], a[220:223], v[20:23], v[52:55]
  v_mfma_f32_16x16x32_bf16 v[60:63], a[224:227], v[20:23], v[60:63]
  s_waitcnt lgkmcnt(1)
  v_mfma_f32_16x16x32_bf16 v[40:43], a[228:231], v[24:27], v[40:43]
  v_mfma_f32_16x16x32_bf16 v[48:51], a[232:235], v[24:27], v[48:51]
  v_mfma_f32_16x16x32_bf16 v[56:59], a[236:239], v[24:27], v[56:59]
  s_waitcnt lgkmcnt(0)
  v_mfma_f32_16x16x32_bf16 v[44:47], a[228:231], v[28:31], v[44:47]
  v_mfma_f32_16x16x32_bf16 v[52:55], a[232:235], v[28:31], v[52:55]
  v_mfma_f32_16x16x32_bf16 v[60:63], a[236:239], v[28:31], v[60:63]
  s_waitcnt vmcnt(0)
  s_barrier
  v_xor_b32 v6, 122880, v6
  v_xor_b32 v7, 122880, v7
  s_mul_i32 s55, s52, 12288
  s_add_u32 s55, s55, s63
  s_add_u32 s56, s55, 4096
  s_cmp_lg_u32 s42, 0
  s_cbranch_scc1 pj_noflag_3
  s_cmp_eq_u32 s52, s61
  s_cbranch_scc1 pj_noflag_3
  v_mov_b32 v10, s52
  s_mov_b64 exec, 1
  buffer_store_dword v10, v9, s[8:11], 0 offen sc1
  s_mov_b64 exec, -1
pj_noflag_3:
  v_cvt_pk_bf16_f32 v64, v40, v41
  v_cvt_pk_bf16_f32 v65, v42, v43
  v_cvt_pk_bf16_f32 v66, v44, v45
  v_cvt_pk_bf16_f32 v67, v46, v47
  v_cvt_pk_bf16_f32 v68, v48, v49
  v_cvt_pk_bf16_f32 v69, v50, v51
  v_cvt_pk_bf16_f32 v70, v52, v53
  v_cvt_pk_bf16_f32 v71, v54, v55
  v_cvt_pk_bf16_f32 v72, v56, v57
  v_cvt_pk_bf16_f32 v73, v58, v59
  v_cvt_pk_bf16_f32 v74, v60, v61
  v_cvt_pk_bf16_f32 v75, v62, v63
  v_permlane16_swap_b32 v64, v66
  v_permlane16_swap_b32 v65, v67
  buffer_store_dwordx4 v[64:67], v8, s[8:11], s55 offen offset:0 sc1
  v_permlane16_swap_b32 v68, v70
  v_permlane16_swap_b32 v69, v71
  buffer_store_dwordx4 v[68:71], v8, s[8:11], s55 offen offset:2048 sc1
  v_permlane16_swap_b32 v72, v74
  v_permlane16_swap_b32 v73, v75
  buffer_store_dwordx4 v[72:75], v8, s[8:11], s56 offen offset:0 sc1
  s_cmp_lg_u32 s52, s61
  s_cbranch_scc1 pj_noeag_4
  s_waitcnt vmcnt(0)
  s_barrier
  s_cmp_lg_u32 s42, 0
  s_cbranch_scc1 pj_noeag_4
  v_mov_b32 v10, s57
  s_mov_b64 exec, 1
  buffer_store_dword v10, v9, s[8:11], 0 offen sc1
  s_mov_b64 exec, -1
pj_noeag_4:
  s_mov_b32 s52, s57
  s_cmp_lt_u32 s52, s62
  s_cbranch_scc1 pj_loop_1
  s_waitcnt vmcnt(0)
  s_barrier
  s_cmp_lg_u32 s42, 0
  s_cbranch_scc1 pj_fin_5
  v_mov_b32 v10, s52
  s_mov_b64 exec, 1
  buffer_store_dword v10, v9, s[8:11], 0 offen sc1
  s_mov_b64 exec, -1
pj_fin_5:
  s_branch L_parta
L_uw:
  s_mov_b32 s4, s32
  s_mov_b32 s5, s33
  s_mov_b32 s6, 7864320
  s_mov_b32 s7, 0x20000
  v_lshrrev_b32 v8, 3, v0
  v_lshrrev_b32 v9, 2, v8
  v_lshlrev_b32 v9, 3, v9
  v_and_b32 v1, 3, v8
  v_add_u32 v1, v1, v9
  s_and_b32 s46, s42, 1
  s_lshl_b32 s46, s46, 2
  s_lshr_b32 s47, s42, 1
  s_lshl_b32 s47, s47, 4
  s_add_u32 s46, s46, s47
  v_add_u32 v1, s46, v1
  v_mul_u32_u24 v1, 1280, v1
  v_lshrrev_b32 v8, 1, v8
  v_bfe_u32 v9, v0, 1, 2
  v_xor_b32 v8, v8, v9
  v_lshlrev_b32 v8, 5, v8
  v_and_b32 v9, 1, v0
  v_lshlrev_b32 v9, 4, v9
  v_add3_u32 v1, v1, v8, v9
  v_lshrrev_b32 v8, 5, v0
  v_lshlrev_b32 v2, 11, v8
  v_bfe_u32 v8, v0, 2, 3
  v_lshl_add_u32 v2, v8, 7, v2
  v_lshrrev_b32 v8, 1, v8
  v_xor_b32 v8, s42, v8
  v_lshl_add_u32 v2, v8, 5, v2
  v_and_b32 v8, 3, v0
  v_lshl_add_u32 v2, v8, 3, v2
  v_add_u32 v3, 0x10000, v2
  v_add_u32 v4, 0x20000, v2
  s_mul_i32 s53, s45, 245760
  v_lshlrev_b32 v5, 4, v0
  s_lshl_b32 s46, s45, 7
  s_add_u32 s47, s46, 2932736
  v_mov_b32 v6, s47
  s_lshl_b32 s47, s42, 2
  s_add_u32 s46, s46, s47
  s_add_u32 s46, s46, 2949120
  v_mov_b32 v7, s46
  s_mul_i32 s54, s45, 786432
  s_add_u32 s54, s54, 58720256
  s_lshl_b32 s55, s45, 10
  s_lshl_b32 s46, s42, 15
  s_add_u32 s55, s55, s46
  s_add_u32 s55, s55, 83886080
  s_mov_b32 s52, 0
  s_mov_b32 s56, 0
  s_add_u32 m0, s51, 0
  s_add_u32 s46, s53, 0
  buffer_load_dwordx4 v1, s[4:7], s46 offen lds
  s_add_u32 m0, s51, 4096
  s_add_u32 s46, s53, 128
  buffer_load_dwordx4 v1, s[4:7], s46 offen lds
  s_add_u32 m0, s51, 8192
  s_add_u32 s46, s53, 256
  buffer_load_dwordx4 v1, s[4:7], s46 offen lds
  s_add_u32 m0, s51, 12288
  s_add_u32 s46, s53, 384
  buffer_load_dwordx4 v1, s[4:7], s46 offen lds
  s_add_u32 m0, s51, 16384
  s_add_u32 s46, s53, 512
  buffer_load_dwordx4 v1, s[4:7], s46 offen lds
  s_add_u32 m0, s51, 20480
  s_add_u32 s46, s53, 640
  buffer_load_dwordx4 v1, s[4:7], s46 offen lds
  s_add_u32 m0, s51, 24576
  s_add_u32 s46, s53, 768
  buffer_load_dwordx4 v1, s[4:7], s46 offen lds
  s_add_u32 m0, s51, 28672
  s_add_u32 s46, s53, 896
  buffer_load_dwordx4 v1, s[4:7], s46 offen lds
  s_add_u32 m0, s51, 32768
  s_add_u32 s46, s53, 1024
  buffer_load_dwordx4 v1, s[4:7], s46 offen lds
  s_add_u32 m0, s51, 36864
  s_add_u32 s46, s53, 1152
  buffer_load_dwordx4 v1, s[4:7], s46 offen lds
  s_add_u32 m0, s51, 40960
  s_add_u32 s46, s53, 40960
  buffer_load_dwordx4 v1, s[4:7], s46 offen lds
  s_add_u32 m0, s51, 45056
  s_add_u32 s46, s53, 41088
  buffer_load_dwordx4 v1, s[4:7], s46 offen lds
  s_add_u32 m0, s51, 49152
  s_add_u32 s46, s53, 41216
  buffer_load_dwordx4 v1, s[4:7], s46 offen lds
  s_add_u32 m0, s51, 53248
  s_add_u32 s46, s53, 41344
  buffer_load_dwordx4 v1, s[4:7], s46 offen lds
  s_add_u32 m0, s51, 57344
  s_add_u32 s46, s53, 41472
  buffer_load_dwordx4 v1, s[4:7], s46 offen lds
  s_add_u32 m0, s51, 61440
  s_add_u32 s46, s53, 41600
  buffer_load_dwordx4 v1, s[4:7], s46 offen lds
  s_add_u32 m0, s51, 65536
  s_add_u32 s46, s53, 41728
  buffer_load_dwordx4 v1, s[4:7], s46 offen lds
  s_add_u32 m0, s51, 69632
  s_add_u32 s46, s53, 41856
  buffer_load_dwordx4 v1, s[4:7], s46 offen lds
  s_add_u32 m0, s51, 73728
  s_add_u32 s46, s53, 41984
  buffer_load_dwordx4 v1, s[4:7], s46 offen lds
  s_add_u32 m0, s51, 77824
  s_add_u32 s46, s53, 42112
  buffer_load_dwordx4 v1, s[4:7], s46 offen lds
  s_add_u32 m0, s51, 81920
  s_add_u32 s46, s53, 81920
  buffer_load_dwordx4 v1, s[4:7], s46 offen lds
  s_add_u32 m0, s51, 86016
  s_add_u32 s46, s53, 82048
  buffer_load_dwordx4 v1, s[4:7], s46 offen lds
  s_add_u32 m0, s51, 90112
  s_add_u32 s46, s53, 82176
  buffer_load_dwordx4 v1, s[4:7], s46 offen lds
  s_add_u32 m0, s51, 94208
  s_add_u32 s46, s53, 82304
  buffer_load_dwordx4 v1, s[4:7], s46 offen lds
  s_add_u32 m0, s51, 98304
  s_add_u32 s46, s53, 82432
  buffer_load_dwordx4 v1, s[4:7], s46 offen lds
  s_add_u32 m0, s51, 102400
  s_add_u32 s46, s53, 82560
  buffer_load_dwordx4 v1, s[4:7], s46 offen lds
  s_add_u32 m0, s51, 106496
  s_add_u32 s46, s53, 82688
  buffer_load_dwordx4 v1, s[4:7], s46 offen lds
  s_add_u32 m0, s51, 110592
  s_add_u32 s46, s53, 82816
  buffer_load_dwordx4 v1, s[4:7], s46 offen lds
  s_add_u32 m0, s51, 114688
  s_add_u32 s46, s53, 82944
  buffer_load_dwordx4 v1, s[4:7], s46 offen lds
  s_add_u32 m0, s51, 118784
  s_add_u32 s46, s53, 83072
  buffer_load_dwordx4 v1, s[4:7], s46 offen lds
  s_waitcnt vmcnt(24)
  s_barrier
  s_add_u32 m0, s51, 122880
  s_add_u32 s46, s53, 122880
  buffer_load_dwordx4 v1, s[4:7], s46 offen lds
  s_add_u32 m0, s51, 126976
  s_add_u32 s46, s53, 123008
  buffer_load_dwordx4 v1, s[4:7], s46 offen lds
  s_add_u32 m0, s51, 131072
  s_add_u32 s46, s53, 123136
  buffer_load_dwordx4 v1, s[4:7], s46 offen lds
  s_add_u32 m0, s51, 135168
  s_add_u32 s46, s53, 123264
  buffer_load_dwordx4 v1, s[4:7], s46 offen lds
  s_add_u32 m0, s51, 139264
  s_add_u32 s46, s53, 123392
  buffer_load_dwordx4 v1, s[4:7], s46 offen lds
  s_add_u32 m0, s51, 143360
  s_add_u32 s46, s53, 123520
  buffer_load_dwordx4 v1, s[4:7], s46 offen lds
  ds_read_b64_tr_b16 a[0:1], v2 offset:0
  ds_read_b64_tr_b16 a[2:3], v2 offset:1024
  ds_read_b64_tr_b16 a[24:25], v2 offset:4096
  ds_read_b64_tr_b16 a[26:27], v2 offset:5120
  ds_read_b64_tr_b16 a[48:49], v2 offset:8192
  ds_read_b64_tr_b16 a[50:51], v2 offset:9216
  ds_read_b64_tr_b16 a[72:73], v2 offset:12288
  ds_read_b64_tr_b16 a[74:75], v2 offset:13312
  ds_read_b64_tr_b16 a[96:97], v2 offset:16384
  ds_read_b64_tr_b16 a[98:99], v2 offset:17408
  ds_read_b64_tr_b16 a[120:121], v2 offset:20480
  ds_read_b64_tr_b16 a[122:123], v2 offset:21504
  s_waitcnt lgkmcnt(0)
  s_waitcnt vmcnt(24)
  s_barrier
  s_add_u32 m0, s51, 0
  s_add_u32 s46, s53, 123648
  buffer_load_dwordx4 v1, s[4:7], s46 offen lds
  s_add_u32 m0, s51, 4096
  s_add_u32 s46, s53, 123776
  buffer_load_dwordx4 v1, s[4:7], s46 offen lds
  s_add_u32 m0, s51, 8192
  s_add_u32 s46, s53, 123904
  buffer_load_dwordx4 v1, s[4:7], s46 offen lds
  s_add_u32 m0, s51, 12288
  s_add_u32 s46, s53, 124032
  buffer_load_dwordx4 v1, s[4:7], s46 offen lds
  s_add_u32 m0, s51, 16384
  s_add_u32 s46, s53, 163840
  buffer_load_dwordx4 v1, s[4:7], s46 offen lds
  s_add_u32 m0, s51, 20480
  s_add_u32 s46, s53, 163968
  buffer_load_dwordx4 v1, s[4:7], s46 offen lds
  ds_read_b64_tr_b16 a[144:145], v2 offset:24576
  ds_read_b64_tr_b16 a[146:147], v2 offset:25600
  ds_read_b64_tr_b16 a[168:169], v2 offset:28672
  ds_read_b64_tr_b16 a[170:171], v2 offset:29696
  ds_read_b64_tr_b16 a[192:193], v2 offset:32768
  ds_read_b64_tr_b16 a[194:195], v2 offset:33792
  ds_read_b64_tr_b16 a[216:217], v2 offset:36864
  ds_read_b64_tr_b16 a[218:219], v2 offset:37888
  ds_read_b64_tr_b16 a[4:5], v2 offset:40960
  ds_read_b64_tr_b16 a[6:7], v2 offset:41984
  ds_read_b64_tr_b16 a[28:29], v2 offset:45056
  ds_read_b64_tr_b16 a[30:31], v2 offset:46080
  s_waitcnt lgkmcnt(0)
  s_waitcnt vmcnt(24)
  s_barrier
  s_add_u32 m0, s51, 24576
  s_add_u32 s46, s53, 164096
  buffer_load_dwordx4 v1, s[4:7], s46 offen lds
  s_add_u32 m0, s51, 28672
  s_add_u32 s46, s53, 164224
  buffer_load_dwordx4 v1, s[4:7], s46 offen lds
  s_add_u32 m0, s51, 32768
  s_add_u32 s46, s53, 164352
  buffer_load_dwordx4 v1, s[4:7], s46 offen lds
  s_add_u32 m0, s51, 36864
  s_add_u32 s46, s53, 164480
  buffer_load_dwordx4 v1, s[4:7], s46 offen lds
  s_add_u32 m0, s51, 40960
  s_add_u32 s46, s53, 164608
  buffer_load_dwordx4 v1, s[4:7], s46 offen lds
  s_add_u32 m0, s51, 45056
  s_add_u32 s46, s53, 164736
  buffer_load_dwordx4 v1, s[4:7], s46 offen lds
  ds_read_b64_tr_b16 a[52:53], v2 offset:49152
  ds_read_b64_tr_b16 a[54:55], v2 offset:50176
  ds_read_b64_tr_b16 a[76:77], v2 offset:53248
  ds_read_b64_tr_b16 a[78:79], v2 offset:54272
  ds_read_b64_tr_b16 a[100:101], v2 offset:57344
  ds_read_b64_tr_b16 a[102:103], v2 offset:58368
  ds_read_b64_tr_b16 a[124:125], v2 offset:61440
  ds_read_b64_tr_b16 a[126:127], v2 offset:62464
  ds_read_b64_tr_b16 a[148:149], v3 offset:0
  ds_read_b64_tr_b16 a[150:151], v3 offset:1024
  ds_read_b64_tr_b16 a[172:173], v3 offset:4096
  ds_read_b64_tr_b16 a[174:175], v3 offset:5120
  s_waitcnt lgkmcnt(0)
  s_waitcnt vmcnt(24)
  s_barrier
  s_add_u32 m0, s51, 49152
  s_add_u32 s46, s53, 164864
  buffer_load_dwordx4 v1, s[4:7], s46 offen lds
  s_add_u32 m0, s51, 53248
  s_add_u32 s46, s53, 164992
  buffer_load_dwordx4 v1, s[4:7], s46 offen lds
  s_add_u32 m0, s51, 57344
  s_add_u32 s46, s53, 204800
  buffer_load_dwordx4 v1, s[4:7], s46 offen lds
  s_add_u32 m0, s51, 61440
  s_add_u32 s46, s53, 204928
  buffer_load_dwordx4 v1, s[4:7], s46 offen lds
  s_add_u32 m0, s51, 65536
  s_add_u32 s46, s53, 205056
  buffer_load_dwordx4 v1, s[4:7], s46 offen lds
  s_add_u32 m0, s51, 69632
  s_add_u32 s46, s53, 205184
  buffer_load_dwordx4 v1, s[4:7], s46 offen lds
  ds_read_b64_tr_b16 a[196:197], v3 offset:8192
  ds_read_b64_tr_b16 a[198:199], v3 offset:9216
  ds_read_b64_tr_b16 a[220:221], v3 offset:12288
  ds_read_b64_tr_b16 a[222:223], v3 offset:13312
  ds_read_b64_tr_b16 a[8:9], v3 offset:16384
  ds_read_b64_tr_b16 a[10:11], v3 offset:17408
  ds_read_b64_tr_b16 a[32:33], v3 offset:20480
  ds_read_b64_tr_b16 a[34:35], v3 offset:21504
  ds_read_b64_tr_b16 a[56:57], v3 offset:24576
  ds_read_b64_tr_b16 a[58:59], v3 offset:25600
  ds_read_b64_tr_b16 a[80:81], v3 offset:28672
  ds_read_b64_tr_b16 a[82:83], v3 offset:29696
  s_waitcnt lgkmcnt(0)
  s_waitcnt vmcnt(24)
  s_barrier
  s_add_u32 m0, s51, 73728
  s_add_u32 s46, s53, 205312
  buffer_load_dwordx4 v1, s[4:7], s46 offen lds
  s_add_u32 m0, s51, 77824
  s_add_u32 s46, s53, 205440
  buffer_load_dwordx4 v1, s[4:7], s46 offen lds
  s_add_u32 m0, s51, 81920
  s_add_u32 s46, s53, 205568
  buffer_load_dwordx4 v1, s[4:7], s46 offen lds
  s_add_u32 m0, s51, 86016
  s_add_u32 s46, s53, 205696
  buffer_load_dwordx4 v1, s[4:7], s46 offen lds
  s_add_u32 m0, s51, 90112
  s_add_u32 s46, s53, 205824
  buffer_load_dwordx4 v1, s[4:7], s46 offen lds
  s_add_u32 m0, s51, 94208
  s_add_u32 s46, s53, 205952
  buffer_load_dwordx4 v1, s[4:7], s46 offen lds
  ds_read_b64_tr_b16 a[104:105], v3 offset:32768
  ds_read_b64_tr_b16 a[106:107], v3 offset:33792
  ds_read_b64_tr_b16 a[128:129], v3 offset:36864
  ds_read_b64_tr_b16 a[130:131], v3 offset:37888
  ds_read_b64_tr_b16 a[152:153], v3 offset:40960
  ds_read_b64_tr_b16 a[154:155], v3 offset:41984
  ds_read_b64_tr_b16 a[176:177], v3 offset:45056
  ds_read_b64_tr_b16 a[178:179], v3 offset:46080
  ds_read_b64_tr_b16 a[200:201], v3 offset:49152
  ds_read_b64_tr_b16 a[202:203], v3 offset:50176
  ds_read_b64_tr_b16 a[224:225], v3 offset:53248
  ds_read_b64_tr_b16 a[226:227], v3 offset:54272
  s_waitcnt lgkmcnt(0)
  s_waitcnt vmcnt(24)
  s_barrier
  ds_read_b64_tr_b16 a[12:13], v3 offset:57344
  ds_read_b64_tr_b16 a[14:15], v3 offset:58368
  ds_read_b64_tr_b16 a[36:37], v3 offset:61440
  ds_read_b64_tr_b16 a[38:39], v3 offset:62464
  ds_read_b64_tr_b16 a[60:61], v4 offset:0
  ds_read_b64_tr_b16 a[62:63], v4 offset:1024
  ds_read_b64_tr_b16 a[84:85], v4 offset:4096
  ds_read_b64_tr_b16 a[86:87], v4 offset:5120
  ds_read_b64_tr_b16 a[108:109], v4 offset:8192
  ds_read_b64_tr_b16 a[110:111], v4 offset:9216
  ds_read_b64_tr_b16 a[132:133], v4 offset:12288
  ds_read_b64_tr_b16 a[134:135], v4 offset:13312
  s_waitcnt lgkmcnt(0)
  s_waitcnt vmcnt(18)
  s_barrier
  ds_read_b64_tr_b16 a[156:157], v2 offset:0
  ds_read_b64_tr_b16 a[158:159], v2 offset:1024
  ds_read_b64_tr_b16 a[180:181], v2 offset:4096
  ds_read_b64_tr_b16 a[182:183], v2 offset:5120
  ds_read_b64_tr_b16 a[204:205], v2 offset:8192
  ds_read_b64_tr_b16 a[206:207], v2 offset:9216
  ds_read_b64_tr_b16 a[228:229], v2 offset:12288
  ds_read_b64_tr_b16 a[230:231], v2 offset:13312
  ds_read_b64_tr_b16 a[16:17], v2 offset:16384
  ds_read_b64_tr_b16 a[18:19], v2 offset:17408
  ds_read_b64_tr_b16 a[40:41], v2 offset:20480
  ds_read_b64_tr_b16 a[42:43], v2 offset:21504
  s_waitcnt lgkmcnt(0)
  s_waitcnt vmcnt(12)
  s_barrier
  ds_read_b64_tr_b16 a[64:65], v2 offset:24576
  ds_read_b64_tr_b16 a[66:67], v2 offset:25600
  ds_read_b64_tr_b16 a[88:89], v2 offset:28672
  ds_read_b64_tr_b16 a[90:91], v2 offset:29696
  ds_read_b64_tr_b16 a[112:113], v2 offset:32768
  ds_read_b64_tr_b16 a[114:115], v2 offset:33792
  ds_read_b64_tr_b16 a[136:137], v2 offset:36864
  ds_read_b64_tr_b16 a[138:139], v2 offset:37888
  ds_read_b64_tr_b16 a[160:161], v2 offset:40960
  ds_read_b64_tr_b16 a[162:163], v2 offset:41984
  ds_read_b64_tr_b16 a[184:185], v2 offset:45056
  ds_read_b64_tr_b16 a[186:187], v2 offset:46080
  s_waitcnt lgkmcnt(0)
  s_waitcnt vmcnt(6)
  s_barrier
  ds_read_b64_tr_b16 a[208:209], v2 offset:49152
  ds_read_b64_tr_b16 a[210:211], v2 offset:50176
  ds_read_b64_tr_b16 a[232:233], v2 offset:53248
  ds_read_b64_tr_b16 a[234:235], v2 offset:54272
  ds_read_b64_tr_b16 a[20:21], v2 offset:57344
  ds_read_b64_tr_b16 a[22:23], v2 offset:58368
  ds_read_b64_tr_b16 a[44:45], v2 offset:61440
  ds_read_b64_tr_b16 a[46:47], v2 offset:62464
  ds_read_b64_tr_b16 a[68:69], v3 offset:0
  ds_read_b64_tr_b16 a[70:71], v3 offset:1024
  ds_read_b64_tr_b16 a[92:93], v3 offset:4096
  ds_read_b64_tr_b16 a[94:95], v3 offset:5120
  s_waitcnt lgkmcnt(0)
  s_waitcnt vmcnt(0)
  s_barrier
  ds_read_b64_tr_b16 a[116:117], v3 offset:8192
  ds_read_b64_tr_b16 a[118:119], v3 offset:9216
  ds_read_b64_tr_b16 a[140:141], v3 offset:12288
  ds_read_b64_tr_b16 a[142:143], v3 offset:13312
  ds_read_b64_tr_b16 a[164:165], v3 offset:16384
  ds_read_b64_tr_b16 a[166:167], v3 offset:17408
  ds_read_b64_tr_b16 a[188:189], v3 offset:20480
  ds_read_b64_tr_b16 a[190:191], v3 offset:21504
  ds_read_b64_tr_b16 a[212:213], v3 offset:24576
  ds_read_b64_tr_b16 a[214:215], v3 offset:25600
  ds_read_b64_tr_b16 a[236:237], v3 offset:28672
  ds_read_b64_tr_b16 a[238:239], v3 offset:29696
  s_waitcnt lgkmcnt(0)
  s_barrier
  s_mov_b32 s57, 1
  s_cmp_ge_u32 s56, s57
  s_cbranch_scc1 wf_done_6
  s_mov_b32 s50, 0
wf_loop_7:
  buffer_load_dword v8, v6, s[8:11], 0 offen sc1
  s_add_u32 s50, s50, 1
  s_cmp_gt_u32 s50, 131072
  s_cbranch_scc1 L_fail
  s_waitcnt vmcnt(0)
  v_readfirstlane_b32 s56, v8
  s_nop 0
  s_cmp_lt_u32 s56, s57
  s_cbranch_scc1 wf_loop_7
wf_done_6:
  s_add_u32 s46, s54, 0
  buffer_load_dwordx4 v[16:19], v5, s[8:11], s46 offen offset:0 sc1
  buffer_load_dwordx4 v[20:23], v5, s[8:11], s46 offen offset:1024 sc1
  buffer_load_dwordx4 v[24:27], v5, s[8:11], s46 offen offset:2048 sc1
  buffer_load_dwordx4 v[28:31], v5, s[8:11], s46 offen offset:3072 sc1
  s_add_u32 s46, s54, 4096
  buffer_load_dwordx4 v[32:35], v5, s[8:11], s46 offen offset:0 sc1
  buffer_load_dwordx4 v[36:39], v5, s[8:11], s46 offen offset:1024 sc1
  buffer_load_dwordx4 v[40:43], v5, s[8:11], s46 offen offset:2048 sc1
  buffer_load_dwordx4 v[44:47], v5, s[8:11], s46 offen offset:3072 sc1
  s_add_u32 s46, s54, 8192
  buffer_load_dwordx4 v[48:51], v5, s[8:11], s46 offen offset:0 sc1
  buffer_load_dwordx4 v[52:55], v5, s[8:11], s46 offen offset:1024 sc1
  buffer_load_dwordx4 v[56:59], v5, s[8:11], s46 offen offset:2048 sc1
  buffer_load_dwordx4 v[60:63], v5, s[8:11], s46 offen offset:3072 sc1
  s_add_u32 s54, s54, 12288
  s_waitcnt vmcnt(0)
u_loop_8:
  s_add_u32 s57, s52, 2
  s_cmp_gt_u32 s57, 64
  s_cbranch_scc1 u_nold_9
  s_cmp_eq_u32 s52, 0
  s_cbranch_scc1 u_nold_9
  s_cmp_ge_u32 s56, s57
  s_cbranch_scc1 wf_done_12
  s_mov_b32 s50, 0
wf_loop_13:
  buffer_load_dword v8, v6, s[8:11], 0 offen sc1
  s_add_u32 s50, s50, 1
  s_cmp_gt_u32 s50, 131072
  s_cbranch_scc1 L_fail
  s_waitcnt vmcnt(0)
  v_readfirstlane_b32 s56, v8
  s_nop 0
  s_cmp_lt_u32 s56, s57
  s_cbranch_scc1 wf_loop_13
wf_done_12:
  s_add_u32 s46, s54, 0
  buffer_load_dwordx4 v[64:67], v5, s[8:11], s46 offen offset:0 sc1
  buffer_load_dwordx4 v[68:71], v5, s[8:11], s46 offen offset:1024 sc1
  buffer_load_dwordx4 v[72:75], v5, s[8:11], s46 offen offset:2048 sc1
  buffer_load_dwordx4 v[76:79], v5, s[8:11], s46 offen offset:3072 sc1
  s_add_u32 s46, s54, 4096
  buffer_load_dwordx4 v[80:83], v5, s[8:11], s46 offen offset:0 sc1
  buffer_load_dwordx4 v[84:87], v5, s[8:11], s46 offen offset:1024 sc1
  buffer_load_dwordx4 v[88:91], v5, s[8:11], s46 offen offset:2048 sc1
  buffer_load_dwordx4 v[92:95], v5, s[8:11], s46 offen offset:3072 sc1
  s_add_u32 s46, s54, 8192
  buffer_load_dwordx4 v[96:99], v5, s[8:11], s46 offen offset:0 sc1
  buffer_load_dwordx4 v[100:103], v5, s[8:11], s46 offen offset:1024 sc1
  buffer_load_dwordx4 v[104:107], v5, s[8:11], s46 offen offset:2048 sc1
  buffer_load_dwordx4 v[108:111], v5, s[8:11], s46 offen offset:3072 sc1
  s_add_u32 s54, s54, 12288
u_nold_9:
  v_mfma_f32_16x16x32_bf16 v[112:115], v[16:19], a[0:3], 0
  v_mfma_f32_16x16x32_bf16 v[116:119], v[40:43], a[0:3], 0
  v_mfma_f32_16x16x32_bf16 v[112:115], v[20:23], a[4:7], v[112:115]
  v_mfma_f32_16x16x32_bf16 v[116:119], v[44:47], a[4:7], v[116:119]
  v_mfma_f32_16x16x32_bf16 v[112:115], v[24:27], a[8:11], v[112:115]
  v_mfma_f32_16x16x32_bf16 v[116:119], v[48:51], a[8:11], v[116:119]
  v_mfma_f32_16x16x32_bf16 v[112:115], v[28:31], a[12:15], v[112:115]
  v_mfma_f32_16x16x32_bf16 v[116:119], v[52:55], a[12:15], v[116:119]
  v_mfma_f32_16x16x32_bf16 v[112:115], v[32:35], a[16:19], v[112:115]
  v_mfma_f32_16x16x32_bf16 v[116:119], v[56:59], a[16:19], v[116:119]
  v_mfma_f32_16x16x32_bf16 v[112:115], v[36:39], a[20:23], v[112:115]
  v_mfma_f32_16x16x32_bf16 v[116:119], v[60:63], a[20:23], v[116:119]
  v_mfma_f32_16x16x32_bf16 v[120:123], v[16:19], a[24:27], 0
  v_mfma_f32_16x16x32_bf16 v[124:127], v[40:43], a[24:27], 0
  v_mfma_f32_16x16x32_bf16 v[120:123], v[20:23], a[28:31], v[120:123]
  v_mfma_f32_16x16x32_bf16 v[124:127], v[44:47], a[28:31], v[124:127]
  v_mfma_f32_16x16x32_bf16 v[120:123], v[24:27], a[32:35], v[120:123]
  v_mfma_f32_16x16x32_bf16 v[124:127], v[48:51], a[32:35], v[124:127]
  v_mfma_f32_16x16x32_bf16 v[120:123], v[28:31], a[36:39], v[120:123]
  v_mfma_f32_16x16x32_bf16 v[124:127], v[52:55], a[36:39], v[124:127]
  v_cvt_pk_bf16_f32 v136, v112, v113
  v_cvt_pk_bf16_f32 v137, v114, v115
  v_mfma_f32_16x16x32_bf16 v[120:123], v[32:35], a[40:43], v[120:123]
  v_cvt_pk_bf16_f32 v138, v116, v117
  v_cvt_pk_bf16_f32 v139, v118, v119
  v_mfma_f32_16x16x32_bf16 v[124:127], v[56:59], a[40:43], v[124:127]
  s_add_u32 s58, s55, 0
  buffer_store_dwordx4 v[136:139], v5, s[8:11], s58 offen sc1
  v_mfma_f32_16x16x32_bf16 v[120:123], v[36:39], a[44:47], v[120:123]
  v_mfma_f32_16x16x32_bf16 v[124:127], v[60:63], a[44:47], v[124:127]
  v_mfma_f32_16x16x32_bf16 v[128:131], v[16:19], a[48:51], 0
  v_mfma_f32_16x16x32_bf16 v[132:135], v[40:43], a[48:51], 0
  v_mfma_f32_16x16x32_bf16 v[128:131], v[20:23], a[52:55], v[128:131]
  v_mfma_f32_16x16x32_bf16 v[132:135], v[44:47], a[52:55], v[132:135]
  v_mfma_f32_16x16x32_bf16 v[128:131], v[24:27], a[56:59], v[128:131]
  v_mfma_f32_16x16x32_bf16 v[132:135], v[48:51], a[56:59], v[132:135]
  v_mfma_f32_16x16x32_bf16 v[128:131], v[28:31], a[60:63], v[128:131]
  v_mfma_f32_16x16x32_bf16 v[132:135], v[52:55], a[60:63], v[132:135]
  v_cvt_pk_bf16_f32 v140, v120, v121
  v_cvt_pk_bf16_f32 v141, v122, v123
  v_mfma_f32_16x16x32_bf16 v[128:131], v[32:35], a[64:67], v[128:131]
  v_cvt_pk_bf16_f32 v142, v124, v125
  v_cvt_pk_bf16_f32 v143, v126, v127
  v_mfma_f32_16x16x32_bf16 v[132:135], v[56:59], a[64:67], v[132:135]
  s_add_u32 s58, s55, 131072
  buffer_store_dwordx4 v[140:143], v5, s[8:11], s58 offen sc1
  v_mfma_f32_16x16x32_bf16 v[128:131], v[36:39], a[68:71], v[128:131]
  v_mfma_f32_16x16x32_bf16 v[132:135], v[60:63], a[68:71], v[132:135]
  v_mfma_f32_16x16x32_bf16 v[112:115], v[16:19], a[72:75], 0
  v_mfma_f32_16x16x32_bf16 v[116:119], v[40:43], a[72:75], 0
  v_mfma_f32_16x16x32_bf16 v[112:115], v[20:23], a[76:79], v[112:115]
  v_mfma_f32_16x16x32_bf16 v[116:119], v[44:47], a[76:79], v[116:119]
  v_mfma_f32_16x16x32_bf16 v[112:115], v[24:27], a[80:83], v[112:115]
  v_mfma_f32_16x16x32_bf16 v[116:119], v[48:51], a[80:83], v[116:119]
  v_mfma_f32_16x16x32_bf16 v[112:115], v[28:31], a[84:87], v[112:115]
  v_mfma_f32_16x16x32_bf16 v[116:119], v[52:55], a[84:87], v[116:119]
  v_cvt_pk_bf16_f32 v144, v128, v129
  v_cvt_pk_bf16_f32 v145, v130, v131
  v_mfma_f32_16x16x32_bf16 v[112:115], v[32:35], a[88:91], v[112:115]
  v_cvt_pk_bf16_f32 v146, v132, v133
  v_cvt_pk_bf16_f32 v147, v134, v135
  v_mfma_f32_16x16x32_bf16 v[116:119], v[56:59], a[88:91], v[116:119]
  s_add_u32 s58, s55, 262144
  buffer_store_dwordx4 v[144:147], v5, s[8:11], s58 offen sc1
  v_mfma_f32_16x16x32_bf16 v[112:115], v[36:39], a[92:95], v[112:115]
  v_mfma_f32_16x16x32_bf16 v[116:119], v[60:63], a[92:95], v[116:119]
  v_mfma_f32_16x16x32_bf16 v[120:123], v[16:19], a[96:99], 0
  v_mfma_f32_16x16x32_bf16 v[124:127], v[40:43], a[96:99], 0
  v_mfma_f32_16x16x32_bf16 v[120:123], v[20:23], a[100:103], v[120:123]
  v_mfma_f32_16x16x32_bf16 v[124:127], v[44:47], a[100:103], v[124:127]
  v_mfma_f32_16x16x32_bf16 v[120:123], v[24:27], a[104:107], v[120:123]
  v_mfma_f32_16x16x32_bf16 v[124:127], v[48:51], a[104:107], v[124:127]
  v_mfma_f32_16x16x32_bf16 v[120:123], v[28:31], a[108:111], v[120:123]
  v_mfma_f32_16x16x32_bf16 v[124:127], v[52:55], a[108:111], v[124:127]
  v_cvt_pk_bf16_f32 v136, v112, v113
  v_cvt_pk_bf16_f32 v137, v114, v115
  v_mfma_f32_16x16x32_bf16 v[120:123], v[32:35], a[112:115], v[120:123]
  v_cvt_pk_bf16_f32 v138, v116, v117
  v_cvt_pk_bf16_f32 v139, v118, v119
  v_mfma_f32_16x16x32_bf16 v[124:127], v[56:59], a[112:115], v[124:127]
  s_add_u32 s58, s55, 393216
  buffer_store_dwordx4 v[136:139], v5, s[8:11], s58 offen sc1
  v_mfma_f32_16x16x32_bf16 v[120:123], v[36:39], a[116:119], v[120:123]
  v_mfma_f32_16x16x32_bf16 v[124:127], v[60:63], a[116:119], v[124:127]
  v_mfma_f32_16x16x32_bf16 v[128:131], v[16:19], a[120:123], 0
  v_mfma_f32_16x16x32_bf16 v[132:135], v[40:43], a[120:123], 0
  v_mfma_f32_16x16x32_bf16 v[128:131], v[20:23], a[124:127], v[128:131]
  v_mfma_f32_16x16x32_bf16 v[132:135], v[44:47], a[124:127], v[132:135]
  v_mfma_f32_16x16x32_bf16 v[128:131], v[24:27], a[128:131], v[128:131]
  v_mfma_f32_16x16x32_bf16 v[132:135], v[48:51], a[128:131], v[132:135]
  v_mfma_f32_16x16x32_bf16 v[128:131], v[28:31], a[132:135], v[128:131]
  v_mfma_f32_16x16x32_bf16 v[132:135], v[52:55], a[132:135], v[132:135]
  v_cvt_pk_bf16_f32 v140, v120, v121
  v_cvt_pk_bf16_f32 v141, v122, v123
  v_mfma_f32_16x16x32_bf16 v[128:131], v[32:35], a[136:139], v[128:131]
  v_cvt_pk_bf16_f32 v142, v124, v125
  v_cvt_pk_bf16_f32 v143, v126, v127
  v_mfma_f32_16x16x32_bf16 v[132:135], v[56:59], a[136:139], v[132:135]
  s_add_u32 s58, s55, 524288
  buffer_store_dwordx4 v[140:143], v5, s[8:11], s58 offen sc1
  v_mfma_f32_16x16x32_bf16 v[128:131], v[36:39], a[140:143], v[128:131]
  v_mfma_f32_16x16x32_bf16 v[132:135], v[60:63], a[140:143], v[132:135]
  v_mfma_f32_16x16x32_bf16 v[112:115], v[16:19], a[144:147], 0
  v_mfma_f32_16x16x32_bf16 v[116:119], v[40:43], a[144:147], 0
  v_mfma_f32_16x16x32_bf16 v[112:115], v[20:23], a[148:151], v[112:115]
  v_mfma_f32_16x16x32_bf16 v[116:119], v[44:47], a[148:151], v[116:119]
  v_mfma_f32_16x16x32_bf16 v[112:115], v[24:27], a[152:155], v[112:115]
  v_mfma_f32_16x16x32_bf16 v[116:119], v[48:51], a[152:155], v[116:119]
  v_mfma_f32_16x16x32_bf16 v[112:115], v[28:31], a[156:159], v[112:115]
  v_mfma_f32_16x16x32_bf16 v[116:119], v[52:55], a[156:159], v[116:119]
  v_cvt_pk_bf16_f32 v144, v128, v129
  v_cvt_pk_bf16_f32 v145, v130, v131
  v_mfma_f32_16x16x32_bf16 v[112:115], v[32:35], a[160:163], v[112:115]
  v_cvt_pk_bf16_f32 v146, v132, v133
  v_cvt_pk_bf16_f32 v147, v134, v135
  v_mfma_f32_16x16x32_bf16 v[116:119], v[56:59], a[160:163], v[116:119]
  s_add_u32 s58, s55, 655360
  buffer_store_dwordx4 v[144:147], v5, s[8:11], s58 offen sc1
  v_mfma_f32_16x16x32_bf16 v[112:115], v[36:39], a[164:167], v[112:115]
  v_mfma_f32_16x16x32_bf16 v[116:119], v[60:63], a[164:167], v[116:119]
  v_mfma_f32_16x16x32_bf16 v[120:123], v[16:19], a[168:171], 0
  v_mfma_f32_16x16x32_bf16 v[124:127], v[40:43], a[168:171], 0
  v_mfma_f32_16x16x32_bf16 v[120:123], v[20:23], a[172:175], v[120:123]
  v_mfma_f32_16x16x32_bf16 v[124:127], v[44:47], a[172:175], v[124:127]
  v_mfma_f32_16x16x32_bf16 v[120:123], v[24:27], a[176:179], v[120:123]
  v_mfma_f32_16x16x32_bf16 v[124:127], v[48:51], a[176:179], v[124:127]
  v_mfma_f32_16x16x32_bf16 v[120:123], v[28:31], a[180:183], v[120:123]
  v_mfma_f32_16x16x32_bf16 v[124:127], v[52:55], a[180:183], v[124:127]
  v_cvt_pk_bf16_f32 v136, v112, v113
  v_cvt_pk_bf16_f32 v137, v114, v115
  v_mfma_f32_16x16x32_bf16 v[120:123], v[32:35], a[184:187], v[120:123]
  v_cvt_pk_bf16_f32 v138, v116, v117
  v_cvt_pk_bf16_f32 v139, v118, v119
  v_mfma_f32_16x16x32_bf16 v[124:127], v[56:59], a[184:187], v[124:127]
  s_add_u32 s58, s55, 786432
  buffer_store_dwordx4 v[136:139], v5, s[8:11], s58 offen sc1
  v_mfma_f32_16x16x32_bf16 v[120:123], v[36:39], a[188:191], v[120:123]
  v_mfma_f32_16x16x32_bf16 v[124:127], v[60:63], a[188:191], v[124:127]
  v_mfma_f32_16x16x32_bf16 v[128:131], v[16:19], a[192:195], 0
  v_mfma_f32_16x16x32_bf16 v[132:135], v[40:43], a[192:195], 0
  v_mfma_f32_16x16x32_bf16 v[128:131], v[20:23], a[196:199], v[128:131]
  v_mfma_f32_16x16x32_bf16 v[132:135], v[44:47], a[196:199], v[132:135]
  v_mfma_f32_16x16x32_bf16 v[128:131], v[24:27], a[200:203], v[128:131]
  v_mfma_f32_16x16x32_bf16 v[132:135], v[48:51], a[200:203], v[132:135]
  v_mfma_f32_16x16x32_bf16 v[128:131], v[28:31], a[204:207], v[128:131]
  v_mfma_f32_16x16x32_bf16 v[132:135], v[52:55], a[204:207], v[132:135]
  v_cvt_pk_bf16_f32 v140, v120, v121
  v_cvt_pk_bf16_f32 v141, v122, v123
  v_mfma_f32_16x16x32_bf16 v[128:131], v[32:35], a[208:211], v[128:131]
  v_cvt_pk_bf16_f32 v142, v124, v125
  v_cvt_pk_bf16_f32 v143, v126, v127
  v_mfma_f32_16x16x32_bf16 v[132:135], v[56:59], a[208:211], v[132:135]
  s_add_u32 s58, s55, 917504
  buffer_store_dwordx4 v[140:143], v5, s[8:11], s58 offen sc1
  v_mfma_f32_16x16x32_bf16 v[128:131], v[36:39], a[212:215], v[128:131]
  v_mfma_f32_16x16x32_bf16 v[132:135], v[60:63], a[212:215], v[132:135]
  v_mfma_f32_16x16x32_bf16 v[112:115], v[16:19], a[216:219], 0
  v_mfma_f32_16x16x32_bf16 v[116:119], v[40:43], a[216:219], 0
  v_mfma_f32_16x16x32_bf16 v[112:115], v[20:23], a[220:223], v[112:115]
  v_mfma_f32_16x16x32_bf16 v[116:119], v[44:47], a[220:223], v[116:119]
  v_mfma_f32_16x16x32_bf16 v[112:115], v[24:27], a[224:227], v[112:115]
  v_mfma_f32_16x16x32_bf16 v[116:119], v[48:51], a[224:227], v[116:119]
  v_mfma_f32_16x16x32_bf16 v[112:115], v[28:31], a[228:231], v[112:115]
  v_mfma_f32_16x16x32_bf16 v[116:119], v[52:55], a[228:231], v[116:119]
  v_cvt_pk_bf16_f32 v144, v128, v129
  v_cvt_pk_bf16_f32 v145, v130, v131
  v_mfma_f32_16x16x32_bf16 v[112:115], v[32:35], a[232:235], v[112:115]
  v_cvt_pk_bf16_f32 v146, v132, v133
  v_cvt_pk_bf16_f32 v147, v134, v135
  v_mfma_f32_16x16x32_bf16 v[116:119], v[56:59], a[232:235], v[116:119]
  s_add_u32 s58, s55, 1048576
  buffer_store_dwordx4 v[144:147], v5, s[8:11], s58 offen sc1
  v_mfma_f32_16x16x32_bf16 v[112:115], v[36:39], a[236:239], v[112:115]
  v_mfma_f32_16x16x32_bf16 v[116:119], v[60:63], a[236:239], v[116:119]
  s_nop 6
  v_cvt_pk_bf16_f32 v136, v112, v113
  v_cvt_pk_bf16_f32 v137, v114, v115
  v_cvt_pk_bf16_f32 v138, v116, v117
  v_cvt_pk_bf16_f32 v139, v118, v119
  s_add_u32 s58, s55, 1179648
  buffer_store_dwordx4 v[136:139], v5, s[8:11], s58 offen sc1
  s_add_u32 s55, s55, 1310720
  s_cmp_lg_u32 s52, 0
  s_cbranch_scc1 u_noeag_10
  s_cmp_ge_u32 s56, s57
  s_cbranch_scc1 wf_done_14
  s_mov_b32 s50, 0
wf_loop_15:
  buffer_load_dword v8, v6, s[8:11], 0 offen sc1
  s_add_u32 s50, s50, 1
  s_cmp_gt_u32 s50, 131072
  s_cbranch_scc1 L_fail
  s_waitcnt vmcnt(0)
  v_readfirstlane_b32 s56, v8
  s_nop 0
  s_cmp_lt_u32 s56, s57
  s_cbranch_scc1 wf_loop_15
wf_done_14:
  s_add_u32 s46, s54, 0
  buffer_load_dwordx4 v[64:67], v5, s[8:11], s46 offen offset:0 sc1
  buffer_load_dwordx4 v[68:71], v5, s[8:11], s46 offen offset:1024 sc1
  buffer_load_dwordx4 v[72:75], v5, s[8:11], s46 offen offset:2048 sc1
  buffer_load_dwordx4 v[76:79], v5, s[8:11], s46 offen offset:3072 sc1
  s_add_u32 s46, s54, 4096
  buffer_load_dwordx4 v[80:83], v5, s[8:11], s46 offen offset:0 sc1
  buffer_load_dwordx4 v[84:87], v5, s[8:11], s46 offen offset:1024 sc1
  buffer_load_dwordx4 v[88:91], v5, s[8:11], s46 offen offset:2048 sc1
  buffer_load_dwordx4 v[92:95], v5, s[8:11], s46 offen offset:3072 sc1
  s_add_u32 s46, s54, 8192
  buffer_load_dwordx4 v[96:99], v5, s[8:11], s46 offen offset:0 sc1
  buffer_load_dwordx4 v[100:103], v5, s[8:11], s46 offen offset:1024 sc1
  buffer_load_dwordx4 v[104:107], v5, s[8:11], s46 offen offset:2048 sc1
  buffer_load_dwordx4 v[108:111], v5, s[8:11], s46 offen offset:3072 sc1
  s_add_u32 s54, s54, 12288
  s_waitcnt vmcnt(0)
  s_mov_b32 s47, 1
  v_mov_b32 v8, s47
  s_mov_b64 exec, 1
  buffer_store_dword v8, v7, s[8:11], 0 offen sc1
  s_mov_b64 exec, -1
  s_branch u_nofl_11
u_noeag_10:
  s_waitcnt vmcnt(10)
  v_mov_b32 v8, s52
  s_mov_b64 exec, 1
  buffer_store_dword v8, v7, s[8:11], 0 offen sc1
  s_mov_b64 exec, -1
u_nofl_11:
  s_add_u32 s52, s52, 1
  s_add_u32 s57, s52, 2
  s_cmp_gt_u32 s57, 64
  s_cbranch_scc1 u_nold_16
  s_cmp_ge_u32 s56, s57
  s_cbranch_scc1 wf_done_19
  s_mov_b32 s50, 0
wf_loop_20:
  buffer_load_dword v8, v6, s[8:11], 0 offen sc1
  s_add_u32 s50, s50, 1
  s_cmp_gt_u32 s50, 131072
  s_cbranch_scc1 L_fail
  s_waitcnt vmcnt(0)
  v_readfirstlane_b32 s56, v8
  s_nop 0
  s_cmp_lt_u32 s56, s57
  s_cbranch_scc1 wf_loop_20
wf_done_19:
  s_add_u32 s46, s54, 0
  buffer_load_dwordx4 v[16:19], v5, s[8:11], s46 offen offset:0 sc1
  buffer_load_dwordx4 v[20:23], v5, s[8:11], s46 offen offset:1024 sc1
  buffer_load_dwordx4 v[24:27], v5, s[8:11], s46 offen offset:2048 sc1
  buffer_load_dwordx4 v[28:31], v5, s[8:11], s46 offen offset:3072 sc1
  s_add_u32 s46, s54, 4096
  buffer_load_dwordx4 v[32:35], v5, s[8:11], s46 offen offset:0 sc1
  buffer_load_dwordx4 v[36:39], v5, s[8:11], s46 offen offset:1024 sc1
  buffer_load_dwordx4 v[40:43], v5, s[8:11], s46 offen offset:2048 sc1
  buffer_load_dwordx4 v[44:47], v5, s[8:11], s46 offen offset:3072 sc1
  s_add_u32 s46, s54, 8192
  buffer_load_dwordx4 v[48:51], v5, s[8:11], s46 offen offset:0 sc1
  buffer_load_dwordx4 v[52:55], v5, s[8:11], s46 offen offset:1024 sc1
  buffer_load_dwordx4 v[56:59], v5, s[8:11], s46 offen offset:2048 sc1
  buffer_load_dwordx4 v[60:63], v5, s[8:11], s46 offen offset:3072 sc1
  s_add_u32 s54, s54, 12288
u_nold_16:
  v_mfma_f32_16x16x32_bf16 v[112:115], v[64:67], a[0:3], 0
  v_mfma_f32_16x16x32_bf16 v[116:119], v[88:91], a[0:3], 0
  v_mfma_f32_16x16x32_bf16 v[112:115], v[68:71], a[4:7], v[112:115]
  v_mfma_f32_16x16x32_bf16 v[116:119], v[92:95], a[4:7], v[116:119]
  v_mfma_f32_16x16x32_bf16 v[112:115], v[72:75], a[8:11], v[112:115]
  v_mfma_f32_16x16x32_bf16 v[116:119], v[96:99], a[8:11], v[116:119]
  v_mfma_f32_16x16x32_bf16 v[112:115], v[76:79], a[12:15], v[112:115]
  v_mfma_f32_16x16x32_bf16 v[116:119], v[100:103], a[12:15], v[116:119]
  v_mfma_f32_16x16x32_bf16 v[112:115], v[80:83], a[16:19], v[112:115]
  v_mfma_f32_16x16x32_bf16 v[116:119], v[104:107], a[16:19], v[116:119]
  v_mfma_f32_16x16x32_bf16 v[112:115], v[84:87], a[20:23], v[112:115]
  v_mfma_f32_16x16x32_bf16 v[116:119], v[108:111], a[20:23], v[116:119]
  v_mfma_f32_16x16x32_bf16 v[120:123], v[64:67], a[24:27], 0
  v_mfma_f32_16x16x32_bf16 v[124:127], v[88:91], a[24:27], 0
  v_mfma_f32_16x16x32_bf16 v[120:123], v[68:71], a[28:31], v[120:123]
  v_mfma_f32_16x16x32_bf16 v[124:127], v[92:95], a[28:31], v[124:127]
  v_mfma_f32_16x16x32_bf16 v[120:123], v[72:75], a[32:35], v[120:123]
  v_mfma_f32_16x16x32_bf16 v[124:127], v[96:99], a[32:35], v[124:127]
  v_mfma_f32_16x16x32_bf16 v[120:123], v[76:79], a[36:39], v[120:123]
  v_mfma_f32_16x16x32_bf16 v[124:127], v[100:103], a[36:39], v[124:127]
  v_cvt_pk_bf16_f32 v136, v112, v113
  v_cvt_pk_bf16_f32 v137, v114, v115
  v_mfma_f32_16x16x32_bf16 v[120:123], v[80:83], a[40:43], v[120:123]
  v_cvt_pk_bf16_f32 v138, v116, v117
  v_cvt_pk_bf16_f32 v139, v118, v119
  v_mfma_f32_16x16x32_bf16 v[124:127], v[104:107], a[40:43], v[124:127]
  s_add_u32 s58, s55, 0
  buffer_store_dwordx4 v[136:139], v5, s[8:11], s58 offen sc1
  v_mfma_f32_16x16x32_bf16 v[120:123], v[84:87], a[44:47], v[120:123]
  v_mfma_f32_16x16x32_bf16 v[124:127], v[108:111], a[44:47], v[124:127]
  v_mfma_f32_16x16x32_bf16 v[128:131], v[64:67], a[48:51], 0
  v_mfma_f32_16x16x32_bf16 v[132:135], v[88:91], a[48:51], 0
  v_mfma_f32_16x16x32_bf16 v[128:131], v[68:71], a[52:55], v[128:131]
  v_mfma_f32_16x16x32_bf16 v[132:135], v[92:95], a[52:55], v[132:135]
  v_mfma_f32_16x16x32_bf16 v[128:131], v[72:75], a[56:59], v[128:131]
  v_mfma_f32_16x16x32_bf16 v[132:135], v[96:99], a[56:59], v[132:135]
  v_mfma_f32_16x16x32_bf16 v[128:131], v[76:79], a[60:63], v[128:131]
  v_mfma_f32_16x16x32_bf16 v[132:135], v[100:103], a[60:63], v[132:135]
  v_cvt_pk_bf16_f32 v140, v120, v121
  v_cvt_pk_bf16_f32 v141, v122, v123
  v_mfma_f32_16x16x32_bf16 v[128:131], v[80:83], a[64:67], v[128:131]
  v_cvt_pk_bf16_f32 v142, v124, v125
  v_cvt_pk_bf16_f32 v143, v126, v127
  v_mfma_f32_16x16x32_bf16 v[132:135], v[104:107], a[64:67], v[132:135]
  s_add_u32 s58, s55, 131072
  buffer_store_dwordx4 v[140:143], v5, s[8:11], s58 offen sc1
  v_mfma_f32_16x16x32_bf16 v[128:131], v[84:87], a[68:71], v[128:131]
  v_mfma_f32_16x16x32_bf16 v[132:135], v[108:111], a[68:71], v[132:135]
  v_mfma_f32_16x16x32_bf16 v[112:115], v[64:67], a[72:75], 0
  v_mfma_f32_16x16x32_bf16 v[116:119], v[88:91], a[72:75], 0
  v_mfma_f32_16x16x32_bf16 v[112:115], v[68:71], a[76:79], v[112:115]
  v_mfma_f32_16x16x32_bf16 v[116:119], v[92:95], a[76:79], v[116:119]
  v_mfma_f32_16x16x32_bf16 v[112:115], v[72:75], a[80:83], v[112:115]
  v_mfma_f32_16x16x32_bf16 v[116:119], v[96:99], a[80:83], v[116:119]
  v_mfma_f32_16x16x32_bf16 v[112:115], v[76:79], a[84:87], v[112:115]
  v_mfma_f32_16x16x32_bf16 v[116:119], v[100:103], a[84:87], v[116:119]
  v_cvt_pk_bf16_f32 v144, v128, v129
  v_cvt_pk_bf16_f32 v145, v130, v131
  v_mfma_f32_16x16x32_bf16 v[112:115], v[80:83], a[88:91], v[112:115]
  v_cvt_pk_bf16_f32 v146, v132, v133
  v_cvt_pk_bf16_f32 v147, v134, v135
  v_mfma_f32_16x16x32_bf16 v[116:119], v[104:107], a[88:91], v[116:119]
  s_add_u32 s58, s55, 262144
  buffer_store_dwordx4 v[144:147], v5, s[8:11], s58 offen sc1
  v_mfma_f32_16x16x32_bf16 v[112:115], v[84:87], a[92:95], v[112:115]
  v_mfma_f32_16x16x32_bf16 v[116:119], v[108:111], a[92:95], v[116:119]
  v_mfma_f32_16x16x32_bf16 v[120:123], v[64:67], a[96:99], 0
  v_mfma_f32_16x16x32_bf16 v[124:127], v[88:91], a[96:99], 0
  v_mfma_f32_16x16x32_bf16 v[120:123], v[68:71], a[100:103], v[120:123]
  v_mfma_f32_16x16x32_bf16 v[124:127], v[92:95], a[100:103], v[124:127]
  v_mfma_f32_16x16x32_bf16 v[120:123], v[72:75], a[104:107], v[120:123]
  v_mfma_f32_16x16x32_bf16 v[124:127], v[96:99], a[104:107], v[124:127]
  v_mfma_f32_16x16x32_bf16 v[120:123], v[76:79], a[108:111], v[120:123]
  v_mfma_f32_16x16x32_bf16 v[124:127], v[100:103], a[108:111], v[124:127]
  v_cvt_pk_bf16_f32 v136, v112, v113
  v_cvt_pk_bf16_f32 v137, v114, v115
  v_mfma_f32_16x16x32_bf16 v[120:123], v[80:83], a[112:115], v[120:123]
  v_cvt_pk_bf16_f32 v138, v116, v117
  v_cvt_pk_bf16_f32 v139, v118, v119
  v_mfma_f32_16x16x32_bf16 v[124:127], v[104:107], a[112:115], v[124:127]
  s_add_u32 s58, s55, 393216
  buffer_store_dwordx4 v[136:139], v5, s[8:11], s58 offen sc1
  v_mfma_f32_16x16x32_bf16 v[120:123], v[84:87], a[116:119], v[120:123]
  v_mfma_f32_16x16x32_bf16 v[124:127], v[108:111], a[116:119], v[124:127]
  v_mfma_f32_16x16x32_bf16 v[128:131], v[64:67], a[120:123], 0
  v_mfma_f32_16x16x32_bf16 v[132:135], v[88:91], a[120:123], 0
  v_mfma_f32_16x16x32_bf16 v[128:131], v[68:71], a[124:127], v[128:131]
  v_mfma_f32_16x16x32_bf16 v[132:135], v[92:95], a[124:127], v[132:135]
  v_mfma_f32_16x16x32_bf16 v[128:131], v[72:75], a[128:131], v[128:131]
  v_mfma_f32_16x16x32_bf16 v[132:135], v[96:99], a[128:131], v[132:135]
  v_mfma_f32_16x16x32_bf16 v[128:131], v[76:79], a[132:135], v[128:131]
  v_mfma_f32_16x16x32_bf16 v[132:135], v[100:103], a[132:135], v[132:135]
  v_cvt_pk_bf16_f32 v140, v120, v121
  v_cvt_pk_bf16_f32 v141, v122, v123
  v_mfma_f32_16x16x32_bf16 v[128:131], v[80:83], a[136:139], v[128:131]
  v_cvt_pk_bf16_f32 v142, v124, v125
  v_cvt_pk_bf16_f32 v143, v126, v127
  v_mfma_f32_16x16x32_bf16 v[132:135], v[104:107], a[136:139], v[132:135]
  s_add_u32 s58, s55, 524288
  buffer_store_dwordx4 v[140:143], v5, s[8:11], s58 offen sc1
  v_mfma_f32_16x16x32_bf16 v[128:131], v[84:87], a[140:143], v[128:131]
  v_mfma_f32_16x16x32_bf16 v[132:135], v[108:111], a[140:143], v[132:135]
  v_mfma_f32_16x16x32_bf16 v[112:115], v[64:67], a[144:147], 0
  v_mfma_f32_16x16x32_bf16 v[116:119], v[88:91], a[144:147], 0
  v_mfma_f32_16x16x32_bf16 v[112:115], v[68:71], a[148:151], v[112:115]
  v_mfma_f32_16x16x32_bf16 v[116:119], v[92:95], a[148:151], v[116:119]
  v_mfma_f32_16x16x32_bf16 v[112:115], v[72:75], a[152:155], v[112:115]
  v_mfma_f32_16x16x32_bf16 v[116:119], v[96:99], a[152:155], v[116:119]
  v_mfma_f32_16x16x32_bf16 v[112:115], v[76:79], a[156:159], v[112:115]
  v_mfma_f32_16x16x32_bf16 v[116:119], v[100:103], a[156:159], v[116:119]
  v_cvt_pk_bf16_f32 v144, v128, v129
  v_cvt_pk_bf16_f32 v145, v130, v131
  v_mfma_f32_16x16x32_bf16 v[112:115], v[80:83], a[160:163], v[112:115]
  v_cvt_pk_bf16_f32 v146, v132, v133
  v_cvt_pk_bf16_f32 v147, v134, v135
  v_mfma_f32_16x16x32_bf16 v[116:119], v[104:107], a[160:163], v[116:119]
  s_add_u32 s58, s55, 655360
  buffer_store_dwordx4 v[144:147], v5, s[8:11], s58 offen sc1
  v_mfma_f32_16x16x32_bf16 v[112:115], v[84:87], a[164:167], v[112:115]
  v_mfma_f32_16x16x32_bf16 v[116:119], v[108:111], a[164:167], v[116:119]
  v_mfma_f32_16x16x32_bf16 v[120:123], v[64:67], a[168:171], 0
  v_mfma_f32_16x16x32_bf16 v[124:127], v[88:91], a[168:171], 0
  v_mfma_f32_16x16x32_bf16 v[120:123], v[68:71], a[172:175], v[120:123]
  v_mfma_f32_16x16x32_bf16 v[124:127], v[92:95], a[172:175], v[124:127]
  v_mfma_f32_16x16x32_bf16 v[120:123], v[72:75], a[176:179], v[120:123]
  v_mfma_f32_16x16x32_bf16 v[124:127], v[96:99], a[176:179], v[124:127]
  v_mfma_f32_16x16x32_bf16 v[120:123], v[76:79], a[180:183], v[120:123]
  v_mfma_f32_16x16x32_bf16 v[124:127], v[100:103], a[180:183], v[124:127]
  v_cvt_pk_bf16_f32 v136, v112, v113
  v_cvt_pk_bf16_f32 v137, v114, v115
  v_mfma_f32_16x16x32_bf16 v[120:123], v[80:83], a[184:187], v[120:123]
  v_cvt_pk_bf16_f32 v138, v116, v117
  v_cvt_pk_bf16_f32 v139, v118, v119
  v_mfma_f32_16x16x32_bf16 v[124:127], v[104:107], a[184:187], v[124:127]
  s_add_u32 s58, s55, 786432
  buffer_store_dwordx4 v[136:139], v5, s[8:11], s58 offen sc1
  v_mfma_f32_16x16x32_bf16 v[120:123], v[84:87], a[188:191], v[120:123]
  v_mfma_f32_16x16x32_bf16 v[124:127], v[108:111], a[188:191], v[124:127]
  v_mfma_f32_16x16x32_bf16 v[128:131], v[64:67], a[192:195], 0
  v_mfma_f32_16x16x32_bf16 v[132:135], v[88:91], a[192:195], 0
  v_mfma_f32_16x16x32_bf16 v[128:131], v[68:71], a[196:199], v[128:131]
  v_mfma_f32_16x16x32_bf16 v[132:135], v[92:95], a[196:199], v[132:135]
  v_mfma_f32_16x16x32_bf16 v[128:131], v[72:75], a[200:203], v[128:131]
  v_mfma_f32_16x16x32_bf16 v[132:135], v[96:99], a[200:203], v[132:135]
  v_mfma_f32_16x16x32_bf16 v[128:131], v[76:79], a[204:207], v[128:131]
  v_mfma_f32_16x16x32_bf16 v[132:135], v[100:103], a[204:207], v[132:135]
  v_cvt_pk_bf16_f32 v140, v120, v121
  v_cvt_pk_bf16_f32 v141, v122, v123
  v_mfma_f32_16x16x32_bf16 v[128:131], v[80:83], a[208:211], v[128:131]
  v_cvt_pk_bf16_f32 v142, v124, v125
  v_cvt_pk_bf16_f32 v143, v126, v127
  v_mfma_f32_16x16x32_bf16 v[132:135], v[104:107], a[208:211], v[132:135]
  s_add_u32 s58, s55, 917504
  buffer_store_dwordx4 v[140:143], v5, s[8:11], s58 offen sc1
  v_mfma_f32_16x16x32_bf16 v[128:131], v[84:87], a[212:215], v[128:131]
  v_mfma_f32_16x16x32_bf16 v[132:135], v[108:111], a[212:215], v[132:135]
  v_mfma_f32_16x16x32_bf16 v[112:115], v[64:67], a[216:219], 0
  v_mfma_f32_16x16x32_bf16 v[116:119], v[88:91], a[216:219], 0
  v_mfma_f32_16x16x32_bf16 v[112:115], v[68:71], a[220:223], v[112:115]
  v_mfma_f32_16x16x32_bf16 v[116:119], v[92:95], a[220:223], v[116:119]
  v_mfma_f32_16x16x32_bf16 v[112:115], v[72:75], a[224:227], v[112:115]
  v_mfma_f32_16x16x32_bf16 v[116:119], v[96:99], a[224:227], v[116:119]
  v_mfma_f32_16x16x32_bf16 v[112:115], v[76:79], a[228:231], v[112:115]
  v_mfma_f32_16x16x32_bf16 v[116:119], v[100:103], a[228:231], v[116:119]
  v_cvt_pk_bf16_f32 v144, v128, v129
  v_cvt_pk_bf16_f32 v145, v130, v131
  v_mfma_f32_16x16x32_bf16 v[112:115], v[80:83], a[232:235], v[112:115]
  v_cvt_pk_bf16_f32 v146, v132, v133
  v_cvt_pk_bf16_f32 v147, v134, v135
  v_mfma_f32_16x16x32_bf16 v[116:119], v[104:107], a[232:235], v[116:119]
  s_add_u32 s58, s55, 1048576
  buffer_store_dwordx4 v[144:147], v5, s[8:11], s58 offen sc1
  v_mfma_f32_16x16x32_bf16 v[112:115], v[84:87], a[236:239], v[112:115]
  v_mfma_f32_16x16x32_bf16 v[116:119], v[108:111], a[236:239], v[116:119]
  s_nop 6
  v_cvt_pk_bf16_f32 v136, v112, v113
  v_cvt_pk_bf16_f32 v137, v114, v115
  v_cvt_pk_bf16_f32 v138, v116, v117
  v_cvt_pk_bf16_f32 v139, v118, v119
  s_add_u32 s58, s55, 1179648
  buffer_store_dwordx4 v[136:139], v5, s[8:11], s58 offen sc1
  s_add_u32 s55, s55, 1310720
  s_waitcnt vmcnt(10)
  v_mov_b32 v8, s52
  s_mov_b64 exec, 1
  buffer_store_dword v8, v7, s[8:11], 0 offen sc1
  s_mov_b64 exec, -1
u_nofl_18:
  s_add_u32 s52, s52, 1
  s_cmp_lt_u32 s52, 64
  s_cbranch_scc1 u_loop_8
  s_waitcnt vmcnt(0)
  v_mov_b32 v8, s52
  s_mov_b64 exec, 1
  buffer_store_dword v8, v7, s[8:11], 0 offen sc1
  s_mov_b64 exec, -1
L_parta:
  s_barrier
  s_lshl_b32 s65, s44, 2
  s_add_u32 s65, s65, s43
  s_sub_u32 s65, s65, 4
  s_cmp_ge_u32 s65, 120
  s_cbranch_scc1 pa_att
  s_mov_b32 s4, s18
  s_mov_b32 s5, s19
  s_mov_b32 s6, 2457600
  s_mov_b32 s7, 0x20000
  s_mov_b32 s12, s16
  s_mov_b32 s13, s17
  s_mov_b32 s14, 2621440
  s_mov_b32 s15, 0x20000
  s_mul_i32 s46, s65, 205
  s_lshr_b32 s46, s46, 11
  s_mul_i32 s47, s46, 10
  s_sub_u32 s47, s65, s47
  s_mul_i32 s60, s47, 384
  s_mul_i32 s63, s47, 786432
  s_add_u32 s63, s63, 197132288
  s_mul_i32 s61, s46, 6
  s_add_u32 s62, s61, 6
  s_mul_i32 s48, s46, 3
  s_add_u32 s49, s48, 31
  s_add_u32 s48, s48, 28
  s_min_u32 s61, s61, s48
  s_min_u32 s62, s62, s49
  s_lshl_b32 s64, s65, 7
  s_add_u32 s64, s64, 2998272
  v_lshrrev_b32 v10, 3, v0
  v_lshrrev_b32 v11, 2, v10
  v_lshlrev_b32 v11, 3, v11
  v_and_b32 v1, 3, v10
  v_add_u32 v1, v1, v11
  s_and_b32 s46, s42, 1
  s_lshl_b32 s46, s46, 2
  s_lshr_b32 s47, s42, 1
  s_lshl_b32 s47, s47, 4
  s_add_u32 s46, s46, s47
  v_add_u32 v1, s46, v1
  v_mul_u32_u24 v1, 3840, v1
  v_lshrrev_b32 v10, 1, v10
  v_bfe_u32 v11, v0, 1, 2
  v_xor_b32 v10, v10, v11
  v_lshlrev_b32 v10, 5, v10
  v_and_b32 v11, 1, v0
  v_lshlrev_b32 v11, 4, v11
  v_add3_u32 v1, v1, v10, v11
  v_lshrrev_b32 v10, 5, v0
  v_lshlrev_b32 v2, 11, v10
  v_bfe_u32 v10, v0, 2, 3
  v_lshl_add_u32 v2, v10, 7, v2
  v_lshrrev_b32 v10, 1, v10
  v_xor_b32 v10, s42, v10
  v_lshl_add_u32 v2, v10, 5, v2
  v_and_b32 v10, 3, v0
  v_lshl_add_u32 v2, v10, 3, v2
  v_add_u32 v3, 0x10000, v2
  v_add_u32 v4, 0x20000, v2
  v_lshrrev_b32 v10, 3, v0
  s_lshl_b32 s46, s42, 3
  v_add_u32 v10, s46, v10
  v_mul_u32_u24 v5, 1280, v10
  v_bfe_u32 v10, v10, 1, 3
  v_and_b32 v11, 7, v0
  v_xor_b32 v10, v10, v11
  v_lshl_add_u32 v5, v10, 4, v5
  v_and_b32 v10, 15, v0
  v_lshlrev_b32 v6, 7, v10
  v_lshrrev_b32 v10, 1, v10
  v_lshrrev_b32 v11, 4, v0
  v_xor_b32 v10, v10, v11
  v_lshl_add_u32 v6, v10, 4, v6
  v_add_u32 v6, 122880, v6
  v_xor_b32 v7, 64, v6
  v_and_b32 v10, 15, v0
  v_lshlrev_b32 v8, 4, v10
  v_bfe_u32 v10, v0, 4, 1
  v_mul_u32_u24 v10, 6144, v10
  v_lshrrev_b32 v11, 5, v0
  v_lshlrev_b32 v11, 8, v11
  v_add3_u32 v8, v8, v10, v11
  s_lshl_b32 s46, s42, 9
  v_add_u32 v8, s46, v8
  v_mov_b32 v9, s64
  s_mov_b32 s52, s61
  s_mul_i32 s53, s52, 40960
  s_add_u32 s54, s51, 122880
  s_add_u32 m0, s54, 0
  s_nop 0
  buffer_load_dwordx4 v5, s[12:15], s53 offen offset:0 lds
  s_add_u32 m0, s54, 3968
  s_nop 0
  buffer_load_dwordx4 v5, s[12:15], s53 offen offset:128 lds
  s_add_u32 m0, s54, 7936
  s_nop 0
  buffer_load_dwordx4 v5, s[12:15], s53 offen offset:256 lds
  s_add_u32 m0, s54, 11904
  s_nop 0
  buffer_load_dwordx4 v5, s[12:15], s53 offen offset:384 lds
  s_add_u32 m0, s54, 15872
  s_nop 0
  buffer_load_dwordx4 v5, s[12:15], s53 offen offset:512 lds
  s_add_u32 m0, s54, 19840
  s_nop 0
  buffer_load_dwordx4 v5, s[12:15], s53 offen offset:640 lds
  s_add_u32 m0, s54, 23808
  s_nop 0
  buffer_load_dwordx4 v5, s[12:15], s53 offen offset:768 lds
  s_add_u32 m0, s54, 27776
  s_nop 0
  buffer_load_dwordx4 v5, s[12:15], s53 offen offset:896 lds
  s_add_u32 m0, s54, 31744
  s_nop 0
  buffer_load_dwordx4 v5, s[12:15], s53 offen offset:1024 lds
  s_add_u32 m0, s54, 35712
  s_nop 0
  buffer_load_dwordx4 v5, s[12:15], s53 offen offset:1152 lds
  s_add_u32 m0, s51, 0
  s_add_u32 s46, s60, 0
  buffer_load_dwordx4 v1, s[4:7], s46 offen lds
  s_add_u32 m0, s51, 4096
  s_add_u32 s46, s60, 128
  buffer_load_dwordx4 v1, s[4:7], s46 offen lds
  s_add_u32 m0, s51, 8192
  s_add_u32 s46, s60, 256
  buffer_load_dwordx4 v1, s[4:7], s46 offen lds
  s_add_u32 m0, s51, 12288
  s_add_u32 s46, s60, 122880
  buffer_load_dwordx4 v1, s[4:7], s46 offen lds
  s_add_u32 m0, s51, 16384
  s_add_u32 s46, s60, 123008
  buffer_load_dwordx4 v1, s[4:7], s46 offen lds
  s_add_u32 m0, s51, 20480
  s_add_u32 s46, s60, 123136
  buffer_load_dwordx4 v1, s[4:7], s46 offen lds
  s_add_u32 m0, s51, 24576
  s_add_u32 s46, s60, 245760
  buffer_load_dwordx4 v1, s[4:7], s46 offen lds
  s_add_u32 m0, s51, 28672
  s_add_u32 s46, s60, 245888
  buffer_load_dwordx4 v1, s[4:7], s46 offen lds
  s_add_u32 m0, s51, 32768
  s_add_u32 s46, s60, 246016
  buffer_load_dwordx4 v1, s[4:7], s46 offen lds
  s_add_u32 m0, s51, 36864
  s_add_u32 s46, s60, 368640
  buffer_load_dwordx4 v1, s[4:7], s46 offen lds
  s_add_u32 m0, s51, 40960
  s_add_u32 s46, s60, 368768
  buffer_load_dwordx4 v1, s[4:7], s46 offen lds
  s_add_u32 m0, s51, 45056
  s_add_u32 s46, s60, 368896
  buffer_load_dwordx4 v1, s[4:7], s46 offen lds
  s_add_u32 m0, s51, 49152
  s_add_u32 s46, s60, 491520
  buffer_load_dwordx4 v1, s[4:7], s46 offen lds
  s_add_u32 m0, s51, 53248
  s_add_u32 s46, s60, 491648
  buffer_load_dwordx4 v1, s[4:7], s46 offen lds
  s_add_u32 m0, s51, 57344
  s_add_u32 s46, s60, 491776
  buffer_load_dwordx4 v1, s[4:7], s46 offen lds
  s_add_u32 m0, s51, 61440
  s_add_u32 s46, s60, 614400
  buffer_load_dwordx4 v1, s[4:7], s46 offen lds
  s_add_u32 m0, s51, 65536
  s_add_u32 s46, s60, 614528
  buffer_load_dwordx4 v1, s[4:7], s46 offen lds
  s_add_u32 m0, s51, 69632
  s_add_u32 s46, s60, 614656
  buffer_load_dwordx4 v1, s[4:7], s46 offen lds
  s_add_u32 m0, s51, 73728
  s_add_u32 s46, s60, 737280
  buffer_load_dwordx4 v1, s[4:7], s46 offen lds
  s_add_u32 m0, s51, 77824
  s_add_u32 s46, s60, 737408
  buffer_load_dwordx4 v1, s[4:7], s46 offen lds
  s_add_u32 m0, s51, 81920
  s_add_u32 s46, s60, 737536
  buffer_load_dwordx4 v1, s[4:7], s46 offen lds
  s_add_u32 m0, s51, 86016
  s_add_u32 s46, s60, 860160
  buffer_load_dwordx4 v1, s[4:7], s46 offen lds
  s_add_u32 m0, s51, 90112
  s_add_u32 s46, s60, 860288
  buffer_load_dwordx4 v1, s[4:7], s46 offen lds
  s_add_u32 m0, s51, 94208
  s_add_u32 s46, s60, 860416
  buffer_load_dwordx4 v1, s[4:7], s46 offen lds
  s_waitcnt vmcnt(18)
  s_barrier
  s_add_u32 m0, s51, 98304
  s_add_u32 s46, s60, 983040
  buffer_load_dwordx4 v1, s[4:7], s46 offen lds
  s_add_u32 m0, s51, 102400
  s_add_u32 s46, s60, 983168
  buffer_load_dwordx4 v1, s[4:7], s46 offen lds
  s_add_u32 m0, s51, 106496
  s_add_u32 s46, s60, 983296
  buffer_load_dwordx4 v1, s[4:7], s46 offen lds
  s_add_u32 m0, s51, 110592
  s_add_u32 s46, s60, 1105920
  buffer_load_dwordx4 v1, s[4:7], s46 offen lds
  s_add_u32 m0, s51, 114688
  s_add_u32 s46, s60, 1106048
  buffer_load_dwordx4 v1, s[4:7], s46 offen lds
  s_add_u32 m0, s51, 118784
  s_add_u32 s46, s60, 1106176
  buffer_load_dwordx4 v1, s[4:7], s46 offen lds
  ds_read_b64_tr_b16 a[0:1], v2 offset:0
  ds_read_b64_tr_b16 a[2:3], v2 offset:1024
  ds_read_b64_tr_b16 a[4:5], v2 offset:4096
  ds_read_b64_tr_b16 a[6:7], v2 offset:5120
  ds_read_b64_tr_b16 a[8:9], v2 offset:8192
  ds_read_b64_tr_b16 a[10:11], v2 offset:9216
  ds_read_b64_tr_b16 a[12:13], v2 offset:12288
  ds_read_b64_tr_b16 a[14:15], v2 offset:13312
  ds_read_b64_tr_b16 a[16:17], v2 offset:16384
  ds_read_b64_tr_b16 a[18:19], v2 offset:17408
  ds_read_b64_tr_b16 a[20:21], v2 offset:20480
  ds_read_b64_tr_b16 a[22:23], v2 offset:21504
  s_waitcnt lgkmcnt(0)
  s_waitcnt vmcnt(18)
  s_barrier
  s_add_u32 m0, s51, 0
  s_add_u32 s46, s60, 1228800
  buffer_load_dwordx4 v1, s[4:7], s46 offen lds
  s_add_u32 m0, s51, 4096
  s_add_u32 s46, s60, 1228928
  buffer_load_dwordx4 v1, s[4:7], s46 offen lds
  s_add_u32 m0, s51, 8192
  s_add_u32 s46, s60, 1229056
  buffer_load_dwordx4 v1, s[4:7], s46 offen lds
  s_add_u32 m0, s51, 12288
  s_add_u32 s46, s60, 1351680
  buffer_load_dwordx4 v1, s[4:7], s46 offen lds
  s_add_u32 m0, s51, 16384
  s_add_u32 s46, s60, 1351808
  buffer_load_dwordx4 v1, s[4:7], s46 offen lds
  s_add_u32 m0, s51, 20480
  s_add_u32 s46, s60, 1351936
  buffer_load_dwordx4 v1, s[4:7], s46 offen lds
  ds_read_b64_tr_b16 a[24:25], v2 offset:24576
  ds_read_b64_tr_b16 a[26:27], v2 offset:25600
  ds_read_b64_tr_b16 a[28:29], v2 offset:28672
  ds_read_b64_tr_b16 a[30:31], v2 offset:29696
  ds_read_b64_tr_b16 a[32:33], v2 offset:32768
  ds_read_b64_tr_b16 a[34:35], v2 offset:33792
  ds_read_b64_tr_b16 a[36:37], v2 offset:36864
  ds_read_b64_tr_b16 a[38:39], v2 offset:37888
  ds_read_b64_tr_b16 a[40:41], v2 offset:40960
  ds_read_b64_tr_b16 a[42:43], v2 offset:41984
  ds_read_b64_tr_b16 a[44:45], v2 offset:45056
  ds_read_b64_tr_b16 a[46:47], v2 offset:46080
  s_waitcnt lgkmcnt(0)
  s_waitcnt vmcnt(18)
  s_barrier
  s_add_u32 m0, s51, 24576
  s_add_u32 s46, s60, 1474560
  buffer_load_dwordx4 v1, s[4:7], s46 offen lds
  s_add_u32 m0, s51, 28672
  s_add_u32 s46, s60, 1474688
  buffer_load_dwordx4 v1, s[4:7], s46 offen lds
  s_add_u32 m0, s51, 32768
  s_add_u32 s46, s60, 1474816
  buffer_load_dwordx4 v1, s[4:7], s46 offen lds
  s_add_u32 m0, s51, 36864
  s_add_u32 s46, s60, 1597440
  buffer_load_dwordx4 v1, s[4:7], s46 offen lds
  s_add_u32 m0, s51, 40960
  s_add_u32 s46, s60, 1597568
  buffer_load_dwordx4 v1, s[4:7], s46 offen lds
  s_add_u32 m0, s51, 45056
  s_add_u32 s46, s60, 1597696
  buffer_load_dwordx4 v1, s[4:7], s46 offen lds
  ds_read_b64_tr_b16 a[48:49], v2 offset:49152
  ds_read_b64_tr_b16 a[50:51], v2 offset:50176
  ds_read_b64_tr_b16 a[52:53], v2 offset:53248
  ds_read_b64_tr_b16 a[54:55], v2 offset:54272
  ds_read_b64_tr_b16 a[56:57], v2 offset:57344
  ds_read_b64_tr_b16 a[58:59], v2 offset:58368
  ds_read_b64_tr_b16 a[60:61], v2 offset:61440
  ds_read_b64_tr_b16 a[62:63], v2 offset:62464
  ds_read_b64_tr_b16 a[64:65], v3 offset:0
  ds_read_b64_tr_b16 a[66:67], v3 offset:1024
  ds_read_b64_tr_b16 a[68:69], v3 offset:4096
  ds_read_b64_tr_b16 a[70:71], v3 offset:5120
  s_waitcnt lgkmcnt(0)
  s_waitcnt vmcnt(18)
  s_barrier
  s_add_u32 m0, s51, 49152
  s_add_u32 s46, s60, 1720320
  buffer_load_dwordx4 v1, s[4:7], s46 offen lds
  s_add_u32 m0, s51, 53248
  s_add_u32 s46, s60, 1720448
  buffer_load_dwordx4 v1, s[4:7], s46 offen lds
  s_add_u32 m0, s51, 57344
  s_add_u32 s46, s60, 1720576
  buffer_load_dwordx4 v1, s[4:7], s46 offen lds
  s_add_u32 m0, s51, 61440
  s_add_u32 s46, s60, 1843200
  buffer_load_dwordx4 v1, s[4:7], s46 offen lds
  s_add_u32 m0, s51, 65536
  s_add_u32 s46, s60, 1843328
  buffer_load_dwordx4 v1, s[4:7], s46 offen lds
  s_add_u32 m0, s51, 69632
  s_add_u32 s46, s60, 1843456
  buffer_load_dwordx4 v1, s[4:7], s46 offen lds
  ds_read_b64_tr_b16 a[72:73], v3 offset:8192
  ds_read_b64_tr_b16 a[74:75], v3 offset:9216
  ds_read_b64_tr_b16 a[76:77], v3 offset:12288
  ds_read_b64_tr_b16 a[78:79], v3 offset:13312
  ds_read_b64_tr_b16 a[80:81], v3 offset:16384
  ds_read_b64_tr_b16 a[82:83], v3 offset:17408
  ds_read_b64_tr_b16 a[84:85], v3 offset:20480
  ds_read_b64_tr_b16 a[86:87], v3 offset:21504
  ds_read_b64_tr_b16 a[88:89], v3 offset:24576
  ds_read_b64_tr_b16 a[90:91], v3 offset:25600
  ds_read_b64_tr_b16 a[92:93], v3 offset:28672
  ds_read_b64_tr_b16 a[94:95], v3 offset:29696
  s_waitcnt lgkmcnt(0)
  s_waitcnt vmcnt(18)
  s_barrier
  s_add_u32 m0, s51, 73728
  s_add_u32 s46, s60, 1966080
  buffer_load_dwordx4 v1, s[4:7], s46 offen lds
  s_add_u32 m0, s51, 77824
  s_add_u32 s46, s60, 1966208
  buffer_load_dwordx4 v1, s[4:7], s46 offen lds
  s_add_u32 m0, s51, 81920
  s_add_u32 s46, s60, 1966336
  buffer_load_dwordx4 v1, s[4:7], s46 offen lds
  s_add_u32 m0, s51, 86016
  s_add_u32 s46, s60, 2088960
  buffer_load_dwordx4 v1, s[4:7], s46 offen lds
  s_add_u32 m0, s51, 90112
  s_add_u32 s46, s60, 2089088
  buffer_load_dwordx4 v1, s[4:7], s46 offen lds
  s_add_u32 m0, s51, 94208
  s_add_u32 s46, s60, 2089216
  buffer_load_dwordx4 v1, s[4:7], s46 offen lds
  ds_read_b64_tr_b16 a[96:97], v3 offset:32768
  ds_read_b64_tr_b16 a[98:99], v3 offset:33792
  ds_read_b64_tr_b16 a[100:101], v3 offset:36864
  ds_read_b64_tr_b16 a[102:103], v3 offset:37888
  ds_read_b64_tr_b16 a[104:105], v3 offset:40960
  ds_read_b64_tr_b16 a[106:107], v3 offset:41984
  ds_read_b64_tr_b16 a[108:109], v3 offset:45056
  ds_read_b64_tr_b16 a[110:111], v3 offset:46080
  ds_read_b64_tr_b16 a[112:113], v3 offset:49152
  ds_read_b64_tr_b16 a[114:115], v3 offset:50176
  ds_read_b64_tr_b16 a[116:117], v3 offset:53248
  ds_read_b64_tr_b16 a[118:119], v3 offset:54272
  s_waitcnt lgkmcnt(0)
  s_waitcnt vmcnt(18)
  s_barrier
  s_add_u32 m0, s51, 98304
  s_add_u32 s46, s60, 2211840
  buffer_load_dwordx4 v1, s[4:7], s46 offen lds
  s_add_u32 m0, s51, 102400
  s_add_u32 s46, s60, 2211968
  buffer_load_dwordx4 v1, s[4:7], s46 offen lds
  s_add_u32 m0, s51, 106496
  s_add_u32 s46, s60, 2212096
  buffer_load_dwordx4 v1, s[4:7], s46 offen lds
  s_add_u32 m0, s51, 110592
  s_add_u32 s46, s60, 2334720
  buffer_load_dwordx4 v1, s[4:7], s46 offen lds
  s_add_u32 m0, s51, 114688
  s_add_u32 s46, s60, 2334848
  buffer_load_dwordx4 v1, s[4:7], s46 offen lds
  s_add_u32 m0, s51, 118784
  s_add_u32 s46, s60, 2334976
  buffer_load_dwordx4 v1, s[4:7], s46 offen lds
  ds_read_b64_tr_b16 a[120:121], v2 offset:0
  ds_read_b64_tr_b16 a[122:123], v2 offset:1024
  ds_read_b64_tr_b16 a[124:125], v2 offset:4096
  ds_read_b64_tr_b16 a[126:127], v2 offset:5120
  ds_read_b64_tr_b16 a[128:129], v2 offset:8192
  ds_read_b64_tr_b16 a[130:131], v2 offset:9216
  ds_read_b64_tr_b16 a[132:133], v2 offset:12288
  ds_read_b64_tr_b16 a[134:135], v2 offset:13312
  ds_read_b64_tr_b16 a[136:137], v2 offset:16384
  ds_read_b64_tr_b16 a[138:139], v2 offset:17408
  ds_read_b64_tr_b16 a[140:141], v2 offset:20480
  ds_read_b64_tr_b16 a[142:143], v2 offset:21504
  s_waitcnt lgkmcnt(0)
  s_waitcnt vmcnt(18)
  s_barrier
  ds_read_b64_tr_b16 a[144:145], v2 offset:24576
  ds_read_b64_tr_b16 a[146:147], v2 offset:25600
  ds_read_b64_tr_b16 a[148:149], v2 offset:28672
  ds_read_b64_tr_b16 a[150:151], v2 offset:29696
  ds_read_b64_tr_b16 a[152:153], v2 offset:32768
  ds_read_b64_tr_b16 a[154:155], v2 offset:33792
  ds_read_b64_tr_b16 a[156:157], v2 offset:36864
  ds_read_b64_tr_b16 a[158:159], v2 offset:37888
  ds_read_b64_tr_b16 a[160:161], v2 offset:40960
  ds_read_b64_tr_b16 a[162:163], v2 offset:41984
  ds_read_b64_tr_b16 a[164:165], v2 offset:45056
  ds_read_b64_tr_b16 a[166:167], v2 offset:46080
  s_waitcnt lgkmcnt(0)
  s_waitcnt vmcnt(12)
  s_barrier
  ds_read_b64_tr_b16 a[168:169], v2 offset:49152
  ds_read_b64_tr_b16 a[170:171], v2 offset:50176
  ds_read_b64_tr_b16 a[172:173], v2 offset:53248
  ds_read_b64_tr_b16 a[174:175], v2 offset:54272
  ds_read_b64_tr_b16 a[176:177], v2 offset:57344
  ds_read_b64_tr_b16 a[178:179], v2 offset:58368
  ds_read_b64_tr_b16 a[180:181], v2 offset:61440
  ds_read_b64_tr_b16 a[182:183], v2 offset:62464
  ds_read_b64_tr_b16 a[184:185], v3 offset:0
  ds_read_b64_tr_b16 a[186:187], v3 offset:1024
  ds_read_b64_tr_b16 a[188:189], v3 offset:4096
  ds_read_b64_tr_b16 a[190:191], v3 offset:5120
  s_waitcnt lgkmcnt(0)
  s_waitcnt vmcnt(6)
  s_barrier
  ds_read_b64_tr_b16 a[192:193], v3 offset:8192
  ds_read_b64_tr_b16 a[194:195], v3 offset:9216
  ds_read_b64_tr_b16 a[196:197], v3 offset:12288
  ds_read_b64_tr_b16 a[198:199], v3 offset:13312
  ds_read_b64_tr_b16 a[200:201], v3 offset:16384
  ds_read_b64_tr_b16 a[202:203], v3 offset:17408
  ds_read_b64_tr_b16 a[204:205], v3 offset:20480
  ds_read_b64_tr_b16 a[206:207], v3 offset:21504
  ds_read_b64_tr_b16 a[208:209], v3 offset:24576
  ds_read_b64_tr_b16 a[210:211], v3 offset:25600
  ds_read_b64_tr_b16 a[212:213], v3 offset:28672
  ds_read_b64_tr_b16 a[214:215], v3 offset:29696
  s_waitcnt lgkmcnt(0)
  s_waitcnt vmcnt(0)
  s_barrier
  ds_read_b64_tr_b16 a[216:217], v3 offset:32768
  ds_read_b64_tr_b16 a[218:219], v3 offset:33792
  ds_read_b64_tr_b16 a[220:221], v3 offset:36864
  ds_read_b64_tr_b16 a[222:223], v3 offset:37888
  ds_read_b64_tr_b16 a[224:225], v3 offset:40960
  ds_read_b64_tr_b16 a[226:227], v3 offset:41984
  ds_read_b64_tr_b16 a[228:229], v3 offset:45056
  ds_read_b64_tr_b16 a[230:231], v3 offset:46080
  ds_read_b64_tr_b16 a[232:233], v3 offset:49152
  ds_read_b64_tr_b16 a[234:235], v3 offset:50176
  ds_read_b64_tr_b16 a[236:237], v3 offset:53248
  ds_read_b64_tr_b16 a[238:239], v3 offset:54272
  s_waitcnt lgkmcnt(0)
  s_barrier
pa_loop_21:
  s_add_u32 s57, s52, 1
  s_xor_b32 s54, s54, 122880
  s_add_u32 s53, s53, 40960
  ds_read_b128 v[16:19], v6 offset:0
  ds_read_b128 v[20:23], v6 offset:2048
  ds_read_b128 v[24:27], v7 offset:0
  ds_read_b128 v[28:31], v7 offset:2048
  ds_read_b128 v[32:35], v6 offset:4096
  s_waitcnt lgkmcnt(4)
  v_mfma_f32_16x16x32_bf16 v[40:43], a[0:3], v[16:19], 0
  s_add_u32 m0, s54, 0
  v_mfma_f32_16x16x32_bf16 v[48:51], a[4:7], v[16:19], 0
  buffer_load_dwordx4 v5, s[12:15], s53 offen offset:0 lds
  v_mfma_f32_16x16x32_bf16 v[56:59], a[8:11], v[16:19], 0
  ds_read_b128 v[36:39], v6 offset:6144
  s_waitcnt lgkmcnt(4)
  v_mfma_f32_16x16x32_bf16 v[44:47], a[0:3], v[20:23], 0
  v_mfma_f32_16x16x32_bf16 v[52:55], a[4:7], v[20:23], 0
  v_mfma_f32_16x16x32_bf16 v[60:63], a[8:11], v[20:23], 0
  ds_read_b128 v[16:19], v7 offset:4096
  s_waitcnt lgkmcnt(4)
  v_mfma_f32_16x16x32_bf16 v[40:43], a[12:15], v[24:27], v[40:43]
  s_add_u32 m0, s54, 3968
  v_mfma_f32_16x16x32_bf16 v[48:51], a[16:19], v[24:27], v[48:51]
  buffer_load_dwordx4 v5, s[12:15], s53 offen offset:128 lds
  v_mfma_f32_16x16x32_bf16 v[56:59], a[20:23], v[24:27], v[56:59]
  ds_read_b128 v[20:23], v7 offset:6144
  s_waitcnt lgkmcnt(4)
  v_mfma_f32_16x16x32_bf16 v[44:47], a[12:15], v[28:31], v[44:47]
  v_mfma_f32_16x16x32_bf16 v[52:55], a[16:19], v[28:31], v[52:55]
  v_mfma_f32_16x16x32_bf16 v[60:63], a[20:23], v[28:31], v[60:63]
  ds_read_b128 v[24:27], v6 offset:8192
  s_waitcnt lgkmcnt(4)
  v_mfma_f32_16x16x32_bf16 v[40:43], a[24:27], v[32:35], v[40:43]
  s_add_u32 m0, s54, 7936
  v_mfma_f32_16x16x32_bf16 v[48:51], a[28:31], v[32:35], v[48:51]
  buffer_load_dwordx4 v5, s[12:15], s53 offen offset:256 lds
  v_mfma_f32_16x16x32_bf16 v[56:59], a[32:35], v[32:35], v[56:59]
  ds_read_b128 v[28:31], v6 offset:10240
  s_waitcnt lgkmcnt(4)
  v_mfma_f32_16x16x32_bf16 v[44:47], a[24:27], v[36:39], v[44:47]
  v_mfma_f32_16x16x32_bf16 v[52:55], a[28:31], v[36:39], v[52:55]
  v_mfma_f32_16x16x32_bf16 v[60:63], a[32:35], v[36:39], v[60:63]
  ds_read_b128 v[32:35], v7 offset:8192
  s_waitcnt lgkmcnt(4)
  v_mfma_f32_16x16x32_bf16 v[40:43], a[36:39], v[16:19], v[40:43]
  s_add_u32 m0, s54, 11904
  v_mfma_f32_16x16x32_bf16 v[48:51], a[40:43], v[16:19], v[48:51]
  buffer_load_dwordx4 v5, s[12:15], s53 offen offset:384 lds
  v_mfma_f32_16x16x32_bf16 v[56:59], a[44:47], v[16:19], v[56:59]
  ds_read_b128 v[36:39], v7 offset:10240
  s_waitcnt lgkmcnt(4)
  v_mfma_f32_16x16x32_bf16 v[44:47], a[36:39], v[20:23], v[44:47]
  v_mfma_f32_16x16x32_bf16 v[52:55], a[40:43], v[20:23], v[52:55]
  v_mfma_f32_16x16x32_bf16 v[60:63], a[44:47], v[20:23], v[60:63]
  ds_read_b128 v[16:19], v6 offset:12288
  s_waitcnt lgkmcnt(4)
  v_mfma_f32_16x16x32_bf16 v[40:43], a[48:51], v[24:27], v[40:43]
  s_add_u32 m0, s54, 15872
  v_mfma_f32_16x16x32_bf16 v[48:51], a[52:55], v[24:27], v[48:51]
  buffer_load_dwordx4 v5, s[12:15], s53 offen offset:512 lds
  v_mfma_f32_16x16x32_bf16 v[56:59], a[56:59], v[24:27], v[56:59]
  ds_read_b128 v[20:23], v6 offset:14336
  s_waitcnt lgkmcnt(4)
  v_mfma_f32_16x16x32_bf16 v[44:47], a[48:51], v[28:31], v[44:47]
  v_mfma_f32_16x16x32_bf16 v[52:55], a[52:55], v[28:31], v[52:55]
  v_mfma_f32_16x16x32_bf16 v[60:63], a[56:59], v[28:31], v[60:63]
  ds_read_b128 v[24:27], v7 offset:12288
  s_waitcnt lgkmcnt(4)
  v_mfma_f32_16x16x32_bf16 v[40:43], a[60:63], v[32:35], v[40:43]
  s_add_u32 m0, s54, 19840
  v_mfma_f32_16x16x32_bf16 v[48:51], a[64:67], v[32:35], v[48:51]
  buffer_load_dwordx4 v5, s[12:15], s53 offen offset:640 lds
  v_mfma_f32_16x16x32_bf16 v[56:59], a[68:71], v[32:35], v[56:59]
  ds_read_b128 v[28:31], v7 offset:14336
  s_waitcnt lgkmcnt(4)
  v_mfma_f32_16x16x32_bf16 v[44:47], a[60:63], v[36:39], v[44:47]
  v_mfma_f32_16x16x32_bf16 v[52:55], a[64:67], v[36:39], v[52:55]
  v_mfma_f32_16x16x32_bf16 v[60:63], a[68:71], v[36:39], v[60:63]
  ds_read_b128 v[32:35], v6 offset:16384
  s_waitcnt lgkmcnt(4)
  v_mfma_f32_16x16x32_bf16 v[40:43], a[72:75], v[16:19], v[40:43]
  s_add_u32 m0, s54, 23808
  v_mfma_f32_16x16x32_bf16 v[48:51], a[76:79], v[16:19], v[48:51]
  buffer_load_dwordx4 v5, s[12:15], s53 offen offset:768 lds
  v_mfma_f32_16x16x32_bf16 v[56:59], a[80:83], v[16:19], v[56:59]
  ds_read_b128 v[36:39], v6 offset:18432
  s_waitcnt lgkmcnt(4)
  v_mfma_f32_16x16x32_bf16 v[44:47], a[72:75], v[20:23], v[44:47]
  v_mfma_f32_16x16x32_bf16 v[52:55], a[76:79], v[20:23], v[52:55]
  v_mfma_f32_16x16x32_bf16 v[60:63], a[80:83], v[20:23], v[60:63]
  ds_read_b128 v[16:19], v7 offset:16384
  s_waitcnt lgkmcnt(4)
  v_mfma_f32_16x16x32_bf16 v[40:43], a[84:87], v[24:27], v[40:43]
  s_add_u32 m0, s54, 27776
  v_mfma_f32_16x16x32_bf16 v[48:51], a[88:91], v[24:27], v[48:51]
  buffer_load_dwordx4 v5, s[12:15], s53 offen offset:896 lds
  v_mfma_f32_16x16x32_bf16 v[56:59], a[92:95], v[24:27], v[56:59]
  ds_read_b128 v[20:23], v7 offset:18432
  s_waitcnt lgkmcnt(4)
  v_mfma_f32_16x16x32_bf16 v[44:47], a[84:87], v[28:31], v[44:47]
  v_mfma_f32_16x16x32_bf16 v[52:55], a[88:91], v[28:31], v[52:55]
  v_mfma_f32_16x16x32_bf16 v[60:63], a[92:95], v[28:31], v[60:63]
  ds_read_b128 v[24:27], v6 offset:20480
  s_waitcnt lgkmcnt(4)
  v_mfma_f32_16x16x32_bf16 v[40:43], a[96:99], v[32:35], v[40:43]
  s_add_u32 m0, s54, 31744
  v_mfma_f32_16x16x32_bf16 v[48:51], a[100:103], v[32:35], v[48:51]
  buffer_load_dwordx4 v5, s[12:15], s53 offen offset:1024 lds
  v_mfma_f32_16x16x32_bf16 v[56:59], a[104:107], v[32:35], v[56:59]
  ds_read_b128 v[28:31], v6 offset:22528
  s_waitcnt lgkmcnt(4)
  v_mfma_f32_16x16x32_bf16 v[44:47], a[96:99], v[36:39], v[44:47]
  v_mfma_f32_16x16x32_bf16 v[52:55], a[100:103], v[36:39], v[52:55]
  v_mfma_f32_16x16x32_bf16 v[60:63], a[104:107], v[36:39], v[60:63]
  ds_read_b128 v[32:35], v7 offset:20480
  s_waitcnt lgkmcnt(4)
  v_mfma_f32_16x16x32_bf16 v[40:43], a[108:111], v[16:19], v[40:43]
  s_add_u32 m0, s54, 35712
  v_mfma_f32_16x16x32_bf16 v[48:51], a[112:115], v[16:19], v[48:51]
  buffer_load_dwordx4 v5, s[12:15], s53 offen offset:1152 lds
  v_mfma_f32_16x16x32_bf16 v[56:59], a[116:119], v[16:19], v[56:59]
  ds_read_b128 v[36:39], v7 offset:22528
  s_waitcnt lgkmcnt(4)
  v_mfma_f32_16x16x32_bf16 v[44:47], a[108:111], v[20:23], v[44:47]
  v_mfma_f32_16x16x32_bf16 v[52:55], a[112:115], v[20:23], v[52:55]
  v_mfma_f32_16x16x32_bf16 v[60:63], a[116:119], v[20:23], v[60:63]
  ds_read_b128 v[16:19], v6 offset:24576
  s_waitcnt lgkmcnt(4)
  v_mfma_f32_16x16x32_bf16 v[40:43], a[120:123], v[24:27], v[40:43]
  v_mfma_f32_16x16x32_bf16 v[48:51], a[124:127], v[24:27], v[48:51]
  v_mfma_f32_16x16x32_bf16 v[56:59], a[128:131], v[24:27], v[56:59]
  ds_read_b128 v[20:23], v6 offset:26624
  s_waitcnt lgkmcnt(4)
  v_mfma_f32_16x16x32_bf16 v[44:47], a[120:123], v[28:31], v[44:47]
  v_mfma_f32_16x16x32_bf16 v[52:55], a[124:127], v[28:31], v[52:55]
  v_mfma_f32_16x16x32_bf16 v[60:63], a[128:131], v[28:31], v[60:63]
  ds_read_b128 v[24:27], v7 offset:24576
  s_waitcnt lgkmcnt(4)
  v_mfma_f32_16x16x32_bf16 v[40:43], a[132:135], v[32:35], v[40:43]
  v_mfma_f32_16x16x32_bf16 v[48:51], a[136:139], v[32:35], v[48:51]
  v_mfma_f32_16x16x32_bf16 v[56:59], a[140:143], v[32:35], v[56:59]
  ds_read_b128 v[28:31], v7 offset:26624
  s_waitcnt lgkmcnt(4)
  v_mfma_f32_16x16x32_bf16 v[44:47], a[132:135], v[36:39], v[44:47]
  v_mfma_f32_16x16x32_bf16 v[52:55], a[136:139], v[36:39], v[52:55]
  v_mfma_f32_16x16x32_bf16 v[60:63], a[140:143], v[36:39], v[60:63]
  ds_read_b128 v[32:35], v6 offset:28672
  s_waitcnt lgkmcnt(4)
  v_mfma_f32_16x16x32_bf16 v[40:43], a[144:147], v[16:19], v[40:43]
  v_mfma_f32_16x16x32_bf16 v[48:51], a[148:151], v[16:19], v[48:51]
  v_mfma_f32_16x16x32_bf16 v[56:59], a[152:155], v[16:19], v[56:59]
  ds_read_b128 v[36:39], v6 offset:30720
  s_waitcnt lgkmcnt(4)
  v_mfma_f32_16x16x32_bf16 v[44:47], a[144:147], v[20:23], v[44:47]
  v_mfma_f32_16x16x32_bf16 v[52:55], a[148:151], v[20:23], v[52:55]
  v_mfma_f32_16x16x32_bf16 v[60:63], a[152:155], v[20:23], v[60:63]
  ds_read_b128 v[16:19], v7 offset:28672
  s_waitcnt lgkmcnt(4)
  v_mfma_f32_16x16x32_bf16 v[40:43], a[156:159], v[24:27], v[40:43]
  v_mfma_f32_16x16x32_bf16 v[48:51], a[160:163], v[24:27], v[48:51]
  v_mfma_f32_16x16x32_bf16 v[56:59], a[164:167], v[24:27], v[56:59]
  ds_read_b128 v[20:23], v7 offset:30720
  s_waitcnt lgkmcnt(4)
  v_mfma_f32_16x16x32_bf16 v[44:47], a[156:159], v[28:31], v[44:47]
  v_mfma_f32_16x16x32_bf16 v[52:55], a[160:163], v[28:31], v[52:55]
  v_mfma_f32_16x16x32_bf16 v[60:63], a[164:167], v[28:31], v[60:63]
  ds_read_b128 v[24:27], v6 offset:32768
  s_waitcnt lgkmcnt(4)
  v_mfma_f32_16x16x32_bf16 v[40:43], a[168:171], v[32:35], v[40:43]
  v_mfma_f32_16x16x32_bf16 v[48:51], a[172:175], v[32:35], v[48:51]
  v_mfma_f32_16x16x32_bf16 v[56:59], a[176:179], v[32:35], v[56:59]
  ds_read_b128 v[28:31], v6 offset:34816
  s_waitcnt lgkmcnt(4)
  v_mfma_f32_16x16x32_bf16 v[44:47], a[168:171], v[36:39], v[44:47]
  v_mfma_f32_16x16x32_bf16 v[52:55], a[172:175], v[36:39], v[52:55]
  v_mfma_f32_16x16x32_bf16 v[60:63], a[176:179], v[36:39], v[60:63]
  ds_read_b128 v[32:35], v7 offset:32768
  s_waitcnt lgkmcnt(4)
  v_mfma_f32_16x16x32_bf16 v[40:43], a[180:183], v[16:19], v[40:43]
  v_mfma_f32_16x16x32_bf16 v[48:51], a[184:187], v[16:19], v[48:51]
  v_mfma_f32_16x16x32_bf16 v[56:59], a[188:191], v[16:19], v[56:59]
  ds_read_b128 v[36:39], v7 offset:34816
  s_waitcnt lgkmcnt(4)
  v_mfma_f32_16x16x32_bf16 v[44:47], a[180:183], v[20:23], v[44:47]
  v_mfma_f32_16x16x32_bf16 v[52:55], a[184:187], v[20:23], v[52:55]
  v_mfma_f32_16x16x32_bf16 v[60:63], a[188:191], v[20:23], v[60:63]
  ds_read_b128 v[16:19], v6 offset:36864
  s_waitcnt lgkmcnt(4)
  v_mfma_f32_16x16x32_bf16 v[40:43], a[192:195], v[24:27], v[40:43]
  v_mfma_f32_16x16x32_bf16 v[48:51], a[196:199], v[24:27], v[48:51]
  v_mfma_f32_16x16x32_bf16 v[56:59], a[200:203], v[24:27], v[56:59]
  ds_read_b128 v[20:23], v6 offset:38912
  s_waitcnt lgkmcnt(4)
  v_mfma_f32_16x16x32_bf16 v[44:47], a[192:195], v[28:31], v[44:47]
  v_mfma_f32_16x16x32_bf16 v[52:55], a[196:199], v[28:31], v[52:55]
  v_mfma_f32_16x16x32_bf16 v[60:63], a[200:203], v[28:31], v[60:63]
  ds_read_b128 v[24:27], v7 offset:36864
  s_waitcnt lgkmcnt(4)
  v_mfma_f32_16x16x32_bf16 v[40:43], a[204:207], v[32:35], v[40:43]
  v_mfma_f32_16x16x32_bf16 v[48:51], a[208:211], v[32:35], v[48:51]
  v_mfma_f32_16x16x32_bf16 v[56:59], a[212:215], v[32:35], v[56:59]
  ds_read_b128 v[28:31], v7 offset:38912
  s_waitcnt lgkmcnt(4)
  v_mfma_f32_16x16x32_bf16 v[44:47], a[204:207], v[36:39], v[44:47]
  v_mfma_f32_16x16x32_bf16 v[52:55], a[208:211], v[36:39], v[52:55]
  v_mfma_f32_16x16x32_bf16 v[60:63], a[212:215], v[36:39], v[60:63]
  s_waitcnt lgkmcnt(3)
  v_mfma_f32_16x16x32_bf16 v[40:43], a[216:219], v[16:19], v[40:43]
  v_mfma_f32_16x16x32_bf16 v[48:51], a[220:223], v[16:19], v[48:51]
  v_mfma_f32_16x16x32_bf16 v[56:59], a[224:227], v[16:19], v[56:59]
  s_waitcnt lgkmcnt(2)
  v_mfma_f32_16x16x32_bf16 v[44:47], a[216:219], v[20:23], v[44:47]
  v_mfma_f32_16x16x32_bf16 v[52:55], a[220:223], v[20:23], v[52:55]
  v_mfma_f32_16x16x32_bf16 v[60:63], a[224:227], v[20:23], v[60:63]
  s_waitcnt lgkmcnt(1)
  v_mfma_f32_16x16x32_bf16 v[40:43], a[228:231], v[24:27], v[40:43]
  v_mfma_f32_16x16x32_bf16 v[48:51], a[232:235], v[24:27], v[48:51]
  v_mfma_f32_16x16x32_bf16 v[56:59], a[236:239], v[24:27], v[56:59]
  s_waitcnt lgkmcnt(0)
  v_mfma_f32_16x16x32_bf16 v[44:47], a[228:231], v[28:31], v[44:47]
  v_mfma_f32_16x16x32_bf16 v[52:55], a[232:235], v[28:31], v[52:55]
  v_mfma_f32_16x16x32_bf16 v[60:63], a[236:239], v[28:31], v[60:63]
  s_waitcnt vmcnt(0)
  s_barrier
  v_xor_b32 v6, 122880, v6
  v_xor_b32 v7, 122880, v7
  s_mul_i32 s55, s52, 12288
  s_add_u32 s55, s55, s63
  s_add_u32 s56, s55, 4096
  s_cmp_lg_u32 s42, 0
  s_cbranch_scc1 pa_noflag_23
  s_cmp_eq_u32 s52, s61
  s_cbranch_scc1 pa_noflag_23
  v_mov_b32 v10, s52
  s_mov_b64 exec, 1
  buffer_store_dword v10, v9, s[8:11], 0 offen sc1
  s_mov_b64 exec, -1
pa_noflag_23:
  v_cvt_pk_bf16_f32 v64, v40, v41
  v_cvt_pk_bf16_f32 v65, v42, v43
  v_cvt_pk_bf16_f32 v66, v44, v45
  v_cvt_pk_bf16_f32 v67, v46, v47
  v_cvt_pk_bf16_f32 v68, v48, v49
  v_cvt_pk_bf16_f32 v69, v50, v51
  v_cvt_pk_bf16_f32 v70, v52, v53
  v_cvt_pk_bf16_f32 v71, v54, v55
  v_cvt_pk_bf16_f32 v72, v56, v57
  v_cvt_pk_bf16_f32 v73, v58, v59
  v_cvt_pk_bf16_f32 v74, v60, v61
  v_cvt_pk_bf16_f32 v75, v62, v63
  v_permlane16_swap_b32 v64, v66
  v_permlane16_swap_b32 v65, v67
  buffer_store_dwordx4 v[64:67], v8, s[8:11], s55 offen offset:0 sc1
  v_permlane16_swap_b32 v68, v70
  v_permlane16_swap_b32 v69, v71
  buffer_store_dwordx4 v[68:71], v8, s[8:11], s55 offen offset:2048 sc1
  v_permlane16_swap_b32 v72, v74
  v_permlane16_swap_b32 v73, v75
  buffer_store_dwordx4 v[72:75], v8, s[8:11], s56 offen offset:0 sc1
  s_mov_b32 s52, s57
  s_cmp_lt_u32 s52, s62
  s_cbranch_scc1 pa_loop_21
  s_waitcnt vmcnt(0)
  s_barrier
  s_cmp_lg_u32 s42, 0
  s_cbranch_scc1 pa_fin_25
  v_mov_b32 v10, s52
  s_mov_b64 exec, 1
  buffer_store_dword v10, v9, s[8:11], 0 offen sc1
  s_mov_b64 exec, -1
pa_fin_25:
pa_att:
  v_min_u32 v1, 19, v0
  v_cmp_lt_u32 vcc, 9, v1
  s_lshl_b32 s46, s65, 4
  s_max_u32 s47, s46, 14
  s_sub_u32 s47, s47, 14
  s_lshr_b32 s47, s47, 5
  s_lshr_b32 s48, s46, 5
  v_mov_b32 v2, s47
  v_mov_b32 v3, s48
  v_cndmask_b32 v2, v2, v3, vcc
  v_subrev_u32 v3, 10, v1
  v_cndmask_b32 v1, v1, v3, vcc
  v_mul_u32_u24 v3, 171, v2
  v_lshrrev_b32 v3, 10, v3
  v_max_u32 v4, 28, v2
  v_subrev_u32 v4, 28, v4
  v_mul_u32_u24 v4, 171, v4
  v_lshrrev_b32 v4, 9, v4
  v_max_u32 v3, v3, v4
  v_mul_u32_u24 v3, 10, v3
  v_add_u32 v1, v1, v3
  v_lshlrev_b32 v1, 7, v1
  v_add_u32 v1, 2998272, v1
  v_lshrrev_b32 v3, 4, v0
  s_lshl_b32 s47, s42, 2
  v_add_u32 v3, s47, v3
  v_mul_u32_u24 v3, 5, v3
  s_mov_b32 s47, 780288
  v_add_u32 v8, 0, v3
  v_mul_u32_u24 v4, 171, v8
  v_lshrrev_b32 v4, 12, v4
  v_mul_lo_u32 v4, v4, s47
  v_lshl_add_u32 v8, v8, 8, v4
  v_add_u32 v9, 1, v3
  v_mul_u32_u24 v4, 171, v9
  v_lshrrev_b32 v4, 12, v4
  v_mul_lo_u32 v4, v4, s47
  v_lshl_add_u32 v9, v9, 8, v4
  v_add_u32 v10, 2, v3
  v_mul_u32_u24 v4, 171, v10
  v_lshrrev_b32 v4, 12, v4
  v_mul_lo_u32 v4, v4, s47
  v_lshl_add_u32 v10, v10, 8, v4
  v_add_u32 v11, 3, v3
  v_mul_u32_u24 v4, 171, v11
  v_lshrrev_b32 v4, 12, v4
  v_mul_lo_u32 v4, v4, s47
  v_lshl_add_u32 v11, v11, 8, v4
  v_add_u32 v12, 4, v3
  v_mul_u32_u24 v4, 171, v12
  v_lshrrev_b32 v4, 12, v4
  v_mul_lo_u32 v4, v4, s47
  v_lshl_add_u32 v12, v12, 8, v4
  v_add_u32 v13, 80, v3
  v_mul_u32_u24 v4, 171, v13
  v_lshrrev_b32 v4, 12, v4
  v_mul_lo_u32 v4, v4, s47
  v_lshl_add_u32 v13, v13, 8, v4
  v_add_u32 v14, 81, v3
  v_mul_u32_u24 v4, 171, v14
  v_lshrrev_b32 v4, 12, v4
  v_mul_lo_u32 v4, v4, s47
  v_lshl_add_u32 v14, v14, 8, v4
  v_add_u32 v15, 82, v3
  v_mul_u32_u24 v4, 171, v15
  v_lshrrev_b32 v4, 12, v4
  v_mul_lo_u32 v4, v4, s47
  v_lshl_add_u32 v15, v15, 8, v4
  v_add_u32 v16, 83, v3
  v_mul_u32_u24 v4, 171, v16
  v_lshrrev_b32 v4, 12, v4
  v_mul_lo_u32 v4, v4, s47
  v_lshl_add_u32 v16, v16, 8, v4
  v_add_u32 v17, 84, v3
  v_mul_u32_u24 v4, 171, v17
  v_lshrrev_b32 v4, 12, v4
  v_mul_lo_u32 v4, v4, s47
  v_lshl_add_u32 v17, v17, 8, v4
  v_add_u32 v18, 160, v3
  v_mul_u32_u24 v4, 171, v18
  v_lshrrev_b32 v4, 12, v4
  v_mul_lo_u32 v4, v4, s47
  v_lshl_add_u32 v18, v18, 8, v4
  v_add_u32 v19, 161, v3
  v_mul_u32_u24 v4, 171, v19
  v_lshrrev_b32 v4, 12, v4
  v_mul_lo_u32 v4, v4, s47
  v_lshl_add_u32 v19, v19, 8, v4
  v_add_u32 v20, 162, v3
  v_mul_u32_u24 v4, 171, v20
  v_lshrrev_b32 v4, 12, v4
  v_mul_lo_u32 v4, v4, s47
  v_lshl_add_u32 v20, v20, 8, v4
  v_add_u32 v21, 163, v3
  v_mul_u32_u24 v4, 171, v21
  v_lshrrev_b32 v4, 12, v4
  v_mul_lo_u32 v4, v4, s47
  v_lshl_add_u32 v21, v21, 8, v4
  v_add_u32 v22, 164, v3
  v_mul_u32_u24 v4, 171, v22
  v_lshrrev_b32 v4, 12, v4
  v_mul_lo_u32 v4, v4, s47
  v_lshl_add_u32 v22, v22, 8, v4
  v_and_b32 v5, 15, v0
  v_add_u32 v6, s46, v5
  v_subrev_u32 v4, 0, v6
  v_max_i32 v4, 0, v4
  v_and_b32 v23, 15, v4
  v_lshlrev_b32 v23, 4, v23
  v_lshrrev_b32 v4, 4, v4
  v_mul_u32_u24 v4, 6144, v4
  v_add_u32 v23, v23, v4
  v_cmp_gt_u32 s[72:73], 0, v6
  v_subrev_u32 v4, 2, v6
  v_max_i32 v4, 0, v4
  v_and_b32 v24, 15, v4
  v_lshlrev_b32 v24, 4, v24
  v_lshrrev_b32 v4, 4, v4
  v_mul_u32_u24 v4, 6144, v4
  v_add_u32 v24, v24, v4
  v_cmp_gt_u32 s[74:75], 2, v6
  v_subrev_u32 v4, 4, v6
  v_max_i32 v4, 0, v4
  v_and_b32 v25, 15, v4
  v_lshlrev_b32 v25, 4, v25
  v_lshrrev_b32 v4, 4, v4
  v_mul_u32_u24 v4, 6144, v4
  v_add_u32 v25, v25, v4
  v_cmp_gt_u32 s[76:77], 4, v6
  v_subrev_u32 v4, 6, v6
  v_max_i32 v4, 0, v4
  v_and_b32 v26, 15, v4
  v_lshlrev_b32 v26, 4, v26
  v_lshrrev_b32 v4, 4, v4
  v_mul_u32_u24 v4, 6144, v4
  v_add_u32 v26, v26, v4
  v_cmp_gt_u32 s[78:79], 6, v6
  v_subrev_u32 v4, 8, v6
  v_max_i32 v4, 0, v4
  v_and_b32 v27, 15, v4
  v_lshlrev_b32 v27, 4, v27
  v_lshrrev_b32 v4, 4, v4
  v_mul_u32_u24 v4, 6144, v4
  v_add_u32 v27, v27, v4
  v_cmp_gt_u32 s[80:81], 8, v6
  v_subrev_u32 v4, 10, v6
  v_max_i32 v4, 0, v4
  v_and_b32 v28, 15, v4
  v_lshlrev_b32 v28, 4, v28
  v_lshrrev_b32 v4, 4, v4
  v_mul_u32_u24 v4, 6144, v4
  v_add_u32 v28, v28, v4
  v_cmp_gt_u32 s[82:83], 10, v6
  v_subrev_u32 v4, 12, v6
  v_max_i32 v4, 0, v4
  v_and_b32 v29, 15, v4
  v_lshlrev_b32 v29, 4, v29
  v_lshrrev_b32 v4, 4, v4
  v_mul_u32_u24 v4, 6144, v4
  v_add_u32 v29, v29, v4
  v_cmp_gt_u32 s[84:85], 12, v6
  v_subrev_u32 v4, 14, v6
  v_max_i32 v4, 0, v4
  v_and_b32 v30, 15, v4
  v_lshlrev_b32 v30, 4, v30
  v_lshrrev_b32 v4, 4, v4
  v_mul_u32_u24 v4, 6144, v4
  v_add_u32 v30, v30, v4
  v_cmp_gt_u32 s[86:87], 14, v6
  s_mov_b32 s50, 0
  s_mov_b32 s66, 197132288
pa_wait:
  buffer_load_dword v4, v1, s[8:11], 0 offen sc1
  s_add_u32 s50, s50, 1
  s_cmp_gt_u32 s50, 131072
  s_cbranch_scc1 L_fail
  s_waitcnt vmcnt(0)
  v_cmp_le_u32 vcc, v4, v2
  s_cbranch_vccnz pa_wait
  v_add_u32 v232, v8, v23
  buffer_load_dwordx4 v[32:35], v232, s[8:11], s66 offen sc1
  v_add_u32 v233, v9, v23
  buffer_load_dwordx4 v[36:39], v233, s[8:11], s66 offen sc1
  v_add_u32 v234, v10, v23
  buffer_load_dwordx4 v[40:43], v234, s[8:11], s66 offen sc1
  v_add_u32 v235, v11, v23
  buffer_load_dwordx4 v[44:47], v235, s[8:11], s66 offen sc1
  v_add_u32 v236, v12, v23
  buffer_load_dwordx4 v[48:51], v236, s[8:11], s66 offen sc1
  v_add_u32 v232, v13, v23
  buffer_load_dwordx4 v[72:75], v232, s[8:11], s66 offen sc1
  v_add_u32 v233, v14, v23
  buffer_load_dwordx4 v[76:79], v233, s[8:11], s66 offen sc1
  v_add_u32 v234, v15, v23
  buffer_load_dwordx4 v[80:83], v234, s[8:11], s66 offen sc1
  v_add_u32 v235, v16, v23
  buffer_load_dwordx4 v[84:87], v235, s[8:11], s66 offen sc1
  v_add_u32 v236, v17, v23
  buffer_load_dwordx4 v[88:91], v236, s[8:11], s66 offen sc1
  v_add_u32 v232, v13, v24
  buffer_load_dwordx4 v[92:95], v232, s[8:11], s66 offen sc1
  v_add_u32 v233, v14, v24
  buffer_load_dwordx4 v[96:99], v233, s[8:11], s66 offen sc1
  v_add_u32 v234, v15, v24
  buffer_load_dwordx4 v[100:103], v234, s[8:11], s66 offen sc1
  v_add_u32 v235, v16, v24
  buffer_load_dwordx4 v[104:107], v235, s[8:11], s66 offen sc1
  v_add_u32 v236, v17, v24
  buffer_load_dwordx4 v[108:111], v236, s[8:11], s66 offen sc1
  v_add_u32 v232, v13, v25
  buffer_load_dwordx4 v[112:115], v232, s[8:11], s66 offen sc1
  v_add_u32 v233, v14, v25
  buffer_load_dwordx4 v[116:119], v233, s[8:11], s66 offen sc1
  v_add_u32 v234, v15, v25
  buffer_load_dwordx4 v[120:123], v234, s[8:11], s66 offen sc1
  v_add_u32 v235, v16, v25
  buffer_load_dwordx4 v[124:127], v235, s[8:11], s66 offen sc1
  v_add_u32 v236, v17, v25
  buffer_load_dwordx4 v[128:131], v236, s[8:11], s66 offen sc1
  v_add_u32 v232, v13, v26
  buffer_load_dwordx4 v[132:135], v232, s[8:11], s66 offen sc1
  v_add_u32 v233, v14, v26
  buffer_load_dwordx4 v[136:139], v233, s[8:11], s66 offen sc1
  v_add_u32 v234, v15, v26
  buffer_load_dwordx4 v[140:143], v234, s[8:11], s66 offen sc1
  v_add_u32 v235, v16, v26
  buffer_load_dwordx4 v[144:147], v235, s[8:11], s66 offen sc1
  v_add_u32 v236, v17, v26
  buffer_load_dwordx4 v[148:151], v236, s[8:11], s66 offen sc1
  v_add_u32 v232, v13, v27
  buffer_load_dwordx4 v[152:155], v232, s[8:11], s66 offen sc1
  v_add_u32 v233, v14, v27
  buffer_load_dwordx4 v[156:159], v233, s[8:11], s66 offen sc1
  v_add_u32 v234, v15, v27
  buffer_load_dwordx4 v[160:163], v234, s[8:11], s66 offen sc1
  v_add_u32 v235, v16, v27
  buffer_load_dwordx4 v[164:167], v235, s[8:11], s66 offen sc1
  v_add_u32 v236, v17, v27
  buffer_load_dwordx4 v[168:171], v236, s[8:11], s66 offen sc1
  v_add_u32 v232, v13, v28
  buffer_load_dwordx4 v[172:175], v232, s[8:11], s66 offen sc1
  v_add_u32 v233, v14, v28
  buffer_load_dwordx4 v[176:179], v233, s[8:11], s66 offen sc1
  v_add_u32 v234, v15, v28
  buffer_load_dwordx4 v[180:183], v234, s[8:11], s66 offen sc1
  v_add_u32 v235, v16, v28
  buffer_load_dwordx4 v[184:187], v235, s[8:11], s66 offen sc1
  v_add_u32 v236, v17, v28
  buffer_load_dwordx4 v[188:191], v236, s[8:11], s66 offen sc1
  v_add_u32 v232, v13, v29
  buffer_load_dwordx4 v[192:195], v232, s[8:11], s66 offen sc1
  v_add_u32 v233, v14, v29
  buffer_load_dwordx4 v[196:199], v233, s[8:11], s66 offen sc1
  v_add_u32 v234, v15, v29
  buffer_load_dwordx4 v[200:203], v234, s[8:11], s66 offen sc1
  v_add_u32 v235, v16, v29
  buffer_load_dwordx4 v[204:207], v235, s[8:11], s66 offen sc1
  v_add_u32 v236, v17, v29
  buffer_load_dwordx4 v[208:211], v236, s[8:11], s66 offen sc1
  v_add_u32 v232, v13, v30
  buffer_load_dwordx4 v[212:215], v232, s[8:11], s66 offen sc1
  v_add_u32 v233, v14, v30
  buffer_load_dwordx4 v[216:219], v233, s[8:11], s66 offen sc1
  v_add_u32 v234, v15, v30
  buffer_load_dwordx4 v[220:223], v234, s[8:11], s66 offen sc1
  v_add_u32 v235, v16, v30
  buffer_load_dwordx4 v[224:227], v235, s[8:11], s66 offen sc1
  v_add_u32 v236, v17, v30
  buffer_load_dwordx4 v[228:231], v236, s[8:11], s66 offen sc1
  s_waitcnt vmcnt(35)
  v_dot2_f32_bf16 v52, v32, v72, 0
  v_dot2_f32_bf16 v60, v42, v82, 0
  v_dot2_f32_bf16 v52, v33, v73, v52
  v_dot2_f32_bf16 v60, v43, v83, v60
  v_dot2_f32_bf16 v52, v34, v74, v52
  v_dot2_f32_bf16 v60, v44, v84, v60
  v_dot2_f32_bf16 v52, v35, v75, v52
  v_dot2_f32_bf16 v60, v45, v85, v60
  v_dot2_f32_bf16 v52, v36, v76, v52
  v_dot2_f32_bf16 v60, v46, v86, v60
  v_dot2_f32_bf16 v52, v37, v77, v52
  v_dot2_f32_bf16 v60, v47, v87, v60
  v_dot2_f32_bf16 v52, v38, v78, v52
  v_dot2_f32_bf16 v60, v48, v88, v60
  v_dot2_f32_bf16 v52, v39, v79, v52
  v_dot2_f32_bf16 v60, v49, v89, v60
  v_dot2_f32_bf16 v52, v40, v80, v52
  v_dot2_f32_bf16 v60, v50, v90, v60
  v_dot2_f32_bf16 v52, v41, v81, v52
  v_dot2_f32_bf16 v60, v51, v91, v60
  v_add_u32 v232, v18, v23
  buffer_load_dwordx4 v[72:75], v232, s[8:11], s66 offen sc1
  v_add_u32 v233, v19, v23
  buffer_load_dwordx4 v[76:79], v233, s[8:11], s66 offen sc1
  v_add_u32 v234, v20, v23
  buffer_load_dwordx4 v[80:83], v234, s[8:11], s66 offen sc1
  v_add_u32 v235, v21, v23
  buffer_load_dwordx4 v[84:87], v235, s[8:11], s66 offen sc1
  v_add_u32 v236, v22, v23
  buffer_load_dwordx4 v[88:91], v236, s[8:11], s66 offen sc1
  s_waitcnt vmcnt(35)
  v_dot2_f32_bf16 v53, v32, v92, 0
  v_dot2_f32_bf16 v61, v42, v102, 0
  v_dot2_f32_bf16 v53, v33, v93, v53
  v_dot2_f32_bf16 v61, v43, v103, v61
  v_dot2_f32_bf16 v53, v34, v94, v53
  v_dot2_f32_bf16 v61, v44, v104, v61
  v_dot2_f32_bf16 v53, v35, v95, v53
  v_dot2_f32_bf16 v61, v45, v105, v61
  v_dot2_f32_bf16 v53, v36, v96, v53
  v_dot2_f32_bf16 v61, v46, v106, v61
  v_dot2_f32_bf16 v53, v37, v97, v53
  v_dot2_f32_bf16 v61, v47, v107, v61
  v_dot2_f32_bf16 v53, v38, v98, v53
  v_dot2_f32_bf16 v61, v48, v108, v61
  v_dot2_f32_bf16 v53, v39, v99, v53
  v_dot2_f32_bf16 v61, v49, v109, v61
  v_dot2_f32_bf16 v53, v40, v100, v53
  v_dot2_f32_bf16 v61, v50, v110, v61
  v_dot2_f32_bf16 v53, v41, v101, v53
  v_dot2_f32_bf16 v61, v51, v111, v61
  v_add_u32 v232, v18, v24
  buffer_load_dwordx4 v[92:95], v232, s[8:11], s66 offen sc1
  v_add_u32 v233, v19, v24
  buffer_load_dwordx4 v[96:99], v233, s[8:11], s66 offen sc1
  v_add_u32 v234, v20, v24
  buffer_load_dwordx4 v[100:103], v234, s[8:11], s66 offen sc1
  v_add_u32 v235, v21, v24
  buffer_load_dwordx4 v[104:107], v235, s[8:11], s66 offen sc1
  v_add_u32 v236, v22, v24
  buffer_load_dwordx4 v[108:111], v236, s[8:11], s66 offen sc1
  s_waitcnt vmcnt(35)
  v_dot2_f32_bf16 v54, v32, v112, 0
  v_dot2_f32_bf16 v62, v42, v122, 0
  v_dot2_f32_bf16 v54, v33, v113, v54
  v_dot2_f32_bf16 v62, v43, v123, v62
  v_dot2_f32_bf16 v54, v34, v114, v54
  v_dot2_f32_bf16 v62, v44, v124, v62
  v_dot2_f32_bf16 v54, v35, v115, v54
  v_dot2_f32_bf16 v62, v45, v125, v62
  v_dot2_f32_bf16 v54, v36, v116, v54
  v_dot2_f32_bf16 v62, v46, v126, v62
  v_dot2_f32_bf16 v54, v37, v117, v54
  v_dot2_f32_bf16 v62, v47, v127, v62
  v_dot2_f32_bf16 v54, v38, v118, v54
  v_dot2_f32_bf16 v62, v48, v128, v62
  v_dot2_f32_bf16 v54, v39, v119, v54
  v_dot2_f32_bf16 v62, v49, v129, v62
  v_dot2_f32_bf16 v54, v40, v120, v54
  v_dot2_f32_bf16 v62, v50, v130, v62
  v_dot2_f32_bf16 v54, v41, v121, v54
  v_dot2_f32_bf16 v62, v51, v131, v62
  v_add_u32 v232, v18, v25
  buffer_load_dwordx4 v[112:115], v232, s[8:11], s66 offen sc1
  v_add_u32 v233, v19, v25
  buffer_load_dwordx4 v[116:119], v233, s[8:11], s66 offen sc1
  v_add_u32 v234, v20, v25
  buffer_load_dwordx4 v[120:123], v234, s[8:11], s66 offen sc1
  v_add_u32 v235, v21, v25
  buffer_load_dwordx4 v[124:127], v235, s[8:11], s66 offen sc1
  v_add_u32 v236, v22, v25
  buffer_load_dwordx4 v[128:131], v236, s[8:11], s66 offen sc1
  s_waitcnt vmcnt(35)
  v_dot2_f32_bf16 v55, v32, v132, 0
  v_dot2_f32_bf16 v63, v42, v142, 0
  v_dot2_f32_bf16 v55, v33, v133, v55
  v_dot2_f32_bf16 v63, v43, v143, v63
  v_dot2_f32_bf16 v55, v34, v134, v55
  v_dot2_f32_bf16 v63, v44, v144, v63
  v_dot2_f32_bf16 v55, v35, v135, v55
  v_dot2_f32_bf16 v63, v45, v145, v63
  v_dot2_f32_bf16 v55, v36, v136, v55
  v_dot2_f32_bf16 v63, v46, v146, v63
  v_dot2_f32_bf16 v55, v37, v137, v55
  v_dot2_f32_bf16 v63, v47, v147, v63
  v_dot2_f32_bf16 v55, v38, v138, v55
  v_dot2_f32_bf16 v63, v48, v148, v63
  v_dot2_f32_bf16 v55, v39, v139, v55
  v_dot2_f32_bf16 v63, v49, v149, v63
  v_dot2_f32_bf16 v55, v40, v140, v55
  v_dot2_f32_bf16 v63, v50, v150, v63
  v_dot2_f32_bf16 v55, v41, v141, v55
  v_dot2_f32_bf16 v63, v51, v151, v63
  v_add_u32 v232, v18, v26
  buffer_load_dwordx4 v[132:135], v232, s[8:11], s66 offen sc1
  v_add_u32 v233, v19, v26
  buffer_load_dwordx4 v[136:139], v233, s[8:11], s66 offen sc1
  v_add_u32 v234, v20, v26
  buffer_load_dwordx4 v[140:143], v234, s[8:11], s66 offen sc1
  v_add_u32 v235, v21, v26
  buffer_load_dwordx4 v[144:147], v235, s[8:11], s66 offen sc1
  v_add_u32 v236, v22, v26
  buffer_load_dwordx4 v[148:151], v236, s[8:11], s66 offen sc1
  s_waitcnt vmcnt(35)
  v_dot2_f32_bf16 v56, v32, v152, 0
  v_dot2_f32_bf16 v64, v42, v162, 0
  v_dot2_f32_bf16 v56, v33, v153, v56
  v_dot2_f32_bf16 v64, v43, v163, v64
  v_dot2_f32_bf16 v56, v34, v154, v56
  v_dot2_f32_bf16 v64, v44, v164, v64
  v_dot2_f32_bf16 v56, v35, v155, v56
  v_dot2_f32_bf16 v64, v45, v165, v64
  v_dot2_f32_bf16 v56, v36, v156, v56
  v_dot2_f32_bf16 v64, v46, v166, v64
  v_dot2_f32_bf16 v56, v37, v157, v56
  v_dot2_f32_bf16 v64, v47, v167, v64
  v_dot2_f32_bf16 v56, v38, v158, v56
  v_dot2_f32_bf16 v64, v48, v168, v64
  v_dot2_f32_bf16 v56, v39, v159, v56
  v_dot2_f32_bf16 v64, v49, v169, v64
  v_dot2_f32_bf16 v56, v40, v160, v56
  v_dot2_f32_bf16 v64, v50, v170, v64
  v_dot2_f32_bf16 v56, v41, v161, v56
  v_dot2_f32_bf16 v64, v51, v171, v64
  v_add_u32 v232, v18, v27
  buffer_load_dwordx4 v[152:155], v232, s[8:11], s66 offen sc1
  v_add_u32 v233, v19, v27
  buffer_load_dwordx4 v[156:159], v233, s[8:11], s66 offen sc1
  v_add_u32 v234, v20, v27
  buffer_load_dwordx4 v[160:163], v234, s[8:11], s66 offen sc1
  v_add_u32 v235, v21, v27
  buffer_load_dwordx4 v[164:167], v235, s[8:11], s66 offen sc1
  v_add_u32 v236, v22, v27
  buffer_load_dwordx4 v[168:171], v236, s[8:11], s66 offen sc1
  s_waitcnt vmcnt(35)
  v_dot2_f32_bf16 v57, v32, v172, 0
  v_dot2_f32_bf16 v65, v42, v182, 0
  v_dot2_f32_bf16 v57, v33, v173, v57
  v_dot2_f32_bf16 v65, v43, v183, v65
  v_dot2_f32_bf16 v57, v34, v174, v57
  v_dot2_f32_bf16 v65, v44, v184, v65
  v_dot2_f32_bf16 v57, v35, v175, v57
  v_dot2_f32_bf16 v65, v45, v185, v65
  v_dot2_f32_bf16 v57, v36, v176, v57
  v_dot2_f32_bf16 v65, v46, v186, v65
  v_dot2_f32_bf16 v57, v37, v177, v57
  v_dot2_f32_bf16 v65, v47, v187, v65
  v_dot2_f32_bf16 v57, v38, v178, v57
  v_dot2_f32_bf16 v65, v48, v188, v65
  v_dot2_f32_bf16 v57, v39, v179, v57
  v_dot2_f32_bf16 v65, v49, v189, v65
  v_dot2_f32_bf16 v57, v40, v180, v57
  v_dot2_f32_bf16 v65, v50, v190, v65
  v_dot2_f32_bf16 v57, v41, v181, v57
  v_dot2_f32_bf16 v65, v51, v191, v65
  v_add_u32 v232, v18, v28
  buffer_load_dwordx4 v[172:175], v232, s[8:11], s66 offen sc1
  v_add_u32 v233, v19, v28
  buffer_load_dwordx4 v[176:179], v233, s[8:11], s66 offen sc1
  v_add_u32 v234, v20, v28
  buffer_load_dwordx4 v[180:183], v234, s[8:11], s66 offen sc1
  v_add_u32 v235, v21, v28
  buffer_load_dwordx4 v[184:187], v235, s[8:11], s66 offen sc1
  v_add_u32 v236, v22, v28
  buffer_load_dwordx4 v[188:191], v236, s[8:11], s66 offen sc1
  s_waitcnt vmcnt(35)
  v_dot2_f32_bf16 v58, v32, v192, 0
  v_dot2_f32_bf16 v66, v42, v202, 0
  v_dot2_f32_bf16 v58, v33, v193, v58
  v_dot2_f32_bf16 v66, v43, v203, v66
  v_dot2_f32_bf16 v58, v34, v194, v58
  v_dot2_f32_bf16 v66, v44, v204, v66
  v_dot2_f32_bf16 v58, v35, v195, v58
  v_dot2_f32_bf16 v66, v45, v205, v66
  v_dot2_f32_bf16 v58, v36, v196, v58
  v_dot2_f32_bf16 v66, v46, v206, v66
  v_dot2_f32_bf16 v58, v37, v197, v58
  v_dot2_f32_bf16 v66, v47, v207, v66
  v_dot2_f32_bf16 v58, v38, v198, v58
  v_dot2_f32_bf16 v66, v48, v208, v66
  v_dot2_f32_bf16 v58, v39, v199, v58
  v_dot2_f32_bf16 v66, v49, v209, v66
  v_dot2_f32_bf16 v58, v40, v200, v58
  v_dot2_f32_bf16 v66, v50, v210, v66
  v_dot2_f32_bf16 v58, v41, v201, v58
  v_dot2_f32_bf16 v66, v51, v211, v66
  v_add_u32 v232, v18, v29
  buffer_load_dwordx4 v[192:195], v232, s[8:11], s66 offen sc1
  v_add_u32 v233, v19, v29
  buffer_load_dwordx4 v[196:199], v233, s[8:11], s66 offen sc1
  v_add_u32 v234, v20, v29
  buffer_load_dwordx4 v[200:203], v234, s[8:11], s66 offen sc1
  v_add_u32 v235, v21, v29
  buffer_load_dwordx4 v[204:207], v235, s[8:11], s66 offen sc1
  v_add_u32 v236, v22, v29
  buffer_load_dwordx4 v[208:211], v236, s[8:11], s66 offen sc1
  s_waitcnt vmcnt(35)
  v_dot2_f32_bf16 v59, v32, v212, 0
  v_dot2_f32_bf16 v67, v42, v222, 0
  v_dot2_f32_bf16 v59, v33, v213, v59
  v_dot2_f32_bf16 v67, v43, v223, v67
  v_dot2_f32_bf16 v59, v34, v214, v59
  v_dot2_f32_bf16 v67, v44, v224, v67
  v_dot2_f32_bf16 v59, v35, v215, v59
  v_dot2_f32_bf16 v67, v45, v225, v67
  v_dot2_f32_bf16 v59, v36, v216, v59
  v_dot2_f32_bf16 v67, v46, v226, v67
  v_dot2_f32_bf16 v59, v37, v217, v59
  v_dot2_f32_bf16 v67, v47, v227, v67
  v_dot2_f32_bf16 v59, v38, v218, v59
  v_dot2_f32_bf16 v67, v48, v228, v67
  v_dot2_f32_bf16 v59, v39, v219, v59
  v_dot2_f32_bf16 v67, v49, v229, v67
  v_dot2_f32_bf16 v59, v40, v220, v59
  v_dot2_f32_bf16 v67, v50, v230, v67
  v_dot2_f32_bf16 v59, v41, v221, v59
  v_dot2_f32_bf16 v67, v51, v231, v67
  v_add_u32 v232, v18, v30
  buffer_load_dwordx4 v[212:215], v232, s[8:11], s66 offen sc1
  v_add_u32 v233, v19, v30
  buffer_load_dwordx4 v[216:219], v233, s[8:11], s66 offen sc1
  v_add_u32 v234, v20, v30
  buffer_load_dwordx4 v[220:223], v234, s[8:11], s66 offen sc1
  v_add_u32 v235, v21, v30
  buffer_load_dwordx4 v[224:227], v235, s[8:11], s66 offen sc1
  v_add_u32 v236, v22, v30
  buffer_load_dwordx4 v[228:231], v236, s[8:11], s66 offen sc1
  s_mov_b32 s46, 1051011932
  v_mov_b32 v232, 3481618353
  v_cndmask_b32 v53, v53, v232, s[74:75]
  v_cndmask_b32 v54, v54, v232, s[76:77]
  v_cndmask_b32 v55, v55, v232, s[78:79]
  v_cndmask_b32 v56, v56, v232, s[80:81]
  v_cndmask_b32 v57, v57, v232, s[82:83]
  v_cndmask_b32 v58, v58, v232, s[84:85]
  v_cndmask_b32 v59, v59, v232, s[86:87]
  v_max_f32 v233, v52, v53
  v_max3_f32 v233, v233, v54, v55
  v_max3_f32 v233, v233, v56, v57
  v_max3_f32 v233, v233, v58, v59
  v_mul_f32 v233, s46, v233
  v_fma_f32 v52, v52, s46, -v233
  v_fma_f32 v53, v53, s46, -v233
  v_fma_f32 v54, v54, s46, -v233
  v_fma_f32 v55, v55, s46, -v233
  v_fma_f32 v56, v56, s46, -v233
  v_fma_f32 v57, v57, s46, -v233
  v_fma_f32 v58, v58, s46, -v233
  v_fma_f32 v59, v59, s46, -v233
  v_exp_f32 v52, v52
  v_exp_f32 v53, v53
  v_exp_f32 v54, v54
  v_exp_f32 v55, v55
  v_exp_f32 v56, v56
  v_exp_f32 v57, v57
  v_exp_f32 v58, v58
  v_exp_f32 v59, v59
  v_add_f32 v233, v52, v53
  v_add_f32 v233, v233, v54
  v_add_f32 v233, v233, v55
  v_add_f32 v233, v233, v56
  v_add_f32 v233, v233, v57
  v_add_f32 v233, v233, v58
  v_add_f32 v233, v233, v59
  v_rcp_f32 v233, v233
  s_nop 0
  v_mul_f32 v52, v52, v233
  v_mul_f32 v53, v53, v233
  v_mul_f32 v54, v54, v233
  v_mul_f32 v55, v55, v233
  v_mul_f32 v56, v56, v233
  v_mul_f32 v57, v57, v233
  v_mul_f32 v58, v58, v233
  v_mul_f32 v59, v59, v233
  v_cndmask_b32 v61, v61, v232, s[74:75]
  v_cndmask_b32 v62, v62, v232, s[76:77]
  v_cndmask_b32 v63, v63, v232, s[78:79]
  v_cndmask_b32 v64, v64, v232, s[80:81]
  v_cndmask_b32 v65, v65, v232, s[82:83]
  v_cndmask_b32 v66, v66, v232, s[84:85]
  v_cndmask_b32 v67, v67, v232, s[86:87]
  v_max_f32 v233, v60, v61
  v_max3_f32 v233, v233, v62, v63
  v_max3_f32 v233, v233, v64, v65
  v_max3_f32 v233, v233, v66, v67
  v_mul_f32 v233, s46, v233
  v_fma_f32 v60, v60, s46, -v233
  v_fma_f32 v61, v61, s46, -v233
  v_fma_f32 v62, v62, s46, -v233
  v_fma_f32 v63, v63, s46, -v233
  v_fma_f32 v64, v64, s46, -v233
  v_fma_f32 v65, v65, s46, -v233
  v_fma_f32 v66, v66, s46, -v233
  v_fma_f32 v67, v67, s46, -v233
  v_exp_f32 v60, v60
  v_exp_f32 v61, v61
  v_exp_f32 v62, v62
  v_exp_f32 v63, v63
  v_exp_f32 v64, v64
  v_exp_f32 v65, v65
  v_exp_f32 v66, v66
  v_exp_f32 v67, v67
  v_add_f32 v233, v60, v61
  v_add_f32 v233, v233, v62
  v_add_f32 v233, v233, v63
  v_add_f32 v233, v233, v64
  v_add_f32 v233, v233, v65
  v_add_f32 v233, v233, v66
  v_add_f32 v233, v233, v67
  v_rcp_f32 v233, v233
  s_nop 0
  v_mul_f32 v60, v60, v233
  v_mul_f32 v61, v61, v233
  v_mul_f32 v62, v62, v233
  v_mul_f32 v63, v63, v233
  v_mul_f32 v64, v64, v233
  v_mul_f32 v65, v65, v233
  v_mul_f32 v66, v66, v233
  v_mul_f32 v67, v67, v233
  v_cvt_pk_bf16_f32 v52, v52, 0
  v_lshlrev_b32 v236, 16, v52
  v_cvt_pk_bf16_f32 v53, v53, 0
  v_lshlrev_b32 v237, 16, v53
  v_cvt_pk_bf16_f32 v54, v54, 0
  v_lshlrev_b32 v238, 16, v54
  v_cvt_pk_bf16_f32 v55, v55, 0
  v_lshlrev_b32 v239, 16, v55
  v_cvt_pk_bf16_f32 v56, v56, 0
  v_lshlrev_b32 v240, 16, v56
  v_cvt_pk_bf16_f32 v57, v57, 0
  v_lshlrev_b32 v241, 16, v57
  v_cvt_pk_bf16_f32 v58, v58, 0
  v_lshlrev_b32 v242, 16, v58
  v_cvt_pk_bf16_f32 v59, v59, 0
  v_lshlrev_b32 v243, 16, v59
  v_cvt_pk_bf16_f32 v60, v60, 0
  v_lshlrev_b32 v244, 16, v60
  v_cvt_pk_bf16_f32 v61, v61, 0
  v_lshlrev_b32 v245, 16, v61
  v_cvt_pk_bf16_f32 v62, v62, 0
  v_lshlrev_b32 v246, 16, v62
  v_cvt_pk_bf16_f32 v63, v63, 0
  v_lshlrev_b32 v247, 16, v63
  v_cvt_pk_bf16_f32 v64, v64, 0
  v_lshlrev_b32 v248, 16, v64
  v_cvt_pk_bf16_f32 v65, v65, 0
  v_lshlrev_b32 v249, 16, v65
  v_cvt_pk_bf16_f32 v66, v66, 0
  v_lshlrev_b32 v250, 16, v66
  v_cvt_pk_bf16_f32 v67, v67, 0
  v_lshlrev_b32 v251, 16, v67
  s_waitcnt vmcnt(35)
  v_dot2_f32_bf16 v8, v72, v52, 0
  v_dot2_f32_bf16 v9, v72, v236, 0
  v_dot2_f32_bf16 v10, v73, v52, 0
  v_dot2_f32_bf16 v11, v73, v236, 0
  v_dot2_f32_bf16 v12, v74, v52, 0
  v_dot2_f32_bf16 v13, v74, v236, 0
  v_dot2_f32_bf16 v14, v75, v52, 0
  v_dot2_f32_bf16 v15, v75, v236, 0
  v_dot2_f32_bf16 v16, v76, v52, 0
  v_dot2_f32_bf16 v17, v76, v236, 0
  v_dot2_f32_bf16 v18, v77, v52, 0
  v_dot2_f32_bf16 v19, v77, v236, 0
  v_dot2_f32_bf16 v20, v78, v52, 0
  v_dot2_f32_bf16 v21, v78, v236, 0
  v_dot2_f32_bf16 v22, v79, v52, 0
  v_dot2_f32_bf16 v23, v79, v236, 0
  v_dot2_f32_bf16 v24, v80, v52, 0
  v_dot2_f32_bf16 v25, v80, v236, 0
  v_dot2_f32_bf16 v26, v81, v52, 0
  v_dot2_f32_bf16 v27, v81, v236, 0
  v_dot2_f32_bf16 v28, v82, v60, 0
  v_dot2_f32_bf16 v29, v82, v244, 0
  v_dot2_f32_bf16 v30, v83, v60, 0
  v_dot2_f32_bf16 v31, v83, v244, 0
  v_dot2_f32_bf16 v32, v84, v60, 0
  v_dot2_f32_bf16 v33, v84, v244, 0
  v_dot2_f32_bf16 v34, v85, v60, 0
  v_dot2_f32_bf16 v35, v85, v244, 0
  v_dot2_f32_bf16 v36, v86, v60, 0
  v_dot2_f32_bf16 v37, v86, v244, 0
  v_dot2_f32_bf16 v38, v87, v60, 0
  v_dot2_f32_bf16 v39, v87, v244, 0
  v_dot2_f32_bf16 v40, v88, v60, 0
  v_dot2_f32_bf16 v41, v88, v244, 0
  v_dot2_f32_bf16 v42, v89, v60, 0
  v_dot2_f32_bf16 v43, v89, v244, 0
  v_dot2_f32_bf16 v44, v90, v60, 0
  v_dot2_f32_bf16 v45, v90, v244, 0
  v_dot2_f32_bf16 v46, v91, v60, 0
  v_dot2_f32_bf16 v47, v91, v244, 0
  s_waitcnt vmcnt(30)
  v_dot2_f32_bf16 v8, v92, v53, v8
  v_dot2_f32_bf16 v9, v92, v237, v9
  v_dot2_f32_bf16 v10, v93, v53, v10
  v_dot2_f32_bf16 v11, v93, v237, v11
  v_dot2_f32_bf16 v12, v94, v53, v12
  v_dot2_f32_bf16 v13, v94, v237, v13
  v_dot2_f32_bf16 v14, v95, v53, v14
  v_dot2_f32_bf16 v15, v95, v237, v15
  v_dot2_f32_bf16 v16, v96, v53, v16
  v_dot2_f32_bf16 v17, v96, v237, v17
  v_dot2_f32_bf16 v18, v97, v53, v18
  v_dot2_f32_bf16 v19, v97, v237, v19
  v_dot2_f32_bf16 v20, v98, v53, v20
  v_dot2_f32_bf16 v21, v98, v237, v21
  v_dot2_f32_bf16 v22, v99, v53, v22
  v_dot2_f32_bf16 v23, v99, v237, v23
  v_dot2_f32_bf16 v24, v100, v53, v24
  v_dot2_f32_bf16 v25, v100, v237, v25
  v_dot2_f32_bf16 v26, v101, v53, v26
  v_dot2_f32_bf16 v27, v101, v237, v27
  v_dot2_f32_bf16 v28, v102, v61, v28
  v_dot2_f32_bf16 v29, v102, v245, v29
  v_dot2_f32_bf16 v30, v103, v61, v30
  v_dot2_f32_bf16 v31, v103, v245, v31
  v_dot2_f32_bf16 v32, v104, v61, v32
  v_dot2_f32_bf16 v33, v104, v245, v33
  v_dot2_f32_bf16 v34, v105, v61, v34
  v_dot2_f32_bf16 v35, v105, v245, v35
  v_dot2_f32_bf16 v36, v106, v61, v36
  v_dot2_f32_bf16 v37, v106, v245, v37
  v_dot2_f32_bf16 v38, v107, v61, v38
  v_dot2_f32_bf16 v39, v107, v245, v39
  v_dot2_f32_bf16 v40, v108, v61, v40
  v_dot2_f32_bf16 v41, v108, v245, v41
  v_dot2_f32_bf16 v42, v109, v61, v42
  v_dot2_f32_bf16 v43, v109, v245, v43
  v_dot2_f32_bf16 v44, v110, v61, v44
  v_dot2_f32_bf16 v45, v110, v245, v45
  v_dot2_f32_bf16 v46, v111, v61, v46
  v_dot2_f32_bf16 v47, v111, v245, v47
  s_waitcnt vmcnt(25)
  v_dot2_f32_bf16 v8, v112, v54, v8
  v_dot2_f32_bf16 v9, v112, v238, v9
  v_dot2_f32_bf16 v10, v113, v54, v10
  v_dot2_f32_bf16 v11, v113, v238, v11
  v_dot2_f32_bf16 v12, v114, v54, v12
  v_dot2_f32_bf16 v13, v114, v238, v13
  v_dot2_f32_bf16 v14, v115, v54, v14
  v_dot2_f32_bf16 v15, v115, v238, v15
  v_dot2_f32_bf16 v16, v116, v54, v16
  v_dot2_f32_bf16 v17, v116, v238, v17
  v_dot2_f32_bf16 v18, v117, v54, v18
  v_dot2_f32_bf16 v19, v117, v238, v19
  v_dot2_f32_bf16 v20, v118, v54, v20
  v_dot2_f32_bf16 v21, v118, v238, v21
  v_dot2_f32_bf16 v22, v119, v54, v22
  v_dot2_f32_bf16 v23, v119, v238, v23
  v_dot2_f32_bf16 v24, v120, v54, v24
  v_dot2_f32_bf16 v25, v120, v238, v25
  v_dot2_f32_bf16 v26, v121, v54, v26
  v_dot2_f32_bf16 v27, v121, v238, v27
  v_dot2_f32_bf16 v28, v122, v62, v28
  v_dot2_f32_bf16 v29, v122, v246, v29
  v_dot2_f32_bf16 v30, v123, v62, v30
  v_dot2_f32_bf16 v31, v123, v246, v31
  v_dot2_f32_bf16 v32, v124, v62, v32
  v_dot2_f32_bf16 v33, v124, v246, v33
  v_dot2_f32_bf16 v34, v125, v62, v34
  v_dot2_f32_bf16 v35, v125, v246, v35
  v_dot2_f32_bf16 v36, v126, v62, v36
  v_dot2_f32_bf16 v37, v126, v246, v37
  v_dot2_f32_bf16 v38, v127, v62, v38
  v_dot2_f32_bf16 v39, v127, v246, v39
  v_dot2_f32_bf16 v40, v128, v62, v40
  v_dot2_f32_bf16 v41, v128, v246, v41
  v_dot2_f32_bf16 v42, v129, v62, v42
  v_dot2_f32_bf16 v43, v129, v246, v43
  v_dot2_f32_bf16 v44, v130, v62, v44
  v_dot2_f32_bf16 v45, v130, v246, v45
  v_dot2_f32_bf16 v46, v131, v62, v46
  v_dot2_f32_bf16 v47, v131, v246, v47
  s_waitcnt vmcnt(20)
  v_dot2_f32_bf16 v8, v132, v55, v8
  v_dot2_f32_bf16 v9, v132, v239, v9
  v_dot2_f32_bf16 v10, v133, v55, v10
  v_dot2_f32_bf16 v11, v133, v239, v11
  v_dot2_f32_bf16 v12, v134, v55, v12
  v_dot2_f32_bf16 v13, v134, v239, v13
  v_dot2_f32_bf16 v14, v135, v55, v14
  v_dot2_f32_bf16 v15, v135, v239, v15
  v_dot2_f32_bf16 v16, v136, v55, v16
  v_dot2_f32_bf16 v17, v136, v239, v17
  v_dot2_f32_bf16 v18, v137, v55, v18
  v_dot2_f32_bf16 v19, v137, v239, v19
  v_dot2_f32_bf16 v20, v138, v55, v20
  v_dot2_f32_bf16 v21, v138, v239, v21
  v_dot2_f32_bf16 v22, v139, v55, v22
  v_dot2_f32_bf16 v23, v139, v239, v23
  v_dot2_f32_bf16 v24, v140, v55, v24
  v_dot2_f32_bf16 v25, v140, v239, v25
  v_dot2_f32_bf16 v26, v141, v55, v26
  v_dot2_f32_bf16 v27, v141, v239, v27
  v_dot2_f32_bf16 v28, v142, v63, v28
  v_dot2_f32_bf16 v29, v142, v247, v29
  v_dot2_f32_bf16 v30, v143, v63, v30
  v_dot2_f32_bf16 v31, v143, v247, v31
  v_dot2_f32_bf16 v32, v144, v63, v32
  v_dot2_f32_bf16 v33, v144, v247, v33
  v_dot2_f32_bf16 v34, v145, v63, v34
  v_dot2_f32_bf16 v35, v145, v247, v35
  v_dot2_f32_bf16 v36, v146, v63, v36
  v_dot2_f32_bf16 v37, v146, v247, v37
  v_dot2_f32_bf16 v38, v147, v63, v38
  v_dot2_f32_bf16 v39, v147, v247, v39
  v_dot2_f32_bf16 v40, v148, v63, v40
  v_dot2_f32_bf16 v41, v148, v247, v41
  v_dot2_f32_bf16 v42, v149, v63, v42
  v_dot2_f32_bf16 v43, v149, v247, v43
  v_dot2_f32_bf16 v44, v150, v63, v44
  v_dot2_f32_bf16 v45, v150, v247, v45
  v_dot2_f32_bf16 v46, v151, v63, v46
  v_dot2_f32_bf16 v47, v151, v247, v47
  s_waitcnt vmcnt(15)
  v_dot2_f32_bf16 v8, v152, v56, v8
  v_dot2_f32_bf16 v9, v152, v240, v9
  v_dot2_f32_bf16 v10, v153, v56, v10
  v_dot2_f32_bf16 v11, v153, v240, v11
  v_dot2_f32_bf16 v12, v154, v56, v12
  v_dot2_f32_bf16 v13, v154, v240, v13
  v_dot2_f32_bf16 v14, v155, v56, v14
  v_dot2_f32_bf16 v15, v155, v240, v15
  v_dot2_f32_bf16 v16, v156, v56, v16
  v_dot2_f32_bf16 v17, v156, v240, v17
  v_dot2_f32_bf16 v18, v157, v56, v18
  v_dot2_f32_bf16 v19, v157, v240, v19
  v_dot2_f32_bf16 v20, v158, v56, v20
  v_dot2_f32_bf16 v21, v158, v240, v21
  v_dot2_f32_bf16 v22, v159, v56, v22
  v_dot2_f32_bf16 v23, v159, v240, v23
  v_dot2_f32_bf16 v24, v160, v56, v24
  v_dot2_f32_bf16 v25, v160, v240, v25
  v_dot2_f32_bf16 v26, v161, v56, v26
  v_dot2_f32_bf16 v27, v161, v240, v27
  v_dot2_f32_bf16 v28, v162, v64, v28
  v_dot2_f32_bf16 v29, v162, v248, v29
  v_dot2_f32_bf16 v30, v163, v64, v30
  v_dot2_f32_bf16 v31, v163, v248, v31
  v_dot2_f32_bf16 v32, v164, v64, v32
  v_dot2_f32_bf16 v33, v164, v248, v33
  v_dot2_f32_bf16 v34, v165, v64, v34
  v_dot2_f32_bf16 v35, v165, v248, v35
  v_dot2_f32_bf16 v36, v166, v64, v36
  v_dot2_f32_bf16 v37, v166, v248, v37
  v_dot2_f32_bf16 v38, v167, v64, v38
  v_dot2_f32_bf16 v39, v167, v248, v39
  v_dot2_f32_bf16 v40, v168, v64, v40
  v_dot2_f32_bf16 v41, v168, v248, v41
  v_dot2_f32_bf16 v42, v169, v64, v42
  v_dot2_f32_bf16 v43, v169, v248, v43
  v_dot2_f32_bf16 v44, v170, v64, v44
  v_dot2_f32_bf16 v45, v170, v248, v45
  v_dot2_f32_bf16 v46, v171, v64, v46
  v_dot2_f32_bf16 v47, v171, v248, v47
  s_waitcnt vmcnt(10)
  v_dot2_f32_bf16 v8, v172, v57, v8
  v_dot2_f32_bf16 v9, v172, v241, v9
  v_dot2_f32_bf16 v10, v173, v57, v10
  v_dot2_f32_bf16 v11, v173, v241, v11
  v_dot2_f32_bf16 v12, v174, v57, v12
  v_dot2_f32_bf16 v13, v174, v241, v13
  v_dot2_f32_bf16 v14, v175, v57, v14
  v_dot2_f32_bf16 v15, v175, v241, v15
  v_dot2_f32_bf16 v16, v176, v57, v16
  v_dot2_f32_bf16 v17, v176, v241, v17
  v_dot2_f32_bf16 v18, v177, v57, v18
  v_dot2_f32_bf16 v19, v177, v241, v19
  v_dot2_f32_bf16 v20, v178, v57, v20
  v_dot2_f32_bf16 v21, v178, v241, v21
  v_dot2_f32_bf16 v22, v179, v57, v22
  v_dot2_f32_bf16 v23, v179, v241, v23
  v_dot2_f32_bf16 v24, v180, v57, v24
  v_dot2_f32_bf16 v25, v180, v241, v25
  v_dot2_f32_bf16 v26, v181, v57, v26
  v_dot2_f32_bf16 v27, v181, v241, v27
  v_dot2_f32_bf16 v28, v182, v65, v28
  v_dot2_f32_bf16 v29, v182, v249, v29
  v_dot2_f32_bf16 v30, v183, v65, v30
  v_dot2_f32_bf16 v31, v183, v249, v31
  v_dot2_f32_bf16 v32, v184, v65, v32
  v_dot2_f32_bf16 v33, v184, v249, v33
  v_dot2_f32_bf16 v34, v185, v65, v34
  v_dot2_f32_bf16 v35, v185, v249, v35
  v_dot2_f32_bf16 v36, v186, v65, v36
  v_dot2_f32_bf16 v37, v186, v249, v37
  v_dot2_f32_bf16 v38, v187, v65, v38
  v_dot2_f32_bf16 v39, v187, v249, v39
  v_dot2_f32_bf16 v40, v188, v65, v40
  v_dot2_f32_bf16 v41, v188, v249, v41
  v_dot2_f32_bf16 v42, v189, v65, v42
  v_dot2_f32_bf16 v43, v189, v249, v43
  v_dot2_f32_bf16 v44, v190, v65, v44
  v_dot2_f32_bf16 v45, v190, v249, v45
  v_dot2_f32_bf16 v46, v191, v65, v46
  v_dot2_f32_bf16 v47, v191, v249, v47
  s_waitcnt vmcnt(5)
  v_dot2_f32_bf16 v8, v192, v58, v8
  v_dot2_f32_bf16 v9, v192, v242, v9
  v_dot2_f32_bf16 v10, v193, v58, v10
  v_dot2_f32_bf16 v11, v193, v242, v11
  v_dot2_f32_bf16 v12, v194, v58, v12
  v_dot2_f32_bf16 v13, v194, v242, v13
  v_dot2_f32_bf16 v14, v195, v58, v14
  v_dot2_f32_bf16 v15, v195, v242, v15
  v_dot2_f32_bf16 v16, v196, v58, v16
  v_dot2_f32_bf16 v17, v196, v242, v17
  v_dot2_f32_bf16 v18, v197, v58, v18
  v_dot2_f32_bf16 v19, v197, v242, v19
  v_dot2_f32_bf16 v20, v198, v58, v20
  v_dot2_f32_bf16 v21, v198, v242, v21
  v_dot2_f32_bf16 v22, v199, v58, v22
  v_dot2_f32_bf16 v23, v199, v242, v23
  v_dot2_f32_bf16 v24, v200, v58, v24
  v_dot2_f32_bf16 v25, v200, v242, v25
  v_dot2_f32_bf16 v26, v201, v58, v26
  v_dot2_f32_bf16 v27, v201, v242, v27
  v_dot2_f32_bf16 v28, v202, v66, v28
  v_dot2_f32_bf16 v29, v202, v250, v29
  v_dot2_f32_bf16 v30, v203, v66, v30
  v_dot2_f32_bf16 v31, v203, v250, v31
  v_dot2_f32_bf16 v32, v204, v66, v32
  v_dot2_f32_bf16 v33, v204, v250, v33
  v_dot2_f32_bf16 v34, v205, v66, v34
  v_dot2_f32_bf16 v35, v205, v250, v35
  v_dot2_f32_bf16 v36, v206, v66, v36
  v_dot2_f32_bf16 v37, v206, v250, v37
  v_dot2_f32_bf16 v38, v207, v66, v38
  v_dot2_f32_bf16 v39, v207, v250, v39
  v_dot2_f32_bf16 v40, v208, v66, v40
  v_dot2_f32_bf16 v41, v208, v250, v41
  v_dot2_f32_bf16 v42, v209, v66, v42
  v_dot2_f32_bf16 v43, v209, v250, v43
  v_dot2_f32_bf16 v44, v210, v66, v44
  v_dot2_f32_bf16 v45, v210, v250, v45
  v_dot2_f32_bf16 v46, v211, v66, v46
  v_dot2_f32_bf16 v47, v211, v250, v47
  s_waitcnt vmcnt(0)
  v_dot2_f32_bf16 v8, v212, v59, v8
  v_dot2_f32_bf16 v9, v212, v243, v9
  v_dot2_f32_bf16 v10, v213, v59, v10
  v_dot2_f32_bf16 v11, v213, v243, v11
  v_dot2_f32_bf16 v12, v214, v59, v12
  v_dot2_f32_bf16 v13, v214, v243, v13
  v_dot2_f32_bf16 v14, v215, v59, v14
  v_dot2_f32_bf16 v15, v215, v243, v15
  v_dot2_f32_bf16 v16, v216, v59, v16
  v_dot2_f32_bf16 v17, v216, v243, v17
  v_dot2_f32_bf16 v18, v217, v59, v18
  v_dot2_f32_bf16 v19, v217, v243, v19
  v_dot2_f32_bf16 v20, v218, v59, v20
  v_dot2_f32_bf16 v21, v218, v243, v21
  v_dot2_f32_bf16 v22, v219, v59, v22
  v_dot2_f32_bf16 v23, v219, v243, v23
  v_dot2_f32_bf16 v24, v220, v59, v24
  v_dot2_f32_bf16 v25, v220, v243, v25
  v_dot2_f32_bf16 v26, v221, v59, v26
  v_dot2_f32_bf16 v27, v221, v243, v27
  v_dot2_f32_bf16 v28, v222, v67, v28
  v_dot2_f32_bf16 v29, v222, v251, v29
  v_dot2_f32_bf16 v30, v223, v67, v30
  v_dot2_f32_bf16 v31, v223, v251, v31
  v_dot2_f32_bf16 v32, v224, v67, v32
  v_dot2_f32_bf16 v33, v224, v251, v33
  v_dot2_f32_bf16 v34, v225, v67, v34
  v_dot2_f32_bf16 v35, v225, v251, v35
  v_dot2_f32_bf16 v36, v226, v67, v36
  v_dot2_f32_bf16 v37, v226, v251, v37
  v_dot2_f32_bf16 v38, v227, v67, v38
  v_dot2_f32_bf16 v39, v227, v251, v39
  v_dot2_f32_bf16 v40, v228, v67, v40
  v_dot2_f32_bf16 v41, v228, v251, v41
  v_dot2_f32_bf16 v42, v229, v67, v42
  v_dot2_f32_bf16 v43, v229, v251, v43
  v_dot2_f32_bf16 v44, v230, v67, v44
  v_dot2_f32_bf16 v45, v230, v251, v45
  v_dot2_f32_bf16 v46, v231, v67, v46
  v_dot2_f32_bf16 v47, v231, v251, v47
  v_cvt_pk_bf16_f32 v72, v8, v9
  v_cvt_pk_bf16_f32 v73, v10, v11
  v_cvt_pk_bf16_f32 v74, v12, v13
  v_cvt_pk_bf16_f32 v75, v14, v15
  v_cvt_pk_bf16_f32 v76, v16, v17
  v_cvt_pk_bf16_f32 v77, v18, v19
  v_cvt_pk_bf16_f32 v78, v20, v21
  v_cvt_pk_bf16_f32 v79, v22, v23
  v_cvt_pk_bf16_f32 v80, v24, v25
  v_cvt_pk_bf16_f32 v81, v26, v27
  v_cvt_pk_bf16_f32 v82, v28, v29
  v_cvt_pk_bf16_f32 v83, v30, v31
  v_cvt_pk_bf16_f32 v84, v32, v33
  v_cvt_pk_bf16_f32 v85, v34, v35
  v_cvt_pk_bf16_f32 v86, v36, v37
  v_cvt_pk_bf16_f32 v87, v38, v39
  v_cvt_pk_bf16_f32 v88, v40, v41
  v_cvt_pk_bf16_f32 v89, v42, v43
  v_cvt_pk_bf16_f32 v90, v44, v45
  v_cvt_pk_bf16_f32 v91, v46, v47
  v_lshlrev_b32 v3, 8, v3
  v_lshl_add_u32 v3, v5, 4, v3
  v_add_u32 v3, 122880, v3
  ds_write_b128 v3, v[72:75] offset:0
  ds_write_b128 v3, v[76:79] offset:256
  ds_write_b128 v3, v[80:83] offset:512
  ds_write_b128 v3, v[84:87] offset:768
  ds_write_b128 v3, v[88:91] offset:1024
  s_waitcnt lgkmcnt(0)
  s_barrier
  v_lshlrev_b32 v13, 4, v0
  v_add_u32 v13, 122880, v13
  ds_read_b128 v[20:23], v13 offset:0
  ds_read_b128 v[24:27], v13 offset:1024
  ds_read_b128 v[28:31], v13 offset:2048
  ds_read_b128 v[32:35], v13 offset:3072
  ds_read_b128 v[36:39], v13 offset:4096
  ds_read_b128 v[40:43], v13 offset:5120
  ds_read_b128 v[44:47], v13 offset:6144
  ds_read_b128 v[48:51], v13 offset:7168
  ds_read_b128 v[52:55], v13 offset:8192
  ds_read_b128 v[56:59], v13 offset:9216
  ds_read_b128 v[60:63], v13 offset:10240
  ds_read_b128 v[64:67], v13 offset:11264
  s_waitcnt lgkmcnt(4)
  ds_read_b128 v[68:71], v13 offset:12288
  ds_read_b128 v[72:75], v13 offset:13312
  ds_read_b128 v[76:79], v13 offset:14336
  ds_read_b128 v[80:83], v13 offset:15360
  ds_read_b128 v[84:87], v13 offset:16384
  ds_read_b128 v[88:91], v13 offset:17408
  ds_read_b128 v[92:95], v13 offset:18432
  ds_read_b128 v[96:99], v13 offset:19456
  s_mov_b32 s4, s20
  s_mov_b32 s5, s21
  s_mov_b32 s6, 819200
  s_mov_b32 s7, 0x20000
  s_mov_b32 s12, s36
  s_mov_b32 s13, s37
  s_mov_b32 s14, 5242880
  s_mov_b32 s15, 0x20000
  v_mul_u32_u24 v12, 2560, v6
  v_lshrrev_b32 v14, 4, v0
  v_lshl_add_u32 v12, v14, 3, v12
  s_lshl_b32 s46, s42, 5
  v_add_u32 v12, s46, v12
  s_mov_b32 s66, 0
  s_waitcnt lgkmcnt(0)
  v_lshrrev_b32 v13, 3, v0
  v_lshrrev_b32 v14, 2, v13
  v_lshlrev_b32 v14, 3, v14
  v_and_b32 v8, 3, v13
  v_add_u32 v8, v8, v14
  s_and_b32 s46, s42, 1
  s_lshl_b32 s46, s46, 2
  s_lshr_b32 s47, s42, 1
  s_lshl_b32 s47, s47, 4
  s_add_u32 s46, s46, s47
  v_add_u32 v8, s46, v8
  v_mul_u32_u24 v8, 1280, v8
  v_lshrrev_b32 v13, 1, v13
  v_bfe_u32 v14, v0, 1, 2
  v_xor_b32 v13, v13, v14
  v_lshlrev_b32 v13, 5, v13
  v_and_b32 v14, 1, v0
  v_lshlrev_b32 v14, 4, v14
  v_add3_u32 v8, v8, v13, v14
  v_lshrrev_b32 v13, 5, v0
  v_lshlrev_b32 v9, 11, v13
  v_bfe_u32 v13, v0, 2, 3
  v_lshl_add_u32 v9, v13, 7, v9
  v_lshrrev_b32 v13, 1, v13
  v_xor_b32 v13, s42, v13
  v_lshl_add_u32 v9, v13, 5, v9
  v_and_b32 v13, 3, v0
  v_lshl_add_u32 v9, v13, 3, v9
  v_add_u32 v10, 0x10000, v9
  v_add_u32 v11, 0x20000, v9
  s_add_u32 m0, s51, 0
  s_add_u32 s46, s66, 0
  buffer_load_dwordx4 v8, s[4:7], s46 offen lds
  s_add_u32 m0, s51, 4096
  s_add_u32 s46, s66, 128
  buffer_load_dwordx4 v8, s[4:7], s46 offen lds
  s_add_u32 m0, s51, 8192
  s_add_u32 s46, s66, 256
  buffer_load_dwordx4 v8, s[4:7], s46 offen lds
  s_add_u32 m0, s51, 12288
  s_add_u32 s46, s66, 384
  buffer_load_dwordx4 v8, s[4:7], s46 offen lds
  s_add_u32 m0, s51, 16384
  s_add_u32 s46, s66, 512
  buffer_load_dwordx4 v8, s[4:7], s46 offen lds
  s_add_u32 m0, s51, 20480
  s_add_u32 s46, s66, 640
  buffer_load_dwordx4 v8, s[4:7], s46 offen lds
  s_add_u32 m0, s51, 24576
  s_add_u32 s46, s66, 768
  buffer_load_dwordx4 v8, s[4:7], s46 offen lds
  s_add_u32 m0, s51, 28672
  s_add_u32 s46, s66, 896
  buffer_load_dwordx4 v8, s[4:7], s46 offen lds
  s_add_u32 m0, s51, 32768
  s_add_u32 s46, s66, 1024
  buffer_load_dwordx4 v8, s[4:7], s46 offen lds
  s_add_u32 m0, s51, 36864
  s_add_u32 s46, s66, 1152
  buffer_load_dwordx4 v8, s[4:7], s46 offen lds
  s_add_u32 m0, s51, 40960
  s_add_u32 s46, s66, 40960
  buffer_load_dwordx4 v8, s[4:7], s46 offen lds
  s_add_u32 m0, s51, 45056
  s_add_u32 s46, s66, 41088
  buffer_load_dwordx4 v8, s[4:7], s46 offen lds
  s_add_u32 m0, s51, 49152
  s_add_u32 s46, s66, 41216
  buffer_load_dwordx4 v8, s[4:7], s46 offen lds
  s_add_u32 m0, s51, 53248
  s_add_u32 s46, s66, 41344
  buffer_load_dwordx4 v8, s[4:7], s46 offen lds
  s_add_u32 m0, s51, 57344
  s_add_u32 s46, s66, 41472
  buffer_load_dwordx4 v8, s[4:7], s46 offen lds
  s_add_u32 m0, s51, 61440
  s_add_u32 s46, s66, 41600
  buffer_load_dwordx4 v8, s[4:7], s46 offen lds
  s_add_u32 m0, s51, 65536
  s_add_u32 s46, s66, 41728
  buffer_load_dwordx4 v8, s[4:7], s46 offen lds
  s_add_u32 m0, s51, 69632
  s_add_u32 s46, s66, 41856
  buffer_load_dwordx4 v8, s[4:7], s46 offen lds
  s_add_u32 m0, s51, 73728
  s_add_u32 s46, s66, 41984
  buffer_load_dwordx4 v8, s[4:7], s46 offen lds
  s_add_u32 m0, s51, 77824
  s_add_u32 s46, s66, 42112
  buffer_load_dwordx4 v8, s[4:7], s46 offen lds
  s_add_u32 m0, s51, 81920
  s_add_u32 s46, s66, 81920
  buffer_load_dwordx4 v8, s[4:7], s46 offen lds
  s_add_u32 m0, s51, 86016
  s_add_u32 s46, s66, 82048
  buffer_load_dwordx4 v8, s[4:7], s46 offen lds
  s_add_u32 m0, s51, 90112
  s_add_u32 s46, s66, 82176
  buffer_load_dwordx4 v8, s[4:7], s46 offen lds
  s_add_u32 m0, s51, 94208
  s_add_u32 s46, s66, 82304
  buffer_load_dwordx4 v8, s[4:7], s46 offen lds
  s_add_u32 m0, s51, 98304
  s_add_u32 s46, s66, 82432
  buffer_load_dwordx4 v8, s[4:7], s46 offen lds
  s_waitcnt vmcnt(20)
  s_barrier
  s_add_u32 m0, s51, 102400
  s_add_u32 s46, s66, 82560
  buffer_load_dwordx4 v8, s[4:7], s46 offen lds
  s_add_u32 m0, s51, 106496
  s_add_u32 s46, s66, 82688
  buffer_load_dwordx4 v8, s[4:7], s46 offen lds
  s_add_u32 m0, s51, 110592
  s_add_u32 s46, s66, 82816
  buffer_load_dwordx4 v8, s[4:7], s46 offen lds
  s_add_u32 m0, s51, 114688
  s_add_u32 s46, s66, 82944
  buffer_load_dwordx4 v8, s[4:7], s46 offen lds
  s_add_u32 m0, s51, 118784
  s_add_u32 s46, s66, 83072
  buffer_load_dwordx4 v8, s[4:7], s46 offen lds
  ds_read_b64_tr_b16 v[100:101], v9 offset:0
  ds_read_b64_tr_b16 v[102:103], v9 offset:1024
  ds_read_b64_tr_b16 v[104:105], v9 offset:4096
  ds_read_b64_tr_b16 v[106:107], v9 offset:5120
  ds_read_b64_tr_b16 v[108:109], v9 offset:8192
  ds_read_b64_tr_b16 v[110:111], v9 offset:9216
  ds_read_b64_tr_b16 v[112:113], v9 offset:12288
  ds_read_b64_tr_b16 v[114:115], v9 offset:13312
  ds_read_b64_tr_b16 v[116:117], v9 offset:16384
  ds_read_b64_tr_b16 v[118:119], v9 offset:17408
  s_waitcnt lgkmcnt(0)
  v_mfma_f32_16x16x32_bf16 v[140:143], v[100:103], v[20:23], 0
  v_mfma_f32_16x16x32_bf16 v[144:147], v[104:107], v[20:23], 0
  v_mfma_f32_16x16x32_bf16 v[148:151], v[108:111], v[20:23], 0
  v_mfma_f32_16x16x32_bf16 v[152:155], v[112:115], v[20:23], 0
  v_mfma_f32_16x16x32_bf16 v[156:159], v[116:119], v[20:23], 0
  s_waitcnt vmcnt(20)
  s_barrier
  s_add_u32 m0, s51, 0
  s_add_u32 s46, s66, 122880
  buffer_load_dwordx4 v8, s[4:7], s46 offen lds
  s_add_u32 m0, s51, 4096
  s_add_u32 s46, s66, 123008
  buffer_load_dwordx4 v8, s[4:7], s46 offen lds
  s_add_u32 m0, s51, 8192
  s_add_u32 s46, s66, 123136
  buffer_load_dwordx4 v8, s[4:7], s46 offen lds
  s_add_u32 m0, s51, 12288
  s_add_u32 s46, s66, 123264
  buffer_load_dwordx4 v8, s[4:7], s46 offen lds
  s_add_u32 m0, s51, 16384
  s_add_u32 s46, s66, 123392
  buffer_load_dwordx4 v8, s[4:7], s46 offen lds
  ds_read_b64_tr_b16 v[120:121], v9 offset:20480
  ds_read_b64_tr_b16 v[122:123], v9 offset:21504
  ds_read_b64_tr_b16 v[124:125], v9 offset:24576
  ds_read_b64_tr_b16 v[126:127], v9 offset:25600
  ds_read_b64_tr_b16 v[128:129], v9 offset:28672
  ds_read_b64_tr_b16 v[130:131], v9 offset:29696
  ds_read_b64_tr_b16 v[132:133], v9 offset:32768
  ds_read_b64_tr_b16 v[134:135], v9 offset:33792
  ds_read_b64_tr_b16 v[136:137], v9 offset:36864
  ds_read_b64_tr_b16 v[138:139], v9 offset:37888
  s_waitcnt lgkmcnt(0)
  v_mfma_f32_16x16x32_bf16 v[160:163], v[120:123], v[20:23], 0
  v_mfma_f32_16x16x32_bf16 v[164:167], v[124:127], v[20:23], 0
  v_mfma_f32_16x16x32_bf16 v[168:171], v[128:131], v[20:23], 0
  v_mfma_f32_16x16x32_bf16 v[172:175], v[132:135], v[20:23], 0
  v_mfma_f32_16x16x32_bf16 v[176:179], v[136:139], v[20:23], 0
  s_waitcnt vmcnt(20)
  s_barrier
  s_add_u32 m0, s51, 20480
  s_add_u32 s46, s66, 123520
  buffer_load_dwordx4 v8, s[4:7], s46 offen lds
  s_add_u32 m0, s51, 24576
  s_add_u32 s46, s66, 123648
  buffer_load_dwordx4 v8, s[4:7], s46 offen lds
  s_add_u32 m0, s51, 28672
  s_add_u32 s46, s66, 123776
  buffer_load_dwordx4 v8, s[4:7], s46 offen lds
  s_add_u32 m0, s51, 32768
  s_add_u32 s46, s66, 123904
  buffer_load_dwordx4 v8, s[4:7], s46 offen lds
  s_add_u32 m0, s51, 36864
  s_add_u32 s46, s66, 124032
  buffer_load_dwordx4 v8, s[4:7], s46 offen lds
  ds_read_b64_tr_b16 v[100:101], v9 offset:40960
  ds_read_b64_tr_b16 v[102:103], v9 offset:41984
  ds_read_b64_tr_b16 v[104:105], v9 offset:45056
  ds_read_b64_tr_b16 v[106:107], v9 offset:46080
  ds_read_b64_tr_b16 v[108:109], v9 offset:49152
  ds_read_b64_tr_b16 v[110:111], v9 offset:50176
  ds_read_b64_tr_b16 v[112:113], v9 offset:53248
  ds_read_b64_tr_b16 v[114:115], v9 offset:54272
  ds_read_b64_tr_b16 v[116:117], v9 offset:57344
  ds_read_b64_tr_b16 v[118:119], v9 offset:58368
  s_waitcnt lgkmcnt(0)
  v_mfma_f32_16x16x32_bf16 v[140:143], v[100:103], v[24:27], v[140:143]
  v_mfma_f32_16x16x32_bf16 v[144:147], v[104:107], v[24:27], v[144:147]
  v_mfma_f32_16x16x32_bf16 v[148:151], v[108:111], v[24:27], v[148:151]
  v_mfma_f32_16x16x32_bf16 v[152:155], v[112:115], v[24:27], v[152:155]
  v_mfma_f32_16x16x32_bf16 v[156:159], v[116:119], v[24:27], v[156:159]
  s_waitcnt vmcnt(20)
  s_barrier
  s_add_u32 m0, s51, 40960
  s_add_u32 s46, s66, 163840
  buffer_load_dwordx4 v8, s[4:7], s46 offen lds
  s_add_u32 m0, s51, 45056
  s_add_u32 s46, s66, 163968
  buffer_load_dwordx4 v8, s[4:7], s46 offen lds
  s_add_u32 m0, s51, 49152
  s_add_u32 s46, s66, 164096
  buffer_load_dwordx4 v8, s[4:7], s46 offen lds
  s_add_u32 m0, s51, 53248
  s_add_u32 s46, s66, 164224
  buffer_load_dwordx4 v8, s[4:7], s46 offen lds
  s_add_u32 m0, s51, 57344
  s_add_u32 s46, s66, 164352
  buffer_load_dwordx4 v8, s[4:7], s46 offen lds
  ds_read_b64_tr_b16 v[120:121], v9 offset:61440
  ds_read_b64_tr_b16 v[122:123], v9 offset:62464
  ds_read_b64_tr_b16 v[124:125], v10 offset:0
  ds_read_b64_tr_b16 v[126:127], v10 offset:1024
  ds_read_b64_tr_b16 v[128:129], v10 offset:4096
  ds_read_b64_tr_b16 v[130:131], v10 offset:5120
  ds_read_b64_tr_b16 v[132:133], v10 offset:8192
  ds_read_b64_tr_b16 v[134:135], v10 offset:9216
  ds_read_b64_tr_b16 v[136:137], v10 offset:12288
  ds_read_b64_tr_b16 v[138:139], v10 offset:13312
  s_waitcnt lgkmcnt(0)
  v_mfma_f32_16x16x32_bf16 v[160:163], v[120:123], v[24:27], v[160:163]
  v_mfma_f32_16x16x32_bf16 v[164:167], v[124:127], v[24:27], v[164:167]
  v_mfma_f32_16x16x32_bf16 v[168:171], v[128:131], v[24:27], v[168:171]
  v_mfma_f32_16x16x32_bf16 v[172:175], v[132:135], v[24:27], v[172:175]
  v_mfma_f32_16x16x32_bf16 v[176:179], v[136:139], v[24:27], v[176:179]
  s_waitcnt vmcnt(20)
  s_barrier
  s_add_u32 m0, s51, 61440
  s_add_u32 s46, s66, 164480
  buffer_load_dwordx4 v8, s[4:7], s46 offen lds
  s_add_u32 m0, s51, 65536
  s_add_u32 s46, s66, 164608
  buffer_load_dwordx4 v8, s[4:7], s46 offen lds
  s_add_u32 m0, s51, 69632
  s_add_u32 s46, s66, 164736
  buffer_load_dwordx4 v8, s[4:7], s46 offen lds
  s_add_u32 m0, s51, 73728
  s_add_u32 s46, s66, 164864
  buffer_load_dwordx4 v8, s[4:7], s46 offen lds
  s_add_u32 m0, s51, 77824
  s_add_u32 s46, s66, 164992
  buffer_load_dwordx4 v8, s[4:7], s46 offen lds
  ds_read_b64_tr_b16 v[100:101], v10 offset:16384
  ds_read_b64_tr_b16 v[102:103], v10 offset:17408
  ds_read_b64_tr_b16 v[104:105], v10 offset:20480
  ds_read_b64_tr_b16 v[106:107], v10 offset:21504
  ds_read_b64_tr_b16 v[108:109], v10 offset:24576
  ds_read_b64_tr_b16 v[110:111], v10 offset:25600
  ds_read_b64_tr_b16 v[112:113], v10 offset:28672
  ds_read_b64_tr_b16 v[114:115], v10 offset:29696
  ds_read_b64_tr_b16 v[116:117], v10 offset:32768
  ds_read_b64_tr_b16 v[118:119], v10 offset:33792
  s_waitcnt lgkmcnt(0)
  v_mfma_f32_16x16x32_bf16 v[140:143], v[100:103], v[28:31], v[140:143]
  v_mfma_f32_16x16x32_bf16 v[144:147], v[104:107], v[28:31], v[144:147]
  v_mfma_f32_16x16x32_bf16 v[148:151], v[108:111], v[28:31], v[148:151]
  v_mfma_f32_16x16x32_bf16 v[152:155], v[112:115], v[28:31], v[152:155]
  v_mfma_f32_16x16x32_bf16 v[156:159], v[116:119], v[28:31], v[156:159]
  s_waitcnt vmcnt(20)
  s_barrier
  s_add_u32 m0, s51, 81920
  s_add_u32 s46, s66, 204800
  buffer_load_dwordx4 v8, s[4:7], s46 offen lds
  s_add_u32 m0, s51, 86016
  s_add_u32 s46, s66, 204928
  buffer_load_dwordx4 v8, s[4:7], s46 offen lds
  s_add_u32 m0, s51, 90112
  s_add_u32 s46, s66, 205056
  buffer_load_dwordx4 v8, s[4:7], s46 offen lds
  s_add_u32 m0, s51, 94208
  s_add_u32 s46, s66, 205184
  buffer_load_dwordx4 v8, s[4:7], s46 offen lds
  s_add_u32 m0, s51, 98304
  s_add_u32 s46, s66, 205312
  buffer_load_dwordx4 v8, s[4:7], s46 offen lds
  ds_read_b64_tr_b16 v[120:121], v10 offset:36864
  ds_read_b64_tr_b16 v[122:123], v10 offset:37888
  ds_read_b64_tr_b16 v[124:125], v10 offset:40960
  ds_read_b64_tr_b16 v[126:127], v10 offset:41984
  ds_read_b64_tr_b16 v[128:129], v10 offset:45056
  ds_read_b64_tr_b16 v[130:131], v10 offset:46080
  ds_read_b64_tr_b16 v[132:133], v10 offset:49152
  ds_read_b64_tr_b16 v[134:135], v10 offset:50176
  ds_read_b64_tr_b16 v[136:137], v10 offset:53248
  ds_read_b64_tr_b16 v[138:139], v10 offset:54272
  s_waitcnt lgkmcnt(0)
  v_mfma_f32_16x16x32_bf16 v[160:163], v[120:123], v[28:31], v[160:163]
  v_mfma_f32_16x16x32_bf16 v[164:167], v[124:127], v[28:31], v[164:167]
  v_mfma_f32_16x16x32_bf16 v[168:171], v[128:131], v[28:31], v[168:171]
  v_mfma_f32_16x16x32_bf16 v[172:175], v[132:135], v[28:31], v[172:175]
  v_mfma_f32_16x16x32_bf16 v[176:179], v[136:139], v[28:31], v[176:179]
  s_waitcnt vmcnt(20)
  s_barrier
  s_add_u32 m0, s51, 102400
  s_add_u32 s46, s66, 205440
  buffer_load_dwordx4 v8, s[4:7], s46 offen lds
  s_add_u32 m0, s51, 106496
  s_add_u32 s46, s66, 205568
  buffer_load_dwordx4 v8, s[4:7], s46 offen lds
  s_add_u32 m0, s51, 110592
  s_add_u32 s46, s66, 205696
  buffer_load_dwordx4 v8, s[4:7], s46 offen lds
  s_add_u32 m0, s51, 114688
  s_add_u32 s46, s66, 205824
  buffer_load_dwordx4 v8, s[4:7], s46 offen lds
  s_add_u32 m0, s51, 118784
  s_add_u32 s46, s66, 205952
  buffer_load_dwordx4 v8, s[4:7], s46 offen lds
  ds_read_b64_tr_b16 v[100:101], v9 offset:0
  ds_read_b64_tr_b16 v[102:103], v9 offset:1024
  ds_read_b64_tr_b16 v[104:105], v9 offset:4096
  ds_read_b64_tr_b16 v[106:107], v9 offset:5120
  ds_read_b64_tr_b16 v[108:109], v9 offset:8192
  ds_read_b64_tr_b16 v[110:111], v9 offset:9216
  ds_read_b64_tr_b16 v[112:113], v9 offset:12288
  ds_read_b64_tr_b16 v[114:115], v9 offset:13312
  ds_read_b64_tr_b16 v[116:117], v9 offset:16384
  ds_read_b64_tr_b16 v[118:119], v9 offset:17408
  s_waitcnt lgkmcnt(0)
  v_mfma_f32_16x16x32_bf16 v[140:143], v[100:103], v[32:35], v[140:143]
  v_mfma_f32_16x16x32_bf16 v[144:147], v[104:107], v[32:35], v[144:147]
  v_mfma_f32_16x16x32_bf16 v[148:151], v[108:111], v[32:35], v[148:151]
  v_mfma_f32_16x16x32_bf16 v[152:155], v[112:115], v[32:35], v[152:155]
  v_mfma_f32_16x16x32_bf16 v[156:159], v[116:119], v[32:35], v[156:159]
  s_waitcnt vmcnt(20)
  s_barrier
  s_add_u32 m0, s51, 0
  s_add_u32 s46, s66, 245760
  buffer_load_dwordx4 v8, s[4:7], s46 offen lds
  s_add_u32 m0, s51, 4096
  s_add_u32 s46, s66, 245888
  buffer_load_dwordx4 v8, s[4:7], s46 offen lds
  s_add_u32 m0, s51, 8192
  s_add_u32 s46, s66, 246016
  buffer_load_dwordx4 v8, s[4:7], s46 offen lds
  s_add_u32 m0, s51, 12288
  s_add_u32 s46, s66, 246144
  buffer_load_dwordx4 v8, s[4:7], s46 offen lds
  s_add_u32 m0, s51, 16384
  s_add_u32 s46, s66, 246272
  buffer_load_dwordx4 v8, s[4:7], s46 offen lds
  ds_read_b64_tr_b16 v[120:121], v9 offset:20480
  ds_read_b64_tr_b16 v[122:123], v9 offset:21504
  ds_read_b64_tr_b16 v[124:125], v9 offset:24576
  ds_read_b64_tr_b16 v[126:127], v9 offset:25600
  ds_read_b64_tr_b16 v[128:129], v9 offset:28672
  ds_read_b64_tr_b16 v[130:131], v9 offset:29696
  ds_read_b64_tr_b16 v[132:133], v9 offset:32768
  ds_read_b64_tr_b16 v[134:135], v9 offset:33792
  ds_read_b64_tr_b16 v[136:137], v9 offset:36864
  ds_read_b64_tr_b16 v[138:139], v9 offset:37888
  s_waitcnt lgkmcnt(0)
  v_mfma_f32_16x16x32_bf16 v[160:163], v[120:123], v[32:35], v[160:163]
  v_mfma_f32_16x16x32_bf16 v[164:167], v[124:127], v[32:35], v[164:167]
  v_mfma_f32_16x16x32_bf16 v[168:171], v[128:131], v[32:35], v[168:171]
  v_mfma_f32_16x16x32_bf16 v[172:175], v[132:135], v[32:35], v[172:175]
  v_mfma_f32_16x16x32_bf16 v[176:179], v[136:139], v[32:35], v[176:179]
  s_waitcnt vmcnt(20)
  s_barrier
  s_add_u32 m0, s51, 20480
  s_add_u32 s46, s66, 246400
  buffer_load_dwordx4 v8, s[4:7], s46 offen lds
  s_add_u32 m0, s51, 24576
  s_add_u32 s46, s66, 246528
  buffer_load_dwordx4 v8, s[4:7], s46 offen lds
  s_add_u32 m0, s51, 28672
  s_add_u32 s46, s66, 246656
  buffer_load_dwordx4 v8, s[4:7], s46 offen lds
  s_add_u32 m0, s51, 32768
  s_add_u32 s46, s66, 246784
  buffer_load_dwordx4 v8, s[4:7], s46 offen lds
  s_add_u32 m0, s51, 36864
  s_add_u32 s46, s66, 246912
  buffer_load_dwordx4 v8, s[4:7], s46 offen lds
  ds_read_b64_tr_b16 v[100:101], v9 offset:40960
  ds_read_b64_tr_b16 v[102:103], v9 offset:41984
  ds_read_b64_tr_b16 v[104:105], v9 offset:45056
  ds_read_b64_tr_b16 v[106:107], v9 offset:46080
  ds_read_b64_tr_b16 v[108:109], v9 offset:49152
  ds_read_b64_tr_b16 v[110:111], v9 offset:50176
  ds_read_b64_tr_b16 v[112:113], v9 offset:53248
  ds_read_b64_tr_b16 v[114:115], v9 offset:54272
  ds_read_b64_tr_b16 v[116:117], v9 offset:57344
  ds_read_b64_tr_b16 v[118:119], v9 offset:58368
  s_waitcnt lgkmcnt(0)
  v_mfma_f32_16x16x32_bf16 v[140:143], v[100:103], v[36:39], v[140:143]
  v_mfma_f32_16x16x32_bf16 v[144:147], v[104:107], v[36:39], v[144:147]
  v_mfma_f32_16x16x32_bf16 v[148:151], v[108:111], v[36:39], v[148:151]
  v_mfma_f32_16x16x32_bf16 v[152:155], v[112:115], v[36:39], v[152:155]
  v_mfma_f32_16x16x32_bf16 v[156:159], v[116:119], v[36:39], v[156:159]
  s_waitcnt vmcnt(20)
  s_barrier
  s_add_u32 m0, s51, 40960
  s_add_u32 s46, s66, 286720
  buffer_load_dwordx4 v8, s[4:7], s46 offen lds
  s_add_u32 m0, s51, 45056
  s_add_u32 s46, s66, 286848
  buffer_load_dwordx4 v8, s[4:7], s46 offen lds
  s_add_u32 m0, s51, 49152
  s_add_u32 s46, s66, 286976
  buffer_load_dwordx4 v8, s[4:7], s46 offen lds
  s_add_u32 m0, s51, 53248
  s_add_u32 s46, s66, 287104
  buffer_load_dwordx4 v8, s[4:7], s46 offen lds
  s_add_u32 m0, s51, 57344
  s_add_u32 s46, s66, 287232
  buffer_load_dwordx4 v8, s[4:7], s46 offen lds
  ds_read_b64_tr_b16 v[120:121], v9 offset:61440
  ds_read_b64_tr_b16 v[122:123], v9 offset:62464
  ds_read_b64_tr_b16 v[124:125], v10 offset:0
  ds_read_b64_tr_b16 v[126:127], v10 offset:1024
  ds_read_b64_tr_b16 v[128:129], v10 offset:4096
  ds_read_b64_tr_b16 v[130:131], v10 offset:5120
  ds_read_b64_tr_b16 v[132:133], v10 offset:8192
  ds_read_b64_tr_b16 v[134:135], v10 offset:9216
  ds_read_b64_tr_b16 v[136:137], v10 offset:12288
  ds_read_b64_tr_b16 v[138:139], v10 offset:13312
  s_waitcnt lgkmcnt(0)
  v_mfma_f32_16x16x32_bf16 v[160:163], v[120:123], v[36:39], v[160:163]
  v_mfma_f32_16x16x32_bf16 v[164:167], v[124:127], v[36:39], v[164:167]
  v_mfma_f32_16x16x32_bf16 v[168:171], v[128:131], v[36:39], v[168:171]
  v_mfma_f32_16x16x32_bf16 v[172:175], v[132:135], v[36:39], v[172:175]
  v_mfma_f32_16x16x32_bf16 v[176:179], v[136:139], v[36:39], v[176:179]
  s_waitcnt vmcnt(20)
  s_barrier
  s_add_u32 m0, s51, 61440
  s_add_u32 s46, s66, 287360
  buffer_load_dwordx4 v8, s[4:7], s46 offen lds
  s_add_u32 m0, s51, 65536
  s_add_u32 s46, s66, 287488
  buffer_load_dwordx4 v8, s[4:7], s46 offen lds
  s_add_u32 m0, s51, 69632
  s_add_u32 s46, s66, 287616
  buffer_load_dwordx4 v8, s[4:7], s46 offen lds
  s_add_u32 m0, s51, 73728
  s_add_u32 s46, s66, 287744
  buffer_load_dwordx4 v8, s[4:7], s46 offen lds
  s_add_u32 m0, s51, 77824
  s_add_u32 s46, s66, 287872
  buffer_load_dwordx4 v8, s[4:7], s46 offen lds
  ds_read_b64_tr_b16 v[100:101], v10 offset:16384
  ds_read_b64_tr_b16 v[102:103], v10 offset:17408
  ds_read_b64_tr_b16 v[104:105], v10 offset:20480
  ds_read_b64_tr_b16 v[106:107], v10 offset:21504
  ds_read_b64_tr_b16 v[108:109], v10 offset:24576
  ds_read_b64_tr_b16 v[110:111], v10 offset:25600
  ds_read_b64_tr_b16 v[112:113], v10 offset:28672
  ds_read_b64_tr_b16 v[114:115], v10 offset:29696
  ds_read_b64_tr_b16 v[116:117], v10 offset:32768
  ds_read_b64_tr_b16 v[118:119], v10 offset:33792
  s_waitcnt lgkmcnt(0)
  v_mfma_f32_16x16x32_bf16 v[140:143], v[100:103], v[40:43], v[140:143]
  v_mfma_f32_16x16x32_bf16 v[144:147], v[104:107], v[40:43], v[144:147]
  v_mfma_f32_16x16x32_bf16 v[148:151], v[108:111], v[40:43], v[148:151]
  v_mfma_f32_16x16x32_bf16 v[152:155], v[112:115], v[40:43], v[152:155]
  v_mfma_f32_16x16x32_bf16 v[156:159], v[116:119], v[40:43], v[156:159]
  s_waitcnt vmcnt(20)
  s_barrier
  s_add_u32 m0, s51, 81920
  s_add_u32 s46, s66, 327680
  buffer_load_dwordx4 v8, s[4:7], s46 offen lds
  s_add_u32 m0, s51, 86016
  s_add_u32 s46, s66, 327808
  buffer_load_dwordx4 v8, s[4:7], s46 offen lds
  s_add_u32 m0, s51, 90112
  s_add_u32 s46, s66, 327936
  buffer_load_dwordx4 v8, s[4:7], s46 offen lds
  s_add_u32 m0, s51, 94208
  s_add_u32 s46, s66, 328064
  buffer_load_dwordx4 v8, s[4:7], s46 offen lds
  s_add_u32 m0, s51, 98304
  s_add_u32 s46, s66, 328192
  buffer_load_dwordx4 v8, s[4:7], s46 offen lds
  ds_read_b64_tr_b16 v[120:121], v10 offset:36864
  ds_read_b64_tr_b16 v[122:123], v10 offset:37888
  ds_read_b64_tr_b16 v[124:125], v10 offset:40960
  ds_read_b64_tr_b16 v[126:127], v10 offset:41984
  ds_read_b64_tr_b16 v[128:129], v10 offset:45056
  ds_read_b64_tr_b16 v[130:131], v10 offset:46080
  ds_read_b64_tr_b16 v[132:133], v10 offset:49152
  ds_read_b64_tr_b16 v[134:135], v10 offset:50176
  ds_read_b64_tr_b16 v[136:137], v10 offset:53248
  ds_read_b64_tr_b16 v[138:139], v10 offset:54272
  s_waitcnt lgkmcnt(0)
  v_mfma_f32_16x16x32_bf16 v[160:163], v[120:123], v[40:43], v[160:163]
  v_mfma_f32_16x16x32_bf16 v[164:167], v[124:127], v[40:43], v[164:167]
  v_mfma_f32_16x16x32_bf16 v[168:171], v[128:131], v[40:43], v[168:171]
  v_mfma_f32_16x16x32_bf16 v[172:175], v[132:135], v[40:43], v[172:175]
  v_mfma_f32_16x16x32_bf16 v[176:179], v[136:139], v[40:43], v[176:179]
  s_waitcnt vmcnt(20)
  s_barrier
  s_add_u32 m0, s51, 102400
  s_add_u32 s46, s66, 328320
  buffer_load_dwordx4 v8, s[4:7], s46 offen lds
  s_add_u32 m0, s51, 106496
  s_add_u32 s46, s66, 328448
  buffer_load_dwordx4 v8, s[4:7], s46 offen lds
  s_add_u32 m0, s51, 110592
  s_add_u32 s46, s66, 328576
  buffer_load_dwordx4 v8, s[4:7], s46 offen lds
  s_add_u32 m0, s51, 114688
  s_add_u32 s46, s66, 328704
  buffer_load_dwordx4 v8, s[4:7], s46 offen lds
  s_add_u32 m0, s51, 118784
  s_add_u32 s46, s66, 328832
  buffer_load_dwordx4 v8, s[4:7], s46 offen lds
  ds_read_b64_tr_b16 v[100:101], v9 offset:0
  ds_read_b64_tr_b16 v[102:103], v9 offset:1024
  ds_read_b64_tr_b16 v[104:105], v9 offset:4096
  ds_read_b64_tr_b16 v[106:107], v9 offset:5120
  ds_read_b64_tr_b16 v[108:109], v9 offset:8192
  ds_read_b64_tr_b16 v[110:111], v9 offset:9216
  ds_read_b64_tr_b16 v[112:113], v9 offset:12288
  ds_read_b64_tr_b16 v[114:115], v9 offset:13312
  ds_read_b64_tr_b16 v[116:117], v9 offset:16384
  ds_read_b64_tr_b16 v[118:119], v9 offset:17408
  s_waitcnt lgkmcnt(0)
  v_mfma_f32_16x16x32_bf16 v[140:143], v[100:103], v[44:47], v[140:143]
  v_mfma_f32_16x16x32_bf16 v[144:147], v[104:107], v[44:47], v[144:147]
  v_mfma_f32_16x16x32_bf16 v[148:151], v[108:111], v[44:47], v[148:151]
  v_mfma_f32_16x16x32_bf16 v[152:155], v[112:115], v[44:47], v[152:155]
  v_mfma_f32_16x16x32_bf16 v[156:159], v[116:119], v[44:47], v[156:159]
  s_waitcnt vmcnt(20)
  s_barrier
  s_add_u32 m0, s51, 0
  s_add_u32 s46, s66, 368640
  buffer_load_dwordx4 v8, s[4:7], s46 offen lds
  s_add_u32 m0, s51, 4096
  s_add_u32 s46, s66, 368768
  buffer_load_dwordx4 v8, s[4:7], s46 offen lds
  s_add_u32 m0, s51, 8192
  s_add_u32 s46, s66, 368896
  buffer_load_dwordx4 v8, s[4:7], s46 offen lds
  s_add_u32 m0, s51, 12288
  s_add_u32 s46, s66, 369024
  buffer_load_dwordx4 v8, s[4:7], s46 offen lds
  s_add_u32 m0, s51, 16384
  s_add_u32 s46, s66, 369152
  buffer_load_dwordx4 v8, s[4:7], s46 offen lds
  ds_read_b64_tr_b16 v[120:121], v9 offset:20480
  ds_read_b64_tr_b16 v[122:123], v9 offset:21504
  ds_read_b64_tr_b16 v[124:125], v9 offset:24576
  ds_read_b64_tr_b16 v[126:127], v9 offset:25600
  ds_read_b64_tr_b16 v[128:129], v9 offset:28672
  ds_read_b64_tr_b16 v[130:131], v9 offset:29696
  ds_read_b64_tr_b16 v[132:133], v9 offset:32768
  ds_read_b64_tr_b16 v[134:135], v9 offset:33792
  ds_read_b64_tr_b16 v[136:137], v9 offset:36864
  ds_read_b64_tr_b16 v[138:139], v9 offset:37888
  s_waitcnt lgkmcnt(0)
  v_mfma_f32_16x16x32_bf16 v[160:163], v[120:123], v[44:47], v[160:163]
  v_mfma_f32_16x16x32_bf16 v[164:167], v[124:127], v[44:47], v[164:167]
  v_mfma_f32_16x16x32_bf16 v[168:171], v[128:131], v[44:47], v[168:171]
  v_mfma_f32_16x16x32_bf16 v[172:175], v[132:135], v[44:47], v[172:175]
  v_mfma_f32_16x16x32_bf16 v[176:179], v[136:139], v[44:47], v[176:179]
  s_waitcnt vmcnt(20)
  s_barrier
  s_add_u32 m0, s51, 20480
  s_add_u32 s46, s66, 369280
  buffer_load_dwordx4 v8, s[4:7], s46 offen lds
  s_add_u32 m0, s51, 24576
  s_add_u32 s46, s66, 369408
  buffer_load_dwordx4 v8, s[4:7], s46 offen lds
  s_add_u32 m0, s51, 28672
  s_add_u32 s46, s66, 369536
  buffer_load_dwordx4 v8, s[4:7], s46 offen lds
  s_add_u32 m0, s51, 32768
  s_add_u32 s46, s66, 369664
  buffer_load_dwordx4 v8, s[4:7], s46 offen lds
  s_add_u32 m0, s51, 36864
  s_add_u32 s46, s66, 369792
  buffer_load_dwordx4 v8, s[4:7], s46 offen lds
  ds_read_b64_tr_b16 v[100:101], v9 offset:40960
  ds_read_b64_tr_b16 v[102:103], v9 offset:41984
  ds_read_b64_tr_b16 v[104:105], v9 offset:45056
  ds_read_b64_tr_b16 v[106:107], v9 offset:46080
  ds_read_b64_tr_b16 v[108:109], v9 offset:49152
  ds_read_b64_tr_b16 v[110:111], v9 offset:50176
  ds_read_b64_tr_b16 v[112:113], v9 offset:53248
  ds_read_b64_tr_b16 v[114:115], v9 offset:54272
  ds_read_b64_tr_b16 v[116:117], v9 offset:57344
  ds_read_b64_tr_b16 v[118:119], v9 offset:58368
  s_waitcnt lgkmcnt(0)
  v_mfma_f32_16x16x32_bf16 v[140:143], v[100:103], v[48:51], v[140:143]
  v_mfma_f32_16x16x32_bf16 v[144:147], v[104:107], v[48:51], v[144:147]
  v_mfma_f32_16x16x32_bf16 v[148:151], v[108:111], v[48:51], v[148:151]
  v_mfma_f32_16x16x32_bf16 v[152:155], v[112:115], v[48:51], v[152:155]
  v_mfma_f32_16x16x32_bf16 v[156:159], v[116:119], v[48:51], v[156:159]
  s_waitcnt vmcnt(20)
  s_barrier
  s_add_u32 m0, s51, 40960
  s_add_u32 s46, s66, 409600
  buffer_load_dwordx4 v8, s[4:7], s46 offen lds
  s_add_u32 m0, s51, 45056
  s_add_u32 s46, s66, 409728
  buffer_load_dwordx4 v8, s[4:7], s46 offen lds
  s_add_u32 m0, s51, 49152
  s_add_u32 s46, s66, 409856
  buffer_load_dwordx4 v8, s[4:7], s46 offen lds
  s_add_u32 m0, s51, 53248
  s_add_u32 s46, s66, 409984
  buffer_load_dwordx4 v8, s[4:7], s46 offen lds
  s_add_u32 m0, s51, 57344
  s_add_u32 s46, s66, 410112
  buffer_load_dwordx4 v8, s[4:7], s46 offen lds
  ds_read_b64_tr_b16 v[120:121], v9 offset:61440
  ds_read_b64_tr_b16 v[122:123], v9 offset:62464
  ds_read_b64_tr_b16 v[124:125], v10 offset:0
  ds_read_b64_tr_b16 v[126:127], v10 offset:1024
  ds_read_b64_tr_b16 v[128:129], v10 offset:4096
  ds_read_b64_tr_b16 v[130:131], v10 offset:5120
  ds_read_b64_tr_b16 v[132:133], v10 offset:8192
  ds_read_b64_tr_b16 v[134:135], v10 offset:9216
  ds_read_b64_tr_b16 v[136:137], v10 offset:12288
  ds_read_b64_tr_b16 v[138:139], v10 offset:13312
  s_waitcnt lgkmcnt(0)
  v_mfma_f32_16x16x32_bf16 v[160:163], v[120:123], v[48:51], v[160:163]
  v_mfma_f32_16x16x32_bf16 v[164:167], v[124:127], v[48:51], v[164:167]
  v_mfma_f32_16x16x32_bf16 v[168:171], v[128:131], v[48:51], v[168:171]
  v_mfma_f32_16x16x32_bf16 v[172:175], v[132:135], v[48:51], v[172:175]
  v_mfma_f32_16x16x32_bf16 v[176:179], v[136:139], v[48:51], v[176:179]
  s_waitcnt vmcnt(20)
  s_barrier
  s_add_u32 m0, s51, 61440
  s_add_u32 s46, s66, 410240
  buffer_load_dwordx4 v8, s[4:7], s46 offen lds
  s_add_u32 m0, s51, 65536
  s_add_u32 s46, s66, 410368
  buffer_load_dwordx4 v8, s[4:7], s46 offen lds
  s_add_u32 m0, s51, 69632
  s_add_u32 s46, s66, 410496
  buffer_load_dwordx4 v8, s[4:7], s46 offen lds
  s_add_u32 m0, s51, 73728
  s_add_u32 s46, s66, 410624
  buffer_load_dwordx4 v8, s[4:7], s46 offen lds
  s_add_u32 m0, s51, 77824
  s_add_u32 s46, s66, 410752
  buffer_load_dwordx4 v8, s[4:7], s46 offen lds
  ds_read_b64_tr_b16 v[100:101], v10 offset:16384
  ds_read_b64_tr_b16 v[102:103], v10 offset:17408
  ds_read_b64_tr_b16 v[104:105], v10 offset:20480
  ds_read_b64_tr_b16 v[106:107], v10 offset:21504
  ds_read_b64_tr_b16 v[108:109], v10 offset:24576
  ds_read_b64_tr_b16 v[110:111], v10 offset:25600
  ds_read_b64_tr_b16 v[112:113], v10 offset:28672
  ds_read_b64_tr_b16 v[114:115], v10 offset:29696
  ds_read_b64_tr_b16 v[116:117], v10 offset:32768
  ds_read_b64_tr_b16 v[118:119], v10 offset:33792
  s_waitcnt lgkmcnt(0)
  v_mfma_f32_16x16x32_bf16 v[140:143], v[100:103], v[52:55], v[140:143]
  v_mfma_f32_16x16x32_bf16 v[144:147], v[104:107], v[52:55], v[144:147]
  v_mfma_f32_16x16x32_bf16 v[148:151], v[108:111], v[52:55], v[148:151]
  v_mfma_f32_16x16x32_bf16 v[152:155], v[112:115], v[52:55], v[152:155]
  v_mfma_f32_16x16x32_bf16 v[156:159], v[116:119], v[52:55], v[156:159]
  s_waitcnt vmcnt(20)
  s_barrier
  s_add_u32 m0, s51, 81920
  s_add_u32 s46, s66, 450560
  buffer_load_dwordx4 v8, s[4:7], s46 offen lds
  s_add_u32 m0, s51, 86016
  s_add_u32 s46, s66, 450688
  buffer_load_dwordx4 v8, s[4:7], s46 offen lds
  s_add_u32 m0, s51, 90112
  s_add_u32 s46, s66, 450816
  buffer_load_dwordx4 v8, s[4:7], s46 offen lds
  s_add_u32 m0, s51, 94208
  s_add_u32 s46, s66, 450944
  buffer_load_dwordx4 v8, s[4:7], s46 offen lds
  s_add_u32 m0, s51, 98304
  s_add_u32 s46, s66, 451072
  buffer_load_dwordx4 v8, s[4:7], s46 offen lds
  ds_read_b64_tr_b16 v[120:121], v10 offset:36864
  ds_read_b64_tr_b16 v[122:123], v10 offset:37888
  ds_read_b64_tr_b16 v[124:125], v10 offset:40960
  ds_read_b64_tr_b16 v[126:127], v10 offset:41984
  ds_read_b64_tr_b16 v[128:129], v10 offset:45056
  ds_read_b64_tr_b16 v[130:131], v10 offset:46080
  ds_read_b64_tr_b16 v[132:133], v10 offset:49152
  ds_read_b64_tr_b16 v[134:135], v10 offset:50176
  ds_read_b64_tr_b16 v[136:137], v10 offset:53248
  ds_read_b64_tr_b16 v[138:139], v10 offset:54272
  s_waitcnt lgkmcnt(0)
  v_mfma_f32_16x16x32_bf16 v[160:163], v[120:123], v[52:55], v[160:163]
  v_mfma_f32_16x16x32_bf16 v[164:167], v[124:127], v[52:55], v[164:167]
  v_mfma_f32_16x16x32_bf16 v[168:171], v[128:131], v[52:55], v[168:171]
  v_mfma_f32_16x16x32_bf16 v[172:175], v[132:135], v[52:55], v[172:175]
  v_mfma_f32_16x16x32_bf16 v[176:179], v[136:139], v[52:55], v[176:179]
  s_waitcnt vmcnt(20)
  s_barrier
  s_add_u32 m0, s51, 102400
  s_add_u32 s46, s66, 451200
  buffer_load_dwordx4 v8, s[4:7], s46 offen lds
  s_add_u32 m0, s51, 106496
  s_add_u32 s46, s66, 451328
  buffer_load_dwordx4 v8, s[4:7], s46 offen lds
  s_add_u32 m0, s51, 110592
  s_add_u32 s46, s66, 451456
  buffer_load_dwordx4 v8, s[4:7], s46 offen lds
  s_add_u32 m0, s51, 114688
  s_add_u32 s46, s66, 451584
  buffer_load_dwordx4 v8, s[4:7], s46 offen lds
  s_add_u32 m0, s51, 118784
  s_add_u32 s46, s66, 451712
  buffer_load_dwordx4 v8, s[4:7], s46 offen lds
  ds_read_b64_tr_b16 v[100:101], v9 offset:0
  ds_read_b64_tr_b16 v[102:103], v9 offset:1024
  ds_read_b64_tr_b16 v[104:105], v9 offset:4096
  ds_read_b64_tr_b16 v[106:107], v9 offset:5120
  ds_read_b64_tr_b16 v[108:109], v9 offset:8192
  ds_read_b64_tr_b16 v[110:111], v9 offset:9216
  ds_read_b64_tr_b16 v[112:113], v9 offset:12288
  ds_read_b64_tr_b16 v[114:115], v9 offset:13312
  ds_read_b64_tr_b16 v[116:117], v9 offset:16384
  ds_read_b64_tr_b16 v[118:119], v9 offset:17408
  s_waitcnt lgkmcnt(0)
  v_mfma_f32_16x16x32_bf16 v[140:143], v[100:103], v[56:59], v[140:143]
  v_mfma_f32_16x16x32_bf16 v[144:147], v[104:107], v[56:59], v[144:147]
  v_mfma_f32_16x16x32_bf16 v[148:151], v[108:111], v[56:59], v[148:151]
  v_mfma_f32_16x16x32_bf16 v[152:155], v[112:115], v[56:59], v[152:155]
  v_mfma_f32_16x16x32_bf16 v[156:159], v[116:119], v[56:59], v[156:159]
  s_waitcnt vmcnt(20)
  s_barrier
  s_add_u32 m0, s51, 0
  s_add_u32 s46, s66, 491520
  buffer_load_dwordx4 v8, s[4:7], s46 offen lds
  s_add_u32 m0, s51, 4096
  s_add_u32 s46, s66, 491648
  buffer_load_dwordx4 v8, s[4:7], s46 offen lds
  s_add_u32 m0, s51, 8192
  s_add_u32 s46, s66, 491776
  buffer_load_dwordx4 v8, s[4:7], s46 offen lds
  s_add_u32 m0, s51, 12288
  s_add_u32 s46, s66, 491904
  buffer_load_dwordx4 v8, s[4:7], s46 offen lds
  s_add_u32 m0, s51, 16384
  s_add_u32 s46, s66, 492032
  buffer_load_dwordx4 v8, s[4:7], s46 offen lds
  ds_read_b64_tr_b16 v[120:121], v9 offset:20480
  ds_read_b64_tr_b16 v[122:123], v9 offset:21504
  ds_read_b64_tr_b16 v[124:125], v9 offset:24576
  ds_read_b64_tr_b16 v[126:127], v9 offset:25600
  ds_read_b64_tr_b16 v[128:129], v9 offset:28672
  ds_read_b64_tr_b16 v[130:131], v9 offset:29696
  ds_read_b64_tr_b16 v[132:133], v9 offset:32768
  ds_read_b64_tr_b16 v[134:135], v9 offset:33792
  ds_read_b64_tr_b16 v[136:137], v9 offset:36864
  ds_read_b64_tr_b16 v[138:139], v9 offset:37888
  s_waitcnt lgkmcnt(0)
  v_mfma_f32_16x16x32_bf16 v[160:163], v[120:123], v[56:59], v[160:163]
  v_mfma_f32_16x16x32_bf16 v[164:167], v[124:127], v[56:59], v[164:167]
  v_mfma_f32_16x16x32_bf16 v[168:171], v[128:131], v[56:59], v[168:171]
  v_mfma_f32_16x16x32_bf16 v[172:175], v[132:135], v[56:59], v[172:175]
  v_mfma_f32_16x16x32_bf16 v[176:179], v[136:139], v[56:59], v[176:179]
  s_waitcnt vmcnt(20)
  s_barrier
  s_add_u32 m0, s51, 20480
  s_add_u32 s46, s66, 492160
  buffer_load_dwordx4 v8, s[4:7], s46 offen lds
  s_add_u32 m0, s51, 24576
  s_add_u32 s46, s66, 492288
  buffer_load_dwordx4 v8, s[4:7], s46 offen lds
  s_add_u32 m0, s51, 28672
  s_add_u32 s46, s66, 492416
  buffer_load_dwordx4 v8, s[4:7], s46 offen lds
  s_add_u32 m0, s51, 32768
  s_add_u32 s46, s66, 492544
  buffer_load_dwordx4 v8, s[4:7], s46 offen lds
  s_add_u32 m0, s51, 36864
  s_add_u32 s46, s66, 492672
  buffer_load_dwordx4 v8, s[4:7], s46 offen lds
  ds_read_b64_tr_b16 v[100:101], v9 offset:40960
  ds_read_b64_tr_b16 v[102:103], v9 offset:41984
  ds_read_b64_tr_b16 v[104:105], v9 offset:45056
  ds_read_b64_tr_b16 v[106:107], v9 offset:46080
  ds_read_b64_tr_b16 v[108:109], v9 offset:49152
  ds_read_b64_tr_b16 v[110:111], v9 offset:50176
  ds_read_b64_tr_b16 v[112:113], v9 offset:53248
  ds_read_b64_tr_b16 v[114:115], v9 offset:54272
  ds_read_b64_tr_b16 v[116:117], v9 offset:57344
  ds_read_b64_tr_b16 v[118:119], v9 offset:58368
  s_waitcnt lgkmcnt(0)
  v_mfma_f32_16x16x32_bf16 v[140:143], v[100:103], v[60:63], v[140:143]
  v_mfma_f32_16x16x32_bf16 v[144:147], v[104:107], v[60:63], v[144:147]
  v_mfma_f32_16x16x32_bf16 v[148:151], v[108:111], v[60:63], v[148:151]
  v_mfma_f32_16x16x32_bf16 v[152:155], v[112:115], v[60:63], v[152:155]
  v_mfma_f32_16x16x32_bf16 v[156:159], v[116:119], v[60:63], v[156:159]
  s_waitcnt vmcnt(20)
  s_barrier
  s_add_u32 m0, s51, 40960
  s_add_u32 s46, s66, 532480
  buffer_load_dwordx4 v8, s[4:7], s46 offen lds
  s_add_u32 m0, s51, 45056
  s_add_u32 s46, s66, 532608
  buffer_load_dwordx4 v8, s[4:7], s46 offen lds
  s_add_u32 m0, s51, 49152
  s_add_u32 s46, s66, 532736
  buffer_load_dwordx4 v8, s[4:7], s46 offen lds
  s_add_u32 m0, s51, 53248
  s_add_u32 s46, s66, 532864
  buffer_load_dwordx4 v8, s[4:7], s46 offen lds
  s_add_u32 m0, s51, 57344
  s_add_u32 s46, s66, 532992
  buffer_load_dwordx4 v8, s[4:7], s46 offen lds
  ds_read_b64_tr_b16 v[120:121], v9 offset:61440
  ds_read_b64_tr_b16 v[122:123], v9 offset:62464
  ds_read_b64_tr_b16 v[124:125], v10 offset:0
  ds_read_b64_tr_b16 v[126:127], v10 offset:1024
  ds_read_b64_tr_b16 v[128:129], v10 offset:4096
  ds_read_b64_tr_b16 v[130:131], v10 offset:5120
  ds_read_b64_tr_b16 v[132:133], v10 offset:8192
  ds_read_b64_tr_b16 v[134:135], v10 offset:9216
  ds_read_b64_tr_b16 v[136:137], v10 offset:12288
  ds_read_b64_tr_b16 v[138:139], v10 offset:13312
  s_waitcnt lgkmcnt(0)
  v_mfma_f32_16x16x32_bf16 v[160:163], v[120:123], v[60:63], v[160:163]
  v_mfma_f32_16x16x32_bf16 v[164:167], v[124:127], v[60:63], v[164:167]
  v_mfma_f32_16x16x32_bf16 v[168:171], v[128:131], v[60:63], v[168:171]
  v_mfma_f32_16x16x32_bf16 v[172:175], v[132:135], v[60:63], v[172:175]
  v_mfma_f32_16x16x32_bf16 v[176:179], v[136:139], v[60:63], v[176:179]
  s_waitcnt vmcnt(20)
  s_barrier
  s_add_u32 m0, s51, 61440
  s_add_u32 s46, s66, 533120
  buffer_load_dwordx4 v8, s[4:7], s46 offen lds
  s_add_u32 m0, s51, 65536
  s_add_u32 s46, s66, 533248
  buffer_load_dwordx4 v8, s[4:7], s46 offen lds
  s_add_u32 m0, s51, 69632
  s_add_u32 s46, s66, 533376
  buffer_load_dwordx4 v8, s[4:7], s46 offen lds
  s_add_u32 m0, s51, 73728
  s_add_u32 s46, s66, 533504
  buffer_load_dwordx4 v8, s[4:7], s46 offen lds
  s_add_u32 m0, s51, 77824
  s_add_u32 s46, s66, 533632
  buffer_load_dwordx4 v8, s[4:7], s46 offen lds
  ds_read_b64_tr_b16 v[100:101], v10 offset:16384
  ds_read_b64_tr_b16 v[102:103], v10 offset:17408
  ds_read_b64_tr_b16 v[104:105], v10 offset:20480
  ds_read_b64_tr_b16 v[106:107], v10 offset:21504
  ds_read_b64_tr_b16 v[108:109], v10 offset:24576
  ds_read_b64_tr_b16 v[110:111], v10 offset:25600
  ds_read_b64_tr_b16 v[112:113], v10 offset:28672
  ds_read_b64_tr_b16 v[114:115], v10 offset:29696
  ds_read_b64_tr_b16 v[116:117], v10 offset:32768
  ds_read_b64_tr_b16 v[118:119], v10 offset:33792
  s_waitcnt lgkmcnt(0)
  v_mfma_f32_16x16x32_bf16 v[140:143], v[100:103], v[64:67], v[140:143]
  v_mfma_f32_16x16x32_bf16 v[144:147], v[104:107], v[64:67], v[144:147]
  v_mfma_f32_16x16x32_bf16 v[148:151], v[108:111], v[64:67], v[148:151]
  v_mfma_f32_16x16x32_bf16 v[152:155], v[112:115], v[64:67], v[152:155]
  v_mfma_f32_16x16x32_bf16 v[156:159], v[116:119], v[64:67], v[156:159]
  s_waitcnt vmcnt(20)
  s_barrier
  s_add_u32 m0, s51, 81920
  s_add_u32 s46, s66, 573440
  buffer_load_dwordx4 v8, s[4:7], s46 offen lds
  s_add_u32 m0, s51, 86016
  s_add_u32 s46, s66, 573568
  buffer_load_dwordx4 v8, s[4:7], s46 offen lds
  s_add_u32 m0, s51, 90112
  s_add_u32 s46, s66, 573696
  buffer_load_dwordx4 v8, s[4:7], s46 offen lds
  s_add_u32 m0, s51, 94208
  s_add_u32 s46, s66, 573824
  buffer_load_dwordx4 v8, s[4:7], s46 offen lds
  s_add_u32 m0, s51, 98304
  s_add_u32 s46, s66, 573952
  buffer_load_dwordx4 v8, s[4:7], s46 offen lds
  ds_read_b64_tr_b16 v[120:121], v10 offset:36864
  ds_read_b64_tr_b16 v[122:123], v10 offset:37888
  ds_read_b64_tr_b16 v[124:125], v10 offset:40960
  ds_read_b64_tr_b16 v[126:127], v10 offset:41984
  ds_read_b64_tr_b16 v[128:129], v10 offset:45056
  ds_read_b64_tr_b16 v[130:131], v10 offset:46080
  ds_read_b64_tr_b16 v[132:133], v10 offset:49152
  ds_read_b64_tr_b16 v[134:135], v10 offset:50176
  ds_read_b64_tr_b16 v[136:137], v10 offset:53248
  ds_read_b64_tr_b16 v[138:139], v10 offset:54272
  s_waitcnt lgkmcnt(0)
  v_mfma_f32_16x16x32_bf16 v[160:163], v[120:123], v[64:67], v[160:163]
  v_mfma_f32_16x16x32_bf16 v[164:167], v[124:127], v[64:67], v[164:167]
  v_mfma_f32_16x16x32_bf16 v[168:171], v[128:131], v[64:67], v[168:171]
  v_mfma_f32_16x16x32_bf16 v[172:175], v[132:135], v[64:67], v[172:175]
  v_mfma_f32_16x16x32_bf16 v[176:179], v[136:139], v[64:67], v[176:179]
  s_waitcnt vmcnt(20)
  s_barrier
  s_add_u32 m0, s51, 102400
  s_add_u32 s46, s66, 574080
  buffer_load_dwordx4 v8, s[4:7], s46 offen lds
  s_add_u32 m0, s51, 106496
  s_add_u32 s46, s66, 574208
  buffer_load_dwordx4 v8, s[4:7], s46 offen lds
  s_add_u32 m0, s51, 110592
  s_add_u32 s46, s66, 574336
  buffer_load_dwordx4 v8, s[4:7], s46 offen lds
  s_add_u32 m0, s51, 114688
  s_add_u32 s46, s66, 574464
  buffer_load_dwordx4 v8, s[4:7], s46 offen lds
  s_add_u32 m0, s51, 118784
  s_add_u32 s46, s66, 574592
  buffer_load_dwordx4 v8, s[4:7], s46 offen lds
  ds_read_b64_tr_b16 v[100:101], v9 offset:0
  ds_read_b64_tr_b16 v[102:103], v9 offset:1024
  ds_read_b64_tr_b16 v[104:105], v9 offset:4096
  ds_read_b64_tr_b16 v[106:107], v9 offset:5120
  ds_read_b64_tr_b16 v[108:109], v9 offset:8192
  ds_read_b64_tr_b16 v[110:111], v9 offset:9216
  ds_read_b64_tr_b16 v[112:113], v9 offset:12288
  ds_read_b64_tr_b16 v[114:115], v9 offset:13312
  ds_read_b64_tr_b16 v[116:117], v9 offset:16384
  ds_read_b64_tr_b16 v[118:119], v9 offset:17408
  s_waitcnt lgkmcnt(0)
  v_mfma_f32_16x16x32_bf16 v[140:143], v[100:103], v[68:71], v[140:143]
  v_mfma_f32_16x16x32_bf16 v[144:147], v[104:107], v[68:71], v[144:147]
  v_mfma_f32_16x16x32_bf16 v[148:151], v[108:111], v[68:71], v[148:151]
  v_mfma_f32_16x16x32_bf16 v[152:155], v[112:115], v[68:71], v[152:155]
  v_mfma_f32_16x16x32_bf16 v[156:159], v[116:119], v[68:71], v[156:159]
  s_waitcnt vmcnt(20)
  s_barrier
  s_add_u32 m0, s51, 0
  s_add_u32 s46, s66, 614400
  buffer_load_dwordx4 v8, s[4:7], s46 offen lds
  s_add_u32 m0, s51, 4096
  s_add_u32 s46, s66, 614528
  buffer_load_dwordx4 v8, s[4:7], s46 offen lds
  s_add_u32 m0, s51, 8192
  s_add_u32 s46, s66, 614656
  buffer_load_dwordx4 v8, s[4:7], s46 offen lds
  s_add_u32 m0, s51, 12288
  s_add_u32 s46, s66, 614784
  buffer_load_dwordx4 v8, s[4:7], s46 offen lds
  s_add_u32 m0, s51, 16384
  s_add_u32 s46, s66, 614912
  buffer_load_dwordx4 v8, s[4:7], s46 offen lds
  ds_read_b64_tr_b16 v[120:121], v9 offset:20480
  ds_read_b64_tr_b16 v[122:123], v9 offset:21504
  ds_read_b64_tr_b16 v[124:125], v9 offset:24576
  ds_read_b64_tr_b16 v[126:127], v9 offset:25600
  ds_read_b64_tr_b16 v[128:129], v9 offset:28672
  ds_read_b64_tr_b16 v[130:131], v9 offset:29696
  ds_read_b64_tr_b16 v[132:133], v9 offset:32768
  ds_read_b64_tr_b16 v[134:135], v9 offset:33792
  ds_read_b64_tr_b16 v[136:137], v9 offset:36864
  ds_read_b64_tr_b16 v[138:139], v9 offset:37888
  s_waitcnt lgkmcnt(0)
  v_mfma_f32_16x16x32_bf16 v[160:163], v[120:123], v[68:71], v[160:163]
  v_mfma_f32_16x16x32_bf16 v[164:167], v[124:127], v[68:71], v[164:167]
  v_mfma_f32_16x16x32_bf16 v[168:171], v[128:131], v[68:71], v[168:171]
  v_mfma_f32_16x16x32_bf16 v[172:175], v[132:135], v[68:71], v[172:175]
  v_mfma_f32_16x16x32_bf16 v[176:179], v[136:139], v[68:71], v[176:179]
  s_waitcnt vmcnt(20)
  s_barrier
  s_add_u32 m0, s51, 20480
  s_add_u32 s46, s66, 615040
  buffer_load_dwordx4 v8, s[4:7], s46 offen lds
  s_add_u32 m0, s51, 24576
  s_add_u32 s46, s66, 615168
  buffer_load_dwordx4 v8, s[4:7], s46 offen lds
  s_add_u32 m0, s51, 28672
  s_add_u32 s46, s66, 615296
  buffer_load_dwordx4 v8, s[4:7], s46 offen lds
  s_add_u32 m0, s51, 32768
  s_add_u32 s46, s66, 615424
  buffer_load_dwordx4 v8, s[4:7], s46 offen lds
  s_add_u32 m0, s51, 36864
  s_add_u32 s46, s66, 615552
  buffer_load_dwordx4 v8, s[4:7], s46 offen lds
  ds_read_b64_tr_b16 v[100:101], v9 offset:40960
  ds_read_b64_tr_b16 v[102:103], v9 offset:41984
  ds_read_b64_tr_b16 v[104:105], v9 offset:45056
  ds_read_b64_tr_b16 v[106:107], v9 offset:46080
  ds_read_b64_tr_b16 v[108:109], v9 offset:49152
  ds_read_b64_tr_b16 v[110:111], v9 offset:50176
  ds_read_b64_tr_b16 v[112:113], v9 offset:53248
  ds_read_b64_tr_b16 v[114:115], v9 offset:54272
  ds_read_b64_tr_b16 v[116:117], v9 offset:57344
  ds_read_b64_tr_b16 v[118:119], v9 offset:58368
  s_waitcnt lgkmcnt(0)
  v_mfma_f32_16x16x32_bf16 v[140:143], v[100:103], v[72:75], v[140:143]
  v_mfma_f32_16x16x32_bf16 v[144:147], v[104:107], v[72:75], v[144:147]
  v_mfma_f32_16x16x32_bf16 v[148:151], v[108:111], v[72:75], v[148:151]
  v_mfma_f32_16x16x32_bf16 v[152:155], v[112:115], v[72:75], v[152:155]
  v_mfma_f32_16x16x32_bf16 v[156:159], v[116:119], v[72:75], v[156:159]
  s_waitcnt vmcnt(20)
  s_barrier
  s_add_u32 m0, s51, 40960
  s_add_u32 s46, s66, 655360
  buffer_load_dwordx4 v8, s[4:7], s46 offen lds
  s_add_u32 m0, s51, 45056
  s_add_u32 s46, s66, 655488
  buffer_load_dwordx4 v8, s[4:7], s46 offen lds
  s_add_u32 m0, s51, 49152
  s_add_u32 s46, s66, 655616
  buffer_load_dwordx4 v8, s[4:7], s46 offen lds
  s_add_u32 m0, s51, 53248
  s_add_u32 s46, s66, 655744
  buffer_load_dwordx4 v8, s[4:7], s46 offen lds
  s_add_u32 m0, s51, 57344
  s_add_u32 s46, s66, 655872
  buffer_load_dwordx4 v8, s[4:7], s46 offen lds
  ds_read_b64_tr_b16 v[120:121], v9 offset:61440
  ds_read_b64_tr_b16 v[122:123], v9 offset:62464
  ds_read_b64_tr_b16 v[124:125], v10 offset:0
  ds_read_b64_tr_b16 v[126:127], v10 offset:1024
  ds_read_b64_tr_b16 v[128:129], v10 offset:4096
  ds_read_b64_tr_b16 v[130:131], v10 offset:5120
  ds_read_b64_tr_b16 v[132:133], v10 offset:8192
  ds_read_b64_tr_b16 v[134:135], v10 offset:9216
  ds_read_b64_tr_b16 v[136:137], v10 offset:12288
  ds_read_b64_tr_b16 v[138:139], v10 offset:13312
  s_waitcnt lgkmcnt(0)
  v_mfma_f32_16x16x32_bf16 v[160:163], v[120:123], v[72:75], v[160:163]
  v_mfma_f32_16x16x32_bf16 v[164:167], v[124:127], v[72:75], v[164:167]
  v_mfma_f32_16x16x32_bf16 v[168:171], v[128:131], v[72:75], v[168:171]
  v_mfma_f32_16x16x32_bf16 v[172:175], v[132:135], v[72:75], v[172:175]
  v_mfma_f32_16x16x32_bf16 v[176:179], v[136:139], v[72:75], v[176:179]
  s_waitcnt vmcnt(20)
  s_barrier
  s_add_u32 m0, s51, 61440
  s_add_u32 s46, s66, 656000
  buffer_load_dwordx4 v8, s[4:7], s46 offen lds
  s_add_u32 m0, s51, 65536
  s_add_u32 s46, s66, 656128
  buffer_load_dwordx4 v8, s[4:7], s46 offen lds
  s_add_u32 m0, s51, 69632
  s_add_u32 s46, s66, 656256
  buffer_load_dwordx4 v8, s[4:7], s46 offen lds
  s_add_u32 m0, s51, 73728
  s_add_u32 s46, s66, 656384
  buffer_load_dwordx4 v8, s[4:7], s46 offen lds
  s_add_u32 m0, s51, 77824
  s_add_u32 s46, s66, 656512
  buffer_load_dwordx4 v8, s[4:7], s46 offen lds
  ds_read_b64_tr_b16 v[100:101], v10 offset:16384
  ds_read_b64_tr_b16 v[102:103], v10 offset:17408
  ds_read_b64_tr_b16 v[104:105], v10 offset:20480
  ds_read_b64_tr_b16 v[106:107], v10 offset:21504
  ds_read_b64_tr_b16 v[108:109], v10 offset:24576
  ds_read_b64_tr_b16 v[110:111], v10 offset:25600
  ds_read_b64_tr_b16 v[112:113], v10 offset:28672
  ds_read_b64_tr_b16 v[114:115], v10 offset:29696
  ds_read_b64_tr_b16 v[116:117], v10 offset:32768
  ds_read_b64_tr_b16 v[118:119], v10 offset:33792
  s_waitcnt lgkmcnt(0)
  v_mfma_f32_16x16x32_bf16 v[140:143], v[100:103], v[76:79], v[140:143]
  v_mfma_f32_16x16x32_bf16 v[144:147], v[104:107], v[76:79], v[144:147]
  v_mfma_f32_16x16x32_bf16 v[148:151], v[108:111], v[76:79], v[148:151]
  v_mfma_f32_16x16x32_bf16 v[152:155], v[112:115], v[76:79], v[152:155]
  v_mfma_f32_16x16x32_bf16 v[156:159], v[116:119], v[76:79], v[156:159]
  s_waitcnt vmcnt(20)
  s_barrier
  s_add_u32 m0, s51, 81920
  s_add_u32 s46, s66, 696320
  buffer_load_dwordx4 v8, s[4:7], s46 offen lds
  s_add_u32 m0, s51, 86016
  s_add_u32 s46, s66, 696448
  buffer_load_dwordx4 v8, s[4:7], s46 offen lds
  s_add_u32 m0, s51, 90112
  s_add_u32 s46, s66, 696576
  buffer_load_dwordx4 v8, s[4:7], s46 offen lds
  s_add_u32 m0, s51, 94208
  s_add_u32 s46, s66, 696704
  buffer_load_dwordx4 v8, s[4:7], s46 offen lds
  s_add_u32 m0, s51, 98304
  s_add_u32 s46, s66, 696832
  buffer_load_dwordx4 v8, s[4:7], s46 offen lds
  ds_read_b64_tr_b16 v[120:121], v10 offset:36864
  ds_read_b64_tr_b16 v[122:123], v10 offset:37888
  ds_read_b64_tr_b16 v[124:125], v10 offset:40960
  ds_read_b64_tr_b16 v[126:127], v10 offset:41984
  ds_read_b64_tr_b16 v[128:129], v10 offset:45056
  ds_read_b64_tr_b16 v[130:131], v10 offset:46080
  ds_read_b64_tr_b16 v[132:133], v10 offset:49152
  ds_read_b64_tr_b16 v[134:135], v10 offset:50176
  ds_read_b64_tr_b16 v[136:137], v10 offset:53248
  ds_read_b64_tr_b16 v[138:139], v10 offset:54272
  s_waitcnt lgkmcnt(0)
  v_mfma_f32_16x16x32_bf16 v[160:163], v[120:123], v[76:79], v[160:163]
  v_mfma_f32_16x16x32_bf16 v[164:167], v[124:127], v[76:79], v[164:167]
  v_mfma_f32_16x16x32_bf16 v[168:171], v[128:131], v[76:79], v[168:171]
  v_mfma_f32_16x16x32_bf16 v[172:175], v[132:135], v[76:79], v[172:175]
  v_mfma_f32_16x16x32_bf16 v[176:179], v[136:139], v[76:79], v[176:179]
  s_waitcnt vmcnt(20)
  s_barrier
  s_add_u32 m0, s51, 102400
  s_add_u32 s46, s66, 696960
  buffer_load_dwordx4 v8, s[4:7], s46 offen lds
  s_add_u32 m0, s51, 106496
  s_add_u32 s46, s66, 697088
  buffer_load_dwordx4 v8, s[4:7], s46 offen lds
  s_add_u32 m0, s51, 110592
  s_add_u32 s46, s66, 697216
  buffer_load_dwordx4 v8, s[4:7], s46 offen lds
  s_add_u32 m0, s51, 114688
  s_add_u32 s46, s66, 697344
  buffer_load_dwordx4 v8, s[4:7], s46 offen lds
  s_add_u32 m0, s51, 118784
  s_add_u32 s46, s66, 697472
  buffer_load_dwordx4 v8, s[4:7], s46 offen lds
  ds_read_b64_tr_b16 v[100:101], v9 offset:0
  ds_read_b64_tr_b16 v[102:103], v9 offset:1024
  ds_read_b64_tr_b16 v[104:105], v9 offset:4096
  ds_read_b64_tr_b16 v[106:107], v9 offset:5120
  ds_read_b64_tr_b16 v[108:109], v9 offset:8192
  ds_read_b64_tr_b16 v[110:111], v9 offset:9216
  ds_read_b64_tr_b16 v[112:113], v9 offset:12288
  ds_read_b64_tr_b16 v[114:115], v9 offset:13312
  ds_read_b64_tr_b16 v[116:117], v9 offset:16384
  ds_read_b64_tr_b16 v[118:119], v9 offset:17408
  s_waitcnt lgkmcnt(0)
  v_mfma_f32_16x16x32_bf16 v[140:143], v[100:103], v[80:83], v[140:143]
  v_mfma_f32_16x16x32_bf16 v[144:147], v[104:107], v[80:83], v[144:147]
  v_mfma_f32_16x16x32_bf16 v[148:151], v[108:111], v[80:83], v[148:151]
  v_mfma_f32_16x16x32_bf16 v[152:155], v[112:115], v[80:83], v[152:155]
  v_mfma_f32_16x16x32_bf16 v[156:159], v[116:119], v[80:83], v[156:159]
  s_waitcnt vmcnt(20)
  s_barrier
  s_add_u32 m0, s51, 0
  s_add_u32 s46, s66, 737280
  buffer_load_dwordx4 v8, s[4:7], s46 offen lds
  s_add_u32 m0, s51, 4096
  s_add_u32 s46, s66, 737408
  buffer_load_dwordx4 v8, s[4:7], s46 offen lds
  s_add_u32 m0, s51, 8192
  s_add_u32 s46, s66, 737536
  buffer_load_dwordx4 v8, s[4:7], s46 offen lds
  s_add_u32 m0, s51, 12288
  s_add_u32 s46, s66, 737664
  buffer_load_dwordx4 v8, s[4:7], s46 offen lds
  s_add_u32 m0, s51, 16384
  s_add_u32 s46, s66, 737792
  buffer_load_dwordx4 v8, s[4:7], s46 offen lds
  ds_read_b64_tr_b16 v[120:121], v9 offset:20480
  ds_read_b64_tr_b16 v[122:123], v9 offset:21504
  ds_read_b64_tr_b16 v[124:125], v9 offset:24576
  ds_read_b64_tr_b16 v[126:127], v9 offset:25600
  ds_read_b64_tr_b16 v[128:129], v9 offset:28672
  ds_read_b64_tr_b16 v[130:131], v9 offset:29696
  ds_read_b64_tr_b16 v[132:133], v9 offset:32768
  ds_read_b64_tr_b16 v[134:135], v9 offset:33792
  ds_read_b64_tr_b16 v[136:137], v9 offset:36864
  ds_read_b64_tr_b16 v[138:139], v9 offset:37888
  s_waitcnt lgkmcnt(0)
  v_mfma_f32_16x16x32_bf16 v[160:163], v[120:123], v[80:83], v[160:163]
  v_mfma_f32_16x16x32_bf16 v[164:167], v[124:127], v[80:83], v[164:167]
  v_mfma_f32_16x16x32_bf16 v[168:171], v[128:131], v[80:83], v[168:171]
  v_mfma_f32_16x16x32_bf16 v[172:175], v[132:135], v[80:83], v[172:175]
  v_mfma_f32_16x16x32_bf16 v[176:179], v[136:139], v[80:83], v[176:179]
  s_waitcnt vmcnt(20)
  s_barrier
  s_add_u32 m0, s51, 20480
  s_add_u32 s46, s66, 737920
  buffer_load_dwordx4 v8, s[4:7], s46 offen lds
  s_add_u32 m0, s51, 24576
  s_add_u32 s46, s66, 738048
  buffer_load_dwordx4 v8, s[4:7], s46 offen lds
  s_add_u32 m0, s51, 28672
  s_add_u32 s46, s66, 738176
  buffer_load_dwordx4 v8, s[4:7], s46 offen lds
  s_add_u32 m0, s51, 32768
  s_add_u32 s46, s66, 738304
  buffer_load_dwordx4 v8, s[4:7], s46 offen lds
  s_add_u32 m0, s51, 36864
  s_add_u32 s46, s66, 738432
  buffer_load_dwordx4 v8, s[4:7], s46 offen lds
  ds_read_b64_tr_b16 v[100:101], v9 offset:40960
  ds_read_b64_tr_b16 v[102:103], v9 offset:41984
  ds_read_b64_tr_b16 v[104:105], v9 offset:45056
  ds_read_b64_tr_b16 v[106:107], v9 offset:46080
  ds_read_b64_tr_b16 v[108:109], v9 offset:49152
  ds_read_b64_tr_b16 v[110:111], v9 offset:50176
  ds_read_b64_tr_b16 v[112:113], v9 offset:53248
  ds_read_b64_tr_b16 v[114:115], v9 offset:54272
  ds_read_b64_tr_b16 v[116:117], v9 offset:57344
  ds_read_b64_tr_b16 v[118:119], v9 offset:58368
  s_waitcnt lgkmcnt(0)
  v_mfma_f32_16x16x32_bf16 v[140:143], v[100:103], v[84:87], v[140:143]
  v_mfma_f32_16x16x32_bf16 v[144:147], v[104:107], v[84:87], v[144:147]
  v_mfma_f32_16x16x32_bf16 v[148:151], v[108:111], v[84:87], v[148:151]
  v_mfma_f32_16x16x32_bf16 v[152:155], v[112:115], v[84:87], v[152:155]
  v_mfma_f32_16x16x32_bf16 v[156:159], v[116:119], v[84:87], v[156:159]
  s_waitcnt vmcnt(20)
  s_barrier
  s_add_u32 m0, s51, 40960
  s_add_u32 s46, s66, 778240
  buffer_load_dwordx4 v8, s[4:7], s46 offen lds
  s_add_u32 m0, s51, 45056
  s_add_u32 s46, s66, 778368
  buffer_load_dwordx4 v8, s[4:7], s46 offen lds
  s_add_u32 m0, s51, 49152
  s_add_u32 s46, s66, 778496
  buffer_load_dwordx4 v8, s[4:7], s46 offen lds
  s_add_u32 m0, s51, 53248
  s_add_u32 s46, s66, 778624
  buffer_load_dwordx4 v8, s[4:7], s46 offen lds
  s_add_u32 m0, s51, 57344
  s_add_u32 s46, s66, 778752
  buffer_load_dwordx4 v8, s[4:7], s46 offen lds
  ds_read_b64_tr_b16 v[120:121], v9 offset:61440
  ds_read_b64_tr_b16 v[122:123], v9 offset:62464
  ds_read_b64_tr_b16 v[124:125], v10 offset:0
  ds_read_b64_tr_b16 v[126:127], v10 offset:1024
  ds_read_b64_tr_b16 v[128:129], v10 offset:4096
  ds_read_b64_tr_b16 v[130:131], v10 offset:5120
  ds_read_b64_tr_b16 v[132:133], v10 offset:8192
  ds_read_b64_tr_b16 v[134:135], v10 offset:9216
  ds_read_b64_tr_b16 v[136:137], v10 offset:12288
  ds_read_b64_tr_b16 v[138:139], v10 offset:13312
  s_waitcnt lgkmcnt(0)
  v_mfma_f32_16x16x32_bf16 v[160:163], v[120:123], v[84:87], v[160:163]
  v_mfma_f32_16x16x32_bf16 v[164:167], v[124:127], v[84:87], v[164:167]
  v_mfma_f32_16x16x32_bf16 v[168:171], v[128:131], v[84:87], v[168:171]
  v_mfma_f32_16x16x32_bf16 v[172:175], v[132:135], v[84:87], v[172:175]
  v_mfma_f32_16x16x32_bf16 v[176:179], v[136:139], v[84:87], v[176:179]
  s_waitcnt vmcnt(20)
  s_barrier
  s_add_u32 m0, s51, 61440
  s_add_u32 s46, s66, 778880
  buffer_load_dwordx4 v8, s[4:7], s46 offen lds
  s_add_u32 m0, s51, 65536
  s_add_u32 s46, s66, 779008
  buffer_load_dwordx4 v8, s[4:7], s46 offen lds
  s_add_u32 m0, s51, 69632
  s_add_u32 s46, s66, 779136
  buffer_load_dwordx4 v8, s[4:7], s46 offen lds
  s_add_u32 m0, s51, 73728
  s_add_u32 s46, s66, 779264
  buffer_load_dwordx4 v8, s[4:7], s46 offen lds
  s_add_u32 m0, s51, 77824
  s_add_u32 s46, s66, 779392
  buffer_load_dwordx4 v8, s[4:7], s46 offen lds
  ds_read_b64_tr_b16 v[100:101], v10 offset:16384
  ds_read_b64_tr_b16 v[102:103], v10 offset:17408
  ds_read_b64_tr_b16 v[104:105], v10 offset:20480
  ds_read_b64_tr_b16 v[106:107], v10 offset:21504
  ds_read_b64_tr_b16 v[108:109], v10 offset:24576
  ds_read_b64_tr_b16 v[110:111], v10 offset:25600
  ds_read_b64_tr_b16 v[112:113], v10 offset:28672
  ds_read_b64_tr_b16 v[114:115], v10 offset:29696
  ds_read_b64_tr_b16 v[116:117], v10 offset:32768
  ds_read_b64_tr_b16 v[118:119], v10 offset:33792
  s_waitcnt lgkmcnt(0)
  v_mfma_f32_16x16x32_bf16 v[140:143], v[100:103], v[88:91], v[140:143]
  v_mfma_f32_16x16x32_bf16 v[144:147], v[104:107], v[88:91], v[144:147]
  v_mfma_f32_16x16x32_bf16 v[148:151], v[108:111], v[88:91], v[148:151]
  v_mfma_f32_16x16x32_bf16 v[152:155], v[112:115], v[88:91], v[152:155]
  v_mfma_f32_16x16x32_bf16 v[156:159], v[116:119], v[88:91], v[156:159]
  s_waitcnt vmcnt(20)
  s_barrier
  ds_read_b64_tr_b16 v[120:121], v10 offset:36864
  ds_read_b64_tr_b16 v[122:123], v10 offset:37888
  ds_read_b64_tr_b16 v[124:125], v10 offset:40960
  ds_read_b64_tr_b16 v[126:127], v10 offset:41984
  ds_read_b64_tr_b16 v[128:129], v10 offset:45056
  ds_read_b64_tr_b16 v[130:131], v10 offset:46080
  ds_read_b64_tr_b16 v[132:133], v10 offset:49152
  ds_read_b64_tr_b16 v[134:135], v10 offset:50176
  ds_read_b64_tr_b16 v[136:137], v10 offset:53248
  ds_read_b64_tr_b16 v[138:139], v10 offset:54272
  s_waitcnt lgkmcnt(0)
  v_mfma_f32_16x16x32_bf16 v[160:163], v[120:123], v[88:91], v[160:163]
  v_mfma_f32_16x16x32_bf16 v[164:167], v[124:127], v[88:91], v[164:167]
  v_mfma_f32_16x16x32_bf16 v[168:171], v[128:131], v[88:91], v[168:171]
  v_mfma_f32_16x16x32_bf16 v[172:175], v[132:135], v[88:91], v[172:175]
  v_mfma_f32_16x16x32_bf16 v[176:179], v[136:139], v[88:91], v[176:179]
  s_waitcnt vmcnt(15)
  s_barrier
  ds_read_b64_tr_b16 v[100:101], v9 offset:0
  ds_read_b64_tr_b16 v[102:103], v9 offset:1024
  ds_read_b64_tr_b16 v[104:105], v9 offset:4096
  ds_read_b64_tr_b16 v[106:107], v9 offset:5120
  ds_read_b64_tr_b16 v[108:109], v9 offset:8192
  ds_read_b64_tr_b16 v[110:111], v9 offset:9216
  ds_read_b64_tr_b16 v[112:113], v9 offset:12288
  ds_read_b64_tr_b16 v[114:115], v9 offset:13312
  ds_read_b64_tr_b16 v[116:117], v9 offset:16384
  ds_read_b64_tr_b16 v[118:119], v9 offset:17408
  s_waitcnt lgkmcnt(0)
  v_mfma_f32_16x16x32_bf16 v[140:143], v[100:103], v[92:95], v[140:143]
  v_mfma_f32_16x16x32_bf16 v[144:147], v[104:107], v[92:95], v[144:147]
  v_mfma_f32_16x16x32_bf16 v[148:151], v[108:111], v[92:95], v[148:151]
  v_mfma_f32_16x16x32_bf16 v[152:155], v[112:115], v[92:95], v[152:155]
  v_mfma_f32_16x16x32_bf16 v[156:159], v[116:119], v[92:95], v[156:159]
  s_waitcnt vmcnt(10)
  s_barrier
  ds_read_b64_tr_b16 v[120:121], v9 offset:20480
  ds_read_b64_tr_b16 v[122:123], v9 offset:21504
  ds_read_b64_tr_b16 v[124:125], v9 offset:24576
  ds_read_b64_tr_b16 v[126:127], v9 offset:25600
  ds_read_b64_tr_b16 v[128:129], v9 offset:28672
  ds_read_b64_tr_b16 v[130:131], v9 offset:29696
  ds_read_b64_tr_b16 v[132:133], v9 offset:32768
  ds_read_b64_tr_b16 v[134:135], v9 offset:33792
  ds_read_b64_tr_b16 v[136:137], v9 offset:36864
  ds_read_b64_tr_b16 v[138:139], v9 offset:37888
  s_waitcnt lgkmcnt(0)
  v_mfma_f32_16x16x32_bf16 v[160:163], v[120:123], v[92:95], v[160:163]
  v_mfma_f32_16x16x32_bf16 v[164:167], v[124:127], v[92:95], v[164:167]
  v_mfma_f32_16x16x32_bf16 v[168:171], v[128:131], v[92:95], v[168:171]
  v_mfma_f32_16x16x32_bf16 v[172:175], v[132:135], v[92:95], v[172:175]
  v_mfma_f32_16x16x32_bf16 v[176:179], v[136:139], v[92:95], v[176:179]
  s_waitcnt vmcnt(5)
  s_barrier
  ds_read_b64_tr_b16 v[100:101], v9 offset:40960
  ds_read_b64_tr_b16 v[102:103], v9 offset:41984
  ds_read_b64_tr_b16 v[104:105], v9 offset:45056
  ds_read_b64_tr_b16 v[106:107], v9 offset:46080
  ds_read_b64_tr_b16 v[108:109], v9 offset:49152
  ds_read_b64_tr_b16 v[110:111], v9 offset:50176
  ds_read_b64_tr_b16 v[112:113], v9 offset:53248
  ds_read_b64_tr_b16 v[114:115], v9 offset:54272
  ds_read_b64_tr_b16 v[116:117], v9 offset:57344
  ds_read_b64_tr_b16 v[118:119], v9 offset:58368
  s_waitcnt lgkmcnt(0)
  v_mfma_f32_16x16x32_bf16 v[140:143], v[100:103], v[96:99], v[140:143]
  v_mfma_f32_16x16x32_bf16 v[144:147], v[104:107], v[96:99], v[144:147]
  v_mfma_f32_16x16x32_bf16 v[148:151], v[108:111], v[96:99], v[148:151]
  v_mfma_f32_16x16x32_bf16 v[152:155], v[112:115], v[96:99], v[152:155]
  v_mfma_f32_16x16x32_bf16 v[156:159], v[116:119], v[96:99], v[156:159]
  s_waitcnt vmcnt(0)
  s_barrier
  ds_read_b64_tr_b16 v[120:121], v9 offset:61440
  ds_read_b64_tr_b16 v[122:123], v9 offset:62464
  ds_read_b64_tr_b16 v[124:125], v10 offset:0
  ds_read_b64_tr_b16 v[126:127], v10 offset:1024
  ds_read_b64_tr_b16 v[128:129], v10 offset:4096
  ds_read_b64_tr_b16 v[130:131], v10 offset:5120
  ds_read_b64_tr_b16 v[132:133], v10 offset:8192
  ds_read_b64_tr_b16 v[134:135], v10 offset:9216
  ds_read_b64_tr_b16 v[136:137], v10 offset:12288
  ds_read_b64_tr_b16 v[138:139], v10 offset:13312
  s_waitcnt lgkmcnt(0)
  v_mfma_f32_16x16x32_bf16 v[160:163], v[120:123], v[96:99], v[160:163]
  v_mfma_f32_16x16x32_bf16 v[164:167], v[124:127], v[96:99], v[164:167]
  v_mfma_f32_16x16x32_bf16 v[168:171], v[128:131], v[96:99], v[168:171]
  v_mfma_f32_16x16x32_bf16 v[172:175], v[132:135], v[96:99], v[172:175]
  v_mfma_f32_16x16x32_bf16 v[176:179], v[136:139], v[96:99], v[176:179]
  s_barrier
  v_cvt_pk_bf16_f32 v140, v140, v141
  v_cvt_pk_bf16_f32 v141, v142, v143
  buffer_store_dwordx2 v[140:141], v12, s[12:15], 0 offen offset:0
  v_cvt_pk_bf16_f32 v144, v144, v145
  v_cvt_pk_bf16_f32 v145, v146, v147
  buffer_store_dwordx2 v[144:145], v12, s[12:15], 0 offen offset:128
  v_cvt_pk_bf16_f32 v148, v148, v149
  v_cvt_pk_bf16_f32 v149, v150, v151
  buffer_store_dwordx2 v[148:149], v12, s[12:15], 0 offen offset:256
  v_cvt_pk_bf16_f32 v152, v152, v153
  v_cvt_pk_bf16_f32 v153, v154, v155
  buffer_store_dwordx2 v[152:153], v12, s[12:15], 0 offen offset:384
  v_cvt_pk_bf16_f32 v156, v156, v157
  v_cvt_pk_bf16_f32 v157, v158, v159
  buffer_store_dwordx2 v[156:157], v12, s[12:15], 0 offen offset:512
  v_cvt_pk_bf16_f32 v160, v160, v161
  v_cvt_pk_bf16_f32 v161, v162, v163
  buffer_store_dwordx2 v[160:161], v12, s[12:15], 0 offen offset:640
  v_cvt_pk_bf16_f32 v164, v164, v165
  v_cvt_pk_bf16_f32 v165, v166, v167
  buffer_store_dwordx2 v[164:165], v12, s[12:15], 0 offen offset:768
  v_cvt_pk_bf16_f32 v168, v168, v169
  v_cvt_pk_bf16_f32 v169, v170, v171
  buffer_store_dwordx2 v[168:169], v12, s[12:15], 0 offen offset:896
  v_cvt_pk_bf16_f32 v172, v172, v173
  v_cvt_pk_bf16_f32 v173, v174, v175
  buffer_store_dwordx2 v[172:173], v12, s[12:15], 0 offen offset:1024
  v_cvt_pk_bf16_f32 v176, v176, v177
  v_cvt_pk_bf16_f32 v177, v178, v179
  buffer_store_dwordx2 v[176:177], v12, s[12:15], 0 offen offset:1152
  s_endpgm
L_recur:
  s_or_b32 s67, s44, s42
  s_cmp_lt_u32 s44, 8
  s_cbranch_scc1 L_score
  s_cmp_lt_u32 s44, 16
  s_cbranch_scc1 L_value
  s_cmp_lt_u32 s44, 26
  s_cbranch_scc1 L_owner
  s_cmp_lt_u32 s44, 30
  s_cbranch_scc1 L_xowner
  s_cmp_lt_u32 s44, 31
  s_cbranch_scc1 L_end
  s_cmp_lg_u32 s42, 0
  s_cbranch_scc1 L_end
  s_cmp_ge_u32 s43, 2
  s_cbranch_scc1 L_end
  s_mul_i32 s62, s43, 1114112
  s_add_u32 s62, s62, 1966080
  v_mov_b32 v1, 0
  s_mov_b64 exec, 1
  buffer_load_dword v2, v1, s[8:11], s62 offen offset:3968 sc1
  s_mov_b32 s63, -1
  s_mov_b32 s64, -1
  s_add_u32 s65, s62, 8192
  s_waitcnt vmcnt(0)
  s_memtime s[72:73]
  s_waitcnt lgkmcnt(0)
  buffer_load_dword v2, v1, s[8:11], s62 offen offset:0 sc1
  s_waitcnt vmcnt(0)
  s_memtime s[74:75]
  s_waitcnt lgkmcnt(0)
  s_sub_u32 s46, s74, s72
  s_min_u32 s63, s63, s46
  s_memtime s[72:73]
  s_waitcnt lgkmcnt(0)
  buffer_load_dword v2, v1, s[8:11], s65 offen offset:0 sc1
  s_waitcnt vmcnt(0)
  s_memtime s[74:75]
  s_waitcnt lgkmcnt(0)
  s_sub_u32 s46, s74, s72
  s_min_u32 s64, s64, s46
  s_memtime s[72:73]
  s_waitcnt lgkmcnt(0)
  buffer_load_dword v2, v1, s[8:11], s62 offen offset:768 sc1
  s_waitcnt vmcnt(0)
  s_memtime s[74:75]
  s_waitcnt lgkmcnt(0)
  s_sub_u32 s46, s74, s72
  s_min_u32 s63, s63, s46
  s_memtime s[72:73]
  s_waitcnt lgkmcnt(0)
  buffer_load_dword v2, v1, s[8:11], s65 offen offset:768 sc1
  s_waitcnt vmcnt(0)
  s_memtime s[74:75]
  s_waitcnt lgkmcnt(0)
  s_sub_u32 s46, s74, s72
  s_min_u32 s64, s64, s46
  s_memtime s[72:73]
  s_waitcnt lgkmcnt(0)
  buffer_load_dword v2, v1, s[8:11], s62 offen offset:1536 sc1
  s_waitcnt vmcnt(0)
  s_memtime s[74:75]
  s_waitcnt lgkmcnt(0)
  s_sub_u32 s46, s74, s72
  s_min_u32 s63, s63, s46
  s_memtime s[72:73]
  s_waitcnt lgkmcnt(0)
  buffer_load_dword v2, v1, s[8:11], s65 offen offset:1536 sc1
  s_waitcnt vmcnt(0)
  s_memtime s[74:75]
  s_waitcnt lgkmcnt(0)
  s_sub_u32 s46, s74, s72
  s_min_u32 s64, s64, s46
  s_memtime s[72:73]
  s_waitcnt lgkmcnt(0)
  buffer_load_dword v2, v1, s[8:11], s62 offen offset:2304 sc1
  s_waitcnt vmcnt(0)
  s_memtime s[74:75]
  s_waitcnt lgkmcnt(0)
  s_sub_u32 s46, s74, s72
  s_min_u32 s63, s63, s46
  s_memtime s[72:73]
  s_waitcnt lgkmcnt(0)
  buffer_load_dword v2, v1, s[8:11], s65 offen offset:2304 sc1
  s_waitcnt vmcnt(0)
  s_memtime s[74:75]
  s_waitcnt lgkmcnt(0)
  s_sub_u32 s46, s74, s72
  s_min_u32 s64, s64, s46
  s_cmp_lt_u32 s64, s63
  s_cselect_b32 s46, 8193, 1
  s_lshl_b32 s47, s43, 7
  s_add_u32 s47, s47, 3014656
  v_mov_b32 v1, s47
  v_mov_b32 v2, s46
  buffer_store_dword v2, v1, s[8:11], 0 offen sc1
  s_waitcnt vmcnt(0)
  s_endpgm
L_score:
  s_mov_b32 s4, s26
  s_mov_b32 s5, s27
  s_mov_b32 s6, 7864320
  s_mov_b32 s7, 0x20000
  s_mov_b32 s12, s28
  s_mov_b32 s13, s29
  s_mov_b32 s14, 7864320
  s_mov_b32 s15, 0x20000
  v_lshrrev_b32 v136, 3, v0
  v_lshrrev_b32 v137, 2, v136
  v_lshlrev_b32 v137, 3, v137
  v_and_b32 v64, 3, v136
  v_add_u32 v64, v64, v137
  s_and_b32 s46, s42, 1
  s_lshl_b32 s46, s46, 2
  s_lshr_b32 s47, s42, 1
  s_lshl_b32 s47, s47, 4
  s_add_u32 s46, s46, s47
  v_add_u32 v64, s46, v64
  v_mul_u32_u24 v64, 12288, v64
  v_lshrrev_b32 v136, 1, v136
  v_bfe_u32 v137, v0, 1, 2
  v_xor_b32 v136, v136, v137
  v_lshlrev_b32 v136, 5, v136
  v_and_b32 v137, 1, v0
  v_lshlrev_b32 v137, 4, v137
  v_add3_u32 v64, v64, v136, v137
  v_lshrrev_b32 v136, 5, v0
  v_lshlrev_b32 v65, 11, v136
  v_bfe_u32 v136, v0, 2, 3
  v_lshl_add_u32 v65, v136, 7, v65
  v_lshrrev_b32 v136, 1, v136
  v_xor_b32 v136, s42, v136
  v_lshl_add_u32 v65, v136, 5, v65
  v_and_b32 v136, 3, v0
  v_lshl_add_u32 v65, v136, 3, v65
  v_add_u32 v66, 0x10000, v65
  v_add_u32 v67, 0x20000, v65
  v_lshlrev_b32 v1, 4, v0
  v_add_u32 v2, s51, v1
  v_add_u32 v3, 0x10000, v2
  s_mul_i32 s62, s45, 384
  s_add_u32 m0, s51, 73728
  s_add_u32 s46, s62, 0
  buffer_load_dwordx4 v64, s[4:7], s46 offen lds
  s_add_u32 m0, s51, 77824
  s_add_u32 s46, s62, 393216
  buffer_load_dwordx4 v64, s[4:7], s46 offen lds
  s_add_u32 m0, s51, 81920
  s_add_u32 s46, s62, 128
  buffer_load_dwordx4 v64, s[4:7], s46 offen lds
  s_add_u32 m0, s51, 86016
  s_add_u32 s46, s62, 393344
  buffer_load_dwordx4 v64, s[4:7], s46 offen lds
  s_add_u32 m0, s51, 90112
  s_add_u32 s46, s62, 256
  buffer_load_dwordx4 v64, s[4:7], s46 offen lds
  s_add_u32 m0, s51, 94208
  s_add_u32 s46, s62, 393472
  buffer_load_dwordx4 v64, s[4:7], s46 offen lds
  s_add_u32 m0, s51, 98304
  s_add_u32 s46, s62, 0
  buffer_load_dwordx4 v64, s[12:15], s46 offen lds
  s_add_u32 m0, s51, 102400
  s_add_u32 s46, s62, 393216
  buffer_load_dwordx4 v64, s[12:15], s46 offen lds
  s_add_u32 m0, s51, 106496
  s_add_u32 s46, s62, 128
  buffer_load_dwordx4 v64, s[12:15], s46 offen lds
  s_add_u32 m0, s51, 110592
  s_add_u32 s46, s62, 393344
  buffer_load_dwordx4 v64, s[12:15], s46 offen lds
  s_add_u32 m0, s51, 114688
  s_add_u32 s46, s62, 256
  buffer_load_dwordx4 v64, s[12:15], s46 offen lds
  s_add_u32 m0, s51, 118784
  s_add_u32 s46, s62, 393472
  buffer_load_dwordx4 v64, s[12:15], s46 offen lds
  s_add_u32 m0, s51, 122880
  s_add_u32 s46, s62, 786432
  buffer_load_dwordx4 v64, s[4:7], s46 offen lds
  s_add_u32 m0, s51, 126976
  s_add_u32 s46, s62, 1179648
  buffer_load_dwordx4 v64, s[4:7], s46 offen lds
  s_add_u32 m0, s51, 131072
  s_add_u32 s46, s62, 786560
  buffer_load_dwordx4 v64, s[4:7], s46 offen lds
  s_add_u32 m0, s51, 135168
  s_add_u32 s46, s62, 1179776
  buffer_load_dwordx4 v64, s[4:7], s46 offen lds
  s_add_u32 m0, s51, 139264
  s_add_u32 s46, s62, 786688
  buffer_load_dwordx4 v64, s[4:7], s46 offen lds
  s_add_u32 m0, s51, 143360
  s_add_u32 s46, s62, 1179904
  buffer_load_dwordx4 v64, s[4:7], s46 offen lds
  s_add_u32 m0, s51, 0
  s_add_u32 s46, s62, 786432
  buffer_load_dwordx4 v64, s[12:15], s46 offen lds
  s_add_u32 m0, s51, 4096
  s_add_u32 s46, s62, 1179648
  buffer_load_dwordx4 v64, s[12:15], s46 offen lds
  s_add_u32 m0, s51, 8192
  s_add_u32 s46, s62, 786560
  buffer_load_dwordx4 v64, s[12:15], s46 offen lds
  s_add_u32 m0, s51, 12288
  s_add_u32 s46, s62, 1179776
  buffer_load_dwordx4 v64, s[12:15], s46 offen lds
  s_add_u32 m0, s51, 16384
  s_add_u32 s46, s62, 786688
  buffer_load_dwordx4 v64, s[12:15], s46 offen lds
  s_add_u32 m0, s51, 20480
  s_add_u32 s46, s62, 1179904
  buffer_load_dwordx4 v64, s[12:15], s46 offen lds
  s_add_u32 m0, s51, 24576
  s_add_u32 s46, s62, 1572864
  buffer_load_dwordx4 v64, s[12:15], s46 offen lds
  s_add_u32 m0, s51, 28672
  s_add_u32 s46, s62, 1966080
  buffer_load_dwordx4 v64, s[12:15], s46 offen lds
  s_add_u32 m0, s51, 32768
  s_add_u32 s46, s62, 1572992
  buffer_load_dwordx4 v64, s[12:15], s46 offen lds
  s_add_u32 m0, s51, 36864
  s_add_u32 s46, s62, 1966208
  buffer_load_dwordx4 v64, s[12:15], s46 offen lds
  s_add_u32 m0, s51, 40960
  s_add_u32 s46, s62, 1573120
  buffer_load_dwordx4 v64, s[12:15], s46 offen lds
  s_add_u32 m0, s51, 45056
  s_add_u32 s46, s62, 1966336
  buffer_load_dwordx4 v64, s[12:15], s46 offen lds
  s_waitcnt vmcnt(24)
  s_barrier
  s_add_u32 m0, s51, 49152
  s_add_u32 s46, s62, 2359296
  buffer_load_dwordx4 v64, s[4:7], s46 offen lds
  s_add_u32 m0, s51, 53248
  s_add_u32 s46, s62, 2752512
  buffer_load_dwordx4 v64, s[4:7], s46 offen lds
  s_add_u32 m0, s51, 57344
  s_add_u32 s46, s62, 2359424
  buffer_load_dwordx4 v64, s[4:7], s46 offen lds
  s_add_u32 m0, s51, 61440
  s_add_u32 s46, s62, 2752640
  buffer_load_dwordx4 v64, s[4:7], s46 offen lds
  s_add_u32 m0, s51, 65536
  s_add_u32 s46, s62, 2359552
  buffer_load_dwordx4 v64, s[4:7], s46 offen lds
  s_add_u32 m0, s51, 69632
  s_add_u32 s46, s62, 2752768
  buffer_load_dwordx4 v64, s[4:7], s46 offen lds
  ds_read_b64_tr_b16 a[0:1], v66 offset:8192
  ds_read_b64_tr_b16 a[2:3], v66 offset:9216
  ds_read_b64_tr_b16 a[4:5], v66 offset:12288
  ds_read_b64_tr_b16 a[6:7], v66 offset:13312
  ds_read_b64_tr_b16 a[8:9], v66 offset:16384
  ds_read_b64_tr_b16 a[10:11], v66 offset:17408
  ds_read_b64_tr_b16 a[12:13], v66 offset:20480
  ds_read_b64_tr_b16 a[14:15], v66 offset:21504
  ds_read_b64_tr_b16 a[16:17], v66 offset:24576
  ds_read_b64_tr_b16 a[18:19], v66 offset:25600
  ds_read_b64_tr_b16 a[20:21], v66 offset:28672
  ds_read_b64_tr_b16 a[22:23], v66 offset:29696
  s_waitcnt lgkmcnt(0)
  s_waitcnt vmcnt(24)
  s_barrier
  s_add_u32 m0, s51, 73728
  s_add_u32 s46, s62, 2359296
  buffer_load_dwordx4 v64, s[12:15], s46 offen lds
  s_add_u32 m0, s51, 77824
  s_add_u32 s46, s62, 2752512
  buffer_load_dwordx4 v64, s[12:15], s46 offen lds
  s_add_u32 m0, s51, 81920
  s_add_u32 s46, s62, 2359424
  buffer_load_dwordx4 v64, s[12:15], s46 offen lds
  s_add_u32 m0, s51, 86016
  s_add_u32 s46, s62, 2752640
  buffer_load_dwordx4 v64, s[12:15], s46 offen lds
  s_add_u32 m0, s51, 90112
  s_add_u32 s46, s62, 2359552
  buffer_load_dwordx4 v64, s[12:15], s46 offen lds
  s_add_u32 m0, s51, 94208
  s_add_u32 s46, s62, 2752768
  buffer_load_dwordx4 v64, s[12:15], s46 offen lds
  ds_read_b64_tr_b16 a[24:25], v66 offset:32768
  ds_read_b64_tr_b16 a[26:27], v66 offset:33792
  ds_read_b64_tr_b16 a[28:29], v66 offset:36864
  ds_read_b64_tr_b16 a[30:31], v66 offset:37888
  ds_read_b64_tr_b16 a[32:33], v66 offset:40960
  ds_read_b64_tr_b16 a[34:35], v66 offset:41984
  ds_read_b64_tr_b16 a[36:37], v66 offset:45056
  ds_read_b64_tr_b16 a[38:39], v66 offset:46080
  ds_read_b64_tr_b16 a[40:41], v66 offset:49152
  ds_read_b64_tr_b16 a[42:43], v66 offset:50176
  ds_read_b64_tr_b16 a[44:45], v66 offset:53248
  ds_read_b64_tr_b16 a[46:47], v66 offset:54272
  s_waitcnt lgkmcnt(0)
  s_waitcnt vmcnt(24)
  s_barrier
  s_add_u32 m0, s51, 98304
  s_add_u32 s46, s62, 3145728
  buffer_load_dwordx4 v64, s[4:7], s46 offen lds
  s_add_u32 m0, s51, 102400
  s_add_u32 s46, s62, 3538944
  buffer_load_dwordx4 v64, s[4:7], s46 offen lds
  s_add_u32 m0, s51, 106496
  s_add_u32 s46, s62, 3145856
  buffer_load_dwordx4 v64, s[4:7], s46 offen lds
  s_add_u32 m0, s51, 110592
  s_add_u32 s46, s62, 3539072
  buffer_load_dwordx4 v64, s[4:7], s46 offen lds
  s_add_u32 m0, s51, 114688
  s_add_u32 s46, s62, 3145984
  buffer_load_dwordx4 v64, s[4:7], s46 offen lds
  s_add_u32 m0, s51, 118784
  s_add_u32 s46, s62, 3539200
  buffer_load_dwordx4 v64, s[4:7], s46 offen lds
  ds_read_b64_tr_b16 a[48:49], v66 offset:57344
  ds_read_b64_tr_b16 a[50:51], v66 offset:58368
  ds_read_b64_tr_b16 a[52:53], v66 offset:61440
  ds_read_b64_tr_b16 a[54:55], v66 offset:62464
  ds_read_b64_tr_b16 a[56:57], v67 offset:0
  ds_read_b64_tr_b16 a[58:59], v67 offset:1024
  ds_read_b64_tr_b16 a[60:61], v67 offset:4096
  ds_read_b64_tr_b16 a[62:63], v67 offset:5120
  ds_read_b64_tr_b16 a[64:65], v67 offset:8192
  ds_read_b64_tr_b16 a[66:67], v67 offset:9216
  ds_read_b64_tr_b16 a[68:69], v67 offset:12288
  ds_read_b64_tr_b16 a[70:71], v67 offset:13312
  s_waitcnt lgkmcnt(0)
  s_waitcnt vmcnt(24)
  s_barrier
  s_add_u32 m0, s51, 122880
  s_add_u32 s46, s62, 3932160
  buffer_load_dwordx4 v64, s[12:15], s46 offen lds
  s_add_u32 m0, s51, 126976
  s_add_u32 s46, s62, 4325376
  buffer_load_dwordx4 v64, s[12:15], s46 offen lds
  s_add_u32 m0, s51, 131072
  s_add_u32 s46, s62, 3932288
  buffer_load_dwordx4 v64, s[12:15], s46 offen lds
  s_add_u32 m0, s51, 135168
  s_add_u32 s46, s62, 4325504
  buffer_load_dwordx4 v64, s[12:15], s46 offen lds
  s_add_u32 m0, s51, 139264
  s_add_u32 s46, s62, 3932416
  buffer_load_dwordx4 v64, s[12:15], s46 offen lds
  s_add_u32 m0, s51, 143360
  s_add_u32 s46, s62, 4325632
  buffer_load_dwordx4 v64, s[12:15], s46 offen lds
  ds_read_b64_tr_b16 a[72:73], v65 offset:0
  ds_read_b64_tr_b16 a[74:75], v65 offset:1024
  ds_read_b64_tr_b16 a[76:77], v65 offset:4096
  ds_read_b64_tr_b16 a[78:79], v65 offset:5120
  ds_read_b64_tr_b16 a[80:81], v65 offset:8192
  ds_read_b64_tr_b16 a[82:83], v65 offset:9216
  ds_read_b64_tr_b16 a[84:85], v65 offset:12288
  ds_read_b64_tr_b16 a[86:87], v65 offset:13312
  ds_read_b64_tr_b16 a[88:89], v65 offset:16384
  ds_read_b64_tr_b16 a[90:91], v65 offset:17408
  ds_read_b64_tr_b16 a[92:93], v65 offset:20480
  ds_read_b64_tr_b16 a[94:95], v65 offset:21504
  s_waitcnt lgkmcnt(0)
  s_waitcnt vmcnt(24)
  s_barrier
  s_add_u32 m0, s51, 0
  s_add_u32 s46, s62, 4718592
  buffer_load_dwordx4 v64, s[4:7], s46 offen lds
  s_add_u32 m0, s51, 4096
  s_add_u32 s46, s62, 5111808
  buffer_load_dwordx4 v64, s[4:7], s46 offen lds
  s_add_u32 m0, s51, 8192
  s_add_u32 s46, s62, 4718720
  buffer_load_dwordx4 v64, s[4:7], s46 offen lds
  s_add_u32 m0, s51, 12288
  s_add_u32 s46, s62, 5111936
  buffer_load_dwordx4 v64, s[4:7], s46 offen lds
  s_add_u32 m0, s51, 16384
  s_add_u32 s46, s62, 4718848
  buffer_load_dwordx4 v64, s[4:7], s46 offen lds
  s_add_u32 m0, s51, 20480
  s_add_u32 s46, s62, 5112064
  buffer_load_dwordx4 v64, s[4:7], s46 offen lds
  ds_read_b64_tr_b16 a[96:97], v65 offset:24576
  ds_read_b64_tr_b16 a[98:99], v65 offset:25600
  ds_read_b64_tr_b16 a[100:101], v65 offset:28672
  ds_read_b64_tr_b16 a[102:103], v65 offset:29696
  ds_read_b64_tr_b16 a[104:105], v65 offset:32768
  ds_read_b64_tr_b16 a[106:107], v65 offset:33792
  ds_read_b64_tr_b16 a[108:109], v65 offset:36864
  ds_read_b64_tr_b16 a[110:111], v65 offset:37888
  ds_read_b64_tr_b16 a[112:113], v65 offset:40960
  ds_read_b64_tr_b16 a[114:115], v65 offset:41984
  ds_read_b64_tr_b16 a[116:117], v65 offset:45056
  ds_read_b64_tr_b16 a[118:119], v65 offset:46080
  s_waitcnt lgkmcnt(0)
  s_waitcnt vmcnt(24)
  s_barrier
  s_add_u32 m0, s51, 24576
  s_add_u32 s46, s62, 4718592
  buffer_load_dwordx4 v64, s[12:15], s46 offen lds
  s_add_u32 m0, s51, 28672
  s_add_u32 s46, s62, 5111808
  buffer_load_dwordx4 v64, s[12:15], s46 offen lds
  s_add_u32 m0, s51, 32768
  s_add_u32 s46, s62, 4718720
  buffer_load_dwordx4 v64, s[12:15], s46 offen lds
  s_add_u32 m0, s51, 36864
  s_add_u32 s46, s62, 5111936
  buffer_load_dwordx4 v64, s[12:15], s46 offen lds
  s_add_u32 m0, s51, 40960
  s_add_u32 s46, s62, 4718848
  buffer_load_dwordx4 v64, s[12:15], s46 offen lds
  s_add_u32 m0, s51, 45056
  s_add_u32 s46, s62, 5112064
  buffer_load_dwordx4 v64, s[12:15], s46 offen lds
  ds_read_b64_tr_b16 a[120:121], v65 offset:49152
  ds_read_b64_tr_b16 a[122:123], v65 offset:50176
  ds_read_b64_tr_b16 a[124:125], v65 offset:53248
  ds_read_b64_tr_b16 a[126:127], v65 offset:54272
  ds_read_b64_tr_b16 a[128:129], v65 offset:57344
  ds_read_b64_tr_b16 a[130:131], v65 offset:58368
  ds_read_b64_tr_b16 a[132:133], v65 offset:61440
  ds_read_b64_tr_b16 a[134:135], v65 offset:62464
  ds_read_b64_tr_b16 a[136:137], v66 offset:0
  ds_read_b64_tr_b16 a[138:139], v66 offset:1024
  ds_read_b64_tr_b16 a[140:141], v66 offset:4096
  ds_read_b64_tr_b16 a[142:143], v66 offset:5120
  s_waitcnt lgkmcnt(0)
  s_waitcnt vmcnt(24)
  s_barrier
  s_add_u32 m0, s51, 49152
  s_add_u32 s46, s62, 5505024
  buffer_load_dwordx4 v64, s[4:7], s46 offen lds
  s_add_u32 m0, s51, 53248
  s_add_u32 s46, s62, 5898240
  buffer_load_dwordx4 v64, s[4:7], s46 offen lds
  s_add_u32 m0, s51, 57344
  s_add_u32 s46, s62, 5505152
  buffer_load_dwordx4 v64, s[4:7], s46 offen lds
  s_add_u32 m0, s51, 61440
  s_add_u32 s46, s62, 5898368
  buffer_load_dwordx4 v64, s[4:7], s46 offen lds
  s_add_u32 m0, s51, 65536
  s_add_u32 s46, s62, 5505280
  buffer_load_dwordx4 v64, s[4:7], s46 offen lds
  s_add_u32 m0, s51, 69632
  s_add_u32 s46, s62, 5898496
  buffer_load_dwordx4 v64, s[4:7], s46 offen lds
  ds_read_b64_tr_b16 a[144:145], v66 offset:8192
  ds_read_b64_tr_b16 a[146:147], v66 offset:9216
  ds_read_b64_tr_b16 a[148:149], v66 offset:12288
  ds_read_b64_tr_b16 a[150:151], v66 offset:13312
  ds_read_b64_tr_b16 a[152:153], v66 offset:16384
  ds_read_b64_tr_b16 a[154:155], v66 offset:17408
  ds_read_b64_tr_b16 a[156:157], v66 offset:20480
  ds_read_b64_tr_b16 a[158:159], v66 offset:21504
  ds_read_b64_tr_b16 a[160:161], v66 offset:24576
  ds_read_b64_tr_b16 a[162:163], v66 offset:25600
  ds_read_b64_tr_b16 a[164:165], v66 offset:28672
  ds_read_b64_tr_b16 a[166:167], v66 offset:29696
  s_waitcnt lgkmcnt(0)
  s_waitcnt vmcnt(24)
  s_barrier
  s_add_u32 m0, s51, 73728
  s_add_u32 s46, s62, 6291456
  buffer_load_dwordx4 v64, s[12:15], s46 offen lds
  s_add_u32 m0, s51, 77824
  s_add_u32 s46, s62, 6684672
  buffer_load_dwordx4 v64, s[12:15], s46 offen lds
  s_add_u32 m0, s51, 81920
  s_add_u32 s46, s62, 6291584
  buffer_load_dwordx4 v64, s[12:15], s46 offen lds
  s_add_u32 m0, s51, 86016
  s_add_u32 s46, s62, 6684800
  buffer_load_dwordx4 v64, s[12:15], s46 offen lds
  s_add_u32 m0, s51, 90112
  s_add_u32 s46, s62, 6291712
  buffer_load_dwordx4 v64, s[12:15], s46 offen lds
  s_add_u32 m0, s51, 94208
  s_add_u32 s46, s62, 6684928
  buffer_load_dwordx4 v64, s[12:15], s46 offen lds
  ds_read_b64_tr_b16 a[168:169], v66 offset:32768
  ds_read_b64_tr_b16 a[170:171], v66 offset:33792
  ds_read_b64_tr_b16 a[172:173], v66 offset:36864
  ds_read_b64_tr_b16 a[174:175], v66 offset:37888
  ds_read_b64_tr_b16 a[176:177], v66 offset:40960
  ds_read_b64_tr_b16 a[178:179], v66 offset:41984
  ds_read_b64_tr_b16 a[180:181], v66 offset:45056
  ds_read_b64_tr_b16 a[182:183], v66 offset:46080
  ds_read_b64_tr_b16 a[184:185], v66 offset:49152
  ds_read_b64_tr_b16 a[186:187], v66 offset:50176
  ds_read_b64_tr_b16 a[188:189], v66 offset:53248
  ds_read_b64_tr_b16 a[190:191], v66 offset:54272
  s_waitcnt lgkmcnt(0)
  s_waitcnt vmcnt(24)
  s_barrier
  s_add_u32 m0, s51, 98304
  s_add_u32 s46, s62, 7077888
  buffer_load_dwordx4 v64, s[4:7], s46 offen lds
  s_add_u32 m0, s51, 102400
  s_add_u32 s46, s62, 7471104
  buffer_load_dwordx4 v64, s[4:7], s46 offen lds
  s_add_u32 m0, s51, 106496
  s_add_u32 s46, s62, 7078016
  buffer_load_dwordx4 v64, s[4:7], s46 offen lds
  s_add_u32 m0, s51, 110592
  s_add_u32 s46, s62, 7471232
  buffer_load_dwordx4 v64, s[4:7], s46 offen lds
  s_add_u32 m0, s51, 114688
  s_add_u32 s46, s62, 7078144
  buffer_load_dwordx4 v64, s[4:7], s46 offen lds
  s_add_u32 m0, s51, 118784
  s_add_u32 s46, s62, 7471360
  buffer_load_dwordx4 v64, s[4:7], s46 offen lds
  ds_read_b64_tr_b16 a[192:193], v66 offset:57344
  ds_read_b64_tr_b16 a[194:195], v66 offset:58368
  ds_read_b64_tr_b16 a[196:197], v66 offset:61440
  ds_read_b64_tr_b16 a[198:199], v66 offset:62464
  ds_read_b64_tr_b16 a[200:201], v67 offset:0
  ds_read_b64_tr_b16 a[202:203], v67 offset:1024
  ds_read_b64_tr_b16 a[204:205], v67 offset:4096
  ds_read_b64_tr_b16 a[206:207], v67 offset:5120
  ds_read_b64_tr_b16 a[208:209], v67 offset:8192
  ds_read_b64_tr_b16 a[210:211], v67 offset:9216
  ds_read_b64_tr_b16 a[212:213], v67 offset:12288
  ds_read_b64_tr_b16 a[214:215], v67 offset:13312
  s_waitcnt lgkmcnt(0)
  s_waitcnt vmcnt(24)
  s_barrier
  s_add_u32 m0, s51, 122880
  s_add_u32 s46, s62, 7077888
  buffer_load_dwordx4 v64, s[12:15], s46 offen lds
  s_add_u32 m0, s51, 126976
  s_add_u32 s46, s62, 7471104
  buffer_load_dwordx4 v64, s[12:15], s46 offen lds
  s_add_u32 m0, s51, 131072
  s_add_u32 s46, s62, 7078016
  buffer_load_dwordx4 v64, s[12:15], s46 offen lds
  s_add_u32 m0, s51, 135168
  s_add_u32 s46, s62, 7471232
  buffer_load_dwordx4 v64, s[12:15], s46 offen lds
  s_add_u32 m0, s51, 139264
  s_add_u32 s46, s62, 7078144
  buffer_load_dwordx4 v64, s[12:15], s46 offen lds
  s_add_u32 m0, s51, 143360
  s_add_u32 s46, s62, 7471360
  buffer_load_dwordx4 v64, s[12:15], s46 offen lds
  ds_read_b64_tr_b16 a[216:217], v65 offset:0
  ds_read_b64_tr_b16 a[218:219], v65 offset:1024
  ds_read_b64_tr_b16 a[220:221], v65 offset:4096
  ds_read_b64_tr_b16 a[222:223], v65 offset:5120
  ds_read_b64_tr_b16 a[224:225], v65 offset:8192
  ds_read_b64_tr_b16 a[226:227], v65 offset:9216
  ds_read_b64_tr_b16 a[228:229], v65 offset:12288
  ds_read_b64_tr_b16 a[230:231], v65 offset:13312
  ds_read_b64_tr_b16 a[232:233], v65 offset:16384
  ds_read_b64_tr_b16 a[234:235], v65 offset:17408
  ds_read_b64_tr_b16 a[236:237], v65 offset:20480
  ds_read_b64_tr_b16 a[238:239], v65 offset:21504
  s_waitcnt lgkmcnt(0)
  s_waitcnt vmcnt(24)
  s_barrier
  s_add_u32 m0, s51, 0
  s_add_u32 s46, s62, 1572864
  buffer_load_dwordx4 v64, s[4:7], s46 offen lds
  s_add_u32 m0, s51, 4096
  s_add_u32 s46, s62, 1966080
  buffer_load_dwordx4 v64, s[4:7], s46 offen lds
  s_add_u32 m0, s51, 8192
  s_add_u32 s46, s62, 1572992
  buffer_load_dwordx4 v64, s[4:7], s46 offen lds
  s_add_u32 m0, s51, 12288
  s_add_u32 s46, s62, 1966208
  buffer_load_dwordx4 v64, s[4:7], s46 offen lds
  s_add_u32 m0, s51, 16384
  s_add_u32 s46, s62, 1573120
  buffer_load_dwordx4 v64, s[4:7], s46 offen lds
  s_add_u32 m0, s51, 20480
  s_add_u32 s46, s62, 1966336
  buffer_load_dwordx4 v64, s[4:7], s46 offen lds
  ds_read_b64_tr_b16 a[240:241], v65 offset:24576
  ds_read_b64_tr_b16 a[242:243], v65 offset:25600
  ds_read_b64_tr_b16 a[244:245], v65 offset:28672
  ds_read_b64_tr_b16 a[246:247], v65 offset:29696
  ds_read_b64_tr_b16 a[248:249], v65 offset:32768
  ds_read_b64_tr_b16 a[250:251], v65 offset:33792
  ds_read_b64_tr_b16 a[252:253], v65 offset:36864
  ds_read_b64_tr_b16 a[254:255], v65 offset:37888
  ds_read_b64_tr_b16 v[152:153], v65 offset:40960
  ds_read_b64_tr_b16 v[154:155], v65 offset:41984
  ds_read_b64_tr_b16 v[156:157], v65 offset:45056
  ds_read_b64_tr_b16 v[158:159], v65 offset:46080
  s_waitcnt lgkmcnt(0)
  s_waitcnt vmcnt(24)
  s_barrier
  s_add_u32 m0, s51, 24576
  s_add_u32 s46, s62, 3145728
  buffer_load_dwordx4 v64, s[12:15], s46 offen lds
  s_add_u32 m0, s51, 28672
  s_add_u32 s46, s62, 3538944
  buffer_load_dwordx4 v64, s[12:15], s46 offen lds
  s_add_u32 m0, s51, 32768
  s_add_u32 s46, s62, 3145856
  buffer_load_dwordx4 v64, s[12:15], s46 offen lds
  s_add_u32 m0, s51, 36864
  s_add_u32 s46, s62, 3539072
  buffer_load_dwordx4 v64, s[12:15], s46 offen lds
  s_add_u32 m0, s51, 40960
  s_add_u32 s46, s62, 3145984
  buffer_load_dwordx4 v64, s[12:15], s46 offen lds
  s_add_u32 m0, s51, 45056
  s_add_u32 s46, s62, 3539200
  buffer_load_dwordx4 v64, s[12:15], s46 offen lds
  ds_read_b64_tr_b16 v[160:161], v65 offset:49152
  ds_read_b64_tr_b16 v[162:163], v65 offset:50176
  ds_read_b64_tr_b16 v[164:165], v65 offset:53248
  ds_read_b64_tr_b16 v[166:167], v65 offset:54272
  ds_read_b64_tr_b16 v[168:169], v65 offset:57344
  ds_read_b64_tr_b16 v[170:171], v65 offset:58368
  ds_read_b64_tr_b16 v[172:173], v65 offset:61440
  ds_read_b64_tr_b16 v[174:175], v65 offset:62464
  ds_read_b64_tr_b16 v[176:177], v66 offset:0
  ds_read_b64_tr_b16 v[178:179], v66 offset:1024
  ds_read_b64_tr_b16 v[180:181], v66 offset:4096
  ds_read_b64_tr_b16 v[182:183], v66 offset:5120
  s_waitcnt lgkmcnt(0)
  s_waitcnt vmcnt(24)
  s_barrier
  s_add_u32 m0, s51, 49152
  s_add_u32 s46, s62, 3932160
  buffer_load_dwordx4 v64, s[4:7], s46 offen lds
  s_add_u32 m0, s51, 53248
  s_add_u32 s46, s62, 4325376
  buffer_load_dwordx4 v64, s[4:7], s46 offen lds
  s_add_u32 m0, s51, 57344
  s_add_u32 s46, s62, 3932288
  buffer_load_dwordx4 v64, s[4:7], s46 offen lds
  s_add_u32 m0, s51, 61440
  s_add_u32 s46, s62, 4325504
  buffer_load_dwordx4 v64, s[4:7], s46 offen lds
  s_add_u32 m0, s51, 65536
  s_add_u32 s46, s62, 3932416
  buffer_load_dwordx4 v64, s[4:7], s46 offen lds
  s_add_u32 m0, s51, 69632
  s_add_u32 s46, s62, 4325632
  buffer_load_dwordx4 v64, s[4:7], s46 offen lds
  ds_read_b64_tr_b16 v[184:185], v66 offset:8192
  ds_read_b64_tr_b16 v[186:187], v66 offset:9216
  ds_read_b64_tr_b16 v[188:189], v66 offset:12288
  ds_read_b64_tr_b16 v[190:191], v66 offset:13312
  ds_read_b64_tr_b16 v[192:193], v66 offset:16384
  ds_read_b64_tr_b16 v[194:195], v66 offset:17408
  ds_read_b64_tr_b16 v[196:197], v66 offset:20480
  ds_read_b64_tr_b16 v[198:199], v66 offset:21504
  ds_read_b64_tr_b16 v[200:201], v66 offset:24576
  ds_read_b64_tr_b16 v[202:203], v66 offset:25600
  ds_read_b64_tr_b16 v[204:205], v66 offset:28672
  ds_read_b64_tr_b16 v[206:207], v66 offset:29696
  s_waitcnt lgkmcnt(0)
  s_waitcnt vmcnt(24)
  s_barrier
  s_add_u32 m0, s51, 73728
  s_add_u32 s46, s62, 5505024
  buffer_load_dwordx4 v64, s[12:15], s46 offen lds
  s_add_u32 m0, s51, 77824
  s_add_u32 s46, s62, 5898240
  buffer_load_dwordx4 v64, s[12:15], s46 offen lds
  s_add_u32 m0, s51, 81920
  s_add_u32 s46, s62, 5505152
  buffer_load_dwordx4 v64, s[12:15], s46 offen lds
  s_add_u32 m0, s51, 86016
  s_add_u32 s46, s62, 5898368
  buffer_load_dwordx4 v64, s[12:15], s46 offen lds
  s_add_u32 m0, s51, 90112
  s_add_u32 s46, s62, 5505280
  buffer_load_dwordx4 v64, s[12:15], s46 offen lds
  s_add_u32 m0, s51, 94208
  s_add_u32 s46, s62, 5898496
  buffer_load_dwordx4 v64, s[12:15], s46 offen lds
  ds_read_b64_tr_b16 v[208:209], v66 offset:32768
  ds_read_b64_tr_b16 v[210:211], v66 offset:33792
  ds_read_b64_tr_b16 v[212:213], v66 offset:36864
  ds_read_b64_tr_b16 v[214:215], v66 offset:37888
  ds_read_b64_tr_b16 v[216:217], v66 offset:40960
  ds_read_b64_tr_b16 v[218:219], v66 offset:41984
  ds_read_b64_tr_b16 v[220:221], v66 offset:45056
  ds_read_b64_tr_b16 v[222:223], v66 offset:46080
  ds_read_b64_tr_b16 v[224:225], v66 offset:49152
  ds_read_b64_tr_b16 v[226:227], v66 offset:50176
  ds_read_b64_tr_b16 v[228:229], v66 offset:53248
  ds_read_b64_tr_b16 v[230:231], v66 offset:54272
  s_waitcnt lgkmcnt(0)
  s_waitcnt vmcnt(24)
  s_barrier
  s_add_u32 m0, s51, 98304
  s_add_u32 s46, s62, 6291456
  buffer_load_dwordx4 v64, s[4:7], s46 offen lds
  s_add_u32 m0, s51, 102400
  s_add_u32 s46, s62, 6684672
  buffer_load_dwordx4 v64, s[4:7], s46 offen lds
  s_add_u32 m0, s51, 106496
  s_add_u32 s46, s62, 6291584
  buffer_load_dwordx4 v64, s[4:7], s46 offen lds
  s_add_u32 m0, s51, 110592
  s_add_u32 s46, s62, 6684800
  buffer_load_dwordx4 v64, s[4:7], s46 offen lds
  s_add_u32 m0, s51, 114688
  s_add_u32 s46, s62, 6291712
  buffer_load_dwordx4 v64, s[4:7], s46 offen lds
  s_add_u32 m0, s51, 118784
  s_add_u32 s46, s62, 6684928
  buffer_load_dwordx4 v64, s[4:7], s46 offen lds
  ds_read_b64_tr_b16 v[232:233], v66 offset:57344
  ds_read_b64_tr_b16 v[234:235], v66 offset:58368
  ds_read_b64_tr_b16 v[236:237], v66 offset:61440
  ds_read_b64_tr_b16 v[238:239], v66 offset:62464
  ds_read_b64_tr_b16 v[240:241], v67 offset:0
  ds_read_b64_tr_b16 v[242:243], v67 offset:1024
  ds_read_b64_tr_b16 v[244:245], v67 offset:4096
  ds_read_b64_tr_b16 v[246:247], v67 offset:5120
  ds_read_b64_tr_b16 v[248:249], v67 offset:8192
  ds_read_b64_tr_b16 v[250:251], v67 offset:9216
  ds_read_b64_tr_b16 v[252:253], v67 offset:12288
  ds_read_b64_tr_b16 v[254:255], v67 offset:13312
  s_waitcnt lgkmcnt(0)
  s_waitcnt vmcnt(24)
  s_barrier
  ds_read_b64_tr_b16 v[40:41], v65 offset:0
  ds_read_b64_tr_b16 v[42:43], v65 offset:1024
  ds_read_b64_tr_b16 v[44:45], v65 offset:4096
  ds_read_b64_tr_b16 v[46:47], v65 offset:5120
  ds_read_b64_tr_b16 v[48:49], v65 offset:8192
  ds_read_b64_tr_b16 v[50:51], v65 offset:9216
  ds_read_b64_tr_b16 v[52:53], v65 offset:12288
  ds_read_b64_tr_b16 v[54:55], v65 offset:13312
  ds_read_b64_tr_b16 v[56:57], v65 offset:16384
  ds_read_b64_tr_b16 v[58:59], v65 offset:17408
  ds_read_b64_tr_b16 v[60:61], v65 offset:20480
  ds_read_b64_tr_b16 v[62:63], v65 offset:21504
  s_waitcnt lgkmcnt(0)
  s_waitcnt vmcnt(18)
  s_barrier
  ds_write_b128 v2, v[40:43] offset:0
  ds_write_b128 v2, v[44:47] offset:4096
  ds_write_b128 v2, v[48:51] offset:8192
  ds_write_b128 v2, v[52:55] offset:12288
  ds_write_b128 v2, v[56:59] offset:16384
  ds_write_b128 v2, v[60:63] offset:20480
  ds_read_b64_tr_b16 v[16:17], v65 offset:24576
  ds_read_b64_tr_b16 v[18:19], v65 offset:25600
  ds_read_b64_tr_b16 v[20:21], v65 offset:28672
  ds_read_b64_tr_b16 v[22:23], v65 offset:29696
  ds_read_b64_tr_b16 v[24:25], v65 offset:32768
  ds_read_b64_tr_b16 v[26:27], v65 offset:33792
  ds_read_b64_tr_b16 v[28:29], v65 offset:36864
  ds_read_b64_tr_b16 v[30:31], v65 offset:37888
  ds_read_b64_tr_b16 v[32:33], v65 offset:40960
  ds_read_b64_tr_b16 v[34:35], v65 offset:41984
  ds_read_b64_tr_b16 v[36:37], v65 offset:45056
  ds_read_b64_tr_b16 v[38:39], v65 offset:46080
  s_waitcnt lgkmcnt(0)
  s_waitcnt vmcnt(12)
  s_barrier
  ds_write_b128 v2, v[16:19] offset:24576
  ds_write_b128 v2, v[20:23] offset:28672
  ds_write_b128 v2, v[24:27] offset:32768
  ds_write_b128 v2, v[28:31] offset:36864
  ds_write_b128 v2, v[32:35] offset:40960
  ds_write_b128 v2, v[36:39] offset:45056
  ds_read_b64_tr_b16 v[40:41], v65 offset:49152
  ds_read_b64_tr_b16 v[42:43], v65 offset:50176
  ds_read_b64_tr_b16 v[44:45], v65 offset:53248
  ds_read_b64_tr_b16 v[46:47], v65 offset:54272
  ds_read_b64_tr_b16 v[48:49], v65 offset:57344
  ds_read_b64_tr_b16 v[50:51], v65 offset:58368
  ds_read_b64_tr_b16 v[52:53], v65 offset:61440
  ds_read_b64_tr_b16 v[54:55], v65 offset:62464
  ds_read_b64_tr_b16 v[56:57], v66 offset:0
  ds_read_b64_tr_b16 v[58:59], v66 offset:1024
  ds_read_b64_tr_b16 v[60:61], v66 offset:4096
  ds_read_b64_tr_b16 v[62:63], v66 offset:5120
  s_waitcnt lgkmcnt(0)
  s_waitcnt vmcnt(6)
  s_barrier
  ds_write_b128 v2, v[40:43] offset:49152
  ds_write_b128 v2, v[44:47] offset:53248
  ds_write_b128 v2, v[48:51] offset:57344
  ds_write_b128 v2, v[52:55] offset:61440
  ds_write_b128 v3, v[56:59] offset:0
  ds_write_b128 v3, v[60:63] offset:4096
  ds_read_b64_tr_b16 v[16:17], v66 offset:8192
  ds_read_b64_tr_b16 v[18:19], v66 offset:9216
  ds_read_b64_tr_b16 v[20:21], v66 offset:12288
  ds_read_b64_tr_b16 v[22:23], v66 offset:13312
  ds_read_b64_tr_b16 v[24:25], v66 offset:16384
  ds_read_b64_tr_b16 v[26:27], v66 offset:17408
  ds_read_b64_tr_b16 v[28:29], v66 offset:20480
  ds_read_b64_tr_b16 v[30:31], v66 offset:21504
  ds_read_b64_tr_b16 v[32:33], v66 offset:24576
  ds_read_b64_tr_b16 v[34:35], v66 offset:25600
  ds_read_b64_tr_b16 v[36:37], v66 offset:28672
  ds_read_b64_tr_b16 v[38:39], v66 offset:29696
  s_waitcnt lgkmcnt(0)
  s_waitcnt vmcnt(0)
  s_barrier
  ds_write_b128 v3, v[16:19] offset:8192
  ds_write_b128 v3, v[20:23] offset:12288
  ds_write_b128 v3, v[24:27] offset:16384
  ds_write_b128 v3, v[28:31] offset:20480
  ds_write_b128 v3, v[32:35] offset:24576
  ds_write_b128 v3, v[36:39] offset:28672
  ds_read_b64_tr_b16 v[40:41], v66 offset:32768
  ds_read_b64_tr_b16 v[42:43], v66 offset:33792
  ds_read_b64_tr_b16 v[44:45], v66 offset:36864
  ds_read_b64_tr_b16 v[46:47], v66 offset:37888
  ds_read_b64_tr_b16 v[48:49], v66 offset:40960
  ds_read_b64_tr_b16 v[50:51], v66 offset:41984
  ds_read_b64_tr_b16 v[52:53], v66 offset:45056
  ds_read_b64_tr_b16 v[54:55], v66 offset:46080
  ds_read_b64_tr_b16 v[56:57], v66 offset:49152
  ds_read_b64_tr_b16 v[58:59], v66 offset:50176
  ds_read_b64_tr_b16 v[60:61], v66 offset:53248
  ds_read_b64_tr_b16 v[62:63], v66 offset:54272
  s_waitcnt lgkmcnt(0)
  s_barrier
  ds_write_b128 v3, v[40:43] offset:32768
  ds_write_b128 v3, v[44:47] offset:36864
  ds_write_b128 v3, v[48:51] offset:40960
  ds_write_b128 v3, v[52:55] offset:45056
  ds_write_b128 v3, v[56:59] offset:49152
  ds_write_b128 v3, v[60:63] offset:53248
  s_waitcnt lgkmcnt(0)
  v_and_b32 v138, 1, v0
  v_lshlrev_b32 v138, 7, v138
  v_add_u32 v138, 3014656, v138
  s_mov_b32 s50, 0
pol_26:
  buffer_load_dword v136, v138, s[8:11], 0 offen sc1
  s_add_u32 s50, s50, 1
  s_cmp_gt_u32 s50, 131072
  s_cbranch_scc1 L_fail
  s_waitcnt vmcnt(0)
  v_cmp_eq_u32 vcc, 0, v136
  s_cbranch_vccnz pol_26
  v_readlane_b32 s54, v136, 0
  v_readlane_b32 s55, v136, 1
  s_and_b32 s54, s54, 0x2000
  s_and_b32 s55, s55, 0x2000
  s_mov_b32 s68, 0xfffffffe
  v_and_b32 v136, 3, v0
  s_lshl_b32 s46, s43, 9
  s_add_u32 s46, s46, s55
  s_add_u32 s46, s46, 2883584
  v_lshl_add_u32 v10, v136, 7, s46
  s_lshl_b32 s46, s43, 7
  s_add_u32 s46, s46, s55
  s_add_u32 s46, s46, 2885632
  v_lshl_add_u32 v11, v136, 9, s46
  v_mov_b32 v7, 0x44444444
  v_mov_b32 v136, 0xeeeeeeee
  v_and_b32 v137, 8, v0
  v_cmp_ne_u32 vcc, 0, v137
  s_nop 1
  v_cndmask_b32 v7, v7, v136, vcc
  s_mov_b32 s69, 1037384597
  s_mov_b32 s70, 3494803967
  v_and_b32 v136, 15, v0
  v_lshrrev_b32 v137, 1, v136
  v_and_b32 v137, 4, v137
  v_xor_b32 v137, v137, v136
  v_lshlrev_b32 v4, 5, v137
  v_lshrrev_b32 v137, 2, v136
  v_lshrrev_b32 v138, 4, v0
  v_xor_b32 v137, v137, v138
  v_lshl_add_u32 v4, v137, 3, v4
  s_lshl_b32 s46, s42, 9
  s_add_u32 s46, s46, 147456
  v_add_u32 v4, s46, v4
  v_lshlrev_b32 v5, 8, v138
  v_and_b32 v137, 1, v138
  v_lshl_add_u32 v5, v137, 7, v5
  v_lshlrev_b32 v137, 1, v137
  v_and_b32 v139, 3, v0
  v_xor_b32 v137, v137, v139
  v_lshl_add_u32 v5, v137, 3, v5
  v_bfe_u32 v137, v0, 2, 2
  v_lshl_add_u32 v5, v137, 5, v5
  v_xor_b32 v6, 0x88, v5
  v_add_u32 v5, 147456, v5
  v_add_u32 v6, 147456, v6
  v_add_u32 v13, 122880, v1
  s_lshl_b32 s46, s42, 16
  s_add_u32 s46, s46, s55
  s_add_u32 s46, s46, 2097152
  s_lshr_b32 s47, s45, 4
  s_add_u32 s47, s47, 1
  s_lshl_b32 s47, s47, 14
  s_and_b32 s48, s45, 15
  s_lshl_b32 s48, s48, 9
  s_add_u32 s47, s47, s48
  s_add_u32 s47, s47, s46
  v_lshrrev_b32 v137, 1, v138
  v_and_b32 v139, 1, v138
  v_lshl_add_u32 v8, v137, 4, v136
  v_lshlrev_b32 v8, 4, v8
  v_lshl_add_u32 v8, v139, 3, v8
  v_add_u32 v8, s47, v8
  s_lshl_b32 s47, s45, 7
  s_add_u32 s47, s47, s46
  s_add_u32 s47, s47, 51200
  v_lshl_add_u32 v9, v137, 3, v136
  v_lshlrev_b32 v9, 3, v9
  v_lshl_add_u32 v9, v139, 2, v9
  v_add_u32 v9, s47, v9
  v_mov_b32 v140, 2146435072
  v_cmp_lt_u32 vcc, 7, v136
  s_nop 1
  v_cndmask_b32 v9, v9, v140, vcc
  v_lshlrev_b32 v14, 4, v136
  v_lshl_add_u32 v14, v139, 3, v14
  v_lshl_add_u32 v14, v137, 2, v14
  s_mul_i32 s47, s45, 768
  s_sub_u32 s47, 32768, s47
  v_add_u32 v14, s47, v14
  s_lshl_b32 s47, s42, 4
  v_add_u32 v136, s47, v136
  v_lshlrev_b32 v138, 2, v138
  v_sub_u32 v136, v136, v138
  v_cmp_gt_i32 s[72:73], 0, v136
  v_cmp_gt_i32 s[74:75], 1, v136
  v_cmp_gt_i32 s[76:77], 2, v136
  v_cmp_gt_i32 s[78:79], 3, v136
  v_cmp_gt_i32 s[80:81], 16, v136
  v_cmp_gt_i32 s[82:83], 17, v136
  v_cmp_gt_i32 s[84:85], 18, v136
  v_cmp_gt_i32 s[86:87], 19, v136
  s_lshl_b32 s46, s45, 7
  s_lshl_b32 s47, s42, 2
  s_add_u32 s47, s47, s46
  s_add_u32 s47, s47, 2981888
  v_mov_b32 v15, s47
  s_cmp_lg_u32 s42, 2
  s_cbranch_scc1 sc_fl
  v_and_b32 v15, 1, v0
  v_lshlrev_b32 v15, 14, v15
  s_add_u32 s46, s46, 2899968
  v_add_u32 v15, s46, v15
sc_fl:
  s_mul_i32 s63, s45, 786432
  s_add_u32 s63, s63, 8388608
  s_lshl_b32 s64, s45, 10
  s_mul_i32 s46, s42, 40960
  s_add_u32 s64, s64, s46
  s_add_u32 s64, s64, 188743680
  s_mov_b32 s61, 0
  s_mov_b32 s52, 0
  s_mov_b32 s58, 0
  s_mov_b32 s65, 524288
  s_mov_b32 s100, 0
sc_loop:
  s_add_u32 s53, s52, 1
  s_cmp_lg_u32 s42, 2
  s_cbranch_scc1 sc_nodma
  s_cmp_ge_u32 s61, s53
  s_cbranch_scc1 wf_done_27
  s_mov_b32 s50, 0
wf_loop_28:
  buffer_load_dword v136, v15, s[8:11], 0 offen sc1
  s_add_u32 s50, s50, 1
  s_cmp_gt_u32 s50, 131072
  s_cbranch_scc1 L_fail
  s_waitcnt vmcnt(0)
  v_min_u32_dpp v136, v136, v136 row_ror:8 row_mask:0xf bank_mask:0xf
  s_nop 1
  v_min_u32_dpp v136, v136, v136 row_ror:4 row_mask:0xf bank_mask:0xf
  s_nop 1
  v_min_u32_dpp v136, v136, v136 row_ror:2 row_mask:0xf bank_mask:0xf
  s_nop 1
  v_min_u32_dpp v136, v136, v136 row_ror:1 row_mask:0xf bank_mask:0xf
  v_mov_b32 v137, v136
  s_nop 1
  v_permlane16_swap_b32 v137, v136
  v_min_u32 v136, v136, v137
  v_mov_b32 v137, v136
  s_nop 1
  v_permlane32_swap_b32 v137, v136
  v_min_u32 v136, v136, v137
  s_nop 0
  v_readfirstlane_b32 s61, v136
  s_nop 0
  s_cmp_lt_u32 s61, s53
  s_cbranch_scc1 wf_loop_28
wf_done_27:
  s_mov_b32 m0, 122880
  s_add_u32 s46, s63, 25165824
  buffer_load_dwordx4 v1, s[8:11], s46 offen offset:0 sc1 lds
  buffer_load_dwordx4 v1, s[8:11], s46 offen offset:1024 sc1 lds
  buffer_load_dwordx4 v1, s[8:11], s46 offen offset:2048 sc1 lds
  buffer_load_dwordx4 v1, s[8:11], s46 offen offset:3072 sc1 lds
  s_mov_b32 m0, 126976
  s_add_u32 s46, s63, 25169920
  buffer_load_dwordx4 v1, s[8:11], s46 offen offset:0 sc1 lds
  buffer_load_dwordx4 v1, s[8:11], s46 offen offset:1024 sc1 lds
  buffer_load_dwordx4 v1, s[8:11], s46 offen offset:2048 sc1 lds
  buffer_load_dwordx4 v1, s[8:11], s46 offen offset:3072 sc1 lds
  s_mov_b32 m0, 131072
  s_add_u32 s46, s63, 25174016
  buffer_load_dwordx4 v1, s[8:11], s46 offen offset:0 sc1 lds
  buffer_load_dwordx4 v1, s[8:11], s46 offen offset:1024 sc1 lds
  buffer_load_dwordx4 v1, s[8:11], s46 offen offset:2048 sc1 lds
  buffer_load_dwordx4 v1, s[8:11], s46 offen offset:3072 sc1 lds
  s_mov_b32 m0, 135168
  s_add_u32 s46, s63, 0
  buffer_load_dwordx4 v1, s[8:11], s46 offen offset:0 sc1 lds
  buffer_load_dwordx4 v1, s[8:11], s46 offen offset:1024 sc1 lds
  buffer_load_dwordx4 v1, s[8:11], s46 offen offset:2048 sc1 lds
  buffer_load_dwordx4 v1, s[8:11], s46 offen offset:3072 sc1 lds
  s_mov_b32 m0, 139264
  s_add_u32 s46, s63, 4096
  buffer_load_dwordx4 v1, s[8:11], s46 offen offset:0 sc1 lds
  buffer_load_dwordx4 v1, s[8:11], s46 offen offset:1024 sc1 lds
  buffer_load_dwordx4 v1, s[8:11], s46 offen offset:2048 sc1 lds
  buffer_load_dwordx4 v1, s[8:11], s46 offen offset:3072 sc1 lds
  s_mov_b32 m0, 143360
  s_add_u32 s46, s63, 8192
  buffer_load_dwordx4 v1, s[8:11], s46 offen offset:0 sc1 lds
  buffer_load_dwordx4 v1, s[8:11], s46 offen offset:1024 sc1 lds
  buffer_load_dwordx4 v1, s[8:11], s46 offen offset:2048 sc1 lds
  buffer_load_dwordx4 v1, s[8:11], s46 offen offset:3072 sc1 lds
sc_nodma:
  s_add_u32 s63, s63, 12288
  s_lshl_b32 s56, s58, 2
  s_add_u32 s56, s56, s43
  s_lshl_b32 s56, s56, 16
  s_add_u32 s56, s56, s55
  s_add_u32 s56, s56, 2097152
  s_add_u32 s59, s56, 4096
  s_add_u32 s57, s56, 49152
  s_lshl_b32 s66, s58, 18
  ds_read_b128 v[56:59], v2 offset:0
  ds_read_b128 v[60:63], v2 offset:4096
  ds_read_b128 v[64:67], v2 offset:8192
  ds_read_b128 v[68:71], v2 offset:12288
  ds_read_b128 v[72:75], v2 offset:16384
  ds_read_b128 v[76:79], v2 offset:20480
  ds_read_b128 v[80:83], v2 offset:24576
  ds_read_b128 v[84:87], v2 offset:28672
  v_mov_b32 v88, 0
  v_mov_b32 v89, 0
  v_mov_b32 v90, 0
  v_mov_b32 v91, 0
  v_mov_b32 v92, 0
  v_mov_b32 v93, 0
  v_mov_b32 v94, 0
  v_mov_b32 v95, 0
  v_mov_b32 v96, 0
  v_mov_b32 v97, 0
  v_mov_b32 v98, 0
  v_mov_b32 v99, 0
  v_mov_b32 v100, 0
  v_mov_b32 v101, 0
  v_mov_b32 v102, 0
  v_mov_b32 v103, 0
  v_mov_b32 v104, 0
  v_mov_b32 v105, 0
  v_mov_b32 v106, 0
  v_mov_b32 v107, 0
  v_mov_b32 v108, 0
  v_mov_b32 v109, 0
  v_mov_b32 v110, 0
  v_mov_b32 v111, 0
  s_cmp_lg_u32 s42, 3
  s_cbranch_scc1 sc_nobell
  s_mov_b32 s50, 0
  s_mov_b64 exec, 15
  buffer_load_dword v112, v10, s[8:11], 0 offen sc1
  s_nop 11
  buffer_load_dword v113, v10, s[8:11], 0 offen sc1
  s_nop 11
  buffer_load_dword v114, v10, s[8:11], 0 offen sc1
  s_nop 11
  buffer_load_dword v115, v10, s[8:11], 0 offen sc1
  s_nop 11
  buffer_load_dword v116, v10, s[8:11], 0 offen sc1
  s_nop 11
  buffer_load_dword v117, v10, s[8:11], 0 offen sc1
  s_nop 11
  buffer_load_dword v118, v10, s[8:11], 0 offen sc1
  s_nop 11
  buffer_load_dword v119, v10, s[8:11], 0 offen sc1
  s_nop 11
  buffer_load_dword v120, v10, s[8:11], 0 offen sc1
  s_nop 11
bell_29:
  buffer_load_dword v121, v10, s[8:11], 0 offen sc1
  s_waitcnt vmcnt(9)
  v_cmp_gt_u32 vcc, s53, v112
  s_cbranch_vccz bell_x_30
  s_nop 7
  buffer_load_dword v112, v10, s[8:11], 0 offen sc1
  s_waitcnt vmcnt(9)
  v_cmp_gt_u32 vcc, s53, v113
  s_cbranch_vccz bell_x_30
  s_nop 7
  buffer_load_dword v113, v10, s[8:11], 0 offen sc1
  s_waitcnt vmcnt(9)
  v_cmp_gt_u32 vcc, s53, v114
  s_cbranch_vccz bell_x_30
  s_nop 7
  buffer_load_dword v114, v10, s[8:11], 0 offen sc1
  s_waitcnt vmcnt(9)
  v_cmp_gt_u32 vcc, s53, v115
  s_cbranch_vccz bell_x_30
  s_nop 7
  buffer_load_dword v115, v10, s[8:11], 0 offen sc1
  s_waitcnt vmcnt(9)
  v_cmp_gt_u32 vcc, s53, v116
  s_cbranch_vccz bell_x_30
  s_nop 7
  buffer_load_dword v116, v10, s[8:11], 0 offen sc1
  s_waitcnt vmcnt(9)
  v_cmp_gt_u32 vcc, s53, v117
  s_cbranch_vccz bell_x_30
  s_nop 7
  buffer_load_dword v117, v10, s[8:11], 0 offen sc1
  s_waitcnt vmcnt(9)
  v_cmp_gt_u32 vcc, s53, v118
  s_cbranch_vccz bell_x_30
  s_nop 7
  buffer_load_dword v118, v10, s[8:11], 0 offen sc1
  s_waitcnt vmcnt(9)
  v_cmp_gt_u32 vcc, s53, v119
  s_cbranch_vccz bell_x_30
  s_nop 7
  buffer_load_dword v119, v10, s[8:11], 0 offen sc1
  s_waitcnt vmcnt(9)
  v_cmp_gt_u32 vcc, s53, v120
  s_cbranch_vccz bell_x_30
  s_nop 7
  buffer_load_dword v120, v10, s[8:11], 0 offen sc1
  s_waitcnt vmcnt(9)
  v_cmp_gt_u32 vcc, s53, v121
  s_cbranch_vccz bell_x_30
  s_add_u32 s50, s50, 1
  s_cmp_gt_u32 s50, 131072
  s_cbranch_scc1 L_fail
  s_branch bell_29
bell_x_30:
  s_mov_b64 exec, -1
sc_nobell:
  s_waitcnt lgkmcnt(0)
  s_barrier
  buffer_load_dwordx4 v[16:19], v1, s[8:11], s56 offen offset:0 sc1
  s_barrier
  buffer_load_dwordx4 v[20:23], v1, s[8:11], s56 offen offset:1024 sc1
  s_barrier
  buffer_load_dwordx4 v[24:27], v1, s[8:11], s56 offen offset:2048 sc1
  s_barrier
  buffer_load_dwordx4 v[28:31], v1, s[8:11], s56 offen offset:3072 sc1
  s_barrier
  buffer_load_dwordx4 v[32:35], v1, s[8:11], s59 offen offset:0 sc1
  s_barrier
  buffer_load_dwordx4 v[36:39], v1, s[8:11], s59 offen offset:1024 sc1
  s_barrier
  buffer_load_dwordx4 v[40:43], v1, s[8:11], s59 offen offset:2048 sc1
sc_go_31:
  s_waitcnt vmcnt(6)
  v_smfmac_f32_16x16x64_bf16 v[88:91], v[16:19], a[0:7], v7
  v_max3_u32 v12, v16, v17, v18
  v_max3_u32 v12, v18, v19, v12
  v_smfmac_f32_16x16x64_bf16 v[92:95], v[16:19], a[8:15], v7
  v_smfmac_f32_16x16x64_bf16 v[96:99], v[16:19], a[16:23], v7
  v_smfmac_f32_16x16x64_bf16 v[100:103], v[16:19], a[24:31], v7
  buffer_load_dwordx4 v[44:47], v1, s[8:11], s59 offen offset:3072 sc1
  s_waitcnt vmcnt(6)
  v_smfmac_f32_16x16x64_bf16 v[88:91], v[20:23], a[48:55], v7
  v_max3_u32 v12, v20, v21, v12
  v_max3_u32 v12, v22, v23, v12
  v_smfmac_f32_16x16x64_bf16 v[92:95], v[20:23], a[56:63], v7
  v_smfmac_f32_16x16x64_bf16 v[96:99], v[20:23], a[64:71], v7
  v_smfmac_f32_16x16x64_bf16 v[100:103], v[20:23], a[72:79], v7
  buffer_load_dwordx4 v[48:51], v1, s[8:11], s57 offen offset:0 sc1
  s_waitcnt vmcnt(6)
  v_smfmac_f32_16x16x64_bf16 v[88:91], v[24:27], v[56:63], v7
  v_max3_u32 v12, v24, v25, v12
  v_max3_u32 v12, v26, v27, v12
  v_smfmac_f32_16x16x64_bf16 v[92:95], v[24:27], v[64:71], v7
  v_smfmac_f32_16x16x64_bf16 v[96:99], v[24:27], v[72:79], v7
  v_smfmac_f32_16x16x64_bf16 v[100:103], v[24:27], a[96:103], v7
  buffer_load_dwordx4 v[52:55], v1, s[8:11], s57 offen offset:1024 sc1
  s_waitcnt vmcnt(6)
  v_smfmac_f32_16x16x64_bf16 v[88:91], v[28:31], a[120:127], v7
  v_max3_u32 v12, v28, v29, v12
  v_max3_u32 v12, v30, v31, v12
  ds_read_b128 v[56:59], v2 offset:49152
  ds_read_b128 v[60:63], v2 offset:53248
  v_smfmac_f32_16x16x64_bf16 v[92:95], v[28:31], a[128:135], v7
  ds_read_b128 v[64:67], v2 offset:57344
  ds_read_b128 v[68:71], v2 offset:61440
  v_smfmac_f32_16x16x64_bf16 v[96:99], v[28:31], a[136:143], v7
  ds_read_b128 v[72:75], v3 offset:0
  ds_read_b128 v[76:79], v3 offset:4096
  v_smfmac_f32_16x16x64_bf16 v[100:103], v[28:31], a[144:151], v7
  s_waitcnt vmcnt(5)
  v_smfmac_f32_16x16x64_bf16 v[88:91], v[32:35], a[168:175], v7
  v_max3_u32 v12, v32, v33, v12
  v_max3_u32 v12, v34, v35, v12
  v_smfmac_f32_16x16x64_bf16 v[92:95], v[32:35], a[176:183], v7
  v_smfmac_f32_16x16x64_bf16 v[96:99], v[32:35], a[184:191], v7
  v_smfmac_f32_16x16x64_bf16 v[100:103], v[32:35], v[80:87], v7
  ds_read_b128 v[80:83], v3 offset:8192
  ds_read_b128 v[84:87], v3 offset:12288
  s_waitcnt vmcnt(4)
  s_waitcnt lgkmcnt(2)
  v_smfmac_f32_16x16x64_bf16 v[88:91], v[36:39], v[56:63], v7
  v_max3_u32 v12, v36, v37, v12
  v_max3_u32 v12, v38, v39, v12
  v_smfmac_f32_16x16x64_bf16 v[92:95], v[36:39], v[64:71], v7
  v_smfmac_f32_16x16x64_bf16 v[96:99], v[36:39], v[72:79], v7
  v_smfmac_f32_16x16x64_bf16 v[100:103], v[36:39], a[192:199], v7
  s_waitcnt vmcnt(3)
  v_smfmac_f32_16x16x64_bf16 v[88:91], v[40:43], a[216:223], v7
  v_max3_u32 v12, v40, v41, v12
  v_max3_u32 v12, v42, v43, v12
  ds_read_b128 v[56:59], v3 offset:32768
  ds_read_b128 v[60:63], v3 offset:36864
  v_smfmac_f32_16x16x64_bf16 v[92:95], v[40:43], a[224:231], v7
  ds_read_b128 v[64:67], v3 offset:40960
  ds_read_b128 v[68:71], v3 offset:45056
  v_smfmac_f32_16x16x64_bf16 v[96:99], v[40:43], a[232:239], v7
  ds_read_b128 v[72:75], v3 offset:49152
  ds_read_b128 v[76:79], v3 offset:53248
  v_smfmac_f32_16x16x64_bf16 v[100:103], v[40:43], a[240:247], v7
  s_waitcnt vmcnt(2)
  s_waitcnt lgkmcnt(6)
  v_smfmac_f32_16x16x64_bf16 v[88:91], v[44:47], v[160:167], v7
  v_max3_u32 v12, v44, v45, v12
  v_max3_u32 v12, v46, v47, v12
  v_smfmac_f32_16x16x64_bf16 v[92:95], v[44:47], v[168:175], v7
  v_smfmac_f32_16x16x64_bf16 v[96:99], v[44:47], v[176:183], v7
  v_smfmac_f32_16x16x64_bf16 v[100:103], v[44:47], v[80:87], v7
  ds_read_b128 v[80:83], v2 offset:32768
  ds_read_b128 v[84:87], v2 offset:36864
  s_waitcnt vmcnt(1)
  s_waitcnt lgkmcnt(2)
  v_smfmac_f32_16x16x64_bf16 v[88:91], v[48:51], v[56:63], v7
  v_max3_u32 v12, v48, v49, v12
  v_max3_u32 v12, v50, v51, v12
  v_smfmac_f32_16x16x64_bf16 v[92:95], v[48:51], v[64:71], v7
  v_smfmac_f32_16x16x64_bf16 v[96:99], v[48:51], v[72:79], v7
  v_smfmac_f32_16x16x64_bf16 v[100:103], v[48:51], v[184:191], v7
  s_waitcnt vmcnt(0)
  v_smfmac_f32_16x16x64_bf16 v[88:91], v[52:55], v[208:215], v7
  v_max3_u32 v12, v52, v53, v12
  v_max3_u32 v12, v54, v55, v12
  ds_read_b128 v[56:59], v3 offset:16384
  ds_read_b128 v[60:63], v3 offset:20480
  v_smfmac_f32_16x16x64_bf16 v[92:95], v[52:55], v[216:223], v7
  ds_read_b128 v[64:67], v2 offset:40960
  ds_read_b128 v[68:71], v2 offset:45056
  v_smfmac_f32_16x16x64_bf16 v[96:99], v[52:55], v[224:231], v7
  ds_read_b128 v[72:75], v3 offset:24576
  ds_read_b128 v[76:79], v3 offset:28672
  v_smfmac_f32_16x16x64_bf16 v[100:103], v[52:55], v[232:239], v7
  v_cmp_eq_u32 vcc, -1, v12
  s_cbranch_vccnz sc_redo_32
sc_ok_33:
  v_smfmac_f32_16x16x64_bf16 v[104:107], v[16:19], a[32:39], v7
  v_smfmac_f32_16x16x64_bf16 v[104:107], v[20:23], a[80:87], v7
  v_cvt_pk_bf16_f32 v136, v88, v89
  v_cvt_pk_bf16_f32 v137, v90, v91
  v_smfmac_f32_16x16x64_bf16 v[104:107], v[24:27], a[104:111], v7
  ds_write_b64 v4, v[136:137] offset:0
  v_cvt_pk_bf16_f32 v138, v92, v93
  v_smfmac_f32_16x16x64_bf16 v[104:107], v[28:31], a[152:159], v7
  v_cvt_pk_bf16_f32 v139, v94, v95
  ds_write_b64 v4, v[138:139] offset:2048
  v_smfmac_f32_16x16x64_bf16 v[104:107], v[36:39], a[200:207], v7
  v_cvt_pk_bf16_f32 v140, v96, v97
  v_cvt_pk_bf16_f32 v141, v98, v99
  v_smfmac_f32_16x16x64_bf16 v[104:107], v[40:43], a[248:255], v7
  ds_write_b64 v4, v[140:141] offset:4096
  v_cvt_pk_bf16_f32 v142, v100, v101
  v_smfmac_f32_16x16x64_bf16 v[104:107], v[48:51], v[192:199], v7
  v_cvt_pk_bf16_f32 v143, v102, v103
  ds_write_b64 v4, v[142:143] offset:6144
  v_smfmac_f32_16x16x64_bf16 v[104:107], v[52:55], v[240:247], v7
  s_waitcnt lgkmcnt(1)
  s_barrier
  v_smfmac_f32_16x16x64_bf16 v[104:107], v[32:35], v[80:87], v7
  ds_read_b64_tr_b16 v[112:113], v5 offset:0
  ds_read_b64_tr_b16 v[114:115], v6 offset:0
  v_smfmac_f32_16x16x64_bf16 v[104:107], v[44:47], v[56:63], v7
  ds_read_b64_tr_b16 v[116:117], v5 offset:1024
  ds_read_b64_tr_b16 v[118:119], v6 offset:1024
  v_smfmac_f32_16x16x64_bf16 v[108:111], v[32:35], v[64:71], v7
  ds_read_b64_tr_b16 v[120:121], v5 offset:2048
  ds_read_b64_tr_b16 v[122:123], v6 offset:2048
  v_smfmac_f32_16x16x64_bf16 v[108:111], v[44:47], v[72:79], v7
  ds_read_b64_tr_b16 v[124:125], v5 offset:3072
  ds_read_b64_tr_b16 v[126:127], v6 offset:3072
  v_smfmac_f32_16x16x64_bf16 v[108:111], v[16:19], a[40:47], v7
  ds_read_b64_tr_b16 v[128:129], v5 offset:4096
  ds_read_b64_tr_b16 v[130:131], v6 offset:4096
  v_smfmac_f32_16x16x64_bf16 v[108:111], v[20:23], a[88:95], v7
  ds_read_b64_tr_b16 v[132:133], v5 offset:5120
  ds_read_b64_tr_b16 v[134:135], v6 offset:5120
  v_smfmac_f32_16x16x64_bf16 v[108:111], v[24:27], a[112:119], v7
  v_cvt_pk_bf16_f32 v136, v104, v105
  v_cvt_pk_bf16_f32 v137, v106, v107
  s_cmp_lg_u32 s67, 0
  s_cbranch_scc1 sc_noring
  v_mov_b32 v144, s53
  s_mov_b64 exec, 15
  buffer_store_dword v144, v11, s[8:11], 0 offen sc1
  s_mov_b64 exec, -1
sc_noring:
  v_smfmac_f32_16x16x64_bf16 v[108:111], v[28:31], a[160:167], v7
  ds_write_b64 v4, v[136:137] offset:8192
  ds_read_b128 v[56:59], v13 offset:0
  v_smfmac_f32_16x16x64_bf16 v[108:111], v[36:39], a[208:215], v7
  ds_read_b128 v[60:63], v13 offset:6144
  ds_read_b128 v[64:67], v13 offset:1024
  v_smfmac_f32_16x16x64_bf16 v[108:111], v[40:43], v[152:159], v7
  ds_read_b128 v[68:71], v13 offset:7168
  ds_read_b128 v[72:75], v13 offset:2048
  v_smfmac_f32_16x16x64_bf16 v[108:111], v[48:51], v[200:207], v7
  ds_read_b128 v[76:79], v13 offset:8192
  ds_read_b128 v[80:83], v13 offset:3072
  v_smfmac_f32_16x16x64_bf16 v[108:111], v[52:55], v[248:255], v7
  ds_read_b128 v[84:87], v13 offset:9216
  s_waitcnt lgkmcnt(0)
  v_mfma_f32_16x16x32_bf16 v[88:91], v[56:59], v[112:115], 0
  v_mfma_f32_16x16x32_bf16 v[92:95], v[60:63], v[112:115], 0
  v_mfma_f32_16x16x32_bf16 v[88:91], v[64:67], v[116:119], v[88:91]
  v_mfma_f32_16x16x32_bf16 v[92:95], v[68:71], v[116:119], v[92:95]
  ds_read_b128 v[56:59], v13 offset:4096
  ds_read_b128 v[60:63], v13 offset:10240
  ds_read_b128 v[64:67], v13 offset:5120
  ds_read_b128 v[68:71], v13 offset:11264
  v_cvt_pk_bf16_f32 v138, v108, v109
  v_cvt_pk_bf16_f32 v139, v110, v111
  ds_write_b64 v4, v[138:139] offset:10240
  v_mfma_f32_16x16x32_bf16 v[88:91], v[72:75], v[120:123], v[88:91]
  v_mfma_f32_16x16x32_bf16 v[92:95], v[76:79], v[120:123], v[92:95]
  v_mfma_f32_16x16x32_bf16 v[88:91], v[80:83], v[124:127], v[88:91]
  s_waitcnt lgkmcnt(0)
  s_barrier
  ds_read_b64_tr_b16 v[16:17], v5 offset:6144
  ds_read_b64_tr_b16 v[18:19], v6 offset:6144
  v_mfma_f32_16x16x32_bf16 v[92:95], v[84:87], v[124:127], v[92:95]
  ds_read_b64_tr_b16 v[20:21], v5 offset:7168
  ds_read_b64_tr_b16 v[22:23], v6 offset:7168
  v_mfma_f32_16x16x32_bf16 v[88:91], v[56:59], v[128:131], v[88:91]
  ds_read_b64_tr_b16 v[24:25], v5 offset:8192
  ds_read_b64_tr_b16 v[26:27], v6 offset:8192
  v_mfma_f32_16x16x32_bf16 v[92:95], v[60:63], v[128:131], v[92:95]
  ds_read_b64_tr_b16 v[28:29], v5 offset:9216
  ds_read_b64_tr_b16 v[30:31], v6 offset:9216
  v_mfma_f32_16x16x32_bf16 v[88:91], v[64:67], v[132:135], v[88:91]
  ds_read_b64_tr_b16 v[32:33], v5 offset:10240
  ds_read_b64_tr_b16 v[34:35], v6 offset:10240
  v_mfma_f32_16x16x32_bf16 v[92:95], v[68:71], v[132:135], v[92:95]
  ds_read_b64_tr_b16 v[36:37], v5 offset:11264
  ds_read_b64_tr_b16 v[38:39], v6 offset:11264
  s_waitcnt lgkmcnt(10)
  v_mfma_f32_16x16x32_bf16 v[96:99], v[16:19], v[112:115], 0
  s_waitcnt lgkmcnt(8)
  v_mfma_f32_16x16x32_bf16 v[96:99], v[20:23], v[116:119], v[96:99]
  s_waitcnt lgkmcnt(6)
  v_mfma_f32_16x16x32_bf16 v[96:99], v[24:27], v[120:123], v[96:99]
  s_waitcnt lgkmcnt(4)
  v_mfma_f32_16x16x32_bf16 v[96:99], v[28:31], v[124:127], v[96:99]
  s_waitcnt lgkmcnt(2)
  v_mfma_f32_16x16x32_bf16 v[96:99], v[32:35], v[128:131], v[96:99]
  v_add_f32_dpp v136, v88, v88 row_ror:8 row_mask:0xf bank_mask:3
  v_add_f32_dpp v137, v89, v89 row_ror:8 row_mask:0xf bank_mask:3
  s_waitcnt lgkmcnt(0)
  v_mfma_f32_16x16x32_bf16 v[96:99], v[36:39], v[132:135], v[96:99]
  v_add_f32_dpp v138, v92, v92 row_ror:8 row_mask:0xf bank_mask:3
  v_add_f32_dpp v139, v93, v93 row_ror:8 row_mask:0xf bank_mask:3
  v_add_f32_dpp v136, v90, v90 row_ror:8 row_mask:0xf bank_mask:12
  v_add_f32_dpp v137, v91, v91 row_ror:8 row_mask:0xf bank_mask:12
  v_add_f32_dpp v138, v94, v94 row_ror:8 row_mask:0xf bank_mask:12
  v_add_f32_dpp v139, v95, v95 row_ror:8 row_mask:0xf bank_mask:12
  v_max3_f32 v142, v136, v137, v138
  v_max_f32 v142, v142, v139
  v_permlane32_swap_b32 v96, v98
  v_permlane32_swap_b32 v97, v99
  v_max_f32_dpp v142, v142, v142 row_ror:8 row_mask:0xf bank_mask:0xf
  v_add_f32 v140, v96, v98
  v_add_f32 v141, v97, v99
  s_nop 0
  v_add_f32_dpp v140, v140, v140 row_ror:8 row_mask:0xf bank_mask:0xf
  v_add_f32_dpp v141, v141, v141 row_ror:8 row_mask:0xf bank_mask:0xf
  v_max3_f32 v142, v142, v140, v141
  v_mov_b32 v143, v142
  s_nop 1
  v_permlane16_swap_b32 v143, v142
  v_max_f32 v142, v142, v143
  v_mov_b32 v143, v142
  s_nop 1
  v_permlane32_swap_b32 v143, v142
  v_max_f32 v142, v142, v143
  v_mul_f32 v142, s69, v142
  v_fma_f32 v136, v136, s69, -v142
  v_fma_f32 v137, v137, s69, -v142
  v_fma_f32 v138, v138, s69, -v142
  v_fma_f32 v139, v139, s69, -v142
  v_fma_f32 v140, v140, s69, -v142
  v_fma_f32 v141, v141, s69, -v142
  v_exp_f32 v136, v136
  v_exp_f32 v137, v137
  v_exp_f32 v138, v138
  v_exp_f32 v139, v139
  v_exp_f32 v140, v140
  v_exp_f32 v141, v141
  v_add_f32 v142, v136, v137
  v_add_f32 v143, v138, v139
  v_add_f32 v142, v142, v143
  v_add_f32 v143, v140, v141
  s_nop 0
  v_add_f32_dpp v142, v142, v142 row_ror:8 row_mask:0xf bank_mask:0xf
  v_add_f32 v142, v142, v143
  v_mov_b32 v143, v142
  s_nop 1
  v_permlane16_swap_b32 v143, v142
  v_add_f32 v142, v142, v143
  v_mov_b32 v143, v142
  s_nop 1
  v_permlane32_swap_b32 v143, v142
  v_add_f32 v142, v142, v143
  v_rcp_f32 v142, v142
  s_nop 0
  v_mul_f32 v136, v136, v142
  v_mul_f32 v137, v137, v142
  v_mul_f32 v138, v138, v142
  v_mul_f32 v139, v139, v142
  v_mul_f32 v140, v140, v142
  v_mul_f32 v141, v141, v142
  v_cvt_pk_bf16_f32 v146, v136, v137
  v_cvt_pk_bf16_f32 v147, v138, v139
  v_cvt_pk_bf16_f32 v148, v140, v141
  v_min_u32 v146, s68, v146
  v_min_u32 v147, s68, v147
  v_min_u32 v148, s68, v148
  buffer_store_dwordx2 v[146:147], v8, s[8:11], s66 offen sc1
  buffer_store_dword v148, v9, s[8:11], s66 offen sc1
  v_mov_b32 v150, -1
  v_mov_b32 v151, -1
  buffer_store_dwordx2 v[150:151], v8, s[8:11], s65 offen sc1
  buffer_store_dword v150, v9, s[8:11], s65 offen sc1
  s_mov_b32 s65, s66
  s_cmp_ge_u32 s42, 2
  s_cbranch_scc1 sc_nox
  v_mov_b32 v136, s52
  s_mov_b64 exec, 1
  buffer_store_dword v136, v15, s[8:11], 0 offen sc1
  s_mov_b64 exec, -1
  s_mul_i32 s46, s42, 6144
  s_add_u32 s46, s46, 12288
  v_add_u32 v136, s46, v13
  ds_read_b128 v[112:115], v136 offset:0
  ds_read_b128 v[116:119], v136 offset:1024
  ds_read_b128 v[120:123], v136 offset:2048
  ds_read_b128 v[124:127], v136 offset:3072
  ds_read_b128 v[128:131], v136 offset:4096
  ds_read_b128 v[132:135], v136 offset:5120
  ds_read_b128 v[56:59], v13 offset:0
  ds_read_b128 v[60:63], v13 offset:6144
  ds_read_b128 v[64:67], v13 offset:1024
  ds_read_b128 v[68:71], v13 offset:7168
  ds_read_b128 v[72:75], v13 offset:2048
  ds_read_b128 v[76:79], v13 offset:8192
  ds_read_b128 v[80:83], v13 offset:3072
  ds_read_b128 v[84:87], v13 offset:9216
  s_waitcnt lgkmcnt(8)
  v_mfma_f32_16x16x32_bf16 v[96:99], v[16:19], v[112:115], 0
  v_mfma_f32_16x16x32_bf16 v[96:99], v[20:23], v[116:119], v[96:99]
  v_mfma_f32_16x16x32_bf16 v[96:99], v[24:27], v[120:123], v[96:99]
  v_mfma_f32_16x16x32_bf16 v[96:99], v[28:31], v[124:127], v[96:99]
  v_mfma_f32_16x16x32_bf16 v[96:99], v[32:35], v[128:131], v[96:99]
  v_mfma_f32_16x16x32_bf16 v[96:99], v[36:39], v[132:135], v[96:99]
  s_waitcnt lgkmcnt(0)
  v_mfma_f32_16x16x32_bf16 v[88:91], v[56:59], v[112:115], 0
  ds_read_b128 v[56:59], v13 offset:4096
  v_mfma_f32_16x16x32_bf16 v[92:95], v[60:63], v[112:115], 0
  ds_read_b128 v[60:63], v13 offset:10240
  v_mfma_f32_16x16x32_bf16 v[88:91], v[64:67], v[116:119], v[88:91]
  ds_read_b128 v[64:67], v13 offset:5120
  v_mfma_f32_16x16x32_bf16 v[92:95], v[68:71], v[116:119], v[92:95]
  ds_read_b128 v[68:71], v13 offset:11264
  v_mfma_f32_16x16x32_bf16 v[88:91], v[72:75], v[120:123], v[88:91]
  v_mfma_f32_16x16x32_bf16 v[92:95], v[76:79], v[120:123], v[92:95]
  v_mfma_f32_16x16x32_bf16 v[88:91], v[80:83], v[124:127], v[88:91]
  v_mfma_f32_16x16x32_bf16 v[92:95], v[84:87], v[124:127], v[92:95]
  s_waitcnt lgkmcnt(0)
  s_barrier
  v_mfma_f32_16x16x32_bf16 v[88:91], v[56:59], v[128:131], v[88:91]
  v_mfma_f32_16x16x32_bf16 v[92:95], v[60:63], v[128:131], v[92:95]
  v_mfma_f32_16x16x32_bf16 v[88:91], v[64:67], v[132:135], v[88:91]
  v_mfma_f32_16x16x32_bf16 v[92:95], v[68:71], v[132:135], v[92:95]
  v_permlane32_swap_b32 v96, v98
  v_permlane32_swap_b32 v97, v99
  v_add_f32 v96, v96, v98
  v_add_f32 v97, v97, v99
  v_mov_b32 v143, s70
  s_nop 1
  v_cndmask_b32 v88, v88, v143, s[72:73]
  v_cndmask_b32 v89, v89, v143, s[74:75]
  v_cndmask_b32 v90, v90, v143, s[76:77]
  v_cndmask_b32 v91, v91, v143, s[78:79]
  v_cndmask_b32 v92, v92, v143, s[80:81]
  v_cndmask_b32 v93, v93, v143, s[82:83]
  v_cndmask_b32 v94, v94, v143, s[84:85]
  v_cndmask_b32 v95, v95, v143, s[86:87]
  v_max_f32 v142, v88, v89
  v_max3_f32 v142, v142, v90, v91
  v_max3_f32 v142, v142, v92, v93
  v_max3_f32 v142, v142, v94, v95
  v_max3_f32 v142, v142, v96, v97
  v_mov_b32 v143, v142
  s_nop 1
  v_permlane16_swap_b32 v143, v142
  v_max_f32 v142, v142, v143
  v_mov_b32 v143, v142
  s_nop 1
  v_permlane32_swap_b32 v143, v142
  v_max_f32 v142, v142, v143
  v_mul_f32 v142, s69, v142
  v_fma_f32 v88, v88, s69, -v142
  v_fma_f32 v89, v89, s69, -v142
  v_fma_f32 v90, v90, s69, -v142
  v_fma_f32 v91, v91, s69, -v142
  v_fma_f32 v92, v92, s69, -v142
  v_fma_f32 v93, v93, s69, -v142
  v_fma_f32 v94, v94, s69, -v142
  v_fma_f32 v95, v95, s69, -v142
  v_fma_f32 v96, v96, s69, -v142
  v_fma_f32 v97, v97, s69, -v142
  v_exp_f32 v88, v88
  v_exp_f32 v89, v89
  v_exp_f32 v90, v90
  v_exp_f32 v91, v91
  v_exp_f32 v92, v92
  v_exp_f32 v93, v93
  v_exp_f32 v94, v94
  v_exp_f32 v95, v95
  v_exp_f32 v96, v96
  v_exp_f32 v97, v97
  v_add_f32 v142, v88, v89
  v_add_f32 v142, v142, v90
  v_add_f32 v142, v142, v91
  v_add_f32 v142, v142, v92
  v_add_f32 v142, v142, v93
  v_add_f32 v142, v142, v94
  v_add_f32 v142, v142, v95
  v_add_f32 v142, v142, v96
  v_add_f32 v142, v142, v97
  v_mov_b32 v143, v142
  s_nop 1
  v_permlane16_swap_b32 v143, v142
  v_add_f32 v142, v142, v143
  v_mov_b32 v143, v142
  s_nop 1
  v_permlane32_swap_b32 v143, v142
  v_add_f32 v142, v142, v143
  v_rcp_f32 v142, v142
  s_nop 0
  v_mul_f32 v88, v88, v142
  v_mul_f32 v89, v89, v142
  v_mul_f32 v90, v90, v142
  v_mul_f32 v91, v91, v142
  v_mul_f32 v92, v92, v142
  v_mul_f32 v93, v93, v142
  v_mul_f32 v94, v94, v142
  v_mul_f32 v95, v95, v142
  v_mul_f32 v96, v96, v142
  v_mul_f32 v97, v97, v142
  v_cvt_pk_bf16_f32 v144, v88, v89
  v_cvt_pk_bf16_f32 v145, v90, v91
  v_cvt_pk_bf16_f32 v146, v92, v93
  v_cvt_pk_bf16_f32 v147, v94, v95
  v_cvt_pk_bf16_f32 v148, v96, v97
  buffer_store_dwordx4 v[144:147], v1, s[8:11], s64 offen sc1
  buffer_store_dword v148, v14, s[8:11], s64 offen sc1
  s_add_u32 s64, s64, 81920
  s_branch sc_join
sc_nox:
  s_barrier
sc_join:
  s_add_u32 s58, s58, 1
  s_cmp_eq_u32 s58, 3
  s_cselect_b32 s58, 0, s58
  s_mov_b32 s52, s53
  s_cmp_lt_u32 s52, 64
  s_cbranch_scc1 sc_loop
  s_waitcnt vmcnt(0)
  s_cmp_ge_u32 s42, 2
  s_cbranch_scc1 sc_fin
  v_mov_b32 v136, s52
  s_mov_b64 exec, 1
  buffer_store_dword v136, v15, s[8:11], 0 offen sc1
  s_mov_b64 exec, -1
sc_fin:
  s_endpgm
sc_redo_32:
  s_mov_b32 s50, 0
  s_waitcnt lgkmcnt(0)
sc_poll_34:
  buffer_load_dwordx4 v[16:19], v1, s[8:11], s56 offen offset:0 sc1
  buffer_load_dwordx4 v[20:23], v1, s[8:11], s56 offen offset:1024 sc1
  buffer_load_dwordx4 v[24:27], v1, s[8:11], s56 offen offset:2048 sc1
  buffer_load_dwordx4 v[28:31], v1, s[8:11], s56 offen offset:3072 sc1
  buffer_load_dwordx4 v[32:35], v1, s[8:11], s59 offen offset:0 sc1
  buffer_load_dwordx4 v[36:39], v1, s[8:11], s59 offen offset:1024 sc1
  buffer_load_dwordx4 v[40:43], v1, s[8:11], s59 offen offset:2048 sc1
  buffer_load_dwordx4 v[44:47], v1, s[8:11], s59 offen offset:3072 sc1
  buffer_load_dwordx4 v[48:51], v1, s[8:11], s57 offen offset:0 sc1
  buffer_load_dwordx4 v[52:55], v1, s[8:11], s57 offen offset:1024 sc1
  s_add_u32 s50, s50, 1
  s_cmp_gt_u32 s50, 131072
  s_cbranch_scc1 L_fail
  s_waitcnt vmcnt(0)
  v_max_u32 v12, v16, v17
  v_max3_u32 v12, v18, v19, v12
  v_max3_u32 v12, v20, v21, v12
  v_max3_u32 v12, v22, v23, v12
  v_max3_u32 v12, v24, v25, v12
  v_max3_u32 v12, v26, v27, v12
  v_max3_u32 v12, v28, v29, v12
  v_max3_u32 v12, v30, v31, v12
  v_max3_u32 v12, v32, v33, v12
  v_max3_u32 v12, v34, v35, v12
  v_max3_u32 v12, v36, v37, v12
  v_max3_u32 v12, v38, v39, v12
  v_max3_u32 v12, v40, v41, v12
  v_max3_u32 v12, v42, v43, v12
  v_max3_u32 v12, v44, v45, v12
  v_max3_u32 v12, v46, v47, v12
  v_max3_u32 v12, v48, v49, v12
  v_max3_u32 v12, v50, v51, v12
  v_max3_u32 v12, v52, v53, v12
  v_max3_u32 v12, v54, v55, v12
  v_cmp_eq_u32 vcc, -1, v12
  s_cbranch_vccnz sc_poll_34
  ds_read_b128 v[56:59], v2 offset:0
  ds_read_b128 v[60:63], v2 offset:4096
  ds_read_b128 v[64:67], v2 offset:8192
  ds_read_b128 v[68:71], v2 offset:12288
  ds_read_b128 v[72:75], v2 offset:16384
  ds_read_b128 v[76:79], v2 offset:20480
  ds_read_b128 v[80:83], v2 offset:24576
  ds_read_b128 v[84:87], v2 offset:28672
  v_mov_b32 v88, 0
  v_mov_b32 v89, 0
  v_mov_b32 v90, 0
  v_mov_b32 v91, 0
  v_mov_b32 v92, 0
  v_mov_b32 v93, 0
  v_mov_b32 v94, 0
  v_mov_b32 v95, 0
  v_mov_b32 v96, 0
  v_mov_b32 v97, 0
  v_mov_b32 v98, 0
  v_mov_b32 v99, 0
  v_mov_b32 v100, 0
  v_mov_b32 v101, 0
  v_mov_b32 v102, 0
  v_mov_b32 v103, 0
  v_mov_b32 v104, 0
  v_mov_b32 v105, 0
  v_mov_b32 v106, 0
  v_mov_b32 v107, 0
  v_mov_b32 v108, 0
  v_mov_b32 v109, 0
  v_mov_b32 v110, 0
  v_mov_b32 v111, 0
  s_waitcnt lgkmcnt(0)
  s_branch sc_go_31
L_value:
  s_mov_b32 s4, s30
  s_mov_b32 s5, s31
  s_mov_b32 s6, 7864320
  s_mov_b32 s7, 0x20000
  s_mov_b32 s12, s32
  s_mov_b32 s13, s33
  s_mov_b32 s14, 7864320
  s_mov_b32 s15, 0x20000
  v_lshrrev_b32 v148, 3, v0
  v_lshrrev_b32 v149, 2, v148
  v_lshlrev_b32 v149, 3, v149
  v_and_b32 v64, 3, v148
  v_add_u32 v64, v64, v149
  s_and_b32 s46, s42, 1
  s_lshl_b32 s46, s46, 2
  s_lshr_b32 s47, s42, 1
  s_lshl_b32 s47, s47, 4
  s_add_u32 s46, s46, s47
  v_add_u32 v64, s46, v64
  v_mul_u32_u24 v64, 12288, v64
  v_lshrrev_b32 v148, 1, v148
  v_bfe_u32 v149, v0, 1, 2
  v_xor_b32 v148, v148, v149
  v_lshlrev_b32 v148, 5, v148
  v_and_b32 v149, 1, v0
  v_lshlrev_b32 v149, 4, v149
  v_add3_u32 v64, v64, v148, v149
  v_lshrrev_b32 v148, 3, v0
  v_lshrrev_b32 v149, 2, v148
  v_lshlrev_b32 v149, 3, v149
  v_and_b32 v65, 3, v148
  v_add_u32 v65, v65, v149
  s_and_b32 s46, s42, 1
  s_lshl_b32 s46, s46, 2
  s_lshr_b32 s47, s42, 1
  s_lshl_b32 s47, s47, 4
  s_add_u32 s46, s46, s47
  v_add_u32 v65, s46, v65
  v_mul_u32_u24 v65, 1280, v65
  v_lshrrev_b32 v148, 1, v148
  v_bfe_u32 v149, v0, 1, 2
  v_xor_b32 v148, v148, v149
  v_lshlrev_b32 v148, 5, v148
  v_and_b32 v149, 1, v0
  v_lshlrev_b32 v149, 4, v149
  v_add3_u32 v65, v65, v148, v149
  v_lshrrev_b32 v148, 5, v0
  v_lshlrev_b32 v66, 11, v148
  v_bfe_u32 v148, v0, 2, 3
  v_lshl_add_u32 v66, v148, 7, v66
  v_lshrrev_b32 v148, 1, v148
  v_xor_b32 v148, s42, v148
  v_lshl_add_u32 v66, v148, 5, v66
  v_and_b32 v148, 3, v0
  v_lshl_add_u32 v66, v148, 3, v66
  v_add_u32 v67, 0x10000, v66
  v_add_u32 v68, 0x20000, v66
  v_lshlrev_b32 v1, 4, v0
  v_add_u32 v2, s51, v1
  v_add_u32 v3, 0x10000, v2
  s_mul_i32 s62, s45, 384
  s_mul_i32 s63, s45, 245760
  s_add_u32 m0, s51, 73728
  s_add_u32 s46, s63, 0
  buffer_load_dwordx4 v65, s[12:15], s46 offen lds
  s_add_u32 m0, s51, 77824
  s_add_u32 s46, s63, 128
  buffer_load_dwordx4 v65, s[12:15], s46 offen lds
  s_add_u32 m0, s51, 81920
  s_add_u32 s46, s63, 256
  buffer_load_dwordx4 v65, s[12:15], s46 offen lds
  s_add_u32 m0, s51, 86016
  s_add_u32 s46, s63, 384
  buffer_load_dwordx4 v65, s[12:15], s46 offen lds
  s_add_u32 m0, s51, 90112
  s_add_u32 s46, s63, 512
  buffer_load_dwordx4 v65, s[12:15], s46 offen lds
  s_add_u32 m0, s51, 94208
  s_add_u32 s46, s63, 640
  buffer_load_dwordx4 v65, s[12:15], s46 offen lds
  s_add_u32 m0, s51, 98304
  s_add_u32 s46, s63, 768
  buffer_load_dwordx4 v65, s[12:15], s46 offen lds
  s_add_u32 m0, s51, 102400
  s_add_u32 s46, s63, 896
  buffer_load_dwordx4 v65, s[12:15], s46 offen lds
  s_add_u32 m0, s51, 106496
  s_add_u32 s46, s63, 1024
  buffer_load_dwordx4 v65, s[12:15], s46 offen lds
  s_add_u32 m0, s51, 110592
  s_add_u32 s46, s63, 1152
  buffer_load_dwordx4 v65, s[12:15], s46 offen lds
  s_add_u32 m0, s51, 114688
  s_add_u32 s46, s63, 40960
  buffer_load_dwordx4 v65, s[12:15], s46 offen lds
  s_add_u32 m0, s51, 118784
  s_add_u32 s46, s63, 41088
  buffer_load_dwordx4 v65, s[12:15], s46 offen lds
  s_add_u32 m0, s51, 122880
  s_add_u32 s46, s63, 41216
  buffer_load_dwordx4 v65, s[12:15], s46 offen lds
  s_add_u32 m0, s51, 126976
  s_add_u32 s46, s63, 41344
  buffer_load_dwordx4 v65, s[12:15], s46 offen lds
  s_add_u32 m0, s51, 131072
  s_add_u32 s46, s63, 41472
  buffer_load_dwordx4 v65, s[12:15], s46 offen lds
  s_add_u32 m0, s51, 135168
  s_add_u32 s46, s63, 41600
  buffer_load_dwordx4 v65, s[12:15], s46 offen lds
  s_add_u32 m0, s51, 139264
  s_add_u32 s46, s63, 41728
  buffer_load_dwordx4 v65, s[12:15], s46 offen lds
  s_add_u32 m0, s51, 143360
  s_add_u32 s46, s63, 41856
  buffer_load_dwordx4 v65, s[12:15], s46 offen lds
  s_add_u32 m0, s51, 0
  s_add_u32 s46, s63, 41984
  buffer_load_dwordx4 v65, s[12:15], s46 offen lds
  s_add_u32 m0, s51, 4096
  s_add_u32 s46, s63, 42112
  buffer_load_dwordx4 v65, s[12:15], s46 offen lds
  s_add_u32 m0, s51, 8192
  s_add_u32 s46, s63, 81920
  buffer_load_dwordx4 v65, s[12:15], s46 offen lds
  s_add_u32 m0, s51, 12288
  s_add_u32 s46, s63, 82048
  buffer_load_dwordx4 v65, s[12:15], s46 offen lds
  s_add_u32 m0, s51, 16384
  s_add_u32 s46, s63, 82176
  buffer_load_dwordx4 v65, s[12:15], s46 offen lds
  s_add_u32 m0, s51, 20480
  s_add_u32 s46, s63, 82304
  buffer_load_dwordx4 v65, s[12:15], s46 offen lds
  s_add_u32 m0, s51, 24576
  s_add_u32 s46, s63, 82432
  buffer_load_dwordx4 v65, s[12:15], s46 offen lds
  s_add_u32 m0, s51, 28672
  s_add_u32 s46, s63, 82560
  buffer_load_dwordx4 v65, s[12:15], s46 offen lds
  s_add_u32 m0, s51, 32768
  s_add_u32 s46, s63, 82688
  buffer_load_dwordx4 v65, s[12:15], s46 offen lds
  s_add_u32 m0, s51, 36864
  s_add_u32 s46, s63, 82816
  buffer_load_dwordx4 v65, s[12:15], s46 offen lds
  s_add_u32 m0, s51, 40960
  s_add_u32 s46, s63, 82944
  buffer_load_dwordx4 v65, s[12:15], s46 offen lds
  s_add_u32 m0, s51, 45056
  s_add_u32 s46, s63, 83072
  buffer_load_dwordx4 v65, s[12:15], s46 offen lds
  s_waitcnt vmcnt(24)
  s_barrier
  s_add_u32 m0, s51, 49152
  s_add_u32 s46, s63, 122880
  buffer_load_dwordx4 v65, s[12:15], s46 offen lds
  s_add_u32 m0, s51, 53248
  s_add_u32 s46, s63, 123008
  buffer_load_dwordx4 v65, s[12:15], s46 offen lds
  s_add_u32 m0, s51, 57344
  s_add_u32 s46, s63, 123136
  buffer_load_dwordx4 v65, s[12:15], s46 offen lds
  s_add_u32 m0, s51, 61440
  s_add_u32 s46, s63, 123264
  buffer_load_dwordx4 v65, s[12:15], s46 offen lds
  s_add_u32 m0, s51, 65536
  s_add_u32 s46, s63, 123392
  buffer_load_dwordx4 v65, s[12:15], s46 offen lds
  s_add_u32 m0, s51, 69632
  s_add_u32 s46, s63, 123520
  buffer_load_dwordx4 v65, s[12:15], s46 offen lds
  ds_read_b64_tr_b16 a[0:1], v67 offset:8192
  ds_read_b64_tr_b16 a[2:3], v67 offset:9216
  ds_read_b64_tr_b16 a[24:25], v67 offset:12288
  ds_read_b64_tr_b16 a[26:27], v67 offset:13312
  ds_read_b64_tr_b16 a[48:49], v67 offset:16384
  ds_read_b64_tr_b16 a[50:51], v67 offset:17408
  ds_read_b64_tr_b16 a[72:73], v67 offset:20480
  ds_read_b64_tr_b16 a[74:75], v67 offset:21504
  ds_read_b64_tr_b16 a[96:97], v67 offset:24576
  ds_read_b64_tr_b16 a[98:99], v67 offset:25600
  ds_read_b64_tr_b16 a[120:121], v67 offset:28672
  ds_read_b64_tr_b16 a[122:123], v67 offset:29696
  s_waitcnt lgkmcnt(0)
  s_waitcnt vmcnt(24)
  s_barrier
  s_add_u32 m0, s51, 73728
  s_add_u32 s46, s63, 123648
  buffer_load_dwordx4 v65, s[12:15], s46 offen lds
  s_add_u32 m0, s51, 77824
  s_add_u32 s46, s63, 123776
  buffer_load_dwordx4 v65, s[12:15], s46 offen lds
  s_add_u32 m0, s51, 81920
  s_add_u32 s46, s63, 123904
  buffer_load_dwordx4 v65, s[12:15], s46 offen lds
  s_add_u32 m0, s51, 86016
  s_add_u32 s46, s63, 124032
  buffer_load_dwordx4 v65, s[12:15], s46 offen lds
  s_add_u32 m0, s51, 90112
  s_add_u32 s46, s63, 163840
  buffer_load_dwordx4 v65, s[12:15], s46 offen lds
  s_add_u32 m0, s51, 94208
  s_add_u32 s46, s63, 163968
  buffer_load_dwordx4 v65, s[12:15], s46 offen lds
  ds_read_b64_tr_b16 a[144:145], v67 offset:32768
  ds_read_b64_tr_b16 a[146:147], v67 offset:33792
  ds_read_b64_tr_b16 a[168:169], v67 offset:36864
  ds_read_b64_tr_b16 a[170:171], v67 offset:37888
  ds_read_b64_tr_b16 a[192:193], v67 offset:40960
  ds_read_b64_tr_b16 a[194:195], v67 offset:41984
  ds_read_b64_tr_b16 a[216:217], v67 offset:45056
  ds_read_b64_tr_b16 a[218:219], v67 offset:46080
  ds_read_b64_tr_b16 a[4:5], v67 offset:49152
  ds_read_b64_tr_b16 a[6:7], v67 offset:50176
  ds_read_b64_tr_b16 a[28:29], v67 offset:53248
  ds_read_b64_tr_b16 a[30:31], v67 offset:54272
  s_waitcnt lgkmcnt(0)
  s_waitcnt vmcnt(24)
  s_barrier
  s_add_u32 m0, s51, 98304
  s_add_u32 s46, s63, 164096
  buffer_load_dwordx4 v65, s[12:15], s46 offen lds
  s_add_u32 m0, s51, 102400
  s_add_u32 s46, s63, 164224
  buffer_load_dwordx4 v65, s[12:15], s46 offen lds
  s_add_u32 m0, s51, 106496
  s_add_u32 s46, s63, 164352
  buffer_load_dwordx4 v65, s[12:15], s46 offen lds
  s_add_u32 m0, s51, 110592
  s_add_u32 s46, s63, 164480
  buffer_load_dwordx4 v65, s[12:15], s46 offen lds
  s_add_u32 m0, s51, 114688
  s_add_u32 s46, s63, 164608
  buffer_load_dwordx4 v65, s[12:15], s46 offen lds
  s_add_u32 m0, s51, 118784
  s_add_u32 s46, s63, 164736
  buffer_load_dwordx4 v65, s[12:15], s46 offen lds
  ds_read_b64_tr_b16 a[52:53], v67 offset:57344
  ds_read_b64_tr_b16 a[54:55], v67 offset:58368
  ds_read_b64_tr_b16 a[76:77], v67 offset:61440
  ds_read_b64_tr_b16 a[78:79], v67 offset:62464
  ds_read_b64_tr_b16 a[100:101], v68 offset:0
  ds_read_b64_tr_b16 a[102:103], v68 offset:1024
  ds_read_b64_tr_b16 a[124:125], v68 offset:4096
  ds_read_b64_tr_b16 a[126:127], v68 offset:5120
  ds_read_b64_tr_b16 a[148:149], v68 offset:8192
  ds_read_b64_tr_b16 a[150:151], v68 offset:9216
  ds_read_b64_tr_b16 a[172:173], v68 offset:12288
  ds_read_b64_tr_b16 a[174:175], v68 offset:13312
  s_waitcnt lgkmcnt(0)
  s_waitcnt vmcnt(24)
  s_barrier
  s_add_u32 m0, s51, 122880
  s_add_u32 s46, s63, 164864
  buffer_load_dwordx4 v65, s[12:15], s46 offen lds
  s_add_u32 m0, s51, 126976
  s_add_u32 s46, s63, 164992
  buffer_load_dwordx4 v65, s[12:15], s46 offen lds
  s_add_u32 m0, s51, 131072
  s_add_u32 s46, s63, 204800
  buffer_load_dwordx4 v65, s[12:15], s46 offen lds
  s_add_u32 m0, s51, 135168
  s_add_u32 s46, s63, 204928
  buffer_load_dwordx4 v65, s[12:15], s46 offen lds
  s_add_u32 m0, s51, 139264
  s_add_u32 s46, s63, 205056
  buffer_load_dwordx4 v65, s[12:15], s46 offen lds
  s_add_u32 m0, s51, 143360
  s_add_u32 s46, s63, 205184
  buffer_load_dwordx4 v65, s[12:15], s46 offen lds
  ds_read_b64_tr_b16 a[196:197], v66 offset:0
  ds_read_b64_tr_b16 a[198:199], v66 offset:1024
  ds_read_b64_tr_b16 a[220:221], v66 offset:4096
  ds_read_b64_tr_b16 a[222:223], v66 offset:5120
  ds_read_b64_tr_b16 a[8:9], v66 offset:8192
  ds_read_b64_tr_b16 a[10:11], v66 offset:9216
  ds_read_b64_tr_b16 a[32:33], v66 offset:12288
  ds_read_b64_tr_b16 a[34:35], v66 offset:13312
  ds_read_b64_tr_b16 a[56:57], v66 offset:16384
  ds_read_b64_tr_b16 a[58:59], v66 offset:17408
  ds_read_b64_tr_b16 a[80:81], v66 offset:20480
  ds_read_b64_tr_b16 a[82:83], v66 offset:21504
  s_waitcnt lgkmcnt(0)
  s_waitcnt vmcnt(24)
  s_barrier
  s_add_u32 m0, s51, 0
  s_add_u32 s46, s63, 205312
  buffer_load_dwordx4 v65, s[12:15], s46 offen lds
  s_add_u32 m0, s51, 4096
  s_add_u32 s46, s63, 205440
  buffer_load_dwordx4 v65, s[12:15], s46 offen lds
  s_add_u32 m0, s51, 8192
  s_add_u32 s46, s63, 205568
  buffer_load_dwordx4 v65, s[12:15], s46 offen lds
  s_add_u32 m0, s51, 12288
  s_add_u32 s46, s63, 205696
  buffer_load_dwordx4 v65, s[12:15], s46 offen lds
  s_add_u32 m0, s51, 16384
  s_add_u32 s46, s63, 205824
  buffer_load_dwordx4 v65, s[12:15], s46 offen lds
  s_add_u32 m0, s51, 20480
  s_add_u32 s46, s63, 205952
  buffer_load_dwordx4 v65, s[12:15], s46 offen lds
  ds_read_b64_tr_b16 a[104:105], v66 offset:24576
  ds_read_b64_tr_b16 a[106:107], v66 offset:25600
  ds_read_b64_tr_b16 a[128:129], v66 offset:28672
  ds_read_b64_tr_b16 a[130:131], v66 offset:29696
  ds_read_b64_tr_b16 a[152:153], v66 offset:32768
  ds_read_b64_tr_b16 a[154:155], v66 offset:33792
  ds_read_b64_tr_b16 a[176:177], v66 offset:36864
  ds_read_b64_tr_b16 a[178:179], v66 offset:37888
  ds_read_b64_tr_b16 a[200:201], v66 offset:40960
  ds_read_b64_tr_b16 a[202:203], v66 offset:41984
  ds_read_b64_tr_b16 a[224:225], v66 offset:45056
  ds_read_b64_tr_b16 a[226:227], v66 offset:46080
  s_waitcnt lgkmcnt(0)
  s_waitcnt vmcnt(24)
  s_barrier
  s_add_u32 m0, s51, 24576
  s_add_u32 s46, s62, 0
  buffer_load_dwordx4 v64, s[4:7], s46 offen lds
  s_add_u32 m0, s51, 28672
  s_add_u32 s46, s62, 393216
  buffer_load_dwordx4 v64, s[4:7], s46 offen lds
  s_add_u32 m0, s51, 32768
  s_add_u32 s46, s62, 128
  buffer_load_dwordx4 v64, s[4:7], s46 offen lds
  s_add_u32 m0, s51, 36864
  s_add_u32 s46, s62, 393344
  buffer_load_dwordx4 v64, s[4:7], s46 offen lds
  s_add_u32 m0, s51, 40960
  s_add_u32 s46, s62, 256
  buffer_load_dwordx4 v64, s[4:7], s46 offen lds
  s_add_u32 m0, s51, 45056
  s_add_u32 s46, s62, 393472
  buffer_load_dwordx4 v64, s[4:7], s46 offen lds
  ds_read_b64_tr_b16 a[12:13], v66 offset:49152
  ds_read_b64_tr_b16 a[14:15], v66 offset:50176
  ds_read_b64_tr_b16 a[36:37], v66 offset:53248
  ds_read_b64_tr_b16 a[38:39], v66 offset:54272
  ds_read_b64_tr_b16 a[60:61], v66 offset:57344
  ds_read_b64_tr_b16 a[62:63], v66 offset:58368
  ds_read_b64_tr_b16 a[84:85], v66 offset:61440
  ds_read_b64_tr_b16 a[86:87], v66 offset:62464
  ds_read_b64_tr_b16 a[108:109], v67 offset:0
  ds_read_b64_tr_b16 a[110:111], v67 offset:1024
  ds_read_b64_tr_b16 a[132:133], v67 offset:4096
  ds_read_b64_tr_b16 a[134:135], v67 offset:5120
  s_waitcnt lgkmcnt(0)
  s_waitcnt vmcnt(24)
  s_barrier
  s_add_u32 m0, s51, 49152
  s_add_u32 s46, s62, 1572864
  buffer_load_dwordx4 v64, s[4:7], s46 offen lds
  s_add_u32 m0, s51, 53248
  s_add_u32 s46, s62, 1966080
  buffer_load_dwordx4 v64, s[4:7], s46 offen lds
  s_add_u32 m0, s51, 57344
  s_add_u32 s46, s62, 1572992
  buffer_load_dwordx4 v64, s[4:7], s46 offen lds
  s_add_u32 m0, s51, 61440
  s_add_u32 s46, s62, 1966208
  buffer_load_dwordx4 v64, s[4:7], s46 offen lds
  s_add_u32 m0, s51, 65536
  s_add_u32 s46, s62, 1573120
  buffer_load_dwordx4 v64, s[4:7], s46 offen lds
  s_add_u32 m0, s51, 69632
  s_add_u32 s46, s62, 1966336
  buffer_load_dwordx4 v64, s[4:7], s46 offen lds
  ds_read_b64_tr_b16 a[156:157], v67 offset:8192
  ds_read_b64_tr_b16 a[158:159], v67 offset:9216
  ds_read_b64_tr_b16 a[180:181], v67 offset:12288
  ds_read_b64_tr_b16 a[182:183], v67 offset:13312
  ds_read_b64_tr_b16 a[204:205], v67 offset:16384
  ds_read_b64_tr_b16 a[206:207], v67 offset:17408
  ds_read_b64_tr_b16 a[228:229], v67 offset:20480
  ds_read_b64_tr_b16 a[230:231], v67 offset:21504
  ds_read_b64_tr_b16 a[16:17], v67 offset:24576
  ds_read_b64_tr_b16 a[18:19], v67 offset:25600
  ds_read_b64_tr_b16 a[40:41], v67 offset:28672
  ds_read_b64_tr_b16 a[42:43], v67 offset:29696
  s_waitcnt lgkmcnt(0)
  s_waitcnt vmcnt(24)
  s_barrier
  s_add_u32 m0, s51, 73728
  s_add_u32 s46, s62, 3145728
  buffer_load_dwordx4 v64, s[4:7], s46 offen lds
  s_add_u32 m0, s51, 77824
  s_add_u32 s46, s62, 3538944
  buffer_load_dwordx4 v64, s[4:7], s46 offen lds
  s_add_u32 m0, s51, 81920
  s_add_u32 s46, s62, 3145856
  buffer_load_dwordx4 v64, s[4:7], s46 offen lds
  s_add_u32 m0, s51, 86016
  s_add_u32 s46, s62, 3539072
  buffer_load_dwordx4 v64, s[4:7], s46 offen lds
  s_add_u32 m0, s51, 90112
  s_add_u32 s46, s62, 3145984
  buffer_load_dwordx4 v64, s[4:7], s46 offen lds
  s_add_u32 m0, s51, 94208
  s_add_u32 s46, s62, 3539200
  buffer_load_dwordx4 v64, s[4:7], s46 offen lds
  ds_read_b64_tr_b16 a[64:65], v67 offset:32768
  ds_read_b64_tr_b16 a[66:67], v67 offset:33792
  ds_read_b64_tr_b16 a[88:89], v67 offset:36864
  ds_read_b64_tr_b16 a[90:91], v67 offset:37888
  ds_read_b64_tr_b16 a[112:113], v67 offset:40960
  ds_read_b64_tr_b16 a[114:115], v67 offset:41984
  ds_read_b64_tr_b16 a[136:137], v67 offset:45056
  ds_read_b64_tr_b16 a[138:139], v67 offset:46080
  ds_read_b64_tr_b16 a[160:161], v67 offset:49152
  ds_read_b64_tr_b16 a[162:163], v67 offset:50176
  ds_read_b64_tr_b16 a[184:185], v67 offset:53248
  ds_read_b64_tr_b16 a[186:187], v67 offset:54272
  s_waitcnt lgkmcnt(0)
  s_waitcnt vmcnt(24)
  s_barrier
  s_add_u32 m0, s51, 98304
  s_add_u32 s46, s62, 4718592
  buffer_load_dwordx4 v64, s[4:7], s46 offen lds
  s_add_u32 m0, s51, 102400
  s_add_u32 s46, s62, 5111808
  buffer_load_dwordx4 v64, s[4:7], s46 offen lds
  s_add_u32 m0, s51, 106496
  s_add_u32 s46, s62, 4718720
  buffer_load_dwordx4 v64, s[4:7], s46 offen lds
  s_add_u32 m0, s51, 110592
  s_add_u32 s46, s62, 5111936
  buffer_load_dwordx4 v64, s[4:7], s46 offen lds
  s_add_u32 m0, s51, 114688
  s_add_u32 s46, s62, 4718848
  buffer_load_dwordx4 v64, s[4:7], s46 offen lds
  s_add_u32 m0, s51, 118784
  s_add_u32 s46, s62, 5112064
  buffer_load_dwordx4 v64, s[4:7], s46 offen lds
  ds_read_b64_tr_b16 a[208:209], v67 offset:57344
  ds_read_b64_tr_b16 a[210:211], v67 offset:58368
  ds_read_b64_tr_b16 a[232:233], v67 offset:61440
  ds_read_b64_tr_b16 a[234:235], v67 offset:62464
  ds_read_b64_tr_b16 a[20:21], v68 offset:0
  ds_read_b64_tr_b16 a[22:23], v68 offset:1024
  ds_read_b64_tr_b16 a[44:45], v68 offset:4096
  ds_read_b64_tr_b16 a[46:47], v68 offset:5120
  ds_read_b64_tr_b16 a[68:69], v68 offset:8192
  ds_read_b64_tr_b16 a[70:71], v68 offset:9216
  ds_read_b64_tr_b16 a[92:93], v68 offset:12288
  ds_read_b64_tr_b16 a[94:95], v68 offset:13312
  s_waitcnt lgkmcnt(0)
  s_waitcnt vmcnt(24)
  s_barrier
  s_add_u32 m0, s51, 122880
  s_add_u32 s46, s62, 6291456
  buffer_load_dwordx4 v64, s[4:7], s46 offen lds
  s_add_u32 m0, s51, 126976
  s_add_u32 s46, s62, 6684672
  buffer_load_dwordx4 v64, s[4:7], s46 offen lds
  s_add_u32 m0, s51, 131072
  s_add_u32 s46, s62, 6291584
  buffer_load_dwordx4 v64, s[4:7], s46 offen lds
  s_add_u32 m0, s51, 135168
  s_add_u32 s46, s62, 6684800
  buffer_load_dwordx4 v64, s[4:7], s46 offen lds
  s_add_u32 m0, s51, 139264
  s_add_u32 s46, s62, 6291712
  buffer_load_dwordx4 v64, s[4:7], s46 offen lds
  s_add_u32 m0, s51, 143360
  s_add_u32 s46, s62, 6684928
  buffer_load_dwordx4 v64, s[4:7], s46 offen lds
  ds_read_b64_tr_b16 a[116:117], v66 offset:0
  ds_read_b64_tr_b16 a[118:119], v66 offset:1024
  ds_read_b64_tr_b16 a[140:141], v66 offset:4096
  ds_read_b64_tr_b16 a[142:143], v66 offset:5120
  ds_read_b64_tr_b16 a[164:165], v66 offset:8192
  ds_read_b64_tr_b16 a[166:167], v66 offset:9216
  ds_read_b64_tr_b16 a[188:189], v66 offset:12288
  ds_read_b64_tr_b16 a[190:191], v66 offset:13312
  ds_read_b64_tr_b16 a[212:213], v66 offset:16384
  ds_read_b64_tr_b16 a[214:215], v66 offset:17408
  ds_read_b64_tr_b16 a[236:237], v66 offset:20480
  ds_read_b64_tr_b16 a[238:239], v66 offset:21504
  s_waitcnt lgkmcnt(0)
  s_waitcnt vmcnt(24)
  s_barrier
  s_add_u32 m0, s51, 0
  s_add_u32 s46, s62, 786432
  buffer_load_dwordx4 v64, s[4:7], s46 offen lds
  s_add_u32 m0, s51, 4096
  s_add_u32 s46, s62, 1179648
  buffer_load_dwordx4 v64, s[4:7], s46 offen lds
  s_add_u32 m0, s51, 8192
  s_add_u32 s46, s62, 786560
  buffer_load_dwordx4 v64, s[4:7], s46 offen lds
  s_add_u32 m0, s51, 12288
  s_add_u32 s46, s62, 1179776
  buffer_load_dwordx4 v64, s[4:7], s46 offen lds
  s_add_u32 m0, s51, 16384
  s_add_u32 s46, s62, 786688
  buffer_load_dwordx4 v64, s[4:7], s46 offen lds
  s_add_u32 m0, s51, 20480
  s_add_u32 s46, s62, 1179904
  buffer_load_dwordx4 v64, s[4:7], s46 offen lds
  ds_read_b64_tr_b16 a[240:241], v66 offset:24576
  ds_read_b64_tr_b16 a[242:243], v66 offset:25600
  ds_read_b64_tr_b16 a[244:245], v66 offset:28672
  ds_read_b64_tr_b16 a[246:247], v66 offset:29696
  ds_read_b64_tr_b16 a[248:249], v66 offset:32768
  ds_read_b64_tr_b16 a[250:251], v66 offset:33792
  ds_read_b64_tr_b16 a[252:253], v66 offset:36864
  ds_read_b64_tr_b16 a[254:255], v66 offset:37888
  ds_read_b64_tr_b16 v[152:153], v66 offset:40960
  ds_read_b64_tr_b16 v[154:155], v66 offset:41984
  ds_read_b64_tr_b16 v[156:157], v66 offset:45056
  ds_read_b64_tr_b16 v[158:159], v66 offset:46080
  s_waitcnt lgkmcnt(0)
  s_waitcnt vmcnt(24)
  s_barrier
  s_add_u32 m0, s51, 24576
  s_add_u32 s46, s62, 2359296
  buffer_load_dwordx4 v64, s[4:7], s46 offen lds
  s_add_u32 m0, s51, 28672
  s_add_u32 s46, s62, 2752512
  buffer_load_dwordx4 v64, s[4:7], s46 offen lds
  s_add_u32 m0, s51, 32768
  s_add_u32 s46, s62, 2359424
  buffer_load_dwordx4 v64, s[4:7], s46 offen lds
  s_add_u32 m0, s51, 36864
  s_add_u32 s46, s62, 2752640
  buffer_load_dwordx4 v64, s[4:7], s46 offen lds
  s_add_u32 m0, s51, 40960
  s_add_u32 s46, s62, 2359552
  buffer_load_dwordx4 v64, s[4:7], s46 offen lds
  s_add_u32 m0, s51, 45056
  s_add_u32 s46, s62, 2752768
  buffer_load_dwordx4 v64, s[4:7], s46 offen lds
  ds_read_b64_tr_b16 v[160:161], v66 offset:49152
  ds_read_b64_tr_b16 v[162:163], v66 offset:50176
  ds_read_b64_tr_b16 v[164:165], v66 offset:53248
  ds_read_b64_tr_b16 v[166:167], v66 offset:54272
  ds_read_b64_tr_b16 v[168:169], v66 offset:57344
  ds_read_b64_tr_b16 v[170:171], v66 offset:58368
  ds_read_b64_tr_b16 v[172:173], v66 offset:61440
  ds_read_b64_tr_b16 v[174:175], v66 offset:62464
  ds_read_b64_tr_b16 v[176:177], v67 offset:0
  ds_read_b64_tr_b16 v[178:179], v67 offset:1024
  ds_read_b64_tr_b16 v[180:181], v67 offset:4096
  ds_read_b64_tr_b16 v[182:183], v67 offset:5120
  s_waitcnt lgkmcnt(0)
  s_waitcnt vmcnt(24)
  s_barrier
  s_add_u32 m0, s51, 49152
  s_add_u32 s46, s62, 3932160
  buffer_load_dwordx4 v64, s[4:7], s46 offen lds
  s_add_u32 m0, s51, 53248
  s_add_u32 s46, s62, 4325376
  buffer_load_dwordx4 v64, s[4:7], s46 offen lds
  s_add_u32 m0, s51, 57344
  s_add_u32 s46, s62, 3932288
  buffer_load_dwordx4 v64, s[4:7], s46 offen lds
  s_add_u32 m0, s51, 61440
  s_add_u32 s46, s62, 4325504
  buffer_load_dwordx4 v64, s[4:7], s46 offen lds
  s_add_u32 m0, s51, 65536
  s_add_u32 s46, s62, 3932416
  buffer_load_dwordx4 v64, s[4:7], s46 offen lds
  s_add_u32 m0, s51, 69632
  s_add_u32 s46, s62, 4325632
  buffer_load_dwordx4 v64, s[4:7], s46 offen lds
  ds_read_b64_tr_b16 v[184:185], v67 offset:8192
  ds_read_b64_tr_b16 v[186:187], v67 offset:9216
  ds_read_b64_tr_b16 v[188:189], v67 offset:12288
  ds_read_b64_tr_b16 v[190:191], v67 offset:13312
  ds_read_b64_tr_b16 v[192:193], v67 offset:16384
  ds_read_b64_tr_b16 v[194:195], v67 offset:17408
  ds_read_b64_tr_b16 v[196:197], v67 offset:20480
  ds_read_b64_tr_b16 v[198:199], v67 offset:21504
  ds_read_b64_tr_b16 v[200:201], v67 offset:24576
  ds_read_b64_tr_b16 v[202:203], v67 offset:25600
  ds_read_b64_tr_b16 v[204:205], v67 offset:28672
  ds_read_b64_tr_b16 v[206:207], v67 offset:29696
  s_waitcnt lgkmcnt(0)
  s_waitcnt vmcnt(24)
  s_barrier
  s_add_u32 m0, s51, 73728
  s_add_u32 s46, s62, 5505024
  buffer_load_dwordx4 v64, s[4:7], s46 offen lds
  s_add_u32 m0, s51, 77824
  s_add_u32 s46, s62, 5898240
  buffer_load_dwordx4 v64, s[4:7], s46 offen lds
  s_add_u32 m0, s51, 81920
  s_add_u32 s46, s62, 5505152
  buffer_load_dwordx4 v64, s[4:7], s46 offen lds
  s_add_u32 m0, s51, 86016
  s_add_u32 s46, s62, 5898368
  buffer_load_dwordx4 v64, s[4:7], s46 offen lds
  s_add_u32 m0, s51, 90112
  s_add_u32 s46, s62, 5505280
  buffer_load_dwordx4 v64, s[4:7], s46 offen lds
  s_add_u32 m0, s51, 94208
  s_add_u32 s46, s62, 5898496
  buffer_load_dwordx4 v64, s[4:7], s46 offen lds
  ds_read_b64_tr_b16 v[208:209], v67 offset:32768
  ds_read_b64_tr_b16 v[210:211], v67 offset:33792
  ds_read_b64_tr_b16 v[212:213], v67 offset:36864
  ds_read_b64_tr_b16 v[214:215], v67 offset:37888
  ds_read_b64_tr_b16 v[216:217], v67 offset:40960
  ds_read_b64_tr_b16 v[218:219], v67 offset:41984
  ds_read_b64_tr_b16 v[220:221], v67 offset:45056
  ds_read_b64_tr_b16 v[222:223], v67 offset:46080
  ds_read_b64_tr_b16 v[224:225], v67 offset:49152
  ds_read_b64_tr_b16 v[226:227], v67 offset:50176
  ds_read_b64_tr_b16 v[228:229], v67 offset:53248
  ds_read_b64_tr_b16 v[230:231], v67 offset:54272
  s_waitcnt lgkmcnt(0)
  s_waitcnt vmcnt(24)
  s_barrier
  s_add_u32 m0, s51, 98304
  s_add_u32 s46, s62, 7077888
  buffer_load_dwordx4 v64, s[4:7], s46 offen lds
  s_add_u32 m0, s51, 102400
  s_add_u32 s46, s62, 7471104
  buffer_load_dwordx4 v64, s[4:7], s46 offen lds
  s_add_u32 m0, s51, 106496
  s_add_u32 s46, s62, 7078016
  buffer_load_dwordx4 v64, s[4:7], s46 offen lds
  s_add_u32 m0, s51, 110592
  s_add_u32 s46, s62, 7471232
  buffer_load_dwordx4 v64, s[4:7], s46 offen lds
  s_add_u32 m0, s51, 114688
  s_add_u32 s46, s62, 7078144
  buffer_load_dwordx4 v64, s[4:7], s46 offen lds
  s_add_u32 m0, s51, 118784
  s_add_u32 s46, s62, 7471360
  buffer_load_dwordx4 v64, s[4:7], s46 offen lds
  ds_read_b64_tr_b16 v[232:233], v67 offset:57344
  ds_read_b64_tr_b16 v[234:235], v67 offset:58368
  ds_read_b64_tr_b16 v[236:237], v67 offset:61440
  ds_read_b64_tr_b16 v[238:239], v67 offset:62464
  ds_read_b64_tr_b16 v[240:241], v68 offset:0
  ds_read_b64_tr_b16 v[242:243], v68 offset:1024
  ds_read_b64_tr_b16 v[244:245], v68 offset:4096
  ds_read_b64_tr_b16 v[246:247], v68 offset:5120
  ds_read_b64_tr_b16 v[248:249], v68 offset:8192
  ds_read_b64_tr_b16 v[250:251], v68 offset:9216
  ds_read_b64_tr_b16 v[252:253], v68 offset:12288
  ds_read_b64_tr_b16 v[254:255], v68 offset:13312
  s_waitcnt lgkmcnt(0)
  s_waitcnt vmcnt(24)
  s_barrier
  ds_read_b64_tr_b16 v[40:41], v66 offset:0
  ds_read_b64_tr_b16 v[42:43], v66 offset:1024
  ds_read_b64_tr_b16 v[44:45], v66 offset:4096
  ds_read_b64_tr_b16 v[46:47], v66 offset:5120
  ds_read_b64_tr_b16 v[48:49], v66 offset:8192
  ds_read_b64_tr_b16 v[50:51], v66 offset:9216
  ds_read_b64_tr_b16 v[52:53], v66 offset:12288
  ds_read_b64_tr_b16 v[54:55], v66 offset:13312
  ds_read_b64_tr_b16 v[56:57], v66 offset:16384
  ds_read_b64_tr_b16 v[58:59], v66 offset:17408
  ds_read_b64_tr_b16 v[60:61], v66 offset:20480
  ds_read_b64_tr_b16 v[62:63], v66 offset:21504
  s_waitcnt lgkmcnt(0)
  s_waitcnt vmcnt(18)
  s_barrier
  ds_write_b128 v2, v[40:43] offset:0
  ds_write_b128 v2, v[44:47] offset:4096
  ds_write_b128 v2, v[48:51] offset:8192
  ds_write_b128 v2, v[52:55] offset:12288
  ds_write_b128 v2, v[56:59] offset:16384
  ds_write_b128 v2, v[60:63] offset:20480
  ds_read_b64_tr_b16 v[16:17], v66 offset:24576
  ds_read_b64_tr_b16 v[18:19], v66 offset:25600
  ds_read_b64_tr_b16 v[20:21], v66 offset:28672
  ds_read_b64_tr_b16 v[22:23], v66 offset:29696
  ds_read_b64_tr_b16 v[24:25], v66 offset:32768
  ds_read_b64_tr_b16 v[26:27], v66 offset:33792
  ds_read_b64_tr_b16 v[28:29], v66 offset:36864
  ds_read_b64_tr_b16 v[30:31], v66 offset:37888
  ds_read_b64_tr_b16 v[32:33], v66 offset:40960
  ds_read_b64_tr_b16 v[34:35], v66 offset:41984
  ds_read_b64_tr_b16 v[36:37], v66 offset:45056
  ds_read_b64_tr_b16 v[38:39], v66 offset:46080
  s_waitcnt lgkmcnt(0)
  s_waitcnt vmcnt(12)
  s_barrier
  ds_write_b128 v2, v[16:19] offset:24576
  ds_write_b128 v2, v[20:23] offset:28672
  ds_write_b128 v2, v[24:27] offset:32768
  ds_write_b128 v2, v[28:31] offset:36864
  ds_write_b128 v2, v[32:35] offset:40960
  ds_write_b128 v2, v[36:39] offset:45056
  ds_read_b64_tr_b16 v[40:41], v66 offset:49152
  ds_read_b64_tr_b16 v[42:43], v66 offset:50176
  ds_read_b64_tr_b16 v[44:45], v66 offset:53248
  ds_read_b64_tr_b16 v[46:47], v66 offset:54272
  ds_read_b64_tr_b16 v[48:49], v66 offset:57344
  ds_read_b64_tr_b16 v[50:51], v66 offset:58368
  ds_read_b64_tr_b16 v[52:53], v66 offset:61440
  ds_read_b64_tr_b16 v[54:55], v66 offset:62464
  ds_read_b64_tr_b16 v[56:57], v67 offset:0
  ds_read_b64_tr_b16 v[58:59], v67 offset:1024
  ds_read_b64_tr_b16 v[60:61], v67 offset:4096
  ds_read_b64_tr_b16 v[62:63], v67 offset:5120
  s_waitcnt lgkmcnt(0)
  s_waitcnt vmcnt(6)
  s_barrier
  ds_write_b128 v2, v[40:43] offset:49152
  ds_write_b128 v2, v[44:47] offset:53248
  ds_write_b128 v2, v[48:51] offset:57344
  ds_write_b128 v2, v[52:55] offset:61440
  ds_write_b128 v3, v[56:59] offset:0
  ds_write_b128 v3, v[60:63] offset:4096
  ds_read_b64_tr_b16 v[16:17], v67 offset:8192
  ds_read_b64_tr_b16 v[18:19], v67 offset:9216
  ds_read_b64_tr_b16 v[20:21], v67 offset:12288
  ds_read_b64_tr_b16 v[22:23], v67 offset:13312
  ds_read_b64_tr_b16 v[24:25], v67 offset:16384
  ds_read_b64_tr_b16 v[26:27], v67 offset:17408
  ds_read_b64_tr_b16 v[28:29], v67 offset:20480
  ds_read_b64_tr_b16 v[30:31], v67 offset:21504
  ds_read_b64_tr_b16 v[32:33], v67 offset:24576
  ds_read_b64_tr_b16 v[34:35], v67 offset:25600
  ds_read_b64_tr_b16 v[36:37], v67 offset:28672
  ds_read_b64_tr_b16 v[38:39], v67 offset:29696
  s_waitcnt lgkmcnt(0)
  s_waitcnt vmcnt(0)
  s_barrier
  ds_write_b128 v3, v[16:19] offset:8192
  ds_write_b128 v3, v[20:23] offset:12288
  ds_write_b128 v3, v[24:27] offset:16384
  ds_write_b128 v3, v[28:31] offset:20480
  ds_write_b128 v3, v[32:35] offset:24576
  ds_write_b128 v3, v[36:39] offset:28672
  ds_read_b64_tr_b16 v[40:41], v67 offset:32768
  ds_read_b64_tr_b16 v[42:43], v67 offset:33792
  ds_read_b64_tr_b16 v[44:45], v67 offset:36864
  ds_read_b64_tr_b16 v[46:47], v67 offset:37888
  ds_read_b64_tr_b16 v[48:49], v67 offset:40960
  ds_read_b64_tr_b16 v[50:51], v67 offset:41984
  ds_read_b64_tr_b16 v[52:53], v67 offset:45056
  ds_read_b64_tr_b16 v[54:55], v67 offset:46080
  ds_read_b64_tr_b16 v[56:57], v67 offset:49152
  ds_read_b64_tr_b16 v[58:59], v67 offset:50176
  ds_read_b64_tr_b16 v[60:61], v67 offset:53248
  ds_read_b64_tr_b16 v[62:63], v67 offset:54272
  s_waitcnt lgkmcnt(0)
  s_barrier
  ds_write_b128 v3, v[40:43] offset:32768
  ds_write_b128 v3, v[44:47] offset:36864
  ds_write_b128 v3, v[48:51] offset:40960
  ds_write_b128 v3, v[52:55] offset:45056
  ds_write_b128 v3, v[56:59] offset:49152
  ds_write_b128 v3, v[60:63] offset:53248
  s_waitcnt lgkmcnt(0)
  v_and_b32 v150, 1, v0
  v_lshlrev_b32 v150, 7, v150
  v_add_u32 v150, 3014656, v150
  s_mov_b32 s50, 0
pol_35:
  buffer_load_dword v148, v150, s[8:11], 0 offen sc1
  s_add_u32 s50, s50, 1
  s_cmp_gt_u32 s50, 131072
  s_cbranch_scc1 L_fail
  s_waitcnt vmcnt(0)
  v_cmp_eq_u32 vcc, 0, v148
  s_cbranch_vccnz pol_35
  v_readlane_b32 s54, v148, 0
  v_readlane_b32 s55, v148, 1
  s_and_b32 s54, s54, 0x2000
  s_and_b32 s55, s55, 0x2000
  s_mov_b32 s68, 0xfffffffe
  v_and_b32 v148, 3, v0
  s_lshl_b32 s46, s43, 9
  s_add_u32 s46, s46, s55
  s_add_u32 s46, s46, 2883584
  v_lshl_add_u32 v10, v148, 7, s46
  v_mov_b32 v7, 0x44444444
  v_mov_b32 v148, 0xeeeeeeee
  v_and_b32 v149, 8, v0
  v_cmp_ne_u32 vcc, 0, v149
  s_nop 1
  v_cndmask_b32 v7, v7, v148, vcc
  v_and_b32 v148, 15, v0
  v_bfe_u32 v149, v0, 4, 1
  v_lshrrev_b32 v150, 5, v0
  v_lshlrev_b32 v8, 4, v148
  v_lshl_add_u32 v8, v149, 3, v8
  v_lshl_add_u32 v4, v150, 2, v8
  s_and_b32 s46, s42, 1
  s_lshl_b32 s46, s46, 7
  v_xor_b32 v4, s46, v4
  s_lshl_b32 s46, s42, 8
  s_add_u32 s46, s46, 122880
  v_add_u32 v4, s46, v4
  s_lshl_b32 s46, s45, 8
  s_lshl_b32 s47, s42, 13
  s_add_u32 s47, s47, s46
  v_lshl_add_u32 v9, v150, 15, v8
  v_add_u32 v9, s47, v9
  s_lshl_b32 s47, s42, 14
  s_add_u32 s47, s47, s46
  s_add_u32 s47, s47, s54
  v_lshl_add_u32 v8, v150, 16, v8
  v_add_u32 v8, s47, v8
  v_lshrrev_b32 v148, 4, v0
  v_lshlrev_b32 v5, 8, v148
  v_lshl_add_u32 v5, v149, 7, v5
  v_bfe_u32 v148, v0, 3, 1
  v_lshl_add_u32 v5, v148, 6, v5
  v_bfe_u32 v148, v0, 1, 1
  v_lshl_add_u32 v5, v148, 5, v5
  v_bfe_u32 v148, v0, 2, 1
  v_lshl_add_u32 v5, v148, 4, v5
  v_and_b32 v148, 1, v0
  v_lshl_add_u32 v5, v148, 3, v5
  v_xor_b32 v6, 0x80, v5
  v_add_u32 v5, 122880, v5
  v_add_u32 v6, 122880, v6
  s_lshl_b32 s46, s45, 7
  s_lshl_b32 s47, s42, 2
  s_add_u32 s47, s47, s46
  s_add_u32 s47, s47, 2965504
  v_mov_b32 v15, s47
  s_mov_b32 s64, 167772160
  s_mov_b32 s52, 0
  s_mov_b32 s58, 0
  s_mov_b32 s65, 1310720
  s_mov_b32 s100, 0
va_loop:
  s_add_u32 s53, s52, 1
  s_lshl_b32 s56, s58, 2
  s_add_u32 s56, s56, s43
  s_lshl_b32 s56, s56, 16
  s_add_u32 s56, s56, s55
  s_add_u32 s56, s56, 2097152
  s_add_u32 s59, s56, 4096
  s_add_u32 s57, s56, 49152
  s_mul_i32 s66, s58, 655360
  ds_read_b128 v[56:59], v2 offset:0
  ds_read_b128 v[60:63], v2 offset:4096
  ds_read_b128 v[64:67], v2 offset:8192
  ds_read_b128 v[68:71], v2 offset:12288
  ds_read_b128 v[72:75], v2 offset:16384
  ds_read_b128 v[76:79], v2 offset:20480
  ds_read_b128 v[80:83], v2 offset:24576
  ds_read_b128 v[84:87], v2 offset:28672
  ds_read_b128 v[88:91], v2 offset:32768
  ds_read_b128 v[92:95], v2 offset:36864
  ds_read_b128 v[96:99], v2 offset:40960
  ds_read_b128 v[100:103], v2 offset:45056
  v_mov_b32 v104, 0
  v_mov_b32 v105, 0
  v_mov_b32 v106, 0
  v_mov_b32 v107, 0
  v_mov_b32 v108, 0
  v_mov_b32 v109, 0
  v_mov_b32 v110, 0
  v_mov_b32 v111, 0
  v_mov_b32 v112, 0
  v_mov_b32 v113, 0
  v_mov_b32 v114, 0
  v_mov_b32 v115, 0
  s_cmp_lg_u32 s42, 3
  s_cbranch_scc1 va_nobell
  s_mov_b32 s50, 0
  s_mov_b64 exec, 15
  buffer_load_dword v116, v10, s[8:11], 0 offen sc1
  s_nop 11
  buffer_load_dword v117, v10, s[8:11], 0 offen sc1
  s_nop 11
  buffer_load_dword v118, v10, s[8:11], 0 offen sc1
  s_nop 11
  buffer_load_dword v119, v10, s[8:11], 0 offen sc1
  s_nop 11
  buffer_load_dword v120, v10, s[8:11], 0 offen sc1
  s_nop 11
  buffer_load_dword v121, v10, s[8:11], 0 offen sc1
  s_nop 11
  buffer_load_dword v122, v10, s[8:11], 0 offen sc1
  s_nop 11
  buffer_load_dword v123, v10, s[8:11], 0 offen sc1
  s_nop 11
  buffer_load_dword v124, v10, s[8:11], 0 offen sc1
  s_nop 11
bell_36:
  buffer_load_dword v125, v10, s[8:11], 0 offen sc1
  s_waitcnt vmcnt(9)
  v_cmp_gt_u32 vcc, s53, v116
  s_cbranch_vccz bell_x_37
  s_nop 7
  buffer_load_dword v116, v10, s[8:11], 0 offen sc1
  s_waitcnt vmcnt(9)
  v_cmp_gt_u32 vcc, s53, v117
  s_cbranch_vccz bell_x_37
  s_nop 7
  buffer_load_dword v117, v10, s[8:11], 0 offen sc1
  s_waitcnt vmcnt(9)
  v_cmp_gt_u32 vcc, s53, v118
  s_cbranch_vccz bell_x_37
  s_nop 7
  buffer_load_dword v118, v10, s[8:11], 0 offen sc1
  s_waitcnt vmcnt(9)
  v_cmp_gt_u32 vcc, s53, v119
  s_cbranch_vccz bell_x_37
  s_nop 7
  buffer_load_dword v119, v10, s[8:11], 0 offen sc1
  s_waitcnt vmcnt(9)
  v_cmp_gt_u32 vcc, s53, v120
  s_cbranch_vccz bell_x_37
  s_nop 7
  buffer_load_dword v120, v10, s[8:11], 0 offen sc1
  s_waitcnt vmcnt(9)
  v_cmp_gt_u32 vcc, s53, v121
  s_cbranch_vccz bell_x_37
  s_nop 7
  buffer_load_dword v121, v10, s[8:11], 0 offen sc1
  s_waitcnt vmcnt(9)
  v_cmp_gt_u32 vcc, s53, v122
  s_cbranch_vccz bell_x_37
  s_nop 7
  buffer_load_dword v122, v10, s[8:11], 0 offen sc1
  s_waitcnt vmcnt(9)
  v_cmp_gt_u32 vcc, s53, v123
  s_cbranch_vccz bell_x_37
  s_nop 7
  buffer_load_dword v123, v10, s[8:11], 0 offen sc1
  s_waitcnt vmcnt(9)
  v_cmp_gt_u32 vcc, s53, v124
  s_cbranch_vccz bell_x_37
  s_nop 7
  buffer_load_dword v124, v10, s[8:11], 0 offen sc1
  s_waitcnt vmcnt(9)
  v_cmp_gt_u32 vcc, s53, v125
  s_cbranch_vccz bell_x_37
  s_add_u32 s50, s50, 1
  s_cmp_gt_u32 s50, 131072
  s_cbranch_scc1 L_fail
  s_branch bell_36
bell_x_37:
  s_mov_b64 exec, -1
va_nobell:
  s_waitcnt lgkmcnt(0)
  s_barrier
  buffer_load_dwordx4 v[16:19], v1, s[8:11], s56 offen offset:0 sc1
  s_barrier
  buffer_load_dwordx4 v[20:23], v1, s[8:11], s56 offen offset:1024 sc1
  s_barrier
  buffer_load_dwordx4 v[24:27], v1, s[8:11], s56 offen offset:2048 sc1
  s_barrier
  buffer_load_dwordx4 v[28:31], v1, s[8:11], s56 offen offset:3072 sc1
  s_barrier
  buffer_load_dwordx4 v[32:35], v1, s[8:11], s59 offen offset:0 sc1
  s_barrier
  buffer_load_dwordx4 v[36:39], v1, s[8:11], s59 offen offset:1024 sc1
  s_barrier
  buffer_load_dwordx4 v[40:43], v1, s[8:11], s59 offen offset:2048 sc1
va_go_38:
  s_waitcnt vmcnt(6)
  v_smfmac_f32_16x16x64_bf16 v[104:107], v[16:19], a[240:247], v7
  v_max3_u32 v12, v16, v17, v18
  v_max3_u32 v12, v18, v19, v12
  v_smfmac_f32_16x16x64_bf16 v[108:111], v[16:19], a[248:255], v7
  v_smfmac_f32_16x16x64_bf16 v[112:115], v[16:19], v[152:159], v7
  buffer_load_dwordx4 v[44:47], v1, s[8:11], s59 offen offset:3072 sc1
  s_waitcnt vmcnt(6)
  v_smfmac_f32_16x16x64_bf16 v[104:107], v[20:23], v[56:63], v7
  v_max3_u32 v12, v20, v21, v12
  v_max3_u32 v12, v22, v23, v12
  v_smfmac_f32_16x16x64_bf16 v[108:111], v[20:23], v[64:71], v7
  v_smfmac_f32_16x16x64_bf16 v[112:115], v[20:23], v[72:79], v7
  v_mov_b32 v16, 0
  v_mov_b32 v17, 0
  v_mov_b32 v18, 0
  v_mov_b32 v19, 0
  v_mov_b32 v20, 0
  v_mov_b32 v21, 0
  v_mov_b32 v22, 0
  v_mov_b32 v23, 0
  buffer_load_dwordx4 v[48:51], v1, s[8:11], s57 offen offset:0 sc1
  s_waitcnt vmcnt(6)
  v_smfmac_f32_16x16x64_bf16 v[104:107], v[24:27], v[160:167], v7
  v_max3_u32 v12, v24, v25, v12
  v_max3_u32 v12, v26, v27, v12
  ds_read_b128 v[56:59], v2 offset:49152
  ds_read_b128 v[60:63], v2 offset:53248
  v_smfmac_f32_16x16x64_bf16 v[108:111], v[24:27], v[168:175], v7
  ds_read_b128 v[64:67], v2 offset:57344
  ds_read_b128 v[68:71], v2 offset:61440
  v_smfmac_f32_16x16x64_bf16 v[112:115], v[24:27], v[176:183], v7
  ds_read_b128 v[72:75], v3 offset:0
  ds_read_b128 v[76:79], v3 offset:4096
  buffer_load_dwordx4 v[52:55], v1, s[8:11], s57 offen offset:1024 sc1
  s_waitcnt vmcnt(6)
  v_smfmac_f32_16x16x64_bf16 v[104:107], v[28:31], v[80:87], v7
  v_max3_u32 v12, v28, v29, v12
  v_max3_u32 v12, v30, v31, v12
  v_smfmac_f32_16x16x64_bf16 v[108:111], v[28:31], v[88:95], v7
  v_smfmac_f32_16x16x64_bf16 v[112:115], v[28:31], v[96:103], v7
  v_mov_b32 v24, 0
  v_mov_b32 v25, 0
  v_mov_b32 v26, 0
  v_mov_b32 v27, 0
  v_mov_b32 v28, 0
  v_mov_b32 v29, 0
  v_mov_b32 v30, 0
  v_mov_b32 v31, 0
  s_waitcnt vmcnt(5)
  v_smfmac_f32_16x16x64_bf16 v[104:107], v[32:35], v[184:191], v7
  v_max3_u32 v12, v32, v33, v12
  v_max3_u32 v12, v34, v35, v12
  ds_read_b128 v[80:83], v3 offset:8192
  ds_read_b128 v[84:87], v3 offset:12288
  v_smfmac_f32_16x16x64_bf16 v[108:111], v[32:35], v[192:199], v7
  ds_read_b128 v[88:91], v3 offset:16384
  ds_read_b128 v[92:95], v3 offset:20480
  v_smfmac_f32_16x16x64_bf16 v[112:115], v[32:35], v[200:207], v7
  ds_read_b128 v[96:99], v3 offset:24576
  ds_read_b128 v[100:103], v3 offset:28672
  s_waitcnt vmcnt(4)
  s_waitcnt lgkmcnt(6)
  v_smfmac_f32_16x16x64_bf16 v[104:107], v[36:39], v[56:63], v7
  v_max3_u32 v12, v36, v37, v12
  v_max3_u32 v12, v38, v39, v12
  v_smfmac_f32_16x16x64_bf16 v[108:111], v[36:39], v[64:71], v7
  v_smfmac_f32_16x16x64_bf16 v[112:115], v[36:39], v[72:79], v7
  v_mov_b32 v32, 0
  v_mov_b32 v33, 0
  v_mov_b32 v34, 0
  v_mov_b32 v35, 0
  v_mov_b32 v36, 0
  v_mov_b32 v37, 0
  v_mov_b32 v38, 0
  v_mov_b32 v39, 0
  s_waitcnt vmcnt(3)
  v_smfmac_f32_16x16x64_bf16 v[104:107], v[40:43], v[208:215], v7
  v_max3_u32 v12, v40, v41, v12
  v_max3_u32 v12, v42, v43, v12
  ds_read_b128 v[56:59], v3 offset:32768
  ds_read_b128 v[60:63], v3 offset:36864
  v_smfmac_f32_16x16x64_bf16 v[108:111], v[40:43], v[216:223], v7
  ds_read_b128 v[64:67], v3 offset:40960
  ds_read_b128 v[68:71], v3 offset:45056
  v_smfmac_f32_16x16x64_bf16 v[112:115], v[40:43], v[224:231], v7
  ds_read_b128 v[72:75], v3 offset:49152
  ds_read_b128 v[76:79], v3 offset:53248
  s_waitcnt vmcnt(2)
  s_waitcnt lgkmcnt(6)
  v_smfmac_f32_16x16x64_bf16 v[104:107], v[44:47], v[80:87], v7
  v_max3_u32 v12, v44, v45, v12
  v_max3_u32 v12, v46, v47, v12
  v_smfmac_f32_16x16x64_bf16 v[108:111], v[44:47], v[88:95], v7
  v_smfmac_f32_16x16x64_bf16 v[112:115], v[44:47], v[96:103], v7
  v_mov_b32 v40, 0
  v_mov_b32 v41, 0
  v_mov_b32 v42, 0
  v_mov_b32 v43, 0
  v_mov_b32 v44, 0
  v_mov_b32 v45, 0
  v_mov_b32 v46, 0
  v_mov_b32 v47, 0
  s_waitcnt vmcnt(1)
  v_smfmac_f32_16x16x64_bf16 v[104:107], v[48:51], v[232:239], v7
  v_max3_u32 v12, v48, v49, v12
  v_max3_u32 v12, v50, v51, v12
  v_smfmac_f32_16x16x64_bf16 v[108:111], v[48:51], v[240:247], v7
  v_smfmac_f32_16x16x64_bf16 v[112:115], v[48:51], v[248:255], v7
  s_waitcnt vmcnt(0)
  s_waitcnt lgkmcnt(0)
  v_smfmac_f32_16x16x64_bf16 v[104:107], v[52:55], v[56:63], v7
  v_max3_u32 v12, v52, v53, v12
  v_max3_u32 v12, v54, v55, v12
  v_smfmac_f32_16x16x64_bf16 v[108:111], v[52:55], v[64:71], v7
  v_smfmac_f32_16x16x64_bf16 v[112:115], v[52:55], v[72:79], v7
  v_mov_b32 v48, 0
  v_mov_b32 v49, 0
  v_mov_b32 v50, 0
  v_mov_b32 v51, 0
  v_cmp_eq_u32 vcc, -1, v12
  s_cbranch_vccnz va_redo_39
va_ok_40:
  v_permlane32_swap_b32 v104, v106
  v_permlane32_swap_b32 v105, v107
  v_add_f32 v104, v104, v106
  v_add_f32 v105, v105, v107
  v_cvt_pk_bf16_f32 v104, v104, v105
  ds_write_b32 v4, v104 offset:0
  v_permlane32_swap_b32 v108, v110
  v_permlane32_swap_b32 v109, v111
  v_add_f32 v108, v108, v110
  v_add_f32 v109, v109, v111
  v_cvt_pk_bf16_f32 v108, v108, v109
  ds_write_b32 v4, v108 offset:1024
  v_permlane32_swap_b32 v112, v114
  v_permlane32_swap_b32 v113, v115
  v_add_f32 v112, v112, v114
  v_add_f32 v113, v113, v115
  v_cvt_pk_bf16_f32 v112, v112, v113
  ds_write_b32 v4, v112 offset:2048
  v_mov_b32 v52, 0
  v_mov_b32 v53, 0
  v_mov_b32 v54, 0
  v_mov_b32 v55, 0
  s_waitcnt lgkmcnt(0)
  s_barrier
  ds_read_b64_tr_b16 v[116:117], v5 offset:0
  ds_read_b64_tr_b16 v[118:119], v6 offset:0
  ds_read_b64_tr_b16 v[120:121], v5 offset:1024
  ds_read_b64_tr_b16 v[122:123], v6 offset:1024
  ds_read_b64_tr_b16 v[124:125], v5 offset:2048
  ds_read_b64_tr_b16 v[126:127], v6 offset:2048
  s_waitcnt lgkmcnt(4)
  v_smfmac_f32_16x16x64_bf16 v[16:19], v[116:119], a[0:7], v7
  v_smfmac_f32_16x16x64_bf16 v[20:23], v[116:119], a[24:31], v7
  s_waitcnt lgkmcnt(2)
  v_smfmac_f32_16x16x64_bf16 v[16:19], v[120:123], a[8:15], v7
  v_smfmac_f32_16x16x64_bf16 v[20:23], v[120:123], a[32:39], v7
  s_waitcnt lgkmcnt(0)
  v_smfmac_f32_16x16x64_bf16 v[16:19], v[124:127], a[16:23], v7
  v_smfmac_f32_16x16x64_bf16 v[20:23], v[124:127], a[40:47], v7
  v_smfmac_f32_16x16x64_bf16 v[24:27], v[116:119], a[48:55], v7
  v_smfmac_f32_16x16x64_bf16 v[28:31], v[116:119], a[72:79], v7
  v_smfmac_f32_16x16x64_bf16 v[24:27], v[120:123], a[56:63], v7
  s_nop 4
  v_permlane32_swap_b32 v16, v20
  v_permlane32_swap_b32 v17, v21
  v_permlane32_swap_b32 v18, v22
  v_smfmac_f32_16x16x64_bf16 v[28:31], v[120:123], a[80:87], v7
  v_permlane32_swap_b32 v19, v23
  v_add_f32 v16, v16, v20
  v_add_f32 v17, v17, v21
  v_smfmac_f32_16x16x64_bf16 v[24:27], v[124:127], a[64:71], v7
  v_add_f32 v18, v18, v22
  v_add_f32 v19, v19, v23
  v_smfmac_f32_16x16x64_bf16 v[28:31], v[124:127], a[88:95], v7
  v_cvt_pk_bf16_f32 v128, v16, v17
  v_cvt_pk_bf16_f32 v129, v18, v19
  v_smfmac_f32_16x16x64_bf16 v[32:35], v[116:119], a[96:103], v7
  v_min_u32 v128, s68, v128
  v_min_u32 v129, s68, v129
  v_smfmac_f32_16x16x64_bf16 v[36:39], v[116:119], a[120:127], v7
  s_add_u32 s46, s66, 0
  buffer_store_dwordx2 v[128:129], v8, s[8:11], s46 offen sc1
  v_smfmac_f32_16x16x64_bf16 v[32:35], v[120:123], a[104:111], v7
  v_permlane32_swap_b32 v24, v28
  v_permlane32_swap_b32 v25, v29
  v_permlane32_swap_b32 v26, v30
  v_smfmac_f32_16x16x64_bf16 v[36:39], v[120:123], a[128:135], v7
  v_permlane32_swap_b32 v27, v31
  v_add_f32 v24, v24, v28
  v_add_f32 v25, v25, v29
  v_smfmac_f32_16x16x64_bf16 v[32:35], v[124:127], a[112:119], v7
  v_add_f32 v26, v26, v30
  v_add_f32 v27, v27, v31
  v_smfmac_f32_16x16x64_bf16 v[36:39], v[124:127], a[136:143], v7
  v_cvt_pk_bf16_f32 v130, v24, v25
  v_cvt_pk_bf16_f32 v131, v26, v27
  v_smfmac_f32_16x16x64_bf16 v[40:43], v[116:119], a[144:151], v7
  v_min_u32 v130, s68, v130
  v_min_u32 v131, s68, v131
  v_smfmac_f32_16x16x64_bf16 v[44:47], v[116:119], a[168:175], v7
  s_add_u32 s46, s66, 131072
  buffer_store_dwordx2 v[130:131], v8, s[8:11], s46 offen sc1
  v_smfmac_f32_16x16x64_bf16 v[40:43], v[120:123], a[152:159], v7
  v_permlane32_swap_b32 v32, v36
  v_permlane32_swap_b32 v33, v37
  v_permlane32_swap_b32 v34, v38
  v_smfmac_f32_16x16x64_bf16 v[44:47], v[120:123], a[176:183], v7
  v_permlane32_swap_b32 v35, v39
  v_add_f32 v32, v32, v36
  v_add_f32 v33, v33, v37
  v_smfmac_f32_16x16x64_bf16 v[40:43], v[124:127], a[160:167], v7
  v_add_f32 v34, v34, v38
  v_add_f32 v35, v35, v39
  v_smfmac_f32_16x16x64_bf16 v[44:47], v[124:127], a[184:191], v7
  v_cvt_pk_bf16_f32 v132, v32, v33
  v_cvt_pk_bf16_f32 v133, v34, v35
  v_smfmac_f32_16x16x64_bf16 v[48:51], v[116:119], a[192:199], v7
  v_min_u32 v132, s68, v132
  v_min_u32 v133, s68, v133
  v_smfmac_f32_16x16x64_bf16 v[52:55], v[116:119], a[216:223], v7
  s_add_u32 s46, s66, 262144
  buffer_store_dwordx2 v[132:133], v8, s[8:11], s46 offen sc1
  v_smfmac_f32_16x16x64_bf16 v[48:51], v[120:123], a[200:207], v7
  v_permlane32_swap_b32 v40, v44
  v_permlane32_swap_b32 v41, v45
  v_permlane32_swap_b32 v42, v46
  v_smfmac_f32_16x16x64_bf16 v[52:55], v[120:123], a[224:231], v7
  v_permlane32_swap_b32 v43, v47
  v_add_f32 v40, v40, v44
  v_add_f32 v41, v41, v45
  v_smfmac_f32_16x16x64_bf16 v[48:51], v[124:127], a[208:215], v7
  v_add_f32 v42, v42, v46
  v_add_f32 v43, v43, v47
  v_smfmac_f32_16x16x64_bf16 v[52:55], v[124:127], a[232:239], v7
  v_cvt_pk_bf16_f32 v134, v40, v41
  v_cvt_pk_bf16_f32 v135, v42, v43
  v_min_u32 v134, s68, v134
  v_min_u32 v135, s68, v135
  s_add_u32 s46, s66, 393216
  buffer_store_dwordx2 v[134:135], v8, s[8:11], s46 offen sc1
  s_nop 1
  v_permlane32_swap_b32 v48, v52
  v_permlane32_swap_b32 v49, v53
  v_permlane32_swap_b32 v50, v54
  v_permlane32_swap_b32 v51, v55
  v_add_f32 v48, v48, v52
  v_add_f32 v49, v49, v53
  v_add_f32 v50, v50, v54
  v_add_f32 v51, v51, v55
  v_cvt_pk_bf16_f32 v136, v48, v49
  v_cvt_pk_bf16_f32 v137, v50, v51
  v_min_u32 v136, s68, v136
  v_min_u32 v137, s68, v137
  s_add_u32 s46, s66, 524288
  buffer_store_dwordx2 v[136:137], v8, s[8:11], s46 offen sc1
  v_mov_b32 v148, s52
  s_mov_b64 exec, 1
  buffer_store_dword v148, v15, s[8:11], 0 offen sc1
  s_mov_b64 exec, -1
  s_add_u32 s46, s64, 0
  buffer_store_dwordx2 v[128:129], v9, s[8:11], s46 offen sc1
  s_add_u32 s46, s64, 65536
  buffer_store_dwordx2 v[130:131], v9, s[8:11], s46 offen sc1
  s_add_u32 s46, s64, 131072
  buffer_store_dwordx2 v[132:133], v9, s[8:11], s46 offen sc1
  s_add_u32 s46, s64, 196608
  buffer_store_dwordx2 v[134:135], v9, s[8:11], s46 offen sc1
  s_add_u32 s46, s64, 262144
  buffer_store_dwordx2 v[136:137], v9, s[8:11], s46 offen sc1
  v_mov_b32 v150, -1
  v_mov_b32 v151, -1
  s_add_u32 s46, s65, 0
  buffer_store_dwordx2 v[150:151], v8, s[8:11], s46 offen sc1
  s_add_u32 s46, s65, 131072
  buffer_store_dwordx2 v[150:151], v8, s[8:11], s46 offen sc1
  s_add_u32 s46, s65, 262144
  buffer_store_dwordx2 v[150:151], v8, s[8:11], s46 offen sc1
  s_add_u32 s46, s65, 393216
  buffer_store_dwordx2 v[150:151], v8, s[8:11], s46 offen sc1
  s_add_u32 s46, s65, 524288
  buffer_store_dwordx2 v[150:151], v8, s[8:11], s46 offen sc1
  s_mov_b32 s65, s66
  s_add_u32 s64, s64, 327680
  s_add_u32 s58, s58, 1
  s_cmp_eq_u32 s58, 3
  s_cselect_b32 s58, 0, s58
  s_mov_b32 s52, s53
  s_cmp_lt_u32 s52, 64
  s_cbranch_scc1 va_loop
  s_waitcnt vmcnt(0)
  v_mov_b32 v148, s52
  s_mov_b64 exec, 1
  buffer_store_dword v148, v15, s[8:11], 0 offen sc1
  s_mov_b64 exec, -1
  s_endpgm
va_redo_39:
  s_mov_b32 s50, 0
  s_waitcnt lgkmcnt(0)
va_poll_41:
  buffer_load_dwordx4 v[16:19], v1, s[8:11], s56 offen offset:0 sc1
  buffer_load_dwordx4 v[20:23], v1, s[8:11], s56 offen offset:1024 sc1
  buffer_load_dwordx4 v[24:27], v1, s[8:11], s56 offen offset:2048 sc1
  buffer_load_dwordx4 v[28:31], v1, s[8:11], s56 offen offset:3072 sc1
  buffer_load_dwordx4 v[32:35], v1, s[8:11], s59 offen offset:0 sc1
  buffer_load_dwordx4 v[36:39], v1, s[8:11], s59 offen offset:1024 sc1
  buffer_load_dwordx4 v[40:43], v1, s[8:11], s59 offen offset:2048 sc1
  buffer_load_dwordx4 v[44:47], v1, s[8:11], s59 offen offset:3072 sc1
  buffer_load_dwordx4 v[48:51], v1, s[8:11], s57 offen offset:0 sc1
  buffer_load_dwordx4 v[52:55], v1, s[8:11], s57 offen offset:1024 sc1
  s_add_u32 s50, s50, 1
  s_cmp_gt_u32 s50, 131072
  s_cbranch_scc1 L_fail
  s_waitcnt vmcnt(0)
  v_max_u32 v12, v16, v17
  v_max3_u32 v12, v18, v19, v12
  v_max3_u32 v12, v20, v21, v12
  v_max3_u32 v12, v22, v23, v12
  v_max3_u32 v12, v24, v25, v12
  v_max3_u32 v12, v26, v27, v12
  v_max3_u32 v12, v28, v29, v12
  v_max3_u32 v12, v30, v31, v12
  v_max3_u32 v12, v32, v33, v12
  v_max3_u32 v12, v34, v35, v12
  v_max3_u32 v12, v36, v37, v12
  v_max3_u32 v12, v38, v39, v12
  v_max3_u32 v12, v40, v41, v12
  v_max3_u32 v12, v42, v43, v12
  v_max3_u32 v12, v44, v45, v12
  v_max3_u32 v12, v46, v47, v12
  v_max3_u32 v12, v48, v49, v12
  v_max3_u32 v12, v50, v51, v12
  v_max3_u32 v12, v52, v53, v12
  v_max3_u32 v12, v54, v55, v12
  v_cmp_eq_u32 vcc, -1, v12
  s_cbranch_vccnz va_poll_41
  ds_read_b128 v[56:59], v2 offset:0
  ds_read_b128 v[60:63], v2 offset:4096
  ds_read_b128 v[64:67], v2 offset:8192
  ds_read_b128 v[68:71], v2 offset:12288
  ds_read_b128 v[72:75], v2 offset:16384
  ds_read_b128 v[76:79], v2 offset:20480
  ds_read_b128 v[80:83], v2 offset:24576
  ds_read_b128 v[84:87], v2 offset:28672
  ds_read_b128 v[88:91], v2 offset:32768
  ds_read_b128 v[92:95], v2 offset:36864
  ds_read_b128 v[96:99], v2 offset:40960
  ds_read_b128 v[100:103], v2 offset:45056
  v_mov_b32 v104, 0
  v_mov_b32 v105, 0
  v_mov_b32 v106, 0
  v_mov_b32 v107, 0
  v_mov_b32 v108, 0
  v_mov_b32 v109, 0
  v_mov_b32 v110, 0
  v_mov_b32 v111, 0
  v_mov_b32 v112, 0
  v_mov_b32 v113, 0
  v_mov_b32 v114, 0
  v_mov_b32 v115, 0
  s_waitcnt lgkmcnt(0)
  s_branch va_go_38
L_owner:
  s_cmp_lg_u32 s42, 0
  s_cbranch_scc1 L_end
  s_mul_i32 s62, s43, 10
  s_add_u32 s62, s62, s44
  s_sub_u32 s62, s62, 16
  s_mov_b32 s12, s24
  s_mov_b32 s13, s25
  s_mov_b32 s14, 10240
  s_mov_b32 s15, 0x20000
  v_and_b32 v12, 1, v0
  v_lshlrev_b32 v12, 7, v12
  v_add_u32 v12, 3014656, v12
  s_mov_b32 s50, 0
pol_42:
  buffer_load_dword v10, v12, s[8:11], 0 offen sc1
  s_add_u32 s50, s50, 1
  s_cmp_gt_u32 s50, 131072
  s_cbranch_scc1 L_fail
  s_waitcnt vmcnt(0)
  v_cmp_eq_u32 vcc, 0, v10
  s_cbranch_vccnz pol_42
  v_readlane_b32 s54, v10, 0
  v_readlane_b32 s55, v10, 1
  s_and_b32 s54, s54, 0x2000
  s_and_b32 s55, s55, 0x2000
  s_mov_b32 s68, 0xfffffffe
  v_and_b32 v10, 3, v0
  s_lshl_b32 s46, s43, 9
  s_add_u32 s46, s46, s55
  s_add_u32 s46, s46, 2885632
  v_lshl_add_u32 v6, v10, 7, s46
  s_lshl_b32 s46, s43, 7
  s_add_u32 s46, s46, s55
  s_add_u32 s46, s46, 2883584
  v_lshl_add_u32 v7, v10, 9, s46
  v_mov_b32 v5, 0x44444444
  v_mov_b32 v10, 0xeeeeeeee
  v_and_b32 v11, 8, v0
  v_cmp_ne_u32 vcc, 0, v11
  s_nop 1
  v_cndmask_b32 v5, v5, v10, vcc
  v_lshlrev_b32 v1, 4, v0
  v_and_b32 v10, 15, v0
  v_lshrrev_b32 v11, 4, v0
  v_lshlrev_b32 v2, 3, v10
  v_lshl_add_u32 v2, v11, 8, v2
  v_and_b32 v12, 1, v11
  v_lshlrev_b32 v12, 2, v12
  v_lshrrev_b32 v13, 1, v11
  v_add_u32 v12, v12, v13
  v_and_b32 v13, 1, v10
  v_lshl_add_u32 v12, v13, 1, v12
  v_mov_b32 v4, 0x05040100
  v_mov_b32 v14, 0x03020706
  v_cmp_eq_u32 vcc, 1, v13
  s_nop 1
  v_cndmask_b32 v4, v4, v14, vcc
  v_bfe_u32 v13, v10, 1, 1
  v_lshl_add_u32 v3, v13, 3, v12
  v_lshlrev_b32 v3, 4, v3
  v_lshrrev_b32 v13, 2, v10
  v_lshl_add_u32 v3, v13, 2, v3
  s_lshl_b32 s46, s62, 8
  s_cmp_ge_u32 s62, 32
  s_cselect_b32 s47, 40960, 0
  s_add_u32 s46, s46, s47
  s_add_u32 s46, s46, s55
  s_add_u32 s46, s46, 2097152
  v_add_u32 v3, s46, v3
  v_mul_u32_u24 v12, 1280, v12
  v_and_b32 v13, 14, v10
  v_lshl_add_u32 v12, v13, 1, v12
  s_lshl_b32 s46, s62, 5
  buffer_load_dword v15, v12, s[12:15], s46 offen
  v_and_b32 v9, 31, v0
  v_lshlrev_b32 v9, 7, v9
  s_and_b32 s46, s62, 3
  s_lshl_b32 s46, s46, 2
  s_add_u32 s46, s46, 2949120
  v_add_u32 v9, s46, v9
  s_lshl_b32 s63, s62, 15
  s_add_u32 s63, s63, 83886080
  s_sub_u32 s67, s44, 16
  s_mov_b32 s61, 0
  s_mov_b32 s52, 0
  s_mov_b32 s58, 0
  s_mov_b32 s100, 0
  s_waitcnt vmcnt(0)
  v_min_u32 v15, s68, v15
  s_mov_b32 s46, 0
  buffer_store_dword v15, v3, s[8:11], s46 offen sc1
  s_mov_b32 s46, 65536
  buffer_store_dword v15, v3, s[8:11], s46 offen sc1
  s_mov_b32 s46, 131072
  buffer_store_dword v15, v3, s[8:11], s46 offen sc1
  s_mov_b32 s46, 196608
  buffer_store_dword v15, v3, s[8:11], s46 offen sc1
  s_mov_b32 s53, 1
  s_cmp_lg_u32 s67, 0
  s_cbranch_scc1 ow_r0
  v_mov_b32 v16, s53
  s_mov_b64 exec, 15
  buffer_store_dword v16, v7, s[8:11], 0 offen sc1
  s_mov_b64 exec, -1
ow_r0:
ow_loop:
  s_add_u32 s53, s52, 1
  s_cmp_ge_u32 s61, s53
  s_cbranch_scc1 wf_done_43
  s_mov_b32 s50, 0
wf_loop_44:
  buffer_load_dword v10, v9, s[8:11], 0 offen sc1
  s_add_u32 s50, s50, 1
  s_cmp_gt_u32 s50, 131072
  s_cbranch_scc1 L_fail
  s_waitcnt vmcnt(0)
  v_min_u32_dpp v10, v10, v10 row_ror:8 row_mask:0xf bank_mask:0xf
  s_nop 1
  v_min_u32_dpp v10, v10, v10 row_ror:4 row_mask:0xf bank_mask:0xf
  s_nop 1
  v_min_u32_dpp v10, v10, v10 row_ror:2 row_mask:0xf bank_mask:0xf
  s_nop 1
  v_min_u32_dpp v10, v10, v10 row_ror:1 row_mask:0xf bank_mask:0xf
  v_mov_b32 v11, v10
  s_nop 1
  v_permlane16_swap_b32 v11, v10
  v_min_u32 v10, v10, v11
  v_mov_b32 v11, v10
  s_nop 1
  v_permlane32_swap_b32 v11, v10
  v_min_u32 v10, v10, v11
  s_nop 0
  v_readfirstlane_b32 s61, v10
  s_nop 0
  s_cmp_lt_u32 s61, s53
  s_cbranch_scc1 wf_loop_44
wf_done_43:
  s_add_u32 s46, s63, 0
  buffer_load_dwordx4 a[0:3], v1, s[8:11], s46 offen offset:0 sc1
  buffer_load_dwordx4 a[4:7], v1, s[8:11], s46 offen offset:1024 sc1
  buffer_load_dwordx4 a[8:11], v1, s[8:11], s46 offen offset:2048 sc1
  buffer_load_dwordx4 a[12:15], v1, s[8:11], s46 offen offset:3072 sc1
  s_add_u32 s46, s63, 4096
  buffer_load_dwordx4 a[16:19], v1, s[8:11], s46 offen offset:0 sc1
  buffer_load_dwordx4 a[20:23], v1, s[8:11], s46 offen offset:1024 sc1
  buffer_load_dwordx4 a[24:27], v1, s[8:11], s46 offen offset:2048 sc1
  buffer_load_dwordx4 a[28:31], v1, s[8:11], s46 offen offset:3072 sc1
  s_add_u32 s46, s63, 8192
  buffer_load_dwordx4 a[32:35], v1, s[8:11], s46 offen offset:0 sc1
  buffer_load_dwordx4 a[36:39], v1, s[8:11], s46 offen offset:1024 sc1
  buffer_load_dwordx4 a[40:43], v1, s[8:11], s46 offen offset:2048 sc1
  buffer_load_dwordx4 a[44:47], v1, s[8:11], s46 offen offset:3072 sc1
  s_add_u32 s46, s63, 12288
  buffer_load_dwordx4 a[48:51], v1, s[8:11], s46 offen offset:0 sc1
  buffer_load_dwordx4 a[52:55], v1, s[8:11], s46 offen offset:1024 sc1
  buffer_load_dwordx4 a[56:59], v1, s[8:11], s46 offen offset:2048 sc1
  buffer_load_dwordx4 a[60:63], v1, s[8:11], s46 offen offset:3072 sc1
  s_add_u32 s46, s63, 16384
  buffer_load_dwordx4 a[64:67], v1, s[8:11], s46 offen offset:0 sc1
  buffer_load_dwordx4 a[68:71], v1, s[8:11], s46 offen offset:1024 sc1
  buffer_load_dwordx4 a[72:75], v1, s[8:11], s46 offen offset:2048 sc1
  buffer_load_dwordx4 a[76:79], v1, s[8:11], s46 offen offset:3072 sc1
  s_add_u32 s46, s63, 20480
  buffer_load_dwordx4 a[80:83], v1, s[8:11], s46 offen offset:0 sc1
  buffer_load_dwordx4 a[84:87], v1, s[8:11], s46 offen offset:1024 sc1
  buffer_load_dwordx4 a[88:91], v1, s[8:11], s46 offen offset:2048 sc1
  buffer_load_dwordx4 a[92:95], v1, s[8:11], s46 offen offset:3072 sc1
  s_add_u32 s46, s63, 24576
  buffer_load_dwordx4 a[96:99], v1, s[8:11], s46 offen offset:0 sc1
  buffer_load_dwordx4 a[100:103], v1, s[8:11], s46 offen offset:1024 sc1
  buffer_load_dwordx4 a[104:107], v1, s[8:11], s46 offen offset:2048 sc1
  buffer_load_dwordx4 a[108:111], v1, s[8:11], s46 offen offset:3072 sc1
  s_add_u32 s46, s63, 28672
  buffer_load_dwordx4 a[112:115], v1, s[8:11], s46 offen offset:0 sc1
  buffer_load_dwordx4 a[116:119], v1, s[8:11], s46 offen offset:1024 sc1
  buffer_load_dwordx4 a[120:123], v1, s[8:11], s46 offen offset:2048 sc1
  buffer_load_dwordx4 a[124:127], v1, s[8:11], s46 offen offset:3072 sc1
  s_add_u32 s63, s63, 1310720
  s_lshl_b32 s56, s58, 2
  s_add_u32 s56, s56, s43
  s_lshl_b32 s56, s56, 16
  s_add_u32 s56, s56, s55
  s_add_u32 s56, s56, 2097152
  s_add_u32 s66, s58, 1
  s_cmp_eq_u32 s66, 3
  s_cselect_b32 s66, 0, s66
  s_mul_i32 s72, s58, 655360
  s_lshl_b32 s46, s62, 14
  s_add_u32 s72, s72, s46
  s_add_u32 s72, s72, s54
  s_add_u32 s73, s72, 4096
  s_add_u32 s74, s56, 16384
  s_add_u32 s75, s56, 20480
  s_add_u32 s76, s56, 32768
  s_add_u32 s77, s56, 36864
  s_add_u32 s78, s56, 51200
  s_lshl_b32 s80, s66, 18
  s_add_u32 s81, s80, 65536
  s_add_u32 s82, s80, 131072
  s_add_u32 s83, s80, 196608
  s_add_u32 s64, s52, 2
  v_mov_b32 v20, 0
  v_mov_b32 v21, 0
  v_mov_b32 v22, 0
  v_mov_b32 v23, 0
  s_waitcnt vmcnt(0)
  s_mov_b32 s50, 0
  s_mov_b64 exec, 15
  buffer_load_dword v136, v6, s[8:11], 0 offen sc1
  s_nop 11
  buffer_load_dword v137, v6, s[8:11], 0 offen sc1
  s_nop 11
  buffer_load_dword v138, v6, s[8:11], 0 offen sc1
  s_nop 11
  buffer_load_dword v139, v6, s[8:11], 0 offen sc1
  s_nop 11
  buffer_load_dword v140, v6, s[8:11], 0 offen sc1
  s_nop 11
  buffer_load_dword v141, v6, s[8:11], 0 offen sc1
  s_nop 11
  buffer_load_dword v142, v6, s[8:11], 0 offen sc1
  s_nop 11
  buffer_load_dword v143, v6, s[8:11], 0 offen sc1
  s_nop 11
  buffer_load_dword v144, v6, s[8:11], 0 offen sc1
  s_nop 11
bell_45:
  buffer_load_dword v145, v6, s[8:11], 0 offen sc1
  s_waitcnt vmcnt(9)
  v_cmp_gt_u32 vcc, s53, v136
  s_cbranch_vccz bell_x_46
  s_nop 7
  buffer_load_dword v136, v6, s[8:11], 0 offen sc1
  s_waitcnt vmcnt(9)
  v_cmp_gt_u32 vcc, s53, v137
  s_cbranch_vccz bell_x_46
  s_nop 7
  buffer_load_dword v137, v6, s[8:11], 0 offen sc1
  s_waitcnt vmcnt(9)
  v_cmp_gt_u32 vcc, s53, v138
  s_cbranch_vccz bell_x_46
  s_nop 7
  buffer_load_dword v138, v6, s[8:11], 0 offen sc1
  s_waitcnt vmcnt(9)
  v_cmp_gt_u32 vcc, s53, v139
  s_cbranch_vccz bell_x_46
  s_nop 7
  buffer_load_dword v139, v6, s[8:11], 0 offen sc1
  s_waitcnt vmcnt(9)
  v_cmp_gt_u32 vcc, s53, v140
  s_cbranch_vccz bell_x_46
  s_nop 7
  buffer_load_dword v140, v6, s[8:11], 0 offen sc1
  s_waitcnt vmcnt(9)
  v_cmp_gt_u32 vcc, s53, v141
  s_cbranch_vccz bell_x_46
  s_nop 7
  buffer_load_dword v141, v6, s[8:11], 0 offen sc1
  s_waitcnt vmcnt(9)
  v_cmp_gt_u32 vcc, s53, v142
  s_cbranch_vccz bell_x_46
  s_nop 7
  buffer_load_dword v142, v6, s[8:11], 0 offen sc1
  s_waitcnt vmcnt(9)
  v_cmp_gt_u32 vcc, s53, v143
  s_cbranch_vccz bell_x_46
  s_nop 7
  buffer_load_dword v143, v6, s[8:11], 0 offen sc1
  s_waitcnt vmcnt(9)
  v_cmp_gt_u32 vcc, s53, v144
  s_cbranch_vccz bell_x_46
  s_nop 7
  buffer_load_dword v144, v6, s[8:11], 0 offen sc1
  s_waitcnt vmcnt(9)
  v_cmp_gt_u32 vcc, s53, v145
  s_cbranch_vccz bell_x_46
  s_add_u32 s50, s50, 1
  s_cmp_gt_u32 s50, 131072
  s_cbranch_scc1 L_fail
  s_branch bell_45
bell_x_46:
  s_mov_b64 exec, -1
  buffer_load_dwordx4 v[24:27], v1, s[8:11], s72 offen offset:0 sc1
  buffer_load_dwordx4 v[28:31], v1, s[8:11], s72 offen offset:1024 sc1
  buffer_load_dwordx4 v[32:35], v1, s[8:11], s72 offen offset:2048 sc1
  buffer_load_dwordx4 v[36:39], v1, s[8:11], s72 offen offset:3072 sc1
  buffer_load_dwordx4 v[40:43], v1, s[8:11], s73 offen offset:0 sc1
  buffer_load_dwordx4 v[44:47], v1, s[8:11], s73 offen offset:1024 sc1
  buffer_load_dwordx4 v[48:51], v1, s[8:11], s73 offen offset:2048 sc1
  buffer_load_dwordx4 v[52:55], v1, s[8:11], s73 offen offset:3072 sc1
  buffer_load_dwordx2 v[56:57], v2, s[8:11], s78 offen offset:0 sc1
  buffer_load_dwordx2 v[58:59], v2, s[8:11], s78 offen offset:128 sc1
  buffer_load_dwordx2 v[60:61], v2, s[8:11], s78 offen offset:1024 sc1
  buffer_load_dwordx2 v[62:63], v2, s[8:11], s78 offen offset:1152 sc1
  buffer_load_dwordx2 v[64:65], v2, s[8:11], s78 offen offset:2048 sc1
  buffer_load_dwordx2 v[66:67], v2, s[8:11], s78 offen offset:2176 sc1
  buffer_load_dwordx2 v[68:69], v2, s[8:11], s78 offen offset:3072 sc1
  buffer_load_dwordx2 v[70:71], v2, s[8:11], s78 offen offset:3200 sc1
  buffer_load_dwordx4 v[72:75], v1, s[8:11], s74 offen offset:0 sc1
  buffer_load_dwordx4 v[76:79], v1, s[8:11], s74 offen offset:1024 sc1
  buffer_load_dwordx4 v[80:83], v1, s[8:11], s74 offen offset:2048 sc1
  buffer_load_dwordx4 v[84:87], v1, s[8:11], s74 offen offset:3072 sc1
  buffer_load_dwordx4 v[88:91], v1, s[8:11], s75 offen offset:0 sc1
  buffer_load_dwordx4 v[92:95], v1, s[8:11], s75 offen offset:1024 sc1
  buffer_load_dwordx4 v[96:99], v1, s[8:11], s75 offen offset:2048 sc1
  buffer_load_dwordx4 v[100:103], v1, s[8:11], s75 offen offset:3072 sc1
  buffer_load_dwordx4 v[104:107], v1, s[8:11], s76 offen offset:0 sc1
  buffer_load_dwordx4 v[108:111], v1, s[8:11], s76 offen offset:1024 sc1
  buffer_load_dwordx4 v[112:115], v1, s[8:11], s76 offen offset:2048 sc1
  buffer_load_dwordx4 v[116:119], v1, s[8:11], s76 offen offset:3072 sc1
  buffer_load_dwordx4 v[120:123], v1, s[8:11], s77 offen offset:0 sc1
  buffer_load_dwordx4 v[124:127], v1, s[8:11], s77 offen offset:1024 sc1
  buffer_load_dwordx4 v[128:131], v1, s[8:11], s77 offen offset:2048 sc1
  buffer_load_dwordx4 v[132:135], v1, s[8:11], s77 offen offset:3072 sc1
  v_mov_b32 v16, s64
  v_mov_b32 v17, 2146435072
  s_cmp_eq_u32 s67, 0
  s_cselect_b64 vcc, 15, 0
  v_cndmask_b32 v17, v17, v7, vcc
  buffer_store_dword v16, v17, s[8:11], 0 offen sc1
  s_waitcnt vmcnt(32)
  v_max3_u32 v8, v24, v25, v26
  v_max3_u32 v8, v26, v27, v8
  s_waitcnt vmcnt(31)
  v_max3_u32 v8, v28, v29, v8
  v_max3_u32 v8, v30, v31, v8
  s_waitcnt vmcnt(30)
  v_max3_u32 v8, v32, v33, v8
  v_max3_u32 v8, v34, v35, v8
  s_waitcnt vmcnt(29)
  v_max3_u32 v8, v36, v37, v8
  v_max3_u32 v8, v38, v39, v8
  s_waitcnt vmcnt(28)
  v_max3_u32 v8, v40, v41, v8
  v_max3_u32 v8, v42, v43, v8
  s_waitcnt vmcnt(27)
  v_max3_u32 v8, v44, v45, v8
  v_max3_u32 v8, v46, v47, v8
  s_waitcnt vmcnt(26)
  v_max3_u32 v8, v48, v49, v8
  v_max3_u32 v8, v50, v51, v8
  s_waitcnt vmcnt(25)
  v_max3_u32 v8, v52, v53, v8
  v_max3_u32 v8, v54, v55, v8
ow_go:
  s_waitcnt vmcnt(23)
  v_smfmac_f32_16x16x64_bf16 v[20:23], v[56:59], v[24:31], v5
  v_max3_u32 v8, v56, v57, v8
  v_max3_u32 v8, v58, v59, v8
  s_waitcnt vmcnt(21)
  v_smfmac_f32_16x16x64_bf16 v[20:23], v[60:63], v[32:39], v5
  v_max3_u32 v8, v60, v61, v8
  v_max3_u32 v8, v62, v63, v8
  s_waitcnt vmcnt(19)
  v_smfmac_f32_16x16x64_bf16 v[20:23], v[64:67], v[40:47], v5
  v_max3_u32 v8, v64, v65, v8
  v_max3_u32 v8, v66, v67, v8
  s_waitcnt vmcnt(17)
  v_smfmac_f32_16x16x64_bf16 v[20:23], v[68:71], v[48:55], v5
  v_max3_u32 v8, v68, v69, v8
  v_max3_u32 v8, v70, v71, v8
  s_waitcnt vmcnt(16)
  v_smfmac_f32_16x16x64_bf16 v[20:23], v[72:75], a[0:7], v5
  v_max3_u32 v8, v72, v73, v8
  v_max3_u32 v8, v74, v75, v8
  s_waitcnt vmcnt(15)
  v_smfmac_f32_16x16x64_bf16 v[20:23], v[76:79], a[8:15], v5
  v_max3_u32 v8, v76, v77, v8
  v_max3_u32 v8, v78, v79, v8
  s_waitcnt vmcnt(14)
  v_smfmac_f32_16x16x64_bf16 v[20:23], v[80:83], a[16:23], v5
  v_max3_u32 v8, v80, v81, v8
  v_max3_u32 v8, v82, v83, v8
  s_waitcnt vmcnt(13)
  v_smfmac_f32_16x16x64_bf16 v[20:23], v[84:87], a[24:31], v5
  v_max3_u32 v8, v84, v85, v8
  v_max3_u32 v8, v86, v87, v8
  s_waitcnt vmcnt(12)
  v_smfmac_f32_16x16x64_bf16 v[20:23], v[88:91], a[32:39], v5
  v_max3_u32 v8, v88, v89, v8
  v_max3_u32 v8, v90, v91, v8
  s_waitcnt vmcnt(11)
  v_smfmac_f32_16x16x64_bf16 v[20:23], v[92:95], a[40:47], v5
  v_max3_u32 v8, v92, v93, v8
  v_max3_u32 v8, v94, v95, v8
  s_waitcnt vmcnt(10)
  v_smfmac_f32_16x16x64_bf16 v[20:23], v[96:99], a[48:55], v5
  v_max3_u32 v8, v96, v97, v8
  v_max3_u32 v8, v98, v99, v8
  s_waitcnt vmcnt(9)
  v_smfmac_f32_16x16x64_bf16 v[20:23], v[100:103], a[56:63], v5
  v_max3_u32 v8, v100, v101, v8
  v_max3_u32 v8, v102, v103, v8
  s_waitcnt vmcnt(8)
  v_smfmac_f32_16x16x64_bf16 v[20:23], v[104:107], a[64:71], v5
  v_max3_u32 v8, v104, v105, v8
  v_max3_u32 v8, v106, v107, v8
  s_waitcnt vmcnt(7)
  v_smfmac_f32_16x16x64_bf16 v[20:23], v[108:111], a[72:79], v5
  v_max3_u32 v8, v108, v109, v8
  v_max3_u32 v8, v110, v111, v8
  s_waitcnt vmcnt(6)
  v_smfmac_f32_16x16x64_bf16 v[20:23], v[112:115], a[80:87], v5
  v_max3_u32 v8, v112, v113, v8
  v_max3_u32 v8, v114, v115, v8
  s_waitcnt vmcnt(5)
  v_smfmac_f32_16x16x64_bf16 v[20:23], v[116:119], a[88:95], v5
  v_max3_u32 v8, v116, v117, v8
  v_max3_u32 v8, v118, v119, v8
  s_waitcnt vmcnt(4)
  v_smfmac_f32_16x16x64_bf16 v[20:23], v[120:123], a[96:103], v5
  v_max3_u32 v8, v120, v121, v8
  v_max3_u32 v8, v122, v123, v8
  s_waitcnt vmcnt(3)
  v_smfmac_f32_16x16x64_bf16 v[20:23], v[124:127], a[104:111], v5
  v_max3_u32 v8, v124, v125, v8
  v_max3_u32 v8, v126, v127, v8
  s_waitcnt vmcnt(2)
  v_smfmac_f32_16x16x64_bf16 v[20:23], v[128:131], a[112:119], v5
  v_max3_u32 v8, v128, v129, v8
  v_max3_u32 v8, v130, v131, v8
  s_waitcnt vmcnt(1)
  v_smfmac_f32_16x16x64_bf16 v[20:23], v[132:135], a[120:127], v5
  v_max3_u32 v8, v132, v133, v8
  v_max3_u32 v8, v134, v135, v8
  v_cmp_eq_u32 vcc, -1, v8
  s_cbranch_vccnz ow_redo
  s_nop 3
  v_permlane32_swap_b32 v20, v21
  v_permlane32_swap_b32 v22, v23
  v_add_f32 v20, v20, v21
  v_add_f32 v22, v22, v23
  v_cvt_pk_bf16_f32 v10, v20, v22
  s_nop 1
  v_mov_b32_dpp v11, v10 quad_perm:[1,0,3,2] row_mask:0xf bank_mask:0xf
  v_perm_b32 v10, v11, v10, v4
  v_min_u32 v10, s68, v10
  buffer_store_dword v10, v3, s[8:11], s80 offen sc1
  buffer_store_dword v10, v3, s[8:11], s81 offen sc1
  buffer_store_dword v10, v3, s[8:11], s82 offen sc1
  buffer_store_dword v10, v3, s[8:11], s83 offen sc1
  v_mov_b32 v11, -1
  s_lshl_b32 s47, s58, 18
  s_add_u32 s46, s47, 0
  buffer_store_dword v11, v3, s[8:11], s46 offen sc1
  s_add_u32 s46, s47, 65536
  buffer_store_dword v11, v3, s[8:11], s46 offen sc1
  s_add_u32 s46, s47, 131072
  buffer_store_dword v11, v3, s[8:11], s46 offen sc1
  s_add_u32 s46, s47, 196608
  buffer_store_dword v11, v3, s[8:11], s46 offen sc1
  s_mov_b32 s58, s66
  s_mov_b32 s52, s53
  s_cmp_lt_u32 s52, 63
  s_cbranch_scc1 ow_loop
  s_endpgm
ow_redo:
  s_mov_b32 s50, 0
ow_poll:
  buffer_load_dwordx4 v[24:27], v1, s[8:11], s72 offen offset:0 sc1
  buffer_load_dwordx4 v[28:31], v1, s[8:11], s72 offen offset:1024 sc1
  buffer_load_dwordx4 v[32:35], v1, s[8:11], s72 offen offset:2048 sc1
  buffer_load_dwordx4 v[36:39], v1, s[8:11], s72 offen offset:3072 sc1
  buffer_load_dwordx4 v[40:43], v1, s[8:11], s73 offen offset:0 sc1
  buffer_load_dwordx4 v[44:47], v1, s[8:11], s73 offen offset:1024 sc1
  buffer_load_dwordx4 v[48:51], v1, s[8:11], s73 offen offset:2048 sc1
  buffer_load_dwordx4 v[52:55], v1, s[8:11], s73 offen offset:3072 sc1
  buffer_load_dwordx2 v[56:57], v2, s[8:11], s78 offen offset:0 sc1
  buffer_load_dwordx2 v[58:59], v2, s[8:11], s78 offen offset:128 sc1
  buffer_load_dwordx2 v[60:61], v2, s[8:11], s78 offen offset:1024 sc1
  buffer_load_dwordx2 v[62:63], v2, s[8:11], s78 offen offset:1152 sc1
  buffer_load_dwordx2 v[64:65], v2, s[8:11], s78 offen offset:2048 sc1
  buffer_load_dwordx2 v[66:67], v2, s[8:11], s78 offen offset:2176 sc1
  buffer_load_dwordx2 v[68:69], v2, s[8:11], s78 offen offset:3072 sc1
  buffer_load_dwordx2 v[70:71], v2, s[8:11], s78 offen offset:3200 sc1
  buffer_load_dwordx4 v[72:75], v1, s[8:11], s74 offen offset:0 sc1
  buffer_load_dwordx4 v[76:79], v1, s[8:11], s74 offen offset:1024 sc1
  buffer_load_dwordx4 v[80:83], v1, s[8:11], s74 offen offset:2048 sc1
  buffer_load_dwordx4 v[84:87], v1, s[8:11], s74 offen offset:3072 sc1
  buffer_load_dwordx4 v[88:91], v1, s[8:11], s75 offen offset:0 sc1
  buffer_load_dwordx4 v[92:95], v1, s[8:11], s75 offen offset:1024 sc1
  buffer_load_dwordx4 v[96:99], v1, s[8:11], s75 offen offset:2048 sc1
  buffer_load_dwordx4 v[100:103], v1, s[8:11], s75 offen offset:3072 sc1
  buffer_load_dwordx4 v[104:107], v1, s[8:11], s76 offen offset:0 sc1
  buffer_load_dwordx4 v[108:111], v1, s[8:11], s76 offen offset:1024 sc1
  buffer_load_dwordx4 v[112:115], v1, s[8:11], s76 offen offset:2048 sc1
  buffer_load_dwordx4 v[116:119], v1, s[8:11], s76 offen offset:3072 sc1
  buffer_load_dwordx4 v[120:123], v1, s[8:11], s77 offen offset:0 sc1
  buffer_load_dwordx4 v[124:127], v1, s[8:11], s77 offen offset:1024 sc1
  buffer_load_dwordx4 v[128:131], v1, s[8:11], s77 offen offset:2048 sc1
  buffer_load_dwordx4 v[132:135], v1, s[8:11], s77 offen offset:3072 sc1
  s_add_u32 s50, s50, 1
  s_cmp_gt_u32 s50, 131072
  s_cbranch_scc1 L_fail
  s_waitcnt vmcnt(0)
  v_max_u32 v8, v24, v25
  v_max3_u32 v8, v26, v27, v8
  v_max3_u32 v8, v28, v29, v8
  v_max3_u32 v8, v30, v31, v8
  v_max3_u32 v8, v32, v33, v8
  v_max3_u32 v8, v34, v35, v8
  v_max3_u32 v8, v36, v37, v8
  v_max3_u32 v8, v38, v39, v8
  v_max3_u32 v8, v40, v41, v8
  v_max3_u32 v8, v42, v43, v8
  v_max3_u32 v8, v44, v45, v8
  v_max3_u32 v8, v46, v47, v8
  v_max3_u32 v8, v48, v49, v8
  v_max3_u32 v8, v50, v51, v8
  v_max3_u32 v8, v52, v53, v8
  v_max3_u32 v8, v54, v55, v8
  v_max3_u32 v8, v56, v57, v8
  v_max3_u32 v8, v58, v59, v8
  v_max3_u32 v8, v60, v61, v8
  v_max3_u32 v8, v62, v63, v8
  v_max3_u32 v8, v64, v65, v8
  v_max3_u32 v8, v66, v67, v8
  v_max3_u32 v8, v68, v69, v8
  v_max3_u32 v8, v70, v71, v8
  v_max3_u32 v8, v72, v73, v8
  v_max3_u32 v8, v74, v75, v8
  v_max3_u32 v8, v76, v77, v8
  v_max3_u32 v8, v78, v79, v8
  v_max3_u32 v8, v80, v81, v8
  v_max3_u32 v8, v82, v83, v8
  v_max3_u32 v8, v84, v85, v8
  v_max3_u32 v8, v86, v87, v8
  v_max3_u32 v8, v88, v89, v8
  v_max3_u32 v8, v90, v91, v8
  v_max3_u32 v8, v92, v93, v8
  v_max3_u32 v8, v94, v95, v8
  v_max3_u32 v8, v96, v97, v8
  v_max3_u32 v8, v98, v99, v8
  v_max3_u32 v8, v100, v101, v8
  v_max3_u32 v8, v102, v103, v8
  v_max3_u32 v8, v104, v105, v8
  v_max3_u32 v8, v106, v107, v8
  v_max3_u32 v8, v108, v109, v8
  v_max3_u32 v8, v110, v111, v8
  v_max3_u32 v8, v112, v113, v8
  v_max3_u32 v8, v114, v115, v8
  v_max3_u32 v8, v116, v117, v8
  v_max3_u32 v8, v118, v119, v8
  v_max3_u32 v8, v120, v121, v8
  v_max3_u32 v8, v122, v123, v8
  v_max3_u32 v8, v124, v125, v8
  v_max3_u32 v8, v126, v127, v8
  v_max3_u32 v8, v128, v129, v8
  v_max3_u32 v8, v130, v131, v8
  v_max3_u32 v8, v132, v133, v8
  v_max3_u32 v8, v134, v135, v8
  v_cmp_eq_u32 vcc, -1, v8
  s_cbranch_vccnz ow_poll
  v_mov_b32 v20, 0
  v_mov_b32 v21, 0
  v_mov_b32 v22, 0
  v_mov_b32 v23, 0
  s_branch ow_go
L_xowner:
  s_mov_b32 s12, s36
  s_mov_b32 s13, s37
  s_mov_b32 s14, 5242880
  s_mov_b32 s15, 0x20000
  s_sub_u32 s48, s44, 26
  s_and_b32 s46, s48, 1
  s_mul_i32 s46, s46, 5
  s_mul_i32 s62, s43, 10
  s_add_u32 s62, s62, s46
  s_lshr_b32 s52, s48, 1
  v_lshlrev_b32 v1, 4, v0
  v_and_b32 v10, 7, v0
  v_lshlrev_b32 v10, 7, v10
  v_add_u32 v10, s51, v10
  v_bfe_u32 v11, v0, 3, 2
  v_lshl_add_u32 v2, v11, 2, v10
  v_add_u32 v3, 2965504, v2
  v_add_u32 v2, 2949120, v2
  v_bfe_u32 v11, v0, 3, 1
  v_lshl_add_u32 v4, v11, 2, v10
  v_add_u32 v4, 2981888, v4
  v_cmp_lt_u32 vcc, 31, v0
  s_nop 1
  v_cndmask_b32 v3, v3, v4, vcc
  s_mul_i32 s46, s42, 10240
  v_add_u32 v5, s46, v1
  v_add_u32 v6, s51, v1
  s_lshl_b32 s63, s62, 15
  s_lshl_b32 s46, s42, 13
  s_add_u32 s63, s63, s46
  s_mul_i32 s47, s52, 1310720
  s_add_u32 s63, s63, s47
  s_add_u32 s63, s63, 83886080
  s_mul_i32 s65, s52, 81920
  s_add_u32 s65, s65, 188743680
  s_lshl_b32 s64, s62, 13
  s_lshl_b32 s46, s42, 11
  s_add_u32 s64, s64, s46
  s_mul_i32 s47, s52, 327680
  s_add_u32 s64, s64, s47
  s_add_u32 s64, s64, 167772160
  s_mul_i32 s66, s52, 81920
  v_and_b32 v10, 15, v0
  v_mul_u32_u24 v10, 2560, v10
  v_lshrrev_b32 v11, 4, v0
  v_lshl_add_u32 v10, v11, 3, v10
  s_add_u32 s46, s42, 0
  s_cmp_ge_u32 s46, 5
  s_cselect_b32 s47, 40800, 0
  s_add_u32 s48, s46, s62
  s_lshl_b32 s48, s48, 5
  s_add_u32 s47, s47, s48
  s_add_u32 s47, s47, 1280
  s_cmp_ge_u32 s46, 10
  s_cselect_b32 s47, 2146435072, s47
  v_add_u32 v7, s47, v10
  s_add_u32 s46, s42, 4
  s_cmp_ge_u32 s46, 5
  s_cselect_b32 s47, 40800, 0
  s_add_u32 s48, s46, s62
  s_lshl_b32 s48, s48, 5
  s_add_u32 s47, s47, s48
  s_add_u32 s47, s47, 1280
  s_cmp_ge_u32 s46, 10
  s_cselect_b32 s47, 2146435072, s47
  v_add_u32 v8, s47, v10
  s_add_u32 s46, s42, 8
  s_cmp_ge_u32 s46, 5
  s_cselect_b32 s47, 40800, 0
  s_add_u32 s48, s46, s62
  s_lshl_b32 s48, s48, 5
  s_add_u32 s47, s47, s48
  s_add_u32 s47, s47, 1280
  s_cmp_ge_u32 s46, 10
  s_cselect_b32 s47, 2146435072, s47
  v_add_u32 v9, s47, v10
  s_mov_b32 s60, 0
  s_mov_b32 s61, 0
xo_loop:
  s_add_u32 s53, s52, 1
  s_cmp_ge_u32 s60, s53
  s_cbranch_scc1 wf_done_47
  s_mov_b32 s50, 0
wf_loop_48:
  buffer_load_dword v10, v2, s[8:11], 0 offen sc1
  s_add_u32 s50, s50, 1
  s_cmp_gt_u32 s50, 131072
  s_cbranch_scc1 L_fail
  s_waitcnt vmcnt(0)
  v_min_u32_dpp v10, v10, v10 row_ror:8 row_mask:0xf bank_mask:0xf
  s_nop 1
  v_min_u32_dpp v10, v10, v10 row_ror:4 row_mask:0xf bank_mask:0xf
  s_nop 1
  v_min_u32_dpp v10, v10, v10 row_ror:2 row_mask:0xf bank_mask:0xf
  s_nop 1
  v_min_u32_dpp v10, v10, v10 row_ror:1 row_mask:0xf bank_mask:0xf
  v_mov_b32 v11, v10
  s_nop 1
  v_permlane16_swap_b32 v11, v10
  v_min_u32 v10, v10, v11
  v_mov_b32 v11, v10
  s_nop 1
  v_permlane32_swap_b32 v11, v10
  v_min_u32 v10, v10, v11
  s_nop 0
  v_readfirstlane_b32 s60, v10
  s_nop 0
  s_cmp_lt_u32 s60, s53
  s_cbranch_scc1 wf_loop_48
wf_done_47:
  s_add_u32 s46, s63, 0
  buffer_load_dwordx4 a[0:3], v1, s[8:11], s46 offen offset:0 sc1
  buffer_load_dwordx4 a[4:7], v1, s[8:11], s46 offen offset:1024 sc1
  buffer_load_dwordx4 a[8:11], v1, s[8:11], s46 offen offset:2048 sc1
  buffer_load_dwordx4 a[12:15], v1, s[8:11], s46 offen offset:3072 sc1
  s_add_u32 s46, s63, 4096
  buffer_load_dwordx4 a[16:19], v1, s[8:11], s46 offen offset:0 sc1
  buffer_load_dwordx4 a[20:23], v1, s[8:11], s46 offen offset:1024 sc1
  buffer_load_dwordx4 a[24:27], v1, s[8:11], s46 offen offset:2048 sc1
  buffer_load_dwordx4 a[28:31], v1, s[8:11], s46 offen offset:3072 sc1
  s_add_u32 s46, s63, 32768
  buffer_load_dwordx4 a[32:35], v1, s[8:11], s46 offen offset:0 sc1
  buffer_load_dwordx4 a[36:39], v1, s[8:11], s46 offen offset:1024 sc1
  buffer_load_dwordx4 a[40:43], v1, s[8:11], s46 offen offset:2048 sc1
  buffer_load_dwordx4 a[44:47], v1, s[8:11], s46 offen offset:3072 sc1
  s_add_u32 s46, s63, 36864
  buffer_load_dwordx4 a[48:51], v1, s[8:11], s46 offen offset:0 sc1
  buffer_load_dwordx4 a[52:55], v1, s[8:11], s46 offen offset:1024 sc1
  buffer_load_dwordx4 a[56:59], v1, s[8:11], s46 offen offset:2048 sc1
  buffer_load_dwordx4 a[60:63], v1, s[8:11], s46 offen offset:3072 sc1
  s_add_u32 s46, s63, 65536
  buffer_load_dwordx4 a[64:67], v1, s[8:11], s46 offen offset:0 sc1
  buffer_load_dwordx4 a[68:71], v1, s[8:11], s46 offen offset:1024 sc1
  buffer_load_dwordx4 a[72:75], v1, s[8:11], s46 offen offset:2048 sc1
  buffer_load_dwordx4 a[76:79], v1, s[8:11], s46 offen offset:3072 sc1
  s_add_u32 s46, s63, 69632
  buffer_load_dwordx4 a[80:83], v1, s[8:11], s46 offen offset:0 sc1
  buffer_load_dwordx4 a[84:87], v1, s[8:11], s46 offen offset:1024 sc1
  buffer_load_dwordx4 a[88:91], v1, s[8:11], s46 offen offset:2048 sc1
  buffer_load_dwordx4 a[92:95], v1, s[8:11], s46 offen offset:3072 sc1
  s_add_u32 s46, s63, 98304
  buffer_load_dwordx4 a[96:99], v1, s[8:11], s46 offen offset:0 sc1
  buffer_load_dwordx4 a[100:103], v1, s[8:11], s46 offen offset:1024 sc1
  buffer_load_dwordx4 a[104:107], v1, s[8:11], s46 offen offset:2048 sc1
  buffer_load_dwordx4 a[108:111], v1, s[8:11], s46 offen offset:3072 sc1
  s_add_u32 s46, s63, 102400
  buffer_load_dwordx4 a[112:115], v1, s[8:11], s46 offen offset:0 sc1
  buffer_load_dwordx4 a[116:119], v1, s[8:11], s46 offen offset:1024 sc1
  buffer_load_dwordx4 a[120:123], v1, s[8:11], s46 offen offset:2048 sc1
  buffer_load_dwordx4 a[124:127], v1, s[8:11], s46 offen offset:3072 sc1
  s_add_u32 s46, s63, 131072
  buffer_load_dwordx4 a[128:131], v1, s[8:11], s46 offen offset:0 sc1
  buffer_load_dwordx4 a[132:135], v1, s[8:11], s46 offen offset:1024 sc1
  buffer_load_dwordx4 a[136:139], v1, s[8:11], s46 offen offset:2048 sc1
  buffer_load_dwordx4 a[140:143], v1, s[8:11], s46 offen offset:3072 sc1
  s_add_u32 s46, s63, 135168
  buffer_load_dwordx4 a[144:147], v1, s[8:11], s46 offen offset:0 sc1
  buffer_load_dwordx4 a[148:151], v1, s[8:11], s46 offen offset:1024 sc1
  buffer_load_dwordx4 a[152:155], v1, s[8:11], s46 offen offset:2048 sc1
  buffer_load_dwordx4 a[156:159], v1, s[8:11], s46 offen offset:3072 sc1
  s_waitcnt vmcnt(24)
  s_cmp_ge_u32 s61, s53
  s_cbranch_scc1 wf_done_49
  s_mov_b32 s50, 0
wf_loop_50:
  buffer_load_dword v10, v3, s[8:11], 0 offen sc1
  s_add_u32 s50, s50, 1
  s_cmp_gt_u32 s50, 131072
  s_cbranch_scc1 L_fail
  s_waitcnt vmcnt(0)
  v_min_u32_dpp v10, v10, v10 row_ror:8 row_mask:0xf bank_mask:0xf
  s_nop 1
  v_min_u32_dpp v10, v10, v10 row_ror:4 row_mask:0xf bank_mask:0xf
  s_nop 1
  v_min_u32_dpp v10, v10, v10 row_ror:2 row_mask:0xf bank_mask:0xf
  s_nop 1
  v_min_u32_dpp v10, v10, v10 row_ror:1 row_mask:0xf bank_mask:0xf
  v_mov_b32 v11, v10
  s_nop 1
  v_permlane16_swap_b32 v11, v10
  v_min_u32 v10, v10, v11
  v_mov_b32 v11, v10
  s_nop 1
  v_permlane32_swap_b32 v11, v10
  v_min_u32 v10, v10, v11
  s_nop 0
  v_readfirstlane_b32 s61, v10
  s_nop 0
  s_cmp_lt_u32 s61, s53
  s_cbranch_scc1 wf_loop_50
wf_done_49:
  s_lshl_b32 s47, s42, 13
  s_add_u32 s47, s47, s65
  s_lshl_b32 s48, s42, 11
  s_add_u32 s48, s48, s65
  s_add_u32 s46, s47, 0
  buffer_load_dwordx4 v[56:59], v1, s[8:11], s46 offen sc1
  s_add_u32 s46, s47, 40960
  buffer_load_dwordx4 v[60:63], v1, s[8:11], s46 offen sc1
  s_add_u32 s46, s47, 1024
  buffer_load_dwordx4 v[64:67], v1, s[8:11], s46 offen sc1
  s_add_u32 s46, s47, 41984
  buffer_load_dwordx4 v[68:71], v1, s[8:11], s46 offen sc1
  s_add_u32 s46, s47, 2048
  buffer_load_dwordx4 v[72:75], v1, s[8:11], s46 offen sc1
  s_add_u32 s46, s47, 43008
  buffer_load_dwordx4 v[76:79], v1, s[8:11], s46 offen sc1
  s_add_u32 s46, s47, 3072
  buffer_load_dwordx4 v[80:83], v1, s[8:11], s46 offen sc1
  s_add_u32 s46, s47, 44032
  buffer_load_dwordx4 v[84:87], v1, s[8:11], s46 offen sc1
  s_add_u32 s46, s47, 4096
  buffer_load_dwordx4 v[88:91], v1, s[8:11], s46 offen sc1
  s_add_u32 s46, s47, 45056
  buffer_load_dwordx4 v[92:95], v1, s[8:11], s46 offen sc1
  s_add_u32 s46, s47, 5120
  buffer_load_dwordx4 v[96:99], v1, s[8:11], s46 offen sc1
  s_add_u32 s46, s47, 46080
  buffer_load_dwordx4 v[100:103], v1, s[8:11], s46 offen sc1
  s_add_u32 s46, s47, 6144
  buffer_load_dwordx4 v[104:107], v1, s[8:11], s46 offen sc1
  s_add_u32 s46, s47, 47104
  buffer_load_dwordx4 v[108:111], v1, s[8:11], s46 offen sc1
  s_add_u32 s46, s47, 7168
  buffer_load_dwordx4 v[112:115], v1, s[8:11], s46 offen sc1
  s_add_u32 s46, s47, 48128
  buffer_load_dwordx4 v[116:119], v1, s[8:11], s46 offen sc1
  s_add_u32 s46, s48, 32768
  buffer_load_dwordx4 v[120:123], v1, s[8:11], s46 offen sc1
  s_add_u32 s46, s48, 73728
  buffer_load_dwordx4 v[124:127], v1, s[8:11], s46 offen sc1
  s_add_u32 s46, s48, 33792
  buffer_load_dwordx4 v[128:131], v1, s[8:11], s46 offen sc1
  s_add_u32 s46, s48, 74752
  buffer_load_dwordx4 v[132:135], v1, s[8:11], s46 offen sc1
  s_add_u32 s46, s64, 0
  buffer_load_dwordx4 v[16:19], v1, s[8:11], s46 offen offset:0 sc1
  buffer_load_dwordx4 v[20:23], v1, s[8:11], s46 offen offset:1024 sc1
  s_add_u32 s46, s64, 8192
  buffer_load_dwordx4 v[24:27], v1, s[8:11], s46 offen offset:0 sc1
  buffer_load_dwordx4 v[28:31], v1, s[8:11], s46 offen offset:1024 sc1
  s_add_u32 s46, s64, 16384
  buffer_load_dwordx4 v[32:35], v1, s[8:11], s46 offen offset:0 sc1
  buffer_load_dwordx4 v[36:39], v1, s[8:11], s46 offen offset:1024 sc1
  s_add_u32 s46, s64, 24576
  buffer_load_dwordx4 v[40:43], v1, s[8:11], s46 offen offset:0 sc1
  buffer_load_dwordx4 v[44:47], v1, s[8:11], s46 offen offset:1024 sc1
  s_add_u32 s46, s64, 32768
  buffer_load_dwordx4 v[48:51], v1, s[8:11], s46 offen offset:0 sc1
  buffer_load_dwordx4 v[52:55], v1, s[8:11], s46 offen offset:1024 sc1
  s_waitcnt vmcnt(29)
  v_mfma_f32_16x16x32_bf16 v[136:139], a[0:3], v[56:59], 0
  v_mfma_f32_16x16x32_bf16 v[140:143], a[32:35], v[56:59], 0
  v_mfma_f32_16x16x32_bf16 v[144:147], a[64:67], v[56:59], 0
  v_mfma_f32_16x16x32_bf16 v[148:151], a[96:99], v[56:59], 0
  v_mfma_f32_16x16x32_bf16 v[152:155], a[128:131], v[56:59], 0
  s_waitcnt vmcnt(28)
  v_mfma_f32_16x16x32_bf16 v[156:159], a[0:3], v[60:63], 0
  v_mfma_f32_16x16x32_bf16 v[160:163], a[32:35], v[60:63], 0
  v_mfma_f32_16x16x32_bf16 v[164:167], a[64:67], v[60:63], 0
  v_mfma_f32_16x16x32_bf16 v[168:171], a[96:99], v[60:63], 0
  v_mfma_f32_16x16x32_bf16 v[172:175], a[128:131], v[60:63], 0
  s_waitcnt vmcnt(27)
  v_mfma_f32_16x16x32_bf16 v[136:139], a[4:7], v[64:67], v[136:139]
  v_mfma_f32_16x16x32_bf16 v[140:143], a[36:39], v[64:67], v[140:143]
  v_mfma_f32_16x16x32_bf16 v[144:147], a[68:71], v[64:67], v[144:147]
  v_mfma_f32_16x16x32_bf16 v[148:151], a[100:103], v[64:67], v[148:151]
  v_mfma_f32_16x16x32_bf16 v[152:155], a[132:135], v[64:67], v[152:155]
  s_waitcnt vmcnt(26)
  v_mfma_f32_16x16x32_bf16 v[156:159], a[4:7], v[68:71], v[156:159]
  v_mfma_f32_16x16x32_bf16 v[160:163], a[36:39], v[68:71], v[160:163]
  v_mfma_f32_16x16x32_bf16 v[164:167], a[68:71], v[68:71], v[164:167]
  v_mfma_f32_16x16x32_bf16 v[168:171], a[100:103], v[68:71], v[168:171]
  v_mfma_f32_16x16x32_bf16 v[172:175], a[132:135], v[68:71], v[172:175]
  s_waitcnt vmcnt(25)
  v_mfma_f32_16x16x32_bf16 v[136:139], a[8:11], v[72:75], v[136:139]
  v_mfma_f32_16x16x32_bf16 v[140:143], a[40:43], v[72:75], v[140:143]
  v_mfma_f32_16x16x32_bf16 v[144:147], a[72:75], v[72:75], v[144:147]
  v_mfma_f32_16x16x32_bf16 v[148:151], a[104:107], v[72:75], v[148:151]
  v_mfma_f32_16x16x32_bf16 v[152:155], a[136:139], v[72:75], v[152:155]
  s_waitcnt vmcnt(24)
  v_mfma_f32_16x16x32_bf16 v[156:159], a[8:11], v[76:79], v[156:159]
  v_mfma_f32_16x16x32_bf16 v[160:163], a[40:43], v[76:79], v[160:163]
  v_mfma_f32_16x16x32_bf16 v[164:167], a[72:75], v[76:79], v[164:167]
  v_mfma_f32_16x16x32_bf16 v[168:171], a[104:107], v[76:79], v[168:171]
  v_mfma_f32_16x16x32_bf16 v[172:175], a[136:139], v[76:79], v[172:175]
  s_waitcnt vmcnt(23)
  v_mfma_f32_16x16x32_bf16 v[136:139], a[12:15], v[80:83], v[136:139]
  v_mfma_f32_16x16x32_bf16 v[140:143], a[44:47], v[80:83], v[140:143]
  v_mfma_f32_16x16x32_bf16 v[144:147], a[76:79], v[80:83], v[144:147]
  v_mfma_f32_16x16x32_bf16 v[148:151], a[108:111], v[80:83], v[148:151]
  v_mfma_f32_16x16x32_bf16 v[152:155], a[140:143], v[80:83], v[152:155]
  s_waitcnt vmcnt(22)
  v_mfma_f32_16x16x32_bf16 v[156:159], a[12:15], v[84:87], v[156:159]
  v_mfma_f32_16x16x32_bf16 v[160:163], a[44:47], v[84:87], v[160:163]
  v_mfma_f32_16x16x32_bf16 v[164:167], a[76:79], v[84:87], v[164:167]
  v_mfma_f32_16x16x32_bf16 v[168:171], a[108:111], v[84:87], v[168:171]
  v_mfma_f32_16x16x32_bf16 v[172:175], a[140:143], v[84:87], v[172:175]
  s_waitcnt vmcnt(21)
  v_mfma_f32_16x16x32_bf16 v[136:139], a[16:19], v[88:91], v[136:139]
  v_mfma_f32_16x16x32_bf16 v[140:143], a[48:51], v[88:91], v[140:143]
  v_mfma_f32_16x16x32_bf16 v[144:147], a[80:83], v[88:91], v[144:147]
  v_mfma_f32_16x16x32_bf16 v[148:151], a[112:115], v[88:91], v[148:151]
  v_mfma_f32_16x16x32_bf16 v[152:155], a[144:147], v[88:91], v[152:155]
  s_waitcnt vmcnt(20)
  v_mfma_f32_16x16x32_bf16 v[156:159], a[16:19], v[92:95], v[156:159]
  v_mfma_f32_16x16x32_bf16 v[160:163], a[48:51], v[92:95], v[160:163]
  v_mfma_f32_16x16x32_bf16 v[164:167], a[80:83], v[92:95], v[164:167]
  v_mfma_f32_16x16x32_bf16 v[168:171], a[112:115], v[92:95], v[168:171]
  v_mfma_f32_16x16x32_bf16 v[172:175], a[144:147], v[92:95], v[172:175]
  s_waitcnt vmcnt(19)
  v_mfma_f32_16x16x32_bf16 v[136:139], a[20:23], v[96:99], v[136:139]
  v_mfma_f32_16x16x32_bf16 v[140:143], a[52:55], v[96:99], v[140:143]
  v_mfma_f32_16x16x32_bf16 v[144:147], a[84:87], v[96:99], v[144:147]
  v_mfma_f32_16x16x32_bf16 v[148:151], a[116:119], v[96:99], v[148:151]
  v_mfma_f32_16x16x32_bf16 v[152:155], a[148:151], v[96:99], v[152:155]
  s_waitcnt vmcnt(18)
  v_mfma_f32_16x16x32_bf16 v[156:159], a[20:23], v[100:103], v[156:159]
  v_mfma_f32_16x16x32_bf16 v[160:163], a[52:55], v[100:103], v[160:163]
  v_mfma_f32_16x16x32_bf16 v[164:167], a[84:87], v[100:103], v[164:167]
  v_mfma_f32_16x16x32_bf16 v[168:171], a[116:119], v[100:103], v[168:171]
  v_mfma_f32_16x16x32_bf16 v[172:175], a[148:151], v[100:103], v[172:175]
  s_waitcnt vmcnt(17)
  v_mfma_f32_16x16x32_bf16 v[136:139], a[24:27], v[104:107], v[136:139]
  v_mfma_f32_16x16x32_bf16 v[140:143], a[56:59], v[104:107], v[140:143]
  v_mfma_f32_16x16x32_bf16 v[144:147], a[88:91], v[104:107], v[144:147]
  v_mfma_f32_16x16x32_bf16 v[148:151], a[120:123], v[104:107], v[148:151]
  v_mfma_f32_16x16x32_bf16 v[152:155], a[152:155], v[104:107], v[152:155]
  s_waitcnt vmcnt(16)
  v_mfma_f32_16x16x32_bf16 v[156:159], a[24:27], v[108:111], v[156:159]
  v_mfma_f32_16x16x32_bf16 v[160:163], a[56:59], v[108:111], v[160:163]
  v_mfma_f32_16x16x32_bf16 v[164:167], a[88:91], v[108:111], v[164:167]
  v_mfma_f32_16x16x32_bf16 v[168:171], a[120:123], v[108:111], v[168:171]
  v_mfma_f32_16x16x32_bf16 v[172:175], a[152:155], v[108:111], v[172:175]
  s_waitcnt vmcnt(15)
  v_mfma_f32_16x16x32_bf16 v[136:139], a[28:31], v[112:115], v[136:139]
  v_mfma_f32_16x16x32_bf16 v[140:143], a[60:63], v[112:115], v[140:143]
  v_mfma_f32_16x16x32_bf16 v[144:147], a[92:95], v[112:115], v[144:147]
  v_mfma_f32_16x16x32_bf16 v[148:151], a[124:127], v[112:115], v[148:151]
  v_mfma_f32_16x16x32_bf16 v[152:155], a[156:159], v[112:115], v[152:155]
  s_waitcnt vmcnt(14)
  v_mfma_f32_16x16x32_bf16 v[156:159], a[28:31], v[116:119], v[156:159]
  v_mfma_f32_16x16x32_bf16 v[160:163], a[60:63], v[116:119], v[160:163]
  v_mfma_f32_16x16x32_bf16 v[164:167], a[92:95], v[116:119], v[164:167]
  v_mfma_f32_16x16x32_bf16 v[168:171], a[124:127], v[116:119], v[168:171]
  v_mfma_f32_16x16x32_bf16 v[172:175], a[156:159], v[116:119], v[172:175]
  s_waitcnt vmcnt(8)
  v_mfma_f32_16x16x32_bf16 v[136:139], v[16:19], v[120:123], v[136:139]
  v_mfma_f32_16x16x32_bf16 v[156:159], v[16:19], v[124:127], v[156:159]
  v_mfma_f32_16x16x32_bf16 v[136:139], v[20:23], v[128:131], v[136:139]
  v_mfma_f32_16x16x32_bf16 v[156:159], v[20:23], v[132:135], v[156:159]
  s_waitcnt vmcnt(6)
  v_mfma_f32_16x16x32_bf16 v[140:143], v[24:27], v[120:123], v[140:143]
  v_mfma_f32_16x16x32_bf16 v[160:163], v[24:27], v[124:127], v[160:163]
  v_mfma_f32_16x16x32_bf16 v[140:143], v[28:31], v[128:131], v[140:143]
  v_mfma_f32_16x16x32_bf16 v[160:163], v[28:31], v[132:135], v[160:163]
  s_waitcnt vmcnt(4)
  v_mfma_f32_16x16x32_bf16 v[144:147], v[32:35], v[120:123], v[144:147]
  v_mfma_f32_16x16x32_bf16 v[164:167], v[32:35], v[124:127], v[164:167]
  v_mfma_f32_16x16x32_bf16 v[144:147], v[36:39], v[128:131], v[144:147]
  v_mfma_f32_16x16x32_bf16 v[164:167], v[36:39], v[132:135], v[164:167]
  s_waitcnt vmcnt(2)
  v_mfma_f32_16x16x32_bf16 v[148:151], v[40:43], v[120:123], v[148:151]
  v_mfma_f32_16x16x32_bf16 v[168:171], v[40:43], v[124:127], v[168:171]
  v_mfma_f32_16x16x32_bf16 v[148:151], v[44:47], v[128:131], v[148:151]
  v_mfma_f32_16x16x32_bf16 v[168:171], v[44:47], v[132:135], v[168:171]
  s_waitcnt vmcnt(0)
  v_mfma_f32_16x16x32_bf16 v[152:155], v[48:51], v[120:123], v[152:155]
  v_mfma_f32_16x16x32_bf16 v[172:175], v[48:51], v[124:127], v[172:175]
  v_mfma_f32_16x16x32_bf16 v[152:155], v[52:55], v[128:131], v[152:155]
  v_mfma_f32_16x16x32_bf16 v[172:175], v[52:55], v[132:135], v[172:175]
  s_barrier
  ds_write_b128 v5, v[136:139] offset:0
  ds_write_b128 v5, v[140:143] offset:1024
  ds_write_b128 v5, v[144:147] offset:2048
  ds_write_b128 v5, v[148:151] offset:3072
  s_nop 1
  ds_write_b128 v5, v[152:155] offset:4096
  ds_write_b128 v5, v[156:159] offset:5120
  ds_write_b128 v5, v[160:163] offset:6144
  ds_write_b128 v5, v[164:167] offset:7168
  ds_write_b128 v5, v[168:171] offset:8192
  ds_write_b128 v5, v[172:175] offset:9216
  s_waitcnt lgkmcnt(0)
  s_barrier
  ds_read_b128 v[176:179], v6 offset:0
  ds_read_b128 v[180:183], v6 offset:10240
  ds_read_b128 v[184:187], v6 offset:20480
  ds_read_b128 v[188:191], v6 offset:30720
  ds_read_b128 v[192:195], v6 offset:4096
  ds_read_b128 v[196:199], v6 offset:14336
  ds_read_b128 v[200:203], v6 offset:24576
  ds_read_b128 v[204:207], v6 offset:34816
  ds_read_b128 v[208:211], v6 offset:8192
  ds_read_b128 v[212:215], v6 offset:18432
  ds_read_b128 v[216:219], v6 offset:28672
  ds_read_b128 v[220:223], v6 offset:38912
  s_waitcnt lgkmcnt(8)
  v_add_f32 v176, v176, v180
  v_add_f32 v184, v184, v188
  v_add_f32 v176, v176, v184
  v_add_f32 v177, v177, v181
  v_add_f32 v185, v185, v189
  v_add_f32 v177, v177, v185
  v_add_f32 v178, v178, v182
  v_add_f32 v186, v186, v190
  v_add_f32 v178, v178, v186
  v_add_f32 v179, v179, v183
  v_add_f32 v187, v187, v191
  v_add_f32 v179, v179, v187
  v_cvt_pk_bf16_f32 v176, v176, v177
  v_cvt_pk_bf16_f32 v177, v178, v179
  buffer_store_dwordx2 v[176:177], v7, s[12:15], s66 offen
  s_waitcnt lgkmcnt(4)
  v_add_f32 v192, v192, v196
  v_add_f32 v200, v200, v204
  v_add_f32 v192, v192, v200
  v_add_f32 v193, v193, v197
  v_add_f32 v201, v201, v205
  v_add_f32 v193, v193, v201
  v_add_f32 v194, v194, v198
  v_add_f32 v202, v202, v206
  v_add_f32 v194, v194, v202
  v_add_f32 v195, v195, v199
  v_add_f32 v203, v203, v207
  v_add_f32 v195, v195, v203
  v_cvt_pk_bf16_f32 v192, v192, v193
  v_cvt_pk_bf16_f32 v193, v194, v195
  buffer_store_dwordx2 v[192:193], v8, s[12:15], s66 offen
  s_waitcnt lgkmcnt(0)
  v_add_f32 v208, v208, v212
  v_add_f32 v216, v216, v220
  v_add_f32 v208, v208, v216
  v_add_f32 v209, v209, v213
  v_add_f32 v217, v217, v221
  v_add_f32 v209, v209, v217
  v_add_f32 v210, v210, v214
  v_add_f32 v218, v218, v222
  v_add_f32 v210, v210, v218
  v_add_f32 v211, v211, v215
  v_add_f32 v219, v219, v223
  v_add_f32 v211, v211, v219
  v_cvt_pk_bf16_f32 v208, v208, v209
  v_cvt_pk_bf16_f32 v209, v210, v211
  buffer_store_dwordx2 v[208:209], v9, s[12:15], s66 offen
  s_add_u32 s63, s63, 2621440
  s_add_u32 s64, s64, 655360
  s_add_u32 s65, s65, 163840
  s_add_u32 s66, s66, 163840
  s_add_u32 s52, s52, 2
  s_cmp_lt_u32 s52, 64
  s_cbranch_scc1 xo_loop
  s_endpgm
L_end:
  s_endpgm
L_fail:
  s_mov_b32 s4, s38
  s_mov_b32 s5, s39
  s_mov_b32 s6, 256
  s_mov_b32 s7, 0x20000
  s_lshl_b32 s46, s43, 8
  s_or_b32 s46, s46, s44
  s_or_b32 s46, s46, 0x10000
  v_mov_b32 v1, 32
  v_mov_b32 v2, s46
  s_mov_b64 exec, 1
  buffer_store_dword v2, v1, s[4:7], 0 offen sc1
  s_waitcnt vmcnt(0)
  s_endpgm
.section .rodata,"a"
.p2align 6
.amdhsa_kernel init_kernel
  .amdhsa_next_free_vgpr 32
  .amdhsa_next_free_sgpr 102
  .amdhsa_accum_offset 32
  .amdhsa_group_segment_fixed_size 0
  .amdhsa_kernarg_size 104
  .amdhsa_user_sgpr_count 2
  .amdhsa_user_sgpr_kernarg_segment_ptr 1
  .amdhsa_system_sgpr_workgroup_id_x 1
.end_amdhsa_kernel
.section .rodata,"a"
.p2align 6
.amdhsa_kernel concat_heads__sliding_local_dilated__memory_aug_recurrent_mem_tr__prompt_kernel
  .amdhsa_next_free_vgpr 512
  .amdhsa_next_free_sgpr 102
  .amdhsa_accum_offset 256
  .amdhsa_group_segment_fixed_size 0
  .amdhsa_kernarg_size 104
  .amdhsa_user_sgpr_count 2
  .amdhsa_user_sgpr_kernarg_segment_ptr 1
  .amdhsa_system_sgpr_workgroup_id_x 1
.end_amdhsa_kernel
```

```asm
; @launch kernel=init_kernel grid=(256,1,1) block=(256,1,1) lds=0
; @launch kernel=concat_heads__sliding_local_dilated__memory_aug_recurrent_mem_tr__prompt_kernel grid=(256,1,1) block=(256,1,1) lds=163840
.amdgcn_target "amdgcn-amd-amdhsa--gfx950"
.text
.globl init_kernel
.p2align 8
.type init_kernel,@function
init_kernel:
  s_cmp_ge_u32 s2, 256
  s_cbranch_scc1 L_init_end
  s_load_dwordx2 s[40:41], s[0:1], 96
  s_waitcnt lgkmcnt(0)
  s_add_u32 s8, s40, 0x1fffff
  s_addc_u32 s9, s41, 0
  s_and_b32 s8, s8, 0xffe00000
  s_mov_b32 s10, 266338304
  s_mov_b32 s11, 0x20000
  s_mul_i32 s3, s2, 12288
  v_lshlrev_b32 v1, 4, v0
  v_add_u32 v1, s3, v1
  v_cmp_gt_u32 vcc, 2883584, v1
  s_nop 1
  v_cndmask_b32 v4, 0, -1, vcc
  v_mov_b32 v5, v4
  v_mov_b32 v6, v4
  v_mov_b32 v7, v4
  buffer_store_dwordx4 v[4:7], v1, s[8:11], 0 offen sc1
  v_add_u32 v1, 4096, v1
  v_cmp_gt_u32 vcc, 2883584, v1
  s_nop 1
  v_cndmask_b32 v8, 0, -1, vcc
  v_mov_b32 v9, v8
  v_mov_b32 v10, v8
  v_mov_b32 v11, v8
  buffer_store_dwordx4 v[8:11], v1, s[8:11], 0 offen sc1
  v_add_u32 v1, 4096, v1
  v_cmp_gt_u32 vcc, 2883584, v1
  s_nop 1
  v_cndmask_b32 v12, 0, -1, vcc
  v_mov_b32 v13, v12
  v_mov_b32 v14, v12
  v_mov_b32 v15, v12
  buffer_store_dwordx4 v[12:15], v1, s[8:11], 0 offen sc1
  v_add_u32 v1, 4096, v1
  s_waitcnt vmcnt(0)
  s_cmp_eq_u32 s3, 1966080
  s_cbranch_scc1 L_init_probe
  s_cmp_lg_u32 s3, 3096576
  s_cbranch_scc1 L_init_end
L_init_probe:
  v_readfirstlane_b32 s4, v0
  s_nop 0
  s_cmp_lg_u32 s4, 0
  s_cbranch_scc1 L_init_end
  v_mov_b32 v1, 0
  s_mov_b64 exec, 1
  s_add_u32 s4, s3, 8192
  s_mov_b32 s6, -1
  s_mov_b32 s7, -1
  s_memtime s[12:13]
  s_waitcnt lgkmcnt(0)
  buffer_load_dword v2, v1, s[8:11], s3 offen offset:256 sc1
  s_waitcnt vmcnt(0)
  s_memtime s[14:15]
  s_waitcnt lgkmcnt(0)
  s_sub_u32 s5, s14, s12
  s_min_u32 s6, s6, s5
  s_memtime s[12:13]
  s_waitcnt lgkmcnt(0)
  buffer_load_dword v2, v1, s[8:11], s4 offen offset:256 sc1
  s_waitcnt vmcnt(0)
  s_memtime s[14:15]
  s_waitcnt lgkmcnt(0)
  s_sub_u32 s5, s14, s12
  s_min_u32 s7, s7, s5
  s_memtime s[12:13]
  s_waitcnt lgkmcnt(0)
  buffer_load_dword v2, v1, s[8:11], s3 offen offset:640 sc1
  s_waitcnt vmcnt(0)
  s_memtime s[14:15]
  s_waitcnt lgkmcnt(0)
  s_sub_u32 s5, s14, s12
  s_min_u32 s6, s6, s5
  s_memtime s[12:13]
  s_waitcnt lgkmcnt(0)
  buffer_load_dword v2, v1, s[8:11], s4 offen offset:640 sc1
  s_waitcnt vmcnt(0)
  s_memtime s[14:15]
  s_waitcnt lgkmcnt(0)
  s_sub_u32 s5, s14, s12
  s_min_u32 s7, s7, s5
  s_cmp_lt_u32 s7, s6
  s_cselect_b32 s5, 0x2000, 0
  s_getreg_b32 s6, hwreg(HW_REG_XCC_ID)
  s_lshl_b32 s6, s6, 11
  s_and_b32 s6, s6, 0x2000
  s_xor_b32 s5, s5, s6
  v_mov_b32 v2, s5
  buffer_store_dword v2, v1, s[8:11], s3 offen sc1
  s_waitcnt vmcnt(0)
L_init_end:
  s_endpgm
.globl concat_heads__sliding_local_dilated__memory_aug_recurrent_mem_tr__prompt_kernel
.p2align 8
.type concat_heads__sliding_local_dilated__memory_aug_recurrent_mem_tr__prompt_kernel,@function
concat_heads__sliding_local_dilated__memory_aug_recurrent_mem_tr__prompt_kernel:
  s_cmp_ge_u32 s2, 256
  s_cbranch_scc1 L_end
  s_load_dwordx16 s[16:31], s[0:1], 0
  s_load_dwordx8 s[32:39], s[0:1], 64
  s_load_dwordx2 s[40:41], s[0:1], 96
  v_lshrrev_b32 v1, 6, v0
  v_and_b32 v0, 63, v0
  v_readfirstlane_b32 s42, v1
  s_getreg_b32 s43, hwreg(HW_REG_XCC_ID)
  s_and_b32 s43, s43, 7
  s_lshl_b32 s51, s42, 10
  s_waitcnt lgkmcnt(0)
  s_add_u32 s8, s40, 0x1fffff
  s_addc_u32 s9, s41, 0
  s_and_b32 s8, s8, 0xffe00000
  s_mov_b32 s10, 266338304
  s_mov_b32 s11, 0x20000
  s_mov_b32 s4, s38
  s_mov_b32 s5, s39
  s_mov_b32 s6, 256
  s_mov_b32 s7, 0x20000
  s_mov_b32 s12, s22
  s_mov_b32 s13, s23
  s_mov_b32 s14, 2621440
  s_mov_b32 s15, 0x20000
  s_cmp_lg_u32 s42, 0
  s_cbranch_scc1 L_role_wait
  s_mov_b32 s47, 0
L_role_try:
  s_lshl_b32 s46, s43, 7
  s_add_u32 s46, s46, 3015680
  v_mov_b32 v1, s46
  v_mov_b32 v2, 1
  s_mov_b64 exec, 1
  buffer_atomic_add v2, v1, s[8:11], 0 offen sc0 sc1
  s_waitcnt vmcnt(0)
  s_mov_b64 exec, -1
  v_readfirstlane_b32 s44, v2
  s_nop 0
  s_cmp_lt_u32 s44, 32
  s_cbranch_scc1 L_role_got
  s_add_u32 s43, s43, 1
  s_and_b32 s43, s43, 7
  s_add_u32 s47, s47, 1
  s_cmp_lt_u32 s47, 8
  s_cbranch_scc1 L_role_try
  s_mov_b32 s43, 0
  s_mov_b32 s44, 32
L_role_got:
  s_lshl_b32 s46, s43, 8
  s_or_b32 s46, s46, s44
  v_mov_b32 v1, 0
  v_mov_b32 v2, s46
  ds_write_b32 v1, v2
  s_waitcnt lgkmcnt(0)
L_role_wait:
  s_barrier
  v_mov_b32 v1, 0
  ds_read_b32 v2, v1
  s_waitcnt lgkmcnt(0)
  v_readfirstlane_b32 s46, v2
  s_barrier
  s_lshr_b32 s43, s46, 8
  s_and_b32 s43, s43, 7
  s_and_b32 s44, s46, 63
  s_and_b32 s46, s44, 7
  s_lshl_b32 s46, s46, 2
  s_and_b32 s47, s43, 3
  s_add_u32 s45, s46, s47
  s_cmp_ge_u32 s44, 32
  s_cbranch_scc1 L_end
  s_cmp_lt_u32 s43, 4
  s_cbranch_scc1 L_recur
  s_cmp_ge_u32 s44, 24
  s_cbranch_scc1 L_uw
  s_lshr_b32 s48, s44, 3
  s_cmp_eq_u32 s48, 0
  s_cselect_b32 s4, s26, s28
  s_cselect_b32 s5, s27, s29
  s_cmp_eq_u32 s48, 2
  s_cselect_b32 s4, s30, s4
  s_cselect_b32 s5, s31, s5
  s_mov_b32 s6, 7864320
  s_mul_i32 s60, s45, 384
  s_mov_b32 s61, 0
  s_mov_b32 s62, 64
  s_mul_i32 s63, s48, 25165824
  s_mul_i32 s46, s45, 786432
  s_add_u32 s63, s63, s46
  s_add_u32 s63, s63, 8388608
  s_lshl_b32 s64, s48, 14
  s_lshl_b32 s46, s45, 7
  s_add_u32 s64, s64, s46
  s_add_u32 s64, s64, 2899968
  v_lshrrev_b32 v10, 3, v0
  v_lshrrev_b32 v11, 2, v10
  v_lshlrev_b32 v11, 3, v11
  v_and_b32 v1, 3, v10
  v_add_u32 v1, v1, v11
  s_and_b32 s46, s42, 1
  s_lshl_b32 s46, s46, 2
  s_lshr_b32 s47, s42, 1
  s_lshl_b32 s47, s47, 4
  s_add_u32 s46, s46, s47
  v_add_u32 v1, s46, v1
  v_mul_u32_u24 v1, 12288, v1
  v_lshrrev_b32 v10, 1, v10
  v_bfe_u32 v11, v0, 1, 2
  v_xor_b32 v10, v10, v11
  v_lshlrev_b32 v10, 5, v10
  v_and_b32 v11, 1, v0
  v_lshlrev_b32 v11, 4, v11
  v_add3_u32 v1, v1, v10, v11
  v_lshrrev_b32 v10, 5, v0
  v_lshlrev_b32 v2, 11, v10
  v_bfe_u32 v10, v0, 2, 3
  v_lshl_add_u32 v2, v10, 7, v2
  v_lshrrev_b32 v10, 1, v10
  v_xor_b32 v10, s42, v10
  v_lshl_add_u32 v2, v10, 5, v2
  v_and_b32 v10, 3, v0
  v_lshl_add_u32 v2, v10, 3, v2
  v_add_u32 v3, 0x10000, v2
  v_add_u32 v4, 0x20000, v2
  v_lshrrev_b32 v10, 3, v0
  s_lshl_b32 s46, s42, 3
  v_add_u32 v10, s46, v10
  v_mul_u32_u24 v5, 1280, v10
  v_bfe_u32 v10, v10, 1, 3
  v_and_b32 v11, 7, v0
  v_xor_b32 v10, v10, v11
  v_lshl_add_u32 v5, v10, 4, v5
  v_and_b32 v10, 15, v0
  v_lshlrev_b32 v6, 7, v10
  v_lshrrev_b32 v10, 1, v10
  v_lshrrev_b32 v11, 4, v0
  v_xor_b32 v10, v10, v11
  v_lshl_add_u32 v6, v10, 4, v6
  v_add_u32 v6, 122880, v6
  v_xor_b32 v7, 64, v6
  v_and_b32 v10, 15, v0
  v_lshlrev_b32 v8, 4, v10
  v_bfe_u32 v10, v0, 4, 1
  v_mul_u32_u24 v10, 6144, v10
  v_lshrrev_b32 v11, 5, v0
  v_lshlrev_b32 v11, 8, v11
  v_add3_u32 v8, v8, v10, v11
  s_lshl_b32 s46, s42, 9
  v_add_u32 v8, s46, v8
  v_mov_b32 v9, s64
  s_mov_b32 s52, s61
  s_mul_i32 s53, s52, 40960
  s_add_u32 s54, s51, 122880
  s_add_u32 m0, s54, 0
  s_nop 0
  buffer_load_dwordx4 v5, s[12:15], s53 offen offset:0 lds
  s_add_u32 m0, s54, 3968
  s_nop 0
  buffer_load_dwordx4 v5, s[12:15], s53 offen offset:128 lds
  s_add_u32 m0, s54, 7936
  s_nop 0
  buffer_load_dwordx4 v5, s[12:15], s53 offen offset:256 lds
  s_add_u32 m0, s54, 11904
  s_nop 0
  buffer_load_dwordx4 v5, s[12:15], s53 offen offset:384 lds
  s_add_u32 m0, s54, 15872
  s_nop 0
  buffer_load_dwordx4 v5, s[12:15], s53 offen offset:512 lds
  s_add_u32 m0, s54, 19840
  s_nop 0
  buffer_load_dwordx4 v5, s[12:15], s53 offen offset:640 lds
  s_add_u32 m0, s54, 23808
  s_nop 0
  buffer_load_dwordx4 v5, s[12:15], s53 offen offset:768 lds
  s_add_u32 m0, s54, 27776
  s_nop 0
  buffer_load_dwordx4 v5, s[12:15], s53 offen offset:896 lds
  s_add_u32 m0, s54, 31744
  s_nop 0
  buffer_load_dwordx4 v5, s[12:15], s53 offen offset:1024 lds
  s_add_u32 m0, s54, 35712
  s_nop 0
  buffer_load_dwordx4 v5, s[12:15], s53 offen offset:1152 lds
  s_add_u32 m0, s51, 0
  s_add_u32 s46, s60, 0
  buffer_load_dwordx4 v1, s[4:7], s46 offen lds
  s_add_u32 m0, s51, 4096
  s_add_u32 s46, s60, 128
  buffer_load_dwordx4 v1, s[4:7], s46 offen lds
  s_add_u32 m0, s51, 8192
  s_add_u32 s46, s60, 256
  buffer_load_dwordx4 v1, s[4:7], s46 offen lds
  s_add_u32 m0, s51, 12288
  s_add_u32 s46, s60, 393216
  buffer_load_dwordx4 v1, s[4:7], s46 offen lds
  s_add_u32 m0, s51, 16384
  s_add_u32 s46, s60, 393344
  buffer_load_dwordx4 v1, s[4:7], s46 offen lds
  s_add_u32 m0, s51, 20480
  s_add_u32 s46, s60, 393472
  buffer_load_dwordx4 v1, s[4:7], s46 offen lds
  s_add_u32 m0, s51, 24576
  s_add_u32 s46, s60, 786432
  buffer_load_dwordx4 v1, s[4:7], s46 offen lds
  s_add_u32 m0, s51, 28672
  s_add_u32 s46, s60, 786560
  buffer_load_dwordx4 v1, s[4:7], s46 offen lds
  s_add_u32 m0, s51, 32768
  s_add_u32 s46, s60, 786688
  buffer_load_dwordx4 v1, s[4:7], s46 offen lds
  s_add_u32 m0, s51, 36864
  s_add_u32 s46, s60, 1179648
  buffer_load_dwordx4 v1, s[4:7], s46 offen lds
  s_add_u32 m0, s51, 40960
  s_add_u32 s46, s60, 1179776
  buffer_load_dwordx4 v1, s[4:7], s46 offen lds
  s_add_u32 m0, s51, 45056
  s_add_u32 s46, s60, 1179904
  buffer_load_dwordx4 v1, s[4:7], s46 offen lds
  s_add_u32 m0, s51, 49152
  s_add_u32 s46, s60, 1572864
  buffer_load_dwordx4 v1, s[4:7], s46 offen lds
  s_add_u32 m0, s51, 53248
  s_add_u32 s46, s60, 1572992
  buffer_load_dwordx4 v1, s[4:7], s46 offen lds
  s_add_u32 m0, s51, 57344
  s_add_u32 s46, s60, 1573120
  buffer_load_dwordx4 v1, s[4:7], s46 offen lds
  s_add_u32 m0, s51, 61440
  s_add_u32 s46, s60, 1966080
  buffer_load_dwordx4 v1, s[4:7], s46 offen lds
  s_add_u32 m0, s51, 65536
  s_add_u32 s46, s60, 1966208
  buffer_load_dwordx4 v1, s[4:7], s46 offen lds
  s_add_u32 m0, s51, 69632
  s_add_u32 s46, s60, 1966336
  buffer_load_dwordx4 v1, s[4:7], s46 offen lds
  s_add_u32 m0, s51, 73728
  s_add_u32 s46, s60, 2359296
  buffer_load_dwordx4 v1, s[4:7], s46 offen lds
  s_add_u32 m0, s51, 77824
  s_add_u32 s46, s60, 2359424
  buffer_load_dwordx4 v1, s[4:7], s46 offen lds
  s_add_u32 m0, s51, 81920
  s_add_u32 s46, s60, 2359552
  buffer_load_dwordx4 v1, s[4:7], s46 offen lds
  s_add_u32 m0, s51, 86016
  s_add_u32 s46, s60, 2752512
  buffer_load_dwordx4 v1, s[4:7], s46 offen lds
  s_add_u32 m0, s51, 90112
  s_add_u32 s46, s60, 2752640
  buffer_load_dwordx4 v1, s[4:7], s46 offen lds
  s_add_u32 m0, s51, 94208
  s_add_u32 s46, s60, 2752768
  buffer_load_dwordx4 v1, s[4:7], s46 offen lds
  s_waitcnt vmcnt(18)
  s_barrier
  s_add_u32 m0, s51, 98304
  s_add_u32 s46, s60, 3145728
  buffer_load_dwordx4 v1, s[4:7], s46 offen lds
  s_add_u32 m0, s51, 102400
  s_add_u32 s46, s60, 3145856
  buffer_load_dwordx4 v1, s[4:7], s46 offen lds
  s_add_u32 m0, s51, 106496
  s_add_u32 s46, s60, 3145984
  buffer_load_dwordx4 v1, s[4:7], s46 offen lds
  s_add_u32 m0, s51, 110592
  s_add_u32 s46, s60, 3538944
  buffer_load_dwordx4 v1, s[4:7], s46 offen lds
  s_add_u32 m0, s51, 114688
  s_add_u32 s46, s60, 3539072
  buffer_load_dwordx4 v1, s[4:7], s46 offen lds
  s_add_u32 m0, s51, 118784
  s_add_u32 s46, s60, 3539200
  buffer_load_dwordx4 v1, s[4:7], s46 offen lds
  ds_read_b64_tr_b16 a[0:1], v2 offset:0
  ds_read_b64_tr_b16 a[2:3], v2 offset:1024
  ds_read_b64_tr_b16 a[4:5], v2 offset:4096
  ds_read_b64_tr_b16 a[6:7], v2 offset:5120
  ds_read_b64_tr_b16 a[8:9], v2 offset:8192
  ds_read_b64_tr_b16 a[10:11], v2 offset:9216
  ds_read_b64_tr_b16 a[12:13], v2 offset:12288
  ds_read_b64_tr_b16 a[14:15], v2 offset:13312
  ds_read_b64_tr_b16 a[16:17], v2 offset:16384
  ds_read_b64_tr_b16 a[18:19], v2 offset:17408
  ds_read_b64_tr_b16 a[20:21], v2 offset:20480
  ds_read_b64_tr_b16 a[22:23], v2 offset:21504
  s_waitcnt lgkmcnt(0)
  s_waitcnt vmcnt(18)
  s_barrier
  s_add_u32 m0, s51, 0
  s_add_u32 s46, s60, 3932160
  buffer_load_dwordx4 v1, s[4:7], s46 offen lds
  s_add_u32 m0, s51, 4096
  s_add_u32 s46, s60, 3932288
  buffer_load_dwordx4 v1, s[4:7], s46 offen lds
  s_add_u32 m0, s51, 8192
  s_add_u32 s46, s60, 3932416
  buffer_load_dwordx4 v1, s[4:7], s46 offen lds
  s_add_u32 m0, s51, 12288
  s_add_u32 s46, s60, 4325376
  buffer_load_dwordx4 v1, s[4:7], s46 offen lds
  s_add_u32 m0, s51, 16384
  s_add_u32 s46, s60, 4325504
  buffer_load_dwordx4 v1, s[4:7], s46 offen lds
  s_add_u32 m0, s51, 20480
  s_add_u32 s46, s60, 4325632
  buffer_load_dwordx4 v1, s[4:7], s46 offen lds
  ds_read_b64_tr_b16 a[24:25], v2 offset:24576
  ds_read_b64_tr_b16 a[26:27], v2 offset:25600
  ds_read_b64_tr_b16 a[28:29], v2 offset:28672
  ds_read_b64_tr_b16 a[30:31], v2 offset:29696
  ds_read_b64_tr_b16 a[32:33], v2 offset:32768
  ds_read_b64_tr_b16 a[34:35], v2 offset:33792
  ds_read_b64_tr_b16 a[36:37], v2 offset:36864
  ds_read_b64_tr_b16 a[38:39], v2 offset:37888
  ds_read_b64_tr_b16 a[40:41], v2 offset:40960
  ds_read_b64_tr_b16 a[42:43], v2 offset:41984
  ds_read_b64_tr_b16 a[44:45], v2 offset:45056
  ds_read_b64_tr_b16 a[46:47], v2 offset:46080
  s_waitcnt lgkmcnt(0)
  s_waitcnt vmcnt(18)
  s_barrier
  s_add_u32 m0, s51, 24576
  s_add_u32 s46, s60, 4718592
  buffer_load_dwordx4 v1, s[4:7], s46 offen lds
  s_add_u32 m0, s51, 28672
  s_add_u32 s46, s60, 4718720
  buffer_load_dwordx4 v1, s[4:7], s46 offen lds
  s_add_u32 m0, s51, 32768
  s_add_u32 s46, s60, 4718848
  buffer_load_dwordx4 v1, s[4:7], s46 offen lds
  s_add_u32 m0, s51, 36864
  s_add_u32 s46, s60, 5111808
  buffer_load_dwordx4 v1, s[4:7], s46 offen lds
  s_add_u32 m0, s51, 40960
  s_add_u32 s46, s60, 5111936
  buffer_load_dwordx4 v1, s[4:7], s46 offen lds
  s_add_u32 m0, s51, 45056
  s_add_u32 s46, s60, 5112064
  buffer_load_dwordx4 v1, s[4:7], s46 offen lds
  ds_read_b64_tr_b16 a[48:49], v2 offset:49152
  ds_read_b64_tr_b16 a[50:51], v2 offset:50176
  ds_read_b64_tr_b16 a[52:53], v2 offset:53248
  ds_read_b64_tr_b16 a[54:55], v2 offset:54272
  ds_read_b64_tr_b16 a[56:57], v2 offset:57344
  ds_read_b64_tr_b16 a[58:59], v2 offset:58368
  ds_read_b64_tr_b16 a[60:61], v2 offset:61440
  ds_read_b64_tr_b16 a[62:63], v2 offset:62464
  ds_read_b64_tr_b16 a[64:65], v3 offset:0
  ds_read_b64_tr_b16 a[66:67], v3 offset:1024
  ds_read_b64_tr_b16 a[68:69], v3 offset:4096
  ds_read_b64_tr_b16 a[70:71], v3 offset:5120
  s_waitcnt lgkmcnt(0)
  s_waitcnt vmcnt(18)
  s_barrier
  s_add_u32 m0, s51, 49152
  s_add_u32 s46, s60, 5505024
  buffer_load_dwordx4 v1, s[4:7], s46 offen lds
  s_add_u32 m0, s51, 53248
  s_add_u32 s46, s60, 5505152
  buffer_load_dwordx4 v1, s[4:7], s46 offen lds
  s_add_u32 m0, s51, 57344
  s_add_u32 s46, s60, 5505280
  buffer_load_dwordx4 v1, s[4:7], s46 offen lds
  s_add_u32 m0, s51, 61440
  s_add_u32 s46, s60, 5898240
  buffer_load_dwordx4 v1, s[4:7], s46 offen lds
  s_add_u32 m0, s51, 65536
  s_add_u32 s46, s60, 5898368
  buffer_load_dwordx4 v1, s[4:7], s46 offen lds
  s_add_u32 m0, s51, 69632
  s_add_u32 s46, s60, 5898496
  buffer_load_dwordx4 v1, s[4:7], s46 offen lds
  ds_read_b64_tr_b16 a[72:73], v3 offset:8192
  ds_read_b64_tr_b16 a[74:75], v3 offset:9216
  ds_read_b64_tr_b16 a[76:77], v3 offset:12288
  ds_read_b64_tr_b16 a[78:79], v3 offset:13312
  ds_read_b64_tr_b16 a[80:81], v3 offset:16384
  ds_read_b64_tr_b16 a[82:83], v3 offset:17408
  ds_read_b64_tr_b16 a[84:85], v3 offset:20480
  ds_read_b64_tr_b16 a[86:87], v3 offset:21504
  ds_read_b64_tr_b16 a[88:89], v3 offset:24576
  ds_read_b64_tr_b16 a[90:91], v3 offset:25600
  ds_read_b64_tr_b16 a[92:93], v3 offset:28672
  ds_read_b64_tr_b16 a[94:95], v3 offset:29696
  s_waitcnt lgkmcnt(0)
  s_waitcnt vmcnt(18)
  s_barrier
  s_add_u32 m0, s51, 73728
  s_add_u32 s46, s60, 6291456
  buffer_load_dwordx4 v1, s[4:7], s46 offen lds
  s_add_u32 m0, s51, 77824
  s_add_u32 s46, s60, 6291584
  buffer_load_dwordx4 v1, s[4:7], s46 offen lds
  s_add_u32 m0, s51, 81920
  s_add_u32 s46, s60, 6291712
  buffer_load_dwordx4 v1, s[4:7], s46 offen lds
  s_add_u32 m0, s51, 86016
  s_add_u32 s46, s60, 6684672
  buffer_load_dwordx4 v1, s[4:7], s46 offen lds
  s_add_u32 m0, s51, 90112
  s_add_u32 s46, s60, 6684800
  buffer_load_dwordx4 v1, s[4:7], s46 offen lds
  s_add_u32 m0, s51, 94208
  s_add_u32 s46, s60, 6684928
  buffer_load_dwordx4 v1, s[4:7], s46 offen lds
  ds_read_b64_tr_b16 a[96:97], v3 offset:32768
  ds_read_b64_tr_b16 a[98:99], v3 offset:33792
  ds_read_b64_tr_b16 a[100:101], v3 offset:36864
  ds_read_b64_tr_b16 a[102:103], v3 offset:37888
  ds_read_b64_tr_b16 a[104:105], v3 offset:40960
  ds_read_b64_tr_b16 a[106:107], v3 offset:41984
  ds_read_b64_tr_b16 a[108:109], v3 offset:45056
  ds_read_b64_tr_b16 a[110:111], v3 offset:46080
  ds_read_b64_tr_b16 a[112:113], v3 offset:49152
  ds_read_b64_tr_b16 a[114:115], v3 offset:50176
  ds_read_b64_tr_b16 a[116:117], v3 offset:53248
  ds_read_b64_tr_b16 a[118:119], v3 offset:54272
  s_waitcnt lgkmcnt(0)
  s_waitcnt vmcnt(18)
  s_barrier
  s_add_u32 m0, s51, 98304
  s_add_u32 s46, s60, 7077888
  buffer_load_dwordx4 v1, s[4:7], s46 offen lds
  s_add_u32 m0, s51, 102400
  s_add_u32 s46, s60, 7078016
  buffer_load_dwordx4 v1, s[4:7], s46 offen lds
  s_add_u32 m0, s51, 106496
  s_add_u32 s46, s60, 7078144
  buffer_load_dwordx4 v1, s[4:7], s46 offen lds
  s_add_u32 m0, s51, 110592
  s_add_u32 s46, s60, 7471104
  buffer_load_dwordx4 v1, s[4:7], s46 offen lds
  s_add_u32 m0, s51, 114688
  s_add_u32 s46, s60, 7471232
  buffer_load_dwordx4 v1, s[4:7], s46 offen lds
  s_add_u32 m0, s51, 118784
  s_add_u32 s46, s60, 7471360
  buffer_load_dwordx4 v1, s[4:7], s46 offen lds
  ds_read_b64_tr_b16 a[120:121], v2 offset:0
  ds_read_b64_tr_b16 a[122:123], v2 offset:1024
  ds_read_b64_tr_b16 a[124:125], v2 offset:4096
  ds_read_b64_tr_b16 a[126:127], v2 offset:5120
  ds_read_b64_tr_b16 a[128:129], v2 offset:8192
  ds_read_b64_tr_b16 a[130:131], v2 offset:9216
  ds_read_b64_tr_b16 a[132:133], v2 offset:12288
  ds_read_b64_tr_b16 a[134:135], v2 offset:13312
  ds_read_b64_tr_b16 a[136:137], v2 offset:16384
  ds_read_b64_tr_b16 a[138:139], v2 offset:17408
  ds_read_b64_tr_b16 a[140:141], v2 offset:20480
  ds_read_b64_tr_b16 a[142:143], v2 offset:21504
  s_waitcnt lgkmcnt(0)
  s_waitcnt vmcnt(18)
  s_barrier
  ds_read_b64_tr_b16 a[144:145], v2 offset:24576
  ds_read_b64_tr_b16 a[146:147], v2 offset:25600
  ds_read_b64_tr_b16 a[148:149], v2 offset:28672
  ds_read_b64_tr_b16 a[150:151], v2 offset:29696
  ds_read_b64_tr_b16 a[152:153], v2 offset:32768
  ds_read_b64_tr_b16 a[154:155], v2 offset:33792
  ds_read_b64_tr_b16 a[156:157], v2 offset:36864
  ds_read_b64_tr_b16 a[158:159], v2 offset:37888
  ds_read_b64_tr_b16 a[160:161], v2 offset:40960
  ds_read_b64_tr_b16 a[162:163], v2 offset:41984
  ds_read_b64_tr_b16 a[164:165], v2 offset:45056
  ds_read_b64_tr_b16 a[166:167], v2 offset:46080
  s_waitcnt lgkmcnt(0)
  s_waitcnt vmcnt(12)
  s_barrier
  ds_read_b64_tr_b16 a[168:169], v2 offset:49152
  ds_read_b64_tr_b16 a[170:171], v2 offset:50176
  ds_read_b64_tr_b16 a[172:173], v2 offset:53248
  ds_read_b64_tr_b16 a[174:175], v2 offset:54272
  ds_read_b64_tr_b16 a[176:177], v2 offset:57344
  ds_read_b64_tr_b16 a[178:179], v2 offset:58368
  ds_read_b64_tr_b16 a[180:181], v2 offset:61440
  ds_read_b64_tr_b16 a[182:183], v2 offset:62464
  ds_read_b64_tr_b16 a[184:185], v3 offset:0
  ds_read_b64_tr_b16 a[186:187], v3 offset:1024
  ds_read_b64_tr_b16 a[188:189], v3 offset:4096
  ds_read_b64_tr_b16 a[190:191], v3 offset:5120
  s_waitcnt lgkmcnt(0)
  s_waitcnt vmcnt(6)
  s_barrier
  ds_read_b64_tr_b16 a[192:193], v3 offset:8192
  ds_read_b64_tr_b16 a[194:195], v3 offset:9216
  ds_read_b64_tr_b16 a[196:197], v3 offset:12288
  ds_read_b64_tr_b16 a[198:199], v3 offset:13312
  ds_read_b64_tr_b16 a[200:201], v3 offset:16384
  ds_read_b64_tr_b16 a[202:203], v3 offset:17408
  ds_read_b64_tr_b16 a[204:205], v3 offset:20480
  ds_read_b64_tr_b16 a[206:207], v3 offset:21504
  ds_read_b64_tr_b16 a[208:209], v3 offset:24576
  ds_read_b64_tr_b16 a[210:211], v3 offset:25600
  ds_read_b64_tr_b16 a[212:213], v3 offset:28672
  ds_read_b64_tr_b16 a[214:215], v3 offset:29696
  s_waitcnt lgkmcnt(0)
  s_waitcnt vmcnt(0)
  s_barrier
  ds_read_b64_tr_b16 a[216:217], v3 offset:32768
  ds_read_b64_tr_b16 a[218:219], v3 offset:33792
  ds_read_b64_tr_b16 a[220:221], v3 offset:36864
  ds_read_b64_tr_b16 a[222:223], v3 offset:37888
  ds_read_b64_tr_b16 a[224:225], v3 offset:40960
  ds_read_b64_tr_b16 a[226:227], v3 offset:41984
  ds_read_b64_tr_b16 a[228:229], v3 offset:45056
  ds_read_b64_tr_b16 a[230:231], v3 offset:46080
  ds_read_b64_tr_b16 a[232:233], v3 offset:49152
  ds_read_b64_tr_b16 a[234:235], v3 offset:50176
  ds_read_b64_tr_b16 a[236:237], v3 offset:53248
  ds_read_b64_tr_b16 a[238:239], v3 offset:54272
  s_waitcnt lgkmcnt(0)
  s_barrier
pj_loop_1:
  s_add_u32 s57, s52, 1
  s_xor_b32 s54, s54, 122880
  s_add_u32 s53, s53, 40960
  ds_read_b128 v[16:19], v6 offset:0
  ds_read_b128 v[20:23], v6 offset:2048
  ds_read_b128 v[24:27], v7 offset:0
  ds_read_b128 v[28:31], v7 offset:2048
  ds_read_b128 v[32:35], v6 offset:4096
  s_waitcnt lgkmcnt(4)
  v_mfma_f32_16x16x32_bf16 v[40:43], a[0:3], v[16:19], 0
  s_add_u32 m0, s54, 0
  v_mfma_f32_16x16x32_bf16 v[48:51], a[4:7], v[16:19], 0
  buffer_load_dwordx4 v5, s[12:15], s53 offen offset:0 lds
  v_mfma_f32_16x16x32_bf16 v[56:59], a[8:11], v[16:19], 0
  ds_read_b128 v[36:39], v6 offset:6144
  s_waitcnt lgkmcnt(4)
  v_mfma_f32_16x16x32_bf16 v[44:47], a[0:3], v[20:23], 0
  v_mfma_f32_16x16x32_bf16 v[52:55], a[4:7], v[20:23], 0
  v_mfma_f32_16x16x32_bf16 v[60:63], a[8:11], v[20:23], 0
  ds_read_b128 v[16:19], v7 offset:4096
  s_waitcnt lgkmcnt(4)
  v_mfma_f32_16x16x32_bf16 v[40:43], a[12:15], v[24:27], v[40:43]
  s_add_u32 m0, s54, 3968
  v_mfma_f32_16x16x32_bf16 v[48:51], a[16:19], v[24:27], v[48:51]
  buffer_load_dwordx4 v5, s[12:15], s53 offen offset:128 lds
  v_mfma_f32_16x16x32_bf16 v[56:59], a[20:23], v[24:27], v[56:59]
  ds_read_b128 v[20:23], v7 offset:6144
  s_waitcnt lgkmcnt(4)
  v_mfma_f32_16x16x32_bf16 v[44:47], a[12:15], v[28:31], v[44:47]
  v_mfma_f32_16x16x32_bf16 v[52:55], a[16:19], v[28:31], v[52:55]
  v_mfma_f32_16x16x32_bf16 v[60:63], a[20:23], v[28:31], v[60:63]
  ds_read_b128 v[24:27], v6 offset:8192
  s_waitcnt lgkmcnt(4)
  v_mfma_f32_16x16x32_bf16 v[40:43], a[24:27], v[32:35], v[40:43]
  s_add_u32 m0, s54, 7936
  v_mfma_f32_16x16x32_bf16 v[48:51], a[28:31], v[32:35], v[48:51]
  buffer_load_dwordx4 v5, s[12:15], s53 offen offset:256 lds
  v_mfma_f32_16x16x32_bf16 v[56:59], a[32:35], v[32:35], v[56:59]
  ds_read_b128 v[28:31], v6 offset:10240
  s_waitcnt lgkmcnt(4)
  v_mfma_f32_16x16x32_bf16 v[44:47], a[24:27], v[36:39], v[44:47]
  v_mfma_f32_16x16x32_bf16 v[52:55], a[28:31], v[36:39], v[52:55]
  v_mfma_f32_16x16x32_bf16 v[60:63], a[32:35], v[36:39], v[60:63]
  ds_read_b128 v[32:35], v7 offset:8192
  s_waitcnt lgkmcnt(4)
  v_mfma_f32_16x16x32_bf16 v[40:43], a[36:39], v[16:19], v[40:43]
  s_add_u32 m0, s54, 11904
  v_mfma_f32_16x16x32_bf16 v[48:51], a[40:43], v[16:19], v[48:51]
  buffer_load_dwordx4 v5, s[12:15], s53 offen offset:384 lds
  v_mfma_f32_16x16x32_bf16 v[56:59], a[44:47], v[16:19], v[56:59]
  ds_read_b128 v[36:39], v7 offset:10240
  s_waitcnt lgkmcnt(4)
  v_mfma_f32_16x16x32_bf16 v[44:47], a[36:39], v[20:23], v[44:47]
  v_mfma_f32_16x16x32_bf16 v[52:55], a[40:43], v[20:23], v[52:55]
  v_mfma_f32_16x16x32_bf16 v[60:63], a[44:47], v[20:23], v[60:63]
  ds_read_b128 v[16:19], v6 offset:12288
  s_waitcnt lgkmcnt(4)
  v_mfma_f32_16x16x32_bf16 v[40:43], a[48:51], v[24:27], v[40:43]
  s_add_u32 m0, s54, 15872
  v_mfma_f32_16x16x32_bf16 v[48:51], a[52:55], v[24:27], v[48:51]
  buffer_load_dwordx4 v5, s[12:15], s53 offen offset:512 lds
  v_mfma_f32_16x16x32_bf16 v[56:59], a[56:59], v[24:27], v[56:59]
  ds_read_b128 v[20:23], v6 offset:14336
  s_waitcnt lgkmcnt(4)
  v_mfma_f32_16x16x32_bf16 v[44:47], a[48:51], v[28:31], v[44:47]
  v_mfma_f32_16x16x32_bf16 v[52:55], a[52:55], v[28:31], v[52:55]
  v_mfma_f32_16x16x32_bf16 v[60:63], a[56:59], v[28:31], v[60:63]
  ds_read_b128 v[24:27], v7 offset:12288
  s_waitcnt lgkmcnt(4)
  v_mfma_f32_16x16x32_bf16 v[40:43], a[60:63], v[32:35], v[40:43]
  s_add_u32 m0, s54, 19840
  v_mfma_f32_16x16x32_bf16 v[48:51], a[64:67], v[32:35], v[48:51]
  buffer_load_dwordx4 v5, s[12:15], s53 offen offset:640 lds
  v_mfma_f32_16x16x32_bf16 v[56:59], a[68:71], v[32:35], v[56:59]
  ds_read_b128 v[28:31], v7 offset:14336
  s_waitcnt lgkmcnt(4)
  v_mfma_f32_16x16x32_bf16 v[44:47], a[60:63], v[36:39], v[44:47]
  v_mfma_f32_16x16x32_bf16 v[52:55], a[64:67], v[36:39], v[52:55]
  v_mfma_f32_16x16x32_bf16 v[60:63], a[68:71], v[36:39], v[60:63]
  ds_read_b128 v[32:35], v6 offset:16384
  s_waitcnt lgkmcnt(4)
  v_mfma_f32_16x16x32_bf16 v[40:43], a[72:75], v[16:19], v[40:43]
  s_add_u32 m0, s54, 23808
  v_mfma_f32_16x16x32_bf16 v[48:51], a[76:79], v[16:19], v[48:51]
  buffer_load_dwordx4 v5, s[12:15], s53 offen offset:768 lds
  v_mfma_f32_16x16x32_bf16 v[56:59], a[80:83], v[16:19], v[56:59]
  ds_read_b128 v[36:39], v6 offset:18432
  s_waitcnt lgkmcnt(4)
  v_mfma_f32_16x16x32_bf16 v[44:47], a[72:75], v[20:23], v[44:47]
  v_mfma_f32_16x16x32_bf16 v[52:55], a[76:79], v[20:23], v[52:55]
  v_mfma_f32_16x16x32_bf16 v[60:63], a[80:83], v[20:23], v[60:63]
  ds_read_b128 v[16:19], v7 offset:16384
  s_waitcnt lgkmcnt(4)
  v_mfma_f32_16x16x32_bf16 v[40:43], a[84:87], v[24:27], v[40:43]
  s_add_u32 m0, s54, 27776
  v_mfma_f32_16x16x32_bf16 v[48:51], a[88:91], v[24:27], v[48:51]
  buffer_load_dwordx4 v5, s[12:15], s53 offen offset:896 lds
  v_mfma_f32_16x16x32_bf16 v[56:59], a[92:95], v[24:27], v[56:59]
  ds_read_b128 v[20:23], v7 offset:18432
  s_waitcnt lgkmcnt(4)
  v_mfma_f32_16x16x32_bf16 v[44:47], a[84:87], v[28:31], v[44:47]
  v_mfma_f32_16x16x32_bf16 v[52:55], a[88:91], v[28:31], v[52:55]
  v_mfma_f32_16x16x32_bf16 v[60:63], a[92:95], v[28:31], v[60:63]
  ds_read_b128 v[24:27], v6 offset:20480
  s_waitcnt lgkmcnt(4)
  v_mfma_f32_16x16x32_bf16 v[40:43], a[96:99], v[32:35], v[40:43]
  s_add_u32 m0, s54, 31744
  v_mfma_f32_16x16x32_bf16 v[48:51], a[100:103], v[32:35], v[48:51]
  buffer_load_dwordx4 v5, s[12:15], s53 offen offset:1024 lds
  v_mfma_f32_16x16x32_bf16 v[56:59], a[104:107], v[32:35], v[56:59]
  ds_read_b128 v[28:31], v6 offset:22528
  s_waitcnt lgkmcnt(4)
  v_mfma_f32_16x16x32_bf16 v[44:47], a[96:99], v[36:39], v[44:47]
  v_mfma_f32_16x16x32_bf16 v[52:55], a[100:103], v[36:39], v[52:55]
  v_mfma_f32_16x16x32_bf16 v[60:63], a[104:107], v[36:39], v[60:63]
  ds_read_b128 v[32:35], v7 offset:20480
  s_waitcnt lgkmcnt(4)
  v_mfma_f32_16x16x32_bf16 v[40:43], a[108:111], v[16:19], v[40:43]
  s_add_u32 m0, s54, 35712
  v_mfma_f32_16x16x32_bf16 v[48:51], a[112:115], v[16:19], v[48:51]
  buffer_load_dwordx4 v5, s[12:15], s53 offen offset:1152 lds
  v_mfma_f32_16x16x32_bf16 v[56:59], a[116:119], v[16:19], v[56:59]
  ds_read_b128 v[36:39], v7 offset:22528
  s_waitcnt lgkmcnt(4)
  v_mfma_f32_16x16x32_bf16 v[44:47], a[108:111], v[20:23], v[44:47]
  v_mfma_f32_16x16x32_bf16 v[52:55], a[112:115], v[20:23], v[52:55]
  v_mfma_f32_16x16x32_bf16 v[60:63], a[116:119], v[20:23], v[60:63]
  ds_read_b128 v[16:19], v6 offset:24576
  s_waitcnt lgkmcnt(4)
  v_mfma_f32_16x16x32_bf16 v[40:43], a[120:123], v[24:27], v[40:43]
  v_mfma_f32_16x16x32_bf16 v[48:51], a[124:127], v[24:27], v[48:51]
  v_mfma_f32_16x16x32_bf16 v[56:59], a[128:131], v[24:27], v[56:59]
  ds_read_b128 v[20:23], v6 offset:26624
  s_waitcnt lgkmcnt(4)
  v_mfma_f32_16x16x32_bf16 v[44:47], a[120:123], v[28:31], v[44:47]
  v_mfma_f32_16x16x32_bf16 v[52:55], a[124:127], v[28:31], v[52:55]
  v_mfma_f32_16x16x32_bf16 v[60:63], a[128:131], v[28:31], v[60:63]
  ds_read_b128 v[24:27], v7 offset:24576
  s_waitcnt lgkmcnt(4)
  v_mfma_f32_16x16x32_bf16 v[40:43], a[132:135], v[32:35], v[40:43]
  v_mfma_f32_16x16x32_bf16 v[48:51], a[136:139], v[32:35], v[48:51]
  v_mfma_f32_16x16x32_bf16 v[56:59], a[140:143], v[32:35], v[56:59]
  ds_read_b128 v[28:31], v7 offset:26624
  s_waitcnt lgkmcnt(4)
  v_mfma_f32_16x16x32_bf16 v[44:47], a[132:135], v[36:39], v[44:47]
  v_mfma_f32_16x16x32_bf16 v[52:55], a[136:139], v[36:39], v[52:55]
  v_mfma_f32_16x16x32_bf16 v[60:63], a[140:143], v[36:39], v[60:63]
  ds_read_b128 v[32:35], v6 offset:28672
  s_waitcnt lgkmcnt(4)
  v_mfma_f32_16x16x32_bf16 v[40:43], a[144:147], v[16:19], v[40:43]
  v_mfma_f32_16x16x32_bf16 v[48:51], a[148:151], v[16:19], v[48:51]
  v_mfma_f32_16x16x32_bf16 v[56:59], a[152:155], v[16:19], v[56:59]
  ds_read_b128 v[36:39], v6 offset:30720
  s_waitcnt lgkmcnt(4)
  v_mfma_f32_16x16x32_bf16 v[44:47], a[144:147], v[20:23], v[44:47]
  v_mfma_f32_16x16x32_bf16 v[52:55], a[148:151], v[20:23], v[52:55]
  v_mfma_f32_16x16x32_bf16 v[60:63], a[152:155], v[20:23], v[60:63]
  ds_read_b128 v[16:19], v7 offset:28672
  s_waitcnt lgkmcnt(4)
  v_mfma_f32_16x16x32_bf16 v[40:43], a[156:159], v[24:27], v[40:43]
  v_mfma_f32_16x16x32_bf16 v[48:51], a[160:163], v[24:27], v[48:51]
  v_mfma_f32_16x16x32_bf16 v[56:59], a[164:167], v[24:27], v[56:59]
  ds_read_b128 v[20:23], v7 offset:30720
  s_waitcnt lgkmcnt(4)
  v_mfma_f32_16x16x32_bf16 v[44:47], a[156:159], v[28:31], v[44:47]
  v_mfma_f32_16x16x32_bf16 v[52:55], a[160:163], v[28:31], v[52:55]
  v_mfma_f32_16x16x32_bf16 v[60:63], a[164:167], v[28:31], v[60:63]
  ds_read_b128 v[24:27], v6 offset:32768
  s_waitcnt lgkmcnt(4)
  v_mfma_f32_16x16x32_bf16 v[40:43], a[168:171], v[32:35], v[40:43]
  v_mfma_f32_16x16x32_bf16 v[48:51], a[172:175], v[32:35], v[48:51]
  v_mfma_f32_16x16x32_bf16 v[56:59], a[176:179], v[32:35], v[56:59]
  ds_read_b128 v[28:31], v6 offset:34816
  s_waitcnt lgkmcnt(4)
  v_mfma_f32_16x16x32_bf16 v[44:47], a[168:171], v[36:39], v[44:47]
  v_mfma_f32_16x16x32_bf16 v[52:55], a[172:175], v[36:39], v[52:55]
  v_mfma_f32_16x16x32_bf16 v[60:63], a[176:179], v[36:39], v[60:63]
  ds_read_b128 v[32:35], v7 offset:32768
  s_waitcnt lgkmcnt(4)
  v_mfma_f32_16x16x32_bf16 v[40:43], a[180:183], v[16:19], v[40:43]
  v_mfma_f32_16x16x32_bf16 v[48:51], a[184:187], v[16:19], v[48:51]
  v_mfma_f32_16x16x32_bf16 v[56:59], a[188:191], v[16:19], v[56:59]
  ds_read_b128 v[36:39], v7 offset:34816
  s_waitcnt lgkmcnt(4)
  v_mfma_f32_16x16x32_bf16 v[44:47], a[180:183], v[20:23], v[44:47]
  v_mfma_f32_16x16x32_bf16 v[52:55], a[184:187], v[20:23], v[52:55]
  v_mfma_f32_16x16x32_bf16 v[60:63], a[188:191], v[20:23], v[60:63]
  ds_read_b128 v[16:19], v6 offset:36864
  s_waitcnt lgkmcnt(4)
  v_mfma_f32_16x16x32_bf16 v[40:43], a[192:195], v[24:27], v[40:43]
  v_mfma_f32_16x16x32_bf16 v[48:51], a[196:199], v[24:27], v[48:51]
  v_mfma_f32_16x16x32_bf16 v[56:59], a[200:203], v[24:27], v[56:59]
  ds_read_b128 v[20:23], v6 offset:38912
  s_waitcnt lgkmcnt(4)
  v_mfma_f32_16x16x32_bf16 v[44:47], a[192:195], v[28:31], v[44:47]
  v_mfma_f32_16x16x32_bf16 v[52:55], a[196:199], v[28:31], v[52:55]
  v_mfma_f32_16x16x32_bf16 v[60:63], a[200:203], v[28:31], v[60:63]
  ds_read_b128 v[24:27], v7 offset:36864
  s_waitcnt lgkmcnt(4)
  v_mfma_f32_16x16x32_bf16 v[40:43], a[204:207], v[32:35], v[40:43]
  v_mfma_f32_16x16x32_bf16 v[48:51], a[208:211], v[32:35], v[48:51]
  v_mfma_f32_16x16x32_bf16 v[56:59], a[212:215], v[32:35], v[56:59]
  ds_read_b128 v[28:31], v7 offset:38912
  s_waitcnt lgkmcnt(4)
  v_mfma_f32_16x16x32_bf16 v[44:47], a[204:207], v[36:39], v[44:47]
  v_mfma_f32_16x16x32_bf16 v[52:55], a[208:211], v[36:39], v[52:55]
  v_mfma_f32_16x16x32_bf16 v[60:63], a[212:215], v[36:39], v[60:63]
  s_waitcnt lgkmcnt(3)
  v_mfma_f32_16x16x32_bf16 v[40:43], a[216:219], v[16:19], v[40:43]
  v_mfma_f32_16x16x32_bf16 v[48:51], a[220:223], v[16:19], v[48:51]
  v_mfma_f32_16x16x32_bf16 v[56:59], a[224:227], v[16:19], v[56:59]
  s_waitcnt lgkmcnt(2)
  v_mfma_f32_16x16x32_bf16 v[44:47], a[216:219], v[20:23], v[44:47]
  v_mfma_f32_16x16x32_bf16 v[52:55], a[220:223], v[20:23], v[52:55]
  v_mfma_f32_16x16x32_bf16 v[60:63], a[224:227], v[20:23], v[60:63]
  s_waitcnt lgkmcnt(1)
  v_mfma_f32_16x16x32_bf16 v[40:43], a[228:231], v[24:27], v[40:43]
  v_mfma_f32_16x16x32_bf16 v[48:51], a[232:235], v[24:27], v[48:51]
  v_mfma_f32_16x16x32_bf16 v[56:59], a[236:239], v[24:27], v[56:59]
  s_waitcnt lgkmcnt(0)
  v_mfma_f32_16x16x32_bf16 v[44:47], a[228:231], v[28:31], v[44:47]
  v_mfma_f32_16x16x32_bf16 v[52:55], a[232:235], v[28:31], v[52:55]
  v_mfma_f32_16x16x32_bf16 v[60:63], a[236:239], v[28:31], v[60:63]
  s_waitcnt vmcnt(0)
  s_barrier
  v_xor_b32 v6, 122880, v6
  v_xor_b32 v7, 122880, v7
  s_mul_i32 s55, s52, 12288
  s_add_u32 s55, s55, s63
  s_add_u32 s56, s55, 4096
  s_cmp_lg_u32 s42, 0
  s_cbranch_scc1 pj_noflag_3
  s_cmp_eq_u32 s52, s61
  s_cbranch_scc1 pj_noflag_3
  v_mov_b32 v10, s52
  s_mov_b64 exec, 1
  buffer_store_dword v10, v9, s[8:11], 0 offen sc1
  s_mov_b64 exec, -1
pj_noflag_3:
  v_cvt_pk_bf16_f32 v64, v40, v41
  v_cvt_pk_bf16_f32 v65, v42, v43
  v_cvt_pk_bf16_f32 v66, v44, v45
  v_cvt_pk_bf16_f32 v67, v46, v47
  v_cvt_pk_bf16_f32 v68, v48, v49
  v_cvt_pk_bf16_f32 v69, v50, v51
  v_cvt_pk_bf16_f32 v70, v52, v53
  v_cvt_pk_bf16_f32 v71, v54, v55
  v_cvt_pk_bf16_f32 v72, v56, v57
  v_cvt_pk_bf16_f32 v73, v58, v59
  v_cvt_pk_bf16_f32 v74, v60, v61
  v_cvt_pk_bf16_f32 v75, v62, v63
  v_permlane16_swap_b32 v64, v66
  v_permlane16_swap_b32 v65, v67
  buffer_store_dwordx4 v[64:67], v8, s[8:11], s55 offen offset:0 sc1
  v_permlane16_swap_b32 v68, v70
  v_permlane16_swap_b32 v69, v71
  buffer_store_dwordx4 v[68:71], v8, s[8:11], s55 offen offset:2048 sc1
  v_permlane16_swap_b32 v72, v74
  v_permlane16_swap_b32 v73, v75
  buffer_store_dwordx4 v[72:75], v8, s[8:11], s56 offen offset:0 sc1
  s_cmp_lg_u32 s52, s61
  s_cbranch_scc1 pj_noeag_4
  s_waitcnt vmcnt(0)
  s_barrier
  s_cmp_lg_u32 s42, 0
  s_cbranch_scc1 pj_noeag_4
  v_mov_b32 v10, s57
  s_mov_b64 exec, 1
  buffer_store_dword v10, v9, s[8:11], 0 offen sc1
  s_mov_b64 exec, -1
pj_noeag_4:
  s_mov_b32 s52, s57
  s_cmp_lt_u32 s52, s62
  s_cbranch_scc1 pj_loop_1
  s_waitcnt vmcnt(0)
  s_barrier
  s_cmp_lg_u32 s42, 0
  s_cbranch_scc1 pj_fin_5
  v_mov_b32 v10, s52
  s_mov_b64 exec, 1
  buffer_store_dword v10, v9, s[8:11], 0 offen sc1
  s_mov_b64 exec, -1
pj_fin_5:
  s_branch L_parta
L_uw:
  s_mov_b32 s4, s32
  s_mov_b32 s5, s33
  s_mov_b32 s6, 7864320
  s_mov_b32 s7, 0x20000
  v_lshrrev_b32 v8, 3, v0
  v_lshrrev_b32 v9, 2, v8
  v_lshlrev_b32 v9, 3, v9
  v_and_b32 v1, 3, v8
  v_add_u32 v1, v1, v9
  s_and_b32 s46, s42, 1
  s_lshl_b32 s46, s46, 2
  s_lshr_b32 s47, s42, 1
  s_lshl_b32 s47, s47, 4
  s_add_u32 s46, s46, s47
  v_add_u32 v1, s46, v1
  v_mul_u32_u24 v1, 1280, v1
  v_lshrrev_b32 v8, 1, v8
  v_bfe_u32 v9, v0, 1, 2
  v_xor_b32 v8, v8, v9
  v_lshlrev_b32 v8, 5, v8
  v_and_b32 v9, 1, v0
  v_lshlrev_b32 v9, 4, v9
  v_add3_u32 v1, v1, v8, v9
  v_lshrrev_b32 v8, 5, v0
  v_lshlrev_b32 v2, 11, v8
  v_bfe_u32 v8, v0, 2, 3
  v_lshl_add_u32 v2, v8, 7, v2
  v_lshrrev_b32 v8, 1, v8
  v_xor_b32 v8, s42, v8
  v_lshl_add_u32 v2, v8, 5, v2
  v_and_b32 v8, 3, v0
  v_lshl_add_u32 v2, v8, 3, v2
  v_add_u32 v3, 0x10000, v2
  v_add_u32 v4, 0x20000, v2
  s_mul_i32 s53, s45, 245760
  v_lshlrev_b32 v5, 4, v0
  s_lshl_b32 s46, s45, 7
  s_add_u32 s47, s46, 2932736
  v_mov_b32 v6, s47
  s_lshl_b32 s47, s42, 2
  s_add_u32 s46, s46, s47
  s_add_u32 s46, s46, 2949120
  v_mov_b32 v7, s46
  s_mul_i32 s54, s45, 786432
  s_add_u32 s54, s54, 58720256
  s_lshl_b32 s55, s45, 10
  s_lshl_b32 s46, s42, 15
  s_add_u32 s55, s55, s46
  s_add_u32 s55, s55, 83886080
  s_mov_b32 s52, 0
  s_mov_b32 s56, 0
  s_add_u32 m0, s51, 0
  s_add_u32 s46, s53, 0
  buffer_load_dwordx4 v1, s[4:7], s46 offen lds
  s_add_u32 m0, s51, 4096
  s_add_u32 s46, s53, 128
  buffer_load_dwordx4 v1, s[4:7], s46 offen lds
  s_add_u32 m0, s51, 8192
  s_add_u32 s46, s53, 256
  buffer_load_dwordx4 v1, s[4:7], s46 offen lds
  s_add_u32 m0, s51, 12288
  s_add_u32 s46, s53, 384
  buffer_load_dwordx4 v1, s[4:7], s46 offen lds
  s_add_u32 m0, s51, 16384
  s_add_u32 s46, s53, 512
  buffer_load_dwordx4 v1, s[4:7], s46 offen lds
  s_add_u32 m0, s51, 20480
  s_add_u32 s46, s53, 640
  buffer_load_dwordx4 v1, s[4:7], s46 offen lds
  s_add_u32 m0, s51, 24576
  s_add_u32 s46, s53, 768
  buffer_load_dwordx4 v1, s[4:7], s46 offen lds
  s_add_u32 m0, s51, 28672
  s_add_u32 s46, s53, 896
  buffer_load_dwordx4 v1, s[4:7], s46 offen lds
  s_add_u32 m0, s51, 32768
  s_add_u32 s46, s53, 1024
  buffer_load_dwordx4 v1, s[4:7], s46 offen lds
  s_add_u32 m0, s51, 36864
  s_add_u32 s46, s53, 1152
  buffer_load_dwordx4 v1, s[4:7], s46 offen lds
  s_add_u32 m0, s51, 40960
  s_add_u32 s46, s53, 40960
  buffer_load_dwordx4 v1, s[4:7], s46 offen lds
  s_add_u32 m0, s51, 45056
  s_add_u32 s46, s53, 41088
  buffer_load_dwordx4 v1, s[4:7], s46 offen lds
  s_add_u32 m0, s51, 49152
  s_add_u32 s46, s53, 41216
  buffer_load_dwordx4 v1, s[4:7], s46 offen lds
  s_add_u32 m0, s51, 53248
  s_add_u32 s46, s53, 41344
  buffer_load_dwordx4 v1, s[4:7], s46 offen lds
  s_add_u32 m0, s51, 57344
  s_add_u32 s46, s53, 41472
  buffer_load_dwordx4 v1, s[4:7], s46 offen lds
  s_add_u32 m0, s51, 61440
  s_add_u32 s46, s53, 41600
  buffer_load_dwordx4 v1, s[4:7], s46 offen lds
  s_add_u32 m0, s51, 65536
  s_add_u32 s46, s53, 41728
  buffer_load_dwordx4 v1, s[4:7], s46 offen lds
  s_add_u32 m0, s51, 69632
  s_add_u32 s46, s53, 41856
  buffer_load_dwordx4 v1, s[4:7], s46 offen lds
  s_add_u32 m0, s51, 73728
  s_add_u32 s46, s53, 41984
  buffer_load_dwordx4 v1, s[4:7], s46 offen lds
  s_add_u32 m0, s51, 77824
  s_add_u32 s46, s53, 42112
  buffer_load_dwordx4 v1, s[4:7], s46 offen lds
  s_add_u32 m0, s51, 81920
  s_add_u32 s46, s53, 81920
  buffer_load_dwordx4 v1, s[4:7], s46 offen lds
  s_add_u32 m0, s51, 86016
  s_add_u32 s46, s53, 82048
  buffer_load_dwordx4 v1, s[4:7], s46 offen lds
  s_add_u32 m0, s51, 90112
  s_add_u32 s46, s53, 82176
  buffer_load_dwordx4 v1, s[4:7], s46 offen lds
  s_add_u32 m0, s51, 94208
  s_add_u32 s46, s53, 82304
  buffer_load_dwordx4 v1, s[4:7], s46 offen lds
  s_add_u32 m0, s51, 98304
  s_add_u32 s46, s53, 82432
  buffer_load_dwordx4 v1, s[4:7], s46 offen lds
  s_add_u32 m0, s51, 102400
  s_add_u32 s46, s53, 82560
  buffer_load_dwordx4 v1, s[4:7], s46 offen lds
  s_add_u32 m0, s51, 106496
  s_add_u32 s46, s53, 82688
  buffer_load_dwordx4 v1, s[4:7], s46 offen lds
  s_add_u32 m0, s51, 110592
  s_add_u32 s46, s53, 82816
  buffer_load_dwordx4 v1, s[4:7], s46 offen lds
  s_add_u32 m0, s51, 114688
  s_add_u32 s46, s53, 82944
  buffer_load_dwordx4 v1, s[4:7], s46 offen lds
  s_add_u32 m0, s51, 118784
  s_add_u32 s46, s53, 83072
  buffer_load_dwordx4 v1, s[4:7], s46 offen lds
  s_waitcnt vmcnt(24)
  s_barrier
  s_add_u32 m0, s51, 122880
  s_add_u32 s46, s53, 122880
  buffer_load_dwordx4 v1, s[4:7], s46 offen lds
  s_add_u32 m0, s51, 126976
  s_add_u32 s46, s53, 123008
  buffer_load_dwordx4 v1, s[4:7], s46 offen lds
  s_add_u32 m0, s51, 131072
  s_add_u32 s46, s53, 123136
  buffer_load_dwordx4 v1, s[4:7], s46 offen lds
  s_add_u32 m0, s51, 135168
  s_add_u32 s46, s53, 123264
  buffer_load_dwordx4 v1, s[4:7], s46 offen lds
  s_add_u32 m0, s51, 139264
  s_add_u32 s46, s53, 123392
  buffer_load_dwordx4 v1, s[4:7], s46 offen lds
  s_add_u32 m0, s51, 143360
  s_add_u32 s46, s53, 123520
  buffer_load_dwordx4 v1, s[4:7], s46 offen lds
  ds_read_b64_tr_b16 a[0:1], v2 offset:0
  ds_read_b64_tr_b16 a[2:3], v2 offset:1024
  ds_read_b64_tr_b16 a[24:25], v2 offset:4096
  ds_read_b64_tr_b16 a[26:27], v2 offset:5120
  ds_read_b64_tr_b16 a[48:49], v2 offset:8192
  ds_read_b64_tr_b16 a[50:51], v2 offset:9216
  ds_read_b64_tr_b16 a[72:73], v2 offset:12288
  ds_read_b64_tr_b16 a[74:75], v2 offset:13312
  ds_read_b64_tr_b16 a[96:97], v2 offset:16384
  ds_read_b64_tr_b16 a[98:99], v2 offset:17408
  ds_read_b64_tr_b16 a[120:121], v2 offset:20480
  ds_read_b64_tr_b16 a[122:123], v2 offset:21504
  s_waitcnt lgkmcnt(0)
  s_waitcnt vmcnt(24)
  s_barrier
  s_add_u32 m0, s51, 0
  s_add_u32 s46, s53, 123648
  buffer_load_dwordx4 v1, s[4:7], s46 offen lds
  s_add_u32 m0, s51, 4096
  s_add_u32 s46, s53, 123776
  buffer_load_dwordx4 v1, s[4:7], s46 offen lds
  s_add_u32 m0, s51, 8192
  s_add_u32 s46, s53, 123904
  buffer_load_dwordx4 v1, s[4:7], s46 offen lds
  s_add_u32 m0, s51, 12288
  s_add_u32 s46, s53, 124032
  buffer_load_dwordx4 v1, s[4:7], s46 offen lds
  s_add_u32 m0, s51, 16384
  s_add_u32 s46, s53, 163840
  buffer_load_dwordx4 v1, s[4:7], s46 offen lds
  s_add_u32 m0, s51, 20480
  s_add_u32 s46, s53, 163968
  buffer_load_dwordx4 v1, s[4:7], s46 offen lds
  ds_read_b64_tr_b16 a[144:145], v2 offset:24576
  ds_read_b64_tr_b16 a[146:147], v2 offset:25600
  ds_read_b64_tr_b16 a[168:169], v2 offset:28672
  ds_read_b64_tr_b16 a[170:171], v2 offset:29696
  ds_read_b64_tr_b16 a[192:193], v2 offset:32768
  ds_read_b64_tr_b16 a[194:195], v2 offset:33792
  ds_read_b64_tr_b16 a[216:217], v2 offset:36864
  ds_read_b64_tr_b16 a[218:219], v2 offset:37888
  ds_read_b64_tr_b16 a[4:5], v2 offset:40960
  ds_read_b64_tr_b16 a[6:7], v2 offset:41984
  ds_read_b64_tr_b16 a[28:29], v2 offset:45056
  ds_read_b64_tr_b16 a[30:31], v2 offset:46080
  s_waitcnt lgkmcnt(0)
  s_waitcnt vmcnt(24)
  s_barrier
  s_add_u32 m0, s51, 24576
  s_add_u32 s46, s53, 164096
  buffer_load_dwordx4 v1, s[4:7], s46 offen lds
  s_add_u32 m0, s51, 28672
  s_add_u32 s46, s53, 164224
  buffer_load_dwordx4 v1, s[4:7], s46 offen lds
  s_add_u32 m0, s51, 32768
  s_add_u32 s46, s53, 164352
  buffer_load_dwordx4 v1, s[4:7], s46 offen lds
  s_add_u32 m0, s51, 36864
  s_add_u32 s46, s53, 164480
  buffer_load_dwordx4 v1, s[4:7], s46 offen lds
  s_add_u32 m0, s51, 40960
  s_add_u32 s46, s53, 164608
  buffer_load_dwordx4 v1, s[4:7], s46 offen lds
  s_add_u32 m0, s51, 45056
  s_add_u32 s46, s53, 164736
  buffer_load_dwordx4 v1, s[4:7], s46 offen lds
  ds_read_b64_tr_b16 a[52:53], v2 offset:49152
  ds_read_b64_tr_b16 a[54:55], v2 offset:50176
  ds_read_b64_tr_b16 a[76:77], v2 offset:53248
  ds_read_b64_tr_b16 a[78:79], v2 offset:54272
  ds_read_b64_tr_b16 a[100:101], v2 offset:57344
  ds_read_b64_tr_b16 a[102:103], v2 offset:58368
  ds_read_b64_tr_b16 a[124:125], v2 offset:61440
  ds_read_b64_tr_b16 a[126:127], v2 offset:62464
  ds_read_b64_tr_b16 a[148:149], v3 offset:0
  ds_read_b64_tr_b16 a[150:151], v3 offset:1024
  ds_read_b64_tr_b16 a[172:173], v3 offset:4096
  ds_read_b64_tr_b16 a[174:175], v3 offset:5120
  s_waitcnt lgkmcnt(0)
  s_waitcnt vmcnt(24)
  s_barrier
  s_add_u32 m0, s51, 49152
  s_add_u32 s46, s53, 164864
  buffer_load_dwordx4 v1, s[4:7], s46 offen lds
  s_add_u32 m0, s51, 53248
  s_add_u32 s46, s53, 164992
  buffer_load_dwordx4 v1, s[4:7], s46 offen lds
  s_add_u32 m0, s51, 57344
  s_add_u32 s46, s53, 204800
  buffer_load_dwordx4 v1, s[4:7], s46 offen lds
  s_add_u32 m0, s51, 61440
  s_add_u32 s46, s53, 204928
  buffer_load_dwordx4 v1, s[4:7], s46 offen lds
  s_add_u32 m0, s51, 65536
  s_add_u32 s46, s53, 205056
  buffer_load_dwordx4 v1, s[4:7], s46 offen lds
  s_add_u32 m0, s51, 69632
  s_add_u32 s46, s53, 205184
  buffer_load_dwordx4 v1, s[4:7], s46 offen lds
  ds_read_b64_tr_b16 a[196:197], v3 offset:8192
  ds_read_b64_tr_b16 a[198:199], v3 offset:9216
  ds_read_b64_tr_b16 a[220:221], v3 offset:12288
  ds_read_b64_tr_b16 a[222:223], v3 offset:13312
  ds_read_b64_tr_b16 a[8:9], v3 offset:16384
  ds_read_b64_tr_b16 a[10:11], v3 offset:17408
  ds_read_b64_tr_b16 a[32:33], v3 offset:20480
  ds_read_b64_tr_b16 a[34:35], v3 offset:21504
  ds_read_b64_tr_b16 a[56:57], v3 offset:24576
  ds_read_b64_tr_b16 a[58:59], v3 offset:25600
  ds_read_b64_tr_b16 a[80:81], v3 offset:28672
  ds_read_b64_tr_b16 a[82:83], v3 offset:29696
  s_waitcnt lgkmcnt(0)
  s_waitcnt vmcnt(24)
  s_barrier
  s_add_u32 m0, s51, 73728
  s_add_u32 s46, s53, 205312
  buffer_load_dwordx4 v1, s[4:7], s46 offen lds
  s_add_u32 m0, s51, 77824
  s_add_u32 s46, s53, 205440
  buffer_load_dwordx4 v1, s[4:7], s46 offen lds
  s_add_u32 m0, s51, 81920
  s_add_u32 s46, s53, 205568
  buffer_load_dwordx4 v1, s[4:7], s46 offen lds
  s_add_u32 m0, s51, 86016
  s_add_u32 s46, s53, 205696
  buffer_load_dwordx4 v1, s[4:7], s46 offen lds
  s_add_u32 m0, s51, 90112
  s_add_u32 s46, s53, 205824
  buffer_load_dwordx4 v1, s[4:7], s46 offen lds
  s_add_u32 m0, s51, 94208
  s_add_u32 s46, s53, 205952
  buffer_load_dwordx4 v1, s[4:7], s46 offen lds
  ds_read_b64_tr_b16 a[104:105], v3 offset:32768
  ds_read_b64_tr_b16 a[106:107], v3 offset:33792
  ds_read_b64_tr_b16 a[128:129], v3 offset:36864
  ds_read_b64_tr_b16 a[130:131], v3 offset:37888
  ds_read_b64_tr_b16 a[152:153], v3 offset:40960
  ds_read_b64_tr_b16 a[154:155], v3 offset:41984
  ds_read_b64_tr_b16 a[176:177], v3 offset:45056
  ds_read_b64_tr_b16 a[178:179], v3 offset:46080
  ds_read_b64_tr_b16 a[200:201], v3 offset:49152
  ds_read_b64_tr_b16 a[202:203], v3 offset:50176
  ds_read_b64_tr_b16 a[224:225], v3 offset:53248
  ds_read_b64_tr_b16 a[226:227], v3 offset:54272
  s_waitcnt lgkmcnt(0)
  s_waitcnt vmcnt(24)
  s_barrier
  ds_read_b64_tr_b16 a[12:13], v3 offset:57344
  ds_read_b64_tr_b16 a[14:15], v3 offset:58368
  ds_read_b64_tr_b16 a[36:37], v3 offset:61440
  ds_read_b64_tr_b16 a[38:39], v3 offset:62464
  ds_read_b64_tr_b16 a[60:61], v4 offset:0
  ds_read_b64_tr_b16 a[62:63], v4 offset:1024
  ds_read_b64_tr_b16 a[84:85], v4 offset:4096
  ds_read_b64_tr_b16 a[86:87], v4 offset:5120
  ds_read_b64_tr_b16 a[108:109], v4 offset:8192
  ds_read_b64_tr_b16 a[110:111], v4 offset:9216
  ds_read_b64_tr_b16 a[132:133], v4 offset:12288
  ds_read_b64_tr_b16 a[134:135], v4 offset:13312
  s_waitcnt lgkmcnt(0)
  s_waitcnt vmcnt(18)
  s_barrier
  ds_read_b64_tr_b16 a[156:157], v2 offset:0
  ds_read_b64_tr_b16 a[158:159], v2 offset:1024
  ds_read_b64_tr_b16 a[180:181], v2 offset:4096
  ds_read_b64_tr_b16 a[182:183], v2 offset:5120
  ds_read_b64_tr_b16 a[204:205], v2 offset:8192
  ds_read_b64_tr_b16 a[206:207], v2 offset:9216
  ds_read_b64_tr_b16 a[228:229], v2 offset:12288
  ds_read_b64_tr_b16 a[230:231], v2 offset:13312
  ds_read_b64_tr_b16 a[16:17], v2 offset:16384
  ds_read_b64_tr_b16 a[18:19], v2 offset:17408
  ds_read_b64_tr_b16 a[40:41], v2 offset:20480
  ds_read_b64_tr_b16 a[42:43], v2 offset:21504
  s_waitcnt lgkmcnt(0)
  s_waitcnt vmcnt(12)
  s_barrier
  ds_read_b64_tr_b16 a[64:65], v2 offset:24576
  ds_read_b64_tr_b16 a[66:67], v2 offset:25600
  ds_read_b64_tr_b16 a[88:89], v2 offset:28672
  ds_read_b64_tr_b16 a[90:91], v2 offset:29696
  ds_read_b64_tr_b16 a[112:113], v2 offset:32768
  ds_read_b64_tr_b16 a[114:115], v2 offset:33792
  ds_read_b64_tr_b16 a[136:137], v2 offset:36864
  ds_read_b64_tr_b16 a[138:139], v2 offset:37888
  ds_read_b64_tr_b16 a[160:161], v2 offset:40960
  ds_read_b64_tr_b16 a[162:163], v2 offset:41984
  ds_read_b64_tr_b16 a[184:185], v2 offset:45056
  ds_read_b64_tr_b16 a[186:187], v2 offset:46080
  s_waitcnt lgkmcnt(0)
  s_waitcnt vmcnt(6)
  s_barrier
  ds_read_b64_tr_b16 a[208:209], v2 offset:49152
  ds_read_b64_tr_b16 a[210:211], v2 offset:50176
  ds_read_b64_tr_b16 a[232:233], v2 offset:53248
  ds_read_b64_tr_b16 a[234:235], v2 offset:54272
  ds_read_b64_tr_b16 a[20:21], v2 offset:57344
  ds_read_b64_tr_b16 a[22:23], v2 offset:58368
  ds_read_b64_tr_b16 a[44:45], v2 offset:61440
  ds_read_b64_tr_b16 a[46:47], v2 offset:62464
  ds_read_b64_tr_b16 a[68:69], v3 offset:0
  ds_read_b64_tr_b16 a[70:71], v3 offset:1024
  ds_read_b64_tr_b16 a[92:93], v3 offset:4096
  ds_read_b64_tr_b16 a[94:95], v3 offset:5120
  s_waitcnt lgkmcnt(0)
  s_waitcnt vmcnt(0)
  s_barrier
  ds_read_b64_tr_b16 a[116:117], v3 offset:8192
  ds_read_b64_tr_b16 a[118:119], v3 offset:9216
  ds_read_b64_tr_b16 a[140:141], v3 offset:12288
  ds_read_b64_tr_b16 a[142:143], v3 offset:13312
  ds_read_b64_tr_b16 a[164:165], v3 offset:16384
  ds_read_b64_tr_b16 a[166:167], v3 offset:17408
  ds_read_b64_tr_b16 a[188:189], v3 offset:20480
  ds_read_b64_tr_b16 a[190:191], v3 offset:21504
  ds_read_b64_tr_b16 a[212:213], v3 offset:24576
  ds_read_b64_tr_b16 a[214:215], v3 offset:25600
  ds_read_b64_tr_b16 a[236:237], v3 offset:28672
  ds_read_b64_tr_b16 a[238:239], v3 offset:29696
  s_waitcnt lgkmcnt(0)
  s_barrier
  s_mov_b32 s57, 1
  s_cmp_ge_u32 s56, s57
  s_cbranch_scc1 wf_done_6
  s_mov_b32 s50, 0
wf_loop_7:
  buffer_load_dword v8, v6, s[8:11], 0 offen sc1
  s_add_u32 s50, s50, 1
  s_cmp_gt_u32 s50, 131072
  s_cbranch_scc1 L_fail
  s_waitcnt vmcnt(0)
  v_readfirstlane_b32 s56, v8
  s_nop 0
  s_cmp_ge_u32 s56, s57
  s_cbranch_scc1 wf_done_6
  s_sleep 2
  s_branch wf_loop_7
wf_done_6:
  s_add_u32 s46, s54, 0
  buffer_load_dwordx4 v[16:19], v5, s[8:11], s46 offen offset:0 sc1
  buffer_load_dwordx4 v[20:23], v5, s[8:11], s46 offen offset:1024 sc1
  buffer_load_dwordx4 v[24:27], v5, s[8:11], s46 offen offset:2048 sc1
  buffer_load_dwordx4 v[28:31], v5, s[8:11], s46 offen offset:3072 sc1
  s_add_u32 s46, s54, 4096
  buffer_load_dwordx4 v[32:35], v5, s[8:11], s46 offen offset:0 sc1
  buffer_load_dwordx4 v[36:39], v5, s[8:11], s46 offen offset:1024 sc1
  buffer_load_dwordx4 v[40:43], v5, s[8:11], s46 offen offset:2048 sc1
  buffer_load_dwordx4 v[44:47], v5, s[8:11], s46 offen offset:3072 sc1
  s_add_u32 s46, s54, 8192
  buffer_load_dwordx4 v[48:51], v5, s[8:11], s46 offen offset:0 sc1
  buffer_load_dwordx4 v[52:55], v5, s[8:11], s46 offen offset:1024 sc1
  buffer_load_dwordx4 v[56:59], v5, s[8:11], s46 offen offset:2048 sc1
  buffer_load_dwordx4 v[60:63], v5, s[8:11], s46 offen offset:3072 sc1
  s_add_u32 s54, s54, 12288
  s_waitcnt vmcnt(0)
u_loop_8:
  s_add_u32 s57, s52, 2
  s_cmp_gt_u32 s57, 64
  s_cbranch_scc1 u_nold_9
  s_cmp_eq_u32 s52, 0
  s_cbranch_scc1 u_nold_9
  s_cmp_ge_u32 s56, s57
  s_cbranch_scc1 wf_done_12
  s_mov_b32 s50, 0
wf_loop_13:
  buffer_load_dword v8, v6, s[8:11], 0 offen sc1
  s_add_u32 s50, s50, 1
  s_cmp_gt_u32 s50, 131072
  s_cbranch_scc1 L_fail
  s_waitcnt vmcnt(0)
  v_readfirstlane_b32 s56, v8
  s_nop 0
  s_cmp_ge_u32 s56, s57
  s_cbranch_scc1 wf_done_12
  s_sleep 2
  s_branch wf_loop_13
wf_done_12:
  s_add_u32 s46, s54, 0
  buffer_load_dwordx4 v[64:67], v5, s[8:11], s46 offen offset:0 sc1
  buffer_load_dwordx4 v[68:71], v5, s[8:11], s46 offen offset:1024 sc1
  buffer_load_dwordx4 v[72:75], v5, s[8:11], s46 offen offset:2048 sc1
  buffer_load_dwordx4 v[76:79], v5, s[8:11], s46 offen offset:3072 sc1
  s_add_u32 s46, s54, 4096
  buffer_load_dwordx4 v[80:83], v5, s[8:11], s46 offen offset:0 sc1
  buffer_load_dwordx4 v[84:87], v5, s[8:11], s46 offen offset:1024 sc1
  buffer_load_dwordx4 v[88:91], v5, s[8:11], s46 offen offset:2048 sc1
  buffer_load_dwordx4 v[92:95], v5, s[8:11], s46 offen offset:3072 sc1
  s_add_u32 s46, s54, 8192
  buffer_load_dwordx4 v[96:99], v5, s[8:11], s46 offen offset:0 sc1
  buffer_load_dwordx4 v[100:103], v5, s[8:11], s46 offen offset:1024 sc1
  buffer_load_dwordx4 v[104:107], v5, s[8:11], s46 offen offset:2048 sc1
  buffer_load_dwordx4 v[108:111], v5, s[8:11], s46 offen offset:3072 sc1
  s_add_u32 s54, s54, 12288
u_nold_9:
  v_mfma_f32_16x16x32_bf16 v[112:115], v[16:19], a[0:3], 0
  v_mfma_f32_16x16x32_bf16 v[116:119], v[40:43], a[0:3], 0
  v_mfma_f32_16x16x32_bf16 v[112:115], v[20:23], a[4:7], v[112:115]
  v_mfma_f32_16x16x32_bf16 v[116:119], v[44:47], a[4:7], v[116:119]
  v_mfma_f32_16x16x32_bf16 v[112:115], v[24:27], a[8:11], v[112:115]
  v_mfma_f32_16x16x32_bf16 v[116:119], v[48:51], a[8:11], v[116:119]
  v_mfma_f32_16x16x32_bf16 v[112:115], v[28:31], a[12:15], v[112:115]
  v_mfma_f32_16x16x32_bf16 v[116:119], v[52:55], a[12:15], v[116:119]
  v_mfma_f32_16x16x32_bf16 v[112:115], v[32:35], a[16:19], v[112:115]
  v_mfma_f32_16x16x32_bf16 v[116:119], v[56:59], a[16:19], v[116:119]
  v_mfma_f32_16x16x32_bf16 v[112:115], v[36:39], a[20:23], v[112:115]
  v_mfma_f32_16x16x32_bf16 v[116:119], v[60:63], a[20:23], v[116:119]
  v_mfma_f32_16x16x32_bf16 v[120:123], v[16:19], a[24:27], 0
  v_mfma_f32_16x16x32_bf16 v[124:127], v[40:43], a[24:27], 0
  v_mfma_f32_16x16x32_bf16 v[120:123], v[20:23], a[28:31], v[120:123]
  v_mfma_f32_16x16x32_bf16 v[124:127], v[44:47], a[28:31], v[124:127]
  v_mfma_f32_16x16x32_bf16 v[120:123], v[24:27], a[32:35], v[120:123]
  v_mfma_f32_16x16x32_bf16 v[124:127], v[48:51], a[32:35], v[124:127]
  v_mfma_f32_16x16x32_bf16 v[120:123], v[28:31], a[36:39], v[120:123]
  v_mfma_f32_16x16x32_bf16 v[124:127], v[52:55], a[36:39], v[124:127]
  v_cvt_pk_bf16_f32 v136, v112, v113
  v_cvt_pk_bf16_f32 v137, v114, v115
  v_mfma_f32_16x16x32_bf16 v[120:123], v[32:35], a[40:43], v[120:123]
  v_cvt_pk_bf16_f32 v138, v116, v117
  v_cvt_pk_bf16_f32 v139, v118, v119
  v_mfma_f32_16x16x32_bf16 v[124:127], v[56:59], a[40:43], v[124:127]
  s_add_u32 s58, s55, 0
  buffer_store_dwordx4 v[136:139], v5, s[8:11], s58 offen sc1
  v_mfma_f32_16x16x32_bf16 v[120:123], v[36:39], a[44:47], v[120:123]
  v_mfma_f32_16x16x32_bf16 v[124:127], v[60:63], a[44:47], v[124:127]
  v_mfma_f32_16x16x32_bf16 v[128:131], v[16:19], a[48:51], 0
  v_mfma_f32_16x16x32_bf16 v[132:135], v[40:43], a[48:51], 0
  v_mfma_f32_16x16x32_bf16 v[128:131], v[20:23], a[52:55], v[128:131]
  v_mfma_f32_16x16x32_bf16 v[132:135], v[44:47], a[52:55], v[132:135]
  v_mfma_f32_16x16x32_bf16 v[128:131], v[24:27], a[56:59], v[128:131]
  v_mfma_f32_16x16x32_bf16 v[132:135], v[48:51], a[56:59], v[132:135]
  v_mfma_f32_16x16x32_bf16 v[128:131], v[28:31], a[60:63], v[128:131]
  v_mfma_f32_16x16x32_bf16 v[132:135], v[52:55], a[60:63], v[132:135]
  v_cvt_pk_bf16_f32 v140, v120, v121
  v_cvt_pk_bf16_f32 v141, v122, v123
  v_mfma_f32_16x16x32_bf16 v[128:131], v[32:35], a[64:67], v[128:131]
  v_cvt_pk_bf16_f32 v142, v124, v125
  v_cvt_pk_bf16_f32 v143, v126, v127
  v_mfma_f32_16x16x32_bf16 v[132:135], v[56:59], a[64:67], v[132:135]
  s_add_u32 s58, s55, 131072
  buffer_store_dwordx4 v[140:143], v5, s[8:11], s58 offen sc1
  v_mfma_f32_16x16x32_bf16 v[128:131], v[36:39], a[68:71], v[128:131]
  v_mfma_f32_16x16x32_bf16 v[132:135], v[60:63], a[68:71], v[132:135]
  v_mfma_f32_16x16x32_bf16 v[112:115], v[16:19], a[72:75], 0
  v_mfma_f32_16x16x32_bf16 v[116:119], v[40:43], a[72:75], 0
  v_mfma_f32_16x16x32_bf16 v[112:115], v[20:23], a[76:79], v[112:115]
  v_mfma_f32_16x16x32_bf16 v[116:119], v[44:47], a[76:79], v[116:119]
  v_mfma_f32_16x16x32_bf16 v[112:115], v[24:27], a[80:83], v[112:115]
  v_mfma_f32_16x16x32_bf16 v[116:119], v[48:51], a[80:83], v[116:119]
  v_mfma_f32_16x16x32_bf16 v[112:115], v[28:31], a[84:87], v[112:115]
  v_mfma_f32_16x16x32_bf16 v[116:119], v[52:55], a[84:87], v[116:119]
  v_cvt_pk_bf16_f32 v144, v128, v129
  v_cvt_pk_bf16_f32 v145, v130, v131
  v_mfma_f32_16x16x32_bf16 v[112:115], v[32:35], a[88:91], v[112:115]
  v_cvt_pk_bf16_f32 v146, v132, v133
  v_cvt_pk_bf16_f32 v147, v134, v135
  v_mfma_f32_16x16x32_bf16 v[116:119], v[56:59], a[88:91], v[116:119]
  s_add_u32 s58, s55, 262144
  buffer_store_dwordx4 v[144:147], v5, s[8:11], s58 offen sc1
  v_mfma_f32_16x16x32_bf16 v[112:115], v[36:39], a[92:95], v[112:115]
  v_mfma_f32_16x16x32_bf16 v[116:119], v[60:63], a[92:95], v[116:119]
  v_mfma_f32_16x16x32_bf16 v[120:123], v[16:19], a[96:99], 0
  v_mfma_f32_16x16x32_bf16 v[124:127], v[40:43], a[96:99], 0
  v_mfma_f32_16x16x32_bf16 v[120:123], v[20:23], a[100:103], v[120:123]
  v_mfma_f32_16x16x32_bf16 v[124:127], v[44:47], a[100:103], v[124:127]
  v_mfma_f32_16x16x32_bf16 v[120:123], v[24:27], a[104:107], v[120:123]
  v_mfma_f32_16x16x32_bf16 v[124:127], v[48:51], a[104:107], v[124:127]
  v_mfma_f32_16x16x32_bf16 v[120:123], v[28:31], a[108:111], v[120:123]
  v_mfma_f32_16x16x32_bf16 v[124:127], v[52:55], a[108:111], v[124:127]
  v_cvt_pk_bf16_f32 v136, v112, v113
  v_cvt_pk_bf16_f32 v137, v114, v115
  v_mfma_f32_16x16x32_bf16 v[120:123], v[32:35], a[112:115], v[120:123]
  v_cvt_pk_bf16_f32 v138, v116, v117
  v_cvt_pk_bf16_f32 v139, v118, v119
  v_mfma_f32_16x16x32_bf16 v[124:127], v[56:59], a[112:115], v[124:127]
  s_add_u32 s58, s55, 393216
  buffer_store_dwordx4 v[136:139], v5, s[8:11], s58 offen sc1
  v_mfma_f32_16x16x32_bf16 v[120:123], v[36:39], a[116:119], v[120:123]
  v_mfma_f32_16x16x32_bf16 v[124:127], v[60:63], a[116:119], v[124:127]
  v_mfma_f32_16x16x32_bf16 v[128:131], v[16:19], a[120:123], 0
  v_mfma_f32_16x16x32_bf16 v[132:135], v[40:43], a[120:123], 0
  v_mfma_f32_16x16x32_bf16 v[128:131], v[20:23], a[124:127], v[128:131]
  v_mfma_f32_16x16x32_bf16 v[132:135], v[44:47], a[124:127], v[132:135]
  v_mfma_f32_16x16x32_bf16 v[128:131], v[24:27], a[128:131], v[128:131]
  v_mfma_f32_16x16x32_bf16 v[132:135], v[48:51], a[128:131], v[132:135]
  v_mfma_f32_16x16x32_bf16 v[128:131], v[28:31], a[132:135], v[128:131]
  v_mfma_f32_16x16x32_bf16 v[132:135], v[52:55], a[132:135], v[132:135]
  v_cvt_pk_bf16_f32 v140, v120, v121
  v_cvt_pk_bf16_f32 v141, v122, v123
  v_mfma_f32_16x16x32_bf16 v[128:131], v[32:35], a[136:139], v[128:131]
  v_cvt_pk_bf16_f32 v142, v124, v125
  v_cvt_pk_bf16_f32 v143, v126, v127
  v_mfma_f32_16x16x32_bf16 v[132:135], v[56:59], a[136:139], v[132:135]
  s_add_u32 s58, s55, 524288
  buffer_store_dwordx4 v[140:143], v5, s[8:11], s58 offen sc1
  v_mfma_f32_16x16x32_bf16 v[128:131], v[36:39], a[140:143], v[128:131]
  v_mfma_f32_16x16x32_bf16 v[132:135], v[60:63], a[140:143], v[132:135]
  v_mfma_f32_16x16x32_bf16 v[112:115], v[16:19], a[144:147], 0
  v_mfma_f32_16x16x32_bf16 v[116:119], v[40:43], a[144:147], 0
  v_mfma_f32_16x16x32_bf16 v[112:115], v[20:23], a[148:151], v[112:115]
  v_mfma_f32_16x16x32_bf16 v[116:119], v[44:47], a[148:151], v[116:119]
  v_mfma_f32_16x16x32_bf16 v[112:115], v[24:27], a[152:155], v[112:115]
  v_mfma_f32_16x16x32_bf16 v[116:119], v[48:51], a[152:155], v[116:119]
  v_mfma_f32_16x16x32_bf16 v[112:115], v[28:31], a[156:159], v[112:115]
  v_mfma_f32_16x16x32_bf16 v[116:119], v[52:55], a[156:159], v[116:119]
  v_cvt_pk_bf16_f32 v144, v128, v129
  v_cvt_pk_bf16_f32 v145, v130, v131
  v_mfma_f32_16x16x32_bf16 v[112:115], v[32:35], a[160:163], v[112:115]
  v_cvt_pk_bf16_f32 v146, v132, v133
  v_cvt_pk_bf16_f32 v147, v134, v135
  v_mfma_f32_16x16x32_bf16 v[116:119], v[56:59], a[160:163], v[116:119]
  s_add_u32 s58, s55, 655360
  buffer_store_dwordx4 v[144:147], v5, s[8:11], s58 offen sc1
  v_mfma_f32_16x16x32_bf16 v[112:115], v[36:39], a[164:167], v[112:115]
  v_mfma_f32_16x16x32_bf16 v[116:119], v[60:63], a[164:167], v[116:119]
  v_mfma_f32_16x16x32_bf16 v[120:123], v[16:19], a[168:171], 0
  v_mfma_f32_16x16x32_bf16 v[124:127], v[40:43], a[168:171], 0
  v_mfma_f32_16x16x32_bf16 v[120:123], v[20:23], a[172:175], v[120:123]
  v_mfma_f32_16x16x32_bf16 v[124:127], v[44:47], a[172:175], v[124:127]
  v_mfma_f32_16x16x32_bf16 v[120:123], v[24:27], a[176:179], v[120:123]
  v_mfma_f32_16x16x32_bf16 v[124:127], v[48:51], a[176:179], v[124:127]
  v_mfma_f32_16x16x32_bf16 v[120:123], v[28:31], a[180:183], v[120:123]
  v_mfma_f32_16x16x32_bf16 v[124:127], v[52:55], a[180:183], v[124:127]
  v_cvt_pk_bf16_f32 v136, v112, v113
  v_cvt_pk_bf16_f32 v137, v114, v115
  v_mfma_f32_16x16x32_bf16 v[120:123], v[32:35], a[184:187], v[120:123]
  v_cvt_pk_bf16_f32 v138, v116, v117
  v_cvt_pk_bf16_f32 v139, v118, v119
  v_mfma_f32_16x16x32_bf16 v[124:127], v[56:59], a[184:187], v[124:127]
  s_add_u32 s58, s55, 786432
  buffer_store_dwordx4 v[136:139], v5, s[8:11], s58 offen sc1
  v_mfma_f32_16x16x32_bf16 v[120:123], v[36:39], a[188:191], v[120:123]
  v_mfma_f32_16x16x32_bf16 v[124:127], v[60:63], a[188:191], v[124:127]
  v_mfma_f32_16x16x32_bf16 v[128:131], v[16:19], a[192:195], 0
  v_mfma_f32_16x16x32_bf16 v[132:135], v[40:43], a[192:195], 0
  v_mfma_f32_16x16x32_bf16 v[128:131], v[20:23], a[196:199], v[128:131]
  v_mfma_f32_16x16x32_bf16 v[132:135], v[44:47], a[196:199], v[132:135]
  v_mfma_f32_16x16x32_bf16 v[128:131], v[24:27], a[200:203], v[128:131]
  v_mfma_f32_16x16x32_bf16 v[132:135], v[48:51], a[200:203], v[132:135]
  v_mfma_f32_16x16x32_bf16 v[128:131], v[28:31], a[204:207], v[128:131]
  v_mfma_f32_16x16x32_bf16 v[132:135], v[52:55], a[204:207], v[132:135]
  v_cvt_pk_bf16_f32 v140, v120, v121
  v_cvt_pk_bf16_f32 v141, v122, v123
  v_mfma_f32_16x16x32_bf16 v[128:131], v[32:35], a[208:211], v[128:131]
  v_cvt_pk_bf16_f32 v142, v124, v125
  v_cvt_pk_bf16_f32 v143, v126, v127
  v_mfma_f32_16x16x32_bf16 v[132:135], v[56:59], a[208:211], v[132:135]
  s_add_u32 s58, s55, 917504
  buffer_store_dwordx4 v[140:143], v5, s[8:11], s58 offen sc1
  v_mfma_f32_16x16x32_bf16 v[128:131], v[36:39], a[212:215], v[128:131]
  v_mfma_f32_16x16x32_bf16 v[132:135], v[60:63], a[212:215], v[132:135]
  v_mfma_f32_16x16x32_bf16 v[112:115], v[16:19], a[216:219], 0
  v_mfma_f32_16x16x32_bf16 v[116:119], v[40:43], a[216:219], 0
  v_mfma_f32_16x16x32_bf16 v[112:115], v[20:23], a[220:223], v[112:115]
  v_mfma_f32_16x16x32_bf16 v[116:119], v[44:47], a[220:223], v[116:119]
  v_mfma_f32_16x16x32_bf16 v[112:115], v[24:27], a[224:227], v[112:115]
  v_mfma_f32_16x16x32_bf16 v[116:119], v[48:51], a[224:227], v[116:119]
  v_mfma_f32_16x16x32_bf16 v[112:115], v[28:31], a[228:231], v[112:115]
  v_mfma_f32_16x16x32_bf16 v[116:119], v[52:55], a[228:231], v[116:119]
  v_cvt_pk_bf16_f32 v144, v128, v129
  v_cvt_pk_bf16_f32 v145, v130, v131
  v_mfma_f32_16x16x32_bf16 v[112:115], v[32:35], a[232:235], v[112:115]
  v_cvt_pk_bf16_f32 v146, v132, v133
  v_cvt_pk_bf16_f32 v147, v134, v135
  v_mfma_f32_16x16x32_bf16 v[116:119], v[56:59], a[232:235], v[116:119]
  s_add_u32 s58, s55, 1048576
  buffer_store_dwordx4 v[144:147], v5, s[8:11], s58 offen sc1
  v_mfma_f32_16x16x32_bf16 v[112:115], v[36:39], a[236:239], v[112:115]
  v_mfma_f32_16x16x32_bf16 v[116:119], v[60:63], a[236:239], v[116:119]
  s_nop 6
  v_cvt_pk_bf16_f32 v136, v112, v113
  v_cvt_pk_bf16_f32 v137, v114, v115
  v_cvt_pk_bf16_f32 v138, v116, v117
  v_cvt_pk_bf16_f32 v139, v118, v119
  s_add_u32 s58, s55, 1179648
  buffer_store_dwordx4 v[136:139], v5, s[8:11], s58 offen sc1
  s_add_u32 s55, s55, 1310720
  s_cmp_lg_u32 s52, 0
  s_cbranch_scc1 u_noeag_10
  s_cmp_ge_u32 s56, s57
  s_cbranch_scc1 wf_done_14
  s_mov_b32 s50, 0
wf_loop_15:
  buffer_load_dword v8, v6, s[8:11], 0 offen sc1
  s_add_u32 s50, s50, 1
  s_cmp_gt_u32 s50, 131072
  s_cbranch_scc1 L_fail
  s_waitcnt vmcnt(0)
  v_readfirstlane_b32 s56, v8
  s_nop 0
  s_cmp_ge_u32 s56, s57
  s_cbranch_scc1 wf_done_14
  s_sleep 2
  s_branch wf_loop_15
wf_done_14:
  s_add_u32 s46, s54, 0
  buffer_load_dwordx4 v[64:67], v5, s[8:11], s46 offen offset:0 sc1
  buffer_load_dwordx4 v[68:71], v5, s[8:11], s46 offen offset:1024 sc1
  buffer_load_dwordx4 v[72:75], v5, s[8:11], s46 offen offset:2048 sc1
  buffer_load_dwordx4 v[76:79], v5, s[8:11], s46 offen offset:3072 sc1
  s_add_u32 s46, s54, 4096
  buffer_load_dwordx4 v[80:83], v5, s[8:11], s46 offen offset:0 sc1
  buffer_load_dwordx4 v[84:87], v5, s[8:11], s46 offen offset:1024 sc1
  buffer_load_dwordx4 v[88:91], v5, s[8:11], s46 offen offset:2048 sc1
  buffer_load_dwordx4 v[92:95], v5, s[8:11], s46 offen offset:3072 sc1
  s_add_u32 s46, s54, 8192
  buffer_load_dwordx4 v[96:99], v5, s[8:11], s46 offen offset:0 sc1
  buffer_load_dwordx4 v[100:103], v5, s[8:11], s46 offen offset:1024 sc1
  buffer_load_dwordx4 v[104:107], v5, s[8:11], s46 offen offset:2048 sc1
  buffer_load_dwordx4 v[108:111], v5, s[8:11], s46 offen offset:3072 sc1
  s_add_u32 s54, s54, 12288
  s_waitcnt vmcnt(0)
  s_mov_b32 s47, 1
  v_mov_b32 v8, s47
  s_mov_b64 exec, 1
  buffer_store_dword v8, v7, s[8:11], 0 offen sc1
  s_mov_b64 exec, -1
  s_branch u_nofl_11
u_noeag_10:
  s_waitcnt vmcnt(10)
  v_mov_b32 v8, s52
  s_mov_b64 exec, 1
  buffer_store_dword v8, v7, s[8:11], 0 offen sc1
  s_mov_b64 exec, -1
u_nofl_11:
  s_add_u32 s52, s52, 1
  s_add_u32 s57, s52, 2
  s_cmp_gt_u32 s57, 64
  s_cbranch_scc1 u_nold_16
  s_cmp_ge_u32 s56, s57
  s_cbranch_scc1 wf_done_19
  s_mov_b32 s50, 0
wf_loop_20:
  buffer_load_dword v8, v6, s[8:11], 0 offen sc1
  s_add_u32 s50, s50, 1
  s_cmp_gt_u32 s50, 131072
  s_cbranch_scc1 L_fail
  s_waitcnt vmcnt(0)
  v_readfirstlane_b32 s56, v8
  s_nop 0
  s_cmp_ge_u32 s56, s57
  s_cbranch_scc1 wf_done_19
  s_sleep 2
  s_branch wf_loop_20
wf_done_19:
  s_add_u32 s46, s54, 0
  buffer_load_dwordx4 v[16:19], v5, s[8:11], s46 offen offset:0 sc1
  buffer_load_dwordx4 v[20:23], v5, s[8:11], s46 offen offset:1024 sc1
  buffer_load_dwordx4 v[24:27], v5, s[8:11], s46 offen offset:2048 sc1
  buffer_load_dwordx4 v[28:31], v5, s[8:11], s46 offen offset:3072 sc1
  s_add_u32 s46, s54, 4096
  buffer_load_dwordx4 v[32:35], v5, s[8:11], s46 offen offset:0 sc1
  buffer_load_dwordx4 v[36:39], v5, s[8:11], s46 offen offset:1024 sc1
  buffer_load_dwordx4 v[40:43], v5, s[8:11], s46 offen offset:2048 sc1
  buffer_load_dwordx4 v[44:47], v5, s[8:11], s46 offen offset:3072 sc1
  s_add_u32 s46, s54, 8192
  buffer_load_dwordx4 v[48:51], v5, s[8:11], s46 offen offset:0 sc1
  buffer_load_dwordx4 v[52:55], v5, s[8:11], s46 offen offset:1024 sc1
  buffer_load_dwordx4 v[56:59], v5, s[8:11], s46 offen offset:2048 sc1
  buffer_load_dwordx4 v[60:63], v5, s[8:11], s46 offen offset:3072 sc1
  s_add_u32 s54, s54, 12288
u_nold_16:
  v_mfma_f32_16x16x32_bf16 v[112:115], v[64:67], a[0:3], 0
  v_mfma_f32_16x16x32_bf16 v[116:119], v[88:91], a[0:3], 0
  v_mfma_f32_16x16x32_bf16 v[112:115], v[68:71], a[4:7], v[112:115]
  v_mfma_f32_16x16x32_bf16 v[116:119], v[92:95], a[4:7], v[116:119]
  v_mfma_f32_16x16x32_bf16 v[112:115], v[72:75], a[8:11], v[112:115]
  v_mfma_f32_16x16x32_bf16 v[116:119], v[96:99], a[8:11], v[116:119]
  v_mfma_f32_16x16x32_bf16 v[112:115], v[76:79], a[12:15], v[112:115]
  v_mfma_f32_16x16x32_bf16 v[116:119], v[100:103], a[12:15], v[116:119]
  v_mfma_f32_16x16x32_bf16 v[112:115], v[80:83], a[16:19], v[112:115]
  v_mfma_f32_16x16x32_bf16 v[116:119], v[104:107], a[16:19], v[116:119]
  v_mfma_f32_16x16x32_bf16 v[112:115], v[84:87], a[20:23], v[112:115]
  v_mfma_f32_16x16x32_bf16 v[116:119], v[108:111], a[20:23], v[116:119]
  v_mfma_f32_16x16x32_bf16 v[120:123], v[64:67], a[24:27], 0
  v_mfma_f32_16x16x32_bf16 v[124:127], v[88:91], a[24:27], 0
  v_mfma_f32_16x16x32_bf16 v[120:123], v[68:71], a[28:31], v[120:123]
  v_mfma_f32_16x16x32_bf16 v[124:127], v[92:95], a[28:31], v[124:127]
  v_mfma_f32_16x16x32_bf16 v[120:123], v[72:75], a[32:35], v[120:123]
  v_mfma_f32_16x16x32_bf16 v[124:127], v[96:99], a[32:35], v[124:127]
  v_mfma_f32_16x16x32_bf16 v[120:123], v[76:79], a[36:39], v[120:123]
  v_mfma_f32_16x16x32_bf16 v[124:127], v[100:103], a[36:39], v[124:127]
  v_cvt_pk_bf16_f32 v136, v112, v113
  v_cvt_pk_bf16_f32 v137, v114, v115
  v_mfma_f32_16x16x32_bf16 v[120:123], v[80:83], a[40:43], v[120:123]
  v_cvt_pk_bf16_f32 v138, v116, v117
  v_cvt_pk_bf16_f32 v139, v118, v119
  v_mfma_f32_16x16x32_bf16 v[124:127], v[104:107], a[40:43], v[124:127]
  s_add_u32 s58, s55, 0
  buffer_store_dwordx4 v[136:139], v5, s[8:11], s58 offen sc1
  v_mfma_f32_16x16x32_bf16 v[120:123], v[84:87], a[44:47], v[120:123]
  v_mfma_f32_16x16x32_bf16 v[124:127], v[108:111], a[44:47], v[124:127]
  v_mfma_f32_16x16x32_bf16 v[128:131], v[64:67], a[48:51], 0
  v_mfma_f32_16x16x32_bf16 v[132:135], v[88:91], a[48:51], 0
  v_mfma_f32_16x16x32_bf16 v[128:131], v[68:71], a[52:55], v[128:131]
  v_mfma_f32_16x16x32_bf16 v[132:135], v[92:95], a[52:55], v[132:135]
  v_mfma_f32_16x16x32_bf16 v[128:131], v[72:75], a[56:59], v[128:131]
  v_mfma_f32_16x16x32_bf16 v[132:135], v[96:99], a[56:59], v[132:135]
  v_mfma_f32_16x16x32_bf16 v[128:131], v[76:79], a[60:63], v[128:131]
  v_mfma_f32_16x16x32_bf16 v[132:135], v[100:103], a[60:63], v[132:135]
  v_cvt_pk_bf16_f32 v140, v120, v121
  v_cvt_pk_bf16_f32 v141, v122, v123
  v_mfma_f32_16x16x32_bf16 v[128:131], v[80:83], a[64:67], v[128:131]
  v_cvt_pk_bf16_f32 v142, v124, v125
  v_cvt_pk_bf16_f32 v143, v126, v127
  v_mfma_f32_16x16x32_bf16 v[132:135], v[104:107], a[64:67], v[132:135]
  s_add_u32 s58, s55, 131072
  buffer_store_dwordx4 v[140:143], v5, s[8:11], s58 offen sc1
  v_mfma_f32_16x16x32_bf16 v[128:131], v[84:87], a[68:71], v[128:131]
  v_mfma_f32_16x16x32_bf16 v[132:135], v[108:111], a[68:71], v[132:135]
  v_mfma_f32_16x16x32_bf16 v[112:115], v[64:67], a[72:75], 0
  v_mfma_f32_16x16x32_bf16 v[116:119], v[88:91], a[72:75], 0
  v_mfma_f32_16x16x32_bf16 v[112:115], v[68:71], a[76:79], v[112:115]
  v_mfma_f32_16x16x32_bf16 v[116:119], v[92:95], a[76:79], v[116:119]
  v_mfma_f32_16x16x32_bf16 v[112:115], v[72:75], a[80:83], v[112:115]
  v_mfma_f32_16x16x32_bf16 v[116:119], v[96:99], a[80:83], v[116:119]
  v_mfma_f32_16x16x32_bf16 v[112:115], v[76:79], a[84:87], v[112:115]
  v_mfma_f32_16x16x32_bf16 v[116:119], v[100:103], a[84:87], v[116:119]
  v_cvt_pk_bf16_f32 v144, v128, v129
  v_cvt_pk_bf16_f32 v145, v130, v131
  v_mfma_f32_16x16x32_bf16 v[112:115], v[80:83], a[88:91], v[112:115]
  v_cvt_pk_bf16_f32 v146, v132, v133
  v_cvt_pk_bf16_f32 v147, v134, v135
  v_mfma_f32_16x16x32_bf16 v[116:119], v[104:107], a[88:91], v[116:119]
  s_add_u32 s58, s55, 262144
  buffer_store_dwordx4 v[144:147], v5, s[8:11], s58 offen sc1
  v_mfma_f32_16x16x32_bf16 v[112:115], v[84:87], a[92:95], v[112:115]
  v_mfma_f32_16x16x32_bf16 v[116:119], v[108:111], a[92:95], v[116:119]
  v_mfma_f32_16x16x32_bf16 v[120:123], v[64:67], a[96:99], 0
  v_mfma_f32_16x16x32_bf16 v[124:127], v[88:91], a[96:99], 0
  v_mfma_f32_16x16x32_bf16 v[120:123], v[68:71], a[100:103], v[120:123]
  v_mfma_f32_16x16x32_bf16 v[124:127], v[92:95], a[100:103], v[124:127]
  v_mfma_f32_16x16x32_bf16 v[120:123], v[72:75], a[104:107], v[120:123]
  v_mfma_f32_16x16x32_bf16 v[124:127], v[96:99], a[104:107], v[124:127]
  v_mfma_f32_16x16x32_bf16 v[120:123], v[76:79], a[108:111], v[120:123]
  v_mfma_f32_16x16x32_bf16 v[124:127], v[100:103], a[108:111], v[124:127]
  v_cvt_pk_bf16_f32 v136, v112, v113
  v_cvt_pk_bf16_f32 v137, v114, v115
  v_mfma_f32_16x16x32_bf16 v[120:123], v[80:83], a[112:115], v[120:123]
  v_cvt_pk_bf16_f32 v138, v116, v117
  v_cvt_pk_bf16_f32 v139, v118, v119
  v_mfma_f32_16x16x32_bf16 v[124:127], v[104:107], a[112:115], v[124:127]
  s_add_u32 s58, s55, 393216
  buffer_store_dwordx4 v[136:139], v5, s[8:11], s58 offen sc1
  v_mfma_f32_16x16x32_bf16 v[120:123], v[84:87], a[116:119], v[120:123]
  v_mfma_f32_16x16x32_bf16 v[124:127], v[108:111], a[116:119], v[124:127]
  v_mfma_f32_16x16x32_bf16 v[128:131], v[64:67], a[120:123], 0
  v_mfma_f32_16x16x32_bf16 v[132:135], v[88:91], a[120:123], 0
  v_mfma_f32_16x16x32_bf16 v[128:131], v[68:71], a[124:127], v[128:131]
  v_mfma_f32_16x16x32_bf16 v[132:135], v[92:95], a[124:127], v[132:135]
  v_mfma_f32_16x16x32_bf16 v[128:131], v[72:75], a[128:131], v[128:131]
  v_mfma_f32_16x16x32_bf16 v[132:135], v[96:99], a[128:131], v[132:135]
  v_mfma_f32_16x16x32_bf16 v[128:131], v[76:79], a[132:135], v[128:131]
  v_mfma_f32_16x16x32_bf16 v[132:135], v[100:103], a[132:135], v[132:135]
  v_cvt_pk_bf16_f32 v140, v120, v121
  v_cvt_pk_bf16_f32 v141, v122, v123
  v_mfma_f32_16x16x32_bf16 v[128:131], v[80:83], a[136:139], v[128:131]
  v_cvt_pk_bf16_f32 v142, v124, v125
  v_cvt_pk_bf16_f32 v143, v126, v127
  v_mfma_f32_16x16x32_bf16 v[132:135], v[104:107], a[136:139], v[132:135]
  s_add_u32 s58, s55, 524288
  buffer_store_dwordx4 v[140:143], v5, s[8:11], s58 offen sc1
  v_mfma_f32_16x16x32_bf16 v[128:131], v[84:87], a[140:143], v[128:131]
  v_mfma_f32_16x16x32_bf16 v[132:135], v[108:111], a[140:143], v[132:135]
  v_mfma_f32_16x16x32_bf16 v[112:115], v[64:67], a[144:147], 0
  v_mfma_f32_16x16x32_bf16 v[116:119], v[88:91], a[144:147], 0
  v_mfma_f32_16x16x32_bf16 v[112:115], v[68:71], a[148:151], v[112:115]
  v_mfma_f32_16x16x32_bf16 v[116:119], v[92:95], a[148:151], v[116:119]
  v_mfma_f32_16x16x32_bf16 v[112:115], v[72:75], a[152:155], v[112:115]
  v_mfma_f32_16x16x32_bf16 v[116:119], v[96:99], a[152:155], v[116:119]
  v_mfma_f32_16x16x32_bf16 v[112:115], v[76:79], a[156:159], v[112:115]
  v_mfma_f32_16x16x32_bf16 v[116:119], v[100:103], a[156:159], v[116:119]
  v_cvt_pk_bf16_f32 v144, v128, v129
  v_cvt_pk_bf16_f32 v145, v130, v131
  v_mfma_f32_16x16x32_bf16 v[112:115], v[80:83], a[160:163], v[112:115]
  v_cvt_pk_bf16_f32 v146, v132, v133
  v_cvt_pk_bf16_f32 v147, v134, v135
  v_mfma_f32_16x16x32_bf16 v[116:119], v[104:107], a[160:163], v[116:119]
  s_add_u32 s58, s55, 655360
  buffer_store_dwordx4 v[144:147], v5, s[8:11], s58 offen sc1
  v_mfma_f32_16x16x32_bf16 v[112:115], v[84:87], a[164:167], v[112:115]
  v_mfma_f32_16x16x32_bf16 v[116:119], v[108:111], a[164:167], v[116:119]
  v_mfma_f32_16x16x32_bf16 v[120:123], v[64:67], a[168:171], 0
  v_mfma_f32_16x16x32_bf16 v[124:127], v[88:91], a[168:171], 0
  v_mfma_f32_16x16x32_bf16 v[120:123], v[68:71], a[172:175], v[120:123]
  v_mfma_f32_16x16x32_bf16 v[124:127], v[92:95], a[172:175], v[124:127]
  v_mfma_f32_16x16x32_bf16 v[120:123], v[72:75], a[176:179], v[120:123]
  v_mfma_f32_16x16x32_bf16 v[124:127], v[96:99], a[176:179], v[124:127]
  v_mfma_f32_16x16x32_bf16 v[120:123], v[76:79], a[180:183], v[120:123]
  v_mfma_f32_16x16x32_bf16 v[124:127], v[100:103], a[180:183], v[124:127]
  v_cvt_pk_bf16_f32 v136, v112, v113
  v_cvt_pk_bf16_f32 v137, v114, v115
  v_mfma_f32_16x16x32_bf16 v[120:123], v[80:83], a[184:187], v[120:123]
  v_cvt_pk_bf16_f32 v138, v116, v117
  v_cvt_pk_bf16_f32 v139, v118, v119
  v_mfma_f32_16x16x32_bf16 v[124:127], v[104:107], a[184:187], v[124:127]
  s_add_u32 s58, s55, 786432
  buffer_store_dwordx4 v[136:139], v5, s[8:11], s58 offen sc1
  v_mfma_f32_16x16x32_bf16 v[120:123], v[84:87], a[188:191], v[120:123]
  v_mfma_f32_16x16x32_bf16 v[124:127], v[108:111], a[188:191], v[124:127]
  v_mfma_f32_16x16x32_bf16 v[128:131], v[64:67], a[192:195], 0
  v_mfma_f32_16x16x32_bf16 v[132:135], v[88:91], a[192:195], 0
  v_mfma_f32_16x16x32_bf16 v[128:131], v[68:71], a[196:199], v[128:131]
  v_mfma_f32_16x16x32_bf16 v[132:135], v[92:95], a[196:199], v[132:135]
  v_mfma_f32_16x16x32_bf16 v[128:131], v[72:75], a[200:203], v[128:131]
  v_mfma_f32_16x16x32_bf16 v[132:135], v[96:99], a[200:203], v[132:135]
  v_mfma_f32_16x16x32_bf16 v[128:131], v[76:79], a[204:207], v[128:131]
  v_mfma_f32_16x16x32_bf16 v[132:135], v[100:103], a[204:207], v[132:135]
  v_cvt_pk_bf16_f32 v140, v120, v121
  v_cvt_pk_bf16_f32 v141, v122, v123
  v_mfma_f32_16x16x32_bf16 v[128:131], v[80:83], a[208:211], v[128:131]
  v_cvt_pk_bf16_f32 v142, v124, v125
  v_cvt_pk_bf16_f32 v143, v126, v127
  v_mfma_f32_16x16x32_bf16 v[132:135], v[104:107], a[208:211], v[132:135]
  s_add_u32 s58, s55, 917504
  buffer_store_dwordx4 v[140:143], v5, s[8:11], s58 offen sc1
  v_mfma_f32_16x16x32_bf16 v[128:131], v[84:87], a[212:215], v[128:131]
  v_mfma_f32_16x16x32_bf16 v[132:135], v[108:111], a[212:215], v[132:135]
  v_mfma_f32_16x16x32_bf16 v[112:115], v[64:67], a[216:219], 0
  v_mfma_f32_16x16x32_bf16 v[116:119], v[88:91], a[216:219], 0
  v_mfma_f32_16x16x32_bf16 v[112:115], v[68:71], a[220:223], v[112:115]
  v_mfma_f32_16x16x32_bf16 v[116:119], v[92:95], a[220:223], v[116:119]
  v_mfma_f32_16x16x32_bf16 v[112:115], v[72:75], a[224:227], v[112:115]
  v_mfma_f32_16x16x32_bf16 v[116:119], v[96:99], a[224:227], v[116:119]
  v_mfma_f32_16x16x32_bf16 v[112:115], v[76:79], a[228:231], v[112:115]
  v_mfma_f32_16x16x32_bf16 v[116:119], v[100:103], a[228:231], v[116:119]
  v_cvt_pk_bf16_f32 v144, v128, v129
  v_cvt_pk_bf16_f32 v145, v130, v131
  v_mfma_f32_16x16x32_bf16 v[112:115], v[80:83], a[232:235], v[112:115]
  v_cvt_pk_bf16_f32 v146, v132, v133
  v_cvt_pk_bf16_f32 v147, v134, v135
  v_mfma_f32_16x16x32_bf16 v[116:119], v[104:107], a[232:235], v[116:119]
  s_add_u32 s58, s55, 1048576
  buffer_store_dwordx4 v[144:147], v5, s[8:11], s58 offen sc1
  v_mfma_f32_16x16x32_bf16 v[112:115], v[84:87], a[236:239], v[112:115]
  v_mfma_f32_16x16x32_bf16 v[116:119], v[108:111], a[236:239], v[116:119]
  s_nop 6
  v_cvt_pk_bf16_f32 v136, v112, v113
  v_cvt_pk_bf16_f32 v137, v114, v115
  v_cvt_pk_bf16_f32 v138, v116, v117
  v_cvt_pk_bf16_f32 v139, v118, v119
  s_add_u32 s58, s55, 1179648
  buffer_store_dwordx4 v[136:139], v5, s[8:11], s58 offen sc1
  s_add_u32 s55, s55, 1310720
  s_waitcnt vmcnt(10)
  v_mov_b32 v8, s52
  s_mov_b64 exec, 1
  buffer_store_dword v8, v7, s[8:11], 0 offen sc1
  s_mov_b64 exec, -1
u_nofl_18:
  s_add_u32 s52, s52, 1
  s_cmp_lt_u32 s52, 64
  s_cbranch_scc1 u_loop_8
  s_waitcnt vmcnt(0)
  v_mov_b32 v8, s52
  s_mov_b64 exec, 1
  buffer_store_dword v8, v7, s[8:11], 0 offen sc1
  s_mov_b64 exec, -1
L_parta:
  s_barrier
  s_lshl_b32 s65, s44, 2
  s_add_u32 s65, s65, s43
  s_sub_u32 s65, s65, 4
  s_cmp_ge_u32 s65, 120
  s_cbranch_scc1 pa_att
  s_mov_b32 s4, s18
  s_mov_b32 s5, s19
  s_mov_b32 s6, 2457600
  s_mov_b32 s7, 0x20000
  s_mov_b32 s12, s16
  s_mov_b32 s13, s17
  s_mov_b32 s14, 2621440
  s_mov_b32 s15, 0x20000
  s_mul_i32 s46, s65, 205
  s_lshr_b32 s46, s46, 11
  s_mul_i32 s47, s46, 10
  s_sub_u32 s47, s65, s47
  s_mul_i32 s60, s47, 384
  s_mul_i32 s63, s47, 786432
  s_add_u32 s63, s63, 197132288
  s_mul_i32 s61, s46, 6
  s_add_u32 s62, s61, 6
  s_mul_i32 s48, s46, 3
  s_add_u32 s49, s48, 31
  s_add_u32 s48, s48, 28
  s_min_u32 s61, s61, s48
  s_min_u32 s62, s62, s49
  s_lshl_b32 s64, s65, 7
  s_add_u32 s64, s64, 2998272
  v_lshrrev_b32 v10, 3, v0
  v_lshrrev_b32 v11, 2, v10
  v_lshlrev_b32 v11, 3, v11
  v_and_b32 v1, 3, v10
  v_add_u32 v1, v1, v11
  s_and_b32 s46, s42, 1
  s_lshl_b32 s46, s46, 2
  s_lshr_b32 s47, s42, 1
  s_lshl_b32 s47, s47, 4
  s_add_u32 s46, s46, s47
  v_add_u32 v1, s46, v1
  v_mul_u32_u24 v1, 3840, v1
  v_lshrrev_b32 v10, 1, v10
  v_bfe_u32 v11, v0, 1, 2
  v_xor_b32 v10, v10, v11
  v_lshlrev_b32 v10, 5, v10
  v_and_b32 v11, 1, v0
  v_lshlrev_b32 v11, 4, v11
  v_add3_u32 v1, v1, v10, v11
  v_lshrrev_b32 v10, 5, v0
  v_lshlrev_b32 v2, 11, v10
  v_bfe_u32 v10, v0, 2, 3
  v_lshl_add_u32 v2, v10, 7, v2
  v_lshrrev_b32 v10, 1, v10
  v_xor_b32 v10, s42, v10
  v_lshl_add_u32 v2, v10, 5, v2
  v_and_b32 v10, 3, v0
  v_lshl_add_u32 v2, v10, 3, v2
  v_add_u32 v3, 0x10000, v2
  v_add_u32 v4, 0x20000, v2
  v_lshrrev_b32 v10, 3, v0
  s_lshl_b32 s46, s42, 3
  v_add_u32 v10, s46, v10
  v_mul_u32_u24 v5, 1280, v10
  v_bfe_u32 v10, v10, 1, 3
  v_and_b32 v11, 7, v0
  v_xor_b32 v10, v10, v11
  v_lshl_add_u32 v5, v10, 4, v5
  v_and_b32 v10, 15, v0
  v_lshlrev_b32 v6, 7, v10
  v_lshrrev_b32 v10, 1, v10
  v_lshrrev_b32 v11, 4, v0
  v_xor_b32 v10, v10, v11
  v_lshl_add_u32 v6, v10, 4, v6
  v_add_u32 v6, 122880, v6
  v_xor_b32 v7, 64, v6
  v_and_b32 v10, 15, v0
  v_lshlrev_b32 v8, 4, v10
  v_bfe_u32 v10, v0, 4, 1
  v_mul_u32_u24 v10, 6144, v10
  v_lshrrev_b32 v11, 5, v0
  v_lshlrev_b32 v11, 8, v11
  v_add3_u32 v8, v8, v10, v11
  s_lshl_b32 s46, s42, 9
  v_add_u32 v8, s46, v8
  v_mov_b32 v9, s64
  s_mov_b32 s52, s61
  s_mul_i32 s53, s52, 40960
  s_add_u32 s54, s51, 122880
  s_add_u32 m0, s54, 0
  s_nop 0
  buffer_load_dwordx4 v5, s[12:15], s53 offen offset:0 lds
  s_add_u32 m0, s54, 3968
  s_nop 0
  buffer_load_dwordx4 v5, s[12:15], s53 offen offset:128 lds
  s_add_u32 m0, s54, 7936
  s_nop 0
  buffer_load_dwordx4 v5, s[12:15], s53 offen offset:256 lds
  s_add_u32 m0, s54, 11904
  s_nop 0
  buffer_load_dwordx4 v5, s[12:15], s53 offen offset:384 lds
  s_add_u32 m0, s54, 15872
  s_nop 0
  buffer_load_dwordx4 v5, s[12:15], s53 offen offset:512 lds
  s_add_u32 m0, s54, 19840
  s_nop 0
  buffer_load_dwordx4 v5, s[12:15], s53 offen offset:640 lds
  s_add_u32 m0, s54, 23808
  s_nop 0
  buffer_load_dwordx4 v5, s[12:15], s53 offen offset:768 lds
  s_add_u32 m0, s54, 27776
  s_nop 0
  buffer_load_dwordx4 v5, s[12:15], s53 offen offset:896 lds
  s_add_u32 m0, s54, 31744
  s_nop 0
  buffer_load_dwordx4 v5, s[12:15], s53 offen offset:1024 lds
  s_add_u32 m0, s54, 35712
  s_nop 0
  buffer_load_dwordx4 v5, s[12:15], s53 offen offset:1152 lds
  s_add_u32 m0, s51, 0
  s_add_u32 s46, s60, 0
  buffer_load_dwordx4 v1, s[4:7], s46 offen lds
  s_add_u32 m0, s51, 4096
  s_add_u32 s46, s60, 128
  buffer_load_dwordx4 v1, s[4:7], s46 offen lds
  s_add_u32 m0, s51, 8192
  s_add_u32 s46, s60, 256
  buffer_load_dwordx4 v1, s[4:7], s46 offen lds
  s_add_u32 m0, s51, 12288
  s_add_u32 s46, s60, 122880
  buffer_load_dwordx4 v1, s[4:7], s46 offen lds
  s_add_u32 m0, s51, 16384
  s_add_u32 s46, s60, 123008
  buffer_load_dwordx4 v1, s[4:7], s46 offen lds
  s_add_u32 m0, s51, 20480
  s_add_u32 s46, s60, 123136
  buffer_load_dwordx4 v1, s[4:7], s46 offen lds
  s_add_u32 m0, s51, 24576
  s_add_u32 s46, s60, 245760
  buffer_load_dwordx4 v1, s[4:7], s46 offen lds
  s_add_u32 m0, s51, 28672
  s_add_u32 s46, s60, 245888
  buffer_load_dwordx4 v1, s[4:7], s46 offen lds
  s_add_u32 m0, s51, 32768
  s_add_u32 s46, s60, 246016
  buffer_load_dwordx4 v1, s[4:7], s46 offen lds
  s_add_u32 m0, s51, 36864
  s_add_u32 s46, s60, 368640
  buffer_load_dwordx4 v1, s[4:7], s46 offen lds
  s_add_u32 m0, s51, 40960
  s_add_u32 s46, s60, 368768
  buffer_load_dwordx4 v1, s[4:7], s46 offen lds
  s_add_u32 m0, s51, 45056
  s_add_u32 s46, s60, 368896
  buffer_load_dwordx4 v1, s[4:7], s46 offen lds
  s_add_u32 m0, s51, 49152
  s_add_u32 s46, s60, 491520
  buffer_load_dwordx4 v1, s[4:7], s46 offen lds
  s_add_u32 m0, s51, 53248
  s_add_u32 s46, s60, 491648
  buffer_load_dwordx4 v1, s[4:7], s46 offen lds
  s_add_u32 m0, s51, 57344
  s_add_u32 s46, s60, 491776
  buffer_load_dwordx4 v1, s[4:7], s46 offen lds
  s_add_u32 m0, s51, 61440
  s_add_u32 s46, s60, 614400
  buffer_load_dwordx4 v1, s[4:7], s46 offen lds
  s_add_u32 m0, s51, 65536
  s_add_u32 s46, s60, 614528
  buffer_load_dwordx4 v1, s[4:7], s46 offen lds
  s_add_u32 m0, s51, 69632
  s_add_u32 s46, s60, 614656
  buffer_load_dwordx4 v1, s[4:7], s46 offen lds
  s_add_u32 m0, s51, 73728
  s_add_u32 s46, s60, 737280
  buffer_load_dwordx4 v1, s[4:7], s46 offen lds
  s_add_u32 m0, s51, 77824
  s_add_u32 s46, s60, 737408
  buffer_load_dwordx4 v1, s[4:7], s46 offen lds
  s_add_u32 m0, s51, 81920
  s_add_u32 s46, s60, 737536
  buffer_load_dwordx4 v1, s[4:7], s46 offen lds
  s_add_u32 m0, s51, 86016
  s_add_u32 s46, s60, 860160
  buffer_load_dwordx4 v1, s[4:7], s46 offen lds
  s_add_u32 m0, s51, 90112
  s_add_u32 s46, s60, 860288
  buffer_load_dwordx4 v1, s[4:7], s46 offen lds
  s_add_u32 m0, s51, 94208
  s_add_u32 s46, s60, 860416
  buffer_load_dwordx4 v1, s[4:7], s46 offen lds
  s_waitcnt vmcnt(18)
  s_barrier
  s_add_u32 m0, s51, 98304
  s_add_u32 s46, s60, 983040
  buffer_load_dwordx4 v1, s[4:7], s46 offen lds
  s_add_u32 m0, s51, 102400
  s_add_u32 s46, s60, 983168
  buffer_load_dwordx4 v1, s[4:7], s46 offen lds
  s_add_u32 m0, s51, 106496
  s_add_u32 s46, s60, 983296
  buffer_load_dwordx4 v1, s[4:7], s46 offen lds
  s_add_u32 m0, s51, 110592
  s_add_u32 s46, s60, 1105920
  buffer_load_dwordx4 v1, s[4:7], s46 offen lds
  s_add_u32 m0, s51, 114688
  s_add_u32 s46, s60, 1106048
  buffer_load_dwordx4 v1, s[4:7], s46 offen lds
  s_add_u32 m0, s51, 118784
  s_add_u32 s46, s60, 1106176
  buffer_load_dwordx4 v1, s[4:7], s46 offen lds
  ds_read_b64_tr_b16 a[0:1], v2 offset:0
  ds_read_b64_tr_b16 a[2:3], v2 offset:1024
  ds_read_b64_tr_b16 a[4:5], v2 offset:4096
  ds_read_b64_tr_b16 a[6:7], v2 offset:5120
  ds_read_b64_tr_b16 a[8:9], v2 offset:8192
  ds_read_b64_tr_b16 a[10:11], v2 offset:9216
  ds_read_b64_tr_b16 a[12:13], v2 offset:12288
  ds_read_b64_tr_b16 a[14:15], v2 offset:13312
  ds_read_b64_tr_b16 a[16:17], v2 offset:16384
  ds_read_b64_tr_b16 a[18:19], v2 offset:17408
  ds_read_b64_tr_b16 a[20:21], v2 offset:20480
  ds_read_b64_tr_b16 a[22:23], v2 offset:21504
  s_waitcnt lgkmcnt(0)
  s_waitcnt vmcnt(18)
  s_barrier
  s_add_u32 m0, s51, 0
  s_add_u32 s46, s60, 1228800
  buffer_load_dwordx4 v1, s[4:7], s46 offen lds
  s_add_u32 m0, s51, 4096
  s_add_u32 s46, s60, 1228928
  buffer_load_dwordx4 v1, s[4:7], s46 offen lds
  s_add_u32 m0, s51, 8192
  s_add_u32 s46, s60, 1229056
  buffer_load_dwordx4 v1, s[4:7], s46 offen lds
  s_add_u32 m0, s51, 12288
  s_add_u32 s46, s60, 1351680
  buffer_load_dwordx4 v1, s[4:7], s46 offen lds
  s_add_u32 m0, s51, 16384
  s_add_u32 s46, s60, 1351808
  buffer_load_dwordx4 v1, s[4:7], s46 offen lds
  s_add_u32 m0, s51, 20480
  s_add_u32 s46, s60, 1351936
  buffer_load_dwordx4 v1, s[4:7], s46 offen lds
  ds_read_b64_tr_b16 a[24:25], v2 offset:24576
  ds_read_b64_tr_b16 a[26:27], v2 offset:25600
  ds_read_b64_tr_b16 a[28:29], v2 offset:28672
  ds_read_b64_tr_b16 a[30:31], v2 offset:29696
  ds_read_b64_tr_b16 a[32:33], v2 offset:32768
  ds_read_b64_tr_b16 a[34:35], v2 offset:33792
  ds_read_b64_tr_b16 a[36:37], v2 offset:36864
  ds_read_b64_tr_b16 a[38:39], v2 offset:37888
  ds_read_b64_tr_b16 a[40:41], v2 offset:40960
  ds_read_b64_tr_b16 a[42:43], v2 offset:41984
  ds_read_b64_tr_b16 a[44:45], v2 offset:45056
  ds_read_b64_tr_b16 a[46:47], v2 offset:46080
  s_waitcnt lgkmcnt(0)
  s_waitcnt vmcnt(18)
  s_barrier
  s_add_u32 m0, s51, 24576
  s_add_u32 s46, s60, 1474560
  buffer_load_dwordx4 v1, s[4:7], s46 offen lds
  s_add_u32 m0, s51, 28672
  s_add_u32 s46, s60, 1474688
  buffer_load_dwordx4 v1, s[4:7], s46 offen lds
  s_add_u32 m0, s51, 32768
  s_add_u32 s46, s60, 1474816
  buffer_load_dwordx4 v1, s[4:7], s46 offen lds
  s_add_u32 m0, s51, 36864
  s_add_u32 s46, s60, 1597440
  buffer_load_dwordx4 v1, s[4:7], s46 offen lds
  s_add_u32 m0, s51, 40960
  s_add_u32 s46, s60, 1597568
  buffer_load_dwordx4 v1, s[4:7], s46 offen lds
  s_add_u32 m0, s51, 45056
  s_add_u32 s46, s60, 1597696
  buffer_load_dwordx4 v1, s[4:7], s46 offen lds
  ds_read_b64_tr_b16 a[48:49], v2 offset:49152
  ds_read_b64_tr_b16 a[50:51], v2 offset:50176
  ds_read_b64_tr_b16 a[52:53], v2 offset:53248
  ds_read_b64_tr_b16 a[54:55], v2 offset:54272
  ds_read_b64_tr_b16 a[56:57], v2 offset:57344
  ds_read_b64_tr_b16 a[58:59], v2 offset:58368
  ds_read_b64_tr_b16 a[60:61], v2 offset:61440
  ds_read_b64_tr_b16 a[62:63], v2 offset:62464
  ds_read_b64_tr_b16 a[64:65], v3 offset:0
  ds_read_b64_tr_b16 a[66:67], v3 offset:1024
  ds_read_b64_tr_b16 a[68:69], v3 offset:4096
  ds_read_b64_tr_b16 a[70:71], v3 offset:5120
  s_waitcnt lgkmcnt(0)
  s_waitcnt vmcnt(18)
  s_barrier
  s_add_u32 m0, s51, 49152
  s_add_u32 s46, s60, 1720320
  buffer_load_dwordx4 v1, s[4:7], s46 offen lds
  s_add_u32 m0, s51, 53248
  s_add_u32 s46, s60, 1720448
  buffer_load_dwordx4 v1, s[4:7], s46 offen lds
  s_add_u32 m0, s51, 57344
  s_add_u32 s46, s60, 1720576
  buffer_load_dwordx4 v1, s[4:7], s46 offen lds
  s_add_u32 m0, s51, 61440
  s_add_u32 s46, s60, 1843200
  buffer_load_dwordx4 v1, s[4:7], s46 offen lds
  s_add_u32 m0, s51, 65536
  s_add_u32 s46, s60, 1843328
  buffer_load_dwordx4 v1, s[4:7], s46 offen lds
  s_add_u32 m0, s51, 69632
  s_add_u32 s46, s60, 1843456
  buffer_load_dwordx4 v1, s[4:7], s46 offen lds
  ds_read_b64_tr_b16 a[72:73], v3 offset:8192
  ds_read_b64_tr_b16 a[74:75], v3 offset:9216
  ds_read_b64_tr_b16 a[76:77], v3 offset:12288
  ds_read_b64_tr_b16 a[78:79], v3 offset:13312
  ds_read_b64_tr_b16 a[80:81], v3 offset:16384
  ds_read_b64_tr_b16 a[82:83], v3 offset:17408
  ds_read_b64_tr_b16 a[84:85], v3 offset:20480
  ds_read_b64_tr_b16 a[86:87], v3 offset:21504
  ds_read_b64_tr_b16 a[88:89], v3 offset:24576
  ds_read_b64_tr_b16 a[90:91], v3 offset:25600
  ds_read_b64_tr_b16 a[92:93], v3 offset:28672
  ds_read_b64_tr_b16 a[94:95], v3 offset:29696
  s_waitcnt lgkmcnt(0)
  s_waitcnt vmcnt(18)
  s_barrier
  s_add_u32 m0, s51, 73728
  s_add_u32 s46, s60, 1966080
  buffer_load_dwordx4 v1, s[4:7], s46 offen lds
  s_add_u32 m0, s51, 77824
  s_add_u32 s46, s60, 1966208
  buffer_load_dwordx4 v1, s[4:7], s46 offen lds
  s_add_u32 m0, s51, 81920
  s_add_u32 s46, s60, 1966336
  buffer_load_dwordx4 v1, s[4:7], s46 offen lds
  s_add_u32 m0, s51, 86016
  s_add_u32 s46, s60, 2088960
  buffer_load_dwordx4 v1, s[4:7], s46 offen lds
  s_add_u32 m0, s51, 90112
  s_add_u32 s46, s60, 2089088
  buffer_load_dwordx4 v1, s[4:7], s46 offen lds
  s_add_u32 m0, s51, 94208
  s_add_u32 s46, s60, 2089216
  buffer_load_dwordx4 v1, s[4:7], s46 offen lds
  ds_read_b64_tr_b16 a[96:97], v3 offset:32768
  ds_read_b64_tr_b16 a[98:99], v3 offset:33792
  ds_read_b64_tr_b16 a[100:101], v3 offset:36864
  ds_read_b64_tr_b16 a[102:103], v3 offset:37888
  ds_read_b64_tr_b16 a[104:105], v3 offset:40960
  ds_read_b64_tr_b16 a[106:107], v3 offset:41984
  ds_read_b64_tr_b16 a[108:109], v3 offset:45056
  ds_read_b64_tr_b16 a[110:111], v3 offset:46080
  ds_read_b64_tr_b16 a[112:113], v3 offset:49152
  ds_read_b64_tr_b16 a[114:115], v3 offset:50176
  ds_read_b64_tr_b16 a[116:117], v3 offset:53248
  ds_read_b64_tr_b16 a[118:119], v3 offset:54272
  s_waitcnt lgkmcnt(0)
  s_waitcnt vmcnt(18)
  s_barrier
  s_add_u32 m0, s51, 98304
  s_add_u32 s46, s60, 2211840
  buffer_load_dwordx4 v1, s[4:7], s46 offen lds
  s_add_u32 m0, s51, 102400
  s_add_u32 s46, s60, 2211968
  buffer_load_dwordx4 v1, s[4:7], s46 offen lds
  s_add_u32 m0, s51, 106496
  s_add_u32 s46, s60, 2212096
  buffer_load_dwordx4 v1, s[4:7], s46 offen lds
  s_add_u32 m0, s51, 110592
  s_add_u32 s46, s60, 2334720
  buffer_load_dwordx4 v1, s[4:7], s46 offen lds
  s_add_u32 m0, s51, 114688
  s_add_u32 s46, s60, 2334848
  buffer_load_dwordx4 v1, s[4:7], s46 offen lds
  s_add_u32 m0, s51, 118784
  s_add_u32 s46, s60, 2334976
  buffer_load_dwordx4 v1, s[4:7], s46 offen lds
  ds_read_b64_tr_b16 a[120:121], v2 offset:0
  ds_read_b64_tr_b16 a[122:123], v2 offset:1024
  ds_read_b64_tr_b16 a[124:125], v2 offset:4096
  ds_read_b64_tr_b16 a[126:127], v2 offset:5120
  ds_read_b64_tr_b16 a[128:129], v2 offset:8192
  ds_read_b64_tr_b16 a[130:131], v2 offset:9216
  ds_read_b64_tr_b16 a[132:133], v2 offset:12288
  ds_read_b64_tr_b16 a[134:135], v2 offset:13312
  ds_read_b64_tr_b16 a[136:137], v2 offset:16384
  ds_read_b64_tr_b16 a[138:139], v2 offset:17408
  ds_read_b64_tr_b16 a[140:141], v2 offset:20480
  ds_read_b64_tr_b16 a[142:143], v2 offset:21504
  s_waitcnt lgkmcnt(0)
  s_waitcnt vmcnt(18)
  s_barrier
  ds_read_b64_tr_b16 a[144:145], v2 offset:24576
  ds_read_b64_tr_b16 a[146:147], v2 offset:25600
  ds_read_b64_tr_b16 a[148:149], v2 offset:28672
  ds_read_b64_tr_b16 a[150:151], v2 offset:29696
  ds_read_b64_tr_b16 a[152:153], v2 offset:32768
  ds_read_b64_tr_b16 a[154:155], v2 offset:33792
  ds_read_b64_tr_b16 a[156:157], v2 offset:36864
  ds_read_b64_tr_b16 a[158:159], v2 offset:37888
  ds_read_b64_tr_b16 a[160:161], v2 offset:40960
  ds_read_b64_tr_b16 a[162:163], v2 offset:41984
  ds_read_b64_tr_b16 a[164:165], v2 offset:45056
  ds_read_b64_tr_b16 a[166:167], v2 offset:46080
  s_waitcnt lgkmcnt(0)
  s_waitcnt vmcnt(12)
  s_barrier
  ds_read_b64_tr_b16 a[168:169], v2 offset:49152
  ds_read_b64_tr_b16 a[170:171], v2 offset:50176
  ds_read_b64_tr_b16 a[172:173], v2 offset:53248
  ds_read_b64_tr_b16 a[174:175], v2 offset:54272
  ds_read_b64_tr_b16 a[176:177], v2 offset:57344
  ds_read_b64_tr_b16 a[178:179], v2 offset:58368
  ds_read_b64_tr_b16 a[180:181], v2 offset:61440
  ds_read_b64_tr_b16 a[182:183], v2 offset:62464
  ds_read_b64_tr_b16 a[184:185], v3 offset:0
  ds_read_b64_tr_b16 a[186:187], v3 offset:1024
  ds_read_b64_tr_b16 a[188:189], v3 offset:4096
  ds_read_b64_tr_b16 a[190:191], v3 offset:5120
  s_waitcnt lgkmcnt(0)
  s_waitcnt vmcnt(6)
  s_barrier
  ds_read_b64_tr_b16 a[192:193], v3 offset:8192
  ds_read_b64_tr_b16 a[194:195], v3 offset:9216
  ds_read_b64_tr_b16 a[196:197], v3 offset:12288
  ds_read_b64_tr_b16 a[198:199], v3 offset:13312
  ds_read_b64_tr_b16 a[200:201], v3 offset:16384
  ds_read_b64_tr_b16 a[202:203], v3 offset:17408
  ds_read_b64_tr_b16 a[204:205], v3 offset:20480
  ds_read_b64_tr_b16 a[206:207], v3 offset:21504
  ds_read_b64_tr_b16 a[208:209], v3 offset:24576
  ds_read_b64_tr_b16 a[210:211], v3 offset:25600
  ds_read_b64_tr_b16 a[212:213], v3 offset:28672
  ds_read_b64_tr_b16 a[214:215], v3 offset:29696
  s_waitcnt lgkmcnt(0)
  s_waitcnt vmcnt(0)
  s_barrier
  ds_read_b64_tr_b16 a[216:217], v3 offset:32768
  ds_read_b64_tr_b16 a[218:219], v3 offset:33792
  ds_read_b64_tr_b16 a[220:221], v3 offset:36864
  ds_read_b64_tr_b16 a[222:223], v3 offset:37888
  ds_read_b64_tr_b16 a[224:225], v3 offset:40960
  ds_read_b64_tr_b16 a[226:227], v3 offset:41984
  ds_read_b64_tr_b16 a[228:229], v3 offset:45056
  ds_read_b64_tr_b16 a[230:231], v3 offset:46080
  ds_read_b64_tr_b16 a[232:233], v3 offset:49152
  ds_read_b64_tr_b16 a[234:235], v3 offset:50176
  ds_read_b64_tr_b16 a[236:237], v3 offset:53248
  ds_read_b64_tr_b16 a[238:239], v3 offset:54272
  s_waitcnt lgkmcnt(0)
  s_barrier
pa_loop_21:
  s_add_u32 s57, s52, 1
  s_xor_b32 s54, s54, 122880
  s_add_u32 s53, s53, 40960
  ds_read_b128 v[16:19], v6 offset:0
  ds_read_b128 v[20:23], v6 offset:2048
  ds_read_b128 v[24:27], v7 offset:0
  ds_read_b128 v[28:31], v7 offset:2048
  ds_read_b128 v[32:35], v6 offset:4096
  s_waitcnt lgkmcnt(4)
  v_mfma_f32_16x16x32_bf16 v[40:43], a[0:3], v[16:19], 0
  s_add_u32 m0, s54, 0
  v_mfma_f32_16x16x32_bf16 v[48:51], a[4:7], v[16:19], 0
  buffer_load_dwordx4 v5, s[12:15], s53 offen offset:0 lds
  v_mfma_f32_16x16x32_bf16 v[56:59], a[8:11], v[16:19], 0
  ds_read_b128 v[36:39], v6 offset:6144
  s_waitcnt lgkmcnt(4)
  v_mfma_f32_16x16x32_bf16 v[44:47], a[0:3], v[20:23], 0
  v_mfma_f32_16x16x32_bf16 v[52:55], a[4:7], v[20:23], 0
  v_mfma_f32_16x16x32_bf16 v[60:63], a[8:11], v[20:23], 0
  ds_read_b128 v[16:19], v7 offset:4096
  s_waitcnt lgkmcnt(4)
  v_mfma_f32_16x16x32_bf16 v[40:43], a[12:15], v[24:27], v[40:43]
  s_add_u32 m0, s54, 3968
  v_mfma_f32_16x16x32_bf16 v[48:51], a[16:19], v[24:27], v[48:51]
  buffer_load_dwordx4 v5, s[12:15], s53 offen offset:128 lds
  v_mfma_f32_16x16x32_bf16 v[56:59], a[20:23], v[24:27], v[56:59]
  ds_read_b128 v[20:23], v7 offset:6144
  s_waitcnt lgkmcnt(4)
  v_mfma_f32_16x16x32_bf16 v[44:47], a[12:15], v[28:31], v[44:47]
  v_mfma_f32_16x16x32_bf16 v[52:55], a[16:19], v[28:31], v[52:55]
  v_mfma_f32_16x16x32_bf16 v[60:63], a[20:23], v[28:31], v[60:63]
  ds_read_b128 v[24:27], v6 offset:8192
  s_waitcnt lgkmcnt(4)
  v_mfma_f32_16x16x32_bf16 v[40:43], a[24:27], v[32:35], v[40:43]
  s_add_u32 m0, s54, 7936
  v_mfma_f32_16x16x32_bf16 v[48:51], a[28:31], v[32:35], v[48:51]
  buffer_load_dwordx4 v5, s[12:15], s53 offen offset:256 lds
  v_mfma_f32_16x16x32_bf16 v[56:59], a[32:35], v[32:35], v[56:59]
  ds_read_b128 v[28:31], v6 offset:10240
  s_waitcnt lgkmcnt(4)
  v_mfma_f32_16x16x32_bf16 v[44:47], a[24:27], v[36:39], v[44:47]
  v_mfma_f32_16x16x32_bf16 v[52:55], a[28:31], v[36:39], v[52:55]
  v_mfma_f32_16x16x32_bf16 v[60:63], a[32:35], v[36:39], v[60:63]
  ds_read_b128 v[32:35], v7 offset:8192
  s_waitcnt lgkmcnt(4)
  v_mfma_f32_16x16x32_bf16 v[40:43], a[36:39], v[16:19], v[40:43]
  s_add_u32 m0, s54, 11904
  v_mfma_f32_16x16x32_bf16 v[48:51], a[40:43], v[16:19], v[48:51]
  buffer_load_dwordx4 v5, s[12:15], s53 offen offset:384 lds
  v_mfma_f32_16x16x32_bf16 v[56:59], a[44:47], v[16:19], v[56:59]
  ds_read_b128 v[36:39], v7 offset:10240
  s_waitcnt lgkmcnt(4)
  v_mfma_f32_16x16x32_bf16 v[44:47], a[36:39], v[20:23], v[44:47]
  v_mfma_f32_16x16x32_bf16 v[52:55], a[40:43], v[20:23], v[52:55]
  v_mfma_f32_16x16x32_bf16 v[60:63], a[44:47], v[20:23], v[60:63]
  ds_read_b128 v[16:19], v6 offset:12288
  s_waitcnt lgkmcnt(4)
  v_mfma_f32_16x16x32_bf16 v[40:43], a[48:51], v[24:27], v[40:43]
  s_add_u32 m0, s54, 15872
  v_mfma_f32_16x16x32_bf16 v[48:51], a[52:55], v[24:27], v[48:51]
  buffer_load_dwordx4 v5, s[12:15], s53 offen offset:512 lds
  v_mfma_f32_16x16x32_bf16 v[56:59], a[56:59], v[24:27], v[56:59]
  ds_read_b128 v[20:23], v6 offset:14336
  s_waitcnt lgkmcnt(4)
  v_mfma_f32_16x16x32_bf16 v[44:47], a[48:51], v[28:31], v[44:47]
  v_mfma_f32_16x16x32_bf16 v[52:55], a[52:55], v[28:31], v[52:55]
  v_mfma_f32_16x16x32_bf16 v[60:63], a[56:59], v[28:31], v[60:63]
  ds_read_b128 v[24:27], v7 offset:12288
  s_waitcnt lgkmcnt(4)
  v_mfma_f32_16x16x32_bf16 v[40:43], a[60:63], v[32:35], v[40:43]
  s_add_u32 m0, s54, 19840
  v_mfma_f32_16x16x32_bf16 v[48:51], a[64:67], v[32:35], v[48:51]
  buffer_load_dwordx4 v5, s[12:15], s53 offen offset:640 lds
  v_mfma_f32_16x16x32_bf16 v[56:59], a[68:71], v[32:35], v[56:59]
  ds_read_b128 v[28:31], v7 offset:14336
  s_waitcnt lgkmcnt(4)
  v_mfma_f32_16x16x32_bf16 v[44:47], a[60:63], v[36:39], v[44:47]
  v_mfma_f32_16x16x32_bf16 v[52:55], a[64:67], v[36:39], v[52:55]
  v_mfma_f32_16x16x32_bf16 v[60:63], a[68:71], v[36:39], v[60:63]
  ds_read_b128 v[32:35], v6 offset:16384
  s_waitcnt lgkmcnt(4)
  v_mfma_f32_16x16x32_bf16 v[40:43], a[72:75], v[16:19], v[40:43]
  s_add_u32 m0, s54, 23808
  v_mfma_f32_16x16x32_bf16 v[48:51], a[76:79], v[16:19], v[48:51]
  buffer_load_dwordx4 v5, s[12:15], s53 offen offset:768 lds
  v_mfma_f32_16x16x32_bf16 v[56:59], a[80:83], v[16:19], v[56:59]
  ds_read_b128 v[36:39], v6 offset:18432
  s_waitcnt lgkmcnt(4)
  v_mfma_f32_16x16x32_bf16 v[44:47], a[72:75], v[20:23], v[44:47]
  v_mfma_f32_16x16x32_bf16 v[52:55], a[76:79], v[20:23], v[52:55]
  v_mfma_f32_16x16x32_bf16 v[60:63], a[80:83], v[20:23], v[60:63]
  ds_read_b128 v[16:19], v7 offset:16384
  s_waitcnt lgkmcnt(4)
  v_mfma_f32_16x16x32_bf16 v[40:43], a[84:87], v[24:27], v[40:43]
  s_add_u32 m0, s54, 27776
  v_mfma_f32_16x16x32_bf16 v[48:51], a[88:91], v[24:27], v[48:51]
  buffer_load_dwordx4 v5, s[12:15], s53 offen offset:896 lds
  v_mfma_f32_16x16x32_bf16 v[56:59], a[92:95], v[24:27], v[56:59]
  ds_read_b128 v[20:23], v7 offset:18432
  s_waitcnt lgkmcnt(4)
  v_mfma_f32_16x16x32_bf16 v[44:47], a[84:87], v[28:31], v[44:47]
  v_mfma_f32_16x16x32_bf16 v[52:55], a[88:91], v[28:31], v[52:55]
  v_mfma_f32_16x16x32_bf16 v[60:63], a[92:95], v[28:31], v[60:63]
  ds_read_b128 v[24:27], v6 offset:20480
  s_waitcnt lgkmcnt(4)
  v_mfma_f32_16x16x32_bf16 v[40:43], a[96:99], v[32:35], v[40:43]
  s_add_u32 m0, s54, 31744
  v_mfma_f32_16x16x32_bf16 v[48:51], a[100:103], v[32:35], v[48:51]
  buffer_load_dwordx4 v5, s[12:15], s53 offen offset:1024 lds
  v_mfma_f32_16x16x32_bf16 v[56:59], a[104:107], v[32:35], v[56:59]
  ds_read_b128 v[28:31], v6 offset:22528
  s_waitcnt lgkmcnt(4)
  v_mfma_f32_16x16x32_bf16 v[44:47], a[96:99], v[36:39], v[44:47]
  v_mfma_f32_16x16x32_bf16 v[52:55], a[100:103], v[36:39], v[52:55]
  v_mfma_f32_16x16x32_bf16 v[60:63], a[104:107], v[36:39], v[60:63]
  ds_read_b128 v[32:35], v7 offset:20480
  s_waitcnt lgkmcnt(4)
  v_mfma_f32_16x16x32_bf16 v[40:43], a[108:111], v[16:19], v[40:43]
  s_add_u32 m0, s54, 35712
  v_mfma_f32_16x16x32_bf16 v[48:51], a[112:115], v[16:19], v[48:51]
  buffer_load_dwordx4 v5, s[12:15], s53 offen offset:1152 lds
  v_mfma_f32_16x16x32_bf16 v[56:59], a[116:119], v[16:19], v[56:59]
  ds_read_b128 v[36:39], v7 offset:22528
  s_waitcnt lgkmcnt(4)
  v_mfma_f32_16x16x32_bf16 v[44:47], a[108:111], v[20:23], v[44:47]
  v_mfma_f32_16x16x32_bf16 v[52:55], a[112:115], v[20:23], v[52:55]
  v_mfma_f32_16x16x32_bf16 v[60:63], a[116:119], v[20:23], v[60:63]
  ds_read_b128 v[16:19], v6 offset:24576
  s_waitcnt lgkmcnt(4)
  v_mfma_f32_16x16x32_bf16 v[40:43], a[120:123], v[24:27], v[40:43]
  v_mfma_f32_16x16x32_bf16 v[48:51], a[124:127], v[24:27], v[48:51]
  v_mfma_f32_16x16x32_bf16 v[56:59], a[128:131], v[24:27], v[56:59]
  ds_read_b128 v[20:23], v6 offset:26624
  s_waitcnt lgkmcnt(4)
  v_mfma_f32_16x16x32_bf16 v[44:47], a[120:123], v[28:31], v[44:47]
  v_mfma_f32_16x16x32_bf16 v[52:55], a[124:127], v[28:31], v[52:55]
  v_mfma_f32_16x16x32_bf16 v[60:63], a[128:131], v[28:31], v[60:63]
  ds_read_b128 v[24:27], v7 offset:24576
  s_waitcnt lgkmcnt(4)
  v_mfma_f32_16x16x32_bf16 v[40:43], a[132:135], v[32:35], v[40:43]
  v_mfma_f32_16x16x32_bf16 v[48:51], a[136:139], v[32:35], v[48:51]
  v_mfma_f32_16x16x32_bf16 v[56:59], a[140:143], v[32:35], v[56:59]
  ds_read_b128 v[28:31], v7 offset:26624
  s_waitcnt lgkmcnt(4)
  v_mfma_f32_16x16x32_bf16 v[44:47], a[132:135], v[36:39], v[44:47]
  v_mfma_f32_16x16x32_bf16 v[52:55], a[136:139], v[36:39], v[52:55]
  v_mfma_f32_16x16x32_bf16 v[60:63], a[140:143], v[36:39], v[60:63]
  ds_read_b128 v[32:35], v6 offset:28672
  s_waitcnt lgkmcnt(4)
  v_mfma_f32_16x16x32_bf16 v[40:43], a[144:147], v[16:19], v[40:43]
  v_mfma_f32_16x16x32_bf16 v[48:51], a[148:151], v[16:19], v[48:51]
  v_mfma_f32_16x16x32_bf16 v[56:59], a[152:155], v[16:19], v[56:59]
  ds_read_b128 v[36:39], v6 offset:30720
  s_waitcnt lgkmcnt(4)
  v_mfma_f32_16x16x32_bf16 v[44:47], a[144:147], v[20:23], v[44:47]
  v_mfma_f32_16x16x32_bf16 v[52:55], a[148:151], v[20:23], v[52:55]
  v_mfma_f32_16x16x32_bf16 v[60:63], a[152:155], v[20:23], v[60:63]
  ds_read_b128 v[16:19], v7 offset:28672
  s_waitcnt lgkmcnt(4)
  v_mfma_f32_16x16x32_bf16 v[40:43], a[156:159], v[24:27], v[40:43]
  v_mfma_f32_16x16x32_bf16 v[48:51], a[160:163], v[24:27], v[48:51]
  v_mfma_f32_16x16x32_bf16 v[56:59], a[164:167], v[24:27], v[56:59]
  ds_read_b128 v[20:23], v7 offset:30720
  s_waitcnt lgkmcnt(4)
  v_mfma_f32_16x16x32_bf16 v[44:47], a[156:159], v[28:31], v[44:47]
  v_mfma_f32_16x16x32_bf16 v[52:55], a[160:163], v[28:31], v[52:55]
  v_mfma_f32_16x16x32_bf16 v[60:63], a[164:167], v[28:31], v[60:63]
  ds_read_b128 v[24:27], v6 offset:32768
  s_waitcnt lgkmcnt(4)
  v_mfma_f32_16x16x32_bf16 v[40:43], a[168:171], v[32:35], v[40:43]
  v_mfma_f32_16x16x32_bf16 v[48:51], a[172:175], v[32:35], v[48:51]
  v_mfma_f32_16x16x32_bf16 v[56:59], a[176:179], v[32:35], v[56:59]
  ds_read_b128 v[28:31], v6 offset:34816
  s_waitcnt lgkmcnt(4)
  v_mfma_f32_16x16x32_bf16 v[44:47], a[168:171], v[36:39], v[44:47]
  v_mfma_f32_16x16x32_bf16 v[52:55], a[172:175], v[36:39], v[52:55]
  v_mfma_f32_16x16x32_bf16 v[60:63], a[176:179], v[36:39], v[60:63]
  ds_read_b128 v[32:35], v7 offset:32768
  s_waitcnt lgkmcnt(4)
  v_mfma_f32_16x16x32_bf16 v[40:43], a[180:183], v[16:19], v[40:43]
  v_mfma_f32_16x16x32_bf16 v[48:51], a[184:187], v[16:19], v[48:51]
  v_mfma_f32_16x16x32_bf16 v[56:59], a[188:191], v[16:19], v[56:59]
  ds_read_b128 v[36:39], v7 offset:34816
  s_waitcnt lgkmcnt(4)
  v_mfma_f32_16x16x32_bf16 v[44:47], a[180:183], v[20:23], v[44:47]
  v_mfma_f32_16x16x32_bf16 v[52:55], a[184:187], v[20:23], v[52:55]
  v_mfma_f32_16x16x32_bf16 v[60:63], a[188:191], v[20:23], v[60:63]
  ds_read_b128 v[16:19], v6 offset:36864
  s_waitcnt lgkmcnt(4)
  v_mfma_f32_16x16x32_bf16 v[40:43], a[192:195], v[24:27], v[40:43]
  v_mfma_f32_16x16x32_bf16 v[48:51], a[196:199], v[24:27], v[48:51]
  v_mfma_f32_16x16x32_bf16 v[56:59], a[200:203], v[24:27], v[56:59]
  ds_read_b128 v[20:23], v6 offset:38912
  s_waitcnt lgkmcnt(4)
  v_mfma_f32_16x16x32_bf16 v[44:47], a[192:195], v[28:31], v[44:47]
  v_mfma_f32_16x16x32_bf16 v[52:55], a[196:199], v[28:31], v[52:55]
  v_mfma_f32_16x16x32_bf16 v[60:63], a[200:203], v[28:31], v[60:63]
  ds_read_b128 v[24:27], v7 offset:36864
  s_waitcnt lgkmcnt(4)
  v_mfma_f32_16x16x32_bf16 v[40:43], a[204:207], v[32:35], v[40:43]
  v_mfma_f32_16x16x32_bf16 v[48:51], a[208:211], v[32:35], v[48:51]
  v_mfma_f32_16x16x32_bf16 v[56:59], a[212:215], v[32:35], v[56:59]
  ds_read_b128 v[28:31], v7 offset:38912
  s_waitcnt lgkmcnt(4)
  v_mfma_f32_16x16x32_bf16 v[44:47], a[204:207], v[36:39], v[44:47]
  v_mfma_f32_16x16x32_bf16 v[52:55], a[208:211], v[36:39], v[52:55]
  v_mfma_f32_16x16x32_bf16 v[60:63], a[212:215], v[36:39], v[60:63]
  s_waitcnt lgkmcnt(3)
  v_mfma_f32_16x16x32_bf16 v[40:43], a[216:219], v[16:19], v[40:43]
  v_mfma_f32_16x16x32_bf16 v[48:51], a[220:223], v[16:19], v[48:51]
  v_mfma_f32_16x16x32_bf16 v[56:59], a[224:227], v[16:19], v[56:59]
  s_waitcnt lgkmcnt(2)
  v_mfma_f32_16x16x32_bf16 v[44:47], a[216:219], v[20:23], v[44:47]
  v_mfma_f32_16x16x32_bf16 v[52:55], a[220:223], v[20:23], v[52:55]
  v_mfma_f32_16x16x32_bf16 v[60:63], a[224:227], v[20:23], v[60:63]
  s_waitcnt lgkmcnt(1)
  v_mfma_f32_16x16x32_bf16 v[40:43], a[228:231], v[24:27], v[40:43]
  v_mfma_f32_16x16x32_bf16 v[48:51], a[232:235], v[24:27], v[48:51]
  v_mfma_f32_16x16x32_bf16 v[56:59], a[236:239], v[24:27], v[56:59]
  s_waitcnt lgkmcnt(0)
  v_mfma_f32_16x16x32_bf16 v[44:47], a[228:231], v[28:31], v[44:47]
  v_mfma_f32_16x16x32_bf16 v[52:55], a[232:235], v[28:31], v[52:55]
  v_mfma_f32_16x16x32_bf16 v[60:63], a[236:239], v[28:31], v[60:63]
  s_waitcnt vmcnt(0)
  s_barrier
  v_xor_b32 v6, 122880, v6
  v_xor_b32 v7, 122880, v7
  s_mul_i32 s55, s52, 12288
  s_add_u32 s55, s55, s63
  s_add_u32 s56, s55, 4096
  s_cmp_lg_u32 s42, 0
  s_cbranch_scc1 pa_noflag_23
  s_cmp_eq_u32 s52, s61
  s_cbranch_scc1 pa_noflag_23
  v_mov_b32 v10, s52
  s_mov_b64 exec, 1
  buffer_store_dword v10, v9, s[8:11], 0 offen sc1
  s_mov_b64 exec, -1
pa_noflag_23:
  v_cvt_pk_bf16_f32 v64, v40, v41
  v_cvt_pk_bf16_f32 v65, v42, v43
  v_cvt_pk_bf16_f32 v66, v44, v45
  v_cvt_pk_bf16_f32 v67, v46, v47
  v_cvt_pk_bf16_f32 v68, v48, v49
  v_cvt_pk_bf16_f32 v69, v50, v51
  v_cvt_pk_bf16_f32 v70, v52, v53
  v_cvt_pk_bf16_f32 v71, v54, v55
  v_cvt_pk_bf16_f32 v72, v56, v57
  v_cvt_pk_bf16_f32 v73, v58, v59
  v_cvt_pk_bf16_f32 v74, v60, v61
  v_cvt_pk_bf16_f32 v75, v62, v63
  v_permlane16_swap_b32 v64, v66
  v_permlane16_swap_b32 v65, v67
  buffer_store_dwordx4 v[64:67], v8, s[8:11], s55 offen offset:0 sc1
  v_permlane16_swap_b32 v68, v70
  v_permlane16_swap_b32 v69, v71
  buffer_store_dwordx4 v[68:71], v8, s[8:11], s55 offen offset:2048 sc1
  v_permlane16_swap_b32 v72, v74
  v_permlane16_swap_b32 v73, v75
  buffer_store_dwordx4 v[72:75], v8, s[8:11], s56 offen offset:0 sc1
  s_mov_b32 s52, s57
  s_cmp_lt_u32 s52, s62
  s_cbranch_scc1 pa_loop_21
  s_waitcnt vmcnt(0)
  s_barrier
  s_cmp_lg_u32 s42, 0
  s_cbranch_scc1 pa_fin_25
  v_mov_b32 v10, s52
  s_mov_b64 exec, 1
  buffer_store_dword v10, v9, s[8:11], 0 offen sc1
  s_mov_b64 exec, -1
pa_fin_25:
pa_att:
  v_min_u32 v1, 19, v0
  v_cmp_lt_u32 vcc, 9, v1
  s_lshl_b32 s46, s65, 4
  s_max_u32 s47, s46, 14
  s_sub_u32 s47, s47, 14
  s_lshr_b32 s47, s47, 5
  s_lshr_b32 s48, s46, 5
  v_mov_b32 v2, s47
  v_mov_b32 v3, s48
  v_cndmask_b32 v2, v2, v3, vcc
  v_subrev_u32 v3, 10, v1
  v_cndmask_b32 v1, v1, v3, vcc
  v_mul_u32_u24 v3, 171, v2
  v_lshrrev_b32 v3, 10, v3
  v_max_u32 v4, 28, v2
  v_subrev_u32 v4, 28, v4
  v_mul_u32_u24 v4, 171, v4
  v_lshrrev_b32 v4, 9, v4
  v_max_u32 v3, v3, v4
  v_mul_u32_u24 v3, 10, v3
  v_add_u32 v1, v1, v3
  v_lshlrev_b32 v1, 7, v1
  v_add_u32 v1, 2998272, v1
  v_lshrrev_b32 v3, 4, v0
  s_lshl_b32 s47, s42, 2
  v_add_u32 v3, s47, v3
  v_mul_u32_u24 v3, 5, v3
  s_mov_b32 s47, 780288
  v_add_u32 v8, 0, v3
  v_mul_u32_u24 v4, 171, v8
  v_lshrrev_b32 v4, 12, v4
  v_mul_lo_u32 v4, v4, s47
  v_lshl_add_u32 v8, v8, 8, v4
  v_add_u32 v9, 1, v3
  v_mul_u32_u24 v4, 171, v9
  v_lshrrev_b32 v4, 12, v4
  v_mul_lo_u32 v4, v4, s47
  v_lshl_add_u32 v9, v9, 8, v4
  v_add_u32 v10, 2, v3
  v_mul_u32_u24 v4, 171, v10
  v_lshrrev_b32 v4, 12, v4
  v_mul_lo_u32 v4, v4, s47
  v_lshl_add_u32 v10, v10, 8, v4
  v_add_u32 v11, 3, v3
  v_mul_u32_u24 v4, 171, v11
  v_lshrrev_b32 v4, 12, v4
  v_mul_lo_u32 v4, v4, s47
  v_lshl_add_u32 v11, v11, 8, v4
  v_add_u32 v12, 4, v3
  v_mul_u32_u24 v4, 171, v12
  v_lshrrev_b32 v4, 12, v4
  v_mul_lo_u32 v4, v4, s47
  v_lshl_add_u32 v12, v12, 8, v4
  v_add_u32 v13, 80, v3
  v_mul_u32_u24 v4, 171, v13
  v_lshrrev_b32 v4, 12, v4
  v_mul_lo_u32 v4, v4, s47
  v_lshl_add_u32 v13, v13, 8, v4
  v_add_u32 v14, 81, v3
  v_mul_u32_u24 v4, 171, v14
  v_lshrrev_b32 v4, 12, v4
  v_mul_lo_u32 v4, v4, s47
  v_lshl_add_u32 v14, v14, 8, v4
  v_add_u32 v15, 82, v3
  v_mul_u32_u24 v4, 171, v15
  v_lshrrev_b32 v4, 12, v4
  v_mul_lo_u32 v4, v4, s47
  v_lshl_add_u32 v15, v15, 8, v4
  v_add_u32 v16, 83, v3
  v_mul_u32_u24 v4, 171, v16
  v_lshrrev_b32 v4, 12, v4
  v_mul_lo_u32 v4, v4, s47
  v_lshl_add_u32 v16, v16, 8, v4
  v_add_u32 v17, 84, v3
  v_mul_u32_u24 v4, 171, v17
  v_lshrrev_b32 v4, 12, v4
  v_mul_lo_u32 v4, v4, s47
  v_lshl_add_u32 v17, v17, 8, v4
  v_add_u32 v18, 160, v3
  v_mul_u32_u24 v4, 171, v18
  v_lshrrev_b32 v4, 12, v4
  v_mul_lo_u32 v4, v4, s47
  v_lshl_add_u32 v18, v18, 8, v4
  v_add_u32 v19, 161, v3
  v_mul_u32_u24 v4, 171, v19
  v_lshrrev_b32 v4, 12, v4
  v_mul_lo_u32 v4, v4, s47
  v_lshl_add_u32 v19, v19, 8, v4
  v_add_u32 v20, 162, v3
  v_mul_u32_u24 v4, 171, v20
  v_lshrrev_b32 v4, 12, v4
  v_mul_lo_u32 v4, v4, s47
  v_lshl_add_u32 v20, v20, 8, v4
  v_add_u32 v21, 163, v3
  v_mul_u32_u24 v4, 171, v21
  v_lshrrev_b32 v4, 12, v4
  v_mul_lo_u32 v4, v4, s47
  v_lshl_add_u32 v21, v21, 8, v4
  v_add_u32 v22, 164, v3
  v_mul_u32_u24 v4, 171, v22
  v_lshrrev_b32 v4, 12, v4
  v_mul_lo_u32 v4, v4, s47
  v_lshl_add_u32 v22, v22, 8, v4
  v_and_b32 v5, 15, v0
  v_add_u32 v6, s46, v5
  v_subrev_u32 v4, 0, v6
  v_max_i32 v4, 0, v4
  v_and_b32 v23, 15, v4
  v_lshlrev_b32 v23, 4, v23
  v_lshrrev_b32 v4, 4, v4
  v_mul_u32_u24 v4, 6144, v4
  v_add_u32 v23, v23, v4
  v_cmp_gt_u32 s[72:73], 0, v6
  v_subrev_u32 v4, 2, v6
  v_max_i32 v4, 0, v4
  v_and_b32 v24, 15, v4
  v_lshlrev_b32 v24, 4, v24
  v_lshrrev_b32 v4, 4, v4
  v_mul_u32_u24 v4, 6144, v4
  v_add_u32 v24, v24, v4
  v_cmp_gt_u32 s[74:75], 2, v6
  v_subrev_u32 v4, 4, v6
  v_max_i32 v4, 0, v4
  v_and_b32 v25, 15, v4
  v_lshlrev_b32 v25, 4, v25
  v_lshrrev_b32 v4, 4, v4
  v_mul_u32_u24 v4, 6144, v4
  v_add_u32 v25, v25, v4
  v_cmp_gt_u32 s[76:77], 4, v6
  v_subrev_u32 v4, 6, v6
  v_max_i32 v4, 0, v4
  v_and_b32 v26, 15, v4
  v_lshlrev_b32 v26, 4, v26
  v_lshrrev_b32 v4, 4, v4
  v_mul_u32_u24 v4, 6144, v4
  v_add_u32 v26, v26, v4
  v_cmp_gt_u32 s[78:79], 6, v6
  v_subrev_u32 v4, 8, v6
  v_max_i32 v4, 0, v4
  v_and_b32 v27, 15, v4
  v_lshlrev_b32 v27, 4, v27
  v_lshrrev_b32 v4, 4, v4
  v_mul_u32_u24 v4, 6144, v4
  v_add_u32 v27, v27, v4
  v_cmp_gt_u32 s[80:81], 8, v6
  v_subrev_u32 v4, 10, v6
  v_max_i32 v4, 0, v4
  v_and_b32 v28, 15, v4
  v_lshlrev_b32 v28, 4, v28
  v_lshrrev_b32 v4, 4, v4
  v_mul_u32_u24 v4, 6144, v4
  v_add_u32 v28, v28, v4
  v_cmp_gt_u32 s[82:83], 10, v6
  v_subrev_u32 v4, 12, v6
  v_max_i32 v4, 0, v4
  v_and_b32 v29, 15, v4
  v_lshlrev_b32 v29, 4, v29
  v_lshrrev_b32 v4, 4, v4
  v_mul_u32_u24 v4, 6144, v4
  v_add_u32 v29, v29, v4
  v_cmp_gt_u32 s[84:85], 12, v6
  v_subrev_u32 v4, 14, v6
  v_max_i32 v4, 0, v4
  v_and_b32 v30, 15, v4
  v_lshlrev_b32 v30, 4, v30
  v_lshrrev_b32 v4, 4, v4
  v_mul_u32_u24 v4, 6144, v4
  v_add_u32 v30, v30, v4
  v_cmp_gt_u32 s[86:87], 14, v6
  s_mov_b32 s50, 0
  s_mov_b32 s66, 197132288
pa_wait:
  buffer_load_dword v4, v1, s[8:11], 0 offen sc1
  s_add_u32 s50, s50, 1
  s_cmp_gt_u32 s50, 131072
  s_cbranch_scc1 L_fail
  s_waitcnt vmcnt(0)
  v_cmp_le_u32 vcc, v4, v2
  s_cbranch_vccnz pa_wait
  v_add_u32 v232, v8, v23
  buffer_load_dwordx4 v[32:35], v232, s[8:11], s66 offen sc1
  v_add_u32 v233, v9, v23
  buffer_load_dwordx4 v[36:39], v233, s[8:11], s66 offen sc1
  v_add_u32 v234, v10, v23
  buffer_load_dwordx4 v[40:43], v234, s[8:11], s66 offen sc1
  v_add_u32 v235, v11, v23
  buffer_load_dwordx4 v[44:47], v235, s[8:11], s66 offen sc1
  v_add_u32 v236, v12, v23
  buffer_load_dwordx4 v[48:51], v236, s[8:11], s66 offen sc1
  v_add_u32 v232, v13, v23
  buffer_load_dwordx4 v[72:75], v232, s[8:11], s66 offen sc1
  v_add_u32 v233, v14, v23
  buffer_load_dwordx4 v[76:79], v233, s[8:11], s66 offen sc1
  v_add_u32 v234, v15, v23
  buffer_load_dwordx4 v[80:83], v234, s[8:11], s66 offen sc1
  v_add_u32 v235, v16, v23
  buffer_load_dwordx4 v[84:87], v235, s[8:11], s66 offen sc1
  v_add_u32 v236, v17, v23
  buffer_load_dwordx4 v[88:91], v236, s[8:11], s66 offen sc1
  v_add_u32 v232, v13, v24
  buffer_load_dwordx4 v[92:95], v232, s[8:11], s66 offen sc1
  v_add_u32 v233, v14, v24
  buffer_load_dwordx4 v[96:99], v233, s[8:11], s66 offen sc1
  v_add_u32 v234, v15, v24
  buffer_load_dwordx4 v[100:103], v234, s[8:11], s66 offen sc1
  v_add_u32 v235, v16, v24
  buffer_load_dwordx4 v[104:107], v235, s[8:11], s66 offen sc1
  v_add_u32 v236, v17, v24
  buffer_load_dwordx4 v[108:111], v236, s[8:11], s66 offen sc1
  v_add_u32 v232, v13, v25
  buffer_load_dwordx4 v[112:115], v232, s[8:11], s66 offen sc1
  v_add_u32 v233, v14, v25
  buffer_load_dwordx4 v[116:119], v233, s[8:11], s66 offen sc1
  v_add_u32 v234, v15, v25
  buffer_load_dwordx4 v[120:123], v234, s[8:11], s66 offen sc1
  v_add_u32 v235, v16, v25
  buffer_load_dwordx4 v[124:127], v235, s[8:11], s66 offen sc1
  v_add_u32 v236, v17, v25
  buffer_load_dwordx4 v[128:131], v236, s[8:11], s66 offen sc1
  v_add_u32 v232, v13, v26
  buffer_load_dwordx4 v[132:135], v232, s[8:11], s66 offen sc1
  v_add_u32 v233, v14, v26
  buffer_load_dwordx4 v[136:139], v233, s[8:11], s66 offen sc1
  v_add_u32 v234, v15, v26
  buffer_load_dwordx4 v[140:143], v234, s[8:11], s66 offen sc1
  v_add_u32 v235, v16, v26
  buffer_load_dwordx4 v[144:147], v235, s[8:11], s66 offen sc1
  v_add_u32 v236, v17, v26
  buffer_load_dwordx4 v[148:151], v236, s[8:11], s66 offen sc1
  v_add_u32 v232, v13, v27
  buffer_load_dwordx4 v[152:155], v232, s[8:11], s66 offen sc1
  v_add_u32 v233, v14, v27
  buffer_load_dwordx4 v[156:159], v233, s[8:11], s66 offen sc1
  v_add_u32 v234, v15, v27
  buffer_load_dwordx4 v[160:163], v234, s[8:11], s66 offen sc1
  v_add_u32 v235, v16, v27
  buffer_load_dwordx4 v[164:167], v235, s[8:11], s66 offen sc1
  v_add_u32 v236, v17, v27
  buffer_load_dwordx4 v[168:171], v236, s[8:11], s66 offen sc1
  v_add_u32 v232, v13, v28
  buffer_load_dwordx4 v[172:175], v232, s[8:11], s66 offen sc1
  v_add_u32 v233, v14, v28
  buffer_load_dwordx4 v[176:179], v233, s[8:11], s66 offen sc1
  v_add_u32 v234, v15, v28
  buffer_load_dwordx4 v[180:183], v234, s[8:11], s66 offen sc1
  v_add_u32 v235, v16, v28
  buffer_load_dwordx4 v[184:187], v235, s[8:11], s66 offen sc1
  v_add_u32 v236, v17, v28
  buffer_load_dwordx4 v[188:191], v236, s[8:11], s66 offen sc1
  v_add_u32 v232, v13, v29
  buffer_load_dwordx4 v[192:195], v232, s[8:11], s66 offen sc1
  v_add_u32 v233, v14, v29
  buffer_load_dwordx4 v[196:199], v233, s[8:11], s66 offen sc1
  v_add_u32 v234, v15, v29
  buffer_load_dwordx4 v[200:203], v234, s[8:11], s66 offen sc1
  v_add_u32 v235, v16, v29
  buffer_load_dwordx4 v[204:207], v235, s[8:11], s66 offen sc1
  v_add_u32 v236, v17, v29
  buffer_load_dwordx4 v[208:211], v236, s[8:11], s66 offen sc1
  v_add_u32 v232, v13, v30
  buffer_load_dwordx4 v[212:215], v232, s[8:11], s66 offen sc1
  v_add_u32 v233, v14, v30
  buffer_load_dwordx4 v[216:219], v233, s[8:11], s66 offen sc1
  v_add_u32 v234, v15, v30
  buffer_load_dwordx4 v[220:223], v234, s[8:11], s66 offen sc1
  v_add_u32 v235, v16, v30
  buffer_load_dwordx4 v[224:227], v235, s[8:11], s66 offen sc1
  v_add_u32 v236, v17, v30
  buffer_load_dwordx4 v[228:231], v236, s[8:11], s66 offen sc1
  s_waitcnt vmcnt(35)
  v_dot2_f32_bf16 v52, v32, v72, 0
  v_dot2_f32_bf16 v60, v42, v82, 0
  v_dot2_f32_bf16 v52, v33, v73, v52
  v_dot2_f32_bf16 v60, v43, v83, v60
  v_dot2_f32_bf16 v52, v34, v74, v52
  v_dot2_f32_bf16 v60, v44, v84, v60
  v_dot2_f32_bf16 v52, v35, v75, v52
  v_dot2_f32_bf16 v60, v45, v85, v60
  v_dot2_f32_bf16 v52, v36, v76, v52
  v_dot2_f32_bf16 v60, v46, v86, v60
  v_dot2_f32_bf16 v52, v37, v77, v52
  v_dot2_f32_bf16 v60, v47, v87, v60
  v_dot2_f32_bf16 v52, v38, v78, v52
  v_dot2_f32_bf16 v60, v48, v88, v60
  v_dot2_f32_bf16 v52, v39, v79, v52
  v_dot2_f32_bf16 v60, v49, v89, v60
  v_dot2_f32_bf16 v52, v40, v80, v52
  v_dot2_f32_bf16 v60, v50, v90, v60
  v_dot2_f32_bf16 v52, v41, v81, v52
  v_dot2_f32_bf16 v60, v51, v91, v60
  v_add_u32 v232, v18, v23
  buffer_load_dwordx4 v[72:75], v232, s[8:11], s66 offen sc1
  v_add_u32 v233, v19, v23
  buffer_load_dwordx4 v[76:79], v233, s[8:11], s66 offen sc1
  v_add_u32 v234, v20, v23
  buffer_load_dwordx4 v[80:83], v234, s[8:11], s66 offen sc1
  v_add_u32 v235, v21, v23
  buffer_load_dwordx4 v[84:87], v235, s[8:11], s66 offen sc1
  v_add_u32 v236, v22, v23
  buffer_load_dwordx4 v[88:91], v236, s[8:11], s66 offen sc1
  s_waitcnt vmcnt(35)
  v_dot2_f32_bf16 v53, v32, v92, 0
  v_dot2_f32_bf16 v61, v42, v102, 0
  v_dot2_f32_bf16 v53, v33, v93, v53
  v_dot2_f32_bf16 v61, v43, v103, v61
  v_dot2_f32_bf16 v53, v34, v94, v53
  v_dot2_f32_bf16 v61, v44, v104, v61
  v_dot2_f32_bf16 v53, v35, v95, v53
  v_dot2_f32_bf16 v61, v45, v105, v61
  v_dot2_f32_bf16 v53, v36, v96, v53
  v_dot2_f32_bf16 v61, v46, v106, v61
  v_dot2_f32_bf16 v53, v37, v97, v53
  v_dot2_f32_bf16 v61, v47, v107, v61
  v_dot2_f32_bf16 v53, v38, v98, v53
  v_dot2_f32_bf16 v61, v48, v108, v61
  v_dot2_f32_bf16 v53, v39, v99, v53
  v_dot2_f32_bf16 v61, v49, v109, v61
  v_dot2_f32_bf16 v53, v40, v100, v53
  v_dot2_f32_bf16 v61, v50, v110, v61
  v_dot2_f32_bf16 v53, v41, v101, v53
  v_dot2_f32_bf16 v61, v51, v111, v61
  v_add_u32 v232, v18, v24
  buffer_load_dwordx4 v[92:95], v232, s[8:11], s66 offen sc1
  v_add_u32 v233, v19, v24
  buffer_load_dwordx4 v[96:99], v233, s[8:11], s66 offen sc1
  v_add_u32 v234, v20, v24
  buffer_load_dwordx4 v[100:103], v234, s[8:11], s66 offen sc1
  v_add_u32 v235, v21, v24
  buffer_load_dwordx4 v[104:107], v235, s[8:11], s66 offen sc1
  v_add_u32 v236, v22, v24
  buffer_load_dwordx4 v[108:111], v236, s[8:11], s66 offen sc1
  s_waitcnt vmcnt(35)
  v_dot2_f32_bf16 v54, v32, v112, 0
  v_dot2_f32_bf16 v62, v42, v122, 0
  v_dot2_f32_bf16 v54, v33, v113, v54
  v_dot2_f32_bf16 v62, v43, v123, v62
  v_dot2_f32_bf16 v54, v34, v114, v54
  v_dot2_f32_bf16 v62, v44, v124, v62
  v_dot2_f32_bf16 v54, v35, v115, v54
  v_dot2_f32_bf16 v62, v45, v125, v62
  v_dot2_f32_bf16 v54, v36, v116, v54
  v_dot2_f32_bf16 v62, v46, v126, v62
  v_dot2_f32_bf16 v54, v37, v117, v54
  v_dot2_f32_bf16 v62, v47, v127, v62
  v_dot2_f32_bf16 v54, v38, v118, v54
  v_dot2_f32_bf16 v62, v48, v128, v62
  v_dot2_f32_bf16 v54, v39, v119, v54
  v_dot2_f32_bf16 v62, v49, v129, v62
  v_dot2_f32_bf16 v54, v40, v120, v54
  v_dot2_f32_bf16 v62, v50, v130, v62
  v_dot2_f32_bf16 v54, v41, v121, v54
  v_dot2_f32_bf16 v62, v51, v131, v62
  v_add_u32 v232, v18, v25
  buffer_load_dwordx4 v[112:115], v232, s[8:11], s66 offen sc1
  v_add_u32 v233, v19, v25
  buffer_load_dwordx4 v[116:119], v233, s[8:11], s66 offen sc1
  v_add_u32 v234, v20, v25
  buffer_load_dwordx4 v[120:123], v234, s[8:11], s66 offen sc1
  v_add_u32 v235, v21, v25
  buffer_load_dwordx4 v[124:127], v235, s[8:11], s66 offen sc1
  v_add_u32 v236, v22, v25
  buffer_load_dwordx4 v[128:131], v236, s[8:11], s66 offen sc1
  s_waitcnt vmcnt(35)
  v_dot2_f32_bf16 v55, v32, v132, 0
  v_dot2_f32_bf16 v63, v42, v142, 0
  v_dot2_f32_bf16 v55, v33, v133, v55
  v_dot2_f32_bf16 v63, v43, v143, v63
  v_dot2_f32_bf16 v55, v34, v134, v55
  v_dot2_f32_bf16 v63, v44, v144, v63
  v_dot2_f32_bf16 v55, v35, v135, v55
  v_dot2_f32_bf16 v63, v45, v145, v63
  v_dot2_f32_bf16 v55, v36, v136, v55
  v_dot2_f32_bf16 v63, v46, v146, v63
  v_dot2_f32_bf16 v55, v37, v137, v55
  v_dot2_f32_bf16 v63, v47, v147, v63
  v_dot2_f32_bf16 v55, v38, v138, v55
  v_dot2_f32_bf16 v63, v48, v148, v63
  v_dot2_f32_bf16 v55, v39, v139, v55
  v_dot2_f32_bf16 v63, v49, v149, v63
  v_dot2_f32_bf16 v55, v40, v140, v55
  v_dot2_f32_bf16 v63, v50, v150, v63
  v_dot2_f32_bf16 v55, v41, v141, v55
  v_dot2_f32_bf16 v63, v51, v151, v63
  v_add_u32 v232, v18, v26
  buffer_load_dwordx4 v[132:135], v232, s[8:11], s66 offen sc1
  v_add_u32 v233, v19, v26
  buffer_load_dwordx4 v[136:139], v233, s[8:11], s66 offen sc1
  v_add_u32 v234, v20, v26
  buffer_load_dwordx4 v[140:143], v234, s[8:11], s66 offen sc1
  v_add_u32 v235, v21, v26
  buffer_load_dwordx4 v[144:147], v235, s[8:11], s66 offen sc1
  v_add_u32 v236, v22, v26
  buffer_load_dwordx4 v[148:151], v236, s[8:11], s66 offen sc1
  s_waitcnt vmcnt(35)
  v_dot2_f32_bf16 v56, v32, v152, 0
  v_dot2_f32_bf16 v64, v42, v162, 0
  v_dot2_f32_bf16 v56, v33, v153, v56
  v_dot2_f32_bf16 v64, v43, v163, v64
  v_dot2_f32_bf16 v56, v34, v154, v56
  v_dot2_f32_bf16 v64, v44, v164, v64
  v_dot2_f32_bf16 v56, v35, v155, v56
  v_dot2_f32_bf16 v64, v45, v165, v64
  v_dot2_f32_bf16 v56, v36, v156, v56
  v_dot2_f32_bf16 v64, v46, v166, v64
  v_dot2_f32_bf16 v56, v37, v157, v56
  v_dot2_f32_bf16 v64, v47, v167, v64
  v_dot2_f32_bf16 v56, v38, v158, v56
  v_dot2_f32_bf16 v64, v48, v168, v64
  v_dot2_f32_bf16 v56, v39, v159, v56
  v_dot2_f32_bf16 v64, v49, v169, v64
  v_dot2_f32_bf16 v56, v40, v160, v56
  v_dot2_f32_bf16 v64, v50, v170, v64
  v_dot2_f32_bf16 v56, v41, v161, v56
  v_dot2_f32_bf16 v64, v51, v171, v64
  v_add_u32 v232, v18, v27
  buffer_load_dwordx4 v[152:155], v232, s[8:11], s66 offen sc1
  v_add_u32 v233, v19, v27
  buffer_load_dwordx4 v[156:159], v233, s[8:11], s66 offen sc1
  v_add_u32 v234, v20, v27
  buffer_load_dwordx4 v[160:163], v234, s[8:11], s66 offen sc1
  v_add_u32 v235, v21, v27
  buffer_load_dwordx4 v[164:167], v235, s[8:11], s66 offen sc1
  v_add_u32 v236, v22, v27
  buffer_load_dwordx4 v[168:171], v236, s[8:11], s66 offen sc1
  s_waitcnt vmcnt(35)
  v_dot2_f32_bf16 v57, v32, v172, 0
  v_dot2_f32_bf16 v65, v42, v182, 0
  v_dot2_f32_bf16 v57, v33, v173, v57
  v_dot2_f32_bf16 v65, v43, v183, v65
  v_dot2_f32_bf16 v57, v34, v174, v57
  v_dot2_f32_bf16 v65, v44, v184, v65
  v_dot2_f32_bf16 v57, v35, v175, v57
  v_dot2_f32_bf16 v65, v45, v185, v65
  v_dot2_f32_bf16 v57, v36, v176, v57
  v_dot2_f32_bf16 v65, v46, v186, v65
  v_dot2_f32_bf16 v57, v37, v177, v57
  v_dot2_f32_bf16 v65, v47, v187, v65
  v_dot2_f32_bf16 v57, v38, v178, v57
  v_dot2_f32_bf16 v65, v48, v188, v65
  v_dot2_f32_bf16 v57, v39, v179, v57
  v_dot2_f32_bf16 v65, v49, v189, v65
  v_dot2_f32_bf16 v57, v40, v180, v57
  v_dot2_f32_bf16 v65, v50, v190, v65
  v_dot2_f32_bf16 v57, v41, v181, v57
  v_dot2_f32_bf16 v65, v51, v191, v65
  v_add_u32 v232, v18, v28
  buffer_load_dwordx4 v[172:175], v232, s[8:11], s66 offen sc1
  v_add_u32 v233, v19, v28
  buffer_load_dwordx4 v[176:179], v233, s[8:11], s66 offen sc1
  v_add_u32 v234, v20, v28
  buffer_load_dwordx4 v[180:183], v234, s[8:11], s66 offen sc1
  v_add_u32 v235, v21, v28
  buffer_load_dwordx4 v[184:187], v235, s[8:11], s66 offen sc1
  v_add_u32 v236, v22, v28
  buffer_load_dwordx4 v[188:191], v236, s[8:11], s66 offen sc1
  s_waitcnt vmcnt(35)
  v_dot2_f32_bf16 v58, v32, v192, 0
  v_dot2_f32_bf16 v66, v42, v202, 0
  v_dot2_f32_bf16 v58, v33, v193, v58
  v_dot2_f32_bf16 v66, v43, v203, v66
  v_dot2_f32_bf16 v58, v34, v194, v58
  v_dot2_f32_bf16 v66, v44, v204, v66
  v_dot2_f32_bf16 v58, v35, v195, v58
  v_dot2_f32_bf16 v66, v45, v205, v66
  v_dot2_f32_bf16 v58, v36, v196, v58
  v_dot2_f32_bf16 v66, v46, v206, v66
  v_dot2_f32_bf16 v58, v37, v197, v58
  v_dot2_f32_bf16 v66, v47, v207, v66
  v_dot2_f32_bf16 v58, v38, v198, v58
  v_dot2_f32_bf16 v66, v48, v208, v66
  v_dot2_f32_bf16 v58, v39, v199, v58
  v_dot2_f32_bf16 v66, v49, v209, v66
  v_dot2_f32_bf16 v58, v40, v200, v58
  v_dot2_f32_bf16 v66, v50, v210, v66
  v_dot2_f32_bf16 v58, v41, v201, v58
  v_dot2_f32_bf16 v66, v51, v211, v66
  v_add_u32 v232, v18, v29
  buffer_load_dwordx4 v[192:195], v232, s[8:11], s66 offen sc1
  v_add_u32 v233, v19, v29
  buffer_load_dwordx4 v[196:199], v233, s[8:11], s66 offen sc1
  v_add_u32 v234, v20, v29
  buffer_load_dwordx4 v[200:203], v234, s[8:11], s66 offen sc1
  v_add_u32 v235, v21, v29
  buffer_load_dwordx4 v[204:207], v235, s[8:11], s66 offen sc1
  v_add_u32 v236, v22, v29
  buffer_load_dwordx4 v[208:211], v236, s[8:11], s66 offen sc1
  s_waitcnt vmcnt(35)
  v_dot2_f32_bf16 v59, v32, v212, 0
  v_dot2_f32_bf16 v67, v42, v222, 0
  v_dot2_f32_bf16 v59, v33, v213, v59
  v_dot2_f32_bf16 v67, v43, v223, v67
  v_dot2_f32_bf16 v59, v34, v214, v59
  v_dot2_f32_bf16 v67, v44, v224, v67
  v_dot2_f32_bf16 v59, v35, v215, v59
  v_dot2_f32_bf16 v67, v45, v225, v67
  v_dot2_f32_bf16 v59, v36, v216, v59
  v_dot2_f32_bf16 v67, v46, v226, v67
  v_dot2_f32_bf16 v59, v37, v217, v59
  v_dot2_f32_bf16 v67, v47, v227, v67
  v_dot2_f32_bf16 v59, v38, v218, v59
  v_dot2_f32_bf16 v67, v48, v228, v67
  v_dot2_f32_bf16 v59, v39, v219, v59
  v_dot2_f32_bf16 v67, v49, v229, v67
  v_dot2_f32_bf16 v59, v40, v220, v59
  v_dot2_f32_bf16 v67, v50, v230, v67
  v_dot2_f32_bf16 v59, v41, v221, v59
  v_dot2_f32_bf16 v67, v51, v231, v67
  v_add_u32 v232, v18, v30
  buffer_load_dwordx4 v[212:215], v232, s[8:11], s66 offen sc1
  v_add_u32 v233, v19, v30
  buffer_load_dwordx4 v[216:219], v233, s[8:11], s66 offen sc1
  v_add_u32 v234, v20, v30
  buffer_load_dwordx4 v[220:223], v234, s[8:11], s66 offen sc1
  v_add_u32 v235, v21, v30
  buffer_load_dwordx4 v[224:227], v235, s[8:11], s66 offen sc1
  v_add_u32 v236, v22, v30
  buffer_load_dwordx4 v[228:231], v236, s[8:11], s66 offen sc1
  s_mov_b32 s46, 1051011932
  v_mov_b32 v232, 3481618353
  v_cndmask_b32 v53, v53, v232, s[74:75]
  v_cndmask_b32 v54, v54, v232, s[76:77]
  v_cndmask_b32 v55, v55, v232, s[78:79]
  v_cndmask_b32 v56, v56, v232, s[80:81]
  v_cndmask_b32 v57, v57, v232, s[82:83]
  v_cndmask_b32 v58, v58, v232, s[84:85]
  v_cndmask_b32 v59, v59, v232, s[86:87]
  v_max_f32 v233, v52, v53
  v_max3_f32 v233, v233, v54, v55
  v_max3_f32 v233, v233, v56, v57
  v_max3_f32 v233, v233, v58, v59
  v_mul_f32 v233, s46, v233
  v_fma_f32 v52, v52, s46, -v233
  v_fma_f32 v53, v53, s46, -v233
  v_fma_f32 v54, v54, s46, -v233
  v_fma_f32 v55, v55, s46, -v233
  v_fma_f32 v56, v56, s46, -v233
  v_fma_f32 v57, v57, s46, -v233
  v_fma_f32 v58, v58, s46, -v233
  v_fma_f32 v59, v59, s46, -v233
  v_exp_f32 v52, v52
  v_exp_f32 v53, v53
  v_exp_f32 v54, v54
  v_exp_f32 v55, v55
  v_exp_f32 v56, v56
  v_exp_f32 v57, v57
  v_exp_f32 v58, v58
  v_exp_f32 v59, v59
  v_add_f32 v233, v52, v53
  v_add_f32 v233, v233, v54
  v_add_f32 v233, v233, v55
  v_add_f32 v233, v233, v56
  v_add_f32 v233, v233, v57
  v_add_f32 v233, v233, v58
  v_add_f32 v233, v233, v59
  v_rcp_f32 v233, v233
  s_nop 0
  v_mul_f32 v52, v52, v233
  v_mul_f32 v53, v53, v233
  v_mul_f32 v54, v54, v233
  v_mul_f32 v55, v55, v233
  v_mul_f32 v56, v56, v233
  v_mul_f32 v57, v57, v233
  v_mul_f32 v58, v58, v233
  v_mul_f32 v59, v59, v233
  v_cndmask_b32 v61, v61, v232, s[74:75]
  v_cndmask_b32 v62, v62, v232, s[76:77]
  v_cndmask_b32 v63, v63, v232, s[78:79]
  v_cndmask_b32 v64, v64, v232, s[80:81]
  v_cndmask_b32 v65, v65, v232, s[82:83]
  v_cndmask_b32 v66, v66, v232, s[84:85]
  v_cndmask_b32 v67, v67, v232, s[86:87]
  v_max_f32 v233, v60, v61
  v_max3_f32 v233, v233, v62, v63
  v_max3_f32 v233, v233, v64, v65
  v_max3_f32 v233, v233, v66, v67
  v_mul_f32 v233, s46, v233
  v_fma_f32 v60, v60, s46, -v233
  v_fma_f32 v61, v61, s46, -v233
  v_fma_f32 v62, v62, s46, -v233
  v_fma_f32 v63, v63, s46, -v233
  v_fma_f32 v64, v64, s46, -v233
  v_fma_f32 v65, v65, s46, -v233
  v_fma_f32 v66, v66, s46, -v233
  v_fma_f32 v67, v67, s46, -v233
  v_exp_f32 v60, v60
  v_exp_f32 v61, v61
  v_exp_f32 v62, v62
  v_exp_f32 v63, v63
  v_exp_f32 v64, v64
  v_exp_f32 v65, v65
  v_exp_f32 v66, v66
  v_exp_f32 v67, v67
  v_add_f32 v233, v60, v61
  v_add_f32 v233, v233, v62
  v_add_f32 v233, v233, v63
  v_add_f32 v233, v233, v64
  v_add_f32 v233, v233, v65
  v_add_f32 v233, v233, v66
  v_add_f32 v233, v233, v67
  v_rcp_f32 v233, v233
  s_nop 0
  v_mul_f32 v60, v60, v233
  v_mul_f32 v61, v61, v233
  v_mul_f32 v62, v62, v233
  v_mul_f32 v63, v63, v233
  v_mul_f32 v64, v64, v233
  v_mul_f32 v65, v65, v233
  v_mul_f32 v66, v66, v233
  v_mul_f32 v67, v67, v233
  v_cvt_pk_bf16_f32 v52, v52, 0
  v_lshlrev_b32 v236, 16, v52
  v_cvt_pk_bf16_f32 v53, v53, 0
  v_lshlrev_b32 v237, 16, v53
  v_cvt_pk_bf16_f32 v54, v54, 0
  v_lshlrev_b32 v238, 16, v54
  v_cvt_pk_bf16_f32 v55, v55, 0
  v_lshlrev_b32 v239, 16, v55
  v_cvt_pk_bf16_f32 v56, v56, 0
  v_lshlrev_b32 v240, 16, v56
  v_cvt_pk_bf16_f32 v57, v57, 0
  v_lshlrev_b32 v241, 16, v57
  v_cvt_pk_bf16_f32 v58, v58, 0
  v_lshlrev_b32 v242, 16, v58
  v_cvt_pk_bf16_f32 v59, v59, 0
  v_lshlrev_b32 v243, 16, v59
  v_cvt_pk_bf16_f32 v60, v60, 0
  v_lshlrev_b32 v244, 16, v60
  v_cvt_pk_bf16_f32 v61, v61, 0
  v_lshlrev_b32 v245, 16, v61
  v_cvt_pk_bf16_f32 v62, v62, 0
  v_lshlrev_b32 v246, 16, v62
  v_cvt_pk_bf16_f32 v63, v63, 0
  v_lshlrev_b32 v247, 16, v63
  v_cvt_pk_bf16_f32 v64, v64, 0
  v_lshlrev_b32 v248, 16, v64
  v_cvt_pk_bf16_f32 v65, v65, 0
  v_lshlrev_b32 v249, 16, v65
  v_cvt_pk_bf16_f32 v66, v66, 0
  v_lshlrev_b32 v250, 16, v66
  v_cvt_pk_bf16_f32 v67, v67, 0
  v_lshlrev_b32 v251, 16, v67
  s_waitcnt vmcnt(35)
  v_dot2_f32_bf16 v8, v72, v52, 0
  v_dot2_f32_bf16 v9, v72, v236, 0
  v_dot2_f32_bf16 v10, v73, v52, 0
  v_dot2_f32_bf16 v11, v73, v236, 0
  v_dot2_f32_bf16 v12, v74, v52, 0
  v_dot2_f32_bf16 v13, v74, v236, 0
  v_dot2_f32_bf16 v14, v75, v52, 0
  v_dot2_f32_bf16 v15, v75, v236, 0
  v_dot2_f32_bf16 v16, v76, v52, 0
  v_dot2_f32_bf16 v17, v76, v236, 0
  v_dot2_f32_bf16 v18, v77, v52, 0
  v_dot2_f32_bf16 v19, v77, v236, 0
  v_dot2_f32_bf16 v20, v78, v52, 0
  v_dot2_f32_bf16 v21, v78, v236, 0
  v_dot2_f32_bf16 v22, v79, v52, 0
  v_dot2_f32_bf16 v23, v79, v236, 0
  v_dot2_f32_bf16 v24, v80, v52, 0
  v_dot2_f32_bf16 v25, v80, v236, 0
  v_dot2_f32_bf16 v26, v81, v52, 0
  v_dot2_f32_bf16 v27, v81, v236, 0
  v_dot2_f32_bf16 v28, v82, v60, 0
  v_dot2_f32_bf16 v29, v82, v244, 0
  v_dot2_f32_bf16 v30, v83, v60, 0
  v_dot2_f32_bf16 v31, v83, v244, 0
  v_dot2_f32_bf16 v32, v84, v60, 0
  v_dot2_f32_bf16 v33, v84, v244, 0
  v_dot2_f32_bf16 v34, v85, v60, 0
  v_dot2_f32_bf16 v35, v85, v244, 0
  v_dot2_f32_bf16 v36, v86, v60, 0
  v_dot2_f32_bf16 v37, v86, v244, 0
  v_dot2_f32_bf16 v38, v87, v60, 0
  v_dot2_f32_bf16 v39, v87, v244, 0
  v_dot2_f32_bf16 v40, v88, v60, 0
  v_dot2_f32_bf16 v41, v88, v244, 0
  v_dot2_f32_bf16 v42, v89, v60, 0
  v_dot2_f32_bf16 v43, v89, v244, 0
  v_dot2_f32_bf16 v44, v90, v60, 0
  v_dot2_f32_bf16 v45, v90, v244, 0
  v_dot2_f32_bf16 v46, v91, v60, 0
  v_dot2_f32_bf16 v47, v91, v244, 0
  s_waitcnt vmcnt(30)
  v_dot2_f32_bf16 v8, v92, v53, v8
  v_dot2_f32_bf16 v9, v92, v237, v9
  v_dot2_f32_bf16 v10, v93, v53, v10
  v_dot2_f32_bf16 v11, v93, v237, v11
  v_dot2_f32_bf16 v12, v94, v53, v12
  v_dot2_f32_bf16 v13, v94, v237, v13
  v_dot2_f32_bf16 v14, v95, v53, v14
  v_dot2_f32_bf16 v15, v95, v237, v15
  v_dot2_f32_bf16 v16, v96, v53, v16
  v_dot2_f32_bf16 v17, v96, v237, v17
  v_dot2_f32_bf16 v18, v97, v53, v18
  v_dot2_f32_bf16 v19, v97, v237, v19
  v_dot2_f32_bf16 v20, v98, v53, v20
  v_dot2_f32_bf16 v21, v98, v237, v21
  v_dot2_f32_bf16 v22, v99, v53, v22
  v_dot2_f32_bf16 v23, v99, v237, v23
  v_dot2_f32_bf16 v24, v100, v53, v24
  v_dot2_f32_bf16 v25, v100, v237, v25
  v_dot2_f32_bf16 v26, v101, v53, v26
  v_dot2_f32_bf16 v27, v101, v237, v27
  v_dot2_f32_bf16 v28, v102, v61, v28
  v_dot2_f32_bf16 v29, v102, v245, v29
  v_dot2_f32_bf16 v30, v103, v61, v30
  v_dot2_f32_bf16 v31, v103, v245, v31
  v_dot2_f32_bf16 v32, v104, v61, v32
  v_dot2_f32_bf16 v33, v104, v245, v33
  v_dot2_f32_bf16 v34, v105, v61, v34
  v_dot2_f32_bf16 v35, v105, v245, v35
  v_dot2_f32_bf16 v36, v106, v61, v36
  v_dot2_f32_bf16 v37, v106, v245, v37
  v_dot2_f32_bf16 v38, v107, v61, v38
  v_dot2_f32_bf16 v39, v107, v245, v39
  v_dot2_f32_bf16 v40, v108, v61, v40
  v_dot2_f32_bf16 v41, v108, v245, v41
  v_dot2_f32_bf16 v42, v109, v61, v42
  v_dot2_f32_bf16 v43, v109, v245, v43
  v_dot2_f32_bf16 v44, v110, v61, v44
  v_dot2_f32_bf16 v45, v110, v245, v45
  v_dot2_f32_bf16 v46, v111, v61, v46
  v_dot2_f32_bf16 v47, v111, v245, v47
  s_waitcnt vmcnt(25)
  v_dot2_f32_bf16 v8, v112, v54, v8
  v_dot2_f32_bf16 v9, v112, v238, v9
  v_dot2_f32_bf16 v10, v113, v54, v10
  v_dot2_f32_bf16 v11, v113, v238, v11
  v_dot2_f32_bf16 v12, v114, v54, v12
  v_dot2_f32_bf16 v13, v114, v238, v13
  v_dot2_f32_bf16 v14, v115, v54, v14
  v_dot2_f32_bf16 v15, v115, v238, v15
  v_dot2_f32_bf16 v16, v116, v54, v16
  v_dot2_f32_bf16 v17, v116, v238, v17
  v_dot2_f32_bf16 v18, v117, v54, v18
  v_dot2_f32_bf16 v19, v117, v238, v19
  v_dot2_f32_bf16 v20, v118, v54, v20
  v_dot2_f32_bf16 v21, v118, v238, v21
  v_dot2_f32_bf16 v22, v119, v54, v22
  v_dot2_f32_bf16 v23, v119, v238, v23
  v_dot2_f32_bf16 v24, v120, v54, v24
  v_dot2_f32_bf16 v25, v120, v238, v25
  v_dot2_f32_bf16 v26, v121, v54, v26
  v_dot2_f32_bf16 v27, v121, v238, v27
  v_dot2_f32_bf16 v28, v122, v62, v28
  v_dot2_f32_bf16 v29, v122, v246, v29
  v_dot2_f32_bf16 v30, v123, v62, v30
  v_dot2_f32_bf16 v31, v123, v246, v31
  v_dot2_f32_bf16 v32, v124, v62, v32
  v_dot2_f32_bf16 v33, v124, v246, v33
  v_dot2_f32_bf16 v34, v125, v62, v34
  v_dot2_f32_bf16 v35, v125, v246, v35
  v_dot2_f32_bf16 v36, v126, v62, v36
  v_dot2_f32_bf16 v37, v126, v246, v37
  v_dot2_f32_bf16 v38, v127, v62, v38
  v_dot2_f32_bf16 v39, v127, v246, v39
  v_dot2_f32_bf16 v40, v128, v62, v40
  v_dot2_f32_bf16 v41, v128, v246, v41
  v_dot2_f32_bf16 v42, v129, v62, v42
  v_dot2_f32_bf16 v43, v129, v246, v43
  v_dot2_f32_bf16 v44, v130, v62, v44
  v_dot2_f32_bf16 v45, v130, v246, v45
  v_dot2_f32_bf16 v46, v131, v62, v46
  v_dot2_f32_bf16 v47, v131, v246, v47
  s_waitcnt vmcnt(20)
  v_dot2_f32_bf16 v8, v132, v55, v8
  v_dot2_f32_bf16 v9, v132, v239, v9
  v_dot2_f32_bf16 v10, v133, v55, v10
  v_dot2_f32_bf16 v11, v133, v239, v11
  v_dot2_f32_bf16 v12, v134, v55, v12
  v_dot2_f32_bf16 v13, v134, v239, v13
  v_dot2_f32_bf16 v14, v135, v55, v14
  v_dot2_f32_bf16 v15, v135, v239, v15
  v_dot2_f32_bf16 v16, v136, v55, v16
  v_dot2_f32_bf16 v17, v136, v239, v17
  v_dot2_f32_bf16 v18, v137, v55, v18
  v_dot2_f32_bf16 v19, v137, v239, v19
  v_dot2_f32_bf16 v20, v138, v55, v20
  v_dot2_f32_bf16 v21, v138, v239, v21
  v_dot2_f32_bf16 v22, v139, v55, v22
  v_dot2_f32_bf16 v23, v139, v239, v23
  v_dot2_f32_bf16 v24, v140, v55, v24
  v_dot2_f32_bf16 v25, v140, v239, v25
  v_dot2_f32_bf16 v26, v141, v55, v26
  v_dot2_f32_bf16 v27, v141, v239, v27
  v_dot2_f32_bf16 v28, v142, v63, v28
  v_dot2_f32_bf16 v29, v142, v247, v29
  v_dot2_f32_bf16 v30, v143, v63, v30
  v_dot2_f32_bf16 v31, v143, v247, v31
  v_dot2_f32_bf16 v32, v144, v63, v32
  v_dot2_f32_bf16 v33, v144, v247, v33
  v_dot2_f32_bf16 v34, v145, v63, v34
  v_dot2_f32_bf16 v35, v145, v247, v35
  v_dot2_f32_bf16 v36, v146, v63, v36
  v_dot2_f32_bf16 v37, v146, v247, v37
  v_dot2_f32_bf16 v38, v147, v63, v38
  v_dot2_f32_bf16 v39, v147, v247, v39
  v_dot2_f32_bf16 v40, v148, v63, v40
  v_dot2_f32_bf16 v41, v148, v247, v41
  v_dot2_f32_bf16 v42, v149, v63, v42
  v_dot2_f32_bf16 v43, v149, v247, v43
  v_dot2_f32_bf16 v44, v150, v63, v44
  v_dot2_f32_bf16 v45, v150, v247, v45
  v_dot2_f32_bf16 v46, v151, v63, v46
  v_dot2_f32_bf16 v47, v151, v247, v47
  s_waitcnt vmcnt(15)
  v_dot2_f32_bf16 v8, v152, v56, v8
  v_dot2_f32_bf16 v9, v152, v240, v9
  v_dot2_f32_bf16 v10, v153, v56, v10
  v_dot2_f32_bf16 v11, v153, v240, v11
  v_dot2_f32_bf16 v12, v154, v56, v12
  v_dot2_f32_bf16 v13, v154, v240, v13
  v_dot2_f32_bf16 v14, v155, v56, v14
  v_dot2_f32_bf16 v15, v155, v240, v15
  v_dot2_f32_bf16 v16, v156, v56, v16
  v_dot2_f32_bf16 v17, v156, v240, v17
  v_dot2_f32_bf16 v18, v157, v56, v18
  v_dot2_f32_bf16 v19, v157, v240, v19
  v_dot2_f32_bf16 v20, v158, v56, v20
  v_dot2_f32_bf16 v21, v158, v240, v21
  v_dot2_f32_bf16 v22, v159, v56, v22
  v_dot2_f32_bf16 v23, v159, v240, v23
  v_dot2_f32_bf16 v24, v160, v56, v24
  v_dot2_f32_bf16 v25, v160, v240, v25
  v_dot2_f32_bf16 v26, v161, v56, v26
  v_dot2_f32_bf16 v27, v161, v240, v27
  v_dot2_f32_bf16 v28, v162, v64, v28
  v_dot2_f32_bf16 v29, v162, v248, v29
  v_dot2_f32_bf16 v30, v163, v64, v30
  v_dot2_f32_bf16 v31, v163, v248, v31
  v_dot2_f32_bf16 v32, v164, v64, v32
  v_dot2_f32_bf16 v33, v164, v248, v33
  v_dot2_f32_bf16 v34, v165, v64, v34
  v_dot2_f32_bf16 v35, v165, v248, v35
  v_dot2_f32_bf16 v36, v166, v64, v36
  v_dot2_f32_bf16 v37, v166, v248, v37
  v_dot2_f32_bf16 v38, v167, v64, v38
  v_dot2_f32_bf16 v39, v167, v248, v39
  v_dot2_f32_bf16 v40, v168, v64, v40
  v_dot2_f32_bf16 v41, v168, v248, v41
  v_dot2_f32_bf16 v42, v169, v64, v42
  v_dot2_f32_bf16 v43, v169, v248, v43
  v_dot2_f32_bf16 v44, v170, v64, v44
  v_dot2_f32_bf16 v45, v170, v248, v45
  v_dot2_f32_bf16 v46, v171, v64, v46
  v_dot2_f32_bf16 v47, v171, v248, v47
  s_waitcnt vmcnt(10)
  v_dot2_f32_bf16 v8, v172, v57, v8
  v_dot2_f32_bf16 v9, v172, v241, v9
  v_dot2_f32_bf16 v10, v173, v57, v10
  v_dot2_f32_bf16 v11, v173, v241, v11
  v_dot2_f32_bf16 v12, v174, v57, v12
  v_dot2_f32_bf16 v13, v174, v241, v13
  v_dot2_f32_bf16 v14, v175, v57, v14
  v_dot2_f32_bf16 v15, v175, v241, v15
  v_dot2_f32_bf16 v16, v176, v57, v16
  v_dot2_f32_bf16 v17, v176, v241, v17
  v_dot2_f32_bf16 v18, v177, v57, v18
  v_dot2_f32_bf16 v19, v177, v241, v19
  v_dot2_f32_bf16 v20, v178, v57, v20
  v_dot2_f32_bf16 v21, v178, v241, v21
  v_dot2_f32_bf16 v22, v179, v57, v22
  v_dot2_f32_bf16 v23, v179, v241, v23
  v_dot2_f32_bf16 v24, v180, v57, v24
  v_dot2_f32_bf16 v25, v180, v241, v25
  v_dot2_f32_bf16 v26, v181, v57, v26
  v_dot2_f32_bf16 v27, v181, v241, v27
  v_dot2_f32_bf16 v28, v182, v65, v28
  v_dot2_f32_bf16 v29, v182, v249, v29
  v_dot2_f32_bf16 v30, v183, v65, v30
  v_dot2_f32_bf16 v31, v183, v249, v31
  v_dot2_f32_bf16 v32, v184, v65, v32
  v_dot2_f32_bf16 v33, v184, v249, v33
  v_dot2_f32_bf16 v34, v185, v65, v34
  v_dot2_f32_bf16 v35, v185, v249, v35
  v_dot2_f32_bf16 v36, v186, v65, v36
  v_dot2_f32_bf16 v37, v186, v249, v37
  v_dot2_f32_bf16 v38, v187, v65, v38
  v_dot2_f32_bf16 v39, v187, v249, v39
  v_dot2_f32_bf16 v40, v188, v65, v40
  v_dot2_f32_bf16 v41, v188, v249, v41
  v_dot2_f32_bf16 v42, v189, v65, v42
  v_dot2_f32_bf16 v43, v189, v249, v43
  v_dot2_f32_bf16 v44, v190, v65, v44
  v_dot2_f32_bf16 v45, v190, v249, v45
  v_dot2_f32_bf16 v46, v191, v65, v46
  v_dot2_f32_bf16 v47, v191, v249, v47
  s_waitcnt vmcnt(5)
  v_dot2_f32_bf16 v8, v192, v58, v8
  v_dot2_f32_bf16 v9, v192, v242, v9
  v_dot2_f32_bf16 v10, v193, v58, v10
  v_dot2_f32_bf16 v11, v193, v242, v11
  v_dot2_f32_bf16 v12, v194, v58, v12
  v_dot2_f32_bf16 v13, v194, v242, v13
  v_dot2_f32_bf16 v14, v195, v58, v14
  v_dot2_f32_bf16 v15, v195, v242, v15
  v_dot2_f32_bf16 v16, v196, v58, v16
  v_dot2_f32_bf16 v17, v196, v242, v17
  v_dot2_f32_bf16 v18, v197, v58, v18
  v_dot2_f32_bf16 v19, v197, v242, v19
  v_dot2_f32_bf16 v20, v198, v58, v20
  v_dot2_f32_bf16 v21, v198, v242, v21
  v_dot2_f32_bf16 v22, v199, v58, v22
  v_dot2_f32_bf16 v23, v199, v242, v23
  v_dot2_f32_bf16 v24, v200, v58, v24
  v_dot2_f32_bf16 v25, v200, v242, v25
  v_dot2_f32_bf16 v26, v201, v58, v26
  v_dot2_f32_bf16 v27, v201, v242, v27
  v_dot2_f32_bf16 v28, v202, v66, v28
  v_dot2_f32_bf16 v29, v202, v250, v29
  v_dot2_f32_bf16 v30, v203, v66, v30
  v_dot2_f32_bf16 v31, v203, v250, v31
  v_dot2_f32_bf16 v32, v204, v66, v32
  v_dot2_f32_bf16 v33, v204, v250, v33
  v_dot2_f32_bf16 v34, v205, v66, v34
  v_dot2_f32_bf16 v35, v205, v250, v35
  v_dot2_f32_bf16 v36, v206, v66, v36
  v_dot2_f32_bf16 v37, v206, v250, v37
  v_dot2_f32_bf16 v38, v207, v66, v38
  v_dot2_f32_bf16 v39, v207, v250, v39
  v_dot2_f32_bf16 v40, v208, v66, v40
  v_dot2_f32_bf16 v41, v208, v250, v41
  v_dot2_f32_bf16 v42, v209, v66, v42
  v_dot2_f32_bf16 v43, v209, v250, v43
  v_dot2_f32_bf16 v44, v210, v66, v44
  v_dot2_f32_bf16 v45, v210, v250, v45
  v_dot2_f32_bf16 v46, v211, v66, v46
  v_dot2_f32_bf16 v47, v211, v250, v47
  s_waitcnt vmcnt(0)
  v_dot2_f32_bf16 v8, v212, v59, v8
  v_dot2_f32_bf16 v9, v212, v243, v9
  v_dot2_f32_bf16 v10, v213, v59, v10
  v_dot2_f32_bf16 v11, v213, v243, v11
  v_dot2_f32_bf16 v12, v214, v59, v12
  v_dot2_f32_bf16 v13, v214, v243, v13
  v_dot2_f32_bf16 v14, v215, v59, v14
  v_dot2_f32_bf16 v15, v215, v243, v15
  v_dot2_f32_bf16 v16, v216, v59, v16
  v_dot2_f32_bf16 v17, v216, v243, v17
  v_dot2_f32_bf16 v18, v217, v59, v18
  v_dot2_f32_bf16 v19, v217, v243, v19
  v_dot2_f32_bf16 v20, v218, v59, v20
  v_dot2_f32_bf16 v21, v218, v243, v21
  v_dot2_f32_bf16 v22, v219, v59, v22
  v_dot2_f32_bf16 v23, v219, v243, v23
  v_dot2_f32_bf16 v24, v220, v59, v24
  v_dot2_f32_bf16 v25, v220, v243, v25
  v_dot2_f32_bf16 v26, v221, v59, v26
  v_dot2_f32_bf16 v27, v221, v243, v27
  v_dot2_f32_bf16 v28, v222, v67, v28
  v_dot2_f32_bf16 v29, v222, v251, v29
  v_dot2_f32_bf16 v30, v223, v67, v30
  v_dot2_f32_bf16 v31, v223, v251, v31
  v_dot2_f32_bf16 v32, v224, v67, v32
  v_dot2_f32_bf16 v33, v224, v251, v33
  v_dot2_f32_bf16 v34, v225, v67, v34
  v_dot2_f32_bf16 v35, v225, v251, v35
  v_dot2_f32_bf16 v36, v226, v67, v36
  v_dot2_f32_bf16 v37, v226, v251, v37
  v_dot2_f32_bf16 v38, v227, v67, v38
  v_dot2_f32_bf16 v39, v227, v251, v39
  v_dot2_f32_bf16 v40, v228, v67, v40
  v_dot2_f32_bf16 v41, v228, v251, v41
  v_dot2_f32_bf16 v42, v229, v67, v42
  v_dot2_f32_bf16 v43, v229, v251, v43
  v_dot2_f32_bf16 v44, v230, v67, v44
  v_dot2_f32_bf16 v45, v230, v251, v45
  v_dot2_f32_bf16 v46, v231, v67, v46
  v_dot2_f32_bf16 v47, v231, v251, v47
  v_cvt_pk_bf16_f32 v72, v8, v9
  v_cvt_pk_bf16_f32 v73, v10, v11
  v_cvt_pk_bf16_f32 v74, v12, v13
  v_cvt_pk_bf16_f32 v75, v14, v15
  v_cvt_pk_bf16_f32 v76, v16, v17
  v_cvt_pk_bf16_f32 v77, v18, v19
  v_cvt_pk_bf16_f32 v78, v20, v21
  v_cvt_pk_bf16_f32 v79, v22, v23
  v_cvt_pk_bf16_f32 v80, v24, v25
  v_cvt_pk_bf16_f32 v81, v26, v27
  v_cvt_pk_bf16_f32 v82, v28, v29
  v_cvt_pk_bf16_f32 v83, v30, v31
  v_cvt_pk_bf16_f32 v84, v32, v33
  v_cvt_pk_bf16_f32 v85, v34, v35
  v_cvt_pk_bf16_f32 v86, v36, v37
  v_cvt_pk_bf16_f32 v87, v38, v39
  v_cvt_pk_bf16_f32 v88, v40, v41
  v_cvt_pk_bf16_f32 v89, v42, v43
  v_cvt_pk_bf16_f32 v90, v44, v45
  v_cvt_pk_bf16_f32 v91, v46, v47
  v_lshlrev_b32 v3, 8, v3
  v_lshl_add_u32 v3, v5, 4, v3
  v_add_u32 v3, 122880, v3
  ds_write_b128 v3, v[72:75] offset:0
  ds_write_b128 v3, v[76:79] offset:256
  ds_write_b128 v3, v[80:83] offset:512
  ds_write_b128 v3, v[84:87] offset:768
  ds_write_b128 v3, v[88:91] offset:1024
  s_waitcnt lgkmcnt(0)
  s_barrier
  v_lshlrev_b32 v13, 4, v0
  v_add_u32 v13, 122880, v13
  ds_read_b128 v[20:23], v13 offset:0
  ds_read_b128 v[24:27], v13 offset:1024
  ds_read_b128 v[28:31], v13 offset:2048
  ds_read_b128 v[32:35], v13 offset:3072
  ds_read_b128 v[36:39], v13 offset:4096
  ds_read_b128 v[40:43], v13 offset:5120
  ds_read_b128 v[44:47], v13 offset:6144
  ds_read_b128 v[48:51], v13 offset:7168
  ds_read_b128 v[52:55], v13 offset:8192
  ds_read_b128 v[56:59], v13 offset:9216
  ds_read_b128 v[60:63], v13 offset:10240
  ds_read_b128 v[64:67], v13 offset:11264
  s_waitcnt lgkmcnt(4)
  ds_read_b128 v[68:71], v13 offset:12288
  ds_read_b128 v[72:75], v13 offset:13312
  ds_read_b128 v[76:79], v13 offset:14336
  ds_read_b128 v[80:83], v13 offset:15360
  ds_read_b128 v[84:87], v13 offset:16384
  ds_read_b128 v[88:91], v13 offset:17408
  ds_read_b128 v[92:95], v13 offset:18432
  ds_read_b128 v[96:99], v13 offset:19456
  s_mov_b32 s4, s20
  s_mov_b32 s5, s21
  s_mov_b32 s6, 819200
  s_mov_b32 s7, 0x20000
  s_mov_b32 s12, s36
  s_mov_b32 s13, s37
  s_mov_b32 s14, 5242880
  s_mov_b32 s15, 0x20000
  v_mul_u32_u24 v12, 2560, v6
  v_lshrrev_b32 v14, 4, v0
  v_lshl_add_u32 v12, v14, 3, v12
  s_lshl_b32 s46, s42, 5
  v_add_u32 v12, s46, v12
  s_mov_b32 s66, 0
  s_waitcnt lgkmcnt(0)
  v_lshrrev_b32 v13, 3, v0
  v_lshrrev_b32 v14, 2, v13
  v_lshlrev_b32 v14, 3, v14
  v_and_b32 v8, 3, v13
  v_add_u32 v8, v8, v14
  s_and_b32 s46, s42, 1
  s_lshl_b32 s46, s46, 2
  s_lshr_b32 s47, s42, 1
  s_lshl_b32 s47, s47, 4
  s_add_u32 s46, s46, s47
  v_add_u32 v8, s46, v8
  v_mul_u32_u24 v8, 1280, v8
  v_lshrrev_b32 v13, 1, v13
  v_bfe_u32 v14, v0, 1, 2
  v_xor_b32 v13, v13, v14
  v_lshlrev_b32 v13, 5, v13
  v_and_b32 v14, 1, v0
  v_lshlrev_b32 v14, 4, v14
  v_add3_u32 v8, v8, v13, v14
  v_lshrrev_b32 v13, 5, v0
  v_lshlrev_b32 v9, 11, v13
  v_bfe_u32 v13, v0, 2, 3
  v_lshl_add_u32 v9, v13, 7, v9
  v_lshrrev_b32 v13, 1, v13
  v_xor_b32 v13, s42, v13
  v_lshl_add_u32 v9, v13, 5, v9
  v_and_b32 v13, 3, v0
  v_lshl_add_u32 v9, v13, 3, v9
  v_add_u32 v10, 0x10000, v9
  v_add_u32 v11, 0x20000, v9
  s_add_u32 m0, s51, 0
  s_add_u32 s46, s66, 0
  buffer_load_dwordx4 v8, s[4:7], s46 offen lds
  s_add_u32 m0, s51, 4096
  s_add_u32 s46, s66, 128
  buffer_load_dwordx4 v8, s[4:7], s46 offen lds
  s_add_u32 m0, s51, 8192
  s_add_u32 s46, s66, 256
  buffer_load_dwordx4 v8, s[4:7], s46 offen lds
  s_add_u32 m0, s51, 12288
  s_add_u32 s46, s66, 384
  buffer_load_dwordx4 v8, s[4:7], s46 offen lds
  s_add_u32 m0, s51, 16384
  s_add_u32 s46, s66, 512
  buffer_load_dwordx4 v8, s[4:7], s46 offen lds
  s_add_u32 m0, s51, 20480
  s_add_u32 s46, s66, 640
  buffer_load_dwordx4 v8, s[4:7], s46 offen lds
  s_add_u32 m0, s51, 24576
  s_add_u32 s46, s66, 768
  buffer_load_dwordx4 v8, s[4:7], s46 offen lds
  s_add_u32 m0, s51, 28672
  s_add_u32 s46, s66, 896
  buffer_load_dwordx4 v8, s[4:7], s46 offen lds
  s_add_u32 m0, s51, 32768
  s_add_u32 s46, s66, 1024
  buffer_load_dwordx4 v8, s[4:7], s46 offen lds
  s_add_u32 m0, s51, 36864
  s_add_u32 s46, s66, 1152
  buffer_load_dwordx4 v8, s[4:7], s46 offen lds
  s_add_u32 m0, s51, 40960
  s_add_u32 s46, s66, 40960
  buffer_load_dwordx4 v8, s[4:7], s46 offen lds
  s_add_u32 m0, s51, 45056
  s_add_u32 s46, s66, 41088
  buffer_load_dwordx4 v8, s[4:7], s46 offen lds
  s_add_u32 m0, s51, 49152
  s_add_u32 s46, s66, 41216
  buffer_load_dwordx4 v8, s[4:7], s46 offen lds
  s_add_u32 m0, s51, 53248
  s_add_u32 s46, s66, 41344
  buffer_load_dwordx4 v8, s[4:7], s46 offen lds
  s_add_u32 m0, s51, 57344
  s_add_u32 s46, s66, 41472
  buffer_load_dwordx4 v8, s[4:7], s46 offen lds
  s_add_u32 m0, s51, 61440
  s_add_u32 s46, s66, 41600
  buffer_load_dwordx4 v8, s[4:7], s46 offen lds
  s_add_u32 m0, s51, 65536
  s_add_u32 s46, s66, 41728
  buffer_load_dwordx4 v8, s[4:7], s46 offen lds
  s_add_u32 m0, s51, 69632
  s_add_u32 s46, s66, 41856
  buffer_load_dwordx4 v8, s[4:7], s46 offen lds
  s_add_u32 m0, s51, 73728
  s_add_u32 s46, s66, 41984
  buffer_load_dwordx4 v8, s[4:7], s46 offen lds
  s_add_u32 m0, s51, 77824
  s_add_u32 s46, s66, 42112
  buffer_load_dwordx4 v8, s[4:7], s46 offen lds
  s_add_u32 m0, s51, 81920
  s_add_u32 s46, s66, 81920
  buffer_load_dwordx4 v8, s[4:7], s46 offen lds
  s_add_u32 m0, s51, 86016
  s_add_u32 s46, s66, 82048
  buffer_load_dwordx4 v8, s[4:7], s46 offen lds
  s_add_u32 m0, s51, 90112
  s_add_u32 s46, s66, 82176
  buffer_load_dwordx4 v8, s[4:7], s46 offen lds
  s_add_u32 m0, s51, 94208
  s_add_u32 s46, s66, 82304
  buffer_load_dwordx4 v8, s[4:7], s46 offen lds
  s_add_u32 m0, s51, 98304
  s_add_u32 s46, s66, 82432
  buffer_load_dwordx4 v8, s[4:7], s46 offen lds
  s_waitcnt vmcnt(20)
  s_barrier
  s_add_u32 m0, s51, 102400
  s_add_u32 s46, s66, 82560
  buffer_load_dwordx4 v8, s[4:7], s46 offen lds
  s_add_u32 m0, s51, 106496
  s_add_u32 s46, s66, 82688
  buffer_load_dwordx4 v8, s[4:7], s46 offen lds
  s_add_u32 m0, s51, 110592
  s_add_u32 s46, s66, 82816
  buffer_load_dwordx4 v8, s[4:7], s46 offen lds
  s_add_u32 m0, s51, 114688
  s_add_u32 s46, s66, 82944
  buffer_load_dwordx4 v8, s[4:7], s46 offen lds
  s_add_u32 m0, s51, 118784
  s_add_u32 s46, s66, 83072
  buffer_load_dwordx4 v8, s[4:7], s46 offen lds
  ds_read_b64_tr_b16 v[100:101], v9 offset:0
  ds_read_b64_tr_b16 v[102:103], v9 offset:1024
  ds_read_b64_tr_b16 v[104:105], v9 offset:4096
  ds_read_b64_tr_b16 v[106:107], v9 offset:5120
  ds_read_b64_tr_b16 v[108:109], v9 offset:8192
  ds_read_b64_tr_b16 v[110:111], v9 offset:9216
  ds_read_b64_tr_b16 v[112:113], v9 offset:12288
  ds_read_b64_tr_b16 v[114:115], v9 offset:13312
  ds_read_b64_tr_b16 v[116:117], v9 offset:16384
  ds_read_b64_tr_b16 v[118:119], v9 offset:17408
  s_waitcnt lgkmcnt(0)
  v_mfma_f32_16x16x32_bf16 v[140:143], v[100:103], v[20:23], 0
  v_mfma_f32_16x16x32_bf16 v[144:147], v[104:107], v[20:23], 0
  v_mfma_f32_16x16x32_bf16 v[148:151], v[108:111], v[20:23], 0
  v_mfma_f32_16x16x32_bf16 v[152:155], v[112:115], v[20:23], 0
  v_mfma_f32_16x16x32_bf16 v[156:159], v[116:119], v[20:23], 0
  s_waitcnt vmcnt(20)
  s_barrier
  s_add_u32 m0, s51, 0
  s_add_u32 s46, s66, 122880
  buffer_load_dwordx4 v8, s[4:7], s46 offen lds
  s_add_u32 m0, s51, 4096
  s_add_u32 s46, s66, 123008
  buffer_load_dwordx4 v8, s[4:7], s46 offen lds
  s_add_u32 m0, s51, 8192
  s_add_u32 s46, s66, 123136
  buffer_load_dwordx4 v8, s[4:7], s46 offen lds
  s_add_u32 m0, s51, 12288
  s_add_u32 s46, s66, 123264
  buffer_load_dwordx4 v8, s[4:7], s46 offen lds
  s_add_u32 m0, s51, 16384
  s_add_u32 s46, s66, 123392
  buffer_load_dwordx4 v8, s[4:7], s46 offen lds
  ds_read_b64_tr_b16 v[120:121], v9 offset:20480
  ds_read_b64_tr_b16 v[122:123], v9 offset:21504
  ds_read_b64_tr_b16 v[124:125], v9 offset:24576
  ds_read_b64_tr_b16 v[126:127], v9 offset:25600
  ds_read_b64_tr_b16 v[128:129], v9 offset:28672
  ds_read_b64_tr_b16 v[130:131], v9 offset:29696
  ds_read_b64_tr_b16 v[132:133], v9 offset:32768
  ds_read_b64_tr_b16 v[134:135], v9 offset:33792
  ds_read_b64_tr_b16 v[136:137], v9 offset:36864
  ds_read_b64_tr_b16 v[138:139], v9 offset:37888
  s_waitcnt lgkmcnt(0)
  v_mfma_f32_16x16x32_bf16 v[160:163], v[120:123], v[20:23], 0
  v_mfma_f32_16x16x32_bf16 v[164:167], v[124:127], v[20:23], 0
  v_mfma_f32_16x16x32_bf16 v[168:171], v[128:131], v[20:23], 0
  v_mfma_f32_16x16x32_bf16 v[172:175], v[132:135], v[20:23], 0
  v_mfma_f32_16x16x32_bf16 v[176:179], v[136:139], v[20:23], 0
  s_waitcnt vmcnt(20)
  s_barrier
  s_add_u32 m0, s51, 20480
  s_add_u32 s46, s66, 123520
  buffer_load_dwordx4 v8, s[4:7], s46 offen lds
  s_add_u32 m0, s51, 24576
  s_add_u32 s46, s66, 123648
  buffer_load_dwordx4 v8, s[4:7], s46 offen lds
  s_add_u32 m0, s51, 28672
  s_add_u32 s46, s66, 123776
  buffer_load_dwordx4 v8, s[4:7], s46 offen lds
  s_add_u32 m0, s51, 32768
  s_add_u32 s46, s66, 123904
  buffer_load_dwordx4 v8, s[4:7], s46 offen lds
  s_add_u32 m0, s51, 36864
  s_add_u32 s46, s66, 124032
  buffer_load_dwordx4 v8, s[4:7], s46 offen lds
  ds_read_b64_tr_b16 v[100:101], v9 offset:40960
  ds_read_b64_tr_b16 v[102:103], v9 offset:41984
  ds_read_b64_tr_b16 v[104:105], v9 offset:45056
  ds_read_b64_tr_b16 v[106:107], v9 offset:46080
  ds_read_b64_tr_b16 v[108:109], v9 offset:49152
  ds_read_b64_tr_b16 v[110:111], v9 offset:50176
  ds_read_b64_tr_b16 v[112:113], v9 offset:53248
  ds_read_b64_tr_b16 v[114:115], v9 offset:54272
  ds_read_b64_tr_b16 v[116:117], v9 offset:57344
  ds_read_b64_tr_b16 v[118:119], v9 offset:58368
  s_waitcnt lgkmcnt(0)
  v_mfma_f32_16x16x32_bf16 v[140:143], v[100:103], v[24:27], v[140:143]
  v_mfma_f32_16x16x32_bf16 v[144:147], v[104:107], v[24:27], v[144:147]
  v_mfma_f32_16x16x32_bf16 v[148:151], v[108:111], v[24:27], v[148:151]
  v_mfma_f32_16x16x32_bf16 v[152:155], v[112:115], v[24:27], v[152:155]
  v_mfma_f32_16x16x32_bf16 v[156:159], v[116:119], v[24:27], v[156:159]
  s_waitcnt vmcnt(20)
  s_barrier
  s_add_u32 m0, s51, 40960
  s_add_u32 s46, s66, 163840
  buffer_load_dwordx4 v8, s[4:7], s46 offen lds
  s_add_u32 m0, s51, 45056
  s_add_u32 s46, s66, 163968
  buffer_load_dwordx4 v8, s[4:7], s46 offen lds
  s_add_u32 m0, s51, 49152
  s_add_u32 s46, s66, 164096
  buffer_load_dwordx4 v8, s[4:7], s46 offen lds
  s_add_u32 m0, s51, 53248
  s_add_u32 s46, s66, 164224
  buffer_load_dwordx4 v8, s[4:7], s46 offen lds
  s_add_u32 m0, s51, 57344
  s_add_u32 s46, s66, 164352
  buffer_load_dwordx4 v8, s[4:7], s46 offen lds
  ds_read_b64_tr_b16 v[120:121], v9 offset:61440
  ds_read_b64_tr_b16 v[122:123], v9 offset:62464
  ds_read_b64_tr_b16 v[124:125], v10 offset:0
  ds_read_b64_tr_b16 v[126:127], v10 offset:1024
  ds_read_b64_tr_b16 v[128:129], v10 offset:4096
  ds_read_b64_tr_b16 v[130:131], v10 offset:5120
  ds_read_b64_tr_b16 v[132:133], v10 offset:8192
  ds_read_b64_tr_b16 v[134:135], v10 offset:9216
  ds_read_b64_tr_b16 v[136:137], v10 offset:12288
  ds_read_b64_tr_b16 v[138:139], v10 offset:13312
  s_waitcnt lgkmcnt(0)
  v_mfma_f32_16x16x32_bf16 v[160:163], v[120:123], v[24:27], v[160:163]
  v_mfma_f32_16x16x32_bf16 v[164:167], v[124:127], v[24:27], v[164:167]
  v_mfma_f32_16x16x32_bf16 v[168:171], v[128:131], v[24:27], v[168:171]
  v_mfma_f32_16x16x32_bf16 v[172:175], v[132:135], v[24:27], v[172:175]
  v_mfma_f32_16x16x32_bf16 v[176:179], v[136:139], v[24:27], v[176:179]
  s_waitcnt vmcnt(20)
  s_barrier
  s_add_u32 m0, s51, 61440
  s_add_u32 s46, s66, 164480
  buffer_load_dwordx4 v8, s[4:7], s46 offen lds
  s_add_u32 m0, s51, 65536
  s_add_u32 s46, s66, 164608
  buffer_load_dwordx4 v8, s[4:7], s46 offen lds
  s_add_u32 m0, s51, 69632
  s_add_u32 s46, s66, 164736
  buffer_load_dwordx4 v8, s[4:7], s46 offen lds
  s_add_u32 m0, s51, 73728
  s_add_u32 s46, s66, 164864
  buffer_load_dwordx4 v8, s[4:7], s46 offen lds
  s_add_u32 m0, s51, 77824
  s_add_u32 s46, s66, 164992
  buffer_load_dwordx4 v8, s[4:7], s46 offen lds
  ds_read_b64_tr_b16 v[100:101], v10 offset:16384
  ds_read_b64_tr_b16 v[102:103], v10 offset:17408
  ds_read_b64_tr_b16 v[104:105], v10 offset:20480
  ds_read_b64_tr_b16 v[106:107], v10 offset:21504
  ds_read_b64_tr_b16 v[108:109], v10 offset:24576
  ds_read_b64_tr_b16 v[110:111], v10 offset:25600
  ds_read_b64_tr_b16 v[112:113], v10 offset:28672
  ds_read_b64_tr_b16 v[114:115], v10 offset:29696
  ds_read_b64_tr_b16 v[116:117], v10 offset:32768
  ds_read_b64_tr_b16 v[118:119], v10 offset:33792
  s_waitcnt lgkmcnt(0)
  v_mfma_f32_16x16x32_bf16 v[140:143], v[100:103], v[28:31], v[140:143]
  v_mfma_f32_16x16x32_bf16 v[144:147], v[104:107], v[28:31], v[144:147]
  v_mfma_f32_16x16x32_bf16 v[148:151], v[108:111], v[28:31], v[148:151]
  v_mfma_f32_16x16x32_bf16 v[152:155], v[112:115], v[28:31], v[152:155]
  v_mfma_f32_16x16x32_bf16 v[156:159], v[116:119], v[28:31], v[156:159]
  s_waitcnt vmcnt(20)
  s_barrier
  s_add_u32 m0, s51, 81920
  s_add_u32 s46, s66, 204800
  buffer_load_dwordx4 v8, s[4:7], s46 offen lds
  s_add_u32 m0, s51, 86016
  s_add_u32 s46, s66, 204928
  buffer_load_dwordx4 v8, s[4:7], s46 offen lds
  s_add_u32 m0, s51, 90112
  s_add_u32 s46, s66, 205056
  buffer_load_dwordx4 v8, s[4:7], s46 offen lds
  s_add_u32 m0, s51, 94208
  s_add_u32 s46, s66, 205184
  buffer_load_dwordx4 v8, s[4:7], s46 offen lds
  s_add_u32 m0, s51, 98304
  s_add_u32 s46, s66, 205312
  buffer_load_dwordx4 v8, s[4:7], s46 offen lds
  ds_read_b64_tr_b16 v[120:121], v10 offset:36864
  ds_read_b64_tr_b16 v[122:123], v10 offset:37888
  ds_read_b64_tr_b16 v[124:125], v10 offset:40960
  ds_read_b64_tr_b16 v[126:127], v10 offset:41984
  ds_read_b64_tr_b16 v[128:129], v10 offset:45056
  ds_read_b64_tr_b16 v[130:131], v10 offset:46080
  ds_read_b64_tr_b16 v[132:133], v10 offset:49152
  ds_read_b64_tr_b16 v[134:135], v10 offset:50176
  ds_read_b64_tr_b16 v[136:137], v10 offset:53248
  ds_read_b64_tr_b16 v[138:139], v10 offset:54272
  s_waitcnt lgkmcnt(0)
  v_mfma_f32_16x16x32_bf16 v[160:163], v[120:123], v[28:31], v[160:163]
  v_mfma_f32_16x16x32_bf16 v[164:167], v[124:127], v[28:31], v[164:167]
  v_mfma_f32_16x16x32_bf16 v[168:171], v[128:131], v[28:31], v[168:171]
  v_mfma_f32_16x16x32_bf16 v[172:175], v[132:135], v[28:31], v[172:175]
  v_mfma_f32_16x16x32_bf16 v[176:179], v[136:139], v[28:31], v[176:179]
  s_waitcnt vmcnt(20)
  s_barrier
  s_add_u32 m0, s51, 102400
  s_add_u32 s46, s66, 205440
  buffer_load_dwordx4 v8, s[4:7], s46 offen lds
  s_add_u32 m0, s51, 106496
  s_add_u32 s46, s66, 205568
  buffer_load_dwordx4 v8, s[4:7], s46 offen lds
  s_add_u32 m0, s51, 110592
  s_add_u32 s46, s66, 205696
  buffer_load_dwordx4 v8, s[4:7], s46 offen lds
  s_add_u32 m0, s51, 114688
  s_add_u32 s46, s66, 205824
  buffer_load_dwordx4 v8, s[4:7], s46 offen lds
  s_add_u32 m0, s51, 118784
  s_add_u32 s46, s66, 205952
  buffer_load_dwordx4 v8, s[4:7], s46 offen lds
  ds_read_b64_tr_b16 v[100:101], v9 offset:0
  ds_read_b64_tr_b16 v[102:103], v9 offset:1024
  ds_read_b64_tr_b16 v[104:105], v9 offset:4096
  ds_read_b64_tr_b16 v[106:107], v9 offset:5120
  ds_read_b64_tr_b16 v[108:109], v9 offset:8192
  ds_read_b64_tr_b16 v[110:111], v9 offset:9216
  ds_read_b64_tr_b16 v[112:113], v9 offset:12288
  ds_read_b64_tr_b16 v[114:115], v9 offset:13312
  ds_read_b64_tr_b16 v[116:117], v9 offset:16384
  ds_read_b64_tr_b16 v[118:119], v9 offset:17408
  s_waitcnt lgkmcnt(0)
  v_mfma_f32_16x16x32_bf16 v[140:143], v[100:103], v[32:35], v[140:143]
  v_mfma_f32_16x16x32_bf16 v[144:147], v[104:107], v[32:35], v[144:147]
  v_mfma_f32_16x16x32_bf16 v[148:151], v[108:111], v[32:35], v[148:151]
  v_mfma_f32_16x16x32_bf16 v[152:155], v[112:115], v[32:35], v[152:155]
  v_mfma_f32_16x16x32_bf16 v[156:159], v[116:119], v[32:35], v[156:159]
  s_waitcnt vmcnt(20)
  s_barrier
  s_add_u32 m0, s51, 0
  s_add_u32 s46, s66, 245760
  buffer_load_dwordx4 v8, s[4:7], s46 offen lds
  s_add_u32 m0, s51, 4096
  s_add_u32 s46, s66, 245888
  buffer_load_dwordx4 v8, s[4:7], s46 offen lds
  s_add_u32 m0, s51, 8192
  s_add_u32 s46, s66, 246016
  buffer_load_dwordx4 v8, s[4:7], s46 offen lds
  s_add_u32 m0, s51, 12288
  s_add_u32 s46, s66, 246144
  buffer_load_dwordx4 v8, s[4:7], s46 offen lds
  s_add_u32 m0, s51, 16384
  s_add_u32 s46, s66, 246272
  buffer_load_dwordx4 v8, s[4:7], s46 offen lds
  ds_read_b64_tr_b16 v[120:121], v9 offset:20480
  ds_read_b64_tr_b16 v[122:123], v9 offset:21504
  ds_read_b64_tr_b16 v[124:125], v9 offset:24576
  ds_read_b64_tr_b16 v[126:127], v9 offset:25600
  ds_read_b64_tr_b16 v[128:129], v9 offset:28672
  ds_read_b64_tr_b16 v[130:131], v9 offset:29696
  ds_read_b64_tr_b16 v[132:133], v9 offset:32768
  ds_read_b64_tr_b16 v[134:135], v9 offset:33792
  ds_read_b64_tr_b16 v[136:137], v9 offset:36864
  ds_read_b64_tr_b16 v[138:139], v9 offset:37888
  s_waitcnt lgkmcnt(0)
  v_mfma_f32_16x16x32_bf16 v[160:163], v[120:123], v[32:35], v[160:163]
  v_mfma_f32_16x16x32_bf16 v[164:167], v[124:127], v[32:35], v[164:167]
  v_mfma_f32_16x16x32_bf16 v[168:171], v[128:131], v[32:35], v[168:171]
  v_mfma_f32_16x16x32_bf16 v[172:175], v[132:135], v[32:35], v[172:175]
  v_mfma_f32_16x16x32_bf16 v[176:179], v[136:139], v[32:35], v[176:179]
  s_waitcnt vmcnt(20)
  s_barrier
  s_add_u32 m0, s51, 20480
  s_add_u32 s46, s66, 246400
  buffer_load_dwordx4 v8, s[4:7], s46 offen lds
  s_add_u32 m0, s51, 24576
  s_add_u32 s46, s66, 246528
  buffer_load_dwordx4 v8, s[4:7], s46 offen lds
  s_add_u32 m0, s51, 28672
  s_add_u32 s46, s66, 246656
  buffer_load_dwordx4 v8, s[4:7], s46 offen lds
  s_add_u32 m0, s51, 32768
  s_add_u32 s46, s66, 246784
  buffer_load_dwordx4 v8, s[4:7], s46 offen lds
  s_add_u32 m0, s51, 36864
  s_add_u32 s46, s66, 246912
  buffer_load_dwordx4 v8, s[4:7], s46 offen lds
  ds_read_b64_tr_b16 v[100:101], v9 offset:40960
  ds_read_b64_tr_b16 v[102:103], v9 offset:41984
  ds_read_b64_tr_b16 v[104:105], v9 offset:45056
  ds_read_b64_tr_b16 v[106:107], v9 offset:46080
  ds_read_b64_tr_b16 v[108:109], v9 offset:49152
  ds_read_b64_tr_b16 v[110:111], v9 offset:50176
  ds_read_b64_tr_b16 v[112:113], v9 offset:53248
  ds_read_b64_tr_b16 v[114:115], v9 offset:54272
  ds_read_b64_tr_b16 v[116:117], v9 offset:57344
  ds_read_b64_tr_b16 v[118:119], v9 offset:58368
  s_waitcnt lgkmcnt(0)
  v_mfma_f32_16x16x32_bf16 v[140:143], v[100:103], v[36:39], v[140:143]
  v_mfma_f32_16x16x32_bf16 v[144:147], v[104:107], v[36:39], v[144:147]
  v_mfma_f32_16x16x32_bf16 v[148:151], v[108:111], v[36:39], v[148:151]
  v_mfma_f32_16x16x32_bf16 v[152:155], v[112:115], v[36:39], v[152:155]
  v_mfma_f32_16x16x32_bf16 v[156:159], v[116:119], v[36:39], v[156:159]
  s_waitcnt vmcnt(20)
  s_barrier
  s_add_u32 m0, s51, 40960
  s_add_u32 s46, s66, 286720
  buffer_load_dwordx4 v8, s[4:7], s46 offen lds
  s_add_u32 m0, s51, 45056
  s_add_u32 s46, s66, 286848
  buffer_load_dwordx4 v8, s[4:7], s46 offen lds
  s_add_u32 m0, s51, 49152
  s_add_u32 s46, s66, 286976
  buffer_load_dwordx4 v8, s[4:7], s46 offen lds
  s_add_u32 m0, s51, 53248
  s_add_u32 s46, s66, 287104
  buffer_load_dwordx4 v8, s[4:7], s46 offen lds
  s_add_u32 m0, s51, 57344
  s_add_u32 s46, s66, 287232
  buffer_load_dwordx4 v8, s[4:7], s46 offen lds
  ds_read_b64_tr_b16 v[120:121], v9 offset:61440
  ds_read_b64_tr_b16 v[122:123], v9 offset:62464
  ds_read_b64_tr_b16 v[124:125], v10 offset:0
  ds_read_b64_tr_b16 v[126:127], v10 offset:1024
  ds_read_b64_tr_b16 v[128:129], v10 offset:4096
  ds_read_b64_tr_b16 v[130:131], v10 offset:5120
  ds_read_b64_tr_b16 v[132:133], v10 offset:8192
  ds_read_b64_tr_b16 v[134:135], v10 offset:9216
  ds_read_b64_tr_b16 v[136:137], v10 offset:12288
  ds_read_b64_tr_b16 v[138:139], v10 offset:13312
  s_waitcnt lgkmcnt(0)
  v_mfma_f32_16x16x32_bf16 v[160:163], v[120:123], v[36:39], v[160:163]
  v_mfma_f32_16x16x32_bf16 v[164:167], v[124:127], v[36:39], v[164:167]
  v_mfma_f32_16x16x32_bf16 v[168:171], v[128:131], v[36:39], v[168:171]
  v_mfma_f32_16x16x32_bf16 v[172:175], v[132:135], v[36:39], v[172:175]
  v_mfma_f32_16x16x32_bf16 v[176:179], v[136:139], v[36:39], v[176:179]
  s_waitcnt vmcnt(20)
  s_barrier
  s_add_u32 m0, s51, 61440
  s_add_u32 s46, s66, 287360
  buffer_load_dwordx4 v8, s[4:7], s46 offen lds
  s_add_u32 m0, s51, 65536
  s_add_u32 s46, s66, 287488
  buffer_load_dwordx4 v8, s[4:7], s46 offen lds
  s_add_u32 m0, s51, 69632
  s_add_u32 s46, s66, 287616
  buffer_load_dwordx4 v8, s[4:7], s46 offen lds
  s_add_u32 m0, s51, 73728
  s_add_u32 s46, s66, 287744
  buffer_load_dwordx4 v8, s[4:7], s46 offen lds
  s_add_u32 m0, s51, 77824
  s_add_u32 s46, s66, 287872
  buffer_load_dwordx4 v8, s[4:7], s46 offen lds
  ds_read_b64_tr_b16 v[100:101], v10 offset:16384
  ds_read_b64_tr_b16 v[102:103], v10 offset:17408
  ds_read_b64_tr_b16 v[104:105], v10 offset:20480
  ds_read_b64_tr_b16 v[106:107], v10 offset:21504
  ds_read_b64_tr_b16 v[108:109], v10 offset:24576
  ds_read_b64_tr_b16 v[110:111], v10 offset:25600
  ds_read_b64_tr_b16 v[112:113], v10 offset:28672
  ds_read_b64_tr_b16 v[114:115], v10 offset:29696
  ds_read_b64_tr_b16 v[116:117], v10 offset:32768
  ds_read_b64_tr_b16 v[118:119], v10 offset:33792
  s_waitcnt lgkmcnt(0)
  v_mfma_f32_16x16x32_bf16 v[140:143], v[100:103], v[40:43], v[140:143]
  v_mfma_f32_16x16x32_bf16 v[144:147], v[104:107], v[40:43], v[144:147]
  v_mfma_f32_16x16x32_bf16 v[148:151], v[108:111], v[40:43], v[148:151]
  v_mfma_f32_16x16x32_bf16 v[152:155], v[112:115], v[40:43], v[152:155]
  v_mfma_f32_16x16x32_bf16 v[156:159], v[116:119], v[40:43], v[156:159]
  s_waitcnt vmcnt(20)
  s_barrier
  s_add_u32 m0, s51, 81920
  s_add_u32 s46, s66, 327680
  buffer_load_dwordx4 v8, s[4:7], s46 offen lds
  s_add_u32 m0, s51, 86016
  s_add_u32 s46, s66, 327808
  buffer_load_dwordx4 v8, s[4:7], s46 offen lds
  s_add_u32 m0, s51, 90112
  s_add_u32 s46, s66, 327936
  buffer_load_dwordx4 v8, s[4:7], s46 offen lds
  s_add_u32 m0, s51, 94208
  s_add_u32 s46, s66, 328064
  buffer_load_dwordx4 v8, s[4:7], s46 offen lds
  s_add_u32 m0, s51, 98304
  s_add_u32 s46, s66, 328192
  buffer_load_dwordx4 v8, s[4:7], s46 offen lds
  ds_read_b64_tr_b16 v[120:121], v10 offset:36864
  ds_read_b64_tr_b16 v[122:123], v10 offset:37888
  ds_read_b64_tr_b16 v[124:125], v10 offset:40960
  ds_read_b64_tr_b16 v[126:127], v10 offset:41984
  ds_read_b64_tr_b16 v[128:129], v10 offset:45056
  ds_read_b64_tr_b16 v[130:131], v10 offset:46080
  ds_read_b64_tr_b16 v[132:133], v10 offset:49152
  ds_read_b64_tr_b16 v[134:135], v10 offset:50176
  ds_read_b64_tr_b16 v[136:137], v10 offset:53248
  ds_read_b64_tr_b16 v[138:139], v10 offset:54272
  s_waitcnt lgkmcnt(0)
  v_mfma_f32_16x16x32_bf16 v[160:163], v[120:123], v[40:43], v[160:163]
  v_mfma_f32_16x16x32_bf16 v[164:167], v[124:127], v[40:43], v[164:167]
  v_mfma_f32_16x16x32_bf16 v[168:171], v[128:131], v[40:43], v[168:171]
  v_mfma_f32_16x16x32_bf16 v[172:175], v[132:135], v[40:43], v[172:175]
  v_mfma_f32_16x16x32_bf16 v[176:179], v[136:139], v[40:43], v[176:179]
  s_waitcnt vmcnt(20)
  s_barrier
  s_add_u32 m0, s51, 102400
  s_add_u32 s46, s66, 328320
  buffer_load_dwordx4 v8, s[4:7], s46 offen lds
  s_add_u32 m0, s51, 106496
  s_add_u32 s46, s66, 328448
  buffer_load_dwordx4 v8, s[4:7], s46 offen lds
  s_add_u32 m0, s51, 110592
  s_add_u32 s46, s66, 328576
  buffer_load_dwordx4 v8, s[4:7], s46 offen lds
  s_add_u32 m0, s51, 114688
  s_add_u32 s46, s66, 328704
  buffer_load_dwordx4 v8, s[4:7], s46 offen lds
  s_add_u32 m0, s51, 118784
  s_add_u32 s46, s66, 328832
  buffer_load_dwordx4 v8, s[4:7], s46 offen lds
  ds_read_b64_tr_b16 v[100:101], v9 offset:0
  ds_read_b64_tr_b16 v[102:103], v9 offset:1024
  ds_read_b64_tr_b16 v[104:105], v9 offset:4096
  ds_read_b64_tr_b16 v[106:107], v9 offset:5120
  ds_read_b64_tr_b16 v[108:109], v9 offset:8192
  ds_read_b64_tr_b16 v[110:111], v9 offset:9216
  ds_read_b64_tr_b16 v[112:113], v9 offset:12288
  ds_read_b64_tr_b16 v[114:115], v9 offset:13312
  ds_read_b64_tr_b16 v[116:117], v9 offset:16384
  ds_read_b64_tr_b16 v[118:119], v9 offset:17408
  s_waitcnt lgkmcnt(0)
  v_mfma_f32_16x16x32_bf16 v[140:143], v[100:103], v[44:47], v[140:143]
  v_mfma_f32_16x16x32_bf16 v[144:147], v[104:107], v[44:47], v[144:147]
  v_mfma_f32_16x16x32_bf16 v[148:151], v[108:111], v[44:47], v[148:151]
  v_mfma_f32_16x16x32_bf16 v[152:155], v[112:115], v[44:47], v[152:155]
  v_mfma_f32_16x16x32_bf16 v[156:159], v[116:119], v[44:47], v[156:159]
  s_waitcnt vmcnt(20)
  s_barrier
  s_add_u32 m0, s51, 0
  s_add_u32 s46, s66, 368640
  buffer_load_dwordx4 v8, s[4:7], s46 offen lds
  s_add_u32 m0, s51, 4096
  s_add_u32 s46, s66, 368768
  buffer_load_dwordx4 v8, s[4:7], s46 offen lds
  s_add_u32 m0, s51, 8192
  s_add_u32 s46, s66, 368896
  buffer_load_dwordx4 v8, s[4:7], s46 offen lds
  s_add_u32 m0, s51, 12288
  s_add_u32 s46, s66, 369024
  buffer_load_dwordx4 v8, s[4:7], s46 offen lds
  s_add_u32 m0, s51, 16384
  s_add_u32 s46, s66, 369152
  buffer_load_dwordx4 v8, s[4:7], s46 offen lds
  ds_read_b64_tr_b16 v[120:121], v9 offset:20480
  ds_read_b64_tr_b16 v[122:123], v9 offset:21504
  ds_read_b64_tr_b16 v[124:125], v9 offset:24576
  ds_read_b64_tr_b16 v[126:127], v9 offset:25600
  ds_read_b64_tr_b16 v[128:129], v9 offset:28672
  ds_read_b64_tr_b16 v[130:131], v9 offset:29696
  ds_read_b64_tr_b16 v[132:133], v9 offset:32768
  ds_read_b64_tr_b16 v[134:135], v9 offset:33792
  ds_read_b64_tr_b16 v[136:137], v9 offset:36864
  ds_read_b64_tr_b16 v[138:139], v9 offset:37888
  s_waitcnt lgkmcnt(0)
  v_mfma_f32_16x16x32_bf16 v[160:163], v[120:123], v[44:47], v[160:163]
  v_mfma_f32_16x16x32_bf16 v[164:167], v[124:127], v[44:47], v[164:167]
  v_mfma_f32_16x16x32_bf16 v[168:171], v[128:131], v[44:47], v[168:171]
  v_mfma_f32_16x16x32_bf16 v[172:175], v[132:135], v[44:47], v[172:175]
  v_mfma_f32_16x16x32_bf16 v[176:179], v[136:139], v[44:47], v[176:179]
  s_waitcnt vmcnt(20)
  s_barrier
  s_add_u32 m0, s51, 20480
  s_add_u32 s46, s66, 369280
  buffer_load_dwordx4 v8, s[4:7], s46 offen lds
  s_add_u32 m0, s51, 24576
  s_add_u32 s46, s66, 369408
  buffer_load_dwordx4 v8, s[4:7], s46 offen lds
  s_add_u32 m0, s51, 28672
  s_add_u32 s46, s66, 369536
  buffer_load_dwordx4 v8, s[4:7], s46 offen lds
  s_add_u32 m0, s51, 32768
  s_add_u32 s46, s66, 369664
  buffer_load_dwordx4 v8, s[4:7], s46 offen lds
  s_add_u32 m0, s51, 36864
  s_add_u32 s46, s66, 369792
  buffer_load_dwordx4 v8, s[4:7], s46 offen lds
  ds_read_b64_tr_b16 v[100:101], v9 offset:40960
  ds_read_b64_tr_b16 v[102:103], v9 offset:41984
  ds_read_b64_tr_b16 v[104:105], v9 offset:45056
  ds_read_b64_tr_b16 v[106:107], v9 offset:46080
  ds_read_b64_tr_b16 v[108:109], v9 offset:49152
  ds_read_b64_tr_b16 v[110:111], v9 offset:50176
  ds_read_b64_tr_b16 v[112:113], v9 offset:53248
  ds_read_b64_tr_b16 v[114:115], v9 offset:54272
  ds_read_b64_tr_b16 v[116:117], v9 offset:57344
  ds_read_b64_tr_b16 v[118:119], v9 offset:58368
  s_waitcnt lgkmcnt(0)
  v_mfma_f32_16x16x32_bf16 v[140:143], v[100:103], v[48:51], v[140:143]
  v_mfma_f32_16x16x32_bf16 v[144:147], v[104:107], v[48:51], v[144:147]
  v_mfma_f32_16x16x32_bf16 v[148:151], v[108:111], v[48:51], v[148:151]
  v_mfma_f32_16x16x32_bf16 v[152:155], v[112:115], v[48:51], v[152:155]
  v_mfma_f32_16x16x32_bf16 v[156:159], v[116:119], v[48:51], v[156:159]
  s_waitcnt vmcnt(20)
  s_barrier
  s_add_u32 m0, s51, 40960
  s_add_u32 s46, s66, 409600
  buffer_load_dwordx4 v8, s[4:7], s46 offen lds
  s_add_u32 m0, s51, 45056
  s_add_u32 s46, s66, 409728
  buffer_load_dwordx4 v8, s[4:7], s46 offen lds
  s_add_u32 m0, s51, 49152
  s_add_u32 s46, s66, 409856
  buffer_load_dwordx4 v8, s[4:7], s46 offen lds
  s_add_u32 m0, s51, 53248
  s_add_u32 s46, s66, 409984
  buffer_load_dwordx4 v8, s[4:7], s46 offen lds
  s_add_u32 m0, s51, 57344
  s_add_u32 s46, s66, 410112
  buffer_load_dwordx4 v8, s[4:7], s46 offen lds
  ds_read_b64_tr_b16 v[120:121], v9 offset:61440
  ds_read_b64_tr_b16 v[122:123], v9 offset:62464
  ds_read_b64_tr_b16 v[124:125], v10 offset:0
  ds_read_b64_tr_b16 v[126:127], v10 offset:1024
  ds_read_b64_tr_b16 v[128:129], v10 offset:4096
  ds_read_b64_tr_b16 v[130:131], v10 offset:5120
  ds_read_b64_tr_b16 v[132:133], v10 offset:8192
  ds_read_b64_tr_b16 v[134:135], v10 offset:9216
  ds_read_b64_tr_b16 v[136:137], v10 offset:12288
  ds_read_b64_tr_b16 v[138:139], v10 offset:13312
  s_waitcnt lgkmcnt(0)
  v_mfma_f32_16x16x32_bf16 v[160:163], v[120:123], v[48:51], v[160:163]
  v_mfma_f32_16x16x32_bf16 v[164:167], v[124:127], v[48:51], v[164:167]
  v_mfma_f32_16x16x32_bf16 v[168:171], v[128:131], v[48:51], v[168:171]
  v_mfma_f32_16x16x32_bf16 v[172:175], v[132:135], v[48:51], v[172:175]
  v_mfma_f32_16x16x32_bf16 v[176:179], v[136:139], v[48:51], v[176:179]
  s_waitcnt vmcnt(20)
  s_barrier
  s_add_u32 m0, s51, 61440
  s_add_u32 s46, s66, 410240
  buffer_load_dwordx4 v8, s[4:7], s46 offen lds
  s_add_u32 m0, s51, 65536
  s_add_u32 s46, s66, 410368
  buffer_load_dwordx4 v8, s[4:7], s46 offen lds
  s_add_u32 m0, s51, 69632
  s_add_u32 s46, s66, 410496
  buffer_load_dwordx4 v8, s[4:7], s46 offen lds
  s_add_u32 m0, s51, 73728
  s_add_u32 s46, s66, 410624
  buffer_load_dwordx4 v8, s[4:7], s46 offen lds
  s_add_u32 m0, s51, 77824
  s_add_u32 s46, s66, 410752
  buffer_load_dwordx4 v8, s[4:7], s46 offen lds
  ds_read_b64_tr_b16 v[100:101], v10 offset:16384
  ds_read_b64_tr_b16 v[102:103], v10 offset:17408
  ds_read_b64_tr_b16 v[104:105], v10 offset:20480
  ds_read_b64_tr_b16 v[106:107], v10 offset:21504
  ds_read_b64_tr_b16 v[108:109], v10 offset:24576
  ds_read_b64_tr_b16 v[110:111], v10 offset:25600
  ds_read_b64_tr_b16 v[112:113], v10 offset:28672
  ds_read_b64_tr_b16 v[114:115], v10 offset:29696
  ds_read_b64_tr_b16 v[116:117], v10 offset:32768
  ds_read_b64_tr_b16 v[118:119], v10 offset:33792
  s_waitcnt lgkmcnt(0)
  v_mfma_f32_16x16x32_bf16 v[140:143], v[100:103], v[52:55], v[140:143]
  v_mfma_f32_16x16x32_bf16 v[144:147], v[104:107], v[52:55], v[144:147]
  v_mfma_f32_16x16x32_bf16 v[148:151], v[108:111], v[52:55], v[148:151]
  v_mfma_f32_16x16x32_bf16 v[152:155], v[112:115], v[52:55], v[152:155]
  v_mfma_f32_16x16x32_bf16 v[156:159], v[116:119], v[52:55], v[156:159]
  s_waitcnt vmcnt(20)
  s_barrier
  s_add_u32 m0, s51, 81920
  s_add_u32 s46, s66, 450560
  buffer_load_dwordx4 v8, s[4:7], s46 offen lds
  s_add_u32 m0, s51, 86016
  s_add_u32 s46, s66, 450688
  buffer_load_dwordx4 v8, s[4:7], s46 offen lds
  s_add_u32 m0, s51, 90112
  s_add_u32 s46, s66, 450816
  buffer_load_dwordx4 v8, s[4:7], s46 offen lds
  s_add_u32 m0, s51, 94208
  s_add_u32 s46, s66, 450944
  buffer_load_dwordx4 v8, s[4:7], s46 offen lds
  s_add_u32 m0, s51, 98304
  s_add_u32 s46, s66, 451072
  buffer_load_dwordx4 v8, s[4:7], s46 offen lds
  ds_read_b64_tr_b16 v[120:121], v10 offset:36864
  ds_read_b64_tr_b16 v[122:123], v10 offset:37888
  ds_read_b64_tr_b16 v[124:125], v10 offset:40960
  ds_read_b64_tr_b16 v[126:127], v10 offset:41984
  ds_read_b64_tr_b16 v[128:129], v10 offset:45056
  ds_read_b64_tr_b16 v[130:131], v10 offset:46080
  ds_read_b64_tr_b16 v[132:133], v10 offset:49152
  ds_read_b64_tr_b16 v[134:135], v10 offset:50176
  ds_read_b64_tr_b16 v[136:137], v10 offset:53248
  ds_read_b64_tr_b16 v[138:139], v10 offset:54272
  s_waitcnt lgkmcnt(0)
  v_mfma_f32_16x16x32_bf16 v[160:163], v[120:123], v[52:55], v[160:163]
  v_mfma_f32_16x16x32_bf16 v[164:167], v[124:127], v[52:55], v[164:167]
  v_mfma_f32_16x16x32_bf16 v[168:171], v[128:131], v[52:55], v[168:171]
  v_mfma_f32_16x16x32_bf16 v[172:175], v[132:135], v[52:55], v[172:175]
  v_mfma_f32_16x16x32_bf16 v[176:179], v[136:139], v[52:55], v[176:179]
  s_waitcnt vmcnt(20)
  s_barrier
  s_add_u32 m0, s51, 102400
  s_add_u32 s46, s66, 451200
  buffer_load_dwordx4 v8, s[4:7], s46 offen lds
  s_add_u32 m0, s51, 106496
  s_add_u32 s46, s66, 451328
  buffer_load_dwordx4 v8, s[4:7], s46 offen lds
  s_add_u32 m0, s51, 110592
  s_add_u32 s46, s66, 451456
  buffer_load_dwordx4 v8, s[4:7], s46 offen lds
  s_add_u32 m0, s51, 114688
  s_add_u32 s46, s66, 451584
  buffer_load_dwordx4 v8, s[4:7], s46 offen lds
  s_add_u32 m0, s51, 118784
  s_add_u32 s46, s66, 451712
  buffer_load_dwordx4 v8, s[4:7], s46 offen lds
  ds_read_b64_tr_b16 v[100:101], v9 offset:0
  ds_read_b64_tr_b16 v[102:103], v9 offset:1024
  ds_read_b64_tr_b16 v[104:105], v9 offset:4096
  ds_read_b64_tr_b16 v[106:107], v9 offset:5120
  ds_read_b64_tr_b16 v[108:109], v9 offset:8192
  ds_read_b64_tr_b16 v[110:111], v9 offset:9216
  ds_read_b64_tr_b16 v[112:113], v9 offset:12288
  ds_read_b64_tr_b16 v[114:115], v9 offset:13312
  ds_read_b64_tr_b16 v[116:117], v9 offset:16384
  ds_read_b64_tr_b16 v[118:119], v9 offset:17408
  s_waitcnt lgkmcnt(0)
  v_mfma_f32_16x16x32_bf16 v[140:143], v[100:103], v[56:59], v[140:143]
  v_mfma_f32_16x16x32_bf16 v[144:147], v[104:107], v[56:59], v[144:147]
  v_mfma_f32_16x16x32_bf16 v[148:151], v[108:111], v[56:59], v[148:151]
  v_mfma_f32_16x16x32_bf16 v[152:155], v[112:115], v[56:59], v[152:155]
  v_mfma_f32_16x16x32_bf16 v[156:159], v[116:119], v[56:59], v[156:159]
  s_waitcnt vmcnt(20)
  s_barrier
  s_add_u32 m0, s51, 0
  s_add_u32 s46, s66, 491520
  buffer_load_dwordx4 v8, s[4:7], s46 offen lds
  s_add_u32 m0, s51, 4096
  s_add_u32 s46, s66, 491648
  buffer_load_dwordx4 v8, s[4:7], s46 offen lds
  s_add_u32 m0, s51, 8192
  s_add_u32 s46, s66, 491776
  buffer_load_dwordx4 v8, s[4:7], s46 offen lds
  s_add_u32 m0, s51, 12288
  s_add_u32 s46, s66, 491904
  buffer_load_dwordx4 v8, s[4:7], s46 offen lds
  s_add_u32 m0, s51, 16384
  s_add_u32 s46, s66, 492032
  buffer_load_dwordx4 v8, s[4:7], s46 offen lds
  ds_read_b64_tr_b16 v[120:121], v9 offset:20480
  ds_read_b64_tr_b16 v[122:123], v9 offset:21504
  ds_read_b64_tr_b16 v[124:125], v9 offset:24576
  ds_read_b64_tr_b16 v[126:127], v9 offset:25600
  ds_read_b64_tr_b16 v[128:129], v9 offset:28672
  ds_read_b64_tr_b16 v[130:131], v9 offset:29696
  ds_read_b64_tr_b16 v[132:133], v9 offset:32768
  ds_read_b64_tr_b16 v[134:135], v9 offset:33792
  ds_read_b64_tr_b16 v[136:137], v9 offset:36864
  ds_read_b64_tr_b16 v[138:139], v9 offset:37888
  s_waitcnt lgkmcnt(0)
  v_mfma_f32_16x16x32_bf16 v[160:163], v[120:123], v[56:59], v[160:163]
  v_mfma_f32_16x16x32_bf16 v[164:167], v[124:127], v[56:59], v[164:167]
  v_mfma_f32_16x16x32_bf16 v[168:171], v[128:131], v[56:59], v[168:171]
  v_mfma_f32_16x16x32_bf16 v[172:175], v[132:135], v[56:59], v[172:175]
  v_mfma_f32_16x16x32_bf16 v[176:179], v[136:139], v[56:59], v[176:179]
  s_waitcnt vmcnt(20)
  s_barrier
  s_add_u32 m0, s51, 20480
  s_add_u32 s46, s66, 492160
  buffer_load_dwordx4 v8, s[4:7], s46 offen lds
  s_add_u32 m0, s51, 24576
  s_add_u32 s46, s66, 492288
  buffer_load_dwordx4 v8, s[4:7], s46 offen lds
  s_add_u32 m0, s51, 28672
  s_add_u32 s46, s66, 492416
  buffer_load_dwordx4 v8, s[4:7], s46 offen lds
  s_add_u32 m0, s51, 32768
  s_add_u32 s46, s66, 492544
  buffer_load_dwordx4 v8, s[4:7], s46 offen lds
  s_add_u32 m0, s51, 36864
  s_add_u32 s46, s66, 492672
  buffer_load_dwordx4 v8, s[4:7], s46 offen lds
  ds_read_b64_tr_b16 v[100:101], v9 offset:40960
  ds_read_b64_tr_b16 v[102:103], v9 offset:41984
  ds_read_b64_tr_b16 v[104:105], v9 offset:45056
  ds_read_b64_tr_b16 v[106:107], v9 offset:46080
  ds_read_b64_tr_b16 v[108:109], v9 offset:49152
  ds_read_b64_tr_b16 v[110:111], v9 offset:50176
  ds_read_b64_tr_b16 v[112:113], v9 offset:53248
  ds_read_b64_tr_b16 v[114:115], v9 offset:54272
  ds_read_b64_tr_b16 v[116:117], v9 offset:57344
  ds_read_b64_tr_b16 v[118:119], v9 offset:58368
  s_waitcnt lgkmcnt(0)
  v_mfma_f32_16x16x32_bf16 v[140:143], v[100:103], v[60:63], v[140:143]
  v_mfma_f32_16x16x32_bf16 v[144:147], v[104:107], v[60:63], v[144:147]
  v_mfma_f32_16x16x32_bf16 v[148:151], v[108:111], v[60:63], v[148:151]
  v_mfma_f32_16x16x32_bf16 v[152:155], v[112:115], v[60:63], v[152:155]
  v_mfma_f32_16x16x32_bf16 v[156:159], v[116:119], v[60:63], v[156:159]
  s_waitcnt vmcnt(20)
  s_barrier
  s_add_u32 m0, s51, 40960
  s_add_u32 s46, s66, 532480
  buffer_load_dwordx4 v8, s[4:7], s46 offen lds
  s_add_u32 m0, s51, 45056
  s_add_u32 s46, s66, 532608
  buffer_load_dwordx4 v8, s[4:7], s46 offen lds
  s_add_u32 m0, s51, 49152
  s_add_u32 s46, s66, 532736
  buffer_load_dwordx4 v8, s[4:7], s46 offen lds
  s_add_u32 m0, s51, 53248
  s_add_u32 s46, s66, 532864
  buffer_load_dwordx4 v8, s[4:7], s46 offen lds
  s_add_u32 m0, s51, 57344
  s_add_u32 s46, s66, 532992
  buffer_load_dwordx4 v8, s[4:7], s46 offen lds
  ds_read_b64_tr_b16 v[120:121], v9 offset:61440
  ds_read_b64_tr_b16 v[122:123], v9 offset:62464
  ds_read_b64_tr_b16 v[124:125], v10 offset:0
  ds_read_b64_tr_b16 v[126:127], v10 offset:1024
  ds_read_b64_tr_b16 v[128:129], v10 offset:4096
  ds_read_b64_tr_b16 v[130:131], v10 offset:5120
  ds_read_b64_tr_b16 v[132:133], v10 offset:8192
  ds_read_b64_tr_b16 v[134:135], v10 offset:9216
  ds_read_b64_tr_b16 v[136:137], v10 offset:12288
  ds_read_b64_tr_b16 v[138:139], v10 offset:13312
  s_waitcnt lgkmcnt(0)
  v_mfma_f32_16x16x32_bf16 v[160:163], v[120:123], v[60:63], v[160:163]
  v_mfma_f32_16x16x32_bf16 v[164:167], v[124:127], v[60:63], v[164:167]
  v_mfma_f32_16x16x32_bf16 v[168:171], v[128:131], v[60:63], v[168:171]
  v_mfma_f32_16x16x32_bf16 v[172:175], v[132:135], v[60:63], v[172:175]
  v_mfma_f32_16x16x32_bf16 v[176:179], v[136:139], v[60:63], v[176:179]
  s_waitcnt vmcnt(20)
  s_barrier
  s_add_u32 m0, s51, 61440
  s_add_u32 s46, s66, 533120
  buffer_load_dwordx4 v8, s[4:7], s46 offen lds
  s_add_u32 m0, s51, 65536
  s_add_u32 s46, s66, 533248
  buffer_load_dwordx4 v8, s[4:7], s46 offen lds
  s_add_u32 m0, s51, 69632
  s_add_u32 s46, s66, 533376
  buffer_load_dwordx4 v8, s[4:7], s46 offen lds
  s_add_u32 m0, s51, 73728
  s_add_u32 s46, s66, 533504
  buffer_load_dwordx4 v8, s[4:7], s46 offen lds
  s_add_u32 m0, s51, 77824
  s_add_u32 s46, s66, 533632
  buffer_load_dwordx4 v8, s[4:7], s46 offen lds
  ds_read_b64_tr_b16 v[100:101], v10 offset:16384
  ds_read_b64_tr_b16 v[102:103], v10 offset:17408
  ds_read_b64_tr_b16 v[104:105], v10 offset:20480
  ds_read_b64_tr_b16 v[106:107], v10 offset:21504
  ds_read_b64_tr_b16 v[108:109], v10 offset:24576
  ds_read_b64_tr_b16 v[110:111], v10 offset:25600
  ds_read_b64_tr_b16 v[112:113], v10 offset:28672
  ds_read_b64_tr_b16 v[114:115], v10 offset:29696
  ds_read_b64_tr_b16 v[116:117], v10 offset:32768
  ds_read_b64_tr_b16 v[118:119], v10 offset:33792
  s_waitcnt lgkmcnt(0)
  v_mfma_f32_16x16x32_bf16 v[140:143], v[100:103], v[64:67], v[140:143]
  v_mfma_f32_16x16x32_bf16 v[144:147], v[104:107], v[64:67], v[144:147]
  v_mfma_f32_16x16x32_bf16 v[148:151], v[108:111], v[64:67], v[148:151]
  v_mfma_f32_16x16x32_bf16 v[152:155], v[112:115], v[64:67], v[152:155]
  v_mfma_f32_16x16x32_bf16 v[156:159], v[116:119], v[64:67], v[156:159]
  s_waitcnt vmcnt(20)
  s_barrier
  s_add_u32 m0, s51, 81920
  s_add_u32 s46, s66, 573440
  buffer_load_dwordx4 v8, s[4:7], s46 offen lds
  s_add_u32 m0, s51, 86016
  s_add_u32 s46, s66, 573568
  buffer_load_dwordx4 v8, s[4:7], s46 offen lds
  s_add_u32 m0, s51, 90112
  s_add_u32 s46, s66, 573696
  buffer_load_dwordx4 v8, s[4:7], s46 offen lds
  s_add_u32 m0, s51, 94208
  s_add_u32 s46, s66, 573824
  buffer_load_dwordx4 v8, s[4:7], s46 offen lds
  s_add_u32 m0, s51, 98304
  s_add_u32 s46, s66, 573952
  buffer_load_dwordx4 v8, s[4:7], s46 offen lds
  ds_read_b64_tr_b16 v[120:121], v10 offset:36864
  ds_read_b64_tr_b16 v[122:123], v10 offset:37888
  ds_read_b64_tr_b16 v[124:125], v10 offset:40960
  ds_read_b64_tr_b16 v[126:127], v10 offset:41984
  ds_read_b64_tr_b16 v[128:129], v10 offset:45056
  ds_read_b64_tr_b16 v[130:131], v10 offset:46080
  ds_read_b64_tr_b16 v[132:133], v10 offset:49152
  ds_read_b64_tr_b16 v[134:135], v10 offset:50176
  ds_read_b64_tr_b16 v[136:137], v10 offset:53248
  ds_read_b64_tr_b16 v[138:139], v10 offset:54272
  s_waitcnt lgkmcnt(0)
  v_mfma_f32_16x16x32_bf16 v[160:163], v[120:123], v[64:67], v[160:163]
  v_mfma_f32_16x16x32_bf16 v[164:167], v[124:127], v[64:67], v[164:167]
  v_mfma_f32_16x16x32_bf16 v[168:171], v[128:131], v[64:67], v[168:171]
  v_mfma_f32_16x16x32_bf16 v[172:175], v[132:135], v[64:67], v[172:175]
  v_mfma_f32_16x16x32_bf16 v[176:179], v[136:139], v[64:67], v[176:179]
  s_waitcnt vmcnt(20)
  s_barrier
  s_add_u32 m0, s51, 102400
  s_add_u32 s46, s66, 574080
  buffer_load_dwordx4 v8, s[4:7], s46 offen lds
  s_add_u32 m0, s51, 106496
  s_add_u32 s46, s66, 574208
  buffer_load_dwordx4 v8, s[4:7], s46 offen lds
  s_add_u32 m0, s51, 110592
  s_add_u32 s46, s66, 574336
  buffer_load_dwordx4 v8, s[4:7], s46 offen lds
  s_add_u32 m0, s51, 114688
  s_add_u32 s46, s66, 574464
  buffer_load_dwordx4 v8, s[4:7], s46 offen lds
  s_add_u32 m0, s51, 118784
  s_add_u32 s46, s66, 574592
  buffer_load_dwordx4 v8, s[4:7], s46 offen lds
  ds_read_b64_tr_b16 v[100:101], v9 offset:0
  ds_read_b64_tr_b16 v[102:103], v9 offset:1024
  ds_read_b64_tr_b16 v[104:105], v9 offset:4096
  ds_read_b64_tr_b16 v[106:107], v9 offset:5120
  ds_read_b64_tr_b16 v[108:109], v9 offset:8192
  ds_read_b64_tr_b16 v[110:111], v9 offset:9216
  ds_read_b64_tr_b16 v[112:113], v9 offset:12288
  ds_read_b64_tr_b16 v[114:115], v9 offset:13312
  ds_read_b64_tr_b16 v[116:117], v9 offset:16384
  ds_read_b64_tr_b16 v[118:119], v9 offset:17408
  s_waitcnt lgkmcnt(0)
  v_mfma_f32_16x16x32_bf16 v[140:143], v[100:103], v[68:71], v[140:143]
  v_mfma_f32_16x16x32_bf16 v[144:147], v[104:107], v[68:71], v[144:147]
  v_mfma_f32_16x16x32_bf16 v[148:151], v[108:111], v[68:71], v[148:151]
  v_mfma_f32_16x16x32_bf16 v[152:155], v[112:115], v[68:71], v[152:155]
  v_mfma_f32_16x16x32_bf16 v[156:159], v[116:119], v[68:71], v[156:159]
  s_waitcnt vmcnt(20)
  s_barrier
  s_add_u32 m0, s51, 0
  s_add_u32 s46, s66, 614400
  buffer_load_dwordx4 v8, s[4:7], s46 offen lds
  s_add_u32 m0, s51, 4096
  s_add_u32 s46, s66, 614528
  buffer_load_dwordx4 v8, s[4:7], s46 offen lds
  s_add_u32 m0, s51, 8192
  s_add_u32 s46, s66, 614656
  buffer_load_dwordx4 v8, s[4:7], s46 offen lds
  s_add_u32 m0, s51, 12288
  s_add_u32 s46, s66, 614784
  buffer_load_dwordx4 v8, s[4:7], s46 offen lds
  s_add_u32 m0, s51, 16384
  s_add_u32 s46, s66, 614912
  buffer_load_dwordx4 v8, s[4:7], s46 offen lds
  ds_read_b64_tr_b16 v[120:121], v9 offset:20480
  ds_read_b64_tr_b16 v[122:123], v9 offset:21504
  ds_read_b64_tr_b16 v[124:125], v9 offset:24576
  ds_read_b64_tr_b16 v[126:127], v9 offset:25600
  ds_read_b64_tr_b16 v[128:129], v9 offset:28672
  ds_read_b64_tr_b16 v[130:131], v9 offset:29696
  ds_read_b64_tr_b16 v[132:133], v9 offset:32768
  ds_read_b64_tr_b16 v[134:135], v9 offset:33792
  ds_read_b64_tr_b16 v[136:137], v9 offset:36864
  ds_read_b64_tr_b16 v[138:139], v9 offset:37888
  s_waitcnt lgkmcnt(0)
  v_mfma_f32_16x16x32_bf16 v[160:163], v[120:123], v[68:71], v[160:163]
  v_mfma_f32_16x16x32_bf16 v[164:167], v[124:127], v[68:71], v[164:167]
  v_mfma_f32_16x16x32_bf16 v[168:171], v[128:131], v[68:71], v[168:171]
  v_mfma_f32_16x16x32_bf16 v[172:175], v[132:135], v[68:71], v[172:175]
  v_mfma_f32_16x16x32_bf16 v[176:179], v[136:139], v[68:71], v[176:179]
  s_waitcnt vmcnt(20)
  s_barrier
  s_add_u32 m0, s51, 20480
  s_add_u32 s46, s66, 615040
  buffer_load_dwordx4 v8, s[4:7], s46 offen lds
  s_add_u32 m0, s51, 24576
  s_add_u32 s46, s66, 615168
  buffer_load_dwordx4 v8, s[4:7], s46 offen lds
  s_add_u32 m0, s51, 28672
  s_add_u32 s46, s66, 615296
  buffer_load_dwordx4 v8, s[4:7], s46 offen lds
  s_add_u32 m0, s51, 32768
  s_add_u32 s46, s66, 615424
  buffer_load_dwordx4 v8, s[4:7], s46 offen lds
  s_add_u32 m0, s51, 36864
  s_add_u32 s46, s66, 615552
  buffer_load_dwordx4 v8, s[4:7], s46 offen lds
  ds_read_b64_tr_b16 v[100:101], v9 offset:40960
  ds_read_b64_tr_b16 v[102:103], v9 offset:41984
  ds_read_b64_tr_b16 v[104:105], v9 offset:45056
  ds_read_b64_tr_b16 v[106:107], v9 offset:46080
  ds_read_b64_tr_b16 v[108:109], v9 offset:49152
  ds_read_b64_tr_b16 v[110:111], v9 offset:50176
  ds_read_b64_tr_b16 v[112:113], v9 offset:53248
  ds_read_b64_tr_b16 v[114:115], v9 offset:54272
  ds_read_b64_tr_b16 v[116:117], v9 offset:57344
  ds_read_b64_tr_b16 v[118:119], v9 offset:58368
  s_waitcnt lgkmcnt(0)
  v_mfma_f32_16x16x32_bf16 v[140:143], v[100:103], v[72:75], v[140:143]
  v_mfma_f32_16x16x32_bf16 v[144:147], v[104:107], v[72:75], v[144:147]
  v_mfma_f32_16x16x32_bf16 v[148:151], v[108:111], v[72:75], v[148:151]
  v_mfma_f32_16x16x32_bf16 v[152:155], v[112:115], v[72:75], v[152:155]
  v_mfma_f32_16x16x32_bf16 v[156:159], v[116:119], v[72:75], v[156:159]
  s_waitcnt vmcnt(20)
  s_barrier
  s_add_u32 m0, s51, 40960
  s_add_u32 s46, s66, 655360
  buffer_load_dwordx4 v8, s[4:7], s46 offen lds
  s_add_u32 m0, s51, 45056
  s_add_u32 s46, s66, 655488
  buffer_load_dwordx4 v8, s[4:7], s46 offen lds
  s_add_u32 m0, s51, 49152
  s_add_u32 s46, s66, 655616
  buffer_load_dwordx4 v8, s[4:7], s46 offen lds
  s_add_u32 m0, s51, 53248
  s_add_u32 s46, s66, 655744
  buffer_load_dwordx4 v8, s[4:7], s46 offen lds
  s_add_u32 m0, s51, 57344
  s_add_u32 s46, s66, 655872
  buffer_load_dwordx4 v8, s[4:7], s46 offen lds
  ds_read_b64_tr_b16 v[120:121], v9 offset:61440
  ds_read_b64_tr_b16 v[122:123], v9 offset:62464
  ds_read_b64_tr_b16 v[124:125], v10 offset:0
  ds_read_b64_tr_b16 v[126:127], v10 offset:1024
  ds_read_b64_tr_b16 v[128:129], v10 offset:4096
  ds_read_b64_tr_b16 v[130:131], v10 offset:5120
  ds_read_b64_tr_b16 v[132:133], v10 offset:8192
  ds_read_b64_tr_b16 v[134:135], v10 offset:9216
  ds_read_b64_tr_b16 v[136:137], v10 offset:12288
  ds_read_b64_tr_b16 v[138:139], v10 offset:13312
  s_waitcnt lgkmcnt(0)
  v_mfma_f32_16x16x32_bf16 v[160:163], v[120:123], v[72:75], v[160:163]
  v_mfma_f32_16x16x32_bf16 v[164:167], v[124:127], v[72:75], v[164:167]
  v_mfma_f32_16x16x32_bf16 v[168:171], v[128:131], v[72:75], v[168:171]
  v_mfma_f32_16x16x32_bf16 v[172:175], v[132:135], v[72:75], v[172:175]
  v_mfma_f32_16x16x32_bf16 v[176:179], v[136:139], v[72:75], v[176:179]
  s_waitcnt vmcnt(20)
  s_barrier
  s_add_u32 m0, s51, 61440
  s_add_u32 s46, s66, 656000
  buffer_load_dwordx4 v8, s[4:7], s46 offen lds
  s_add_u32 m0, s51, 65536
  s_add_u32 s46, s66, 656128
  buffer_load_dwordx4 v8, s[4:7], s46 offen lds
  s_add_u32 m0, s51, 69632
  s_add_u32 s46, s66, 656256
  buffer_load_dwordx4 v8, s[4:7], s46 offen lds
  s_add_u32 m0, s51, 73728
  s_add_u32 s46, s66, 656384
  buffer_load_dwordx4 v8, s[4:7], s46 offen lds
  s_add_u32 m0, s51, 77824
  s_add_u32 s46, s66, 656512
  buffer_load_dwordx4 v8, s[4:7], s46 offen lds
  ds_read_b64_tr_b16 v[100:101], v10 offset:16384
  ds_read_b64_tr_b16 v[102:103], v10 offset:17408
  ds_read_b64_tr_b16 v[104:105], v10 offset:20480
  ds_read_b64_tr_b16 v[106:107], v10 offset:21504
  ds_read_b64_tr_b16 v[108:109], v10 offset:24576
  ds_read_b64_tr_b16 v[110:111], v10 offset:25600
  ds_read_b64_tr_b16 v[112:113], v10 offset:28672
  ds_read_b64_tr_b16 v[114:115], v10 offset:29696
  ds_read_b64_tr_b16 v[116:117], v10 offset:32768
  ds_read_b64_tr_b16 v[118:119], v10 offset:33792
  s_waitcnt lgkmcnt(0)
  v_mfma_f32_16x16x32_bf16 v[140:143], v[100:103], v[76:79], v[140:143]
  v_mfma_f32_16x16x32_bf16 v[144:147], v[104:107], v[76:79], v[144:147]
  v_mfma_f32_16x16x32_bf16 v[148:151], v[108:111], v[76:79], v[148:151]
  v_mfma_f32_16x16x32_bf16 v[152:155], v[112:115], v[76:79], v[152:155]
  v_mfma_f32_16x16x32_bf16 v[156:159], v[116:119], v[76:79], v[156:159]
  s_waitcnt vmcnt(20)
  s_barrier
  s_add_u32 m0, s51, 81920
  s_add_u32 s46, s66, 696320
  buffer_load_dwordx4 v8, s[4:7], s46 offen lds
  s_add_u32 m0, s51, 86016
  s_add_u32 s46, s66, 696448
  buffer_load_dwordx4 v8, s[4:7], s46 offen lds
  s_add_u32 m0, s51, 90112
  s_add_u32 s46, s66, 696576
  buffer_load_dwordx4 v8, s[4:7], s46 offen lds
  s_add_u32 m0, s51, 94208
  s_add_u32 s46, s66, 696704
  buffer_load_dwordx4 v8, s[4:7], s46 offen lds
  s_add_u32 m0, s51, 98304
  s_add_u32 s46, s66, 696832
  buffer_load_dwordx4 v8, s[4:7], s46 offen lds
  ds_read_b64_tr_b16 v[120:121], v10 offset:36864
  ds_read_b64_tr_b16 v[122:123], v10 offset:37888
  ds_read_b64_tr_b16 v[124:125], v10 offset:40960
  ds_read_b64_tr_b16 v[126:127], v10 offset:41984
  ds_read_b64_tr_b16 v[128:129], v10 offset:45056
  ds_read_b64_tr_b16 v[130:131], v10 offset:46080
  ds_read_b64_tr_b16 v[132:133], v10 offset:49152
  ds_read_b64_tr_b16 v[134:135], v10 offset:50176
  ds_read_b64_tr_b16 v[136:137], v10 offset:53248
  ds_read_b64_tr_b16 v[138:139], v10 offset:54272
  s_waitcnt lgkmcnt(0)
  v_mfma_f32_16x16x32_bf16 v[160:163], v[120:123], v[76:79], v[160:163]
  v_mfma_f32_16x16x32_bf16 v[164:167], v[124:127], v[76:79], v[164:167]
  v_mfma_f32_16x16x32_bf16 v[168:171], v[128:131], v[76:79], v[168:171]
  v_mfma_f32_16x16x32_bf16 v[172:175], v[132:135], v[76:79], v[172:175]
  v_mfma_f32_16x16x32_bf16 v[176:179], v[136:139], v[76:79], v[176:179]
  s_waitcnt vmcnt(20)
  s_barrier
  s_add_u32 m0, s51, 102400
  s_add_u32 s46, s66, 696960
  buffer_load_dwordx4 v8, s[4:7], s46 offen lds
  s_add_u32 m0, s51, 106496
  s_add_u32 s46, s66, 697088
  buffer_load_dwordx4 v8, s[4:7], s46 offen lds
  s_add_u32 m0, s51, 110592
  s_add_u32 s46, s66, 697216
  buffer_load_dwordx4 v8, s[4:7], s46 offen lds
  s_add_u32 m0, s51, 114688
  s_add_u32 s46, s66, 697344
  buffer_load_dwordx4 v8, s[4:7], s46 offen lds
  s_add_u32 m0, s51, 118784
  s_add_u32 s46, s66, 697472
  buffer_load_dwordx4 v8, s[4:7], s46 offen lds
  ds_read_b64_tr_b16 v[100:101], v9 offset:0
  ds_read_b64_tr_b16 v[102:103], v9 offset:1024
  ds_read_b64_tr_b16 v[104:105], v9 offset:4096
  ds_read_b64_tr_b16 v[106:107], v9 offset:5120
  ds_read_b64_tr_b16 v[108:109], v9 offset:8192
  ds_read_b64_tr_b16 v[110:111], v9 offset:9216
  ds_read_b64_tr_b16 v[112:113], v9 offset:12288
  ds_read_b64_tr_b16 v[114:115], v9 offset:13312
  ds_read_b64_tr_b16 v[116:117], v9 offset:16384
  ds_read_b64_tr_b16 v[118:119], v9 offset:17408
  s_waitcnt lgkmcnt(0)
  v_mfma_f32_16x16x32_bf16 v[140:143], v[100:103], v[80:83], v[140:143]
  v_mfma_f32_16x16x32_bf16 v[144:147], v[104:107], v[80:83], v[144:147]
  v_mfma_f32_16x16x32_bf16 v[148:151], v[108:111], v[80:83], v[148:151]
  v_mfma_f32_16x16x32_bf16 v[152:155], v[112:115], v[80:83], v[152:155]
  v_mfma_f32_16x16x32_bf16 v[156:159], v[116:119], v[80:83], v[156:159]
  s_waitcnt vmcnt(20)
  s_barrier
  s_add_u32 m0, s51, 0
  s_add_u32 s46, s66, 737280
  buffer_load_dwordx4 v8, s[4:7], s46 offen lds
  s_add_u32 m0, s51, 4096
  s_add_u32 s46, s66, 737408
  buffer_load_dwordx4 v8, s[4:7], s46 offen lds
  s_add_u32 m0, s51, 8192
  s_add_u32 s46, s66, 737536
  buffer_load_dwordx4 v8, s[4:7], s46 offen lds
  s_add_u32 m0, s51, 12288
  s_add_u32 s46, s66, 737664
  buffer_load_dwordx4 v8, s[4:7], s46 offen lds
  s_add_u32 m0, s51, 16384
  s_add_u32 s46, s66, 737792
  buffer_load_dwordx4 v8, s[4:7], s46 offen lds
  ds_read_b64_tr_b16 v[120:121], v9 offset:20480
  ds_read_b64_tr_b16 v[122:123], v9 offset:21504
  ds_read_b64_tr_b16 v[124:125], v9 offset:24576
  ds_read_b64_tr_b16 v[126:127], v9 offset:25600
  ds_read_b64_tr_b16 v[128:129], v9 offset:28672
  ds_read_b64_tr_b16 v[130:131], v9 offset:29696
  ds_read_b64_tr_b16 v[132:133], v9 offset:32768
  ds_read_b64_tr_b16 v[134:135], v9 offset:33792
  ds_read_b64_tr_b16 v[136:137], v9 offset:36864
  ds_read_b64_tr_b16 v[138:139], v9 offset:37888
  s_waitcnt lgkmcnt(0)
  v_mfma_f32_16x16x32_bf16 v[160:163], v[120:123], v[80:83], v[160:163]
  v_mfma_f32_16x16x32_bf16 v[164:167], v[124:127], v[80:83], v[164:167]
  v_mfma_f32_16x16x32_bf16 v[168:171], v[128:131], v[80:83], v[168:171]
  v_mfma_f32_16x16x32_bf16 v[172:175], v[132:135], v[80:83], v[172:175]
  v_mfma_f32_16x16x32_bf16 v[176:179], v[136:139], v[80:83], v[176:179]
  s_waitcnt vmcnt(20)
  s_barrier
  s_add_u32 m0, s51, 20480
  s_add_u32 s46, s66, 737920
  buffer_load_dwordx4 v8, s[4:7], s46 offen lds
  s_add_u32 m0, s51, 24576
  s_add_u32 s46, s66, 738048
  buffer_load_dwordx4 v8, s[4:7], s46 offen lds
  s_add_u32 m0, s51, 28672
  s_add_u32 s46, s66, 738176
  buffer_load_dwordx4 v8, s[4:7], s46 offen lds
  s_add_u32 m0, s51, 32768
  s_add_u32 s46, s66, 738304
  buffer_load_dwordx4 v8, s[4:7], s46 offen lds
  s_add_u32 m0, s51, 36864
  s_add_u32 s46, s66, 738432
  buffer_load_dwordx4 v8, s[4:7], s46 offen lds
  ds_read_b64_tr_b16 v[100:101], v9 offset:40960
  ds_read_b64_tr_b16 v[102:103], v9 offset:41984
  ds_read_b64_tr_b16 v[104:105], v9 offset:45056
  ds_read_b64_tr_b16 v[106:107], v9 offset:46080
  ds_read_b64_tr_b16 v[108:109], v9 offset:49152
  ds_read_b64_tr_b16 v[110:111], v9 offset:50176
  ds_read_b64_tr_b16 v[112:113], v9 offset:53248
  ds_read_b64_tr_b16 v[114:115], v9 offset:54272
  ds_read_b64_tr_b16 v[116:117], v9 offset:57344
  ds_read_b64_tr_b16 v[118:119], v9 offset:58368
  s_waitcnt lgkmcnt(0)
  v_mfma_f32_16x16x32_bf16 v[140:143], v[100:103], v[84:87], v[140:143]
  v_mfma_f32_16x16x32_bf16 v[144:147], v[104:107], v[84:87], v[144:147]
  v_mfma_f32_16x16x32_bf16 v[148:151], v[108:111], v[84:87], v[148:151]
  v_mfma_f32_16x16x32_bf16 v[152:155], v[112:115], v[84:87], v[152:155]
  v_mfma_f32_16x16x32_bf16 v[156:159], v[116:119], v[84:87], v[156:159]
  s_waitcnt vmcnt(20)
  s_barrier
  s_add_u32 m0, s51, 40960
  s_add_u32 s46, s66, 778240
  buffer_load_dwordx4 v8, s[4:7], s46 offen lds
  s_add_u32 m0, s51, 45056
  s_add_u32 s46, s66, 778368
  buffer_load_dwordx4 v8, s[4:7], s46 offen lds
  s_add_u32 m0, s51, 49152
  s_add_u32 s46, s66, 778496
  buffer_load_dwordx4 v8, s[4:7], s46 offen lds
  s_add_u32 m0, s51, 53248
  s_add_u32 s46, s66, 778624
  buffer_load_dwordx4 v8, s[4:7], s46 offen lds
  s_add_u32 m0, s51, 57344
  s_add_u32 s46, s66, 778752
  buffer_load_dwordx4 v8, s[4:7], s46 offen lds
  ds_read_b64_tr_b16 v[120:121], v9 offset:61440
  ds_read_b64_tr_b16 v[122:123], v9 offset:62464
  ds_read_b64_tr_b16 v[124:125], v10 offset:0
  ds_read_b64_tr_b16 v[126:127], v10 offset:1024
  ds_read_b64_tr_b16 v[128:129], v10 offset:4096
  ds_read_b64_tr_b16 v[130:131], v10 offset:5120
  ds_read_b64_tr_b16 v[132:133], v10 offset:8192
  ds_read_b64_tr_b16 v[134:135], v10 offset:9216
  ds_read_b64_tr_b16 v[136:137], v10 offset:12288
  ds_read_b64_tr_b16 v[138:139], v10 offset:13312
  s_waitcnt lgkmcnt(0)
  v_mfma_f32_16x16x32_bf16 v[160:163], v[120:123], v[84:87], v[160:163]
  v_mfma_f32_16x16x32_bf16 v[164:167], v[124:127], v[84:87], v[164:167]
  v_mfma_f32_16x16x32_bf16 v[168:171], v[128:131], v[84:87], v[168:171]
  v_mfma_f32_16x16x32_bf16 v[172:175], v[132:135], v[84:87], v[172:175]
  v_mfma_f32_16x16x32_bf16 v[176:179], v[136:139], v[84:87], v[176:179]
  s_waitcnt vmcnt(20)
  s_barrier
  s_add_u32 m0, s51, 61440
  s_add_u32 s46, s66, 778880
  buffer_load_dwordx4 v8, s[4:7], s46 offen lds
  s_add_u32 m0, s51, 65536
  s_add_u32 s46, s66, 779008
  buffer_load_dwordx4 v8, s[4:7], s46 offen lds
  s_add_u32 m0, s51, 69632
  s_add_u32 s46, s66, 779136
  buffer_load_dwordx4 v8, s[4:7], s46 offen lds
  s_add_u32 m0, s51, 73728
  s_add_u32 s46, s66, 779264
  buffer_load_dwordx4 v8, s[4:7], s46 offen lds
  s_add_u32 m0, s51, 77824
  s_add_u32 s46, s66, 779392
  buffer_load_dwordx4 v8, s[4:7], s46 offen lds
  ds_read_b64_tr_b16 v[100:101], v10 offset:16384
  ds_read_b64_tr_b16 v[102:103], v10 offset:17408
  ds_read_b64_tr_b16 v[104:105], v10 offset:20480
  ds_read_b64_tr_b16 v[106:107], v10 offset:21504
  ds_read_b64_tr_b16 v[108:109], v10 offset:24576
  ds_read_b64_tr_b16 v[110:111], v10 offset:25600
  ds_read_b64_tr_b16 v[112:113], v10 offset:28672
  ds_read_b64_tr_b16 v[114:115], v10 offset:29696
  ds_read_b64_tr_b16 v[116:117], v10 offset:32768
  ds_read_b64_tr_b16 v[118:119], v10 offset:33792
  s_waitcnt lgkmcnt(0)
  v_mfma_f32_16x16x32_bf16 v[140:143], v[100:103], v[88:91], v[140:143]
  v_mfma_f32_16x16x32_bf16 v[144:147], v[104:107], v[88:91], v[144:147]
  v_mfma_f32_16x16x32_bf16 v[148:151], v[108:111], v[88:91], v[148:151]
  v_mfma_f32_16x16x32_bf16 v[152:155], v[112:115], v[88:91], v[152:155]
  v_mfma_f32_16x16x32_bf16 v[156:159], v[116:119], v[88:91], v[156:159]
  s_waitcnt vmcnt(20)
  s_barrier
  ds_read_b64_tr_b16 v[120:121], v10 offset:36864
  ds_read_b64_tr_b16 v[122:123], v10 offset:37888
  ds_read_b64_tr_b16 v[124:125], v10 offset:40960
  ds_read_b64_tr_b16 v[126:127], v10 offset:41984
  ds_read_b64_tr_b16 v[128:129], v10 offset:45056
  ds_read_b64_tr_b16 v[130:131], v10 offset:46080
  ds_read_b64_tr_b16 v[132:133], v10 offset:49152
  ds_read_b64_tr_b16 v[134:135], v10 offset:50176
  ds_read_b64_tr_b16 v[136:137], v10 offset:53248
  ds_read_b64_tr_b16 v[138:139], v10 offset:54272
  s_waitcnt lgkmcnt(0)
  v_mfma_f32_16x16x32_bf16 v[160:163], v[120:123], v[88:91], v[160:163]
  v_mfma_f32_16x16x32_bf16 v[164:167], v[124:127], v[88:91], v[164:167]
  v_mfma_f32_16x16x32_bf16 v[168:171], v[128:131], v[88:91], v[168:171]
  v_mfma_f32_16x16x32_bf16 v[172:175], v[132:135], v[88:91], v[172:175]
  v_mfma_f32_16x16x32_bf16 v[176:179], v[136:139], v[88:91], v[176:179]
  s_waitcnt vmcnt(15)
  s_barrier
  ds_read_b64_tr_b16 v[100:101], v9 offset:0
  ds_read_b64_tr_b16 v[102:103], v9 offset:1024
  ds_read_b64_tr_b16 v[104:105], v9 offset:4096
  ds_read_b64_tr_b16 v[106:107], v9 offset:5120
  ds_read_b64_tr_b16 v[108:109], v9 offset:8192
  ds_read_b64_tr_b16 v[110:111], v9 offset:9216
  ds_read_b64_tr_b16 v[112:113], v9 offset:12288
  ds_read_b64_tr_b16 v[114:115], v9 offset:13312
  ds_read_b64_tr_b16 v[116:117], v9 offset:16384
  ds_read_b64_tr_b16 v[118:119], v9 offset:17408
  s_waitcnt lgkmcnt(0)
  v_mfma_f32_16x16x32_bf16 v[140:143], v[100:103], v[92:95], v[140:143]
  v_mfma_f32_16x16x32_bf16 v[144:147], v[104:107], v[92:95], v[144:147]
  v_mfma_f32_16x16x32_bf16 v[148:151], v[108:111], v[92:95], v[148:151]
  v_mfma_f32_16x16x32_bf16 v[152:155], v[112:115], v[92:95], v[152:155]
  v_mfma_f32_16x16x32_bf16 v[156:159], v[116:119], v[92:95], v[156:159]
  s_waitcnt vmcnt(10)
  s_barrier
  ds_read_b64_tr_b16 v[120:121], v9 offset:20480
  ds_read_b64_tr_b16 v[122:123], v9 offset:21504
  ds_read_b64_tr_b16 v[124:125], v9 offset:24576
  ds_read_b64_tr_b16 v[126:127], v9 offset:25600
  ds_read_b64_tr_b16 v[128:129], v9 offset:28672
  ds_read_b64_tr_b16 v[130:131], v9 offset:29696
  ds_read_b64_tr_b16 v[132:133], v9 offset:32768
  ds_read_b64_tr_b16 v[134:135], v9 offset:33792
  ds_read_b64_tr_b16 v[136:137], v9 offset:36864
  ds_read_b64_tr_b16 v[138:139], v9 offset:37888
  s_waitcnt lgkmcnt(0)
  v_mfma_f32_16x16x32_bf16 v[160:163], v[120:123], v[92:95], v[160:163]
  v_mfma_f32_16x16x32_bf16 v[164:167], v[124:127], v[92:95], v[164:167]
  v_mfma_f32_16x16x32_bf16 v[168:171], v[128:131], v[92:95], v[168:171]
  v_mfma_f32_16x16x32_bf16 v[172:175], v[132:135], v[92:95], v[172:175]
  v_mfma_f32_16x16x32_bf16 v[176:179], v[136:139], v[92:95], v[176:179]
  s_waitcnt vmcnt(5)
  s_barrier
  ds_read_b64_tr_b16 v[100:101], v9 offset:40960
  ds_read_b64_tr_b16 v[102:103], v9 offset:41984
  ds_read_b64_tr_b16 v[104:105], v9 offset:45056
  ds_read_b64_tr_b16 v[106:107], v9 offset:46080
  ds_read_b64_tr_b16 v[108:109], v9 offset:49152
  ds_read_b64_tr_b16 v[110:111], v9 offset:50176
  ds_read_b64_tr_b16 v[112:113], v9 offset:53248
  ds_read_b64_tr_b16 v[114:115], v9 offset:54272
  ds_read_b64_tr_b16 v[116:117], v9 offset:57344
  ds_read_b64_tr_b16 v[118:119], v9 offset:58368
  s_waitcnt lgkmcnt(0)
  v_mfma_f32_16x16x32_bf16 v[140:143], v[100:103], v[96:99], v[140:143]
  v_mfma_f32_16x16x32_bf16 v[144:147], v[104:107], v[96:99], v[144:147]
  v_mfma_f32_16x16x32_bf16 v[148:151], v[108:111], v[96:99], v[148:151]
  v_mfma_f32_16x16x32_bf16 v[152:155], v[112:115], v[96:99], v[152:155]
  v_mfma_f32_16x16x32_bf16 v[156:159], v[116:119], v[96:99], v[156:159]
  s_waitcnt vmcnt(0)
  s_barrier
  ds_read_b64_tr_b16 v[120:121], v9 offset:61440
  ds_read_b64_tr_b16 v[122:123], v9 offset:62464
  ds_read_b64_tr_b16 v[124:125], v10 offset:0
  ds_read_b64_tr_b16 v[126:127], v10 offset:1024
  ds_read_b64_tr_b16 v[128:129], v10 offset:4096
  ds_read_b64_tr_b16 v[130:131], v10 offset:5120
  ds_read_b64_tr_b16 v[132:133], v10 offset:8192
  ds_read_b64_tr_b16 v[134:135], v10 offset:9216
  ds_read_b64_tr_b16 v[136:137], v10 offset:12288
  ds_read_b64_tr_b16 v[138:139], v10 offset:13312
  s_waitcnt lgkmcnt(0)
  v_mfma_f32_16x16x32_bf16 v[160:163], v[120:123], v[96:99], v[160:163]
  v_mfma_f32_16x16x32_bf16 v[164:167], v[124:127], v[96:99], v[164:167]
  v_mfma_f32_16x16x32_bf16 v[168:171], v[128:131], v[96:99], v[168:171]
  v_mfma_f32_16x16x32_bf16 v[172:175], v[132:135], v[96:99], v[172:175]
  v_mfma_f32_16x16x32_bf16 v[176:179], v[136:139], v[96:99], v[176:179]
  s_barrier
  v_cvt_pk_bf16_f32 v140, v140, v141
  v_cvt_pk_bf16_f32 v141, v142, v143
  buffer_store_dwordx2 v[140:141], v12, s[12:15], 0 offen offset:0
  v_cvt_pk_bf16_f32 v144, v144, v145
  v_cvt_pk_bf16_f32 v145, v146, v147
  buffer_store_dwordx2 v[144:145], v12, s[12:15], 0 offen offset:128
  v_cvt_pk_bf16_f32 v148, v148, v149
  v_cvt_pk_bf16_f32 v149, v150, v151
  buffer_store_dwordx2 v[148:149], v12, s[12:15], 0 offen offset:256
  v_cvt_pk_bf16_f32 v152, v152, v153
  v_cvt_pk_bf16_f32 v153, v154, v155
  buffer_store_dwordx2 v[152:153], v12, s[12:15], 0 offen offset:384
  v_cvt_pk_bf16_f32 v156, v156, v157
  v_cvt_pk_bf16_f32 v157, v158, v159
  buffer_store_dwordx2 v[156:157], v12, s[12:15], 0 offen offset:512
  v_cvt_pk_bf16_f32 v160, v160, v161
  v_cvt_pk_bf16_f32 v161, v162, v163
  buffer_store_dwordx2 v[160:161], v12, s[12:15], 0 offen offset:640
  v_cvt_pk_bf16_f32 v164, v164, v165
  v_cvt_pk_bf16_f32 v165, v166, v167
  buffer_store_dwordx2 v[164:165], v12, s[12:15], 0 offen offset:768
  v_cvt_pk_bf16_f32 v168, v168, v169
  v_cvt_pk_bf16_f32 v169, v170, v171
  buffer_store_dwordx2 v[168:169], v12, s[12:15], 0 offen offset:896
  v_cvt_pk_bf16_f32 v172, v172, v173
  v_cvt_pk_bf16_f32 v173, v174, v175
  buffer_store_dwordx2 v[172:173], v12, s[12:15], 0 offen offset:1024
  v_cvt_pk_bf16_f32 v176, v176, v177
  v_cvt_pk_bf16_f32 v177, v178, v179
  buffer_store_dwordx2 v[176:177], v12, s[12:15], 0 offen offset:1152
  s_endpgm
L_recur:
  s_or_b32 s67, s44, s42
  s_cmp_lt_u32 s44, 8
  s_cbranch_scc1 L_score
  s_cmp_lt_u32 s44, 16
  s_cbranch_scc1 L_value
  s_cmp_lt_u32 s44, 26
  s_cbranch_scc1 L_owner
  s_branch L_xowner
L_score:
  s_mov_b32 s4, s26
  s_mov_b32 s5, s27
  s_mov_b32 s6, 7864320
  s_mov_b32 s7, 0x20000
  s_mov_b32 s12, s28
  s_mov_b32 s13, s29
  s_mov_b32 s14, 7864320
  s_mov_b32 s15, 0x20000
  v_lshrrev_b32 v136, 3, v0
  v_lshrrev_b32 v137, 2, v136
  v_lshlrev_b32 v137, 3, v137
  v_and_b32 v64, 3, v136
  v_add_u32 v64, v64, v137
  s_and_b32 s46, s42, 1
  s_lshl_b32 s46, s46, 2
  s_lshr_b32 s47, s42, 1
  s_lshl_b32 s47, s47, 4
  s_add_u32 s46, s46, s47
  v_add_u32 v64, s46, v64
  v_mul_u32_u24 v64, 12288, v64
  v_lshrrev_b32 v136, 1, v136
  v_bfe_u32 v137, v0, 1, 2
  v_xor_b32 v136, v136, v137
  v_lshlrev_b32 v136, 5, v136
  v_and_b32 v137, 1, v0
  v_lshlrev_b32 v137, 4, v137
  v_add3_u32 v64, v64, v136, v137
  v_lshrrev_b32 v136, 5, v0
  v_lshlrev_b32 v65, 11, v136
  v_bfe_u32 v136, v0, 2, 3
  v_lshl_add_u32 v65, v136, 7, v65
  v_lshrrev_b32 v136, 1, v136
  v_xor_b32 v136, s42, v136
  v_lshl_add_u32 v65, v136, 5, v65
  v_and_b32 v136, 3, v0
  v_lshl_add_u32 v65, v136, 3, v65
  v_add_u32 v66, 0x10000, v65
  v_add_u32 v67, 0x20000, v65
  v_lshlrev_b32 v1, 4, v0
  v_add_u32 v2, s51, v1
  v_add_u32 v3, 0x10000, v2
  s_mul_i32 s62, s45, 384
  s_cmp_ge_u32 s44, 10
  s_cselect_b32 s47, 10, 0
  s_sub_u32 s47, s44, s47
  s_mov_b32 s47, 0
  s_mul_i32 s72, s47, 786432
  s_add_u32 s72, s72, s62
  s_cmp_ge_u32 s47, 8
  s_cselect_b32 s46, 40960, 0
  s_lshl_b32 s24, s47, 10
  s_add_u32 s24, s24, s46
  s_add_u32 s47, s47, 1
  s_cmp_eq_u32 s47, 10
  s_cselect_b32 s47, 0, s47
  s_mul_i32 s73, s47, 786432
  s_add_u32 s73, s73, s62
  s_cmp_ge_u32 s47, 8
  s_cselect_b32 s46, 40960, 0
  s_lshl_b32 s25, s47, 10
  s_add_u32 s25, s25, s46
  s_add_u32 s47, s47, 1
  s_cmp_eq_u32 s47, 10
  s_cselect_b32 s47, 0, s47
  s_mul_i32 s74, s47, 786432
  s_add_u32 s74, s74, s62
  s_cmp_ge_u32 s47, 8
  s_cselect_b32 s46, 40960, 0
  s_lshl_b32 s26, s47, 10
  s_add_u32 s26, s26, s46
  s_add_u32 s47, s47, 1
  s_cmp_eq_u32 s47, 10
  s_cselect_b32 s47, 0, s47
  s_mul_i32 s75, s47, 786432
  s_add_u32 s75, s75, s62
  s_cmp_ge_u32 s47, 8
  s_cselect_b32 s46, 40960, 0
  s_lshl_b32 s27, s47, 10
  s_add_u32 s27, s27, s46
  s_add_u32 s47, s47, 1
  s_cmp_eq_u32 s47, 10
  s_cselect_b32 s47, 0, s47
  s_mul_i32 s76, s47, 786432
  s_add_u32 s76, s76, s62
  s_cmp_ge_u32 s47, 8
  s_cselect_b32 s46, 40960, 0
  s_lshl_b32 s28, s47, 10
  s_add_u32 s28, s28, s46
  s_add_u32 s47, s47, 1
  s_cmp_eq_u32 s47, 10
  s_cselect_b32 s47, 0, s47
  s_mul_i32 s77, s47, 786432
  s_add_u32 s77, s77, s62
  s_cmp_ge_u32 s47, 8
  s_cselect_b32 s46, 40960, 0
  s_lshl_b32 s29, s47, 10
  s_add_u32 s29, s29, s46
  s_add_u32 s47, s47, 1
  s_cmp_eq_u32 s47, 10
  s_cselect_b32 s47, 0, s47
  s_mul_i32 s78, s47, 786432
  s_add_u32 s78, s78, s62
  s_cmp_ge_u32 s47, 8
  s_cselect_b32 s46, 40960, 0
  s_lshl_b32 s30, s47, 10
  s_add_u32 s30, s30, s46
  s_add_u32 s47, s47, 1
  s_cmp_eq_u32 s47, 10
  s_cselect_b32 s47, 0, s47
  s_mul_i32 s79, s47, 786432
  s_add_u32 s79, s79, s62
  s_cmp_ge_u32 s47, 8
  s_cselect_b32 s46, 40960, 0
  s_lshl_b32 s31, s47, 10
  s_add_u32 s31, s31, s46
  s_add_u32 s47, s47, 1
  s_cmp_eq_u32 s47, 10
  s_cselect_b32 s47, 0, s47
  s_mul_i32 s80, s47, 786432
  s_add_u32 s80, s80, s62
  s_cmp_ge_u32 s47, 8
  s_cselect_b32 s46, 40960, 0
  s_lshl_b32 s32, s47, 10
  s_add_u32 s32, s32, s46
  s_add_u32 s47, s47, 1
  s_cmp_eq_u32 s47, 10
  s_cselect_b32 s47, 0, s47
  s_mul_i32 s81, s47, 786432
  s_add_u32 s81, s81, s62
  s_cmp_ge_u32 s47, 8
  s_cselect_b32 s46, 40960, 0
  s_lshl_b32 s33, s47, 10
  s_add_u32 s33, s33, s46
  s_add_u32 s47, s47, 1
  s_cmp_eq_u32 s47, 10
  s_cselect_b32 s47, 0, s47
  s_add_u32 m0, s51, 73728
  s_add_u32 s46, s72, 0
  buffer_load_dwordx4 v64, s[4:7], s46 offen lds
  s_add_u32 m0, s51, 77824
  s_add_u32 s46, s72, 393216
  buffer_load_dwordx4 v64, s[4:7], s46 offen lds
  s_add_u32 m0, s51, 81920
  s_add_u32 s46, s72, 128
  buffer_load_dwordx4 v64, s[4:7], s46 offen lds
  s_add_u32 m0, s51, 86016
  s_add_u32 s46, s72, 393344
  buffer_load_dwordx4 v64, s[4:7], s46 offen lds
  s_add_u32 m0, s51, 90112
  s_add_u32 s46, s72, 256
  buffer_load_dwordx4 v64, s[4:7], s46 offen lds
  s_add_u32 m0, s51, 94208
  s_add_u32 s46, s72, 393472
  buffer_load_dwordx4 v64, s[4:7], s46 offen lds
  s_add_u32 m0, s51, 98304
  s_add_u32 s46, s72, 0
  buffer_load_dwordx4 v64, s[12:15], s46 offen lds
  s_add_u32 m0, s51, 102400
  s_add_u32 s46, s72, 393216
  buffer_load_dwordx4 v64, s[12:15], s46 offen lds
  s_add_u32 m0, s51, 106496
  s_add_u32 s46, s72, 128
  buffer_load_dwordx4 v64, s[12:15], s46 offen lds
  s_add_u32 m0, s51, 110592
  s_add_u32 s46, s72, 393344
  buffer_load_dwordx4 v64, s[12:15], s46 offen lds
  s_add_u32 m0, s51, 114688
  s_add_u32 s46, s72, 256
  buffer_load_dwordx4 v64, s[12:15], s46 offen lds
  s_add_u32 m0, s51, 118784
  s_add_u32 s46, s72, 393472
  buffer_load_dwordx4 v64, s[12:15], s46 offen lds
  s_add_u32 m0, s51, 122880
  s_add_u32 s46, s73, 0
  buffer_load_dwordx4 v64, s[4:7], s46 offen lds
  s_add_u32 m0, s51, 126976
  s_add_u32 s46, s73, 393216
  buffer_load_dwordx4 v64, s[4:7], s46 offen lds
  s_add_u32 m0, s51, 131072
  s_add_u32 s46, s73, 128
  buffer_load_dwordx4 v64, s[4:7], s46 offen lds
  s_add_u32 m0, s51, 135168
  s_add_u32 s46, s73, 393344
  buffer_load_dwordx4 v64, s[4:7], s46 offen lds
  s_add_u32 m0, s51, 139264
  s_add_u32 s46, s73, 256
  buffer_load_dwordx4 v64, s[4:7], s46 offen lds
  s_add_u32 m0, s51, 143360
  s_add_u32 s46, s73, 393472
  buffer_load_dwordx4 v64, s[4:7], s46 offen lds
  s_add_u32 m0, s51, 0
  s_add_u32 s46, s73, 0
  buffer_load_dwordx4 v64, s[12:15], s46 offen lds
  s_add_u32 m0, s51, 4096
  s_add_u32 s46, s73, 393216
  buffer_load_dwordx4 v64, s[12:15], s46 offen lds
  s_add_u32 m0, s51, 8192
  s_add_u32 s46, s73, 128
  buffer_load_dwordx4 v64, s[12:15], s46 offen lds
  s_add_u32 m0, s51, 12288
  s_add_u32 s46, s73, 393344
  buffer_load_dwordx4 v64, s[12:15], s46 offen lds
  s_add_u32 m0, s51, 16384
  s_add_u32 s46, s73, 256
  buffer_load_dwordx4 v64, s[12:15], s46 offen lds
  s_add_u32 m0, s51, 20480
  s_add_u32 s46, s73, 393472
  buffer_load_dwordx4 v64, s[12:15], s46 offen lds
  s_add_u32 m0, s51, 24576
  s_add_u32 s46, s74, 0
  buffer_load_dwordx4 v64, s[12:15], s46 offen lds
  s_add_u32 m0, s51, 28672
  s_add_u32 s46, s74, 393216
  buffer_load_dwordx4 v64, s[12:15], s46 offen lds
  s_add_u32 m0, s51, 32768
  s_add_u32 s46, s74, 128
  buffer_load_dwordx4 v64, s[12:15], s46 offen lds
  s_add_u32 m0, s51, 36864
  s_add_u32 s46, s74, 393344
  buffer_load_dwordx4 v64, s[12:15], s46 offen lds
  s_add_u32 m0, s51, 40960
  s_add_u32 s46, s74, 256
  buffer_load_dwordx4 v64, s[12:15], s46 offen lds
  s_add_u32 m0, s51, 45056
  s_add_u32 s46, s74, 393472
  buffer_load_dwordx4 v64, s[12:15], s46 offen lds
  s_waitcnt vmcnt(24)
  s_barrier
  s_add_u32 m0, s51, 49152
  s_add_u32 s46, s75, 0
  buffer_load_dwordx4 v64, s[4:7], s46 offen lds
  s_add_u32 m0, s51, 53248
  s_add_u32 s46, s75, 393216
  buffer_load_dwordx4 v64, s[4:7], s46 offen lds
  s_add_u32 m0, s51, 57344
  s_add_u32 s46, s75, 128
  buffer_load_dwordx4 v64, s[4:7], s46 offen lds
  s_add_u32 m0, s51, 61440
  s_add_u32 s46, s75, 393344
  buffer_load_dwordx4 v64, s[4:7], s46 offen lds
  s_add_u32 m0, s51, 65536
  s_add_u32 s46, s75, 256
  buffer_load_dwordx4 v64, s[4:7], s46 offen lds
  s_add_u32 m0, s51, 69632
  s_add_u32 s46, s75, 393472
  buffer_load_dwordx4 v64, s[4:7], s46 offen lds
  ds_read_b64_tr_b16 a[0:1], v66 offset:8192
  ds_read_b64_tr_b16 a[2:3], v66 offset:9216
  ds_read_b64_tr_b16 a[4:5], v66 offset:12288
  ds_read_b64_tr_b16 a[6:7], v66 offset:13312
  ds_read_b64_tr_b16 a[8:9], v66 offset:16384
  ds_read_b64_tr_b16 a[10:11], v66 offset:17408
  ds_read_b64_tr_b16 a[12:13], v66 offset:20480
  ds_read_b64_tr_b16 a[14:15], v66 offset:21504
  ds_read_b64_tr_b16 a[16:17], v66 offset:24576
  ds_read_b64_tr_b16 a[18:19], v66 offset:25600
  ds_read_b64_tr_b16 a[20:21], v66 offset:28672
  ds_read_b64_tr_b16 a[22:23], v66 offset:29696
  s_waitcnt lgkmcnt(0)
  s_waitcnt vmcnt(24)
  s_barrier
  s_add_u32 m0, s51, 73728
  s_add_u32 s46, s75, 0
  buffer_load_dwordx4 v64, s[12:15], s46 offen lds
  s_add_u32 m0, s51, 77824
  s_add_u32 s46, s75, 393216
  buffer_load_dwordx4 v64, s[12:15], s46 offen lds
  s_add_u32 m0, s51, 81920
  s_add_u32 s46, s75, 128
  buffer_load_dwordx4 v64, s[12:15], s46 offen lds
  s_add_u32 m0, s51, 86016
  s_add_u32 s46, s75, 393344
  buffer_load_dwordx4 v64, s[12:15], s46 offen lds
  s_add_u32 m0, s51, 90112
  s_add_u32 s46, s75, 256
  buffer_load_dwordx4 v64, s[12:15], s46 offen lds
  s_add_u32 m0, s51, 94208
  s_add_u32 s46, s75, 393472
  buffer_load_dwordx4 v64, s[12:15], s46 offen lds
  ds_read_b64_tr_b16 a[24:25], v66 offset:32768
  ds_read_b64_tr_b16 a[26:27], v66 offset:33792
  ds_read_b64_tr_b16 a[28:29], v66 offset:36864
  ds_read_b64_tr_b16 a[30:31], v66 offset:37888
  ds_read_b64_tr_b16 a[32:33], v66 offset:40960
  ds_read_b64_tr_b16 a[34:35], v66 offset:41984
  ds_read_b64_tr_b16 a[36:37], v66 offset:45056
  ds_read_b64_tr_b16 a[38:39], v66 offset:46080
  ds_read_b64_tr_b16 a[40:41], v66 offset:49152
  ds_read_b64_tr_b16 a[42:43], v66 offset:50176
  ds_read_b64_tr_b16 a[44:45], v66 offset:53248
  ds_read_b64_tr_b16 a[46:47], v66 offset:54272
  s_waitcnt lgkmcnt(0)
  s_waitcnt vmcnt(24)
  s_barrier
  s_add_u32 m0, s51, 98304
  s_add_u32 s46, s76, 0
  buffer_load_dwordx4 v64, s[4:7], s46 offen lds
  s_add_u32 m0, s51, 102400
  s_add_u32 s46, s76, 393216
  buffer_load_dwordx4 v64, s[4:7], s46 offen lds
  s_add_u32 m0, s51, 106496
  s_add_u32 s46, s76, 128
  buffer_load_dwordx4 v64, s[4:7], s46 offen lds
  s_add_u32 m0, s51, 110592
  s_add_u32 s46, s76, 393344
  buffer_load_dwordx4 v64, s[4:7], s46 offen lds
  s_add_u32 m0, s51, 114688
  s_add_u32 s46, s76, 256
  buffer_load_dwordx4 v64, s[4:7], s46 offen lds
  s_add_u32 m0, s51, 118784
  s_add_u32 s46, s76, 393472
  buffer_load_dwordx4 v64, s[4:7], s46 offen lds
  ds_read_b64_tr_b16 a[48:49], v66 offset:57344
  ds_read_b64_tr_b16 a[50:51], v66 offset:58368
  ds_read_b64_tr_b16 a[52:53], v66 offset:61440
  ds_read_b64_tr_b16 a[54:55], v66 offset:62464
  ds_read_b64_tr_b16 a[56:57], v67 offset:0
  ds_read_b64_tr_b16 a[58:59], v67 offset:1024
  ds_read_b64_tr_b16 a[60:61], v67 offset:4096
  ds_read_b64_tr_b16 a[62:63], v67 offset:5120
  ds_read_b64_tr_b16 a[64:65], v67 offset:8192
  ds_read_b64_tr_b16 a[66:67], v67 offset:9216
  ds_read_b64_tr_b16 a[68:69], v67 offset:12288
  ds_read_b64_tr_b16 a[70:71], v67 offset:13312
  s_waitcnt lgkmcnt(0)
  s_waitcnt vmcnt(24)
  s_barrier
  s_add_u32 m0, s51, 122880
  s_add_u32 s46, s77, 0
  buffer_load_dwordx4 v64, s[12:15], s46 offen lds
  s_add_u32 m0, s51, 126976
  s_add_u32 s46, s77, 393216
  buffer_load_dwordx4 v64, s[12:15], s46 offen lds
  s_add_u32 m0, s51, 131072
  s_add_u32 s46, s77, 128
  buffer_load_dwordx4 v64, s[12:15], s46 offen lds
  s_add_u32 m0, s51, 135168
  s_add_u32 s46, s77, 393344
  buffer_load_dwordx4 v64, s[12:15], s46 offen lds
  s_add_u32 m0, s51, 139264
  s_add_u32 s46, s77, 256
  buffer_load_dwordx4 v64, s[12:15], s46 offen lds
  s_add_u32 m0, s51, 143360
  s_add_u32 s46, s77, 393472
  buffer_load_dwordx4 v64, s[12:15], s46 offen lds
  ds_read_b64_tr_b16 a[72:73], v65 offset:0
  ds_read_b64_tr_b16 a[74:75], v65 offset:1024
  ds_read_b64_tr_b16 a[76:77], v65 offset:4096
  ds_read_b64_tr_b16 a[78:79], v65 offset:5120
  ds_read_b64_tr_b16 a[80:81], v65 offset:8192
  ds_read_b64_tr_b16 a[82:83], v65 offset:9216
  ds_read_b64_tr_b16 a[84:85], v65 offset:12288
  ds_read_b64_tr_b16 a[86:87], v65 offset:13312
  ds_read_b64_tr_b16 a[88:89], v65 offset:16384
  ds_read_b64_tr_b16 a[90:91], v65 offset:17408
  ds_read_b64_tr_b16 a[92:93], v65 offset:20480
  ds_read_b64_tr_b16 a[94:95], v65 offset:21504
  s_waitcnt lgkmcnt(0)
  s_waitcnt vmcnt(24)
  s_barrier
  s_add_u32 m0, s51, 0
  s_add_u32 s46, s78, 0
  buffer_load_dwordx4 v64, s[4:7], s46 offen lds
  s_add_u32 m0, s51, 4096
  s_add_u32 s46, s78, 393216
  buffer_load_dwordx4 v64, s[4:7], s46 offen lds
  s_add_u32 m0, s51, 8192
  s_add_u32 s46, s78, 128
  buffer_load_dwordx4 v64, s[4:7], s46 offen lds
  s_add_u32 m0, s51, 12288
  s_add_u32 s46, s78, 393344
  buffer_load_dwordx4 v64, s[4:7], s46 offen lds
  s_add_u32 m0, s51, 16384
  s_add_u32 s46, s78, 256
  buffer_load_dwordx4 v64, s[4:7], s46 offen lds
  s_add_u32 m0, s51, 20480
  s_add_u32 s46, s78, 393472
  buffer_load_dwordx4 v64, s[4:7], s46 offen lds
  ds_read_b64_tr_b16 a[96:97], v65 offset:24576
  ds_read_b64_tr_b16 a[98:99], v65 offset:25600
  ds_read_b64_tr_b16 a[100:101], v65 offset:28672
  ds_read_b64_tr_b16 a[102:103], v65 offset:29696
  ds_read_b64_tr_b16 a[104:105], v65 offset:32768
  ds_read_b64_tr_b16 a[106:107], v65 offset:33792
  ds_read_b64_tr_b16 a[108:109], v65 offset:36864
  ds_read_b64_tr_b16 a[110:111], v65 offset:37888
  ds_read_b64_tr_b16 a[112:113], v65 offset:40960
  ds_read_b64_tr_b16 a[114:115], v65 offset:41984
  ds_read_b64_tr_b16 a[116:117], v65 offset:45056
  ds_read_b64_tr_b16 a[118:119], v65 offset:46080
  s_waitcnt lgkmcnt(0)
  s_waitcnt vmcnt(24)
  s_barrier
  s_add_u32 m0, s51, 24576
  s_add_u32 s46, s78, 0
  buffer_load_dwordx4 v64, s[12:15], s46 offen lds
  s_add_u32 m0, s51, 28672
  s_add_u32 s46, s78, 393216
  buffer_load_dwordx4 v64, s[12:15], s46 offen lds
  s_add_u32 m0, s51, 32768
  s_add_u32 s46, s78, 128
  buffer_load_dwordx4 v64, s[12:15], s46 offen lds
  s_add_u32 m0, s51, 36864
  s_add_u32 s46, s78, 393344
  buffer_load_dwordx4 v64, s[12:15], s46 offen lds
  s_add_u32 m0, s51, 40960
  s_add_u32 s46, s78, 256
  buffer_load_dwordx4 v64, s[12:15], s46 offen lds
  s_add_u32 m0, s51, 45056
  s_add_u32 s46, s78, 393472
  buffer_load_dwordx4 v64, s[12:15], s46 offen lds
  ds_read_b64_tr_b16 a[120:121], v65 offset:49152
  ds_read_b64_tr_b16 a[122:123], v65 offset:50176
  ds_read_b64_tr_b16 a[124:125], v65 offset:53248
  ds_read_b64_tr_b16 a[126:127], v65 offset:54272
  ds_read_b64_tr_b16 a[128:129], v65 offset:57344
  ds_read_b64_tr_b16 a[130:131], v65 offset:58368
  ds_read_b64_tr_b16 a[132:133], v65 offset:61440
  ds_read_b64_tr_b16 a[134:135], v65 offset:62464
  ds_read_b64_tr_b16 a[136:137], v66 offset:0
  ds_read_b64_tr_b16 a[138:139], v66 offset:1024
  ds_read_b64_tr_b16 a[140:141], v66 offset:4096
  ds_read_b64_tr_b16 a[142:143], v66 offset:5120
  s_waitcnt lgkmcnt(0)
  s_waitcnt vmcnt(24)
  s_barrier
  s_add_u32 m0, s51, 49152
  s_add_u32 s46, s79, 0
  buffer_load_dwordx4 v64, s[4:7], s46 offen lds
  s_add_u32 m0, s51, 53248
  s_add_u32 s46, s79, 393216
  buffer_load_dwordx4 v64, s[4:7], s46 offen lds
  s_add_u32 m0, s51, 57344
  s_add_u32 s46, s79, 128
  buffer_load_dwordx4 v64, s[4:7], s46 offen lds
  s_add_u32 m0, s51, 61440
  s_add_u32 s46, s79, 393344
  buffer_load_dwordx4 v64, s[4:7], s46 offen lds
  s_add_u32 m0, s51, 65536
  s_add_u32 s46, s79, 256
  buffer_load_dwordx4 v64, s[4:7], s46 offen lds
  s_add_u32 m0, s51, 69632
  s_add_u32 s46, s79, 393472
  buffer_load_dwordx4 v64, s[4:7], s46 offen lds
  ds_read_b64_tr_b16 a[144:145], v66 offset:8192
  ds_read_b64_tr_b16 a[146:147], v66 offset:9216
  ds_read_b64_tr_b16 a[148:149], v66 offset:12288
  ds_read_b64_tr_b16 a[150:151], v66 offset:13312
  ds_read_b64_tr_b16 a[152:153], v66 offset:16384
  ds_read_b64_tr_b16 a[154:155], v66 offset:17408
  ds_read_b64_tr_b16 a[156:157], v66 offset:20480
  ds_read_b64_tr_b16 a[158:159], v66 offset:21504
  ds_read_b64_tr_b16 a[160:161], v66 offset:24576
  ds_read_b64_tr_b16 a[162:163], v66 offset:25600
  ds_read_b64_tr_b16 a[164:165], v66 offset:28672
  ds_read_b64_tr_b16 a[166:167], v66 offset:29696
  s_waitcnt lgkmcnt(0)
  s_waitcnt vmcnt(24)
  s_barrier
  s_add_u32 m0, s51, 73728
  s_add_u32 s46, s80, 0
  buffer_load_dwordx4 v64, s[12:15], s46 offen lds
  s_add_u32 m0, s51, 77824
  s_add_u32 s46, s80, 393216
  buffer_load_dwordx4 v64, s[12:15], s46 offen lds
  s_add_u32 m0, s51, 81920
  s_add_u32 s46, s80, 128
  buffer_load_dwordx4 v64, s[12:15], s46 offen lds
  s_add_u32 m0, s51, 86016
  s_add_u32 s46, s80, 393344
  buffer_load_dwordx4 v64, s[12:15], s46 offen lds
  s_add_u32 m0, s51, 90112
  s_add_u32 s46, s80, 256
  buffer_load_dwordx4 v64, s[12:15], s46 offen lds
  s_add_u32 m0, s51, 94208
  s_add_u32 s46, s80, 393472
  buffer_load_dwordx4 v64, s[12:15], s46 offen lds
  ds_read_b64_tr_b16 a[168:169], v66 offset:32768
  ds_read_b64_tr_b16 a[170:171], v66 offset:33792
  ds_read_b64_tr_b16 a[172:173], v66 offset:36864
  ds_read_b64_tr_b16 a[174:175], v66 offset:37888
  ds_read_b64_tr_b16 a[176:177], v66 offset:40960
  ds_read_b64_tr_b16 a[178:179], v66 offset:41984
  ds_read_b64_tr_b16 a[180:181], v66 offset:45056
  ds_read_b64_tr_b16 a[182:183], v66 offset:46080
  ds_read_b64_tr_b16 a[184:185], v66 offset:49152
  ds_read_b64_tr_b16 a[186:187], v66 offset:50176
  ds_read_b64_tr_b16 a[188:189], v66 offset:53248
  ds_read_b64_tr_b16 a[190:191], v66 offset:54272
  s_waitcnt lgkmcnt(0)
  s_waitcnt vmcnt(24)
  s_barrier
  s_add_u32 m0, s51, 98304
  s_add_u32 s46, s81, 0
  buffer_load_dwordx4 v64, s[4:7], s46 offen lds
  s_add_u32 m0, s51, 102400
  s_add_u32 s46, s81, 393216
  buffer_load_dwordx4 v64, s[4:7], s46 offen lds
  s_add_u32 m0, s51, 106496
  s_add_u32 s46, s81, 128
  buffer_load_dwordx4 v64, s[4:7], s46 offen lds
  s_add_u32 m0, s51, 110592
  s_add_u32 s46, s81, 393344
  buffer_load_dwordx4 v64, s[4:7], s46 offen lds
  s_add_u32 m0, s51, 114688
  s_add_u32 s46, s81, 256
  buffer_load_dwordx4 v64, s[4:7], s46 offen lds
  s_add_u32 m0, s51, 118784
  s_add_u32 s46, s81, 393472
  buffer_load_dwordx4 v64, s[4:7], s46 offen lds
  ds_read_b64_tr_b16 a[192:193], v66 offset:57344
  ds_read_b64_tr_b16 a[194:195], v66 offset:58368
  ds_read_b64_tr_b16 a[196:197], v66 offset:61440
  ds_read_b64_tr_b16 a[198:199], v66 offset:62464
  ds_read_b64_tr_b16 a[200:201], v67 offset:0
  ds_read_b64_tr_b16 a[202:203], v67 offset:1024
  ds_read_b64_tr_b16 a[204:205], v67 offset:4096
  ds_read_b64_tr_b16 a[206:207], v67 offset:5120
  ds_read_b64_tr_b16 a[208:209], v67 offset:8192
  ds_read_b64_tr_b16 a[210:211], v67 offset:9216
  ds_read_b64_tr_b16 a[212:213], v67 offset:12288
  ds_read_b64_tr_b16 a[214:215], v67 offset:13312
  s_waitcnt lgkmcnt(0)
  s_waitcnt vmcnt(24)
  s_barrier
  s_add_u32 m0, s51, 122880
  s_add_u32 s46, s81, 0
  buffer_load_dwordx4 v64, s[12:15], s46 offen lds
  s_add_u32 m0, s51, 126976
  s_add_u32 s46, s81, 393216
  buffer_load_dwordx4 v64, s[12:15], s46 offen lds
  s_add_u32 m0, s51, 131072
  s_add_u32 s46, s81, 128
  buffer_load_dwordx4 v64, s[12:15], s46 offen lds
  s_add_u32 m0, s51, 135168
  s_add_u32 s46, s81, 393344
  buffer_load_dwordx4 v64, s[12:15], s46 offen lds
  s_add_u32 m0, s51, 139264
  s_add_u32 s46, s81, 256
  buffer_load_dwordx4 v64, s[12:15], s46 offen lds
  s_add_u32 m0, s51, 143360
  s_add_u32 s46, s81, 393472
  buffer_load_dwordx4 v64, s[12:15], s46 offen lds
  ds_read_b64_tr_b16 a[216:217], v65 offset:0
  ds_read_b64_tr_b16 a[218:219], v65 offset:1024
  ds_read_b64_tr_b16 a[220:221], v65 offset:4096
  ds_read_b64_tr_b16 a[222:223], v65 offset:5120
  ds_read_b64_tr_b16 a[224:225], v65 offset:8192
  ds_read_b64_tr_b16 a[226:227], v65 offset:9216
  ds_read_b64_tr_b16 a[228:229], v65 offset:12288
  ds_read_b64_tr_b16 a[230:231], v65 offset:13312
  ds_read_b64_tr_b16 a[232:233], v65 offset:16384
  ds_read_b64_tr_b16 a[234:235], v65 offset:17408
  ds_read_b64_tr_b16 a[236:237], v65 offset:20480
  ds_read_b64_tr_b16 a[238:239], v65 offset:21504
  s_waitcnt lgkmcnt(0)
  s_waitcnt vmcnt(24)
  s_barrier
  s_add_u32 m0, s51, 0
  s_add_u32 s46, s74, 0
  buffer_load_dwordx4 v64, s[4:7], s46 offen lds
  s_add_u32 m0, s51, 4096
  s_add_u32 s46, s74, 393216
  buffer_load_dwordx4 v64, s[4:7], s46 offen lds
  s_add_u32 m0, s51, 8192
  s_add_u32 s46, s74, 128
  buffer_load_dwordx4 v64, s[4:7], s46 offen lds
  s_add_u32 m0, s51, 12288
  s_add_u32 s46, s74, 393344
  buffer_load_dwordx4 v64, s[4:7], s46 offen lds
  s_add_u32 m0, s51, 16384
  s_add_u32 s46, s74, 256
  buffer_load_dwordx4 v64, s[4:7], s46 offen lds
  s_add_u32 m0, s51, 20480
  s_add_u32 s46, s74, 393472
  buffer_load_dwordx4 v64, s[4:7], s46 offen lds
  ds_read_b64_tr_b16 a[240:241], v65 offset:24576
  ds_read_b64_tr_b16 a[242:243], v65 offset:25600
  ds_read_b64_tr_b16 a[244:245], v65 offset:28672
  ds_read_b64_tr_b16 a[246:247], v65 offset:29696
  ds_read_b64_tr_b16 a[248:249], v65 offset:32768
  ds_read_b64_tr_b16 a[250:251], v65 offset:33792
  ds_read_b64_tr_b16 a[252:253], v65 offset:36864
  ds_read_b64_tr_b16 a[254:255], v65 offset:37888
  ds_read_b64_tr_b16 v[152:153], v65 offset:40960
  ds_read_b64_tr_b16 v[154:155], v65 offset:41984
  ds_read_b64_tr_b16 v[156:157], v65 offset:45056
  ds_read_b64_tr_b16 v[158:159], v65 offset:46080
  s_waitcnt lgkmcnt(0)
  s_waitcnt vmcnt(24)
  s_barrier
  s_add_u32 m0, s51, 24576
  s_add_u32 s46, s76, 0
  buffer_load_dwordx4 v64, s[12:15], s46 offen lds
  s_add_u32 m0, s51, 28672
  s_add_u32 s46, s76, 393216
  buffer_load_dwordx4 v64, s[12:15], s46 offen lds
  s_add_u32 m0, s51, 32768
  s_add_u32 s46, s76, 128
  buffer_load_dwordx4 v64, s[12:15], s46 offen lds
  s_add_u32 m0, s51, 36864
  s_add_u32 s46, s76, 393344
  buffer_load_dwordx4 v64, s[12:15], s46 offen lds
  s_add_u32 m0, s51, 40960
  s_add_u32 s46, s76, 256
  buffer_load_dwordx4 v64, s[12:15], s46 offen lds
  s_add_u32 m0, s51, 45056
  s_add_u32 s46, s76, 393472
  buffer_load_dwordx4 v64, s[12:15], s46 offen lds
  ds_read_b64_tr_b16 v[160:161], v65 offset:49152
  ds_read_b64_tr_b16 v[162:163], v65 offset:50176
  ds_read_b64_tr_b16 v[164:165], v65 offset:53248
  ds_read_b64_tr_b16 v[166:167], v65 offset:54272
  ds_read_b64_tr_b16 v[168:169], v65 offset:57344
  ds_read_b64_tr_b16 v[170:171], v65 offset:58368
  ds_read_b64_tr_b16 v[172:173], v65 offset:61440
  ds_read_b64_tr_b16 v[174:175], v65 offset:62464
  ds_read_b64_tr_b16 v[176:177], v66 offset:0
  ds_read_b64_tr_b16 v[178:179], v66 offset:1024
  ds_read_b64_tr_b16 v[180:181], v66 offset:4096
  ds_read_b64_tr_b16 v[182:183], v66 offset:5120
  s_waitcnt lgkmcnt(0)
  s_waitcnt vmcnt(24)
  s_barrier
  s_add_u32 m0, s51, 49152
  s_add_u32 s46, s77, 0
  buffer_load_dwordx4 v64, s[4:7], s46 offen lds
  s_add_u32 m0, s51, 53248
  s_add_u32 s46, s77, 393216
  buffer_load_dwordx4 v64, s[4:7], s46 offen lds
  s_add_u32 m0, s51, 57344
  s_add_u32 s46, s77, 128
  buffer_load_dwordx4 v64, s[4:7], s46 offen lds
  s_add_u32 m0, s51, 61440
  s_add_u32 s46, s77, 393344
  buffer_load_dwordx4 v64, s[4:7], s46 offen lds
  s_add_u32 m0, s51, 65536
  s_add_u32 s46, s77, 256
  buffer_load_dwordx4 v64, s[4:7], s46 offen lds
  s_add_u32 m0, s51, 69632
  s_add_u32 s46, s77, 393472
  buffer_load_dwordx4 v64, s[4:7], s46 offen lds
  ds_read_b64_tr_b16 v[184:185], v66 offset:8192
  ds_read_b64_tr_b16 v[186:187], v66 offset:9216
  ds_read_b64_tr_b16 v[188:189], v66 offset:12288
  ds_read_b64_tr_b16 v[190:191], v66 offset:13312
  ds_read_b64_tr_b16 v[192:193], v66 offset:16384
  ds_read_b64_tr_b16 v[194:195], v66 offset:17408
  ds_read_b64_tr_b16 v[196:197], v66 offset:20480
  ds_read_b64_tr_b16 v[198:199], v66 offset:21504
  ds_read_b64_tr_b16 v[200:201], v66 offset:24576
  ds_read_b64_tr_b16 v[202:203], v66 offset:25600
  ds_read_b64_tr_b16 v[204:205], v66 offset:28672
  ds_read_b64_tr_b16 v[206:207], v66 offset:29696
  s_waitcnt lgkmcnt(0)
  s_waitcnt vmcnt(24)
  s_barrier
  s_add_u32 m0, s51, 73728
  s_add_u32 s46, s79, 0
  buffer_load_dwordx4 v64, s[12:15], s46 offen lds
  s_add_u32 m0, s51, 77824
  s_add_u32 s46, s79, 393216
  buffer_load_dwordx4 v64, s[12:15], s46 offen lds
  s_add_u32 m0, s51, 81920
  s_add_u32 s46, s79, 128
  buffer_load_dwordx4 v64, s[12:15], s46 offen lds
  s_add_u32 m0, s51, 86016
  s_add_u32 s46, s79, 393344
  buffer_load_dwordx4 v64, s[12:15], s46 offen lds
  s_add_u32 m0, s51, 90112
  s_add_u32 s46, s79, 256
  buffer_load_dwordx4 v64, s[12:15], s46 offen lds
  s_add_u32 m0, s51, 94208
  s_add_u32 s46, s79, 393472
  buffer_load_dwordx4 v64, s[12:15], s46 offen lds
  ds_read_b64_tr_b16 v[208:209], v66 offset:32768
  ds_read_b64_tr_b16 v[210:211], v66 offset:33792
  ds_read_b64_tr_b16 v[212:213], v66 offset:36864
  ds_read_b64_tr_b16 v[214:215], v66 offset:37888
  ds_read_b64_tr_b16 v[216:217], v66 offset:40960
  ds_read_b64_tr_b16 v[218:219], v66 offset:41984
  ds_read_b64_tr_b16 v[220:221], v66 offset:45056
  ds_read_b64_tr_b16 v[222:223], v66 offset:46080
  ds_read_b64_tr_b16 v[224:225], v66 offset:49152
  ds_read_b64_tr_b16 v[226:227], v66 offset:50176
  ds_read_b64_tr_b16 v[228:229], v66 offset:53248
  ds_read_b64_tr_b16 v[230:231], v66 offset:54272
  s_waitcnt lgkmcnt(0)
  s_waitcnt vmcnt(24)
  s_barrier
  s_add_u32 m0, s51, 98304
  s_add_u32 s46, s80, 0
  buffer_load_dwordx4 v64, s[4:7], s46 offen lds
  s_add_u32 m0, s51, 102400
  s_add_u32 s46, s80, 393216
  buffer_load_dwordx4 v64, s[4:7], s46 offen lds
  s_add_u32 m0, s51, 106496
  s_add_u32 s46, s80, 128
  buffer_load_dwordx4 v64, s[4:7], s46 offen lds
  s_add_u32 m0, s51, 110592
  s_add_u32 s46, s80, 393344
  buffer_load_dwordx4 v64, s[4:7], s46 offen lds
  s_add_u32 m0, s51, 114688
  s_add_u32 s46, s80, 256
  buffer_load_dwordx4 v64, s[4:7], s46 offen lds
  s_add_u32 m0, s51, 118784
  s_add_u32 s46, s80, 393472
  buffer_load_dwordx4 v64, s[4:7], s46 offen lds
  ds_read_b64_tr_b16 v[232:233], v66 offset:57344
  ds_read_b64_tr_b16 v[234:235], v66 offset:58368
  ds_read_b64_tr_b16 v[236:237], v66 offset:61440
  ds_read_b64_tr_b16 v[238:239], v66 offset:62464
  ds_read_b64_tr_b16 v[240:241], v67 offset:0
  ds_read_b64_tr_b16 v[242:243], v67 offset:1024
  ds_read_b64_tr_b16 v[244:245], v67 offset:4096
  ds_read_b64_tr_b16 v[246:247], v67 offset:5120
  ds_read_b64_tr_b16 v[248:249], v67 offset:8192
  ds_read_b64_tr_b16 v[250:251], v67 offset:9216
  ds_read_b64_tr_b16 v[252:253], v67 offset:12288
  ds_read_b64_tr_b16 v[254:255], v67 offset:13312
  s_waitcnt lgkmcnt(0)
  s_waitcnt vmcnt(24)
  s_barrier
  ds_read_b64_tr_b16 v[40:41], v65 offset:0
  ds_read_b64_tr_b16 v[42:43], v65 offset:1024
  ds_read_b64_tr_b16 v[44:45], v65 offset:4096
  ds_read_b64_tr_b16 v[46:47], v65 offset:5120
  ds_read_b64_tr_b16 v[48:49], v65 offset:8192
  ds_read_b64_tr_b16 v[50:51], v65 offset:9216
  ds_read_b64_tr_b16 v[52:53], v65 offset:12288
  ds_read_b64_tr_b16 v[54:55], v65 offset:13312
  ds_read_b64_tr_b16 v[56:57], v65 offset:16384
  ds_read_b64_tr_b16 v[58:59], v65 offset:17408
  ds_read_b64_tr_b16 v[60:61], v65 offset:20480
  ds_read_b64_tr_b16 v[62:63], v65 offset:21504
  s_waitcnt lgkmcnt(0)
  s_waitcnt vmcnt(18)
  s_barrier
  ds_write_b128 v2, v[40:43] offset:0
  ds_write_b128 v2, v[44:47] offset:4096
  ds_write_b128 v2, v[48:51] offset:8192
  ds_write_b128 v2, v[52:55] offset:12288
  ds_write_b128 v2, v[56:59] offset:16384
  ds_write_b128 v2, v[60:63] offset:20480
  ds_read_b64_tr_b16 v[16:17], v65 offset:24576
  ds_read_b64_tr_b16 v[18:19], v65 offset:25600
  ds_read_b64_tr_b16 v[20:21], v65 offset:28672
  ds_read_b64_tr_b16 v[22:23], v65 offset:29696
  ds_read_b64_tr_b16 v[24:25], v65 offset:32768
  ds_read_b64_tr_b16 v[26:27], v65 offset:33792
  ds_read_b64_tr_b16 v[28:29], v65 offset:36864
  ds_read_b64_tr_b16 v[30:31], v65 offset:37888
  ds_read_b64_tr_b16 v[32:33], v65 offset:40960
  ds_read_b64_tr_b16 v[34:35], v65 offset:41984
  ds_read_b64_tr_b16 v[36:37], v65 offset:45056
  ds_read_b64_tr_b16 v[38:39], v65 offset:46080
  s_waitcnt lgkmcnt(0)
  s_waitcnt vmcnt(12)
  s_barrier
  ds_write_b128 v2, v[16:19] offset:24576
  ds_write_b128 v2, v[20:23] offset:28672
  ds_write_b128 v2, v[24:27] offset:32768
  ds_write_b128 v2, v[28:31] offset:36864
  ds_write_b128 v2, v[32:35] offset:40960
  ds_write_b128 v2, v[36:39] offset:45056
  ds_read_b64_tr_b16 v[40:41], v65 offset:49152
  ds_read_b64_tr_b16 v[42:43], v65 offset:50176
  ds_read_b64_tr_b16 v[44:45], v65 offset:53248
  ds_read_b64_tr_b16 v[46:47], v65 offset:54272
  ds_read_b64_tr_b16 v[48:49], v65 offset:57344
  ds_read_b64_tr_b16 v[50:51], v65 offset:58368
  ds_read_b64_tr_b16 v[52:53], v65 offset:61440
  ds_read_b64_tr_b16 v[54:55], v65 offset:62464
  ds_read_b64_tr_b16 v[56:57], v66 offset:0
  ds_read_b64_tr_b16 v[58:59], v66 offset:1024
  ds_read_b64_tr_b16 v[60:61], v66 offset:4096
  ds_read_b64_tr_b16 v[62:63], v66 offset:5120
  s_waitcnt lgkmcnt(0)
  s_waitcnt vmcnt(6)
  s_barrier
  ds_write_b128 v2, v[40:43] offset:49152
  ds_write_b128 v2, v[44:47] offset:53248
  ds_write_b128 v2, v[48:51] offset:57344
  ds_write_b128 v2, v[52:55] offset:61440
  ds_write_b128 v3, v[56:59] offset:0
  ds_write_b128 v3, v[60:63] offset:4096
  ds_read_b64_tr_b16 v[16:17], v66 offset:8192
  ds_read_b64_tr_b16 v[18:19], v66 offset:9216
  ds_read_b64_tr_b16 v[20:21], v66 offset:12288
  ds_read_b64_tr_b16 v[22:23], v66 offset:13312
  ds_read_b64_tr_b16 v[24:25], v66 offset:16384
  ds_read_b64_tr_b16 v[26:27], v66 offset:17408
  ds_read_b64_tr_b16 v[28:29], v66 offset:20480
  ds_read_b64_tr_b16 v[30:31], v66 offset:21504
  ds_read_b64_tr_b16 v[32:33], v66 offset:24576
  ds_read_b64_tr_b16 v[34:35], v66 offset:25600
  ds_read_b64_tr_b16 v[36:37], v66 offset:28672
  ds_read_b64_tr_b16 v[38:39], v66 offset:29696
  s_waitcnt lgkmcnt(0)
  s_waitcnt vmcnt(0)
  s_barrier
  ds_write_b128 v3, v[16:19] offset:8192
  ds_write_b128 v3, v[20:23] offset:12288
  ds_write_b128 v3, v[24:27] offset:16384
  ds_write_b128 v3, v[28:31] offset:20480
  ds_write_b128 v3, v[32:35] offset:24576
  ds_write_b128 v3, v[36:39] offset:28672
  ds_read_b64_tr_b16 v[40:41], v66 offset:32768
  ds_read_b64_tr_b16 v[42:43], v66 offset:33792
  ds_read_b64_tr_b16 v[44:45], v66 offset:36864
  ds_read_b64_tr_b16 v[46:47], v66 offset:37888
  ds_read_b64_tr_b16 v[48:49], v66 offset:40960
  ds_read_b64_tr_b16 v[50:51], v66 offset:41984
  ds_read_b64_tr_b16 v[52:53], v66 offset:45056
  ds_read_b64_tr_b16 v[54:55], v66 offset:46080
  ds_read_b64_tr_b16 v[56:57], v66 offset:49152
  ds_read_b64_tr_b16 v[58:59], v66 offset:50176
  ds_read_b64_tr_b16 v[60:61], v66 offset:53248
  ds_read_b64_tr_b16 v[62:63], v66 offset:54272
  s_waitcnt lgkmcnt(0)
  s_barrier
  ds_write_b128 v3, v[40:43] offset:32768
  ds_write_b128 v3, v[44:47] offset:36864
  ds_write_b128 v3, v[48:51] offset:40960
  ds_write_b128 v3, v[52:55] offset:45056
  ds_write_b128 v3, v[56:59] offset:49152
  ds_write_b128 v3, v[60:63] offset:53248
  s_waitcnt lgkmcnt(0)
  v_and_b32 v138, 1, v0
  v_mul_u32_u24 v138, 1130496, v138
  v_add_u32 v138, 1966080, v138
  buffer_load_dword v136, v138, s[8:11], 0 offen sc1
  s_waitcnt vmcnt(0)
  v_readlane_b32 s54, v136, 0
  v_readlane_b32 s55, v136, 1
  s_and_b32 s54, s54, 0x2000
  s_and_b32 s55, s55, 0x2000
  s_mov_b32 s68, 0xfffffffe
  v_and_b32 v136, 3, v0
  s_lshl_b32 s46, s43, 9
  s_add_u32 s46, s46, s55
  s_add_u32 s46, s46, 2883584
  v_lshl_add_u32 v10, v136, 7, s46
  s_lshl_b32 s46, s43, 7
  s_add_u32 s46, s46, s55
  s_add_u32 s46, s46, 2885632
  v_lshl_add_u32 v11, v136, 9, s46
  v_mov_b32 v7, 0x44444444
  v_mov_b32 v136, 0xeeeeeeee
  v_and_b32 v137, 2, v0
  v_cmp_ne_u32 vcc, 0, v137
  s_nop 1
  v_cndmask_b32 v7, v7, v136, vcc
  s_mov_b32 s69, 1037384597
  s_mov_b32 s70, 3494803967
  v_and_b32 v136, 15, v0
  v_lshrrev_b32 v138, 4, v0
  v_lshlrev_b32 v4, 4, v136
  v_lshl_add_u32 v4, v138, 2, v4
  s_lshl_b32 s46, s42, 8
  s_add_u32 s46, s46, 147456
  v_add_u32 v4, s46, v4
  v_lshlrev_b32 v5, 7, v138
  v_bfe_u32 v137, v0, 2, 2
  v_lshl_add_u32 v5, v137, 4, v5
  v_and_b32 v137, 1, v0
  v_lshl_add_u32 v5, v137, 3, v5
  v_add_u32 v5, 147456, v5
  v_add_u32 v13, 122880, v1
  v_bfe_u32 v140, v0, 1, 2
  v_lshl_add_u32 v140, v140, 2, v137
  v_bfe_u32 v137, v0, 3, 1
  v_lshl_add_u32 v140, v137, 1, v140
  v_cmp_eq_u32 s[18:19], 1, v137
  s_add_u32 s46, s55, 2097152
  s_lshr_b32 s47, s45, 4
  s_add_u32 s47, s47, 1
  s_lshl_b32 s47, s47, 14
  s_and_b32 s48, s45, 15
  s_lshl_b32 s48, s48, 9
  s_add_u32 s47, s47, s48
  s_add_u32 s47, s47, s46
  v_lshrrev_b32 v137, 1, v138
  v_and_b32 v139, 1, v138
  v_lshl_add_u32 v8, v137, 4, v140
  v_lshlrev_b32 v8, 4, v8
  v_lshl_add_u32 v8, v139, 3, v8
  v_add_u32 v8, s47, v8
  s_lshl_b32 s47, s45, 7
  s_add_u32 s47, s47, s46
  s_add_u32 s47, s47, 51200
  v_lshlrev_b32 v9, 3, v140
  v_lshl_add_u32 v9, v139, 2, v9
  v_add_u32 v9, s47, v9
  v_lshl_add_u32 v9, v137, 30, v9
  v_mov_b32 v140, 2146435072
  s_cmp_eq_u32 s44, 0
  s_cselect_b64 vcc, 15, 0
  v_cndmask_b32 v11, v140, v11, vcc
  v_lshlrev_b32 v14, 4, v136
  v_lshl_add_u32 v14, v139, 3, v14
  v_lshl_add_u32 v14, v137, 2, v14
  s_mul_i32 s47, s45, 768
  s_sub_u32 s47, 32768, s47
  v_add_u32 v14, s47, v14
  s_lshl_b32 s47, s42, 4
  v_add_u32 v136, s47, v136
  v_lshlrev_b32 v138, 2, v138
  v_sub_u32 v136, v136, v138
  v_cmp_gt_i32 s[72:73], 0, v136
  v_cmp_gt_i32 s[74:75], 1, v136
  v_cmp_gt_i32 s[76:77], 2, v136
  v_cmp_gt_i32 s[78:79], 3, v136
  v_cmp_gt_i32 s[80:81], 16, v136
  v_cmp_gt_i32 s[82:83], 17, v136
  v_cmp_gt_i32 s[84:85], 18, v136
  v_cmp_gt_i32 s[86:87], 19, v136
  s_lshl_b32 s46, s45, 7
  s_lshl_b32 s47, s42, 2
  s_add_u32 s47, s47, s46
  s_add_u32 s47, s47, 2981888
  v_mov_b32 v15, s47
  s_cmp_lg_u32 s42, 2
  s_cbranch_scc1 sc_fl
  v_and_b32 v15, 1, v0
  v_lshlrev_b32 v15, 14, v15
  s_add_u32 s46, s46, 2899968
  v_add_u32 v15, s46, v15
sc_fl:
  s_mul_i32 s63, s45, 786432
  s_mul_i32 s20, s42, 6144
  s_add_u32 s20, s20, s63
  s_add_u32 s20, s20, 8388608
  s_cmp_eq_u32 s42, 2
  s_cselect_b32 s20, 2146435072, s20
  s_lshl_b32 s21, s42, 12
  s_add_u32 s63, s63, s21
  s_add_u32 s63, s63, 33554432
  s_add_u32 s21, s21, 122880
  s_mov_b32 s22, 12288
  s_lshl_b32 s64, s45, 10
  s_mul_i32 s46, s42, 40960
  s_add_u32 s64, s64, s46
  s_add_u32 s64, s64, 188743680
  s_mov_b32 s61, 0
  s_mov_b32 s52, 0
  s_mov_b32 s58, 0
  s_mov_b32 s65, 524288
  s_mov_b32 s100, 0
  s_cmp_lg_u32 s42, 2
  s_cbranch_scc1 sc_k0
  s_mov_b32 s53, 1
  s_cmp_ge_u32 s61, s53
  s_cbranch_scc1 wf_done_26
  s_mov_b32 s50, 0
wf_loop_27:
  buffer_load_dword v136, v15, s[8:11], 0 offen sc1
  s_add_u32 s50, s50, 1
  s_cmp_gt_u32 s50, 131072
  s_cbranch_scc1 L_fail
  s_waitcnt vmcnt(0)
  v_min_u32_dpp v136, v136, v136 row_ror:8 row_mask:0xf bank_mask:0xf
  s_nop 1
  v_min_u32_dpp v136, v136, v136 row_ror:4 row_mask:0xf bank_mask:0xf
  s_nop 1
  v_min_u32_dpp v136, v136, v136 row_ror:2 row_mask:0xf bank_mask:0xf
  s_nop 1
  v_min_u32_dpp v136, v136, v136 row_ror:1 row_mask:0xf bank_mask:0xf
  v_mov_b32 v137, v136
  s_nop 1
  v_permlane16_swap_b32 v137, v136
  v_min_u32 v136, v136, v137
  v_mov_b32 v137, v136
  s_nop 1
  v_permlane32_swap_b32 v137, v136
  v_min_u32 v136, v136, v137
  s_nop 0
  v_readfirstlane_b32 s61, v136
  s_nop 0
  s_cmp_ge_u32 s61, s53
  s_cbranch_scc1 wf_done_26
  s_sleep 2
  s_branch wf_loop_27
wf_done_26:
sc_k0:
  s_barrier
  s_cmp_eq_u32 s42, 3
  s_cbranch_scc1 scs_loop
  s_mov_b32 m0, s21
  s_nop 0
  buffer_load_dwordx4 v1, s[8:11], s63 offen offset:0 sc1 lds
  buffer_load_dwordx4 v1, s[8:11], s63 offen offset:1024 sc1 lds
  buffer_load_dwordx4 v1, s[8:11], s63 offen offset:2048 sc1 lds
  buffer_load_dwordx4 v1, s[8:11], s63 offen offset:3072 sc1 lds
  s_waitcnt vmcnt(0)
  s_branch sch_loop
scs_loop:
  s_add_u32 s53, s52, 1
  s_lshl_b32 s56, s58, 2
  s_add_u32 s56, s56, s43
  s_lshl_b32 s56, s56, 16
  s_add_u32 s56, s56, s55
  s_add_u32 s56, s56, 2097152
  v_add_u32 v12, s56, v1
  s_lshl_b32 s66, s58, 18
  s_mov_b64 s[16:17], -1
  s_mov_b32 s71, 0
  ds_read_b128 v[56:59], v2 offset:0
  ds_read_b128 v[60:63], v2 offset:4096
  ds_read_b128 v[64:67], v2 offset:8192
  ds_read_b128 v[68:71], v2 offset:12288
  ds_read_b128 v[72:75], v2 offset:16384
  ds_read_b128 v[76:79], v2 offset:20480
  ds_read_b128 v[80:83], v2 offset:24576
  ds_read_b128 v[84:87], v2 offset:28672
  v_mov_b32 v88, 0
  v_mov_b32 v89, 0
  v_mov_b32 v90, 0
  v_mov_b32 v91, 0
  v_mov_b32 v92, 0
  v_mov_b32 v93, 0
  v_mov_b32 v94, 0
  v_mov_b32 v95, 0
  v_mov_b32 v96, 0
  v_mov_b32 v97, 0
  v_mov_b32 v98, 0
  v_mov_b32 v99, 0
  v_mov_b32 v100, 0
  v_mov_b32 v101, 0
  v_mov_b32 v102, 0
  v_mov_b32 v103, 0
  v_mov_b32 v104, 0
  v_mov_b32 v105, 0
  v_mov_b32 v106, 0
  v_mov_b32 v107, 0
  v_mov_b32 v108, 0
  v_mov_b32 v109, 0
  v_mov_b32 v110, 0
  v_mov_b32 v111, 0
  v_mov_b32 v6, s53
  s_waitcnt lgkmcnt(0)
  s_barrier
  buffer_load_dwordx4 v[16:19], v12, s[8:11], s24 offen sc1
  s_barrier
  buffer_load_dwordx4 v[20:23], v12, s[8:11], s25 offen sc1
  s_barrier
  buffer_load_dwordx4 v[24:27], v12, s[8:11], s26 offen sc1
  s_barrier
  buffer_load_dwordx4 v[28:31], v12, s[8:11], s27 offen sc1
  s_barrier
  buffer_load_dwordx4 v[32:35], v12, s[8:11], s28 offen sc1
  s_barrier
  buffer_load_dwordx4 v[36:39], v12, s[8:11], s29 offen sc1
  s_barrier
  buffer_load_dwordx4 v[40:43], v12, s[8:11], s30 offen sc1
  s_barrier
  buffer_load_dwordx4 v[44:47], v12, s[8:11], s31 offen sc1
  s_barrier
  buffer_load_dwordx4 v[48:51], v12, s[8:11], s32 offen sc1
  s_barrier
  buffer_load_dwordx4 v[52:55], v12, s[8:11], s33 offen sc1
scs_go_28:
  s_waitcnt vmcnt(9)
  v_smfmac_f32_16x16x64_bf16 v[88:91], v[16:19], a[0:7], v7
  v_smfmac_f32_16x16x64_bf16 v[92:95], v[16:19], a[8:15], v7
  v_smfmac_f32_16x16x64_bf16 v[96:99], v[16:19], a[16:23], v7
  v_smfmac_f32_16x16x64_bf16 v[100:103], v[16:19], a[24:31], v7
  s_waitcnt vmcnt(8)
  v_smfmac_f32_16x16x64_bf16 v[88:91], v[20:23], a[48:55], v7
  v_smfmac_f32_16x16x64_bf16 v[92:95], v[20:23], a[56:63], v7
  v_smfmac_f32_16x16x64_bf16 v[96:99], v[20:23], a[64:71], v7
  v_smfmac_f32_16x16x64_bf16 v[100:103], v[20:23], a[72:79], v7
  s_waitcnt vmcnt(7)
  v_smfmac_f32_16x16x64_bf16 v[88:91], v[24:27], v[56:63], v7
  v_smfmac_f32_16x16x64_bf16 v[92:95], v[24:27], v[64:71], v7
  ds_read_b128 v[56:59], v2 offset:49152
  v_smfmac_f32_16x16x64_bf16 v[96:99], v[24:27], v[72:79], v7
  ds_read_b128 v[60:63], v2 offset:53248
  v_smfmac_f32_16x16x64_bf16 v[100:103], v[24:27], a[96:103], v7
  ds_read_b128 v[64:67], v2 offset:57344
  s_waitcnt vmcnt(6)
  v_smfmac_f32_16x16x64_bf16 v[88:91], v[28:31], a[120:127], v7
  ds_read_b128 v[68:71], v2 offset:61440
  v_smfmac_f32_16x16x64_bf16 v[92:95], v[28:31], a[128:135], v7
  ds_read_b128 v[72:75], v3 offset:0
  v_smfmac_f32_16x16x64_bf16 v[96:99], v[28:31], a[136:143], v7
  ds_read_b128 v[76:79], v3 offset:4096
  v_smfmac_f32_16x16x64_bf16 v[100:103], v[28:31], a[144:151], v7
  s_waitcnt vmcnt(5)
  v_smfmac_f32_16x16x64_bf16 v[88:91], v[32:35], a[168:175], v7
  v_smfmac_f32_16x16x64_bf16 v[92:95], v[32:35], a[176:183], v7
  v_smfmac_f32_16x16x64_bf16 v[96:99], v[32:35], a[184:191], v7
  v_smfmac_f32_16x16x64_bf16 v[100:103], v[32:35], v[80:87], v7
  ds_read_b128 v[80:83], v3 offset:8192
  s_waitcnt vmcnt(4)
  s_waitcnt lgkmcnt(5)
  v_smfmac_f32_16x16x64_bf16 v[88:91], v[36:39], v[56:63], v7
  ds_read_b128 v[84:87], v3 offset:12288
  s_waitcnt lgkmcnt(4)
  v_smfmac_f32_16x16x64_bf16 v[92:95], v[36:39], v[64:71], v7
  ds_read_b128 v[56:59], v3 offset:32768
  s_waitcnt lgkmcnt(3)
  v_smfmac_f32_16x16x64_bf16 v[96:99], v[36:39], v[72:79], v7
  ds_read_b128 v[60:63], v3 offset:36864
  v_smfmac_f32_16x16x64_bf16 v[100:103], v[36:39], a[192:199], v7
  ds_read_b128 v[64:67], v3 offset:40960
  s_waitcnt vmcnt(3)
  v_smfmac_f32_16x16x64_bf16 v[88:91], v[40:43], a[216:223], v7
  ds_read_b128 v[68:71], v3 offset:45056
  v_smfmac_f32_16x16x64_bf16 v[92:95], v[40:43], a[224:231], v7
  ds_read_b128 v[72:75], v3 offset:49152
  v_smfmac_f32_16x16x64_bf16 v[96:99], v[40:43], a[232:239], v7
  ds_read_b128 v[76:79], v3 offset:53248
  v_smfmac_f32_16x16x64_bf16 v[100:103], v[40:43], a[240:247], v7
  s_waitcnt vmcnt(2)
  v_smfmac_f32_16x16x64_bf16 v[88:91], v[44:47], v[160:167], v7
  v_smfmac_f32_16x16x64_bf16 v[92:95], v[44:47], v[168:175], v7
  v_smfmac_f32_16x16x64_bf16 v[96:99], v[44:47], v[176:183], v7
  s_waitcnt lgkmcnt(6)
  v_smfmac_f32_16x16x64_bf16 v[100:103], v[44:47], v[80:87], v7
  ds_read_b128 v[80:83], v2 offset:32768
  s_waitcnt vmcnt(1)
  s_waitcnt lgkmcnt(5)
  v_smfmac_f32_16x16x64_bf16 v[88:91], v[48:51], v[56:63], v7
  ds_read_b128 v[84:87], v2 offset:36864
  s_waitcnt lgkmcnt(4)
  v_smfmac_f32_16x16x64_bf16 v[92:95], v[48:51], v[64:71], v7
  ds_read_b128 v[56:59], v3 offset:16384
  s_waitcnt lgkmcnt(3)
  v_smfmac_f32_16x16x64_bf16 v[96:99], v[48:51], v[72:79], v7
  ds_read_b128 v[60:63], v3 offset:20480
  v_smfmac_f32_16x16x64_bf16 v[100:103], v[48:51], v[184:191], v7
  ds_read_b128 v[64:67], v2 offset:40960
  s_waitcnt vmcnt(0)
  v_smfmac_f32_16x16x64_bf16 v[88:91], v[52:55], v[208:215], v7
  ds_read_b128 v[68:71], v2 offset:45056
  v_smfmac_f32_16x16x64_bf16 v[92:95], v[52:55], v[216:223], v7
  ds_read_b128 v[72:75], v3 offset:24576
  v_smfmac_f32_16x16x64_bf16 v[96:99], v[52:55], v[224:231], v7
  ds_read_b128 v[76:79], v3 offset:28672
  v_smfmac_f32_16x16x64_bf16 v[100:103], v[52:55], v[232:239], v7
  v_smfmac_f32_16x16x64_bf16 v[104:107], v[16:19], a[32:39], v7
  v_add_f32 v88, v88, v90
  v_smfmac_f32_16x16x64_bf16 v[104:107], v[20:23], a[80:87], v7
  v_add_f32 v89, v89, v91
  v_smfmac_f32_16x16x64_bf16 v[104:107], v[24:27], a[104:111], v7
  v_cmp_u_f32 vcc, v88, v89
  v_smfmac_f32_16x16x64_bf16 v[104:107], v[28:31], a[152:159], v7
  v_cvt_pk_bf16_f32 v136, v88, v89
  v_smfmac_f32_16x16x64_bf16 v[104:107], v[36:39], a[200:207], v7
  s_and_b64 vcc, vcc, s[16:17]
  s_cbranch_scc1 scs_redo_29
  v_add_f32 v92, v92, v94
  v_smfmac_f32_16x16x64_bf16 v[104:107], v[40:43], a[248:255], v7
  ds_write_b32 v4, v136 offset:0
  v_add_f32 v93, v93, v95
  v_smfmac_f32_16x16x64_bf16 v[104:107], v[48:51], v[192:199], v7
  s_waitcnt lgkmcnt(1)
  v_cvt_pk_bf16_f32 v137, v92, v93
  v_smfmac_f32_16x16x64_bf16 v[104:107], v[52:55], v[240:247], v7
  ds_write_b32 v4, v137 offset:1024
  v_add_f32 v96, v96, v98
  v_smfmac_f32_16x16x64_bf16 v[104:107], v[32:35], v[80:87], v7
  v_add_f32 v97, v97, v99
  v_smfmac_f32_16x16x64_bf16 v[104:107], v[44:47], v[56:63], v7
  ds_read_b128 v[80:83], v13 offset:3072
  v_cvt_pk_bf16_f32 v138, v96, v97
  v_smfmac_f32_16x16x64_bf16 v[108:111], v[32:35], v[64:71], v7
  ds_write_b32 v4, v138 offset:2048
  v_add_f32 v100, v100, v102
  v_smfmac_f32_16x16x64_bf16 v[108:111], v[44:47], v[72:79], v7
  ds_read_b128 v[56:59], v13 offset:0
  v_add_f32 v101, v101, v103
  v_smfmac_f32_16x16x64_bf16 v[108:111], v[16:19], a[40:47], v7
  ds_read_b128 v[60:63], v13 offset:6144
  v_cvt_pk_bf16_f32 v139, v100, v101
  v_smfmac_f32_16x16x64_bf16 v[108:111], v[20:23], a[88:95], v7
  ds_write_b32 v4, v139 offset:3072
  v_add_f32 v104, v104, v106
  v_smfmac_f32_16x16x64_bf16 v[108:111], v[24:27], a[112:119], v7
  s_waitcnt lgkmcnt(3)
  s_barrier
  v_add_f32 v105, v105, v107
  v_smfmac_f32_16x16x64_bf16 v[108:111], v[28:31], a[160:167], v7
  ds_read_b64_tr_b16 v[112:113], v5 offset:0
  ds_read_b64_tr_b16 v[114:115], v5 offset:64
  v_cvt_pk_bf16_f32 v140, v104, v105
  v_smfmac_f32_16x16x64_bf16 v[108:111], v[36:39], a[208:215], v7
  ds_write_b32 v4, v140 offset:4096
  ds_read_b64_tr_b16 v[116:117], v5 offset:512
  v_smfmac_f32_16x16x64_bf16 v[108:111], v[40:43], v[152:159], v7
  ds_read_b64_tr_b16 v[118:119], v5 offset:576
  ds_read_b128 v[64:67], v13 offset:1024
  v_smfmac_f32_16x16x64_bf16 v[108:111], v[48:51], v[200:207], v7
  ds_read_b64_tr_b16 v[120:121], v5 offset:1024
  ds_read_b128 v[68:71], v13 offset:7168
  v_smfmac_f32_16x16x64_bf16 v[108:111], v[52:55], v[248:255], v7
  ds_read_b64_tr_b16 v[122:123], v5 offset:1088
  ds_read_b128 v[72:75], v13 offset:2048
  s_waitcnt lgkmcnt(8)
  v_mfma_f32_16x16x32_bf16 v[88:91], v[56:59], v[112:115], 0
  ds_read_b128 v[76:79], v13 offset:8192
  ds_read_b128 v[84:87], v13 offset:9216
  v_mfma_f32_16x16x32_bf16 v[92:95], v[60:63], v[112:115], 0
  ds_read_b64_tr_b16 v[124:125], v5 offset:1536
  ds_read_b64_tr_b16 v[126:127], v5 offset:1600
  s_waitcnt lgkmcnt(8)
  v_add_f32 v108, v108, v110
  v_mfma_f32_16x16x32_bf16 v[88:91], v[64:67], v[116:119], v[88:91]
  s_waitcnt lgkmcnt(6)
  v_add_f32 v109, v109, v111
  v_cvt_pk_bf16_f32 v141, v108, v109
  v_mfma_f32_16x16x32_bf16 v[92:95], v[68:71], v[116:119], v[92:95]
  ds_write_b32 v4, v141 offset:5120
  ds_read_b128 v[56:59], v13 offset:4096
  s_waitcnt lgkmcnt(6)
  v_mfma_f32_16x16x32_bf16 v[88:91], v[72:75], v[120:123], v[88:91]
  ds_read_b64_tr_b16 v[128:129], v5 offset:2048
  ds_read_b64_tr_b16 v[130:131], v5 offset:2112
  buffer_store_dword v6, v11, s[8:11], 0 offen sc1
  s_waitcnt lgkmcnt(7)
  v_mfma_f32_16x16x32_bf16 v[92:95], v[76:79], v[120:123], v[92:95]
  ds_read_b128 v[60:63], v13 offset:10240
  ds_read_b128 v[64:67], v13 offset:5120
  s_waitcnt lgkmcnt(6)
  v_mfma_f32_16x16x32_bf16 v[88:91], v[80:83], v[124:127], v[88:91]
  ds_read_b64_tr_b16 v[132:133], v5 offset:2560
  ds_read_b64_tr_b16 v[134:135], v5 offset:2624
  v_mfma_f32_16x16x32_bf16 v[92:95], v[84:87], v[124:127], v[92:95]
  ds_read_b128 v[68:71], v13 offset:11264
  s_waitcnt lgkmcnt(8)
  s_barrier
  s_waitcnt lgkmcnt(5)
  v_mfma_f32_16x16x32_bf16 v[88:91], v[56:59], v[128:131], v[88:91]
  ds_read_b64_tr_b16 v[16:17], v5 offset:3072
  ds_read_b64_tr_b16 v[18:19], v5 offset:3136
  s_waitcnt lgkmcnt(6)
  v_mfma_f32_16x16x32_bf16 v[92:95], v[60:63], v[128:131], v[92:95]
  ds_read_b64_tr_b16 v[20:21], v5 offset:3584
  ds_read_b64_tr_b16 v[22:23], v5 offset:3648
  s_waitcnt lgkmcnt(5)
  v_mfma_f32_16x16x32_bf16 v[88:91], v[64:67], v[132:135], v[88:91]
  ds_read_b64_tr_b16 v[24:25], v5 offset:4096
  ds_read_b64_tr_b16 v[26:27], v5 offset:4160
  s_waitcnt lgkmcnt(6)
  v_mfma_f32_16x16x32_bf16 v[92:95], v[68:71], v[132:135], v[92:95]
  ds_read_b64_tr_b16 v[28:29], v5 offset:4608
  ds_read_b64_tr_b16 v[30:31], v5 offset:4672
  s_waitcnt lgkmcnt(6)
  v_mfma_f32_16x16x32_bf16 v[96:99], v[16:19], v[112:115], 0
  ds_read_b64_tr_b16 v[32:33], v5 offset:5120
  ds_read_b64_tr_b16 v[34:35], v5 offset:5184
  s_waitcnt lgkmcnt(6)
  v_mfma_f32_16x16x32_bf16 v[96:99], v[20:23], v[116:119], v[96:99]
  ds_read_b64_tr_b16 v[36:37], v5 offset:5632
  ds_read_b64_tr_b16 v[38:39], v5 offset:5696
  s_waitcnt lgkmcnt(6)
  v_cndmask_b32 v136, v88, v90, s[18:19]
  v_mfma_f32_16x16x32_bf16 v[96:99], v[24:27], v[120:123], v[96:99]
  s_barrier
  s_waitcnt lgkmcnt(4)
  v_cndmask_b32 v137, v89, v91, s[18:19]
  v_cndmask_b32 v138, v92, v94, s[18:19]
  v_mfma_f32_16x16x32_bf16 v[96:99], v[28:31], v[124:127], v[96:99]
  s_waitcnt lgkmcnt(2)
  v_cndmask_b32 v139, v93, v95, s[18:19]
  v_max3_f32 v142, v136, v137, v138
  v_mfma_f32_16x16x32_bf16 v[96:99], v[32:35], v[128:131], v[96:99]
  s_waitcnt lgkmcnt(0)
  v_max_f32 v142, v142, v139
  v_mov_b32 v143, v142
  v_mfma_f32_16x16x32_bf16 v[96:99], v[36:39], v[132:135], v[96:99]
  s_nop 0
  v_permlane32_swap_b32 v143, v142
  v_max_f32 v142, v142, v143
  s_nop 4
  v_cndmask_b32 v140, v96, v98, s[18:19]
  v_cndmask_b32 v141, v97, v99, s[18:19]
  v_max3_f32 v142, v142, v140, v141
  s_nop 1
  v_max_f32_dpp v142, v142, v142 row_ror:8 row_mask:0xf bank_mask:0xf
  v_mov_b32 v143, v142
  s_nop 1
  v_permlane16_swap_b32 v143, v142
  v_max_f32 v142, v142, v143
  v_mul_f32 v142, s69, v142
  v_fma_f32 v136, v136, s69, -v142
  v_fma_f32 v137, v137, s69, -v142
  v_fma_f32 v138, v138, s69, -v142
  v_fma_f32 v139, v139, s69, -v142
  v_fma_f32 v140, v140, s69, -v142
  v_fma_f32 v141, v141, s69, -v142
  v_exp_f32 v136, v136
  v_exp_f32 v137, v137
  v_exp_f32 v138, v138
  v_exp_f32 v139, v139
  v_add_f32 v142, v136, v137
  v_add_f32 v143, v138, v139
  v_add_f32 v142, v142, v143
  v_mov_b32 v143, v142
  v_exp_f32 v140, v140
  v_exp_f32 v141, v141
  v_permlane32_swap_b32 v143, v142
  v_add_f32 v144, v140, v141
  v_add_f32 v142, v142, v143
  v_add_f32 v142, v142, v144
  s_nop 1
  v_add_f32_dpp v142, v142, v142 row_ror:8 row_mask:0xf bank_mask:0xf
  v_mov_b32 v143, v142
  s_nop 1
  v_permlane16_swap_b32 v143, v142
  v_add_f32 v142, v142, v143
  v_rcp_f32 v142, v142
  s_nop 0
  v_mul_f32 v136, v136, v142
  v_mul_f32 v137, v137, v142
  v_mul_f32 v138, v138, v142
  v_mul_f32 v139, v139, v142
  v_cvt_pk_bf16_f32 v146, v136, v137
  v_cvt_pk_bf16_f32 v147, v138, v139
  buffer_store_dwordx2 v[146:147], v8, s[8:11], s66 offen sc1
  v_mul_f32 v140, v140, v142
  v_mul_f32 v141, v141, v142
  v_cvt_pk_bf16_f32 v148, v140, v141
  buffer_store_dword v148, v9, s[8:11], s66 offen sc1
  v_mov_b32 v150, -1
  v_mov_b32 v151, -1
  s_add_u32 s46, s65, 0
  buffer_store_dwordx2 v[150:151], v8, s[8:11], s46 offen sc1
  buffer_store_dword v150, v9, s[8:11], s46 offen sc1
  s_mov_b32 s65, s66
  v_add_u32 v13, s22, v13
  s_sub_u32 s22, 0, s22
  s_add_u32 s58, s58, 1
  s_cmp_eq_u32 s58, 3
  s_cselect_b32 s58, 0, s58
  s_mov_b32 s52, s53
  s_cmp_lt_u32 s52, 64
  s_cbranch_scc1 scs_loop
  s_endpgm
sch_loop:
  s_add_u32 s53, s52, 1
  s_lshl_b32 s56, s58, 2
  s_add_u32 s56, s56, s43
  s_lshl_b32 s56, s56, 16
  s_add_u32 s56, s56, s55
  s_add_u32 s56, s56, 2097152
  v_add_u32 v12, s56, v1
  s_lshl_b32 s66, s58, 18
  s_mov_b64 s[16:17], -1
  s_mov_b32 s71, 0
  ds_read_b128 v[56:59], v2 offset:0
  ds_read_b128 v[60:63], v2 offset:4096
  ds_read_b128 v[64:67], v2 offset:8192
  ds_read_b128 v[68:71], v2 offset:12288
  ds_read_b128 v[72:75], v2 offset:16384
  ds_read_b128 v[76:79], v2 offset:20480
  ds_read_b128 v[80:83], v2 offset:24576
  ds_read_b128 v[84:87], v2 offset:28672
  v_mov_b32 v88, 0
  v_mov_b32 v89, 0
  v_mov_b32 v90, 0
  v_mov_b32 v91, 0
  v_mov_b32 v92, 0
  v_mov_b32 v93, 0
  v_mov_b32 v94, 0
  v_mov_b32 v95, 0
  v_mov_b32 v96, 0
  v_mov_b32 v97, 0
  v_mov_b32 v98, 0
  v_mov_b32 v99, 0
  v_mov_b32 v100, 0
  v_mov_b32 v101, 0
  v_mov_b32 v102, 0
  v_mov_b32 v103, 0
  v_mov_b32 v104, 0
  v_mov_b32 v105, 0
  v_mov_b32 v106, 0
  v_mov_b32 v107, 0
  v_mov_b32 v108, 0
  v_mov_b32 v109, 0
  v_mov_b32 v110, 0
  v_mov_b32 v111, 0
  s_add_u32 s63, s63, 12288
  s_add_u32 s21, s21, s22
  s_mov_b32 m0, s21
  s_add_u32 s23, s20, 4096
  s_cmp_lg_u32 s42, 2
  s_cbranch_scc1 sc_nobell
  s_add_u32 s49, s52, 2
  s_min_u32 s49, s49, 64
  s_cmp_ge_u32 s61, s49
  s_cbranch_scc1 wf_done_30
  s_mov_b32 s50, 0
wf_loop_31:
  buffer_load_dword v136, v15, s[8:11], 0 offen sc1
  s_add_u32 s50, s50, 1
  s_cmp_gt_u32 s50, 131072
  s_cbranch_scc1 L_fail
  s_waitcnt vmcnt(0)
  v_min_u32_dpp v136, v136, v136 row_ror:8 row_mask:0xf bank_mask:0xf
  s_nop 1
  v_min_u32_dpp v136, v136, v136 row_ror:4 row_mask:0xf bank_mask:0xf
  s_nop 1
  v_min_u32_dpp v136, v136, v136 row_ror:2 row_mask:0xf bank_mask:0xf
  s_nop 1
  v_min_u32_dpp v136, v136, v136 row_ror:1 row_mask:0xf bank_mask:0xf
  v_mov_b32 v137, v136
  s_nop 1
  v_permlane16_swap_b32 v137, v136
  v_min_u32 v136, v136, v137
  v_mov_b32 v137, v136
  s_nop 1
  v_permlane32_swap_b32 v137, v136
  v_min_u32 v136, v136, v137
  s_nop 0
  v_readfirstlane_b32 s61, v136
  s_nop 0
  s_cmp_ge_u32 s61, s49
  s_cbranch_scc1 wf_done_30
  s_sleep 2
  s_branch wf_loop_31
wf_done_30:
  s_mov_b32 s50, 0
  s_mov_b64 exec, 15
  buffer_load_dword v112, v10, s[8:11], 0 offen sc1
  s_nop 11
  buffer_load_dword v113, v10, s[8:11], 0 offen sc1
  s_nop 11
  buffer_load_dword v114, v10, s[8:11], 0 offen sc1
  s_nop 11
  buffer_load_dword v115, v10, s[8:11], 0 offen sc1
  s_nop 11
  buffer_load_dword v116, v10, s[8:11], 0 offen sc1
  s_nop 11
  buffer_load_dword v117, v10, s[8:11], 0 offen sc1
  s_nop 11
  buffer_load_dword v118, v10, s[8:11], 0 offen sc1
  s_nop 11
  buffer_load_dword v119, v10, s[8:11], 0 offen sc1
  s_nop 11
  buffer_load_dword v120, v10, s[8:11], 0 offen sc1
  s_nop 11
bell_32:
  buffer_load_dword v121, v10, s[8:11], 0 offen sc1
  s_waitcnt vmcnt(9)
  v_cmp_gt_u32 vcc, s53, v112
  s_cbranch_vccz bell_x_33
  s_nop 7
  buffer_load_dword v112, v10, s[8:11], 0 offen sc1
  s_waitcnt vmcnt(9)
  v_cmp_gt_u32 vcc, s53, v113
  s_cbranch_vccz bell_x_33
  s_nop 7
  buffer_load_dword v113, v10, s[8:11], 0 offen sc1
  s_waitcnt vmcnt(9)
  v_cmp_gt_u32 vcc, s53, v114
  s_cbranch_vccz bell_x_33
  s_nop 7
  buffer_load_dword v114, v10, s[8:11], 0 offen sc1
  s_waitcnt vmcnt(9)
  v_cmp_gt_u32 vcc, s53, v115
  s_cbranch_vccz bell_x_33
  s_nop 7
  buffer_load_dword v115, v10, s[8:11], 0 offen sc1
  s_waitcnt vmcnt(9)
  v_cmp_gt_u32 vcc, s53, v116
  s_cbranch_vccz bell_x_33
  s_nop 7
  buffer_load_dword v116, v10, s[8:11], 0 offen sc1
  s_waitcnt vmcnt(9)
  v_cmp_gt_u32 vcc, s53, v117
  s_cbranch_vccz bell_x_33
  s_nop 7
  buffer_load_dword v117, v10, s[8:11], 0 offen sc1
  s_waitcnt vmcnt(9)
  v_cmp_gt_u32 vcc, s53, v118
  s_cbranch_vccz bell_x_33
  s_nop 7
  buffer_load_dword v118, v10, s[8:11], 0 offen sc1
  s_waitcnt vmcnt(9)
  v_cmp_gt_u32 vcc, s53, v119
  s_cbranch_vccz bell_x_33
  s_nop 7
  buffer_load_dword v119, v10, s[8:11], 0 offen sc1
  s_waitcnt vmcnt(9)
  v_cmp_gt_u32 vcc, s53, v120
  s_cbranch_vccz bell_x_33
  s_nop 7
  buffer_load_dword v120, v10, s[8:11], 0 offen sc1
  s_waitcnt vmcnt(9)
  v_cmp_gt_u32 vcc, s53, v121
  s_cbranch_vccz bell_x_33
  s_add_u32 s50, s50, 1
  s_cmp_gt_u32 s50, 131072
  s_cbranch_scc1 L_fail
  s_branch bell_32
bell_x_33:
  s_mov_b64 exec, -1
sc_nobell:
  s_waitcnt lgkmcnt(0)
  s_barrier
  buffer_load_dwordx4 v[16:19], v12, s[8:11], s24 offen sc1
  s_barrier
  buffer_load_dwordx4 v[20:23], v12, s[8:11], s25 offen sc1
  s_barrier
  buffer_load_dwordx4 v[24:27], v12, s[8:11], s26 offen sc1
  s_barrier
  buffer_load_dwordx4 v[28:31], v12, s[8:11], s27 offen sc1
  s_barrier
  buffer_load_dwordx4 v[32:35], v12, s[8:11], s28 offen sc1
  s_barrier
  buffer_load_dwordx4 v[36:39], v12, s[8:11], s29 offen sc1
  s_barrier
  buffer_load_dwordx4 v[40:43], v12, s[8:11], s30 offen sc1
  s_barrier
  buffer_load_dwordx4 v[44:47], v12, s[8:11], s31 offen sc1
  s_barrier
  buffer_load_dwordx4 v[48:51], v12, s[8:11], s32 offen sc1
  s_barrier
  buffer_load_dwordx4 v[52:55], v12, s[8:11], s33 offen sc1
sch_go_34:
  s_waitcnt vmcnt(9)
  v_smfmac_f32_16x16x64_bf16 v[88:91], v[16:19], a[0:7], v7
  v_smfmac_f32_16x16x64_bf16 v[92:95], v[16:19], a[8:15], v7
  v_smfmac_f32_16x16x64_bf16 v[96:99], v[16:19], a[16:23], v7
  v_smfmac_f32_16x16x64_bf16 v[100:103], v[16:19], a[24:31], v7
  s_waitcnt vmcnt(8)
  v_smfmac_f32_16x16x64_bf16 v[88:91], v[20:23], a[48:55], v7
  v_smfmac_f32_16x16x64_bf16 v[92:95], v[20:23], a[56:63], v7
  v_smfmac_f32_16x16x64_bf16 v[96:99], v[20:23], a[64:71], v7
  v_smfmac_f32_16x16x64_bf16 v[100:103], v[20:23], a[72:79], v7
  s_waitcnt vmcnt(7)
  v_smfmac_f32_16x16x64_bf16 v[88:91], v[24:27], v[56:63], v7
  buffer_load_dwordx4 v[112:115], v1, s[8:11], s20 offen offset:0 sc1
  v_smfmac_f32_16x16x64_bf16 v[92:95], v[24:27], v[64:71], v7
  ds_read_b128 v[56:59], v2 offset:49152
  v_smfmac_f32_16x16x64_bf16 v[96:99], v[24:27], v[72:79], v7
  ds_read_b128 v[60:63], v2 offset:53248
  v_smfmac_f32_16x16x64_bf16 v[100:103], v[24:27], a[96:103], v7
  ds_read_b128 v[64:67], v2 offset:57344
  buffer_load_dwordx4 v[116:119], v1, s[8:11], s20 offen offset:1024 sc1
  s_waitcnt vmcnt(8)
  v_smfmac_f32_16x16x64_bf16 v[88:91], v[28:31], a[120:127], v7
  ds_read_b128 v[68:71], v2 offset:61440
  v_smfmac_f32_16x16x64_bf16 v[92:95], v[28:31], a[128:135], v7
  ds_read_b128 v[72:75], v3 offset:0
  v_smfmac_f32_16x16x64_bf16 v[96:99], v[28:31], a[136:143], v7
  ds_read_b128 v[76:79], v3 offset:4096
  buffer_load_dwordx4 v[120:123], v1, s[8:11], s20 offen offset:2048 sc1
  v_smfmac_f32_16x16x64_bf16 v[100:103], v[28:31], a[144:151], v7
  s_waitcnt vmcnt(8)
  v_smfmac_f32_16x16x64_bf16 v[88:91], v[32:35], a[168:175], v7
  v_smfmac_f32_16x16x64_bf16 v[92:95], v[32:35], a[176:183], v7
  buffer_load_dwordx4 v[124:127], v1, s[8:11], s20 offen offset:3072 sc1
  v_smfmac_f32_16x16x64_bf16 v[96:99], v[32:35], a[184:191], v7
  v_smfmac_f32_16x16x64_bf16 v[100:103], v[32:35], v[80:87], v7
  ds_read_b128 v[80:83], v3 offset:8192
  s_waitcnt vmcnt(8)
  s_waitcnt lgkmcnt(5)
  v_smfmac_f32_16x16x64_bf16 v[88:91], v[36:39], v[56:63], v7
  ds_read_b128 v[84:87], v3 offset:12288
  buffer_load_dwordx4 v[128:131], v1, s[8:11], s23 offen offset:0 sc1
  s_waitcnt lgkmcnt(4)
  v_smfmac_f32_16x16x64_bf16 v[92:95], v[36:39], v[64:71], v7
  ds_read_b128 v[56:59], v3 offset:32768
  s_waitcnt lgkmcnt(3)
  v_smfmac_f32_16x16x64_bf16 v[96:99], v[36:39], v[72:79], v7
  ds_read_b128 v[60:63], v3 offset:36864
  v_smfmac_f32_16x16x64_bf16 v[100:103], v[36:39], a[192:199], v7
  ds_read_b128 v[64:67], v3 offset:40960
  buffer_load_dwordx4 v[132:135], v1, s[8:11], s23 offen offset:1024 sc1
  s_waitcnt vmcnt(9)
  v_smfmac_f32_16x16x64_bf16 v[88:91], v[40:43], a[216:223], v7
  ds_read_b128 v[68:71], v3 offset:45056
  v_smfmac_f32_16x16x64_bf16 v[92:95], v[40:43], a[224:231], v7
  ds_read_b128 v[72:75], v3 offset:49152
  v_smfmac_f32_16x16x64_bf16 v[96:99], v[40:43], a[232:239], v7
  ds_read_b128 v[76:79], v3 offset:53248
  buffer_load_dwordx4 v1, s[8:11], s63 offen offset:0 sc1 lds
  v_smfmac_f32_16x16x64_bf16 v[100:103], v[40:43], a[240:247], v7
  s_waitcnt vmcnt(9)
  v_smfmac_f32_16x16x64_bf16 v[88:91], v[44:47], v[160:167], v7
  v_smfmac_f32_16x16x64_bf16 v[92:95], v[44:47], v[168:175], v7
  buffer_load_dwordx4 v1, s[8:11], s63 offen offset:1024 sc1 lds
  v_smfmac_f32_16x16x64_bf16 v[96:99], v[44:47], v[176:183], v7
  s_waitcnt lgkmcnt(6)
  v_smfmac_f32_16x16x64_bf16 v[100:103], v[44:47], v[80:87], v7
  ds_read_b128 v[80:83], v2 offset:32768
  s_waitcnt vmcnt(9)
  s_waitcnt lgkmcnt(5)
  v_smfmac_f32_16x16x64_bf16 v[88:91], v[48:51], v[56:63], v7
  ds_read_b128 v[84:87], v2 offset:36864
  buffer_load_dwordx4 v1, s[8:11], s63 offen offset:2048 sc1 lds
  s_waitcnt lgkmcnt(4)
  v_smfmac_f32_16x16x64_bf16 v[92:95], v[48:51], v[64:71], v7
  ds_read_b128 v[56:59], v3 offset:16384
  s_waitcnt lgkmcnt(3)
  v_smfmac_f32_16x16x64_bf16 v[96:99], v[48:51], v[72:79], v7
  ds_read_b128 v[60:63], v3 offset:20480
  v_smfmac_f32_16x16x64_bf16 v[100:103], v[48:51], v[184:191], v7
  ds_read_b128 v[64:67], v2 offset:40960
  buffer_load_dwordx4 v1, s[8:11], s63 offen offset:3072 sc1 lds
  s_waitcnt vmcnt(10)
  v_smfmac_f32_16x16x64_bf16 v[88:91], v[52:55], v[208:215], v7
  ds_read_b128 v[68:71], v2 offset:45056
  v_smfmac_f32_16x16x64_bf16 v[92:95], v[52:55], v[216:223], v7
  ds_read_b128 v[72:75], v3 offset:24576
  v_smfmac_f32_16x16x64_bf16 v[96:99], v[52:55], v[224:231], v7
  ds_read_b128 v[76:79], v3 offset:28672
  v_smfmac_f32_16x16x64_bf16 v[100:103], v[52:55], v[232:239], v7
  v_smfmac_f32_16x16x64_bf16 v[104:107], v[16:19], a[32:39], v7
  v_add_f32 v88, v88, v90
  v_smfmac_f32_16x16x64_bf16 v[104:107], v[20:23], a[80:87], v7
  v_add_f32 v89, v89, v91
  v_smfmac_f32_16x16x64_bf16 v[104:107], v[24:27], a[104:111], v7
  v_cmp_u_f32 vcc, v88, v89
  v_smfmac_f32_16x16x64_bf16 v[104:107], v[28:31], a[152:159], v7
  v_cvt_pk_bf16_f32 v136, v88, v89
  v_smfmac_f32_16x16x64_bf16 v[104:107], v[36:39], a[200:207], v7
  s_and_b64 vcc, vcc, s[16:17]
  s_cbranch_scc1 sch_redo_35
  v_add_f32 v92, v92, v94
  v_smfmac_f32_16x16x64_bf16 v[104:107], v[40:43], a[248:255], v7
  ds_write_b32 v4, v136 offset:0
  v_add_f32 v93, v93, v95
  v_smfmac_f32_16x16x64_bf16 v[104:107], v[48:51], v[192:199], v7
  s_waitcnt lgkmcnt(1)
  v_cvt_pk_bf16_f32 v137, v92, v93
  v_smfmac_f32_16x16x64_bf16 v[104:107], v[52:55], v[240:247], v7
  ds_write_b32 v4, v137 offset:1024
  v_add_f32 v96, v96, v98
  v_smfmac_f32_16x16x64_bf16 v[104:107], v[32:35], v[80:87], v7
  v_add_f32 v97, v97, v99
  v_smfmac_f32_16x16x64_bf16 v[104:107], v[44:47], v[56:63], v7
  v_cvt_pk_bf16_f32 v138, v96, v97
  v_smfmac_f32_16x16x64_bf16 v[108:111], v[32:35], v[64:71], v7
  ds_write_b32 v4, v138 offset:2048
  v_add_f32 v100, v100, v102
  v_smfmac_f32_16x16x64_bf16 v[108:111], v[44:47], v[72:79], v7
  v_add_f32 v101, v101, v103
  v_smfmac_f32_16x16x64_bf16 v[108:111], v[16:19], a[40:47], v7
  v_cvt_pk_bf16_f32 v139, v100, v101
  v_smfmac_f32_16x16x64_bf16 v[108:111], v[20:23], a[88:95], v7
  ds_write_b32 v4, v139 offset:3072
  v_add_f32 v104, v104, v106
  v_smfmac_f32_16x16x64_bf16 v[108:111], v[24:27], a[112:119], v7
  s_waitcnt lgkmcnt(1)
  s_barrier
  v_add_f32 v105, v105, v107
  v_smfmac_f32_16x16x64_bf16 v[108:111], v[28:31], a[160:167], v7
  v_cvt_pk_bf16_f32 v140, v104, v105
  v_smfmac_f32_16x16x64_bf16 v[108:111], v[36:39], a[208:215], v7
  ds_write_b32 v4, v140 offset:4096
  v_smfmac_f32_16x16x64_bf16 v[108:111], v[40:43], v[152:159], v7
  v_smfmac_f32_16x16x64_bf16 v[108:111], v[48:51], v[200:207], v7
  v_smfmac_f32_16x16x64_bf16 v[108:111], v[52:55], v[248:255], v7
  s_nop 7
  v_add_f32 v108, v108, v110
  v_add_f32 v109, v109, v111
  v_cvt_pk_bf16_f32 v141, v108, v109
  ds_write_b32 v4, v141 offset:5120
  s_waitcnt lgkmcnt(0)
  s_barrier
  s_barrier
  s_cmp_ge_u32 s42, 2
  s_cbranch_scc1 sc_nox
  ds_read_b128 v[56:59], v13 offset:0
  ds_read_b128 v[60:63], v13 offset:6144
  ds_read_b128 v[64:67], v13 offset:1024
  ds_read_b128 v[68:71], v13 offset:7168
  ds_read_b128 v[72:75], v13 offset:2048
  ds_read_b128 v[76:79], v13 offset:8192
  ds_read_b128 v[80:83], v13 offset:3072
  ds_read_b128 v[84:87], v13 offset:9216
  s_waitcnt vmcnt(0)
  s_waitcnt lgkmcnt(7)
  v_mfma_f32_16x16x32_bf16 v[88:91], v[56:59], v[112:115], 0
  ds_read_b128 v[56:59], v13 offset:4096
  s_waitcnt lgkmcnt(7)
  v_mfma_f32_16x16x32_bf16 v[92:95], v[60:63], v[112:115], 0
  ds_read_b128 v[60:63], v13 offset:10240
  s_waitcnt lgkmcnt(7)
  v_mfma_f32_16x16x32_bf16 v[88:91], v[64:67], v[116:119], v[88:91]
  ds_read_b128 v[64:67], v13 offset:5120
  s_waitcnt lgkmcnt(7)
  v_mfma_f32_16x16x32_bf16 v[92:95], v[68:71], v[116:119], v[92:95]
  ds_read_b128 v[68:71], v13 offset:11264
  s_waitcnt lgkmcnt(7)
  v_mfma_f32_16x16x32_bf16 v[88:91], v[72:75], v[120:123], v[88:91]
  ds_read_b64_tr_b16 v[16:17], v5 offset:3072
  ds_read_b64_tr_b16 v[18:19], v5 offset:3136
  s_waitcnt lgkmcnt(8)
  v_mfma_f32_16x16x32_bf16 v[92:95], v[76:79], v[120:123], v[92:95]
  ds_read_b64_tr_b16 v[20:21], v5 offset:3584
  ds_read_b64_tr_b16 v[22:23], v5 offset:3648
  s_waitcnt lgkmcnt(9)
  v_mfma_f32_16x16x32_bf16 v[88:91], v[80:83], v[124:127], v[88:91]
  ds_read_b64_tr_b16 v[24:25], v5 offset:4096
  ds_read_b64_tr_b16 v[26:27], v5 offset:4160
  s_waitcnt lgkmcnt(10)
  v_mfma_f32_16x16x32_bf16 v[92:95], v[84:87], v[124:127], v[92:95]
  ds_read_b64_tr_b16 v[28:29], v5 offset:4608
  ds_read_b64_tr_b16 v[30:31], v5 offset:4672
  s_waitcnt lgkmcnt(11)
  v_mfma_f32_16x16x32_bf16 v[88:91], v[56:59], v[128:131], v[88:91]
  ds_read_b64_tr_b16 v[32:33], v5 offset:5120
  ds_read_b64_tr_b16 v[34:35], v5 offset:5184
  s_waitcnt lgkmcnt(12)
  v_mfma_f32_16x16x32_bf16 v[92:95], v[60:63], v[128:131], v[92:95]
  ds_read_b64_tr_b16 v[36:37], v5 offset:5632
  ds_read_b64_tr_b16 v[38:39], v5 offset:5696
  s_waitcnt lgkmcnt(13)
  v_mfma_f32_16x16x32_bf16 v[88:91], v[64:67], v[132:135], v[88:91]
  s_waitcnt lgkmcnt(12)
  v_mfma_f32_16x16x32_bf16 v[92:95], v[68:71], v[132:135], v[92:95]
  s_waitcnt lgkmcnt(10)
  v_mfma_f32_16x16x32_bf16 v[96:99], v[16:19], v[112:115], 0
  s_waitcnt lgkmcnt(8)
  v_mfma_f32_16x16x32_bf16 v[96:99], v[20:23], v[116:119], v[96:99]
  s_waitcnt lgkmcnt(6)
  v_mfma_f32_16x16x32_bf16 v[96:99], v[24:27], v[120:123], v[96:99]
  s_waitcnt lgkmcnt(4)
  v_mfma_f32_16x16x32_bf16 v[96:99], v[28:31], v[124:127], v[96:99]
  s_waitcnt lgkmcnt(2)
  v_mfma_f32_16x16x32_bf16 v[96:99], v[32:35], v[128:131], v[96:99]
  s_waitcnt lgkmcnt(0)
  v_mfma_f32_16x16x32_bf16 v[96:99], v[36:39], v[132:135], v[96:99]
  v_mov_b32 v143, s70
  v_cndmask_b32 v88, v88, v143, s[72:73]
  v_cndmask_b32 v89, v89, v143, s[74:75]
  v_cndmask_b32 v90, v90, v143, s[76:77]
  v_cndmask_b32 v91, v91, v143, s[78:79]
  v_cndmask_b32 v92, v92, v143, s[80:81]
  v_cndmask_b32 v93, v93, v143, s[82:83]
  v_cndmask_b32 v94, v94, v143, s[84:85]
  v_cndmask_b32 v95, v95, v143, s[86:87]
  s_mov_b32 vcc_lo, 0
  s_mov_b32 vcc_hi, -1
  v_cndmask_b32 v96, v96, v98, vcc
  v_cndmask_b32 v97, v97, v99, vcc
  v_max_f32 v142, v88, v89
  v_max3_f32 v142, v142, v90, v91
  v_max3_f32 v142, v142, v92, v93
  v_max3_f32 v142, v142, v94, v95
  v_max3_f32 v142, v142, v96, v97
  v_mov_b32 v143, v142
  s_nop 1
  v_permlane16_swap_b32 v143, v142
  v_max_f32 v142, v142, v143
  v_mov_b32 v143, v142
  s_nop 1
  v_permlane32_swap_b32 v143, v142
  v_max_f32 v142, v142, v143
  v_mul_f32 v142, s69, v142
  v_fma_f32 v88, v88, s69, -v142
  v_fma_f32 v89, v89, s69, -v142
  v_fma_f32 v90, v90, s69, -v142
  v_fma_f32 v91, v91, s69, -v142
  v_fma_f32 v92, v92, s69, -v142
  v_fma_f32 v93, v93, s69, -v142
  v_fma_f32 v94, v94, s69, -v142
  v_fma_f32 v95, v95, s69, -v142
  v_fma_f32 v96, v96, s69, -v142
  v_fma_f32 v97, v97, s69, -v142
  v_exp_f32 v88, v88
  v_exp_f32 v89, v89
  v_exp_f32 v90, v90
  v_exp_f32 v91, v91
  v_exp_f32 v92, v92
  v_exp_f32 v93, v93
  v_exp_f32 v94, v94
  v_exp_f32 v95, v95
  v_exp_f32 v96, v96
  v_exp_f32 v97, v97
  v_add_f32 v142, v88, v89
  v_add_f32 v142, v142, v90
  v_add_f32 v142, v142, v91
  v_add_f32 v142, v142, v92
  v_add_f32 v142, v142, v93
  v_add_f32 v142, v142, v94
  v_add_f32 v142, v142, v95
  v_add_f32 v142, v142, v96
  v_add_f32 v142, v142, v97
  v_mov_b32 v143, v142
  s_nop 1
  v_permlane16_swap_b32 v143, v142
  v_add_f32 v142, v142, v143
  v_mov_b32 v143, v142
  s_nop 1
  v_permlane32_swap_b32 v143, v142
  v_add_f32 v142, v142, v143
  v_rcp_f32 v142, v142
  s_nop 0
  v_mul_f32 v88, v88, v142
  v_mul_f32 v89, v89, v142
  v_mul_f32 v90, v90, v142
  v_mul_f32 v91, v91, v142
  v_mul_f32 v92, v92, v142
  v_mul_f32 v93, v93, v142
  v_mul_f32 v94, v94, v142
  v_mul_f32 v95, v95, v142
  v_mul_f32 v96, v96, v142
  v_mul_f32 v97, v97, v142
  v_cvt_pk_bf16_f32 v144, v88, v89
  v_cvt_pk_bf16_f32 v145, v90, v91
  v_cvt_pk_bf16_f32 v146, v92, v93
  v_cvt_pk_bf16_f32 v147, v94, v95
  v_cvt_pk_bf16_f32 v148, v96, v97
  buffer_store_dwordx4 v[144:147], v1, s[8:11], s64 offen sc1
  buffer_store_dword v148, v14, s[8:11], s64 offen sc1
  s_add_u32 s64, s64, 81920
  s_add_u32 s20, s20, 12288
  s_branch sc_join
sc_nox:
  s_waitcnt vmcnt(0)
sc_join:
  v_add_u32 v13, s22, v13
  s_sub_u32 s22, 0, s22
  s_add_u32 s58, s58, 1
  s_cmp_eq_u32 s58, 3
  s_cselect_b32 s58, 0, s58
  s_mov_b32 s52, s53
  s_cmp_lt_u32 s52, 64
  s_cbranch_scc1 sch_loop
  s_waitcnt vmcnt(0)
  s_cmp_ge_u32 s42, 2
  s_cbranch_scc1 L_end
  v_mov_b32 v136, s52
  s_mov_b64 exec, 1
  buffer_store_dword v136, v15, s[8:11], 0 offen sc1
  s_mov_b64 exec, -1
  s_endpgm
scs_redo_29:
  s_mov_b32 s50, 0
scs_poll_36:
  buffer_load_dwordx4 v[16:19], v12, s[8:11], s24 offen sc1
  buffer_load_dwordx4 v[20:23], v12, s[8:11], s25 offen sc1
  buffer_load_dwordx4 v[24:27], v12, s[8:11], s26 offen sc1
  buffer_load_dwordx4 v[28:31], v12, s[8:11], s27 offen sc1
  buffer_load_dwordx4 v[32:35], v12, s[8:11], s28 offen sc1
  buffer_load_dwordx4 v[36:39], v12, s[8:11], s29 offen sc1
  buffer_load_dwordx4 v[40:43], v12, s[8:11], s30 offen sc1
  buffer_load_dwordx4 v[44:47], v12, s[8:11], s31 offen sc1
  buffer_load_dwordx4 v[48:51], v12, s[8:11], s32 offen sc1
  buffer_load_dwordx4 v[52:55], v12, s[8:11], s33 offen sc1
  s_add_u32 s71, s71, 1
  s_cmp_le_u32 s71, 2
  s_cbranch_scc1 scs_again_37
  s_add_u32 s50, s50, 1
  s_cmp_gt_u32 s50, 131072
  s_cbranch_scc1 L_fail
  s_waitcnt vmcnt(0)
  v_max_u32 v149, v16, v17
  v_max3_u32 v149, v18, v19, v149
  v_max3_u32 v149, v20, v21, v149
  v_max3_u32 v149, v22, v23, v149
  v_max3_u32 v149, v24, v25, v149
  v_max3_u32 v149, v26, v27, v149
  v_max3_u32 v149, v28, v29, v149
  v_max3_u32 v149, v30, v31, v149
  v_max3_u32 v149, v32, v33, v149
  v_max3_u32 v149, v34, v35, v149
  v_max3_u32 v149, v36, v37, v149
  v_max3_u32 v149, v38, v39, v149
  v_max3_u32 v149, v40, v41, v149
  v_max3_u32 v149, v42, v43, v149
  v_max3_u32 v149, v44, v45, v149
  v_max3_u32 v149, v46, v47, v149
  v_max3_u32 v149, v48, v49, v149
  v_max3_u32 v149, v50, v51, v149
  v_max3_u32 v149, v52, v53, v149
  v_max3_u32 v149, v54, v55, v149
  v_cmp_eq_u32 vcc, -1, v149
  s_cbranch_vccnz scs_poll_36
  s_mov_b64 s[16:17], 0
scs_again_37:
  s_waitcnt lgkmcnt(0)
  ds_read_b128 v[56:59], v2 offset:0
  ds_read_b128 v[60:63], v2 offset:4096
  ds_read_b128 v[64:67], v2 offset:8192
  ds_read_b128 v[68:71], v2 offset:12288
  ds_read_b128 v[72:75], v2 offset:16384
  ds_read_b128 v[76:79], v2 offset:20480
  ds_read_b128 v[80:83], v2 offset:24576
  ds_read_b128 v[84:87], v2 offset:28672
  v_mov_b32 v88, 0
  v_mov_b32 v89, 0
  v_mov_b32 v90, 0
  v_mov_b32 v91, 0
  v_mov_b32 v92, 0
  v_mov_b32 v93, 0
  v_mov_b32 v94, 0
  v_mov_b32 v95, 0
  v_mov_b32 v96, 0
  v_mov_b32 v97, 0
  v_mov_b32 v98, 0
  v_mov_b32 v99, 0
  v_mov_b32 v100, 0
  v_mov_b32 v101, 0
  v_mov_b32 v102, 0
  v_mov_b32 v103, 0
  v_mov_b32 v104, 0
  v_mov_b32 v105, 0
  v_mov_b32 v106, 0
  v_mov_b32 v107, 0
  v_mov_b32 v108, 0
  v_mov_b32 v109, 0
  v_mov_b32 v110, 0
  v_mov_b32 v111, 0
  s_waitcnt lgkmcnt(0)
  s_branch scs_go_28
sch_redo_35:
  s_mov_b32 s50, 0
sch_poll_38:
  buffer_load_dwordx4 v[16:19], v12, s[8:11], s24 offen sc1
  buffer_load_dwordx4 v[20:23], v12, s[8:11], s25 offen sc1
  buffer_load_dwordx4 v[24:27], v12, s[8:11], s26 offen sc1
  buffer_load_dwordx4 v[28:31], v12, s[8:11], s27 offen sc1
  buffer_load_dwordx4 v[32:35], v12, s[8:11], s28 offen sc1
  buffer_load_dwordx4 v[36:39], v12, s[8:11], s29 offen sc1
  buffer_load_dwordx4 v[40:43], v12, s[8:11], s30 offen sc1
  buffer_load_dwordx4 v[44:47], v12, s[8:11], s31 offen sc1
  buffer_load_dwordx4 v[48:51], v12, s[8:11], s32 offen sc1
  buffer_load_dwordx4 v[52:55], v12, s[8:11], s33 offen sc1
  s_add_u32 s71, s71, 1
  s_cmp_le_u32 s71, 2
  s_cbranch_scc1 sch_again_39
  s_add_u32 s50, s50, 1
  s_cmp_gt_u32 s50, 131072
  s_cbranch_scc1 L_fail
  s_waitcnt vmcnt(0)
  v_max_u32 v149, v16, v17
  v_max3_u32 v149, v18, v19, v149
  v_max3_u32 v149, v20, v21, v149
  v_max3_u32 v149, v22, v23, v149
  v_max3_u32 v149, v24, v25, v149
  v_max3_u32 v149, v26, v27, v149
  v_max3_u32 v149, v28, v29, v149
  v_max3_u32 v149, v30, v31, v149
  v_max3_u32 v149, v32, v33, v149
  v_max3_u32 v149, v34, v35, v149
  v_max3_u32 v149, v36, v37, v149
  v_max3_u32 v149, v38, v39, v149
  v_max3_u32 v149, v40, v41, v149
  v_max3_u32 v149, v42, v43, v149
  v_max3_u32 v149, v44, v45, v149
  v_max3_u32 v149, v46, v47, v149
  v_max3_u32 v149, v48, v49, v149
  v_max3_u32 v149, v50, v51, v149
  v_max3_u32 v149, v52, v53, v149
  v_max3_u32 v149, v54, v55, v149
  v_cmp_eq_u32 vcc, -1, v149
  s_cbranch_vccnz sch_poll_38
  s_mov_b64 s[16:17], 0
sch_again_39:
  s_waitcnt lgkmcnt(0)
  ds_read_b128 v[56:59], v2 offset:0
  ds_read_b128 v[60:63], v2 offset:4096
  ds_read_b128 v[64:67], v2 offset:8192
  ds_read_b128 v[68:71], v2 offset:12288
  ds_read_b128 v[72:75], v2 offset:16384
  ds_read_b128 v[76:79], v2 offset:20480
  ds_read_b128 v[80:83], v2 offset:24576
  ds_read_b128 v[84:87], v2 offset:28672
  v_mov_b32 v88, 0
  v_mov_b32 v89, 0
  v_mov_b32 v90, 0
  v_mov_b32 v91, 0
  v_mov_b32 v92, 0
  v_mov_b32 v93, 0
  v_mov_b32 v94, 0
  v_mov_b32 v95, 0
  v_mov_b32 v96, 0
  v_mov_b32 v97, 0
  v_mov_b32 v98, 0
  v_mov_b32 v99, 0
  v_mov_b32 v100, 0
  v_mov_b32 v101, 0
  v_mov_b32 v102, 0
  v_mov_b32 v103, 0
  v_mov_b32 v104, 0
  v_mov_b32 v105, 0
  v_mov_b32 v106, 0
  v_mov_b32 v107, 0
  v_mov_b32 v108, 0
  v_mov_b32 v109, 0
  v_mov_b32 v110, 0
  v_mov_b32 v111, 0
  s_waitcnt lgkmcnt(0)
  s_branch sch_go_34
L_value:
  s_mov_b32 s4, s30
  s_mov_b32 s5, s31
  s_mov_b32 s6, 7864320
  s_mov_b32 s7, 0x20000
  s_mov_b32 s12, s32
  s_mov_b32 s13, s33
  s_mov_b32 s14, 7864320
  s_mov_b32 s15, 0x20000
  v_lshrrev_b32 v140, 3, v0
  v_lshrrev_b32 v141, 2, v140
  v_lshlrev_b32 v141, 3, v141
  v_and_b32 v64, 3, v140
  v_add_u32 v64, v64, v141
  s_and_b32 s46, s42, 1
  s_lshl_b32 s46, s46, 2
  s_lshr_b32 s47, s42, 1
  s_lshl_b32 s47, s47, 4
  s_add_u32 s46, s46, s47
  v_add_u32 v64, s46, v64
  v_mul_u32_u24 v64, 12288, v64
  v_lshrrev_b32 v140, 1, v140
  v_bfe_u32 v141, v0, 1, 2
  v_xor_b32 v140, v140, v141
  v_lshlrev_b32 v140, 5, v140
  v_and_b32 v141, 1, v0
  v_lshlrev_b32 v141, 4, v141
  v_add3_u32 v64, v64, v140, v141
  v_lshrrev_b32 v140, 3, v0
  v_lshrrev_b32 v141, 2, v140
  v_lshlrev_b32 v141, 3, v141
  v_and_b32 v65, 3, v140
  v_add_u32 v65, v65, v141
  s_and_b32 s46, s42, 1
  s_lshl_b32 s46, s46, 2
  s_lshr_b32 s47, s42, 1
  s_lshl_b32 s47, s47, 4
  s_add_u32 s46, s46, s47
  v_add_u32 v65, s46, v65
  v_mul_u32_u24 v65, 1280, v65
  v_lshrrev_b32 v140, 1, v140
  v_bfe_u32 v141, v0, 1, 2
  v_xor_b32 v140, v140, v141
  v_lshlrev_b32 v140, 5, v140
  v_and_b32 v141, 1, v0
  v_lshlrev_b32 v141, 4, v141
  v_add3_u32 v65, v65, v140, v141
  v_lshrrev_b32 v140, 5, v0
  v_lshlrev_b32 v66, 11, v140
  v_bfe_u32 v140, v0, 2, 3
  v_lshl_add_u32 v66, v140, 7, v66
  v_lshrrev_b32 v140, 1, v140
  v_xor_b32 v140, s42, v140
  v_lshl_add_u32 v66, v140, 5, v66
  v_and_b32 v140, 3, v0
  v_lshl_add_u32 v66, v140, 3, v66
  v_add_u32 v67, 0x10000, v66
  v_add_u32 v68, 0x20000, v66
  v_lshlrev_b32 v1, 4, v0
  v_add_u32 v2, s51, v1
  v_add_u32 v3, 0x10000, v2
  s_mul_i32 s62, s45, 384
  s_mul_i32 s63, s45, 245760
  s_cmp_ge_u32 s44, 10
  s_cselect_b32 s47, 10, 0
  s_sub_u32 s47, s44, s47
  s_mov_b32 s47, 0
  s_mul_i32 s72, s47, 786432
  s_add_u32 s72, s72, s62
  s_cmp_ge_u32 s47, 8
  s_cselect_b32 s46, 40960, 0
  s_lshl_b32 s24, s47, 10
  s_add_u32 s24, s24, s46
  s_add_u32 s47, s47, 1
  s_cmp_eq_u32 s47, 10
  s_cselect_b32 s47, 0, s47
  s_mul_i32 s73, s47, 786432
  s_add_u32 s73, s73, s62
  s_cmp_ge_u32 s47, 8
  s_cselect_b32 s46, 40960, 0
  s_lshl_b32 s25, s47, 10
  s_add_u32 s25, s25, s46
  s_add_u32 s47, s47, 1
  s_cmp_eq_u32 s47, 10
  s_cselect_b32 s47, 0, s47
  s_mul_i32 s74, s47, 786432
  s_add_u32 s74, s74, s62
  s_cmp_ge_u32 s47, 8
  s_cselect_b32 s46, 40960, 0
  s_lshl_b32 s26, s47, 10
  s_add_u32 s26, s26, s46
  s_add_u32 s47, s47, 1
  s_cmp_eq_u32 s47, 10
  s_cselect_b32 s47, 0, s47
  s_mul_i32 s75, s47, 786432
  s_add_u32 s75, s75, s62
  s_cmp_ge_u32 s47, 8
  s_cselect_b32 s46, 40960, 0
  s_lshl_b32 s27, s47, 10
  s_add_u32 s27, s27, s46
  s_add_u32 s47, s47, 1
  s_cmp_eq_u32 s47, 10
  s_cselect_b32 s47, 0, s47
  s_mul_i32 s76, s47, 786432
  s_add_u32 s76, s76, s62
  s_cmp_ge_u32 s47, 8
  s_cselect_b32 s46, 40960, 0
  s_lshl_b32 s28, s47, 10
  s_add_u32 s28, s28, s46
  s_add_u32 s47, s47, 1
  s_cmp_eq_u32 s47, 10
  s_cselect_b32 s47, 0, s47
  s_mul_i32 s77, s47, 786432
  s_add_u32 s77, s77, s62
  s_cmp_ge_u32 s47, 8
  s_cselect_b32 s46, 40960, 0
  s_lshl_b32 s29, s47, 10
  s_add_u32 s29, s29, s46
  s_add_u32 s47, s47, 1
  s_cmp_eq_u32 s47, 10
  s_cselect_b32 s47, 0, s47
  s_mul_i32 s78, s47, 786432
  s_add_u32 s78, s78, s62
  s_cmp_ge_u32 s47, 8
  s_cselect_b32 s46, 40960, 0
  s_lshl_b32 s30, s47, 10
  s_add_u32 s30, s30, s46
  s_add_u32 s47, s47, 1
  s_cmp_eq_u32 s47, 10
  s_cselect_b32 s47, 0, s47
  s_mul_i32 s79, s47, 786432
  s_add_u32 s79, s79, s62
  s_cmp_ge_u32 s47, 8
  s_cselect_b32 s46, 40960, 0
  s_lshl_b32 s31, s47, 10
  s_add_u32 s31, s31, s46
  s_add_u32 s47, s47, 1
  s_cmp_eq_u32 s47, 10
  s_cselect_b32 s47, 0, s47
  s_mul_i32 s80, s47, 786432
  s_add_u32 s80, s80, s62
  s_cmp_ge_u32 s47, 8
  s_cselect_b32 s46, 40960, 0
  s_lshl_b32 s32, s47, 10
  s_add_u32 s32, s32, s46
  s_add_u32 s47, s47, 1
  s_cmp_eq_u32 s47, 10
  s_cselect_b32 s47, 0, s47
  s_mul_i32 s81, s47, 786432
  s_add_u32 s81, s81, s62
  s_cmp_ge_u32 s47, 8
  s_cselect_b32 s46, 40960, 0
  s_lshl_b32 s33, s47, 10
  s_add_u32 s33, s33, s46
  s_add_u32 s47, s47, 1
  s_cmp_eq_u32 s47, 10
  s_cselect_b32 s47, 0, s47
  s_add_u32 m0, s51, 73728
  s_add_u32 s46, s63, 0
  buffer_load_dwordx4 v65, s[12:15], s46 offen lds
  s_add_u32 m0, s51, 77824
  s_add_u32 s46, s63, 128
  buffer_load_dwordx4 v65, s[12:15], s46 offen lds
  s_add_u32 m0, s51, 81920
  s_add_u32 s46, s63, 256
  buffer_load_dwordx4 v65, s[12:15], s46 offen lds
  s_add_u32 m0, s51, 86016
  s_add_u32 s46, s63, 384
  buffer_load_dwordx4 v65, s[12:15], s46 offen lds
  s_add_u32 m0, s51, 90112
  s_add_u32 s46, s63, 512
  buffer_load_dwordx4 v65, s[12:15], s46 offen lds
  s_add_u32 m0, s51, 94208
  s_add_u32 s46, s63, 640
  buffer_load_dwordx4 v65, s[12:15], s46 offen lds
  s_add_u32 m0, s51, 98304
  s_add_u32 s46, s63, 768
  buffer_load_dwordx4 v65, s[12:15], s46 offen lds
  s_add_u32 m0, s51, 102400
  s_add_u32 s46, s63, 896
  buffer_load_dwordx4 v65, s[12:15], s46 offen lds
  s_add_u32 m0, s51, 106496
  s_add_u32 s46, s63, 1024
  buffer_load_dwordx4 v65, s[12:15], s46 offen lds
  s_add_u32 m0, s51, 110592
  s_add_u32 s46, s63, 1152
  buffer_load_dwordx4 v65, s[12:15], s46 offen lds
  s_add_u32 m0, s51, 114688
  s_add_u32 s46, s63, 40960
  buffer_load_dwordx4 v65, s[12:15], s46 offen lds
  s_add_u32 m0, s51, 118784
  s_add_u32 s46, s63, 41088
  buffer_load_dwordx4 v65, s[12:15], s46 offen lds
  s_add_u32 m0, s51, 122880
  s_add_u32 s46, s63, 41216
  buffer_load_dwordx4 v65, s[12:15], s46 offen lds
  s_add_u32 m0, s51, 126976
  s_add_u32 s46, s63, 41344
  buffer_load_dwordx4 v65, s[12:15], s46 offen lds
  s_add_u32 m0, s51, 131072
  s_add_u32 s46, s63, 41472
  buffer_load_dwordx4 v65, s[12:15], s46 offen lds
  s_add_u32 m0, s51, 135168
  s_add_u32 s46, s63, 41600
  buffer_load_dwordx4 v65, s[12:15], s46 offen lds
  s_add_u32 m0, s51, 139264
  s_add_u32 s46, s63, 41728
  buffer_load_dwordx4 v65, s[12:15], s46 offen lds
  s_add_u32 m0, s51, 143360
  s_add_u32 s46, s63, 41856
  buffer_load_dwordx4 v65, s[12:15], s46 offen lds
  s_add_u32 m0, s51, 0
  s_add_u32 s46, s63, 41984
  buffer_load_dwordx4 v65, s[12:15], s46 offen lds
  s_add_u32 m0, s51, 4096
  s_add_u32 s46, s63, 42112
  buffer_load_dwordx4 v65, s[12:15], s46 offen lds
  s_add_u32 m0, s51, 8192
  s_add_u32 s46, s63, 81920
  buffer_load_dwordx4 v65, s[12:15], s46 offen lds
  s_add_u32 m0, s51, 12288
  s_add_u32 s46, s63, 82048
  buffer_load_dwordx4 v65, s[12:15], s46 offen lds
  s_add_u32 m0, s51, 16384
  s_add_u32 s46, s63, 82176
  buffer_load_dwordx4 v65, s[12:15], s46 offen lds
  s_add_u32 m0, s51, 20480
  s_add_u32 s46, s63, 82304
  buffer_load_dwordx4 v65, s[12:15], s46 offen lds
  s_add_u32 m0, s51, 24576
  s_add_u32 s46, s63, 82432
  buffer_load_dwordx4 v65, s[12:15], s46 offen lds
  s_add_u32 m0, s51, 28672
  s_add_u32 s46, s63, 82560
  buffer_load_dwordx4 v65, s[12:15], s46 offen lds
  s_add_u32 m0, s51, 32768
  s_add_u32 s46, s63, 82688
  buffer_load_dwordx4 v65, s[12:15], s46 offen lds
  s_add_u32 m0, s51, 36864
  s_add_u32 s46, s63, 82816
  buffer_load_dwordx4 v65, s[12:15], s46 offen lds
  s_add_u32 m0, s51, 40960
  s_add_u32 s46, s63, 82944
  buffer_load_dwordx4 v65, s[12:15], s46 offen lds
  s_add_u32 m0, s51, 45056
  s_add_u32 s46, s63, 83072
  buffer_load_dwordx4 v65, s[12:15], s46 offen lds
  s_waitcnt vmcnt(24)
  s_barrier
  s_add_u32 m0, s51, 49152
  s_add_u32 s46, s63, 122880
  buffer_load_dwordx4 v65, s[12:15], s46 offen lds
  s_add_u32 m0, s51, 53248
  s_add_u32 s46, s63, 123008
  buffer_load_dwordx4 v65, s[12:15], s46 offen lds
  s_add_u32 m0, s51, 57344
  s_add_u32 s46, s63, 123136
  buffer_load_dwordx4 v65, s[12:15], s46 offen lds
  s_add_u32 m0, s51, 61440
  s_add_u32 s46, s63, 123264
  buffer_load_dwordx4 v65, s[12:15], s46 offen lds
  s_add_u32 m0, s51, 65536
  s_add_u32 s46, s63, 123392
  buffer_load_dwordx4 v65, s[12:15], s46 offen lds
  s_add_u32 m0, s51, 69632
  s_add_u32 s46, s63, 123520
  buffer_load_dwordx4 v65, s[12:15], s46 offen lds
  ds_read_b64_tr_b16 a[0:1], v67 offset:8192
  ds_read_b64_tr_b16 a[2:3], v67 offset:9216
  ds_read_b64_tr_b16 a[24:25], v67 offset:12288
  ds_read_b64_tr_b16 a[26:27], v67 offset:13312
  ds_read_b64_tr_b16 a[48:49], v67 offset:16384
  ds_read_b64_tr_b16 a[50:51], v67 offset:17408
  ds_read_b64_tr_b16 a[72:73], v67 offset:20480
  ds_read_b64_tr_b16 a[74:75], v67 offset:21504
  ds_read_b64_tr_b16 a[96:97], v67 offset:24576
  ds_read_b64_tr_b16 a[98:99], v67 offset:25600
  ds_read_b64_tr_b16 a[120:121], v67 offset:28672
  ds_read_b64_tr_b16 a[122:123], v67 offset:29696
  s_waitcnt lgkmcnt(0)
  s_waitcnt vmcnt(24)
  s_barrier
  s_add_u32 m0, s51, 73728
  s_add_u32 s46, s63, 123648
  buffer_load_dwordx4 v65, s[12:15], s46 offen lds
  s_add_u32 m0, s51, 77824
  s_add_u32 s46, s63, 123776
  buffer_load_dwordx4 v65, s[12:15], s46 offen lds
  s_add_u32 m0, s51, 81920
  s_add_u32 s46, s63, 123904
  buffer_load_dwordx4 v65, s[12:15], s46 offen lds
  s_add_u32 m0, s51, 86016
  s_add_u32 s46, s63, 124032
  buffer_load_dwordx4 v65, s[12:15], s46 offen lds
  s_add_u32 m0, s51, 90112
  s_add_u32 s46, s63, 163840
  buffer_load_dwordx4 v65, s[12:15], s46 offen lds
  s_add_u32 m0, s51, 94208
  s_add_u32 s46, s63, 163968
  buffer_load_dwordx4 v65, s[12:15], s46 offen lds
  ds_read_b64_tr_b16 a[144:145], v67 offset:32768
  ds_read_b64_tr_b16 a[146:147], v67 offset:33792
  ds_read_b64_tr_b16 a[168:169], v67 offset:36864
  ds_read_b64_tr_b16 a[170:171], v67 offset:37888
  ds_read_b64_tr_b16 a[192:193], v67 offset:40960
  ds_read_b64_tr_b16 a[194:195], v67 offset:41984
  ds_read_b64_tr_b16 a[216:217], v67 offset:45056
  ds_read_b64_tr_b16 a[218:219], v67 offset:46080
  ds_read_b64_tr_b16 a[4:5], v67 offset:49152
  ds_read_b64_tr_b16 a[6:7], v67 offset:50176
  ds_read_b64_tr_b16 a[28:29], v67 offset:53248
  ds_read_b64_tr_b16 a[30:31], v67 offset:54272
  s_waitcnt lgkmcnt(0)
  s_waitcnt vmcnt(24)
  s_barrier
  s_add_u32 m0, s51, 98304
  s_add_u32 s46, s63, 164096
  buffer_load_dwordx4 v65, s[12:15], s46 offen lds
  s_add_u32 m0, s51, 102400
  s_add_u32 s46, s63, 164224
  buffer_load_dwordx4 v65, s[12:15], s46 offen lds
  s_add_u32 m0, s51, 106496
  s_add_u32 s46, s63, 164352
  buffer_load_dwordx4 v65, s[12:15], s46 offen lds
  s_add_u32 m0, s51, 110592
  s_add_u32 s46, s63, 164480
  buffer_load_dwordx4 v65, s[12:15], s46 offen lds
  s_add_u32 m0, s51, 114688
  s_add_u32 s46, s63, 164608
  buffer_load_dwordx4 v65, s[12:15], s46 offen lds
  s_add_u32 m0, s51, 118784
  s_add_u32 s46, s63, 164736
  buffer_load_dwordx4 v65, s[12:15], s46 offen lds
  ds_read_b64_tr_b16 a[52:53], v67 offset:57344
  ds_read_b64_tr_b16 a[54:55], v67 offset:58368
  ds_read_b64_tr_b16 a[76:77], v67 offset:61440
  ds_read_b64_tr_b16 a[78:79], v67 offset:62464
  ds_read_b64_tr_b16 a[100:101], v68 offset:0
  ds_read_b64_tr_b16 a[102:103], v68 offset:1024
  ds_read_b64_tr_b16 a[124:125], v68 offset:4096
  ds_read_b64_tr_b16 a[126:127], v68 offset:5120
  ds_read_b64_tr_b16 a[148:149], v68 offset:8192
  ds_read_b64_tr_b16 a[150:151], v68 offset:9216
  ds_read_b64_tr_b16 a[172:173], v68 offset:12288
  ds_read_b64_tr_b16 a[174:175], v68 offset:13312
  s_waitcnt lgkmcnt(0)
  s_waitcnt vmcnt(24)
  s_barrier
  s_add_u32 m0, s51, 122880
  s_add_u32 s46, s63, 164864
  buffer_load_dwordx4 v65, s[12:15], s46 offen lds
  s_add_u32 m0, s51, 126976
  s_add_u32 s46, s63, 164992
  buffer_load_dwordx4 v65, s[12:15], s46 offen lds
  s_add_u32 m0, s51, 131072
  s_add_u32 s46, s63, 204800
  buffer_load_dwordx4 v65, s[12:15], s46 offen lds
  s_add_u32 m0, s51, 135168
  s_add_u32 s46, s63, 204928
  buffer_load_dwordx4 v65, s[12:15], s46 offen lds
  s_add_u32 m0, s51, 139264
  s_add_u32 s46, s63, 205056
  buffer_load_dwordx4 v65, s[12:15], s46 offen lds
  s_add_u32 m0, s51, 143360
  s_add_u32 s46, s63, 205184
  buffer_load_dwordx4 v65, s[12:15], s46 offen lds
  ds_read_b64_tr_b16 a[196:197], v66 offset:0
  ds_read_b64_tr_b16 a[198:199], v66 offset:1024
  ds_read_b64_tr_b16 a[220:221], v66 offset:4096
  ds_read_b64_tr_b16 a[222:223], v66 offset:5120
  ds_read_b64_tr_b16 a[8:9], v66 offset:8192
  ds_read_b64_tr_b16 a[10:11], v66 offset:9216
  ds_read_b64_tr_b16 a[32:33], v66 offset:12288
  ds_read_b64_tr_b16 a[34:35], v66 offset:13312
  ds_read_b64_tr_b16 a[56:57], v66 offset:16384
  ds_read_b64_tr_b16 a[58:59], v66 offset:17408
  ds_read_b64_tr_b16 a[80:81], v66 offset:20480
  ds_read_b64_tr_b16 a[82:83], v66 offset:21504
  s_waitcnt lgkmcnt(0)
  s_waitcnt vmcnt(24)
  s_barrier
  s_add_u32 m0, s51, 0
  s_add_u32 s46, s63, 205312
  buffer_load_dwordx4 v65, s[12:15], s46 offen lds
  s_add_u32 m0, s51, 4096
  s_add_u32 s46, s63, 205440
  buffer_load_dwordx4 v65, s[12:15], s46 offen lds
  s_add_u32 m0, s51, 8192
  s_add_u32 s46, s63, 205568
  buffer_load_dwordx4 v65, s[12:15], s46 offen lds
  s_add_u32 m0, s51, 12288
  s_add_u32 s46, s63, 205696
  buffer_load_dwordx4 v65, s[12:15], s46 offen lds
  s_add_u32 m0, s51, 16384
  s_add_u32 s46, s63, 205824
  buffer_load_dwordx4 v65, s[12:15], s46 offen lds
  s_add_u32 m0, s51, 20480
  s_add_u32 s46, s63, 205952
  buffer_load_dwordx4 v65, s[12:15], s46 offen lds
  ds_read_b64_tr_b16 a[104:105], v66 offset:24576
  ds_read_b64_tr_b16 a[106:107], v66 offset:25600
  ds_read_b64_tr_b16 a[128:129], v66 offset:28672
  ds_read_b64_tr_b16 a[130:131], v66 offset:29696
  ds_read_b64_tr_b16 a[152:153], v66 offset:32768
  ds_read_b64_tr_b16 a[154:155], v66 offset:33792
  ds_read_b64_tr_b16 a[176:177], v66 offset:36864
  ds_read_b64_tr_b16 a[178:179], v66 offset:37888
  ds_read_b64_tr_b16 a[200:201], v66 offset:40960
  ds_read_b64_tr_b16 a[202:203], v66 offset:41984
  ds_read_b64_tr_b16 a[224:225], v66 offset:45056
  ds_read_b64_tr_b16 a[226:227], v66 offset:46080
  s_waitcnt lgkmcnt(0)
  s_waitcnt vmcnt(24)
  s_barrier
  s_add_u32 m0, s51, 24576
  s_add_u32 s46, s72, 0
  buffer_load_dwordx4 v64, s[4:7], s46 offen lds
  s_add_u32 m0, s51, 28672
  s_add_u32 s46, s72, 393216
  buffer_load_dwordx4 v64, s[4:7], s46 offen lds
  s_add_u32 m0, s51, 32768
  s_add_u32 s46, s72, 128
  buffer_load_dwordx4 v64, s[4:7], s46 offen lds
  s_add_u32 m0, s51, 36864
  s_add_u32 s46, s72, 393344
  buffer_load_dwordx4 v64, s[4:7], s46 offen lds
  s_add_u32 m0, s51, 40960
  s_add_u32 s46, s72, 256
  buffer_load_dwordx4 v64, s[4:7], s46 offen lds
  s_add_u32 m0, s51, 45056
  s_add_u32 s46, s72, 393472
  buffer_load_dwordx4 v64, s[4:7], s46 offen lds
  ds_read_b64_tr_b16 a[12:13], v66 offset:49152
  ds_read_b64_tr_b16 a[14:15], v66 offset:50176
  ds_read_b64_tr_b16 a[36:37], v66 offset:53248
  ds_read_b64_tr_b16 a[38:39], v66 offset:54272
  ds_read_b64_tr_b16 a[60:61], v66 offset:57344
  ds_read_b64_tr_b16 a[62:63], v66 offset:58368
  ds_read_b64_tr_b16 a[84:85], v66 offset:61440
  ds_read_b64_tr_b16 a[86:87], v66 offset:62464
  ds_read_b64_tr_b16 a[108:109], v67 offset:0
  ds_read_b64_tr_b16 a[110:111], v67 offset:1024
  ds_read_b64_tr_b16 a[132:133], v67 offset:4096
  ds_read_b64_tr_b16 a[134:135], v67 offset:5120
  s_waitcnt lgkmcnt(0)
  s_waitcnt vmcnt(24)
  s_barrier
  s_add_u32 m0, s51, 49152
  s_add_u32 s46, s74, 0
  buffer_load_dwordx4 v64, s[4:7], s46 offen lds
  s_add_u32 m0, s51, 53248
  s_add_u32 s46, s74, 393216
  buffer_load_dwordx4 v64, s[4:7], s46 offen lds
  s_add_u32 m0, s51, 57344
  s_add_u32 s46, s74, 128
  buffer_load_dwordx4 v64, s[4:7], s46 offen lds
  s_add_u32 m0, s51, 61440
  s_add_u32 s46, s74, 393344
  buffer_load_dwordx4 v64, s[4:7], s46 offen lds
  s_add_u32 m0, s51, 65536
  s_add_u32 s46, s74, 256
  buffer_load_dwordx4 v64, s[4:7], s46 offen lds
  s_add_u32 m0, s51, 69632
  s_add_u32 s46, s74, 393472
  buffer_load_dwordx4 v64, s[4:7], s46 offen lds
  ds_read_b64_tr_b16 a[156:157], v67 offset:8192
  ds_read_b64_tr_b16 a[158:159], v67 offset:9216
  ds_read_b64_tr_b16 a[180:181], v67 offset:12288
  ds_read_b64_tr_b16 a[182:183], v67 offset:13312
  ds_read_b64_tr_b16 a[204:205], v67 offset:16384
  ds_read_b64_tr_b16 a[206:207], v67 offset:17408
  ds_read_b64_tr_b16 a[228:229], v67 offset:20480
  ds_read_b64_tr_b16 a[230:231], v67 offset:21504
  ds_read_b64_tr_b16 a[16:17], v67 offset:24576
  ds_read_b64_tr_b16 a[18:19], v67 offset:25600
  ds_read_b64_tr_b16 a[40:41], v67 offset:28672
  ds_read_b64_tr_b16 a[42:43], v67 offset:29696
  s_waitcnt lgkmcnt(0)
  s_waitcnt vmcnt(24)
  s_barrier
  s_add_u32 m0, s51, 73728
  s_add_u32 s46, s76, 0
  buffer_load_dwordx4 v64, s[4:7], s46 offen lds
  s_add_u32 m0, s51, 77824
  s_add_u32 s46, s76, 393216
  buffer_load_dwordx4 v64, s[4:7], s46 offen lds
  s_add_u32 m0, s51, 81920
  s_add_u32 s46, s76, 128
  buffer_load_dwordx4 v64, s[4:7], s46 offen lds
  s_add_u32 m0, s51, 86016
  s_add_u32 s46, s76, 393344
  buffer_load_dwordx4 v64, s[4:7], s46 offen lds
  s_add_u32 m0, s51, 90112
  s_add_u32 s46, s76, 256
  buffer_load_dwordx4 v64, s[4:7], s46 offen lds
  s_add_u32 m0, s51, 94208
  s_add_u32 s46, s76, 393472
  buffer_load_dwordx4 v64, s[4:7], s46 offen lds
  ds_read_b64_tr_b16 a[64:65], v67 offset:32768
  ds_read_b64_tr_b16 a[66:67], v67 offset:33792
  ds_read_b64_tr_b16 a[88:89], v67 offset:36864
  ds_read_b64_tr_b16 a[90:91], v67 offset:37888
  ds_read_b64_tr_b16 a[112:113], v67 offset:40960
  ds_read_b64_tr_b16 a[114:115], v67 offset:41984
  ds_read_b64_tr_b16 a[136:137], v67 offset:45056
  ds_read_b64_tr_b16 a[138:139], v67 offset:46080
  ds_read_b64_tr_b16 a[160:161], v67 offset:49152
  ds_read_b64_tr_b16 a[162:163], v67 offset:50176
  ds_read_b64_tr_b16 a[184:185], v67 offset:53248
  ds_read_b64_tr_b16 a[186:187], v67 offset:54272
  s_waitcnt lgkmcnt(0)
  s_waitcnt vmcnt(24)
  s_barrier
  s_add_u32 m0, s51, 98304
  s_add_u32 s46, s78, 0
  buffer_load_dwordx4 v64, s[4:7], s46 offen lds
  s_add_u32 m0, s51, 102400
  s_add_u32 s46, s78, 393216
  buffer_load_dwordx4 v64, s[4:7], s46 offen lds
  s_add_u32 m0, s51, 106496
  s_add_u32 s46, s78, 128
  buffer_load_dwordx4 v64, s[4:7], s46 offen lds
  s_add_u32 m0, s51, 110592
  s_add_u32 s46, s78, 393344
  buffer_load_dwordx4 v64, s[4:7], s46 offen lds
  s_add_u32 m0, s51, 114688
  s_add_u32 s46, s78, 256
  buffer_load_dwordx4 v64, s[4:7], s46 offen lds
  s_add_u32 m0, s51, 118784
  s_add_u32 s46, s78, 393472
  buffer_load_dwordx4 v64, s[4:7], s46 offen lds
  ds_read_b64_tr_b16 a[208:209], v67 offset:57344
  ds_read_b64_tr_b16 a[210:211], v67 offset:58368
  ds_read_b64_tr_b16 a[232:233], v67 offset:61440
  ds_read_b64_tr_b16 a[234:235], v67 offset:62464
  ds_read_b64_tr_b16 a[20:21], v68 offset:0
  ds_read_b64_tr_b16 a[22:23], v68 offset:1024
  ds_read_b64_tr_b16 a[44:45], v68 offset:4096
  ds_read_b64_tr_b16 a[46:47], v68 offset:5120
  ds_read_b64_tr_b16 a[68:69], v68 offset:8192
  ds_read_b64_tr_b16 a[70:71], v68 offset:9216
  ds_read_b64_tr_b16 a[92:93], v68 offset:12288
  ds_read_b64_tr_b16 a[94:95], v68 offset:13312
  s_waitcnt lgkmcnt(0)
  s_waitcnt vmcnt(24)
  s_barrier
  s_add_u32 m0, s51, 122880
  s_add_u32 s46, s80, 0
  buffer_load_dwordx4 v64, s[4:7], s46 offen lds
  s_add_u32 m0, s51, 126976
  s_add_u32 s46, s80, 393216
  buffer_load_dwordx4 v64, s[4:7], s46 offen lds
  s_add_u32 m0, s51, 131072
  s_add_u32 s46, s80, 128
  buffer_load_dwordx4 v64, s[4:7], s46 offen lds
  s_add_u32 m0, s51, 135168
  s_add_u32 s46, s80, 393344
  buffer_load_dwordx4 v64, s[4:7], s46 offen lds
  s_add_u32 m0, s51, 139264
  s_add_u32 s46, s80, 256
  buffer_load_dwordx4 v64, s[4:7], s46 offen lds
  s_add_u32 m0, s51, 143360
  s_add_u32 s46, s80, 393472
  buffer_load_dwordx4 v64, s[4:7], s46 offen lds
  ds_read_b64_tr_b16 a[116:117], v66 offset:0
  ds_read_b64_tr_b16 a[118:119], v66 offset:1024
  ds_read_b64_tr_b16 a[140:141], v66 offset:4096
  ds_read_b64_tr_b16 a[142:143], v66 offset:5120
  ds_read_b64_tr_b16 a[164:165], v66 offset:8192
  ds_read_b64_tr_b16 a[166:167], v66 offset:9216
  ds_read_b64_tr_b16 a[188:189], v66 offset:12288
  ds_read_b64_tr_b16 a[190:191], v66 offset:13312
  ds_read_b64_tr_b16 a[212:213], v66 offset:16384
  ds_read_b64_tr_b16 a[214:215], v66 offset:17408
  ds_read_b64_tr_b16 a[236:237], v66 offset:20480
  ds_read_b64_tr_b16 a[238:239], v66 offset:21504
  s_waitcnt lgkmcnt(0)
  s_waitcnt vmcnt(24)
  s_barrier
  s_add_u32 m0, s51, 0
  s_add_u32 s46, s73, 0
  buffer_load_dwordx4 v64, s[4:7], s46 offen lds
  s_add_u32 m0, s51, 4096
  s_add_u32 s46, s73, 393216
  buffer_load_dwordx4 v64, s[4:7], s46 offen lds
  s_add_u32 m0, s51, 8192
  s_add_u32 s46, s73, 128
  buffer_load_dwordx4 v64, s[4:7], s46 offen lds
  s_add_u32 m0, s51, 12288
  s_add_u32 s46, s73, 393344
  buffer_load_dwordx4 v64, s[4:7], s46 offen lds
  s_add_u32 m0, s51, 16384
  s_add_u32 s46, s73, 256
  buffer_load_dwordx4 v64, s[4:7], s46 offen lds
  s_add_u32 m0, s51, 20480
  s_add_u32 s46, s73, 393472
  buffer_load_dwordx4 v64, s[4:7], s46 offen lds
  ds_read_b64_tr_b16 a[240:241], v66 offset:24576
  ds_read_b64_tr_b16 a[242:243], v66 offset:25600
  ds_read_b64_tr_b16 a[244:245], v66 offset:28672
  ds_read_b64_tr_b16 a[246:247], v66 offset:29696
  ds_read_b64_tr_b16 a[248:249], v66 offset:32768
  ds_read_b64_tr_b16 a[250:251], v66 offset:33792
  ds_read_b64_tr_b16 a[252:253], v66 offset:36864
  ds_read_b64_tr_b16 a[254:255], v66 offset:37888
  ds_read_b64_tr_b16 v[152:153], v66 offset:40960
  ds_read_b64_tr_b16 v[154:155], v66 offset:41984
  ds_read_b64_tr_b16 v[156:157], v66 offset:45056
  ds_read_b64_tr_b16 v[158:159], v66 offset:46080
  s_waitcnt lgkmcnt(0)
  s_waitcnt vmcnt(24)
  s_barrier
  s_add_u32 m0, s51, 24576
  s_add_u32 s46, s75, 0
  buffer_load_dwordx4 v64, s[4:7], s46 offen lds
  s_add_u32 m0, s51, 28672
  s_add_u32 s46, s75, 393216
  buffer_load_dwordx4 v64, s[4:7], s46 offen lds
  s_add_u32 m0, s51, 32768
  s_add_u32 s46, s75, 128
  buffer_load_dwordx4 v64, s[4:7], s46 offen lds
  s_add_u32 m0, s51, 36864
  s_add_u32 s46, s75, 393344
  buffer_load_dwordx4 v64, s[4:7], s46 offen lds
  s_add_u32 m0, s51, 40960
  s_add_u32 s46, s75, 256
  buffer_load_dwordx4 v64, s[4:7], s46 offen lds
  s_add_u32 m0, s51, 45056
  s_add_u32 s46, s75, 393472
  buffer_load_dwordx4 v64, s[4:7], s46 offen lds
  ds_read_b64_tr_b16 v[160:161], v66 offset:49152
  ds_read_b64_tr_b16 v[162:163], v66 offset:50176
  ds_read_b64_tr_b16 v[164:165], v66 offset:53248
  ds_read_b64_tr_b16 v[166:167], v66 offset:54272
  ds_read_b64_tr_b16 v[168:169], v66 offset:57344
  ds_read_b64_tr_b16 v[170:171], v66 offset:58368
  ds_read_b64_tr_b16 v[172:173], v66 offset:61440
  ds_read_b64_tr_b16 v[174:175], v66 offset:62464
  ds_read_b64_tr_b16 v[176:177], v67 offset:0
  ds_read_b64_tr_b16 v[178:179], v67 offset:1024
  ds_read_b64_tr_b16 v[180:181], v67 offset:4096
  ds_read_b64_tr_b16 v[182:183], v67 offset:5120
  s_waitcnt lgkmcnt(0)
  s_waitcnt vmcnt(24)
  s_barrier
  s_add_u32 m0, s51, 49152
  s_add_u32 s46, s77, 0
  buffer_load_dwordx4 v64, s[4:7], s46 offen lds
  s_add_u32 m0, s51, 53248
  s_add_u32 s46, s77, 393216
  buffer_load_dwordx4 v64, s[4:7], s46 offen lds
  s_add_u32 m0, s51, 57344
  s_add_u32 s46, s77, 128
  buffer_load_dwordx4 v64, s[4:7], s46 offen lds
  s_add_u32 m0, s51, 61440
  s_add_u32 s46, s77, 393344
  buffer_load_dwordx4 v64, s[4:7], s46 offen lds
  s_add_u32 m0, s51, 65536
  s_add_u32 s46, s77, 256
  buffer_load_dwordx4 v64, s[4:7], s46 offen lds
  s_add_u32 m0, s51, 69632
  s_add_u32 s46, s77, 393472
  buffer_load_dwordx4 v64, s[4:7], s46 offen lds
  ds_read_b64_tr_b16 v[184:185], v67 offset:8192
  ds_read_b64_tr_b16 v[186:187], v67 offset:9216
  ds_read_b64_tr_b16 v[188:189], v67 offset:12288
  ds_read_b64_tr_b16 v[190:191], v67 offset:13312
  ds_read_b64_tr_b16 v[192:193], v67 offset:16384
  ds_read_b64_tr_b16 v[194:195], v67 offset:17408
  ds_read_b64_tr_b16 v[196:197], v67 offset:20480
  ds_read_b64_tr_b16 v[198:199], v67 offset:21504
  ds_read_b64_tr_b16 v[200:201], v67 offset:24576
  ds_read_b64_tr_b16 v[202:203], v67 offset:25600
  ds_read_b64_tr_b16 v[204:205], v67 offset:28672
  ds_read_b64_tr_b16 v[206:207], v67 offset:29696
  s_waitcnt lgkmcnt(0)
  s_waitcnt vmcnt(24)
  s_barrier
  s_add_u32 m0, s51, 73728
  s_add_u32 s46, s79, 0
  buffer_load_dwordx4 v64, s[4:7], s46 offen lds
  s_add_u32 m0, s51, 77824
  s_add_u32 s46, s79, 393216
  buffer_load_dwordx4 v64, s[4:7], s46 offen lds
  s_add_u32 m0, s51, 81920
  s_add_u32 s46, s79, 128
  buffer_load_dwordx4 v64, s[4:7], s46 offen lds
  s_add_u32 m0, s51, 86016
  s_add_u32 s46, s79, 393344
  buffer_load_dwordx4 v64, s[4:7], s46 offen lds
  s_add_u32 m0, s51, 90112
  s_add_u32 s46, s79, 256
  buffer_load_dwordx4 v64, s[4:7], s46 offen lds
  s_add_u32 m0, s51, 94208
  s_add_u32 s46, s79, 393472
  buffer_load_dwordx4 v64, s[4:7], s46 offen lds
  ds_read_b64_tr_b16 v[208:209], v67 offset:32768
  ds_read_b64_tr_b16 v[210:211], v67 offset:33792
  ds_read_b64_tr_b16 v[212:213], v67 offset:36864
  ds_read_b64_tr_b16 v[214:215], v67 offset:37888
  ds_read_b64_tr_b16 v[216:217], v67 offset:40960
  ds_read_b64_tr_b16 v[218:219], v67 offset:41984
  ds_read_b64_tr_b16 v[220:221], v67 offset:45056
  ds_read_b64_tr_b16 v[222:223], v67 offset:46080
  ds_read_b64_tr_b16 v[224:225], v67 offset:49152
  ds_read_b64_tr_b16 v[226:227], v67 offset:50176
  ds_read_b64_tr_b16 v[228:229], v67 offset:53248
  ds_read_b64_tr_b16 v[230:231], v67 offset:54272
  s_waitcnt lgkmcnt(0)
  s_waitcnt vmcnt(24)
  s_barrier
  s_add_u32 m0, s51, 98304
  s_add_u32 s46, s81, 0
  buffer_load_dwordx4 v64, s[4:7], s46 offen lds
  s_add_u32 m0, s51, 102400
  s_add_u32 s46, s81, 393216
  buffer_load_dwordx4 v64, s[4:7], s46 offen lds
  s_add_u32 m0, s51, 106496
  s_add_u32 s46, s81, 128
  buffer_load_dwordx4 v64, s[4:7], s46 offen lds
  s_add_u32 m0, s51, 110592
  s_add_u32 s46, s81, 393344
  buffer_load_dwordx4 v64, s[4:7], s46 offen lds
  s_add_u32 m0, s51, 114688
  s_add_u32 s46, s81, 256
  buffer_load_dwordx4 v64, s[4:7], s46 offen lds
  s_add_u32 m0, s51, 118784
  s_add_u32 s46, s81, 393472
  buffer_load_dwordx4 v64, s[4:7], s46 offen lds
  ds_read_b64_tr_b16 v[232:233], v67 offset:57344
  ds_read_b64_tr_b16 v[234:235], v67 offset:58368
  ds_read_b64_tr_b16 v[236:237], v67 offset:61440
  ds_read_b64_tr_b16 v[238:239], v67 offset:62464
  ds_read_b64_tr_b16 v[240:241], v68 offset:0
  ds_read_b64_tr_b16 v[242:243], v68 offset:1024
  ds_read_b64_tr_b16 v[244:245], v68 offset:4096
  ds_read_b64_tr_b16 v[246:247], v68 offset:5120
  ds_read_b64_tr_b16 v[248:249], v68 offset:8192
  ds_read_b64_tr_b16 v[250:251], v68 offset:9216
  ds_read_b64_tr_b16 v[252:253], v68 offset:12288
  ds_read_b64_tr_b16 v[254:255], v68 offset:13312
  s_waitcnt lgkmcnt(0)
  s_waitcnt vmcnt(24)
  s_barrier
  ds_read_b64_tr_b16 v[40:41], v66 offset:0
  ds_read_b64_tr_b16 v[42:43], v66 offset:1024
  ds_read_b64_tr_b16 v[44:45], v66 offset:4096
  ds_read_b64_tr_b16 v[46:47], v66 offset:5120
  ds_read_b64_tr_b16 v[48:49], v66 offset:8192
  ds_read_b64_tr_b16 v[50:51], v66 offset:9216
  ds_read_b64_tr_b16 v[52:53], v66 offset:12288
  ds_read_b64_tr_b16 v[54:55], v66 offset:13312
  ds_read_b64_tr_b16 v[56:57], v66 offset:16384
  ds_read_b64_tr_b16 v[58:59], v66 offset:17408
  ds_read_b64_tr_b16 v[60:61], v66 offset:20480
  ds_read_b64_tr_b16 v[62:63], v66 offset:21504
  s_waitcnt lgkmcnt(0)
  s_waitcnt vmcnt(18)
  s_barrier
  ds_write_b128 v2, v[40:43] offset:0
  ds_write_b128 v2, v[44:47] offset:4096
  ds_write_b128 v2, v[48:51] offset:8192
  ds_write_b128 v2, v[52:55] offset:12288
  ds_write_b128 v2, v[56:59] offset:16384
  ds_write_b128 v2, v[60:63] offset:20480
  ds_read_b64_tr_b16 v[16:17], v66 offset:24576
  ds_read_b64_tr_b16 v[18:19], v66 offset:25600
  ds_read_b64_tr_b16 v[20:21], v66 offset:28672
  ds_read_b64_tr_b16 v[22:23], v66 offset:29696
  ds_read_b64_tr_b16 v[24:25], v66 offset:32768
  ds_read_b64_tr_b16 v[26:27], v66 offset:33792
  ds_read_b64_tr_b16 v[28:29], v66 offset:36864
  ds_read_b64_tr_b16 v[30:31], v66 offset:37888
  ds_read_b64_tr_b16 v[32:33], v66 offset:40960
  ds_read_b64_tr_b16 v[34:35], v66 offset:41984
  ds_read_b64_tr_b16 v[36:37], v66 offset:45056
  ds_read_b64_tr_b16 v[38:39], v66 offset:46080
  s_waitcnt lgkmcnt(0)
  s_waitcnt vmcnt(12)
  s_barrier
  ds_write_b128 v2, v[16:19] offset:24576
  ds_write_b128 v2, v[20:23] offset:28672
  ds_write_b128 v2, v[24:27] offset:32768
  ds_write_b128 v2, v[28:31] offset:36864
  ds_write_b128 v2, v[32:35] offset:40960
  ds_write_b128 v2, v[36:39] offset:45056
  ds_read_b64_tr_b16 v[40:41], v66 offset:49152
  ds_read_b64_tr_b16 v[42:43], v66 offset:50176
  ds_read_b64_tr_b16 v[44:45], v66 offset:53248
  ds_read_b64_tr_b16 v[46:47], v66 offset:54272
  ds_read_b64_tr_b16 v[48:49], v66 offset:57344
  ds_read_b64_tr_b16 v[50:51], v66 offset:58368
  ds_read_b64_tr_b16 v[52:53], v66 offset:61440
  ds_read_b64_tr_b16 v[54:55], v66 offset:62464
  ds_read_b64_tr_b16 v[56:57], v67 offset:0
  ds_read_b64_tr_b16 v[58:59], v67 offset:1024
  ds_read_b64_tr_b16 v[60:61], v67 offset:4096
  ds_read_b64_tr_b16 v[62:63], v67 offset:5120
  s_waitcnt lgkmcnt(0)
  s_waitcnt vmcnt(6)
  s_barrier
  ds_write_b128 v2, v[40:43] offset:49152
  ds_write_b128 v2, v[44:47] offset:53248
  ds_write_b128 v2, v[48:51] offset:57344
  ds_write_b128 v2, v[52:55] offset:61440
  ds_write_b128 v3, v[56:59] offset:0
  ds_write_b128 v3, v[60:63] offset:4096
  ds_read_b64_tr_b16 v[16:17], v67 offset:8192
  ds_read_b64_tr_b16 v[18:19], v67 offset:9216
  ds_read_b64_tr_b16 v[20:21], v67 offset:12288
  ds_read_b64_tr_b16 v[22:23], v67 offset:13312
  ds_read_b64_tr_b16 v[24:25], v67 offset:16384
  ds_read_b64_tr_b16 v[26:27], v67 offset:17408
  ds_read_b64_tr_b16 v[28:29], v67 offset:20480
  ds_read_b64_tr_b16 v[30:31], v67 offset:21504
  ds_read_b64_tr_b16 v[32:33], v67 offset:24576
  ds_read_b64_tr_b16 v[34:35], v67 offset:25600
  ds_read_b64_tr_b16 v[36:37], v67 offset:28672
  ds_read_b64_tr_b16 v[38:39], v67 offset:29696
  s_waitcnt lgkmcnt(0)
  s_waitcnt vmcnt(0)
  s_barrier
  ds_write_b128 v3, v[16:19] offset:8192
  ds_write_b128 v3, v[20:23] offset:12288
  ds_write_b128 v3, v[24:27] offset:16384
  ds_write_b128 v3, v[28:31] offset:20480
  ds_write_b128 v3, v[32:35] offset:24576
  ds_write_b128 v3, v[36:39] offset:28672
  ds_read_b64_tr_b16 v[40:41], v67 offset:32768
  ds_read_b64_tr_b16 v[42:43], v67 offset:33792
  ds_read_b64_tr_b16 v[44:45], v67 offset:36864
  ds_read_b64_tr_b16 v[46:47], v67 offset:37888
  ds_read_b64_tr_b16 v[48:49], v67 offset:40960
  ds_read_b64_tr_b16 v[50:51], v67 offset:41984
  ds_read_b64_tr_b16 v[52:53], v67 offset:45056
  ds_read_b64_tr_b16 v[54:55], v67 offset:46080
  ds_read_b64_tr_b16 v[56:57], v67 offset:49152
  ds_read_b64_tr_b16 v[58:59], v67 offset:50176
  ds_read_b64_tr_b16 v[60:61], v67 offset:53248
  ds_read_b64_tr_b16 v[62:63], v67 offset:54272
  s_waitcnt lgkmcnt(0)
  s_barrier
  ds_write_b128 v3, v[40:43] offset:32768
  ds_write_b128 v3, v[44:47] offset:36864
  ds_write_b128 v3, v[48:51] offset:40960
  ds_write_b128 v3, v[52:55] offset:45056
  ds_write_b128 v3, v[56:59] offset:49152
  ds_write_b128 v3, v[60:63] offset:53248
  s_waitcnt lgkmcnt(0)
  v_and_b32 v142, 1, v0
  v_mul_u32_u24 v142, 1130496, v142
  v_add_u32 v142, 1966080, v142
  buffer_load_dword v140, v142, s[8:11], 0 offen sc1
  s_waitcnt vmcnt(0)
  v_readlane_b32 s54, v140, 0
  v_readlane_b32 s55, v140, 1
  s_and_b32 s54, s54, 0x2000
  s_and_b32 s55, s55, 0x2000
  s_mov_b32 s68, 0xfffffffe
  v_and_b32 v140, 3, v0
  s_lshl_b32 s46, s43, 9
  s_add_u32 s46, s46, s55
  s_add_u32 s46, s46, 2883584
  v_lshl_add_u32 v10, v140, 7, s46
  v_mov_b32 v7, 0x44444444
  v_mov_b32 v140, 0xeeeeeeee
  v_and_b32 v141, 2, v0
  v_cmp_ne_u32 vcc, 0, v141
  s_nop 1
  v_cndmask_b32 v7, v7, v140, vcc
  v_and_b32 v140, 15, v0
  v_lshrrev_b32 v141, 4, v0
  v_lshlrev_b32 v8, 4, v140
  v_lshrrev_b32 v142, 1, v141
  v_lshl_add_u32 v8, v142, 3, v8
  v_and_b32 v143, 1, v141
  v_lshrrev_b32 v142, 2, v140
  v_lshlrev_b32 v4, 6, v142
  v_and_b32 v142, 1, v140
  v_lshl_add_u32 v4, v142, 5, v4
  v_lshl_add_u32 v4, v141, 3, v4
  v_bfe_u32 v142, v140, 1, 1
  v_lshl_add_u32 v4, v142, 2, v4
  s_and_b32 s46, s42, 1
  s_lshl_b32 s46, s46, 7
  v_xor_b32 v4, s46, v4
  s_lshl_b32 s46, s42, 8
  s_add_u32 s46, s46, 122880
  v_add_u32 v4, s46, v4
  s_lshl_b32 s46, s45, 8
  s_lshl_b32 s47, s42, 13
  s_add_u32 s47, s47, s46
  v_lshl_add_u32 v9, v143, 15, v8
  v_add_u32 v9, s47, v9
  s_lshl_b32 s47, s42, 14
  s_add_u32 s47, s47, s46
  s_add_u32 s47, s47, s54
  v_lshl_add_u32 v8, v143, 16, v8
  v_add_u32 v8, s47, v8
  v_lshlrev_b32 v5, 8, v141
  v_and_b32 v142, 1, v141
  v_lshl_add_u32 v5, v142, 7, v5
  v_lshl_add_u32 v5, v140, 3, v5
  v_xor_b32 v6, 0x80, v5
  v_add_u32 v5, 122880, v5
  v_add_u32 v6, 122880, v6
  s_lshl_b32 s46, s45, 7
  s_lshl_b32 s47, s42, 2
  s_add_u32 s47, s47, s46
  s_add_u32 s47, s47, 2965504
  v_mov_b32 v15, s47
  s_mov_b32 s64, 167772160
  s_mov_b32 s52, 0
  s_mov_b32 s58, 0
  s_mov_b32 s65, 1310720
  s_mov_b32 s100, 0
va_loop:
  s_add_u32 s53, s52, 1
  s_lshl_b32 s56, s58, 2
  s_add_u32 s56, s56, s43
  s_lshl_b32 s56, s56, 16
  s_add_u32 s56, s56, s55
  s_add_u32 s56, s56, 2097152
  v_add_u32 v11, s56, v1
  s_mul_i32 s66, s58, 655360
  s_mov_b64 s[16:17], -1
  s_mov_b32 s71, 0
  ds_read_b128 v[56:59], v2 offset:0
  ds_read_b128 v[60:63], v2 offset:4096
  ds_read_b128 v[64:67], v2 offset:8192
  ds_read_b128 v[68:71], v2 offset:12288
  ds_read_b128 v[72:75], v2 offset:16384
  ds_read_b128 v[76:79], v2 offset:20480
  ds_read_b128 v[80:83], v2 offset:24576
  ds_read_b128 v[84:87], v2 offset:28672
  ds_read_b128 v[88:91], v2 offset:32768
  ds_read_b128 v[92:95], v2 offset:36864
  ds_read_b128 v[96:99], v2 offset:40960
  ds_read_b128 v[100:103], v2 offset:45056
  v_mov_b32 v104, 0
  v_mov_b32 v105, 0
  v_mov_b32 v106, 0
  v_mov_b32 v107, 0
  v_mov_b32 v108, 0
  v_mov_b32 v109, 0
  v_mov_b32 v110, 0
  v_mov_b32 v111, 0
  v_mov_b32 v112, 0
  v_mov_b32 v113, 0
  v_mov_b32 v114, 0
  v_mov_b32 v115, 0
  s_cmp_lg_u32 s42, 3
  s_cbranch_scc1 va_nobell
  s_mov_b32 s50, 0
  s_mov_b64 exec, 15
  buffer_load_dword v116, v10, s[8:11], 0 offen sc1
  s_nop 11
  buffer_load_dword v117, v10, s[8:11], 0 offen sc1
  s_nop 11
  buffer_load_dword v118, v10, s[8:11], 0 offen sc1
  s_nop 11
  buffer_load_dword v119, v10, s[8:11], 0 offen sc1
  s_nop 11
  buffer_load_dword v120, v10, s[8:11], 0 offen sc1
  s_nop 11
  buffer_load_dword v121, v10, s[8:11], 0 offen sc1
  s_nop 11
  buffer_load_dword v122, v10, s[8:11], 0 offen sc1
  s_nop 11
  buffer_load_dword v123, v10, s[8:11], 0 offen sc1
  s_nop 11
  buffer_load_dword v124, v10, s[8:11], 0 offen sc1
  s_nop 11
bell_40:
  buffer_load_dword v125, v10, s[8:11], 0 offen sc1
  s_waitcnt vmcnt(9)
  v_cmp_gt_u32 vcc, s53, v116
  s_cbranch_vccz bell_x_41
  s_nop 7
  buffer_load_dword v116, v10, s[8:11], 0 offen sc1
  s_waitcnt vmcnt(9)
  v_cmp_gt_u32 vcc, s53, v117
  s_cbranch_vccz bell_x_41
  s_nop 7
  buffer_load_dword v117, v10, s[8:11], 0 offen sc1
  s_waitcnt vmcnt(9)
  v_cmp_gt_u32 vcc, s53, v118
  s_cbranch_vccz bell_x_41
  s_nop 7
  buffer_load_dword v118, v10, s[8:11], 0 offen sc1
  s_waitcnt vmcnt(9)
  v_cmp_gt_u32 vcc, s53, v119
  s_cbranch_vccz bell_x_41
  s_nop 7
  buffer_load_dword v119, v10, s[8:11], 0 offen sc1
  s_waitcnt vmcnt(9)
  v_cmp_gt_u32 vcc, s53, v120
  s_cbranch_vccz bell_x_41
  s_nop 7
  buffer_load_dword v120, v10, s[8:11], 0 offen sc1
  s_waitcnt vmcnt(9)
  v_cmp_gt_u32 vcc, s53, v121
  s_cbranch_vccz bell_x_41
  s_nop 7
  buffer_load_dword v121, v10, s[8:11], 0 offen sc1
  s_waitcnt vmcnt(9)
  v_cmp_gt_u32 vcc, s53, v122
  s_cbranch_vccz bell_x_41
  s_nop 7
  buffer_load_dword v122, v10, s[8:11], 0 offen sc1
  s_waitcnt vmcnt(9)
  v_cmp_gt_u32 vcc, s53, v123
  s_cbranch_vccz bell_x_41
  s_nop 7
  buffer_load_dword v123, v10, s[8:11], 0 offen sc1
  s_waitcnt vmcnt(9)
  v_cmp_gt_u32 vcc, s53, v124
  s_cbranch_vccz bell_x_41
  s_nop 7
  buffer_load_dword v124, v10, s[8:11], 0 offen sc1
  s_waitcnt vmcnt(9)
  v_cmp_gt_u32 vcc, s53, v125
  s_cbranch_vccz bell_x_41
  s_add_u32 s50, s50, 1
  s_cmp_gt_u32 s50, 131072
  s_cbranch_scc1 L_fail
  s_branch bell_40
bell_x_41:
  s_mov_b64 exec, -1
va_nobell:
  s_waitcnt lgkmcnt(0)
  s_barrier
  buffer_load_dwordx4 v[16:19], v11, s[8:11], s24 offen sc1
  s_barrier
  buffer_load_dwordx4 v[20:23], v11, s[8:11], s25 offen sc1
  s_barrier
  buffer_load_dwordx4 v[24:27], v11, s[8:11], s26 offen sc1
  s_barrier
  buffer_load_dwordx4 v[28:31], v11, s[8:11], s27 offen sc1
  s_barrier
  buffer_load_dwordx4 v[32:35], v11, s[8:11], s28 offen sc1
  s_barrier
  buffer_load_dwordx4 v[36:39], v11, s[8:11], s29 offen sc1
  s_barrier
  buffer_load_dwordx4 v[40:43], v11, s[8:11], s30 offen sc1
  s_barrier
  buffer_load_dwordx4 v[44:47], v11, s[8:11], s31 offen sc1
  s_barrier
  buffer_load_dwordx4 v[48:51], v11, s[8:11], s32 offen sc1
  s_barrier
  buffer_load_dwordx4 v[52:55], v11, s[8:11], s33 offen sc1
va_go_42:
  s_waitcnt vmcnt(9)
  v_smfmac_f32_16x16x64_bf16 v[104:107], v[16:19], a[240:247], v7
  v_smfmac_f32_16x16x64_bf16 v[108:111], v[16:19], a[248:255], v7
  v_smfmac_f32_16x16x64_bf16 v[112:115], v[16:19], v[152:159], v7
  s_waitcnt vmcnt(8)
  v_smfmac_f32_16x16x64_bf16 v[104:107], v[20:23], v[56:63], v7
  v_mov_b32 v16, 0
  v_smfmac_f32_16x16x64_bf16 v[108:111], v[20:23], v[64:71], v7
  ds_read_b128 v[56:59], v2 offset:49152
  v_mov_b32 v17, 0
  v_smfmac_f32_16x16x64_bf16 v[112:115], v[20:23], v[72:79], v7
  ds_read_b128 v[60:63], v2 offset:53248
  v_mov_b32 v18, 0
  v_mov_b32 v19, 0
  s_waitcnt vmcnt(7)
  v_smfmac_f32_16x16x64_bf16 v[104:107], v[24:27], v[160:167], v7
  ds_read_b128 v[64:67], v2 offset:57344
  v_mov_b32 v20, 0
  v_smfmac_f32_16x16x64_bf16 v[108:111], v[24:27], v[168:175], v7
  ds_read_b128 v[68:71], v2 offset:61440
  v_mov_b32 v21, 0
  v_smfmac_f32_16x16x64_bf16 v[112:115], v[24:27], v[176:183], v7
  ds_read_b128 v[72:75], v3 offset:0
  v_mov_b32 v22, 0
  v_mov_b32 v23, 0
  s_waitcnt vmcnt(6)
  v_smfmac_f32_16x16x64_bf16 v[104:107], v[28:31], v[80:87], v7
  ds_read_b128 v[76:79], v3 offset:4096
  v_mov_b32 v24, 0
  v_smfmac_f32_16x16x64_bf16 v[108:111], v[28:31], v[88:95], v7
  ds_read_b128 v[80:83], v3 offset:8192
  v_mov_b32 v25, 0
  v_smfmac_f32_16x16x64_bf16 v[112:115], v[28:31], v[96:103], v7
  ds_read_b128 v[84:87], v3 offset:12288
  v_mov_b32 v26, 0
  v_mov_b32 v27, 0
  s_waitcnt vmcnt(5)
  v_smfmac_f32_16x16x64_bf16 v[104:107], v[32:35], v[184:191], v7
  ds_read_b128 v[88:91], v3 offset:16384
  v_mov_b32 v28, 0
  v_smfmac_f32_16x16x64_bf16 v[108:111], v[32:35], v[192:199], v7
  ds_read_b128 v[92:95], v3 offset:20480
  v_mov_b32 v29, 0
  v_smfmac_f32_16x16x64_bf16 v[112:115], v[32:35], v[200:207], v7
  ds_read_b128 v[96:99], v3 offset:24576
  v_mov_b32 v30, 0
  v_mov_b32 v31, 0
  s_waitcnt vmcnt(4)
  s_waitcnt lgkmcnt(9)
  v_smfmac_f32_16x16x64_bf16 v[104:107], v[36:39], v[56:63], v7
  ds_read_b128 v[100:103], v3 offset:28672
  v_mov_b32 v32, 0
  s_waitcnt lgkmcnt(8)
  v_smfmac_f32_16x16x64_bf16 v[108:111], v[36:39], v[64:71], v7
  ds_read_b128 v[56:59], v3 offset:32768
  v_mov_b32 v33, 0
  s_waitcnt lgkmcnt(7)
  v_smfmac_f32_16x16x64_bf16 v[112:115], v[36:39], v[72:79], v7
  ds_read_b128 v[60:63], v3 offset:36864
  v_mov_b32 v34, 0
  v_mov_b32 v35, 0
  s_waitcnt vmcnt(3)
  v_smfmac_f32_16x16x64_bf16 v[104:107], v[40:43], v[208:215], v7
  ds_read_b128 v[64:67], v3 offset:40960
  v_mov_b32 v36, 0
  v_smfmac_f32_16x16x64_bf16 v[108:111], v[40:43], v[216:223], v7
  ds_read_b128 v[68:71], v3 offset:45056
  v_mov_b32 v37, 0
  v_smfmac_f32_16x16x64_bf16 v[112:115], v[40:43], v[224:231], v7
  ds_read_b128 v[72:75], v3 offset:49152
  v_mov_b32 v38, 0
  v_mov_b32 v39, 0
  s_waitcnt vmcnt(2)
  s_waitcnt lgkmcnt(9)
  v_smfmac_f32_16x16x64_bf16 v[104:107], v[44:47], v[80:87], v7
  ds_read_b128 v[76:79], v3 offset:53248
  v_mov_b32 v40, 0
  s_waitcnt lgkmcnt(8)
  v_smfmac_f32_16x16x64_bf16 v[108:111], v[44:47], v[88:95], v7
  v_mov_b32 v41, 0
  s_waitcnt lgkmcnt(6)
  v_smfmac_f32_16x16x64_bf16 v[112:115], v[44:47], v[96:103], v7
  v_mov_b32 v42, 0
  v_mov_b32 v43, 0
  s_waitcnt vmcnt(1)
  v_smfmac_f32_16x16x64_bf16 v[104:107], v[48:51], v[232:239], v7
  v_mov_b32 v44, 0
  v_smfmac_f32_16x16x64_bf16 v[108:111], v[48:51], v[240:247], v7
  v_mov_b32 v45, 0
  v_smfmac_f32_16x16x64_bf16 v[112:115], v[48:51], v[248:255], v7
  v_mov_b32 v46, 0
  v_mov_b32 v47, 0
  s_waitcnt vmcnt(0)
  s_waitcnt lgkmcnt(4)
  v_smfmac_f32_16x16x64_bf16 v[104:107], v[52:55], v[56:63], v7
  v_mov_b32 v48, 0
  s_waitcnt lgkmcnt(2)
  v_smfmac_f32_16x16x64_bf16 v[108:111], v[52:55], v[64:71], v7
  v_mov_b32 v49, 0
  s_waitcnt lgkmcnt(0)
  v_smfmac_f32_16x16x64_bf16 v[112:115], v[52:55], v[72:79], v7
  v_mov_b32 v50, 0
  v_mov_b32 v51, 0
  v_add_f32 v104, v104, v106
  v_add_f32 v105, v105, v107
  v_cmp_u_f32 vcc, v104, v105
  v_cvt_pk_bf16_f32 v106, v104, v105
  v_add_f32 v108, v108, v110
  v_add_f32 v109, v109, v111
  v_cvt_pk_bf16_f32 v110, v108, v109
  v_add_f32 v112, v112, v114
  v_add_f32 v113, v113, v115
  v_cvt_pk_bf16_f32 v114, v112, v113
  s_and_b64 vcc, vcc, s[16:17]
  s_cbranch_scc1 va_redo_43
  ds_write_b32 v4, v106 offset:0
  ds_write_b32 v4, v110 offset:1024
  ds_write_b32 v4, v114 offset:2048
  v_mov_b32 v52, 0
  v_mov_b32 v53, 0
  v_mov_b32 v54, 0
  v_mov_b32 v55, 0
  s_waitcnt lgkmcnt(0)
  s_barrier
  ds_read_b64_tr_b16 v[116:117], v5 offset:0
  ds_read_b64_tr_b16 v[118:119], v6 offset:0
  ds_read_b64_tr_b16 v[120:121], v5 offset:1024
  ds_read_b64_tr_b16 v[122:123], v6 offset:1024
  ds_read_b64_tr_b16 v[124:125], v5 offset:2048
  ds_read_b64_tr_b16 v[126:127], v6 offset:2048
  s_waitcnt lgkmcnt(4)
  v_smfmac_f32_16x16x64_bf16 v[16:19], v[116:119], a[0:7], v7
  s_waitcnt lgkmcnt(2)
  v_smfmac_f32_16x16x64_bf16 v[16:19], v[120:123], a[8:15], v7
  s_waitcnt lgkmcnt(0)
  v_smfmac_f32_16x16x64_bf16 v[16:19], v[124:127], a[16:23], v7
  v_smfmac_f32_16x16x64_bf16 v[20:23], v[116:119], a[24:31], v7
  v_smfmac_f32_16x16x64_bf16 v[20:23], v[120:123], a[32:39], v7
  v_add_f32 v16, v16, v18
  v_smfmac_f32_16x16x64_bf16 v[20:23], v[124:127], a[40:47], v7
  v_add_f32 v17, v17, v19
  v_smfmac_f32_16x16x64_bf16 v[24:27], v[116:119], a[48:55], v7
  v_cvt_pk_bf16_f32 v128, v16, v17
  v_smfmac_f32_16x16x64_bf16 v[24:27], v[120:123], a[56:63], v7
  v_add_f32 v20, v20, v22
  v_smfmac_f32_16x16x64_bf16 v[24:27], v[124:127], a[64:71], v7
  v_add_f32 v21, v21, v23
  v_smfmac_f32_16x16x64_bf16 v[28:31], v[116:119], a[72:79], v7
  s_add_u32 s46, s66, 0
  v_cvt_pk_bf16_f32 v129, v20, v21
  v_smfmac_f32_16x16x64_bf16 v[28:31], v[120:123], a[80:87], v7
  v_add_f32 v24, v24, v26
  v_smfmac_f32_16x16x64_bf16 v[28:31], v[124:127], a[88:95], v7
  v_permlane16_swap_b32 v128, v129
  v_add_f32 v25, v25, v27
  v_smfmac_f32_16x16x64_bf16 v[32:35], v[116:119], a[96:103], v7
  buffer_store_dwordx2 v[128:129], v8, s[8:11], s46 offen sc1
  v_cvt_pk_bf16_f32 v130, v24, v25
  v_smfmac_f32_16x16x64_bf16 v[32:35], v[120:123], a[104:111], v7
  v_add_f32 v28, v28, v30
  v_smfmac_f32_16x16x64_bf16 v[32:35], v[124:127], a[112:119], v7
  v_add_f32 v29, v29, v31
  v_smfmac_f32_16x16x64_bf16 v[36:39], v[116:119], a[120:127], v7
  s_add_u32 s46, s66, 131072
  v_cvt_pk_bf16_f32 v131, v28, v29
  v_smfmac_f32_16x16x64_bf16 v[36:39], v[120:123], a[128:135], v7
  v_add_f32 v32, v32, v34
  v_smfmac_f32_16x16x64_bf16 v[36:39], v[124:127], a[136:143], v7
  v_permlane16_swap_b32 v130, v131
  v_add_f32 v33, v33, v35
  v_smfmac_f32_16x16x64_bf16 v[40:43], v[116:119], a[144:151], v7
  buffer_store_dwordx2 v[130:131], v8, s[8:11], s46 offen sc1
  v_cvt_pk_bf16_f32 v132, v32, v33
  v_smfmac_f32_16x16x64_bf16 v[40:43], v[120:123], a[152:159], v7
  v_add_f32 v36, v36, v38
  v_smfmac_f32_16x16x64_bf16 v[40:43], v[124:127], a[160:167], v7
  v_add_f32 v37, v37, v39
  v_smfmac_f32_16x16x64_bf16 v[44:47], v[116:119], a[168:175], v7
  s_add_u32 s46, s66, 262144
  v_cvt_pk_bf16_f32 v133, v36, v37
  v_smfmac_f32_16x16x64_bf16 v[44:47], v[120:123], a[176:183], v7
  v_add_f32 v40, v40, v42
  v_smfmac_f32_16x16x64_bf16 v[44:47], v[124:127], a[184:191], v7
  v_permlane16_swap_b32 v132, v133
  v_add_f32 v41, v41, v43
  v_smfmac_f32_16x16x64_bf16 v[48:51], v[116:119], a[192:199], v7
  buffer_store_dwordx2 v[132:133], v8, s[8:11], s46 offen sc1
  v_cvt_pk_bf16_f32 v134, v40, v41
  v_smfmac_f32_16x16x64_bf16 v[48:51], v[120:123], a[200:207], v7
  v_add_f32 v44, v44, v46
  v_smfmac_f32_16x16x64_bf16 v[48:51], v[124:127], a[208:215], v7
  v_add_f32 v45, v45, v47
  v_smfmac_f32_16x16x64_bf16 v[52:55], v[116:119], a[216:223], v7
  s_add_u32 s46, s66, 393216
  v_cvt_pk_bf16_f32 v135, v44, v45
  v_smfmac_f32_16x16x64_bf16 v[52:55], v[120:123], a[224:231], v7
  v_add_f32 v48, v48, v50
  v_smfmac_f32_16x16x64_bf16 v[52:55], v[124:127], a[232:239], v7
  v_permlane16_swap_b32 v134, v135
  buffer_store_dwordx2 v[134:135], v8, s[8:11], s46 offen sc1
  v_add_f32 v49, v49, v51
  v_cvt_pk_bf16_f32 v136, v48, v49
  s_nop 3
  v_add_f32 v52, v52, v54
  v_add_f32 v53, v53, v55
  v_cvt_pk_bf16_f32 v137, v52, v53
  s_add_u32 s46, s66, 524288
  s_nop 0
  v_permlane16_swap_b32 v136, v137
  buffer_store_dwordx2 v[136:137], v8, s[8:11], s46 offen sc1
  s_add_u32 s58, s58, 1
  s_cmp_eq_u32 s58, 3
  s_cselect_b32 s58, 0, s58
  s_mov_b32 s52, s53
  s_cmp_lt_u32 s52, 64
  s_cbranch_scc1 va_loop
  s_mov_b32 s46, 188416000
  buffer_store_dwordx2 v[128:129], v9, s[8:11], s46 offen sc1
  s_mov_b32 s46, 188481536
  buffer_store_dwordx2 v[130:131], v9, s[8:11], s46 offen sc1
  s_mov_b32 s46, 188547072
  buffer_store_dwordx2 v[132:133], v9, s[8:11], s46 offen sc1
  s_mov_b32 s46, 188612608
  buffer_store_dwordx2 v[134:135], v9, s[8:11], s46 offen sc1
  s_mov_b32 s46, 188678144
  buffer_store_dwordx2 v[136:137], v9, s[8:11], s46 offen sc1
  s_waitcnt vmcnt(0)
  v_mov_b32 v140, s52
  s_mov_b64 exec, 1
  buffer_store_dword v140, v15, s[8:11], 0 offen sc1
  s_mov_b64 exec, -1
  s_endpgm
va_redo_43:
  s_mov_b32 s50, 0
va_poll_44:
  buffer_load_dwordx4 v[16:19], v11, s[8:11], s24 offen sc1
  buffer_load_dwordx4 v[20:23], v11, s[8:11], s25 offen sc1
  buffer_load_dwordx4 v[24:27], v11, s[8:11], s26 offen sc1
  buffer_load_dwordx4 v[28:31], v11, s[8:11], s27 offen sc1
  buffer_load_dwordx4 v[32:35], v11, s[8:11], s28 offen sc1
  buffer_load_dwordx4 v[36:39], v11, s[8:11], s29 offen sc1
  buffer_load_dwordx4 v[40:43], v11, s[8:11], s30 offen sc1
  buffer_load_dwordx4 v[44:47], v11, s[8:11], s31 offen sc1
  buffer_load_dwordx4 v[48:51], v11, s[8:11], s32 offen sc1
  buffer_load_dwordx4 v[52:55], v11, s[8:11], s33 offen sc1
  s_add_u32 s71, s71, 1
  s_cmp_le_u32 s71, 2
  s_cbranch_scc1 va_again_45
  s_add_u32 s50, s50, 1
  s_cmp_gt_u32 s50, 131072
  s_cbranch_scc1 L_fail
  s_waitcnt vmcnt(0)
  v_max_u32 v12, v16, v17
  v_max3_u32 v12, v18, v19, v12
  v_max3_u32 v12, v20, v21, v12
  v_max3_u32 v12, v22, v23, v12
  v_max3_u32 v12, v24, v25, v12
  v_max3_u32 v12, v26, v27, v12
  v_max3_u32 v12, v28, v29, v12
  v_max3_u32 v12, v30, v31, v12
  v_max3_u32 v12, v32, v33, v12
  v_max3_u32 v12, v34, v35, v12
  v_max3_u32 v12, v36, v37, v12
  v_max3_u32 v12, v38, v39, v12
  v_max3_u32 v12, v40, v41, v12
  v_max3_u32 v12, v42, v43, v12
  v_max3_u32 v12, v44, v45, v12
  v_max3_u32 v12, v46, v47, v12
  v_max3_u32 v12, v48, v49, v12
  v_max3_u32 v12, v50, v51, v12
  v_max3_u32 v12, v52, v53, v12
  v_max3_u32 v12, v54, v55, v12
  v_cmp_eq_u32 vcc, -1, v12
  s_cbranch_vccnz va_poll_44
  s_mov_b64 s[16:17], 0
va_again_45:
  s_waitcnt lgkmcnt(0)
  ds_read_b128 v[56:59], v2 offset:0
  ds_read_b128 v[60:63], v2 offset:4096
  ds_read_b128 v[64:67], v2 offset:8192
  ds_read_b128 v[68:71], v2 offset:12288
  ds_read_b128 v[72:75], v2 offset:16384
  ds_read_b128 v[76:79], v2 offset:20480
  ds_read_b128 v[80:83], v2 offset:24576
  ds_read_b128 v[84:87], v2 offset:28672
  ds_read_b128 v[88:91], v2 offset:32768
  ds_read_b128 v[92:95], v2 offset:36864
  ds_read_b128 v[96:99], v2 offset:40960
  ds_read_b128 v[100:103], v2 offset:45056
  v_mov_b32 v104, 0
  v_mov_b32 v105, 0
  v_mov_b32 v106, 0
  v_mov_b32 v107, 0
  v_mov_b32 v108, 0
  v_mov_b32 v109, 0
  v_mov_b32 v110, 0
  v_mov_b32 v111, 0
  v_mov_b32 v112, 0
  v_mov_b32 v113, 0
  v_mov_b32 v114, 0
  v_mov_b32 v115, 0
  s_waitcnt lgkmcnt(0)
  s_branch va_go_42
L_owner:
  s_cmp_ge_u32 s42, 2
  s_cbranch_scc1 L_end
  s_mul_i32 s62, s43, 10
  s_add_u32 s62, s62, s44
  s_sub_u32 s62, s62, 16
  s_mov_b32 s12, s24
  s_mov_b32 s13, s25
  s_mov_b32 s14, 10240
  s_mov_b32 s15, 0x20000
  v_and_b32 v12, 1, v0
  v_mul_u32_u24 v12, 1130496, v12
  v_add_u32 v12, 1966080, v12
  buffer_load_dword v10, v12, s[8:11], 0 offen sc1
  s_waitcnt vmcnt(0)
  v_readlane_b32 s54, v10, 0
  v_readlane_b32 s55, v10, 1
  s_and_b32 s54, s54, 0x2000
  s_and_b32 s55, s55, 0x2000
  s_mov_b32 s68, 0xfffffffe
  v_and_b32 v10, 3, v0
  s_lshl_b32 s46, s43, 9
  s_add_u32 s46, s46, s55
  s_add_u32 s46, s46, 2885632
  v_lshl_add_u32 v6, v10, 7, s46
  s_lshl_b32 s46, s43, 7
  s_add_u32 s46, s46, s55
  s_add_u32 s46, s46, 2883584
  v_lshl_add_u32 v7, v10, 9, s46
  s_cmp_eq_u32 s42, 0
  s_cbranch_scc1 ow_main
  s_mov_b32 s53, 1
ow_listen:
  s_mov_b32 s50, 0
  s_mov_b64 exec, 15
  buffer_load_dword v136, v6, s[8:11], 0 offen sc1
  s_nop 11
  buffer_load_dword v137, v6, s[8:11], 0 offen sc1
  s_nop 11
  buffer_load_dword v138, v6, s[8:11], 0 offen sc1
  s_nop 11
  buffer_load_dword v139, v6, s[8:11], 0 offen sc1
  s_nop 11
  buffer_load_dword v140, v6, s[8:11], 0 offen sc1
  s_nop 11
  buffer_load_dword v141, v6, s[8:11], 0 offen sc1
  s_nop 11
  buffer_load_dword v142, v6, s[8:11], 0 offen sc1
  s_nop 11
  buffer_load_dword v143, v6, s[8:11], 0 offen sc1
  s_nop 11
  buffer_load_dword v144, v6, s[8:11], 0 offen sc1
  s_nop 11
bell_46:
  buffer_load_dword v145, v6, s[8:11], 0 offen sc1
  s_waitcnt vmcnt(9)
  v_cmp_gt_u32 vcc, s53, v136
  s_cbranch_vccz bell_x_47
  s_nop 7
  buffer_load_dword v136, v6, s[8:11], 0 offen sc1
  s_waitcnt vmcnt(9)
  v_cmp_gt_u32 vcc, s53, v137
  s_cbranch_vccz bell_x_47
  s_nop 7
  buffer_load_dword v137, v6, s[8:11], 0 offen sc1
  s_waitcnt vmcnt(9)
  v_cmp_gt_u32 vcc, s53, v138
  s_cbranch_vccz bell_x_47
  s_nop 7
  buffer_load_dword v138, v6, s[8:11], 0 offen sc1
  s_waitcnt vmcnt(9)
  v_cmp_gt_u32 vcc, s53, v139
  s_cbranch_vccz bell_x_47
  s_nop 7
  buffer_load_dword v139, v6, s[8:11], 0 offen sc1
  s_waitcnt vmcnt(9)
  v_cmp_gt_u32 vcc, s53, v140
  s_cbranch_vccz bell_x_47
  s_nop 7
  buffer_load_dword v140, v6, s[8:11], 0 offen sc1
  s_waitcnt vmcnt(9)
  v_cmp_gt_u32 vcc, s53, v141
  s_cbranch_vccz bell_x_47
  s_nop 7
  buffer_load_dword v141, v6, s[8:11], 0 offen sc1
  s_waitcnt vmcnt(9)
  v_cmp_gt_u32 vcc, s53, v142
  s_cbranch_vccz bell_x_47
  s_nop 7
  buffer_load_dword v142, v6, s[8:11], 0 offen sc1
  s_waitcnt vmcnt(9)
  v_cmp_gt_u32 vcc, s53, v143
  s_cbranch_vccz bell_x_47
  s_nop 7
  buffer_load_dword v143, v6, s[8:11], 0 offen sc1
  s_waitcnt vmcnt(9)
  v_cmp_gt_u32 vcc, s53, v144
  s_cbranch_vccz bell_x_47
  s_nop 7
  buffer_load_dword v144, v6, s[8:11], 0 offen sc1
  s_waitcnt vmcnt(9)
  v_cmp_gt_u32 vcc, s53, v145
  s_cbranch_vccz bell_x_47
  s_add_u32 s50, s50, 1
  s_cmp_gt_u32 s50, 131072
  s_cbranch_scc1 L_fail
  s_branch bell_46
bell_x_47:
  s_mov_b64 exec, -1
  s_barrier
  s_barrier
  s_sleep 16
  s_add_u32 s53, s53, 1
  s_cmp_lt_u32 s53, 64
  s_cbranch_scc1 ow_listen
  s_endpgm
ow_main:
  v_mov_b32 v5, 0x44444444
  v_mov_b32 v10, 0xeeeeeeee
  v_and_b32 v11, 2, v0
  v_cmp_ne_u32 vcc, 0, v11
  s_nop 1
  v_cndmask_b32 v5, v5, v10, vcc
  v_lshlrev_b32 v1, 4, v0
  v_and_b32 v10, 15, v0
  v_lshrrev_b32 v11, 4, v0
  v_lshlrev_b32 v2, 3, v10
  v_lshl_add_u32 v2, v11, 8, v2
  v_and_b32 v13, 1, v10
  v_lshl_add_u32 v12, v11, 1, v13
  v_mov_b32 v4, 0x05040100
  v_mov_b32 v14, 0x03020706
  v_cmp_eq_u32 vcc, 1, v13
  s_nop 1
  v_cndmask_b32 v4, v4, v14, vcc
  v_and_b32 v13, 3, v10
  v_lshl_add_u32 v3, v11, 2, v13
  v_lshlrev_b32 v3, 4, v3
  v_lshrrev_b32 v13, 2, v10
  v_lshl_add_u32 v3, v13, 2, v3
  v_mov_b32 v14, 2146435072
  s_cmp_eq_u32 s44, 16
  s_cselect_b64 vcc, 15, 0
  v_cndmask_b32 v7, v14, v7, vcc
  s_lshl_b32 s46, s43, 7
  s_add_u32 s46, s46, s55
  s_add_u32 s46, s46, 2887680
  v_mov_b32 v19, s46
  s_cmp_eq_u32 s44, 17
  s_cselect_b64 vcc, 1, 0
  v_cndmask_b32 v19, v14, v19, vcc
  s_lshl_b32 s46, s62, 8
  s_cmp_ge_u32 s62, 32
  s_cselect_b32 s47, 40960, 0
  s_add_u32 s46, s46, s47
  s_add_u32 s46, s46, s55
  s_add_u32 s46, s46, 2097152
  v_add_u32 v3, s46, v3
  v_mul_u32_u24 v12, 1280, v12
  v_and_b32 v13, 14, v10
  v_lshl_add_u32 v12, v13, 1, v12
  s_lshl_b32 s46, s62, 5
  buffer_load_dword v15, v12, s[12:15], s46 offen
  v_and_b32 v9, 31, v0
  v_lshlrev_b32 v9, 7, v9
  s_and_b32 s46, s62, 3
  s_lshl_b32 s46, s46, 2
  s_add_u32 s46, s46, 2949120
  v_add_u32 v9, s46, v9
  s_lshl_b32 s63, s62, 15
  s_add_u32 s63, s63, 83886080
  s_lshl_b32 s65, s62, 13
  s_add_u32 s65, s65, 167772160
  s_mov_b32 s61, 0
  s_mov_b32 s52, 0
  s_mov_b32 s58, 0
  s_mov_b32 s100, 0
  s_waitcnt vmcnt(0)
  v_min_u32 v15, s68, v15
  s_mov_b32 s46, 0
  buffer_store_dword v15, v3, s[8:11], s46 offen sc1
  s_mov_b32 s46, 65536
  buffer_store_dword v15, v3, s[8:11], s46 offen sc1
  s_mov_b32 s46, 131072
  buffer_store_dword v15, v3, s[8:11], s46 offen sc1
  s_mov_b32 s46, 196608
  buffer_store_dword v15, v3, s[8:11], s46 offen sc1
  v_mov_b32 v16, 1
  buffer_store_dword v16, v7, s[8:11], 0 offen sc1
  s_mov_b32 s49, 1
  s_cmp_ge_u32 s61, s49
  s_cbranch_scc1 wf_done_48
  s_mov_b32 s50, 0
wf_loop_49:
  buffer_load_dword v12, v9, s[8:11], 0 offen sc1
  s_add_u32 s50, s50, 1
  s_cmp_gt_u32 s50, 131072
  s_cbranch_scc1 L_fail
  s_waitcnt vmcnt(0)
  v_min_u32_dpp v12, v12, v12 row_ror:8 row_mask:0xf bank_mask:0xf
  s_nop 1
  v_min_u32_dpp v12, v12, v12 row_ror:4 row_mask:0xf bank_mask:0xf
  s_nop 1
  v_min_u32_dpp v12, v12, v12 row_ror:2 row_mask:0xf bank_mask:0xf
  s_nop 1
  v_min_u32_dpp v12, v12, v12 row_ror:1 row_mask:0xf bank_mask:0xf
  v_mov_b32 v13, v12
  s_nop 1
  v_permlane16_swap_b32 v13, v12
  v_min_u32 v12, v12, v13
  v_mov_b32 v13, v12
  s_nop 1
  v_permlane32_swap_b32 v13, v12
  v_min_u32 v12, v12, v13
  s_nop 0
  v_readfirstlane_b32 s61, v12
  s_nop 0
  s_cmp_ge_u32 s61, s49
  s_cbranch_scc1 wf_done_48
  s_sleep 2
  s_branch wf_loop_49
wf_done_48:
  s_add_u32 s46, s63, 0
  buffer_load_dwordx4 a[0:3], v1, s[8:11], s46 offen offset:0 sc1
  buffer_load_dwordx4 a[4:7], v1, s[8:11], s46 offen offset:1024 sc1
  buffer_load_dwordx4 a[8:11], v1, s[8:11], s46 offen offset:2048 sc1
  buffer_load_dwordx4 a[12:15], v1, s[8:11], s46 offen offset:3072 sc1
  s_add_u32 s46, s63, 4096
  buffer_load_dwordx4 a[16:19], v1, s[8:11], s46 offen offset:0 sc1
  buffer_load_dwordx4 a[20:23], v1, s[8:11], s46 offen offset:1024 sc1
  buffer_load_dwordx4 a[24:27], v1, s[8:11], s46 offen offset:2048 sc1
  buffer_load_dwordx4 a[28:31], v1, s[8:11], s46 offen offset:3072 sc1
  s_add_u32 s46, s63, 8192
  buffer_load_dwordx4 a[32:35], v1, s[8:11], s46 offen offset:0 sc1
  buffer_load_dwordx4 a[36:39], v1, s[8:11], s46 offen offset:1024 sc1
  buffer_load_dwordx4 a[40:43], v1, s[8:11], s46 offen offset:2048 sc1
  buffer_load_dwordx4 a[44:47], v1, s[8:11], s46 offen offset:3072 sc1
  s_add_u32 s46, s63, 12288
  buffer_load_dwordx4 a[48:51], v1, s[8:11], s46 offen offset:0 sc1
  buffer_load_dwordx4 a[52:55], v1, s[8:11], s46 offen offset:1024 sc1
  buffer_load_dwordx4 a[56:59], v1, s[8:11], s46 offen offset:2048 sc1
  buffer_load_dwordx4 a[60:63], v1, s[8:11], s46 offen offset:3072 sc1
  s_add_u32 s46, s63, 16384
  buffer_load_dwordx4 a[64:67], v1, s[8:11], s46 offen offset:0 sc1
  buffer_load_dwordx4 a[68:71], v1, s[8:11], s46 offen offset:1024 sc1
  buffer_load_dwordx4 a[72:75], v1, s[8:11], s46 offen offset:2048 sc1
  buffer_load_dwordx4 a[76:79], v1, s[8:11], s46 offen offset:3072 sc1
  s_add_u32 s46, s63, 20480
  buffer_load_dwordx4 a[80:83], v1, s[8:11], s46 offen offset:0 sc1
  buffer_load_dwordx4 a[84:87], v1, s[8:11], s46 offen offset:1024 sc1
  buffer_load_dwordx4 a[88:91], v1, s[8:11], s46 offen offset:2048 sc1
  buffer_load_dwordx4 a[92:95], v1, s[8:11], s46 offen offset:3072 sc1
  s_add_u32 s46, s63, 24576
  buffer_load_dwordx4 a[96:99], v1, s[8:11], s46 offen offset:0 sc1
  buffer_load_dwordx4 a[100:103], v1, s[8:11], s46 offen offset:1024 sc1
  buffer_load_dwordx4 a[104:107], v1, s[8:11], s46 offen offset:2048 sc1
  buffer_load_dwordx4 a[108:111], v1, s[8:11], s46 offen offset:3072 sc1
  s_add_u32 s46, s63, 28672
  buffer_load_dwordx4 a[112:115], v1, s[8:11], s46 offen offset:0 sc1
  buffer_load_dwordx4 a[116:119], v1, s[8:11], s46 offen offset:1024 sc1
  buffer_load_dwordx4 a[120:123], v1, s[8:11], s46 offen offset:2048 sc1
  buffer_load_dwordx4 a[124:127], v1, s[8:11], s46 offen offset:3072 sc1
  s_add_u32 s63, s63, 1310720
ow_loop:
  s_add_u32 s53, s52, 1
  s_lshl_b32 s56, s58, 2
  s_add_u32 s56, s56, s43
  s_lshl_b32 s56, s56, 16
  s_add_u32 s56, s56, s55
  s_add_u32 s56, s56, 2097152
  s_add_u32 s66, s58, 1
  s_cmp_eq_u32 s66, 3
  s_cselect_b32 s66, 0, s66
  s_mul_i32 s72, s58, 655360
  s_lshl_b32 s46, s62, 14
  s_add_u32 s72, s72, s46
  s_add_u32 s72, s72, s54
  s_add_u32 s73, s72, 4096
  s_and_b32 s46, s43, 3
  s_lshl_b32 s46, s46, 16
  s_sub_u32 s56, s56, s46
  s_add_u32 s74, s56, 16384
  s_add_u32 s75, s56, 20480
  s_add_u32 s76, s56, 32768
  s_add_u32 s77, s56, 36864
  s_add_u32 s78, s56, 51200
  s_lshl_b32 s80, s66, 18
  s_add_u32 s81, s80, 65536
  s_add_u32 s82, s80, 131072
  s_add_u32 s83, s80, 196608
  s_add_u32 s64, s52, 2
  v_mov_b32 v16, s64
  s_mov_b64 s[16:17], -1
  s_mov_b32 s71, 0
  v_mov_b32 v20, 0
  v_mov_b32 v21, 0
  v_mov_b32 v22, 0
  v_mov_b32 v23, 0
  s_add_u32 s49, s52, 4
  s_min_u32 s49, s49, 64
  s_cmp_ge_u32 s61, s49
  s_cbranch_scc1 ow_norf
  buffer_load_dword v12, v9, s[8:11], 0 offen sc1
  s_waitcnt vmcnt(0)
  v_min_u32_dpp v12, v12, v12 row_ror:8 row_mask:0xf bank_mask:0xf
  s_nop 1
  v_min_u32_dpp v12, v12, v12 row_ror:4 row_mask:0xf bank_mask:0xf
  s_nop 1
  v_min_u32_dpp v12, v12, v12 row_ror:2 row_mask:0xf bank_mask:0xf
  s_nop 1
  v_min_u32_dpp v12, v12, v12 row_ror:1 row_mask:0xf bank_mask:0xf
  v_mov_b32 v13, v12
  s_nop 1
  v_permlane16_swap_b32 v13, v12
  v_min_u32 v12, v12, v13
  v_mov_b32 v13, v12
  s_nop 1
  v_permlane32_swap_b32 v13, v12
  v_min_u32 v12, v12, v13
  s_nop 0
  v_readfirstlane_b32 s61, v12
ow_norf:
  s_waitcnt vmcnt(0)
  s_barrier
  buffer_load_dwordx4 v[24:27], v1, s[8:11], s72 offen offset:0 sc1
  buffer_load_dwordx4 v[28:31], v1, s[8:11], s72 offen offset:1024 sc1
  buffer_load_dwordx4 v[32:35], v1, s[8:11], s72 offen offset:2048 sc1
  buffer_load_dwordx4 v[36:39], v1, s[8:11], s72 offen offset:3072 sc1
  buffer_load_dwordx4 v[40:43], v1, s[8:11], s73 offen offset:0 sc1
  buffer_load_dwordx4 v[44:47], v1, s[8:11], s73 offen offset:1024 sc1
  buffer_load_dwordx4 v[48:51], v1, s[8:11], s73 offen offset:2048 sc1
  buffer_load_dwordx4 v[52:55], v1, s[8:11], s73 offen offset:3072 sc1
  buffer_load_dwordx2 v[56:57], v2, s[8:11], s78 offen offset:0 sc1
  buffer_load_dwordx2 v[58:59], v2, s[8:11], s78 offen offset:128 sc1
  buffer_load_dwordx2 v[60:61], v2, s[8:11], s78 offen offset:1024 sc1
  buffer_load_dwordx2 v[62:63], v2, s[8:11], s78 offen offset:1152 sc1
  buffer_load_dwordx2 v[64:65], v2, s[8:11], s78 offen offset:2048 sc1
  buffer_load_dwordx2 v[66:67], v2, s[8:11], s78 offen offset:2176 sc1
  buffer_load_dwordx2 v[68:69], v2, s[8:11], s78 offen offset:3072 sc1
  buffer_load_dwordx2 v[70:71], v2, s[8:11], s78 offen offset:3200 sc1
  buffer_load_dwordx4 v[72:75], v1, s[8:11], s74 offen offset:0 sc1
  buffer_load_dwordx4 v[76:79], v1, s[8:11], s74 offen offset:1024 sc1
  buffer_load_dwordx4 v[80:83], v1, s[8:11], s74 offen offset:2048 sc1
  buffer_load_dwordx4 v[84:87], v1, s[8:11], s74 offen offset:3072 sc1
  buffer_load_dwordx4 v[88:91], v1, s[8:11], s75 offen offset:0 sc1
  buffer_load_dwordx4 v[92:95], v1, s[8:11], s75 offen offset:1024 sc1
  buffer_load_dwordx4 v[96:99], v1, s[8:11], s75 offen offset:2048 sc1
  buffer_load_dwordx4 v[100:103], v1, s[8:11], s75 offen offset:3072 sc1
  buffer_load_dwordx4 v[104:107], v1, s[8:11], s76 offen offset:0 sc1
  buffer_load_dwordx4 v[108:111], v1, s[8:11], s76 offen offset:1024 sc1
  buffer_load_dwordx4 v[112:115], v1, s[8:11], s76 offen offset:2048 sc1
  buffer_load_dwordx4 v[116:119], v1, s[8:11], s76 offen offset:3072 sc1
  buffer_load_dwordx4 v[120:123], v1, s[8:11], s77 offen offset:0 sc1
  buffer_load_dwordx4 v[124:127], v1, s[8:11], s77 offen offset:1024 sc1
  buffer_load_dwordx4 v[128:131], v1, s[8:11], s77 offen offset:2048 sc1
  buffer_load_dwordx4 v[132:135], v1, s[8:11], s77 offen offset:3072 sc1
ow_go:
  s_waitcnt vmcnt(22)
  v_smfmac_f32_16x16x64_bf16 v[20:23], v[56:59], v[24:31], v5
  s_waitcnt vmcnt(20)
  v_smfmac_f32_16x16x64_bf16 v[20:23], v[60:63], v[32:39], v5
  s_waitcnt vmcnt(18)
  v_smfmac_f32_16x16x64_bf16 v[20:23], v[64:67], v[40:47], v5
  s_waitcnt vmcnt(16)
  v_smfmac_f32_16x16x64_bf16 v[20:23], v[68:71], v[48:55], v5
  s_waitcnt vmcnt(15)
  v_smfmac_f32_16x16x64_bf16 v[20:23], v[72:75], a[0:7], v5
  s_waitcnt vmcnt(14)
  v_smfmac_f32_16x16x64_bf16 v[20:23], v[76:79], a[8:15], v5
  buffer_store_dword v16, v7, s[8:11], 0 offen sc1
  s_waitcnt vmcnt(14)
  v_smfmac_f32_16x16x64_bf16 v[20:23], v[80:83], a[16:23], v5
  s_waitcnt vmcnt(13)
  v_smfmac_f32_16x16x64_bf16 v[20:23], v[84:87], a[24:31], v5
  s_waitcnt vmcnt(12)
  v_smfmac_f32_16x16x64_bf16 v[20:23], v[88:91], a[32:39], v5
  s_waitcnt vmcnt(11)
  v_smfmac_f32_16x16x64_bf16 v[20:23], v[92:95], a[40:47], v5
  s_waitcnt vmcnt(10)
  v_smfmac_f32_16x16x64_bf16 v[20:23], v[96:99], a[48:55], v5
  s_waitcnt vmcnt(9)
  v_smfmac_f32_16x16x64_bf16 v[20:23], v[100:103], a[56:63], v5
  s_waitcnt vmcnt(8)
  v_smfmac_f32_16x16x64_bf16 v[20:23], v[104:107], a[64:71], v5
  s_waitcnt vmcnt(7)
  v_smfmac_f32_16x16x64_bf16 v[20:23], v[108:111], a[72:79], v5
  s_waitcnt vmcnt(6)
  v_smfmac_f32_16x16x64_bf16 v[20:23], v[112:115], a[80:87], v5
  s_waitcnt vmcnt(5)
  v_smfmac_f32_16x16x64_bf16 v[20:23], v[116:119], a[88:95], v5
  s_waitcnt vmcnt(4)
  v_smfmac_f32_16x16x64_bf16 v[20:23], v[120:123], a[96:103], v5
  s_waitcnt vmcnt(3)
  v_smfmac_f32_16x16x64_bf16 v[20:23], v[124:127], a[104:111], v5
  s_waitcnt vmcnt(2)
  v_smfmac_f32_16x16x64_bf16 v[20:23], v[128:131], a[112:119], v5
  s_waitcnt vmcnt(1)
  v_smfmac_f32_16x16x64_bf16 v[20:23], v[132:135], a[120:127], v5
  s_nop 7
  v_add_f32 v20, v20, v22
  v_add_f32 v21, v21, v23
  v_cvt_pk_bf16_f32 v10, v20, v21
  v_cmp_u_f32 vcc, v20, v21
  s_nop 0
  v_mov_b32_dpp v11, v10 quad_perm:[1,0,3,2] row_mask:0xf bank_mask:0xf
  v_perm_b32 v10, v11, v10, v4
  s_and_b64 vcc, vcc, s[16:17]
  s_cbranch_scc1 ow_redo
  buffer_store_dword v10, v3, s[8:11], s80 offen sc1
  buffer_store_dword v10, v3, s[8:11], s81 offen sc1
  buffer_store_dword v10, v3, s[8:11], s82 offen sc1
  buffer_store_dword v10, v3, s[8:11], s83 offen sc1
  s_barrier
  s_add_u32 s49, s52, 2
  s_cmp_ge_u32 s61, s49
  s_cbranch_scc1 wf_done_50
  s_mov_b32 s50, 0
wf_loop_51:
  buffer_load_dword v12, v9, s[8:11], 0 offen sc1
  s_add_u32 s50, s50, 1
  s_cmp_gt_u32 s50, 131072
  s_cbranch_scc1 L_fail
  s_waitcnt vmcnt(0)
  v_min_u32_dpp v12, v12, v12 row_ror:8 row_mask:0xf bank_mask:0xf
  s_nop 1
  v_min_u32_dpp v12, v12, v12 row_ror:4 row_mask:0xf bank_mask:0xf
  s_nop 1
  v_min_u32_dpp v12, v12, v12 row_ror:2 row_mask:0xf bank_mask:0xf
  s_nop 1
  v_min_u32_dpp v12, v12, v12 row_ror:1 row_mask:0xf bank_mask:0xf
  v_mov_b32 v13, v12
  s_nop 1
  v_permlane16_swap_b32 v13, v12
  v_min_u32 v12, v12, v13
  v_mov_b32 v13, v12
  s_nop 1
  v_permlane32_swap_b32 v13, v12
  v_min_u32 v12, v12, v13
  s_nop 0
  v_readfirstlane_b32 s61, v12
  s_nop 0
  s_cmp_ge_u32 s61, s49
  s_cbranch_scc1 wf_done_50
  s_sleep 2
  s_branch wf_loop_51
wf_done_50:
  s_add_u32 s46, s63, 0
  buffer_load_dwordx4 a[0:3], v1, s[8:11], s46 offen offset:0 sc1
  buffer_load_dwordx4 a[4:7], v1, s[8:11], s46 offen offset:1024 sc1
  buffer_load_dwordx4 a[8:11], v1, s[8:11], s46 offen offset:2048 sc1
  buffer_load_dwordx4 a[12:15], v1, s[8:11], s46 offen offset:3072 sc1
  s_add_u32 s46, s63, 4096
  buffer_load_dwordx4 a[16:19], v1, s[8:11], s46 offen offset:0 sc1
  buffer_load_dwordx4 a[20:23], v1, s[8:11], s46 offen offset:1024 sc1
  buffer_load_dwordx4 a[24:27], v1, s[8:11], s46 offen offset:2048 sc1
  buffer_load_dwordx4 a[28:31], v1, s[8:11], s46 offen offset:3072 sc1
  s_add_u32 s46, s63, 8192
  buffer_load_dwordx4 a[32:35], v1, s[8:11], s46 offen offset:0 sc1
  buffer_load_dwordx4 a[36:39], v1, s[8:11], s46 offen offset:1024 sc1
  buffer_load_dwordx4 a[40:43], v1, s[8:11], s46 offen offset:2048 sc1
  buffer_load_dwordx4 a[44:47], v1, s[8:11], s46 offen offset:3072 sc1
  s_add_u32 s46, s63, 12288
  buffer_load_dwordx4 a[48:51], v1, s[8:11], s46 offen offset:0 sc1
  buffer_load_dwordx4 a[52:55], v1, s[8:11], s46 offen offset:1024 sc1
  buffer_load_dwordx4 a[56:59], v1, s[8:11], s46 offen offset:2048 sc1
  buffer_load_dwordx4 a[60:63], v1, s[8:11], s46 offen offset:3072 sc1
  s_add_u32 s46, s63, 16384
  buffer_load_dwordx4 a[64:67], v1, s[8:11], s46 offen offset:0 sc1
  buffer_load_dwordx4 a[68:71], v1, s[8:11], s46 offen offset:1024 sc1
  buffer_load_dwordx4 a[72:75], v1, s[8:11], s46 offen offset:2048 sc1
  buffer_load_dwordx4 a[76:79], v1, s[8:11], s46 offen offset:3072 sc1
  s_add_u32 s46, s63, 20480
  buffer_load_dwordx4 a[80:83], v1, s[8:11], s46 offen offset:0 sc1
  buffer_load_dwordx4 a[84:87], v1, s[8:11], s46 offen offset:1024 sc1
  buffer_load_dwordx4 a[88:91], v1, s[8:11], s46 offen offset:2048 sc1
  buffer_load_dwordx4 a[92:95], v1, s[8:11], s46 offen offset:3072 sc1
  s_add_u32 s46, s63, 24576
  buffer_load_dwordx4 a[96:99], v1, s[8:11], s46 offen offset:0 sc1
  buffer_load_dwordx4 a[100:103], v1, s[8:11], s46 offen offset:1024 sc1
  buffer_load_dwordx4 a[104:107], v1, s[8:11], s46 offen offset:2048 sc1
  buffer_load_dwordx4 a[108:111], v1, s[8:11], s46 offen offset:3072 sc1
  s_add_u32 s46, s63, 28672
  buffer_load_dwordx4 a[112:115], v1, s[8:11], s46 offen offset:0 sc1
  buffer_load_dwordx4 a[116:119], v1, s[8:11], s46 offen offset:1024 sc1
  buffer_load_dwordx4 a[120:123], v1, s[8:11], s46 offen offset:2048 sc1
  buffer_load_dwordx4 a[124:127], v1, s[8:11], s46 offen offset:3072 sc1
  s_add_u32 s63, s63, 1310720
  v_mov_b32 v12, s52
  buffer_store_dword v12, v19, s[8:11], 0 offen sc1
  v_mov_b32 v11, -1
  s_lshl_b32 s47, s58, 18
  s_add_u32 s46, s47, 0
  buffer_store_dword v11, v3, s[8:11], s46 offen sc1
  s_add_u32 s46, s47, 65536
  buffer_store_dword v11, v3, s[8:11], s46 offen sc1
  s_add_u32 s46, s47, 131072
  buffer_store_dword v11, v3, s[8:11], s46 offen sc1
  s_add_u32 s46, s47, 196608
  buffer_store_dword v11, v3, s[8:11], s46 offen sc1
  v_mov_b32 v20, -1
  v_mov_b32 v21, -1
  v_mov_b32 v22, -1
  v_mov_b32 v23, -1
  s_add_u32 s46, s65, 4096
  buffer_store_dwordx4 v[20:23], v1, s[8:11], s72 offen offset:0 sc1
  buffer_store_dwordx4 v[20:23], v1, s[8:11], s72 offen offset:1024 sc1
  buffer_store_dwordx4 v[20:23], v1, s[8:11], s72 offen offset:2048 sc1
  buffer_store_dwordx4 v[20:23], v1, s[8:11], s72 offen offset:3072 sc1
  buffer_store_dwordx4 v[20:23], v1, s[8:11], s73 offen offset:0 sc1
  buffer_store_dwordx4 v[20:23], v1, s[8:11], s73 offen offset:1024 sc1
  buffer_store_dwordx4 v[20:23], v1, s[8:11], s73 offen offset:2048 sc1
  buffer_store_dwordx4 v[20:23], v1, s[8:11], s73 offen offset:3072 sc1
  buffer_store_dwordx4 v[24:27], v1, s[8:11], s65 offen offset:0 sc1
  buffer_store_dwordx4 v[28:31], v1, s[8:11], s65 offen offset:1024 sc1
  buffer_store_dwordx4 v[32:35], v1, s[8:11], s65 offen offset:2048 sc1
  buffer_store_dwordx4 v[36:39], v1, s[8:11], s65 offen offset:3072 sc1
  buffer_store_dwordx4 v[40:43], v1, s[8:11], s46 offen offset:0 sc1
  buffer_store_dwordx4 v[44:47], v1, s[8:11], s46 offen offset:1024 sc1
  buffer_store_dwordx4 v[48:51], v1, s[8:11], s46 offen offset:2048 sc1
  buffer_store_dwordx4 v[52:55], v1, s[8:11], s46 offen offset:3072 sc1
  s_add_u32 s65, s65, 327680
  s_mov_b32 s58, s66
  s_mov_b32 s52, s53
  s_cmp_lt_u32 s52, 63
  s_cbranch_scc1 ow_loop
  s_lshl_b32 s46, s62, 7
  s_add_u32 s46, s46, 2973696
  v_mov_b32 v9, s46
  s_mov_b32 s46, 64
  s_waitcnt vmcnt(0)
  v_mov_b32 v10, s46
  s_mov_b64 exec, 1
  buffer_store_dword v10, v9, s[8:11], 0 offen sc1
  s_mov_b64 exec, -1
  s_endpgm
ow_redo:
  s_mov_b32 s50, 0
ow_poll:
  buffer_load_dwordx4 v[24:27], v1, s[8:11], s72 offen offset:0 sc1
  buffer_load_dwordx4 v[28:31], v1, s[8:11], s72 offen offset:1024 sc1
  buffer_load_dwordx4 v[32:35], v1, s[8:11], s72 offen offset:2048 sc1
  buffer_load_dwordx4 v[36:39], v1, s[8:11], s72 offen offset:3072 sc1
  buffer_load_dwordx4 v[40:43], v1, s[8:11], s73 offen offset:0 sc1
  buffer_load_dwordx4 v[44:47], v1, s[8:11], s73 offen offset:1024 sc1
  buffer_load_dwordx4 v[48:51], v1, s[8:11], s73 offen offset:2048 sc1
  buffer_load_dwordx4 v[52:55], v1, s[8:11], s73 offen offset:3072 sc1
  buffer_load_dwordx2 v[56:57], v2, s[8:11], s78 offen offset:0 sc1
  buffer_load_dwordx2 v[58:59], v2, s[8:11], s78 offen offset:128 sc1
  buffer_load_dwordx2 v[60:61], v2, s[8:11], s78 offen offset:1024 sc1
  buffer_load_dwordx2 v[62:63], v2, s[8:11], s78 offen offset:1152 sc1
  buffer_load_dwordx2 v[64:65], v2, s[8:11], s78 offen offset:2048 sc1
  buffer_load_dwordx2 v[66:67], v2, s[8:11], s78 offen offset:2176 sc1
  buffer_load_dwordx2 v[68:69], v2, s[8:11], s78 offen offset:3072 sc1
  buffer_load_dwordx2 v[70:71], v2, s[8:11], s78 offen offset:3200 sc1
  buffer_load_dwordx4 v[72:75], v1, s[8:11], s74 offen offset:0 sc1
  buffer_load_dwordx4 v[76:79], v1, s[8:11], s74 offen offset:1024 sc1
  buffer_load_dwordx4 v[80:83], v1, s[8:11], s74 offen offset:2048 sc1
  buffer_load_dwordx4 v[84:87], v1, s[8:11], s74 offen offset:3072 sc1
  buffer_load_dwordx4 v[88:91], v1, s[8:11], s75 offen offset:0 sc1
  buffer_load_dwordx4 v[92:95], v1, s[8:11], s75 offen offset:1024 sc1
  buffer_load_dwordx4 v[96:99], v1, s[8:11], s75 offen offset:2048 sc1
  buffer_load_dwordx4 v[100:103], v1, s[8:11], s75 offen offset:3072 sc1
  buffer_load_dwordx4 v[104:107], v1, s[8:11], s76 offen offset:0 sc1
  buffer_load_dwordx4 v[108:111], v1, s[8:11], s76 offen offset:1024 sc1
  buffer_load_dwordx4 v[112:115], v1, s[8:11], s76 offen offset:2048 sc1
  buffer_load_dwordx4 v[116:119], v1, s[8:11], s76 offen offset:3072 sc1
  buffer_load_dwordx4 v[120:123], v1, s[8:11], s77 offen offset:0 sc1
  buffer_load_dwordx4 v[124:127], v1, s[8:11], s77 offen offset:1024 sc1
  buffer_load_dwordx4 v[128:131], v1, s[8:11], s77 offen offset:2048 sc1
  buffer_load_dwordx4 v[132:135], v1, s[8:11], s77 offen offset:3072 sc1
  s_add_u32 s71, s71, 1
  s_cmp_le_u32 s71, 2
  s_cbranch_scc1 ow_again
  s_add_u32 s50, s50, 1
  s_cmp_gt_u32 s50, 131072
  s_cbranch_scc1 L_fail
  s_waitcnt vmcnt(0)
  v_max_u32 v8, v24, v25
  v_max3_u32 v8, v26, v27, v8
  v_max3_u32 v8, v28, v29, v8
  v_max3_u32 v8, v30, v31, v8
  v_max3_u32 v8, v32, v33, v8
  v_max3_u32 v8, v34, v35, v8
  v_max3_u32 v8, v36, v37, v8
  v_max3_u32 v8, v38, v39, v8
  v_max3_u32 v8, v40, v41, v8
  v_max3_u32 v8, v42, v43, v8
  v_max3_u32 v8, v44, v45, v8
  v_max3_u32 v8, v46, v47, v8
  v_max3_u32 v8, v48, v49, v8
  v_max3_u32 v8, v50, v51, v8
  v_max3_u32 v8, v52, v53, v8
  v_max3_u32 v8, v54, v55, v8
  v_max3_u32 v8, v56, v57, v8
  v_max3_u32 v8, v58, v59, v8
  v_max3_u32 v8, v60, v61, v8
  v_max3_u32 v8, v62, v63, v8
  v_max3_u32 v8, v64, v65, v8
  v_max3_u32 v8, v66, v67, v8
  v_max3_u32 v8, v68, v69, v8
  v_max3_u32 v8, v70, v71, v8
  v_max3_u32 v8, v72, v73, v8
  v_max3_u32 v8, v74, v75, v8
  v_max3_u32 v8, v76, v77, v8
  v_max3_u32 v8, v78, v79, v8
  v_max3_u32 v8, v80, v81, v8
  v_max3_u32 v8, v82, v83, v8
  v_max3_u32 v8, v84, v85, v8
  v_max3_u32 v8, v86, v87, v8
  v_max3_u32 v8, v88, v89, v8
  v_max3_u32 v8, v90, v91, v8
  v_max3_u32 v8, v92, v93, v8
  v_max3_u32 v8, v94, v95, v8
  v_max3_u32 v8, v96, v97, v8
  v_max3_u32 v8, v98, v99, v8
  v_max3_u32 v8, v100, v101, v8
  v_max3_u32 v8, v102, v103, v8
  v_max3_u32 v8, v104, v105, v8
  v_max3_u32 v8, v106, v107, v8
  v_max3_u32 v8, v108, v109, v8
  v_max3_u32 v8, v110, v111, v8
  v_max3_u32 v8, v112, v113, v8
  v_max3_u32 v8, v114, v115, v8
  v_max3_u32 v8, v116, v117, v8
  v_max3_u32 v8, v118, v119, v8
  v_max3_u32 v8, v120, v121, v8
  v_max3_u32 v8, v122, v123, v8
  v_max3_u32 v8, v124, v125, v8
  v_max3_u32 v8, v126, v127, v8
  v_max3_u32 v8, v128, v129, v8
  v_max3_u32 v8, v130, v131, v8
  v_max3_u32 v8, v132, v133, v8
  v_max3_u32 v8, v134, v135, v8
  v_cmp_eq_u32 vcc, -1, v8
  s_cbranch_vccnz ow_poll
  s_mov_b64 s[16:17], 0
ow_again:
  v_mov_b32 v20, 0
  v_mov_b32 v21, 0
  v_mov_b32 v22, 0
  v_mov_b32 v23, 0
  s_branch ow_go
L_xowner:
  s_mov_b32 s12, s36
  s_mov_b32 s13, s37
  s_mov_b32 s14, 5242880
  s_mov_b32 s15, 0x20000
  v_and_b32 v12, 1, v0
  v_mul_u32_u24 v12, 1130496, v12
  v_add_u32 v12, 1966080, v12
  buffer_load_dword v10, v12, s[8:11], 0 offen sc1
  s_waitcnt vmcnt(0)
  v_readlane_b32 s54, v10, 0
  v_readlane_b32 s55, v10, 1
  s_and_b32 s54, s54, 0x2000
  s_and_b32 s55, s55, 0x2000
  s_mov_b32 s68, 0xfffffffe
  s_lshl_b32 s46, s43, 7
  s_add_u32 s46, s46, s55
  s_add_u32 s46, s46, 2887680
  v_mov_b32 v14, s46
  s_sub_u32 s48, s44, 26
  s_and_b32 s46, s48, 1
  s_mul_i32 s46, s46, 5
  s_mul_i32 s62, s43, 10
  s_add_u32 s62, s62, s46
  s_lshr_b32 s52, s48, 1
  v_lshlrev_b32 v1, 4, v0
  v_and_b32 v10, 7, v0
  v_lshlrev_b32 v10, 7, v10
  v_add_u32 v10, s51, v10
  v_bfe_u32 v11, v0, 3, 2
  v_lshl_add_u32 v2, v11, 2, v10
  v_add_u32 v3, 2965504, v2
  v_add_u32 v2, 2949120, v2
  v_bfe_u32 v11, v0, 3, 1
  v_lshl_add_u32 v4, v11, 2, v10
  v_add_u32 v4, 2981888, v4
  v_cmp_lt_u32 vcc, 31, v0
  s_nop 1
  v_cndmask_b32 v3, v3, v4, vcc
  v_and_b32 v11, 15, v0
  v_min_u32 v11, 4, v11
  v_add_u32 v11, s62, v11
  v_lshlrev_b32 v11, 7, v11
  v_add_u32 v11, 2973696, v11
  v_cmp_lt_u32 vcc, 47, v0
  s_nop 1
  v_cndmask_b32 v3, v3, v11, vcc
  s_mul_i32 s46, s42, 10240
  v_add_u32 v5, s46, v1
  v_add_u32 v6, s51, v1
  s_lshl_b32 s63, s62, 15
  s_lshl_b32 s46, s42, 13
  s_add_u32 s63, s63, s46
  s_mul_i32 s47, s52, 1310720
  s_add_u32 s63, s63, s47
  s_add_u32 s63, s63, 83886080
  s_mul_i32 s65, s52, 81920
  s_add_u32 s65, s65, 188743680
  s_lshl_b32 s64, s62, 13
  s_lshl_b32 s46, s42, 11
  s_add_u32 s64, s64, s46
  s_mul_i32 s47, s52, 327680
  s_add_u32 s64, s64, s47
  s_add_u32 s64, s64, 167772160
  s_mul_i32 s66, s52, 81920
  v_and_b32 v10, 15, v0
  v_mul_u32_u24 v10, 2560, v10
  v_lshrrev_b32 v11, 4, v0
  v_lshl_add_u32 v10, v11, 3, v10
  s_add_u32 s46, s42, 0
  s_cmp_ge_u32 s46, 5
  s_cselect_b32 s47, 40800, 0
  s_add_u32 s48, s46, s62
  s_lshl_b32 s48, s48, 5
  s_add_u32 s47, s47, s48
  s_add_u32 s47, s47, 1280
  s_cmp_ge_u32 s46, 10
  s_cselect_b32 s47, 2146435072, s47
  v_add_u32 v7, s47, v10
  s_add_u32 s46, s42, 4
  s_cmp_ge_u32 s46, 5
  s_cselect_b32 s47, 40800, 0
  s_add_u32 s48, s46, s62
  s_lshl_b32 s48, s48, 5
  s_add_u32 s47, s47, s48
  s_add_u32 s47, s47, 1280
  s_cmp_ge_u32 s46, 10
  s_cselect_b32 s47, 2146435072, s47
  v_add_u32 v8, s47, v10
  s_add_u32 s46, s42, 8
  s_cmp_ge_u32 s46, 5
  s_cselect_b32 s47, 40800, 0
  s_add_u32 s48, s46, s62
  s_lshl_b32 s48, s48, 5
  s_add_u32 s47, s47, s48
  s_add_u32 s47, s47, 1280
  s_cmp_ge_u32 s46, 10
  s_cselect_b32 s47, 2146435072, s47
  v_add_u32 v9, s47, v10
  s_mov_b32 s60, 0
  s_mov_b32 s61, 0
xo_loop:
  s_add_u32 s53, s52, 1
  s_cmp_ge_u32 s60, s53
  s_cbranch_scc1 wf_done_52
  s_mov_b32 s50, 0
wf_loop_53:
  buffer_load_dword v10, v2, s[8:11], 0 offen sc1
  s_add_u32 s50, s50, 1
  s_cmp_gt_u32 s50, 131072
  s_cbranch_scc1 L_fail
  s_waitcnt vmcnt(0)
  v_min_u32_dpp v10, v10, v10 row_ror:8 row_mask:0xf bank_mask:0xf
  s_nop 1
  v_min_u32_dpp v10, v10, v10 row_ror:4 row_mask:0xf bank_mask:0xf
  s_nop 1
  v_min_u32_dpp v10, v10, v10 row_ror:2 row_mask:0xf bank_mask:0xf
  s_nop 1
  v_min_u32_dpp v10, v10, v10 row_ror:1 row_mask:0xf bank_mask:0xf
  v_mov_b32 v11, v10
  s_nop 1
  v_permlane16_swap_b32 v11, v10
  v_min_u32 v10, v10, v11
  v_mov_b32 v11, v10
  s_nop 1
  v_permlane32_swap_b32 v11, v10
  v_min_u32 v10, v10, v11
  s_nop 0
  v_readfirstlane_b32 s60, v10
  s_nop 0
  s_cmp_ge_u32 s60, s53
  s_cbranch_scc1 wf_done_52
  s_sleep 2
  s_branch wf_loop_53
wf_done_52:
  s_add_u32 s46, s63, 0
  buffer_load_dwordx4 a[0:3], v1, s[8:11], s46 offen offset:0 sc1
  buffer_load_dwordx4 a[4:7], v1, s[8:11], s46 offen offset:1024 sc1
  buffer_load_dwordx4 a[8:11], v1, s[8:11], s46 offen offset:2048 sc1
  buffer_load_dwordx4 a[12:15], v1, s[8:11], s46 offen offset:3072 sc1
  s_add_u32 s46, s63, 4096
  buffer_load_dwordx4 a[16:19], v1, s[8:11], s46 offen offset:0 sc1
  buffer_load_dwordx4 a[20:23], v1, s[8:11], s46 offen offset:1024 sc1
  buffer_load_dwordx4 a[24:27], v1, s[8:11], s46 offen offset:2048 sc1
  buffer_load_dwordx4 a[28:31], v1, s[8:11], s46 offen offset:3072 sc1
  s_add_u32 s46, s63, 32768
  buffer_load_dwordx4 a[32:35], v1, s[8:11], s46 offen offset:0 sc1
  buffer_load_dwordx4 a[36:39], v1, s[8:11], s46 offen offset:1024 sc1
  buffer_load_dwordx4 a[40:43], v1, s[8:11], s46 offen offset:2048 sc1
  buffer_load_dwordx4 a[44:47], v1, s[8:11], s46 offen offset:3072 sc1
  s_add_u32 s46, s63, 36864
  buffer_load_dwordx4 a[48:51], v1, s[8:11], s46 offen offset:0 sc1
  buffer_load_dwordx4 a[52:55], v1, s[8:11], s46 offen offset:1024 sc1
  buffer_load_dwordx4 a[56:59], v1, s[8:11], s46 offen offset:2048 sc1
  buffer_load_dwordx4 a[60:63], v1, s[8:11], s46 offen offset:3072 sc1
  s_add_u32 s46, s63, 65536
  buffer_load_dwordx4 a[64:67], v1, s[8:11], s46 offen offset:0 sc1
  buffer_load_dwordx4 a[68:71], v1, s[8:11], s46 offen offset:1024 sc1
  buffer_load_dwordx4 a[72:75], v1, s[8:11], s46 offen offset:2048 sc1
  buffer_load_dwordx4 a[76:79], v1, s[8:11], s46 offen offset:3072 sc1
  s_add_u32 s46, s63, 69632
  buffer_load_dwordx4 a[80:83], v1, s[8:11], s46 offen offset:0 sc1
  buffer_load_dwordx4 a[84:87], v1, s[8:11], s46 offen offset:1024 sc1
  buffer_load_dwordx4 a[88:91], v1, s[8:11], s46 offen offset:2048 sc1
  buffer_load_dwordx4 a[92:95], v1, s[8:11], s46 offen offset:3072 sc1
  s_add_u32 s46, s63, 98304
  buffer_load_dwordx4 a[96:99], v1, s[8:11], s46 offen offset:0 sc1
  buffer_load_dwordx4 a[100:103], v1, s[8:11], s46 offen offset:1024 sc1
  buffer_load_dwordx4 a[104:107], v1, s[8:11], s46 offen offset:2048 sc1
  buffer_load_dwordx4 a[108:111], v1, s[8:11], s46 offen offset:3072 sc1
  s_add_u32 s46, s63, 102400
  buffer_load_dwordx4 a[112:115], v1, s[8:11], s46 offen offset:0 sc1
  buffer_load_dwordx4 a[116:119], v1, s[8:11], s46 offen offset:1024 sc1
  buffer_load_dwordx4 a[120:123], v1, s[8:11], s46 offen offset:2048 sc1
  buffer_load_dwordx4 a[124:127], v1, s[8:11], s46 offen offset:3072 sc1
  s_add_u32 s46, s63, 131072
  buffer_load_dwordx4 a[128:131], v1, s[8:11], s46 offen offset:0 sc1
  buffer_load_dwordx4 a[132:135], v1, s[8:11], s46 offen offset:1024 sc1
  buffer_load_dwordx4 a[136:139], v1, s[8:11], s46 offen offset:2048 sc1
  buffer_load_dwordx4 a[140:143], v1, s[8:11], s46 offen offset:3072 sc1
  s_add_u32 s46, s63, 135168
  buffer_load_dwordx4 a[144:147], v1, s[8:11], s46 offen offset:0 sc1
  buffer_load_dwordx4 a[148:151], v1, s[8:11], s46 offen offset:1024 sc1
  buffer_load_dwordx4 a[152:155], v1, s[8:11], s46 offen offset:2048 sc1
  buffer_load_dwordx4 a[156:159], v1, s[8:11], s46 offen offset:3072 sc1
  s_waitcnt vmcnt(24)
  s_add_u32 s53, s52, 2
  s_cmp_ge_u32 s52, 61
  s_cbranch_scc1 xo_last
  s_cmp_lg_u32 s42, 0
  s_cbranch_scc1 xo_go
  s_cmp_ge_u32 s61, s53
  s_cbranch_scc1 wf_done_54
  s_mov_b32 s50, 0
wf_loop_55:
  buffer_load_dword v10, v14, s[8:11], 0 offen sc1
  s_add_u32 s50, s50, 1
  s_cmp_gt_u32 s50, 131072
  s_cbranch_scc1 L_fail
  s_waitcnt vmcnt(0)
  v_readfirstlane_b32 s61, v10
  s_nop 0
  s_cmp_ge_u32 s61, s53
  s_cbranch_scc1 wf_done_54
  s_sleep 2
  s_branch wf_loop_55
wf_done_54:
  s_branch xo_go
xo_last:
  s_mov_b32 s53, 64
  s_mov_b32 s61, 0
  s_cmp_ge_u32 s61, s53
  s_cbranch_scc1 wf_done_56
  s_mov_b32 s50, 0
wf_loop_57:
  buffer_load_dword v10, v3, s[8:11], 0 offen sc1
  s_add_u32 s50, s50, 1
  s_cmp_gt_u32 s50, 131072
  s_cbranch_scc1 L_fail
  s_waitcnt vmcnt(0)
  v_min_u32_dpp v10, v10, v10 row_ror:8 row_mask:0xf bank_mask:0xf
  s_nop 1
  v_min_u32_dpp v10, v10, v10 row_ror:4 row_mask:0xf bank_mask:0xf
  s_nop 1
  v_min_u32_dpp v10, v10, v10 row_ror:2 row_mask:0xf bank_mask:0xf
  s_nop 1
  v_min_u32_dpp v10, v10, v10 row_ror:1 row_mask:0xf bank_mask:0xf
  v_mov_b32 v11, v10
  s_nop 1
  v_permlane16_swap_b32 v11, v10
  v_min_u32 v10, v10, v11
  v_mov_b32 v11, v10
  s_nop 1
  v_permlane32_swap_b32 v11, v10
  v_min_u32 v10, v10, v11
  s_nop 0
  v_readfirstlane_b32 s61, v10
  s_nop 0
  s_cmp_ge_u32 s61, s53
  s_cbranch_scc1 wf_done_56
  s_sleep 2
  s_branch wf_loop_57
wf_done_56:
xo_go:
  s_barrier
  s_lshl_b32 s47, s42, 13
  s_add_u32 s47, s47, s65
  s_lshl_b32 s48, s42, 11
  s_add_u32 s48, s48, s65
  s_add_u32 s46, s47, 0
  buffer_load_dwordx4 v[56:59], v1, s[8:11], s46 offen sc1
  s_add_u32 s46, s47, 40960
  buffer_load_dwordx4 v[60:63], v1, s[8:11], s46 offen sc1
  s_add_u32 s46, s47, 1024
  buffer_load_dwordx4 v[64:67], v1, s[8:11], s46 offen sc1
  s_add_u32 s46, s47, 41984
  buffer_load_dwordx4 v[68:71], v1, s[8:11], s46 offen sc1
  s_add_u32 s46, s47, 2048
  buffer_load_dwordx4 v[72:75], v1, s[8:11], s46 offen sc1
  s_add_u32 s46, s47, 43008
  buffer_load_dwordx4 v[76:79], v1, s[8:11], s46 offen sc1
  s_add_u32 s46, s47, 3072
  buffer_load_dwordx4 v[80:83], v1, s[8:11], s46 offen sc1
  s_add_u32 s46, s47, 44032
  buffer_load_dwordx4 v[84:87], v1, s[8:11], s46 offen sc1
  s_add_u32 s46, s47, 4096
  buffer_load_dwordx4 v[88:91], v1, s[8:11], s46 offen sc1
  s_add_u32 s46, s47, 45056
  buffer_load_dwordx4 v[92:95], v1, s[8:11], s46 offen sc1
  s_add_u32 s46, s47, 5120
  buffer_load_dwordx4 v[96:99], v1, s[8:11], s46 offen sc1
  s_add_u32 s46, s47, 46080
  buffer_load_dwordx4 v[100:103], v1, s[8:11], s46 offen sc1
  s_add_u32 s46, s47, 6144
  buffer_load_dwordx4 v[104:107], v1, s[8:11], s46 offen sc1
  s_add_u32 s46, s47, 47104
  buffer_load_dwordx4 v[108:111], v1, s[8:11], s46 offen sc1
  s_add_u32 s46, s47, 7168
  buffer_load_dwordx4 v[112:115], v1, s[8:11], s46 offen sc1
  s_add_u32 s46, s47, 48128
  buffer_load_dwordx4 v[116:119], v1, s[8:11], s46 offen sc1
  s_add_u32 s46, s48, 32768
  buffer_load_dwordx4 v[120:123], v1, s[8:11], s46 offen sc1
  s_add_u32 s46, s48, 73728
  buffer_load_dwordx4 v[124:127], v1, s[8:11], s46 offen sc1
  s_add_u32 s46, s48, 33792
  buffer_load_dwordx4 v[128:131], v1, s[8:11], s46 offen sc1
  s_add_u32 s46, s48, 74752
  buffer_load_dwordx4 v[132:135], v1, s[8:11], s46 offen sc1
  s_add_u32 s46, s64, 0
  buffer_load_dwordx4 v[16:19], v1, s[8:11], s46 offen offset:0 sc1
  buffer_load_dwordx4 v[20:23], v1, s[8:11], s46 offen offset:1024 sc1
  s_add_u32 s46, s64, 8192
  buffer_load_dwordx4 v[24:27], v1, s[8:11], s46 offen offset:0 sc1
  buffer_load_dwordx4 v[28:31], v1, s[8:11], s46 offen offset:1024 sc1
  s_add_u32 s46, s64, 16384
  buffer_load_dwordx4 v[32:35], v1, s[8:11], s46 offen offset:0 sc1
  buffer_load_dwordx4 v[36:39], v1, s[8:11], s46 offen offset:1024 sc1
  s_add_u32 s46, s64, 24576
  buffer_load_dwordx4 v[40:43], v1, s[8:11], s46 offen offset:0 sc1
  buffer_load_dwordx4 v[44:47], v1, s[8:11], s46 offen offset:1024 sc1
  s_add_u32 s46, s64, 32768
  buffer_load_dwordx4 v[48:51], v1, s[8:11], s46 offen offset:0 sc1
  buffer_load_dwordx4 v[52:55], v1, s[8:11], s46 offen offset:1024 sc1
  s_waitcnt vmcnt(29)
  v_mfma_f32_16x16x32_bf16 v[136:139], a[0:3], v[56:59], 0
  v_mfma_f32_16x16x32_bf16 v[140:143], a[32:35], v[56:59], 0
  v_mfma_f32_16x16x32_bf16 v[144:147], a[64:67], v[56:59], 0
  v_mfma_f32_16x16x32_bf16 v[148:151], a[96:99], v[56:59], 0
  v_mfma_f32_16x16x32_bf16 v[152:155], a[128:131], v[56:59], 0
  s_waitcnt vmcnt(28)
  v_mfma_f32_16x16x32_bf16 v[156:159], a[0:3], v[60:63], 0
  v_mfma_f32_16x16x32_bf16 v[160:163], a[32:35], v[60:63], 0
  v_mfma_f32_16x16x32_bf16 v[164:167], a[64:67], v[60:63], 0
  v_mfma_f32_16x16x32_bf16 v[168:171], a[96:99], v[60:63], 0
  v_mfma_f32_16x16x32_bf16 v[172:175], a[128:131], v[60:63], 0
  s_waitcnt vmcnt(27)
  v_mfma_f32_16x16x32_bf16 v[136:139], a[4:7], v[64:67], v[136:139]
  v_mfma_f32_16x16x32_bf16 v[140:143], a[36:39], v[64:67], v[140:143]
  v_mfma_f32_16x16x32_bf16 v[144:147], a[68:71], v[64:67], v[144:147]
  v_mfma_f32_16x16x32_bf16 v[148:151], a[100:103], v[64:67], v[148:151]
  v_mfma_f32_16x16x32_bf16 v[152:155], a[132:135], v[64:67], v[152:155]
  s_waitcnt vmcnt(26)
  v_mfma_f32_16x16x32_bf16 v[156:159], a[4:7], v[68:71], v[156:159]
  v_mfma_f32_16x16x32_bf16 v[160:163], a[36:39], v[68:71], v[160:163]
  v_mfma_f32_16x16x32_bf16 v[164:167], a[68:71], v[68:71], v[164:167]
  v_mfma_f32_16x16x32_bf16 v[168:171], a[100:103], v[68:71], v[168:171]
  v_mfma_f32_16x16x32_bf16 v[172:175], a[132:135], v[68:71], v[172:175]
  s_waitcnt vmcnt(25)
  v_mfma_f32_16x16x32_bf16 v[136:139], a[8:11], v[72:75], v[136:139]
  v_mfma_f32_16x16x32_bf16 v[140:143], a[40:43], v[72:75], v[140:143]
  v_mfma_f32_16x16x32_bf16 v[144:147], a[72:75], v[72:75], v[144:147]
  v_mfma_f32_16x16x32_bf16 v[148:151], a[104:107], v[72:75], v[148:151]
  v_mfma_f32_16x16x32_bf16 v[152:155], a[136:139], v[72:75], v[152:155]
  s_waitcnt vmcnt(24)
  v_mfma_f32_16x16x32_bf16 v[156:159], a[8:11], v[76:79], v[156:159]
  v_mfma_f32_16x16x32_bf16 v[160:163], a[40:43], v[76:79], v[160:163]
  v_mfma_f32_16x16x32_bf16 v[164:167], a[72:75], v[76:79], v[164:167]
  v_mfma_f32_16x16x32_bf16 v[168:171], a[104:107], v[76:79], v[168:171]
  v_mfma_f32_16x16x32_bf16 v[172:175], a[136:139], v[76:79], v[172:175]
  s_waitcnt vmcnt(23)
  v_mfma_f32_16x16x32_bf16 v[136:139], a[12:15], v[80:83], v[136:139]
  v_mfma_f32_16x16x32_bf16 v[140:143], a[44:47], v[80:83], v[140:143]
  v_mfma_f32_16x16x32_bf16 v[144:147], a[76:79], v[80:83], v[144:147]
  v_mfma_f32_16x16x32_bf16 v[148:151], a[108:111], v[80:83], v[148:151]
  v_mfma_f32_16x16x32_bf16 v[152:155], a[140:143], v[80:83], v[152:155]
  s_waitcnt vmcnt(22)
  v_mfma_f32_16x16x32_bf16 v[156:159], a[12:15], v[84:87], v[156:159]
  v_mfma_f32_16x16x32_bf16 v[160:163], a[44:47], v[84:87], v[160:163]
  v_mfma_f32_16x16x32_bf16 v[164:167], a[76:79], v[84:87], v[164:167]
  v_mfma_f32_16x16x32_bf16 v[168:171], a[108:111], v[84:87], v[168:171]
  v_mfma_f32_16x16x32_bf16 v[172:175], a[140:143], v[84:87], v[172:175]
  s_waitcnt vmcnt(21)
  v_mfma_f32_16x16x32_bf16 v[136:139], a[16:19], v[88:91], v[136:139]
  v_mfma_f32_16x16x32_bf16 v[140:143], a[48:51], v[88:91], v[140:143]
  v_mfma_f32_16x16x32_bf16 v[144:147], a[80:83], v[88:91], v[144:147]
  v_mfma_f32_16x16x32_bf16 v[148:151], a[112:115], v[88:91], v[148:151]
  v_mfma_f32_16x16x32_bf16 v[152:155], a[144:147], v[88:91], v[152:155]
  s_waitcnt vmcnt(20)
  v_mfma_f32_16x16x32_bf16 v[156:159], a[16:19], v[92:95], v[156:159]
  v_mfma_f32_16x16x32_bf16 v[160:163], a[48:51], v[92:95], v[160:163]
  v_mfma_f32_16x16x32_bf16 v[164:167], a[80:83], v[92:95], v[164:167]
  v_mfma_f32_16x16x32_bf16 v[168:171], a[112:115], v[92:95], v[168:171]
  v_mfma_f32_16x16x32_bf16 v[172:175], a[144:147], v[92:95], v[172:175]
  s_waitcnt vmcnt(19)
  v_mfma_f32_16x16x32_bf16 v[136:139], a[20:23], v[96:99], v[136:139]
  v_mfma_f32_16x16x32_bf16 v[140:143], a[52:55], v[96:99], v[140:143]
  v_mfma_f32_16x16x32_bf16 v[144:147], a[84:87], v[96:99], v[144:147]
  v_mfma_f32_16x16x32_bf16 v[148:151], a[116:119], v[96:99], v[148:151]
  v_mfma_f32_16x16x32_bf16 v[152:155], a[148:151], v[96:99], v[152:155]
  s_waitcnt vmcnt(18)
  v_mfma_f32_16x16x32_bf16 v[156:159], a[20:23], v[100:103], v[156:159]
  v_mfma_f32_16x16x32_bf16 v[160:163], a[52:55], v[100:103], v[160:163]
  v_mfma_f32_16x16x32_bf16 v[164:167], a[84:87], v[100:103], v[164:167]
  v_mfma_f32_16x16x32_bf16 v[168:171], a[116:119], v[100:103], v[168:171]
  v_mfma_f32_16x16x32_bf16 v[172:175], a[148:151], v[100:103], v[172:175]
  s_waitcnt vmcnt(17)
  v_mfma_f32_16x16x32_bf16 v[136:139], a[24:27], v[104:107], v[136:139]
  v_mfma_f32_16x16x32_bf16 v[140:143], a[56:59], v[104:107], v[140:143]
  v_mfma_f32_16x16x32_bf16 v[144:147], a[88:91], v[104:107], v[144:147]
  v_mfma_f32_16x16x32_bf16 v[148:151], a[120:123], v[104:107], v[148:151]
  v_mfma_f32_16x16x32_bf16 v[152:155], a[152:155], v[104:107], v[152:155]
  s_waitcnt vmcnt(16)
  v_mfma_f32_16x16x32_bf16 v[156:159], a[24:27], v[108:111], v[156:159]
  v_mfma_f32_16x16x32_bf16 v[160:163], a[56:59], v[108:111], v[160:163]
  v_mfma_f32_16x16x32_bf16 v[164:167], a[88:91], v[108:111], v[164:167]
  v_mfma_f32_16x16x32_bf16 v[168:171], a[120:123], v[108:111], v[168:171]
  v_mfma_f32_16x16x32_bf16 v[172:175], a[152:155], v[108:111], v[172:175]
  s_waitcnt vmcnt(15)
  v_mfma_f32_16x16x32_bf16 v[136:139], a[28:31], v[112:115], v[136:139]
  v_mfma_f32_16x16x32_bf16 v[140:143], a[60:63], v[112:115], v[140:143]
  v_mfma_f32_16x16x32_bf16 v[144:147], a[92:95], v[112:115], v[144:147]
  v_mfma_f32_16x16x32_bf16 v[148:151], a[124:127], v[112:115], v[148:151]
  v_mfma_f32_16x16x32_bf16 v[152:155], a[156:159], v[112:115], v[152:155]
  s_waitcnt vmcnt(14)
  v_mfma_f32_16x16x32_bf16 v[156:159], a[28:31], v[116:119], v[156:159]
  v_mfma_f32_16x16x32_bf16 v[160:163], a[60:63], v[116:119], v[160:163]
  v_mfma_f32_16x16x32_bf16 v[164:167], a[92:95], v[116:119], v[164:167]
  v_mfma_f32_16x16x32_bf16 v[168:171], a[124:127], v[116:119], v[168:171]
  v_mfma_f32_16x16x32_bf16 v[172:175], a[156:159], v[116:119], v[172:175]
  s_waitcnt vmcnt(8)
  v_mfma_f32_16x16x32_bf16 v[136:139], v[16:19], v[120:123], v[136:139]
  v_mfma_f32_16x16x32_bf16 v[156:159], v[16:19], v[124:127], v[156:159]
  v_mfma_f32_16x16x32_bf16 v[136:139], v[20:23], v[128:131], v[136:139]
  v_mfma_f32_16x16x32_bf16 v[156:159], v[20:23], v[132:135], v[156:159]
  s_waitcnt vmcnt(6)
  v_mfma_f32_16x16x32_bf16 v[140:143], v[24:27], v[120:123], v[140:143]
  v_mfma_f32_16x16x32_bf16 v[160:163], v[24:27], v[124:127], v[160:163]
  v_mfma_f32_16x16x32_bf16 v[140:143], v[28:31], v[128:131], v[140:143]
  v_mfma_f32_16x16x32_bf16 v[160:163], v[28:31], v[132:135], v[160:163]
  s_waitcnt vmcnt(4)
  v_mfma_f32_16x16x32_bf16 v[144:147], v[32:35], v[120:123], v[144:147]
  v_mfma_f32_16x16x32_bf16 v[164:167], v[32:35], v[124:127], v[164:167]
  v_mfma_f32_16x16x32_bf16 v[144:147], v[36:39], v[128:131], v[144:147]
  v_mfma_f32_16x16x32_bf16 v[164:167], v[36:39], v[132:135], v[164:167]
  s_waitcnt vmcnt(2)
  v_mfma_f32_16x16x32_bf16 v[148:151], v[40:43], v[120:123], v[148:151]
  v_mfma_f32_16x16x32_bf16 v[168:171], v[40:43], v[124:127], v[168:171]
  v_mfma_f32_16x16x32_bf16 v[148:151], v[44:47], v[128:131], v[148:151]
  v_mfma_f32_16x16x32_bf16 v[168:171], v[44:47], v[132:135], v[168:171]
  s_waitcnt vmcnt(0)
  v_mfma_f32_16x16x32_bf16 v[152:155], v[48:51], v[120:123], v[152:155]
  v_mfma_f32_16x16x32_bf16 v[172:175], v[48:51], v[124:127], v[172:175]
  v_mfma_f32_16x16x32_bf16 v[152:155], v[52:55], v[128:131], v[152:155]
  v_mfma_f32_16x16x32_bf16 v[172:175], v[52:55], v[132:135], v[172:175]
  ds_write_b128 v5, v[136:139] offset:0
  ds_write_b128 v5, v[140:143] offset:1024
  ds_write_b128 v5, v[144:147] offset:2048
  ds_write_b128 v5, v[148:151] offset:3072
  s_nop 2
  ds_write_b128 v5, v[152:155] offset:4096
  ds_write_b128 v5, v[156:159] offset:5120
  ds_write_b128 v5, v[160:163] offset:6144
  ds_write_b128 v5, v[164:167] offset:7168
  ds_write_b128 v5, v[168:171] offset:8192
  ds_write_b128 v5, v[172:175] offset:9216
  s_waitcnt lgkmcnt(0)
  s_barrier
  ds_read_b128 v[176:179], v6 offset:0
  ds_read_b128 v[180:183], v6 offset:10240
  ds_read_b128 v[184:187], v6 offset:20480
  ds_read_b128 v[188:191], v6 offset:30720
  ds_read_b128 v[192:195], v6 offset:4096
  ds_read_b128 v[196:199], v6 offset:14336
  ds_read_b128 v[200:203], v6 offset:24576
  ds_read_b128 v[204:207], v6 offset:34816
  ds_read_b128 v[208:211], v6 offset:8192
  ds_read_b128 v[212:215], v6 offset:18432
  ds_read_b128 v[216:219], v6 offset:28672
  ds_read_b128 v[220:223], v6 offset:38912
  s_waitcnt lgkmcnt(8)
  v_add_f32 v176, v176, v180
  v_add_f32 v184, v184, v188
  v_add_f32 v176, v176, v184
  v_add_f32 v177, v177, v181
  v_add_f32 v185, v185, v189
  v_add_f32 v177, v177, v185
  v_add_f32 v178, v178, v182
  v_add_f32 v186, v186, v190
  v_add_f32 v178, v178, v186
  v_add_f32 v179, v179, v183
  v_add_f32 v187, v187, v191
  v_add_f32 v179, v179, v187
  v_cvt_pk_bf16_f32 v176, v176, v177
  v_cvt_pk_bf16_f32 v177, v178, v179
  buffer_store_dwordx2 v[176:177], v7, s[12:15], s66 offen
  s_waitcnt lgkmcnt(4)
  v_add_f32 v192, v192, v196
  v_add_f32 v200, v200, v204
  v_add_f32 v192, v192, v200
  v_add_f32 v193, v193, v197
  v_add_f32 v201, v201, v205
  v_add_f32 v193, v193, v201
  v_add_f32 v194, v194, v198
  v_add_f32 v202, v202, v206
  v_add_f32 v194, v194, v202
  v_add_f32 v195, v195, v199
  v_add_f32 v203, v203, v207
  v_add_f32 v195, v195, v203
  v_cvt_pk_bf16_f32 v192, v192, v193
  v_cvt_pk_bf16_f32 v193, v194, v195
  buffer_store_dwordx2 v[192:193], v8, s[12:15], s66 offen
  s_waitcnt lgkmcnt(0)
  v_add_f32 v208, v208, v212
  v_add_f32 v216, v216, v220
  v_add_f32 v208, v208, v216
  v_add_f32 v209, v209, v213
  v_add_f32 v217, v217, v221
  v_add_f32 v209, v209, v217
  v_add_f32 v210, v210, v214
  v_add_f32 v218, v218, v222
  v_add_f32 v210, v210, v218
  v_add_f32 v211, v211, v215
  v_add_f32 v219, v219, v223
  v_add_f32 v211, v211, v219
  v_cvt_pk_bf16_f32 v208, v208, v209
  v_cvt_pk_bf16_f32 v209, v210, v211
  buffer_store_dwordx2 v[208:209], v9, s[12:15], s66 offen
  s_add_u32 s63, s63, 3932160
  s_add_u32 s64, s64, 983040
  s_add_u32 s65, s65, 245760
  s_add_u32 s66, s66, 245760
  s_add_u32 s52, s52, 3
  s_cmp_lt_u32 s52, 64
  s_cbranch_scc1 xo_loop
  s_endpgm
L_end:
  s_endpgm
L_fail:
  s_mov_b32 s4, s38
  s_mov_b32 s5, s39
  s_mov_b32 s6, 256
  s_mov_b32 s7, 0x20000
  s_lshl_b32 s46, s43, 8
  s_or_b32 s46, s46, s44
  s_or_b32 s46, s46, 0x10000
  v_mov_b32 v1, 32
  v_mov_b32 v2, s46
  s_mov_b64 exec, 1
  buffer_store_dword v2, v1, s[4:7], 0 offen sc1
  s_waitcnt vmcnt(0)
  s_endpgm
.section .rodata,"a"
.p2align 6
.amdhsa_kernel init_kernel
  .amdhsa_next_free_vgpr 32
  .amdhsa_next_free_sgpr 102
  .amdhsa_accum_offset 32
  .amdhsa_group_segment_fixed_size 0
  .amdhsa_kernarg_size 104
  .amdhsa_user_sgpr_count 2
  .amdhsa_user_sgpr_kernarg_segment_ptr 1
  .amdhsa_system_sgpr_workgroup_id_x 1
.end_amdhsa_kernel
.section .rodata,"a"
.p2align 6
.amdhsa_kernel concat_heads__sliding_local_dilated__memory_aug_recurrent_mem_tr__prompt_kernel
  .amdhsa_next_free_vgpr 512
  .amdhsa_next_free_sgpr 102
  .amdhsa_accum_offset 256
  .amdhsa_group_segment_fixed_size 0
  .amdhsa_kernarg_size 104
  .amdhsa_user_sgpr_count 2
  .amdhsa_user_sgpr_kernarg_segment_ptr 1
  .amdhsa_system_sgpr_workgroup_id_x 1
.end_amdhsa_kernel
```

```asm
; @launch grid=(256,1,1) block=(256,1,1) lds=163840
.amdgcn_target "amdgcn-amd-amdhsa--gfx950"
.text
.globl concat_heads__sliding_local_dilated__memory_aug_recurrent_mem_tr__prompt_kernel
.p2align 8
.type concat_heads__sliding_local_dilated__memory_aug_recurrent_mem_tr__prompt_kernel,@function
concat_heads__sliding_local_dilated__memory_aug_recurrent_mem_tr__prompt_kernel:
  s_cmp_ge_u32 s2, 256
  s_cbranch_scc1 L_end
  v_lshrrev_b32 v1, 6, v0
  v_and_b32 v0, 63, v0
  v_readfirstlane_b32 s42, v1
  s_getreg_b32 s46, hwreg(HW_REG_XCC_ID)
  s_lshr_b32 s44, s2, 3
  s_lshl_b32 s51, s42, 10
  s_mov_b32 s3, 0
L_reroll:
  s_load_dwordx16 s[16:31], s[0:1], 0
  s_load_dwordx8 s[32:39], s[0:1], 64
  s_load_dwordx2 s[40:41], s[0:1], 96
  s_and_b32 s43, s46, 7
  s_and_b32 s46, s44, 7
  s_lshl_b32 s46, s46, 2
  s_and_b32 s47, s43, 3
  s_add_u32 s45, s46, s47
  s_waitcnt lgkmcnt(0)
  s_add_u32 s8, s40, 0x1fffff
  s_addc_u32 s9, s41, 0
  s_and_b32 s8, s8, 0xffe00000
  s_mov_b32 s10, 266338304
  s_mov_b32 s11, 0x20000
  s_mov_b32 s4, s38
  s_mov_b32 s5, s39
  s_mov_b32 s6, 256
  s_mov_b32 s7, 0x20000
  s_mov_b32 s12, s22
  s_mov_b32 s13, s23
  s_mov_b32 s14, 2621440
  s_mov_b32 s15, 0x20000
  s_or_b32 s46, s2, s42
  s_cbranch_scc1 L_norot
  v_mov_b32 v1, 0
  s_or_b32 s46, s43, 8
  v_mov_b32 v2, s46
  buffer_store_dword v2, v1, s[4:7], 0 offen sc1
L_norot:
  s_cmp_lt_u32 s43, 4
  s_cbranch_scc1 L_recur
  s_cmp_ge_u32 s44, 24
  s_cbranch_scc1 L_uw
  s_lshr_b32 s48, s44, 3
  s_cmp_eq_u32 s48, 0
  s_cselect_b32 s4, s26, s28
  s_cselect_b32 s5, s27, s29
  s_cmp_eq_u32 s48, 2
  s_cselect_b32 s4, s30, s4
  s_cselect_b32 s5, s31, s5
  s_mov_b32 s6, 7864320
  s_mul_i32 s60, s45, 384
  s_mov_b32 s61, 0
  s_mov_b32 s62, 64
  s_cselect_b32 s63, 50331648, 0
  s_add_u32 s63, s63, 31457280
  s_cmp_lg_u32 s48, 1
  s_cselect_b32 s46, 0x2000, 0
  s_add_u32 s63, s63, s46
  s_mov_b32 s67, s45
  s_lshl_b32 s64, s48, 5
  s_add_u32 s64, s64, s45
  s_lshl_b32 s64, s64, 7
  s_add_u32 s64, s64, 1048576
  v_lshrrev_b32 v10, 3, v0
  v_lshrrev_b32 v11, 2, v10
  v_lshlrev_b32 v11, 3, v11
  v_and_b32 v1, 3, v10
  v_add_u32 v1, v1, v11
  s_and_b32 s46, s42, 1
  s_lshl_b32 s46, s46, 2
  s_lshr_b32 s47, s42, 1
  s_lshl_b32 s47, s47, 4
  s_add_u32 s46, s46, s47
  v_add_u32 v1, s46, v1
  v_mul_u32_u24 v1, 12288, v1
  v_lshrrev_b32 v10, 1, v10
  v_bfe_u32 v11, v0, 1, 2
  v_xor_b32 v10, v10, v11
  v_lshlrev_b32 v10, 5, v10
  v_and_b32 v11, 1, v0
  v_lshlrev_b32 v11, 4, v11
  v_add3_u32 v1, v1, v10, v11
  v_lshrrev_b32 v10, 5, v0
  v_lshlrev_b32 v2, 11, v10
  v_bfe_u32 v10, v0, 2, 3
  v_lshl_add_u32 v2, v10, 7, v2
  v_lshrrev_b32 v10, 1, v10
  v_xor_b32 v10, s42, v10
  v_lshl_add_u32 v2, v10, 5, v2
  v_and_b32 v10, 3, v0
  v_lshl_add_u32 v2, v10, 3, v2
  v_add_u32 v3, 0x10000, v2
  v_add_u32 v4, 0x20000, v2
  v_lshrrev_b32 v10, 3, v0
  s_lshl_b32 s46, s42, 3
  v_add_u32 v10, s46, v10
  v_mul_u32_u24 v5, 1280, v10
  v_bfe_u32 v10, v10, 1, 3
  v_and_b32 v11, 7, v0
  v_xor_b32 v10, v10, v11
  v_lshl_add_u32 v5, v10, 4, v5
  v_and_b32 v10, 15, v0
  v_lshlrev_b32 v6, 7, v10
  v_lshrrev_b32 v10, 1, v10
  v_lshrrev_b32 v11, 4, v0
  v_xor_b32 v10, v10, v11
  v_lshl_add_u32 v6, v10, 4, v6
  v_add_u32 v6, 122880, v6
  v_xor_b32 v7, 64, v6
  v_and_b32 v10, 15, v0
  v_lshlrev_b32 v8, 4, v10
  v_bfe_u32 v10, v0, 4, 1
  v_lshlrev_b32 v10, 11, v10
  v_lshrrev_b32 v11, 5, v0
  v_lshlrev_b32 v11, 8, v11
  v_add3_u32 v8, v8, v10, v11
  s_lshl_b32 s46, s42, 9
  v_add_u32 v8, s46, v8
  v_mov_b32 v9, s64
  v_mov_b32 v10, 2146435072
  s_cmp_eq_u32 s42, 0
  s_cselect_b64 vcc, 1, 0
  v_cndmask_b32 v9, v10, v9, vcc
  s_lshl_b32 s46, s43, 7
  s_add_u32 s46, s46, 1076736
  v_mov_b32 v14, s46
  s_mov_b32 s68, 0
  s_mov_b32 s52, s61
  s_mul_i32 s53, s52, 40960
  s_add_u32 s54, s51, 122880
  s_add_u32 m0, s54, 0
  s_nop 0
  buffer_load_dwordx4 v5, s[12:15], s53 offen offset:0 lds
  s_add_u32 m0, s54, 3968
  s_nop 0
  buffer_load_dwordx4 v5, s[12:15], s53 offen offset:128 lds
  s_add_u32 m0, s54, 7936
  s_nop 0
  buffer_load_dwordx4 v5, s[12:15], s53 offen offset:256 lds
  s_add_u32 m0, s54, 11904
  s_nop 0
  buffer_load_dwordx4 v5, s[12:15], s53 offen offset:384 lds
  s_add_u32 m0, s54, 15872
  s_nop 0
  buffer_load_dwordx4 v5, s[12:15], s53 offen offset:512 lds
  s_add_u32 m0, s54, 19840
  s_nop 0
  buffer_load_dwordx4 v5, s[12:15], s53 offen offset:640 lds
  s_add_u32 m0, s54, 23808
  s_nop 0
  buffer_load_dwordx4 v5, s[12:15], s53 offen offset:768 lds
  s_add_u32 m0, s54, 27776
  s_nop 0
  buffer_load_dwordx4 v5, s[12:15], s53 offen offset:896 lds
  s_add_u32 m0, s54, 31744
  s_nop 0
  buffer_load_dwordx4 v5, s[12:15], s53 offen offset:1024 lds
  s_add_u32 m0, s54, 35712
  s_nop 0
  buffer_load_dwordx4 v5, s[12:15], s53 offen offset:1152 lds
  s_add_u32 m0, s51, 0
  s_add_u32 s46, s60, 0
  buffer_load_dwordx4 v1, s[4:7], s46 offen lds
  s_add_u32 m0, s51, 4096
  s_add_u32 s46, s60, 128
  buffer_load_dwordx4 v1, s[4:7], s46 offen lds
  s_add_u32 m0, s51, 8192
  s_add_u32 s46, s60, 256
  buffer_load_dwordx4 v1, s[4:7], s46 offen lds
  s_add_u32 m0, s51, 12288
  s_add_u32 s46, s60, 393216
  buffer_load_dwordx4 v1, s[4:7], s46 offen lds
  s_add_u32 m0, s51, 16384
  s_add_u32 s46, s60, 393344
  buffer_load_dwordx4 v1, s[4:7], s46 offen lds
  s_add_u32 m0, s51, 20480
  s_add_u32 s46, s60, 393472
  buffer_load_dwordx4 v1, s[4:7], s46 offen lds
  s_add_u32 m0, s51, 24576
  s_add_u32 s46, s60, 786432
  buffer_load_dwordx4 v1, s[4:7], s46 offen lds
  s_add_u32 m0, s51, 28672
  s_add_u32 s46, s60, 786560
  buffer_load_dwordx4 v1, s[4:7], s46 offen lds
  s_add_u32 m0, s51, 32768
  s_add_u32 s46, s60, 786688
  buffer_load_dwordx4 v1, s[4:7], s46 offen lds
  s_add_u32 m0, s51, 36864
  s_add_u32 s46, s60, 1179648
  buffer_load_dwordx4 v1, s[4:7], s46 offen lds
  s_add_u32 m0, s51, 40960
  s_add_u32 s46, s60, 1179776
  buffer_load_dwordx4 v1, s[4:7], s46 offen lds
  s_add_u32 m0, s51, 45056
  s_add_u32 s46, s60, 1179904
  buffer_load_dwordx4 v1, s[4:7], s46 offen lds
  s_add_u32 m0, s51, 49152
  s_add_u32 s46, s60, 1572864
  buffer_load_dwordx4 v1, s[4:7], s46 offen lds
  s_add_u32 m0, s51, 53248
  s_add_u32 s46, s60, 1572992
  buffer_load_dwordx4 v1, s[4:7], s46 offen lds
  s_add_u32 m0, s51, 57344
  s_add_u32 s46, s60, 1573120
  buffer_load_dwordx4 v1, s[4:7], s46 offen lds
  s_add_u32 m0, s51, 61440
  s_add_u32 s46, s60, 1966080
  buffer_load_dwordx4 v1, s[4:7], s46 offen lds
  s_add_u32 m0, s51, 65536
  s_add_u32 s46, s60, 1966208
  buffer_load_dwordx4 v1, s[4:7], s46 offen lds
  s_add_u32 m0, s51, 69632
  s_add_u32 s46, s60, 1966336
  buffer_load_dwordx4 v1, s[4:7], s46 offen lds
  s_add_u32 m0, s51, 73728
  s_add_u32 s46, s60, 2359296
  buffer_load_dwordx4 v1, s[4:7], s46 offen lds
  s_add_u32 m0, s51, 77824
  s_add_u32 s46, s60, 2359424
  buffer_load_dwordx4 v1, s[4:7], s46 offen lds
  s_add_u32 m0, s51, 81920
  s_add_u32 s46, s60, 2359552
  buffer_load_dwordx4 v1, s[4:7], s46 offen lds
  s_add_u32 m0, s51, 86016
  s_add_u32 s46, s60, 2752512
  buffer_load_dwordx4 v1, s[4:7], s46 offen lds
  s_add_u32 m0, s51, 90112
  s_add_u32 s46, s60, 2752640
  buffer_load_dwordx4 v1, s[4:7], s46 offen lds
  s_add_u32 m0, s51, 94208
  s_add_u32 s46, s60, 2752768
  buffer_load_dwordx4 v1, s[4:7], s46 offen lds
  s_waitcnt vmcnt(18)
  s_barrier
  s_add_u32 m0, s51, 98304
  s_add_u32 s46, s60, 3145728
  buffer_load_dwordx4 v1, s[4:7], s46 offen lds
  s_add_u32 m0, s51, 102400
  s_add_u32 s46, s60, 3145856
  buffer_load_dwordx4 v1, s[4:7], s46 offen lds
  s_add_u32 m0, s51, 106496
  s_add_u32 s46, s60, 3145984
  buffer_load_dwordx4 v1, s[4:7], s46 offen lds
  s_add_u32 m0, s51, 110592
  s_add_u32 s46, s60, 3538944
  buffer_load_dwordx4 v1, s[4:7], s46 offen lds
  s_add_u32 m0, s51, 114688
  s_add_u32 s46, s60, 3539072
  buffer_load_dwordx4 v1, s[4:7], s46 offen lds
  s_add_u32 m0, s51, 118784
  s_add_u32 s46, s60, 3539200
  buffer_load_dwordx4 v1, s[4:7], s46 offen lds
  ds_read_b64_tr_b16 a[0:1], v2 offset:0
  ds_read_b64_tr_b16 a[2:3], v2 offset:1024
  ds_read_b64_tr_b16 a[4:5], v2 offset:4096
  ds_read_b64_tr_b16 a[6:7], v2 offset:5120
  ds_read_b64_tr_b16 a[8:9], v2 offset:8192
  ds_read_b64_tr_b16 a[10:11], v2 offset:9216
  ds_read_b64_tr_b16 a[12:13], v2 offset:12288
  ds_read_b64_tr_b16 a[14:15], v2 offset:13312
  ds_read_b64_tr_b16 a[16:17], v2 offset:16384
  ds_read_b64_tr_b16 a[18:19], v2 offset:17408
  ds_read_b64_tr_b16 a[20:21], v2 offset:20480
  ds_read_b64_tr_b16 a[22:23], v2 offset:21504
  s_waitcnt lgkmcnt(0)
  s_waitcnt vmcnt(18)
  s_barrier
  s_add_u32 m0, s51, 0
  s_add_u32 s46, s60, 3932160
  buffer_load_dwordx4 v1, s[4:7], s46 offen lds
  s_add_u32 m0, s51, 4096
  s_add_u32 s46, s60, 3932288
  buffer_load_dwordx4 v1, s[4:7], s46 offen lds
  s_add_u32 m0, s51, 8192
  s_add_u32 s46, s60, 3932416
  buffer_load_dwordx4 v1, s[4:7], s46 offen lds
  s_add_u32 m0, s51, 12288
  s_add_u32 s46, s60, 4325376
  buffer_load_dwordx4 v1, s[4:7], s46 offen lds
  s_add_u32 m0, s51, 16384
  s_add_u32 s46, s60, 4325504
  buffer_load_dwordx4 v1, s[4:7], s46 offen lds
  s_add_u32 m0, s51, 20480
  s_add_u32 s46, s60, 4325632
  buffer_load_dwordx4 v1, s[4:7], s46 offen lds
  ds_read_b64_tr_b16 a[24:25], v2 offset:24576
  ds_read_b64_tr_b16 a[26:27], v2 offset:25600
  ds_read_b64_tr_b16 a[28:29], v2 offset:28672
  ds_read_b64_tr_b16 a[30:31], v2 offset:29696
  ds_read_b64_tr_b16 a[32:33], v2 offset:32768
  ds_read_b64_tr_b16 a[34:35], v2 offset:33792
  ds_read_b64_tr_b16 a[36:37], v2 offset:36864
  ds_read_b64_tr_b16 a[38:39], v2 offset:37888
  ds_read_b64_tr_b16 a[40:41], v2 offset:40960
  ds_read_b64_tr_b16 a[42:43], v2 offset:41984
  ds_read_b64_tr_b16 a[44:45], v2 offset:45056
  ds_read_b64_tr_b16 a[46:47], v2 offset:46080
  s_waitcnt lgkmcnt(0)
  s_waitcnt vmcnt(18)
  s_barrier
  s_add_u32 m0, s51, 24576
  s_add_u32 s46, s60, 4718592
  buffer_load_dwordx4 v1, s[4:7], s46 offen lds
  s_add_u32 m0, s51, 28672
  s_add_u32 s46, s60, 4718720
  buffer_load_dwordx4 v1, s[4:7], s46 offen lds
  s_add_u32 m0, s51, 32768
  s_add_u32 s46, s60, 4718848
  buffer_load_dwordx4 v1, s[4:7], s46 offen lds
  s_add_u32 m0, s51, 36864
  s_add_u32 s46, s60, 5111808
  buffer_load_dwordx4 v1, s[4:7], s46 offen lds
  s_add_u32 m0, s51, 40960
  s_add_u32 s46, s60, 5111936
  buffer_load_dwordx4 v1, s[4:7], s46 offen lds
  s_add_u32 m0, s51, 45056
  s_add_u32 s46, s60, 5112064
  buffer_load_dwordx4 v1, s[4:7], s46 offen lds
  ds_read_b64_tr_b16 a[48:49], v2 offset:49152
  ds_read_b64_tr_b16 a[50:51], v2 offset:50176
  ds_read_b64_tr_b16 a[52:53], v2 offset:53248
  ds_read_b64_tr_b16 a[54:55], v2 offset:54272
  ds_read_b64_tr_b16 a[56:57], v2 offset:57344
  ds_read_b64_tr_b16 a[58:59], v2 offset:58368
  ds_read_b64_tr_b16 a[60:61], v2 offset:61440
  ds_read_b64_tr_b16 a[62:63], v2 offset:62464
  ds_read_b64_tr_b16 a[64:65], v3 offset:0
  ds_read_b64_tr_b16 a[66:67], v3 offset:1024
  ds_read_b64_tr_b16 a[68:69], v3 offset:4096
  ds_read_b64_tr_b16 a[70:71], v3 offset:5120
  s_waitcnt lgkmcnt(0)
  s_waitcnt vmcnt(18)
  s_barrier
  s_add_u32 m0, s51, 49152
  s_add_u32 s46, s60, 5505024
  buffer_load_dwordx4 v1, s[4:7], s46 offen lds
  s_add_u32 m0, s51, 53248
  s_add_u32 s46, s60, 5505152
  buffer_load_dwordx4 v1, s[4:7], s46 offen lds
  s_add_u32 m0, s51, 57344
  s_add_u32 s46, s60, 5505280
  buffer_load_dwordx4 v1, s[4:7], s46 offen lds
  s_add_u32 m0, s51, 61440
  s_add_u32 s46, s60, 5898240
  buffer_load_dwordx4 v1, s[4:7], s46 offen lds
  s_add_u32 m0, s51, 65536
  s_add_u32 s46, s60, 5898368
  buffer_load_dwordx4 v1, s[4:7], s46 offen lds
  s_add_u32 m0, s51, 69632
  s_add_u32 s46, s60, 5898496
  buffer_load_dwordx4 v1, s[4:7], s46 offen lds
  ds_read_b64_tr_b16 a[72:73], v3 offset:8192
  ds_read_b64_tr_b16 a[74:75], v3 offset:9216
  ds_read_b64_tr_b16 a[76:77], v3 offset:12288
  ds_read_b64_tr_b16 a[78:79], v3 offset:13312
  ds_read_b64_tr_b16 a[80:81], v3 offset:16384
  ds_read_b64_tr_b16 a[82:83], v3 offset:17408
  ds_read_b64_tr_b16 a[84:85], v3 offset:20480
  ds_read_b64_tr_b16 a[86:87], v3 offset:21504
  ds_read_b64_tr_b16 a[88:89], v3 offset:24576
  ds_read_b64_tr_b16 a[90:91], v3 offset:25600
  ds_read_b64_tr_b16 a[92:93], v3 offset:28672
  ds_read_b64_tr_b16 a[94:95], v3 offset:29696
  s_waitcnt lgkmcnt(0)
  s_waitcnt vmcnt(18)
  s_barrier
  s_add_u32 m0, s51, 73728
  s_add_u32 s46, s60, 6291456
  buffer_load_dwordx4 v1, s[4:7], s46 offen lds
  s_add_u32 m0, s51, 77824
  s_add_u32 s46, s60, 6291584
  buffer_load_dwordx4 v1, s[4:7], s46 offen lds
  s_add_u32 m0, s51, 81920
  s_add_u32 s46, s60, 6291712
  buffer_load_dwordx4 v1, s[4:7], s46 offen lds
  s_add_u32 m0, s51, 86016
  s_add_u32 s46, s60, 6684672
  buffer_load_dwordx4 v1, s[4:7], s46 offen lds
  s_add_u32 m0, s51, 90112
  s_add_u32 s46, s60, 6684800
  buffer_load_dwordx4 v1, s[4:7], s46 offen lds
  s_add_u32 m0, s51, 94208
  s_add_u32 s46, s60, 6684928
  buffer_load_dwordx4 v1, s[4:7], s46 offen lds
  ds_read_b64_tr_b16 a[96:97], v3 offset:32768
  ds_read_b64_tr_b16 a[98:99], v3 offset:33792
  ds_read_b64_tr_b16 a[100:101], v3 offset:36864
  ds_read_b64_tr_b16 a[102:103], v3 offset:37888
  ds_read_b64_tr_b16 a[104:105], v3 offset:40960
  ds_read_b64_tr_b16 a[106:107], v3 offset:41984
  ds_read_b64_tr_b16 a[108:109], v3 offset:45056
  ds_read_b64_tr_b16 a[110:111], v3 offset:46080
  ds_read_b64_tr_b16 a[112:113], v3 offset:49152
  ds_read_b64_tr_b16 a[114:115], v3 offset:50176
  ds_read_b64_tr_b16 a[116:117], v3 offset:53248
  ds_read_b64_tr_b16 a[118:119], v3 offset:54272
  s_waitcnt lgkmcnt(0)
  s_waitcnt vmcnt(18)
  s_barrier
  s_add_u32 m0, s51, 98304
  s_add_u32 s46, s60, 7077888
  buffer_load_dwordx4 v1, s[4:7], s46 offen lds
  s_add_u32 m0, s51, 102400
  s_add_u32 s46, s60, 7078016
  buffer_load_dwordx4 v1, s[4:7], s46 offen lds
  s_add_u32 m0, s51, 106496
  s_add_u32 s46, s60, 7078144
  buffer_load_dwordx4 v1, s[4:7], s46 offen lds
  s_add_u32 m0, s51, 110592
  s_add_u32 s46, s60, 7471104
  buffer_load_dwordx4 v1, s[4:7], s46 offen lds
  s_add_u32 m0, s51, 114688
  s_add_u32 s46, s60, 7471232
  buffer_load_dwordx4 v1, s[4:7], s46 offen lds
  s_add_u32 m0, s51, 118784
  s_add_u32 s46, s60, 7471360
  buffer_load_dwordx4 v1, s[4:7], s46 offen lds
  ds_read_b64_tr_b16 a[120:121], v2 offset:0
  ds_read_b64_tr_b16 a[122:123], v2 offset:1024
  ds_read_b64_tr_b16 a[124:125], v2 offset:4096
  ds_read_b64_tr_b16 a[126:127], v2 offset:5120
  ds_read_b64_tr_b16 a[128:129], v2 offset:8192
  ds_read_b64_tr_b16 a[130:131], v2 offset:9216
  ds_read_b64_tr_b16 a[132:133], v2 offset:12288
  ds_read_b64_tr_b16 a[134:135], v2 offset:13312
  ds_read_b64_tr_b16 a[136:137], v2 offset:16384
  ds_read_b64_tr_b16 a[138:139], v2 offset:17408
  ds_read_b64_tr_b16 a[140:141], v2 offset:20480
  ds_read_b64_tr_b16 a[142:143], v2 offset:21504
  s_waitcnt lgkmcnt(0)
  s_waitcnt vmcnt(18)
  s_barrier
  ds_read_b64_tr_b16 a[144:145], v2 offset:24576
  ds_read_b64_tr_b16 a[146:147], v2 offset:25600
  ds_read_b64_tr_b16 a[148:149], v2 offset:28672
  ds_read_b64_tr_b16 a[150:151], v2 offset:29696
  ds_read_b64_tr_b16 a[152:153], v2 offset:32768
  ds_read_b64_tr_b16 a[154:155], v2 offset:33792
  ds_read_b64_tr_b16 a[156:157], v2 offset:36864
  ds_read_b64_tr_b16 a[158:159], v2 offset:37888
  ds_read_b64_tr_b16 a[160:161], v2 offset:40960
  ds_read_b64_tr_b16 a[162:163], v2 offset:41984
  ds_read_b64_tr_b16 a[164:165], v2 offset:45056
  ds_read_b64_tr_b16 a[166:167], v2 offset:46080
  s_waitcnt lgkmcnt(0)
  s_waitcnt vmcnt(12)
  s_barrier
  ds_read_b64_tr_b16 a[168:169], v2 offset:49152
  ds_read_b64_tr_b16 a[170:171], v2 offset:50176
  ds_read_b64_tr_b16 a[172:173], v2 offset:53248
  ds_read_b64_tr_b16 a[174:175], v2 offset:54272
  ds_read_b64_tr_b16 a[176:177], v2 offset:57344
  ds_read_b64_tr_b16 a[178:179], v2 offset:58368
  ds_read_b64_tr_b16 a[180:181], v2 offset:61440
  ds_read_b64_tr_b16 a[182:183], v2 offset:62464
  ds_read_b64_tr_b16 a[184:185], v3 offset:0
  ds_read_b64_tr_b16 a[186:187], v3 offset:1024
  ds_read_b64_tr_b16 a[188:189], v3 offset:4096
  ds_read_b64_tr_b16 a[190:191], v3 offset:5120
  s_waitcnt lgkmcnt(0)
  s_waitcnt vmcnt(6)
  s_barrier
  ds_read_b64_tr_b16 a[192:193], v3 offset:8192
  ds_read_b64_tr_b16 a[194:195], v3 offset:9216
  ds_read_b64_tr_b16 a[196:197], v3 offset:12288
  ds_read_b64_tr_b16 a[198:199], v3 offset:13312
  ds_read_b64_tr_b16 a[200:201], v3 offset:16384
  ds_read_b64_tr_b16 a[202:203], v3 offset:17408
  ds_read_b64_tr_b16 a[204:205], v3 offset:20480
  ds_read_b64_tr_b16 a[206:207], v3 offset:21504
  ds_read_b64_tr_b16 a[208:209], v3 offset:24576
  ds_read_b64_tr_b16 a[210:211], v3 offset:25600
  ds_read_b64_tr_b16 a[212:213], v3 offset:28672
  ds_read_b64_tr_b16 a[214:215], v3 offset:29696
  s_waitcnt lgkmcnt(0)
  s_waitcnt vmcnt(0)
  s_barrier
  ds_read_b64_tr_b16 a[216:217], v3 offset:32768
  ds_read_b64_tr_b16 a[218:219], v3 offset:33792
  ds_read_b64_tr_b16 a[220:221], v3 offset:36864
  ds_read_b64_tr_b16 a[222:223], v3 offset:37888
  ds_read_b64_tr_b16 a[224:225], v3 offset:40960
  ds_read_b64_tr_b16 a[226:227], v3 offset:41984
  ds_read_b64_tr_b16 a[228:229], v3 offset:45056
  ds_read_b64_tr_b16 a[230:231], v3 offset:46080
  ds_read_b64_tr_b16 a[232:233], v3 offset:49152
  ds_read_b64_tr_b16 a[234:235], v3 offset:50176
  ds_read_b64_tr_b16 a[236:237], v3 offset:53248
  ds_read_b64_tr_b16 a[238:239], v3 offset:54272
  s_waitcnt lgkmcnt(0)
  s_barrier
  v_and_b32 v11, 3, v0
  v_lshlrev_b32 v11, 2, v11
  s_mov_b32 s50, 0
ss_1:
  global_load_dword v10, v11, s[38:39] sc1
  s_add_u32 s50, s50, 1
  s_cmp_gt_u32 s50, 131072
  s_cbranch_scc1 L_fail
  s_waitcnt vmcnt(0)
  v_readlane_b32 s46, v10, 0
  v_readlane_b32 s47, v10, 2
  s_cmp_lg_u32 s46, 0
  s_cselect_b32 s48, 7, 0
  s_add_u32 s46, s46, s2
  s_xor_b32 s49, s46, s43
  s_and_b32 s49, s49, s48
  s_cbranch_scc1 L_reroll
  s_cmp_lg_u32 s47, 0
  s_cbranch_scc1 ss_ok_2
  s_sleep 10
  s_branch ss_1
ss_ok_2:
  v_readlane_b32 s3, v10, 1
  s_nop 0
  s_and_b32 s3, s3, 0x2000
  s_mov_b32 s54, s51
  s_add_u32 s53, s53, 40960
  s_add_u32 m0, s54, 0
  s_nop 0
  buffer_load_dwordx4 v5, s[12:15], s53 offen offset:0 lds
  s_add_u32 m0, s54, 3968
  s_nop 0
  buffer_load_dwordx4 v5, s[12:15], s53 offen offset:128 lds
  s_add_u32 m0, s54, 7936
  s_nop 0
  buffer_load_dwordx4 v5, s[12:15], s53 offen offset:256 lds
  s_add_u32 m0, s54, 11904
  s_nop 0
  buffer_load_dwordx4 v5, s[12:15], s53 offen offset:384 lds
  s_add_u32 m0, s54, 15872
  s_nop 0
  buffer_load_dwordx4 v5, s[12:15], s53 offen offset:512 lds
  s_add_u32 m0, s54, 19840
  s_nop 0
  buffer_load_dwordx4 v5, s[12:15], s53 offen offset:640 lds
  s_add_u32 m0, s54, 23808
  s_nop 0
  buffer_load_dwordx4 v5, s[12:15], s53 offen offset:768 lds
  s_add_u32 m0, s54, 27776
  s_nop 0
  buffer_load_dwordx4 v5, s[12:15], s53 offen offset:896 lds
  s_add_u32 m0, s54, 31744
  s_nop 0
  buffer_load_dwordx4 v5, s[12:15], s53 offen offset:1024 lds
  s_add_u32 m0, s54, 35712
  s_nop 0
  buffer_load_dwordx4 v5, s[12:15], s53 offen offset:1152 lds
  s_mov_b32 s55, 2146435072
  s_mov_b32 s56, 2146435072
  s_mov_b32 s57, 2146435072
  s_xor_b32 s63, s63, s3
  s_mov_b32 s58, 122880
  ds_read_b128 v[16:19], v6 offset:0
  ds_read_b128 v[20:23], v7 offset:0
  ds_read_b128 v[24:27], v6 offset:4096
  ds_read_b128 v[28:31], v7 offset:4096
  s_waitcnt lgkmcnt(3)
pj_loop_3:
  v_mfma_f32_16x16x32_bf16 v[40:43], a[0:3], v[16:19], 0
  ds_read_b128 v[32:35], v6 offset:8192
  v_mfma_f32_16x16x32_bf16 v[48:51], a[4:7], v[16:19], 0
  v_mfma_f32_16x16x32_bf16 v[56:59], a[8:11], v[16:19], 0
  s_waitcnt lgkmcnt(3)
  v_cvt_pk_bf16_f32 v66, v44, v45
  v_mfma_f32_16x16x32_bf16 v[40:43], a[12:15], v[20:23], v[40:43]
  ds_read_b128 v[16:19], v7 offset:8192
  v_cvt_pk_bf16_f32 v67, v46, v47
  v_mfma_f32_16x16x32_bf16 v[48:51], a[16:19], v[20:23], v[48:51]
  v_cvt_pk_bf16_f32 v70, v52, v53
  v_mfma_f32_16x16x32_bf16 v[56:59], a[20:23], v[20:23], v[56:59]
  s_waitcnt lgkmcnt(3)
  v_cvt_pk_bf16_f32 v71, v54, v55
  v_mfma_f32_16x16x32_bf16 v[40:43], a[24:27], v[24:27], v[40:43]
  ds_read_b128 v[20:23], v6 offset:12288
  v_cvt_pk_bf16_f32 v74, v60, v61
  v_mfma_f32_16x16x32_bf16 v[48:51], a[28:31], v[24:27], v[48:51]
  v_cvt_pk_bf16_f32 v75, v62, v63
  v_mfma_f32_16x16x32_bf16 v[56:59], a[32:35], v[24:27], v[56:59]
  s_waitcnt lgkmcnt(3)
  v_mfma_f32_16x16x32_bf16 v[40:43], a[36:39], v[28:31], v[40:43]
  ds_read_b128 v[24:27], v7 offset:12288
  v_permlane16_swap_b32 v64, v66
  v_mfma_f32_16x16x32_bf16 v[48:51], a[40:43], v[28:31], v[48:51]
  v_permlane16_swap_b32 v65, v67
  v_mfma_f32_16x16x32_bf16 v[56:59], a[44:47], v[28:31], v[56:59]
  buffer_store_dwordx4 v[64:67], v8, s[8:11], s55 offen sc1
  s_waitcnt lgkmcnt(3)
  v_mfma_f32_16x16x32_bf16 v[40:43], a[48:51], v[32:35], v[40:43]
  ds_read_b128 v[28:31], v6 offset:16384
  v_permlane16_swap_b32 v68, v70
  v_mfma_f32_16x16x32_bf16 v[48:51], a[52:55], v[32:35], v[48:51]
  v_permlane16_swap_b32 v69, v71
  v_mfma_f32_16x16x32_bf16 v[56:59], a[56:59], v[32:35], v[56:59]
  buffer_store_dwordx4 v[68:71], v8, s[8:11], s56 offen sc1
  s_waitcnt lgkmcnt(3)
  v_mfma_f32_16x16x32_bf16 v[40:43], a[60:63], v[16:19], v[40:43]
  ds_read_b128 v[32:35], v7 offset:16384
  v_permlane16_swap_b32 v72, v74
  v_mfma_f32_16x16x32_bf16 v[48:51], a[64:67], v[16:19], v[48:51]
  v_permlane16_swap_b32 v73, v75
  v_mfma_f32_16x16x32_bf16 v[56:59], a[68:71], v[16:19], v[56:59]
  buffer_store_dwordx4 v[72:75], v8, s[8:11], s57 offen sc1
  s_waitcnt lgkmcnt(3)
  v_mfma_f32_16x16x32_bf16 v[40:43], a[72:75], v[20:23], v[40:43]
  ds_read_b128 v[16:19], v6 offset:20480
  v_mfma_f32_16x16x32_bf16 v[48:51], a[76:79], v[20:23], v[48:51]
  v_mfma_f32_16x16x32_bf16 v[56:59], a[80:83], v[20:23], v[56:59]
  s_waitcnt lgkmcnt(3)
  v_mfma_f32_16x16x32_bf16 v[40:43], a[84:87], v[24:27], v[40:43]
  ds_read_b128 v[20:23], v7 offset:20480
  v_mfma_f32_16x16x32_bf16 v[48:51], a[88:91], v[24:27], v[48:51]
  v_mov_b32 v10, s52
  v_mfma_f32_16x16x32_bf16 v[56:59], a[92:95], v[24:27], v[56:59]
  s_waitcnt lgkmcnt(3)
  v_mfma_f32_16x16x32_bf16 v[40:43], a[96:99], v[28:31], v[40:43]
  ds_read_b128 v[24:27], v6 offset:24576
  v_mfma_f32_16x16x32_bf16 v[48:51], a[100:103], v[28:31], v[48:51]
  s_add_u32 s53, s53, 40960
  s_add_u32 s54, s54, 40960
  v_mfma_f32_16x16x32_bf16 v[56:59], a[104:107], v[28:31], v[56:59]
  s_waitcnt lgkmcnt(3)
  v_mfma_f32_16x16x32_bf16 v[40:43], a[108:111], v[32:35], v[40:43]
  ds_read_b128 v[28:31], v7 offset:24576
  v_mfma_f32_16x16x32_bf16 v[48:51], a[112:115], v[32:35], v[48:51]
  s_cmp_ge_u32 s54, 163840
  s_cselect_b32 s54, s51, s54
  v_mfma_f32_16x16x32_bf16 v[56:59], a[116:119], v[32:35], v[56:59]
  s_waitcnt lgkmcnt(3)
  v_mfma_f32_16x16x32_bf16 v[40:43], a[120:123], v[16:19], v[40:43]
  ds_read_b128 v[32:35], v6 offset:28672
  v_mfma_f32_16x16x32_bf16 v[48:51], a[124:127], v[16:19], v[48:51]
  s_cmp_eq_u32 s58, 122880
  s_cselect_b32 s59, 163840, 0
  v_mfma_f32_16x16x32_bf16 v[56:59], a[128:131], v[16:19], v[56:59]
  s_waitcnt lgkmcnt(3)
  v_mfma_f32_16x16x32_bf16 v[40:43], a[132:135], v[20:23], v[40:43]
  ds_read_b128 v[16:19], v7 offset:28672
  v_mfma_f32_16x16x32_bf16 v[48:51], a[136:139], v[20:23], v[48:51]
  s_sub_u32 s59, 40960, s59
  s_add_u32 s58, s58, s59
  v_mfma_f32_16x16x32_bf16 v[56:59], a[140:143], v[20:23], v[56:59]
  s_waitcnt lgkmcnt(3)
  v_mfma_f32_16x16x32_bf16 v[40:43], a[144:147], v[24:27], v[40:43]
  ds_read_b128 v[20:23], v6 offset:32768
  v_mfma_f32_16x16x32_bf16 v[48:51], a[148:151], v[24:27], v[48:51]
  s_lshr_b32 s55, s67, 1
  v_mfma_f32_16x16x32_bf16 v[56:59], a[152:155], v[24:27], v[56:59]
  s_lshl_b32 s55, s55, 14
  s_waitcnt lgkmcnt(3)
  v_mfma_f32_16x16x32_bf16 v[40:43], a[156:159], v[28:31], v[40:43]
  ds_read_b128 v[24:27], v7 offset:32768
  v_mfma_f32_16x16x32_bf16 v[48:51], a[160:163], v[28:31], v[48:51]
  s_and_b32 s56, s67, 1
  v_mfma_f32_16x16x32_bf16 v[56:59], a[164:167], v[28:31], v[56:59]
  s_lshl_b32 s56, s56, 12
  s_waitcnt lgkmcnt(3)
  v_mfma_f32_16x16x32_bf16 v[40:43], a[168:171], v[32:35], v[40:43]
  ds_read_b128 v[28:31], v6 offset:36864
  v_mfma_f32_16x16x32_bf16 v[48:51], a[172:175], v[32:35], v[48:51]
  s_add_u32 s55, s55, s56
  v_mfma_f32_16x16x32_bf16 v[56:59], a[176:179], v[32:35], v[56:59]
  s_add_u32 s55, s55, s63
  s_waitcnt lgkmcnt(3)
  v_mfma_f32_16x16x32_bf16 v[40:43], a[180:183], v[16:19], v[40:43]
  ds_read_b128 v[32:35], v7 offset:36864
  v_mfma_f32_16x16x32_bf16 v[48:51], a[184:187], v[16:19], v[48:51]
  s_lshr_b32 s56, s55, 8
  v_mfma_f32_16x16x32_bf16 v[56:59], a[188:191], v[16:19], v[56:59]
  s_and_b32 s56, s56, 0x2000
  s_waitcnt lgkmcnt(3)
  v_mfma_f32_16x16x32_bf16 v[40:43], a[192:195], v[20:23], v[40:43]
  ds_read_b128 v[16:19], v6 offset:2048
  v_mfma_f32_16x16x32_bf16 v[48:51], a[196:199], v[20:23], v[48:51]
  s_xor_b32 s55, s55, s56
  v_mfma_f32_16x16x32_bf16 v[56:59], a[200:203], v[20:23], v[56:59]
  s_add_u32 s67, s67, 32
  s_waitcnt lgkmcnt(3)
  v_mfma_f32_16x16x32_bf16 v[40:43], a[204:207], v[24:27], v[40:43]
  ds_read_b128 v[20:23], v7 offset:2048
  v_mfma_f32_16x16x32_bf16 v[48:51], a[208:211], v[24:27], v[48:51]
  s_cmp_ge_u32 s67, 1024
  s_cselect_b32 s56, 1024, 0
  v_mfma_f32_16x16x32_bf16 v[56:59], a[212:215], v[24:27], v[56:59]
  s_sub_u32 s67, s67, s56
  s_waitcnt lgkmcnt(3)
  v_mfma_f32_16x16x32_bf16 v[40:43], a[216:219], v[28:31], v[40:43]
  ds_read_b128 v[24:27], v6 offset:6144
  v_mfma_f32_16x16x32_bf16 v[48:51], a[220:223], v[28:31], v[48:51]
  s_add_u32 s56, s55, 16777216
  v_mfma_f32_16x16x32_bf16 v[56:59], a[224:227], v[28:31], v[56:59]
  s_add_u32 s57, s55, 33554432
  s_waitcnt lgkmcnt(3)
  v_mfma_f32_16x16x32_bf16 v[40:43], a[228:231], v[32:35], v[40:43]
  ds_read_b128 v[28:31], v7 offset:6144
  v_mfma_f32_16x16x32_bf16 v[48:51], a[232:235], v[32:35], v[48:51]
  v_mfma_f32_16x16x32_bf16 v[56:59], a[236:239], v[32:35], v[56:59]
  s_waitcnt lgkmcnt(3)
  v_mfma_f32_16x16x32_bf16 v[44:47], a[0:3], v[16:19], 0
  ds_read_b128 v[32:35], v6 offset:10240
  v_mfma_f32_16x16x32_bf16 v[52:55], a[4:7], v[16:19], 0
  v_mfma_f32_16x16x32_bf16 v[60:63], a[8:11], v[16:19], 0
  s_waitcnt lgkmcnt(3)
  v_cvt_pk_bf16_f32 v64, v40, v41
  v_mfma_f32_16x16x32_bf16 v[44:47], a[12:15], v[20:23], v[44:47]
  ds_read_b128 v[16:19], v7 offset:10240
  v_cvt_pk_bf16_f32 v65, v42, v43
  v_mfma_f32_16x16x32_bf16 v[52:55], a[16:19], v[20:23], v[52:55]
  v_cvt_pk_bf16_f32 v68, v48, v49
  v_mfma_f32_16x16x32_bf16 v[60:63], a[20:23], v[20:23], v[60:63]
  s_waitcnt lgkmcnt(3)
  v_cvt_pk_bf16_f32 v69, v50, v51
  v_mfma_f32_16x16x32_bf16 v[44:47], a[24:27], v[24:27], v[44:47]
  ds_read_b128 v[20:23], v6 offset:14336
  v_cvt_pk_bf16_f32 v72, v56, v57
  v_mfma_f32_16x16x32_bf16 v[52:55], a[28:31], v[24:27], v[52:55]
  v_cvt_pk_bf16_f32 v73, v58, v59
  v_mfma_f32_16x16x32_bf16 v[60:63], a[32:35], v[24:27], v[60:63]
  s_waitcnt lgkmcnt(3)
  v_mfma_f32_16x16x32_bf16 v[44:47], a[36:39], v[28:31], v[44:47]
  ds_read_b128 v[24:27], v7 offset:14336
  v_mfma_f32_16x16x32_bf16 v[52:55], a[40:43], v[28:31], v[52:55]
  s_waitcnt vmcnt(0)
  s_barrier
  v_mfma_f32_16x16x32_bf16 v[60:63], a[44:47], v[28:31], v[60:63]
  buffer_store_dword v10, v9, s[8:11], 0 offen sc1
  s_waitcnt lgkmcnt(3)
  v_mfma_f32_16x16x32_bf16 v[44:47], a[48:51], v[32:35], v[44:47]
  ds_read_b128 v[28:31], v6 offset:18432
  s_add_u32 m0, s54, 0
  v_mfma_f32_16x16x32_bf16 v[52:55], a[52:55], v[32:35], v[52:55]
  buffer_load_dwordx4 v5, s[12:15], s53 offen offset:0 lds
  v_mfma_f32_16x16x32_bf16 v[60:63], a[56:59], v[32:35], v[60:63]
  s_waitcnt lgkmcnt(3)
  v_mfma_f32_16x16x32_bf16 v[44:47], a[60:63], v[16:19], v[44:47]
  ds_read_b128 v[32:35], v7 offset:18432
  s_add_u32 m0, s54, 3968
  v_mfma_f32_16x16x32_bf16 v[52:55], a[64:67], v[16:19], v[52:55]
  buffer_load_dwordx4 v5, s[12:15], s53 offen offset:128 lds
  v_mfma_f32_16x16x32_bf16 v[60:63], a[68:71], v[16:19], v[60:63]
  s_waitcnt lgkmcnt(3)
  v_mfma_f32_16x16x32_bf16 v[44:47], a[72:75], v[20:23], v[44:47]
  ds_read_b128 v[16:19], v6 offset:22528
  s_add_u32 m0, s54, 7936
  v_mfma_f32_16x16x32_bf16 v[52:55], a[76:79], v[20:23], v[52:55]
  buffer_load_dwordx4 v5, s[12:15], s53 offen offset:256 lds
  v_mfma_f32_16x16x32_bf16 v[60:63], a[80:83], v[20:23], v[60:63]
  s_waitcnt lgkmcnt(3)
  v_mfma_f32_16x16x32_bf16 v[44:47], a[84:87], v[24:27], v[44:47]
  ds_read_b128 v[20:23], v7 offset:22528
  s_add_u32 m0, s54, 11904
  v_mfma_f32_16x16x32_bf16 v[52:55], a[88:91], v[24:27], v[52:55]
  buffer_load_dwordx4 v5, s[12:15], s53 offen offset:384 lds
  v_mfma_f32_16x16x32_bf16 v[60:63], a[92:95], v[24:27], v[60:63]
  s_waitcnt lgkmcnt(3)
  v_mfma_f32_16x16x32_bf16 v[44:47], a[96:99], v[28:31], v[44:47]
  ds_read_b128 v[24:27], v6 offset:26624
  s_add_u32 m0, s54, 15872
  v_mfma_f32_16x16x32_bf16 v[52:55], a[100:103], v[28:31], v[52:55]
  buffer_load_dwordx4 v5, s[12:15], s53 offen offset:512 lds
  v_mfma_f32_16x16x32_bf16 v[60:63], a[104:107], v[28:31], v[60:63]
  s_waitcnt lgkmcnt(3)
  v_mfma_f32_16x16x32_bf16 v[44:47], a[108:111], v[32:35], v[44:47]
  ds_read_b128 v[28:31], v7 offset:26624
  s_add_u32 m0, s54, 19840
  v_mfma_f32_16x16x32_bf16 v[52:55], a[112:115], v[32:35], v[52:55]
  buffer_load_dwordx4 v5, s[12:15], s53 offen offset:640 lds
  v_mfma_f32_16x16x32_bf16 v[60:63], a[116:119], v[32:35], v[60:63]
  s_waitcnt lgkmcnt(3)
  v_mfma_f32_16x16x32_bf16 v[44:47], a[120:123], v[16:19], v[44:47]
  ds_read_b128 v[32:35], v6 offset:30720
  s_add_u32 m0, s54, 23808
  v_mfma_f32_16x16x32_bf16 v[52:55], a[124:127], v[16:19], v[52:55]
  buffer_load_dwordx4 v5, s[12:15], s53 offen offset:768 lds
  v_mfma_f32_16x16x32_bf16 v[60:63], a[128:131], v[16:19], v[60:63]
  s_waitcnt lgkmcnt(3)
  v_mfma_f32_16x16x32_bf16 v[44:47], a[132:135], v[20:23], v[44:47]
  ds_read_b128 v[16:19], v7 offset:30720
  s_add_u32 m0, s54, 27776
  v_mfma_f32_16x16x32_bf16 v[52:55], a[136:139], v[20:23], v[52:55]
  buffer_load_dwordx4 v5, s[12:15], s53 offen offset:896 lds
  v_mfma_f32_16x16x32_bf16 v[60:63], a[140:143], v[20:23], v[60:63]
  s_waitcnt lgkmcnt(3)
  v_mfma_f32_16x16x32_bf16 v[44:47], a[144:147], v[24:27], v[44:47]
  ds_read_b128 v[20:23], v6 offset:34816
  s_add_u32 m0, s54, 31744
  v_mfma_f32_16x16x32_bf16 v[52:55], a[148:151], v[24:27], v[52:55]
  buffer_load_dwordx4 v5, s[12:15], s53 offen offset:1024 lds
  v_mfma_f32_16x16x32_bf16 v[60:63], a[152:155], v[24:27], v[60:63]
  s_waitcnt lgkmcnt(3)
  v_mfma_f32_16x16x32_bf16 v[44:47], a[156:159], v[28:31], v[44:47]
  ds_read_b128 v[24:27], v7 offset:34816
  s_add_u32 m0, s54, 35712
  v_mfma_f32_16x16x32_bf16 v[52:55], a[160:163], v[28:31], v[52:55]
  buffer_load_dwordx4 v5, s[12:15], s53 offen offset:1152 lds
  v_mfma_f32_16x16x32_bf16 v[60:63], a[164:167], v[28:31], v[60:63]
  s_waitcnt lgkmcnt(3)
  v_mfma_f32_16x16x32_bf16 v[44:47], a[168:171], v[32:35], v[44:47]
  ds_read_b128 v[28:31], v6 offset:38912
  v_mfma_f32_16x16x32_bf16 v[52:55], a[172:175], v[32:35], v[52:55]
  s_max_u32 s69, s52, 24
  s_sub_u32 s69, s69, 24
  v_mfma_f32_16x16x32_bf16 v[60:63], a[176:179], v[32:35], v[60:63]
  s_waitcnt lgkmcnt(3)
  v_mfma_f32_16x16x32_bf16 v[44:47], a[180:183], v[16:19], v[44:47]
  ds_read_b128 v[32:35], v7 offset:38912
  v_mfma_f32_16x16x32_bf16 v[52:55], a[184:187], v[16:19], v[52:55]
  v_add_u32 v6, s59, v6
  v_add_u32 v7, s59, v7
  v_mfma_f32_16x16x32_bf16 v[60:63], a[188:191], v[16:19], v[60:63]
  s_waitcnt lgkmcnt(3)
  v_mfma_f32_16x16x32_bf16 v[44:47], a[192:195], v[20:23], v[44:47]
  ds_read_b128 v[16:19], v6 offset:0
  v_mfma_f32_16x16x32_bf16 v[52:55], a[196:199], v[20:23], v[52:55]
  s_cmp_lt_u32 s68, s69
  s_cbranch_scc1 pj_slow
pj_back:
  v_mfma_f32_16x16x32_bf16 v[60:63], a[200:203], v[20:23], v[60:63]
  s_waitcnt lgkmcnt(3)
  v_mfma_f32_16x16x32_bf16 v[44:47], a[204:207], v[24:27], v[44:47]
  ds_read_b128 v[20:23], v7 offset:0
  v_mfma_f32_16x16x32_bf16 v[52:55], a[208:211], v[24:27], v[52:55]
  s_add_u32 s52, s52, 1
  v_mfma_f32_16x16x32_bf16 v[60:63], a[212:215], v[24:27], v[60:63]
  s_waitcnt lgkmcnt(3)
  v_mfma_f32_16x16x32_bf16 v[44:47], a[216:219], v[28:31], v[44:47]
  ds_read_b128 v[24:27], v6 offset:4096
  v_mfma_f32_16x16x32_bf16 v[52:55], a[220:223], v[28:31], v[52:55]
  v_mfma_f32_16x16x32_bf16 v[60:63], a[224:227], v[28:31], v[60:63]
  s_waitcnt lgkmcnt(3)
  v_mfma_f32_16x16x32_bf16 v[44:47], a[228:231], v[32:35], v[44:47]
  ds_read_b128 v[28:31], v7 offset:4096
  v_mfma_f32_16x16x32_bf16 v[52:55], a[232:235], v[32:35], v[52:55]
  s_cmp_lt_u32 s52, s62
  v_mfma_f32_16x16x32_bf16 v[60:63], a[236:239], v[32:35], v[60:63]
  s_waitcnt lgkmcnt(3)
  s_cbranch_scc1 pj_loop_3
  v_cvt_pk_bf16_f32 v66, v44, v45
  v_cvt_pk_bf16_f32 v67, v46, v47
  s_nop 1
  v_cvt_pk_bf16_f32 v70, v52, v53
  v_cvt_pk_bf16_f32 v71, v54, v55
  v_cvt_pk_bf16_f32 v74, v60, v61
  v_cvt_pk_bf16_f32 v75, v62, v63
  v_permlane16_swap_b32 v64, v66
  v_permlane16_swap_b32 v65, v67
  v_permlane16_swap_b32 v68, v70
  v_permlane16_swap_b32 v69, v71
  v_permlane16_swap_b32 v72, v74
  v_permlane16_swap_b32 v73, v75
  buffer_store_dwordx4 v[64:67], v8, s[8:11], s55 offen sc1
  buffer_store_dwordx4 v[68:71], v8, s[8:11], s56 offen sc1
  buffer_store_dwordx4 v[72:75], v8, s[8:11], s57 offen sc1
  v_mov_b32 v10, s52
  s_waitcnt vmcnt(0) lgkmcnt(0)
  s_barrier
  buffer_store_dword v10, v9, s[8:11], 0 offen sc1
  s_branch pj_done
pj_slow:
  s_cmp_ge_u32 s68, s69
  s_cbranch_scc1 wf_done_4
  s_mov_b32 s50, 0
wf_loop_5:
  buffer_load_dword v11, v14, s[8:11], 0 offen sc1
  s_add_u32 s50, s50, 1
  s_cmp_gt_u32 s50, 131072
  s_cbranch_scc1 L_fail
  s_waitcnt vmcnt(0)
  v_readfirstlane_b32 s68, v11
  s_nop 0
  s_cmp_ge_u32 s68, s69
  s_cbranch_scc1 wf_done_4
  s_sleep 2
  s_branch wf_loop_5
wf_done_4:
  s_branch pj_back
pj_done:
  s_branch L_parta
L_uw:
  s_mov_b32 s4, s32
  s_mov_b32 s5, s33
  s_mov_b32 s6, 7864320
  s_mov_b32 s7, 0x20000
  v_lshrrev_b32 v8, 3, v0
  v_lshrrev_b32 v9, 2, v8
  v_lshlrev_b32 v9, 3, v9
  v_and_b32 v1, 3, v8
  v_add_u32 v1, v1, v9
  s_and_b32 s46, s42, 1
  s_lshl_b32 s46, s46, 2
  s_lshr_b32 s47, s42, 1
  s_lshl_b32 s47, s47, 4
  s_add_u32 s46, s46, s47
  v_add_u32 v1, s46, v1
  v_mul_u32_u24 v1, 1280, v1
  v_lshrrev_b32 v8, 1, v8
  v_bfe_u32 v9, v0, 1, 2
  v_xor_b32 v8, v8, v9
  v_lshlrev_b32 v8, 5, v8
  v_and_b32 v9, 1, v0
  v_lshlrev_b32 v9, 4, v9
  v_add3_u32 v1, v1, v8, v9
  v_lshrrev_b32 v8, 5, v0
  v_lshlrev_b32 v2, 11, v8
  v_bfe_u32 v8, v0, 2, 3
  v_lshl_add_u32 v2, v8, 7, v2
  v_lshrrev_b32 v8, 1, v8
  v_xor_b32 v8, s42, v8
  v_lshl_add_u32 v2, v8, 5, v2
  v_and_b32 v8, 3, v0
  v_lshl_add_u32 v2, v8, 3, v2
  v_add_u32 v3, 0x10000, v2
  v_add_u32 v4, 0x20000, v2
  s_mul_i32 s53, s45, 245760
  v_lshlrev_b32 v5, 4, v0
  s_lshl_b32 s46, s45, 7
  s_add_u32 s47, s46, 1056768
  v_mov_b32 v6, s47
  s_lshl_b32 s47, s42, 2
  s_add_u32 s46, s46, s47
  s_add_u32 s46, s46, 1060864
  v_mov_b32 v7, s46
  v_mov_b32 v8, 2146435072
  v_cmp_eq_u32 vcc, 0, v0
  s_nop 1
  v_cndmask_b32 v7, v8, v7, vcc
  v_cndmask_b32 v6, v8, v6, vcc
  s_mov_b32 s60, s51
  s_add_u32 s61, s51, 81797120
  s_mov_b32 s62, s45
  v_mov_b32 v12, v5
  s_lshr_b32 s55, s45, 3
  s_lshl_b32 s55, s55, 14
  s_and_b32 s46, s45, 7
  s_lshl_b32 s46, s46, 10
  s_add_u32 s55, s55, s46
  s_lshl_b32 s46, s42, 16
  s_add_u32 s55, s55, s46
  s_add_u32 s55, s55, 81788928
  s_mov_b32 s52, 0
  s_mov_b32 s56, 0
  s_add_u32 m0, s51, 0
  s_add_u32 s46, s53, 0
  buffer_load_dwordx4 v1, s[4:7], s46 offen lds
  s_add_u32 m0, s51, 4096
  s_add_u32 s46, s53, 128
  buffer_load_dwordx4 v1, s[4:7], s46 offen lds
  s_add_u32 m0, s51, 8192
  s_add_u32 s46, s53, 256
  buffer_load_dwordx4 v1, s[4:7], s46 offen lds
  s_add_u32 m0, s51, 12288
  s_add_u32 s46, s53, 384
  buffer_load_dwordx4 v1, s[4:7], s46 offen lds
  s_add_u32 m0, s51, 16384
  s_add_u32 s46, s53, 512
  buffer_load_dwordx4 v1, s[4:7], s46 offen lds
  s_add_u32 m0, s51, 20480
  s_add_u32 s46, s53, 640
  buffer_load_dwordx4 v1, s[4:7], s46 offen lds
  s_add_u32 m0, s51, 24576
  s_add_u32 s46, s53, 768
  buffer_load_dwordx4 v1, s[4:7], s46 offen lds
  s_add_u32 m0, s51, 28672
  s_add_u32 s46, s53, 896
  buffer_load_dwordx4 v1, s[4:7], s46 offen lds
  s_add_u32 m0, s51, 32768
  s_add_u32 s46, s53, 1024
  buffer_load_dwordx4 v1, s[4:7], s46 offen lds
  s_add_u32 m0, s51, 36864
  s_add_u32 s46, s53, 1152
  buffer_load_dwordx4 v1, s[4:7], s46 offen lds
  s_add_u32 m0, s51, 40960
  s_add_u32 s46, s53, 40960
  buffer_load_dwordx4 v1, s[4:7], s46 offen lds
  s_add_u32 m0, s51, 45056
  s_add_u32 s46, s53, 41088
  buffer_load_dwordx4 v1, s[4:7], s46 offen lds
  s_add_u32 m0, s51, 49152
  s_add_u32 s46, s53, 41216
  buffer_load_dwordx4 v1, s[4:7], s46 offen lds
  s_add_u32 m0, s51, 53248
  s_add_u32 s46, s53, 41344
  buffer_load_dwordx4 v1, s[4:7], s46 offen lds
  s_add_u32 m0, s51, 57344
  s_add_u32 s46, s53, 41472
  buffer_load_dwordx4 v1, s[4:7], s46 offen lds
  s_add_u32 m0, s51, 61440
  s_add_u32 s46, s53, 41600
  buffer_load_dwordx4 v1, s[4:7], s46 offen lds
  s_add_u32 m0, s51, 65536
  s_add_u32 s46, s53, 41728
  buffer_load_dwordx4 v1, s[4:7], s46 offen lds
  s_add_u32 m0, s51, 69632
  s_add_u32 s46, s53, 41856
  buffer_load_dwordx4 v1, s[4:7], s46 offen lds
  s_add_u32 m0, s51, 73728
  s_add_u32 s46, s53, 41984
  buffer_load_dwordx4 v1, s[4:7], s46 offen lds
  s_add_u32 m0, s51, 77824
  s_add_u32 s46, s53, 42112
  buffer_load_dwordx4 v1, s[4:7], s46 offen lds
  s_add_u32 m0, s51, 81920
  s_add_u32 s46, s53, 81920
  buffer_load_dwordx4 v1, s[4:7], s46 offen lds
  s_add_u32 m0, s51, 86016
  s_add_u32 s46, s53, 82048
  buffer_load_dwordx4 v1, s[4:7], s46 offen lds
  s_add_u32 m0, s51, 90112
  s_add_u32 s46, s53, 82176
  buffer_load_dwordx4 v1, s[4:7], s46 offen lds
  s_add_u32 m0, s51, 94208
  s_add_u32 s46, s53, 82304
  buffer_load_dwordx4 v1, s[4:7], s46 offen lds
  s_add_u32 m0, s51, 98304
  s_add_u32 s46, s53, 82432
  buffer_load_dwordx4 v1, s[4:7], s46 offen lds
  s_add_u32 m0, s51, 102400
  s_add_u32 s46, s53, 82560
  buffer_load_dwordx4 v1, s[4:7], s46 offen lds
  s_add_u32 m0, s51, 106496
  s_add_u32 s46, s53, 82688
  buffer_load_dwordx4 v1, s[4:7], s46 offen lds
  s_add_u32 m0, s51, 110592
  s_add_u32 s46, s53, 82816
  buffer_load_dwordx4 v1, s[4:7], s46 offen lds
  s_add_u32 m0, s51, 114688
  s_add_u32 s46, s53, 82944
  buffer_load_dwordx4 v1, s[4:7], s46 offen lds
  s_add_u32 m0, s51, 118784
  s_add_u32 s46, s53, 83072
  buffer_load_dwordx4 v1, s[4:7], s46 offen lds
  s_waitcnt vmcnt(24)
  s_barrier
  s_add_u32 m0, s51, 122880
  s_add_u32 s46, s53, 122880
  buffer_load_dwordx4 v1, s[4:7], s46 offen lds
  s_add_u32 m0, s51, 126976
  s_add_u32 s46, s53, 123008
  buffer_load_dwordx4 v1, s[4:7], s46 offen lds
  s_add_u32 m0, s51, 131072
  s_add_u32 s46, s53, 123136
  buffer_load_dwordx4 v1, s[4:7], s46 offen lds
  s_add_u32 m0, s51, 135168
  s_add_u32 s46, s53, 123264
  buffer_load_dwordx4 v1, s[4:7], s46 offen lds
  s_add_u32 m0, s51, 139264
  s_add_u32 s46, s53, 123392
  buffer_load_dwordx4 v1, s[4:7], s46 offen lds
  s_add_u32 m0, s51, 143360
  s_add_u32 s46, s53, 123520
  buffer_load_dwordx4 v1, s[4:7], s46 offen lds
  ds_read_b64_tr_b16 a[0:1], v2 offset:0
  ds_read_b64_tr_b16 a[2:3], v2 offset:1024
  ds_read_b64_tr_b16 a[24:25], v2 offset:4096
  ds_read_b64_tr_b16 a[26:27], v2 offset:5120
  ds_read_b64_tr_b16 a[48:49], v2 offset:8192
  ds_read_b64_tr_b16 a[50:51], v2 offset:9216
  ds_read_b64_tr_b16 a[72:73], v2 offset:12288
  ds_read_b64_tr_b16 a[74:75], v2 offset:13312
  ds_read_b64_tr_b16 a[96:97], v2 offset:16384
  ds_read_b64_tr_b16 a[98:99], v2 offset:17408
  ds_read_b64_tr_b16 a[120:121], v2 offset:20480
  ds_read_b64_tr_b16 a[122:123], v2 offset:21504
  s_waitcnt lgkmcnt(0)
  s_waitcnt vmcnt(24)
  s_barrier
  s_add_u32 m0, s51, 0
  s_add_u32 s46, s53, 123648
  buffer_load_dwordx4 v1, s[4:7], s46 offen lds
  s_add_u32 m0, s51, 4096
  s_add_u32 s46, s53, 123776
  buffer_load_dwordx4 v1, s[4:7], s46 offen lds
  s_add_u32 m0, s51, 8192
  s_add_u32 s46, s53, 123904
  buffer_load_dwordx4 v1, s[4:7], s46 offen lds
  s_add_u32 m0, s51, 12288
  s_add_u32 s46, s53, 124032
  buffer_load_dwordx4 v1, s[4:7], s46 offen lds
  s_add_u32 m0, s51, 16384
  s_add_u32 s46, s53, 163840
  buffer_load_dwordx4 v1, s[4:7], s46 offen lds
  s_add_u32 m0, s51, 20480
  s_add_u32 s46, s53, 163968
  buffer_load_dwordx4 v1, s[4:7], s46 offen lds
  ds_read_b64_tr_b16 a[144:145], v2 offset:24576
  ds_read_b64_tr_b16 a[146:147], v2 offset:25600
  ds_read_b64_tr_b16 a[168:169], v2 offset:28672
  ds_read_b64_tr_b16 a[170:171], v2 offset:29696
  ds_read_b64_tr_b16 a[192:193], v2 offset:32768
  ds_read_b64_tr_b16 a[194:195], v2 offset:33792
  ds_read_b64_tr_b16 a[216:217], v2 offset:36864
  ds_read_b64_tr_b16 a[218:219], v2 offset:37888
  ds_read_b64_tr_b16 a[4:5], v2 offset:40960
  ds_read_b64_tr_b16 a[6:7], v2 offset:41984
  ds_read_b64_tr_b16 a[28:29], v2 offset:45056
  ds_read_b64_tr_b16 a[30:31], v2 offset:46080
  s_waitcnt lgkmcnt(0)
  s_waitcnt vmcnt(24)
  s_barrier
  s_add_u32 m0, s51, 24576
  s_add_u32 s46, s53, 164096
  buffer_load_dwordx4 v1, s[4:7], s46 offen lds
  s_add_u32 m0, s51, 28672
  s_add_u32 s46, s53, 164224
  buffer_load_dwordx4 v1, s[4:7], s46 offen lds
  s_add_u32 m0, s51, 32768
  s_add_u32 s46, s53, 164352
  buffer_load_dwordx4 v1, s[4:7], s46 offen lds
  s_add_u32 m0, s51, 36864
  s_add_u32 s46, s53, 164480
  buffer_load_dwordx4 v1, s[4:7], s46 offen lds
  s_add_u32 m0, s51, 40960
  s_add_u32 s46, s53, 164608
  buffer_load_dwordx4 v1, s[4:7], s46 offen lds
  s_add_u32 m0, s51, 45056
  s_add_u32 s46, s53, 164736
  buffer_load_dwordx4 v1, s[4:7], s46 offen lds
  ds_read_b64_tr_b16 a[52:53], v2 offset:49152
  ds_read_b64_tr_b16 a[54:55], v2 offset:50176
  ds_read_b64_tr_b16 a[76:77], v2 offset:53248
  ds_read_b64_tr_b16 a[78:79], v2 offset:54272
  ds_read_b64_tr_b16 a[100:101], v2 offset:57344
  ds_read_b64_tr_b16 a[102:103], v2 offset:58368
  ds_read_b64_tr_b16 a[124:125], v2 offset:61440
  ds_read_b64_tr_b16 a[126:127], v2 offset:62464
  ds_read_b64_tr_b16 a[148:149], v3 offset:0
  ds_read_b64_tr_b16 a[150:151], v3 offset:1024
  ds_read_b64_tr_b16 a[172:173], v3 offset:4096
  ds_read_b64_tr_b16 a[174:175], v3 offset:5120
  s_waitcnt lgkmcnt(0)
  s_waitcnt vmcnt(24)
  s_barrier
  s_add_u32 m0, s51, 49152
  s_add_u32 s46, s53, 164864
  buffer_load_dwordx4 v1, s[4:7], s46 offen lds
  s_add_u32 m0, s51, 53248
  s_add_u32 s46, s53, 164992
  buffer_load_dwordx4 v1, s[4:7], s46 offen lds
  s_add_u32 m0, s51, 57344
  s_add_u32 s46, s53, 204800
  buffer_load_dwordx4 v1, s[4:7], s46 offen lds
  s_add_u32 m0, s51, 61440
  s_add_u32 s46, s53, 204928
  buffer_load_dwordx4 v1, s[4:7], s46 offen lds
  s_add_u32 m0, s51, 65536
  s_add_u32 s46, s53, 205056
  buffer_load_dwordx4 v1, s[4:7], s46 offen lds
  s_add_u32 m0, s51, 69632
  s_add_u32 s46, s53, 205184
  buffer_load_dwordx4 v1, s[4:7], s46 offen lds
  ds_read_b64_tr_b16 a[196:197], v3 offset:8192
  ds_read_b64_tr_b16 a[198:199], v3 offset:9216
  ds_read_b64_tr_b16 a[220:221], v3 offset:12288
  ds_read_b64_tr_b16 a[222:223], v3 offset:13312
  ds_read_b64_tr_b16 a[8:9], v3 offset:16384
  ds_read_b64_tr_b16 a[10:11], v3 offset:17408
  ds_read_b64_tr_b16 a[32:33], v3 offset:20480
  ds_read_b64_tr_b16 a[34:35], v3 offset:21504
  ds_read_b64_tr_b16 a[56:57], v3 offset:24576
  ds_read_b64_tr_b16 a[58:59], v3 offset:25600
  ds_read_b64_tr_b16 a[80:81], v3 offset:28672
  ds_read_b64_tr_b16 a[82:83], v3 offset:29696
  s_waitcnt lgkmcnt(0)
  s_waitcnt vmcnt(24)
  s_barrier
  s_add_u32 m0, s51, 73728
  s_add_u32 s46, s53, 205312
  buffer_load_dwordx4 v1, s[4:7], s46 offen lds
  s_add_u32 m0, s51, 77824
  s_add_u32 s46, s53, 205440
  buffer_load_dwordx4 v1, s[4:7], s46 offen lds
  s_add_u32 m0, s51, 81920
  s_add_u32 s46, s53, 205568
  buffer_load_dwordx4 v1, s[4:7], s46 offen lds
  s_add_u32 m0, s51, 86016
  s_add_u32 s46, s53, 205696
  buffer_load_dwordx4 v1, s[4:7], s46 offen lds
  s_add_u32 m0, s51, 90112
  s_add_u32 s46, s53, 205824
  buffer_load_dwordx4 v1, s[4:7], s46 offen lds
  s_add_u32 m0, s51, 94208
  s_add_u32 s46, s53, 205952
  buffer_load_dwordx4 v1, s[4:7], s46 offen lds
  ds_read_b64_tr_b16 a[104:105], v3 offset:32768
  ds_read_b64_tr_b16 a[106:107], v3 offset:33792
  ds_read_b64_tr_b16 a[128:129], v3 offset:36864
  ds_read_b64_tr_b16 a[130:131], v3 offset:37888
  ds_read_b64_tr_b16 a[152:153], v3 offset:40960
  ds_read_b64_tr_b16 a[154:155], v3 offset:41984
  ds_read_b64_tr_b16 a[176:177], v3 offset:45056
  ds_read_b64_tr_b16 a[178:179], v3 offset:46080
  ds_read_b64_tr_b16 a[200:201], v3 offset:49152
  ds_read_b64_tr_b16 a[202:203], v3 offset:50176
  ds_read_b64_tr_b16 a[224:225], v3 offset:53248
  ds_read_b64_tr_b16 a[226:227], v3 offset:54272
  s_waitcnt lgkmcnt(0)
  s_waitcnt vmcnt(24)
  s_barrier
  ds_read_b64_tr_b16 a[12:13], v3 offset:57344
  ds_read_b64_tr_b16 a[14:15], v3 offset:58368
  ds_read_b64_tr_b16 a[36:37], v3 offset:61440
  ds_read_b64_tr_b16 a[38:39], v3 offset:62464
  ds_read_b64_tr_b16 a[60:61], v4 offset:0
  ds_read_b64_tr_b16 a[62:63], v4 offset:1024
  ds_read_b64_tr_b16 a[84:85], v4 offset:4096
  ds_read_b64_tr_b16 a[86:87], v4 offset:5120
  ds_read_b64_tr_b16 a[108:109], v4 offset:8192
  ds_read_b64_tr_b16 a[110:111], v4 offset:9216
  ds_read_b64_tr_b16 a[132:133], v4 offset:12288
  ds_read_b64_tr_b16 a[134:135], v4 offset:13312
  s_waitcnt lgkmcnt(0)
  s_waitcnt vmcnt(18)
  s_barrier
  ds_read_b64_tr_b16 a[156:157], v2 offset:0
  ds_read_b64_tr_b16 a[158:159], v2 offset:1024
  ds_read_b64_tr_b16 a[180:181], v2 offset:4096
  ds_read_b64_tr_b16 a[182:183], v2 offset:5120
  ds_read_b64_tr_b16 a[204:205], v2 offset:8192
  ds_read_b64_tr_b16 a[206:207], v2 offset:9216
  ds_read_b64_tr_b16 a[228:229], v2 offset:12288
  ds_read_b64_tr_b16 a[230:231], v2 offset:13312
  ds_read_b64_tr_b16 a[16:17], v2 offset:16384
  ds_read_b64_tr_b16 a[18:19], v2 offset:17408
  ds_read_b64_tr_b16 a[40:41], v2 offset:20480
  ds_read_b64_tr_b16 a[42:43], v2 offset:21504
  s_waitcnt lgkmcnt(0)
  s_waitcnt vmcnt(12)
  s_barrier
  ds_read_b64_tr_b16 a[64:65], v2 offset:24576
  ds_read_b64_tr_b16 a[66:67], v2 offset:25600
  ds_read_b64_tr_b16 a[88:89], v2 offset:28672
  ds_read_b64_tr_b16 a[90:91], v2 offset:29696
  ds_read_b64_tr_b16 a[112:113], v2 offset:32768
  ds_read_b64_tr_b16 a[114:115], v2 offset:33792
  ds_read_b64_tr_b16 a[136:137], v2 offset:36864
  ds_read_b64_tr_b16 a[138:139], v2 offset:37888
  ds_read_b64_tr_b16 a[160:161], v2 offset:40960
  ds_read_b64_tr_b16 a[162:163], v2 offset:41984
  ds_read_b64_tr_b16 a[184:185], v2 offset:45056
  ds_read_b64_tr_b16 a[186:187], v2 offset:46080
  s_waitcnt lgkmcnt(0)
  s_waitcnt vmcnt(6)
  s_barrier
  ds_read_b64_tr_b16 a[208:209], v2 offset:49152
  ds_read_b64_tr_b16 a[210:211], v2 offset:50176
  ds_read_b64_tr_b16 a[232:233], v2 offset:53248
  ds_read_b64_tr_b16 a[234:235], v2 offset:54272
  ds_read_b64_tr_b16 a[20:21], v2 offset:57344
  ds_read_b64_tr_b16 a[22:23], v2 offset:58368
  ds_read_b64_tr_b16 a[44:45], v2 offset:61440
  ds_read_b64_tr_b16 a[46:47], v2 offset:62464
  ds_read_b64_tr_b16 a[68:69], v3 offset:0
  ds_read_b64_tr_b16 a[70:71], v3 offset:1024
  ds_read_b64_tr_b16 a[92:93], v3 offset:4096
  ds_read_b64_tr_b16 a[94:95], v3 offset:5120
  s_waitcnt lgkmcnt(0)
  s_waitcnt vmcnt(0)
  s_barrier
  ds_read_b64_tr_b16 a[116:117], v3 offset:8192
  ds_read_b64_tr_b16 a[118:119], v3 offset:9216
  ds_read_b64_tr_b16 a[140:141], v3 offset:12288
  ds_read_b64_tr_b16 a[142:143], v3 offset:13312
  ds_read_b64_tr_b16 a[164:165], v3 offset:16384
  ds_read_b64_tr_b16 a[166:167], v3 offset:17408
  ds_read_b64_tr_b16 a[188:189], v3 offset:20480
  ds_read_b64_tr_b16 a[190:191], v3 offset:21504
  ds_read_b64_tr_b16 a[212:213], v3 offset:24576
  ds_read_b64_tr_b16 a[214:215], v3 offset:25600
  ds_read_b64_tr_b16 a[236:237], v3 offset:28672
  ds_read_b64_tr_b16 a[238:239], v3 offset:29696
  s_waitcnt lgkmcnt(0)
  s_barrier
  v_and_b32 v9, 3, v0
  v_lshlrev_b32 v9, 2, v9
  s_mov_b32 s50, 0
ss_6:
  global_load_dword v8, v9, s[38:39] sc1
  s_add_u32 s50, s50, 1
  s_cmp_gt_u32 s50, 131072
  s_cbranch_scc1 L_fail
  s_waitcnt vmcnt(0)
  v_readlane_b32 s46, v8, 0
  v_readlane_b32 s47, v8, 2
  s_cmp_lg_u32 s46, 0
  s_cselect_b32 s48, 7, 0
  s_add_u32 s46, s46, s2
  s_xor_b32 s49, s46, s43
  s_and_b32 s49, s49, s48
  s_cbranch_scc1 L_reroll
  s_cmp_lg_u32 s47, 0
  s_cbranch_scc1 ss_ok_7
  s_sleep 10
  s_branch ss_6
ss_ok_7:
  v_readlane_b32 s3, v8, 1
  s_nop 0
  s_and_b32 s3, s3, 0x2000
  s_xor_b32 s61, s61, s3
  s_xor_b32 s55, s55, s3
  s_mov_b32 s57, 1
  s_cmp_ge_u32 s56, s57
  s_cbranch_scc1 wf_done_8
  s_mov_b32 s50, 0
wf_loop_9:
  buffer_load_dword v13, v6, s[8:11], 0 offen sc1
  s_add_u32 s50, s50, 1
  s_cmp_gt_u32 s50, 131072
  s_cbranch_scc1 L_fail
  s_waitcnt vmcnt(0)
  v_readfirstlane_b32 s56, v13
  s_nop 0
  s_cmp_ge_u32 s56, s57
  s_cbranch_scc1 wf_done_8
  s_sleep 2
  s_branch wf_loop_9
wf_done_8:
  s_lshr_b32 s54, s62, 1
  s_lshl_b32 s54, s54, 14
  s_and_b32 s47, s62, 1
  s_lshl_b32 s47, s47, 12
  s_add_u32 s54, s54, s47
  s_add_u32 s54, s54, s61
  s_lshr_b32 s47, s54, 8
  s_and_b32 s47, s47, 0x2000
  s_xor_b32 s54, s54, s47
  s_add_u32 m0, s60, 0
  s_add_u32 s47, s54, 0
  buffer_load_dwordx4 v5, s[8:11], s47 offen sc1 lds
  s_add_u32 m0, s60, 4096
  s_add_u32 s47, s54, 16777216
  buffer_load_dwordx4 v5, s[8:11], s47 offen sc1 lds
  s_add_u32 m0, s60, 8192
  s_add_u32 s47, s54, 33554432
  buffer_load_dwordx4 v5, s[8:11], s47 offen sc1 lds
  s_mov_b32 s59, 2146435072
  s_waitcnt vmcnt(0)
  s_barrier
  ds_read_b128 v[16:19], v12 offset:0
  ds_read_b128 v[40:43], v12 offset:2048
  ds_read_b128 v[20:23], v12 offset:1024
  ds_read_b128 v[44:47], v12 offset:3072
  ds_read_b128 v[24:27], v12 offset:4096
  ds_read_b128 v[48:51], v12 offset:6144
  ds_read_b128 v[28:31], v12 offset:5120
  ds_read_b128 v[52:55], v12 offset:7168
  ds_read_b128 v[32:35], v12 offset:8192
  ds_read_b128 v[56:59], v12 offset:10240
  ds_read_b128 v[36:39], v12 offset:9216
  ds_read_b128 v[60:63], v12 offset:11264
u_loop:
  s_waitcnt lgkmcnt(8)
  v_mfma_f32_16x16x32_bf16 v[64:67], v[16:19], a[0:3], 0
  buffer_load_dword v13, v6, s[8:11], 0 offen sc1
  v_mfma_f32_16x16x32_bf16 v[68:71], v[40:43], a[0:3], 0
  v_mfma_f32_16x16x32_bf16 v[64:67], v[20:23], a[4:7], v[64:67]
  v_cvt_pk_bf16_f32 v84, v72, v73
  v_mfma_f32_16x16x32_bf16 v[68:71], v[44:47], a[4:7], v[68:71]
  s_waitcnt lgkmcnt(4)
  v_cvt_pk_bf16_f32 v85, v74, v75
  v_mfma_f32_16x16x32_bf16 v[64:67], v[24:27], a[8:11], v[64:67]
  v_cvt_pk_bf16_f32 v86, v76, v77
  v_mfma_f32_16x16x32_bf16 v[68:71], v[48:51], a[8:11], v[68:71]
  v_cvt_pk_bf16_f32 v87, v78, v79
  v_mfma_f32_16x16x32_bf16 v[64:67], v[28:31], a[12:15], v[64:67]
  buffer_store_dwordx4 v[84:87], v5, s[8:11], s59 offen sc1
  v_mfma_f32_16x16x32_bf16 v[68:71], v[52:55], a[12:15], v[68:71]
  s_add_u32 s58, s55, 0
  s_waitcnt lgkmcnt(0)
  v_mfma_f32_16x16x32_bf16 v[64:67], v[32:35], a[16:19], v[64:67]
  s_lshr_b32 s46, s58, 8
  v_mfma_f32_16x16x32_bf16 v[68:71], v[56:59], a[16:19], v[68:71]
  s_and_b32 s46, s46, 0x2000
  v_mfma_f32_16x16x32_bf16 v[64:67], v[36:39], a[20:23], v[64:67]
  s_xor_b32 s58, s58, s46
  v_mfma_f32_16x16x32_bf16 v[68:71], v[60:63], a[20:23], v[68:71]
  v_mfma_f32_16x16x32_bf16 v[72:75], v[16:19], a[24:27], 0
  s_add_u32 s59, s55, 2359296
  v_mfma_f32_16x16x32_bf16 v[76:79], v[40:43], a[24:27], 0
  s_lshr_b32 s46, s59, 8
  v_mfma_f32_16x16x32_bf16 v[72:75], v[20:23], a[28:31], v[72:75]
  s_and_b32 s46, s46, 0x2000
  v_cvt_pk_bf16_f32 v80, v64, v65
  v_mfma_f32_16x16x32_bf16 v[76:79], v[44:47], a[28:31], v[76:79]
  s_xor_b32 s59, s59, s46
  v_cvt_pk_bf16_f32 v81, v66, v67
  v_mfma_f32_16x16x32_bf16 v[72:75], v[24:27], a[32:35], v[72:75]
  v_cvt_pk_bf16_f32 v82, v68, v69
  v_mfma_f32_16x16x32_bf16 v[76:79], v[48:51], a[32:35], v[76:79]
  s_add_u32 s57, s52, 2
  s_min_u32 s57, s57, 64
  v_cvt_pk_bf16_f32 v83, v70, v71
  v_mfma_f32_16x16x32_bf16 v[72:75], v[28:31], a[36:39], v[72:75]
  buffer_store_dwordx4 v[80:83], v5, s[8:11], s58 offen sc1
  v_mfma_f32_16x16x32_bf16 v[76:79], v[52:55], a[36:39], v[76:79]
  s_add_u32 s58, s55, 262144
  v_mfma_f32_16x16x32_bf16 v[72:75], v[32:35], a[40:43], v[72:75]
  s_lshr_b32 s46, s58, 8
  v_mfma_f32_16x16x32_bf16 v[76:79], v[56:59], a[40:43], v[76:79]
  s_and_b32 s46, s46, 0x2000
  v_mfma_f32_16x16x32_bf16 v[72:75], v[36:39], a[44:47], v[72:75]
  s_xor_b32 s58, s58, s46
  v_mfma_f32_16x16x32_bf16 v[76:79], v[60:63], a[44:47], v[76:79]
  s_xor_b32 s60, s60, 0x4000
  v_mov_b32 v8, s52
  v_mfma_f32_16x16x32_bf16 v[64:67], v[16:19], a[48:51], 0
  s_add_u32 s62, s62, 32
  v_xor_b32 v12, 0x4000, v12
  v_mfma_f32_16x16x32_bf16 v[68:71], v[40:43], a[48:51], 0
  s_cmp_ge_u32 s62, 1024
  s_cselect_b32 s47, 1024, 0
  v_mfma_f32_16x16x32_bf16 v[64:67], v[20:23], a[52:55], v[64:67]
  s_sub_u32 s62, s62, s47
  v_cvt_pk_bf16_f32 v84, v72, v73
  v_mfma_f32_16x16x32_bf16 v[68:71], v[44:47], a[52:55], v[68:71]
  s_lshr_b32 s54, s62, 1
  v_cvt_pk_bf16_f32 v85, v74, v75
  v_mfma_f32_16x16x32_bf16 v[64:67], v[24:27], a[56:59], v[64:67]
  s_lshl_b32 s54, s54, 14
  v_cvt_pk_bf16_f32 v86, v76, v77
  v_mfma_f32_16x16x32_bf16 v[68:71], v[48:51], a[56:59], v[68:71]
  s_and_b32 s47, s62, 1
  v_cvt_pk_bf16_f32 v87, v78, v79
  v_mfma_f32_16x16x32_bf16 v[64:67], v[28:31], a[60:63], v[64:67]
  buffer_store_dwordx4 v[84:87], v5, s[8:11], s58 offen sc1
  s_lshl_b32 s47, s47, 12
  v_mfma_f32_16x16x32_bf16 v[68:71], v[52:55], a[60:63], v[68:71]
  s_add_u32 s58, s55, 524288
  s_add_u32 s54, s54, s47
  v_mfma_f32_16x16x32_bf16 v[64:67], v[32:35], a[64:67], v[64:67]
  s_lshr_b32 s46, s58, 8
  s_add_u32 s54, s54, s61
  v_mfma_f32_16x16x32_bf16 v[68:71], v[56:59], a[64:67], v[68:71]
  s_and_b32 s46, s46, 0x2000
  s_lshr_b32 s47, s54, 8
  v_mfma_f32_16x16x32_bf16 v[64:67], v[36:39], a[68:71], v[64:67]
  s_xor_b32 s58, s58, s46
  s_and_b32 s47, s47, 0x2000
  v_mfma_f32_16x16x32_bf16 v[68:71], v[60:63], a[68:71], v[68:71]
  s_xor_b32 s54, s54, s47
  v_mfma_f32_16x16x32_bf16 v[72:75], v[16:19], a[72:75], 0
  v_mfma_f32_16x16x32_bf16 v[76:79], v[40:43], a[72:75], 0
  v_mfma_f32_16x16x32_bf16 v[72:75], v[20:23], a[76:79], v[72:75]
  v_cvt_pk_bf16_f32 v80, v64, v65
  v_mfma_f32_16x16x32_bf16 v[76:79], v[44:47], a[76:79], v[76:79]
  v_cvt_pk_bf16_f32 v81, v66, v67
  v_mfma_f32_16x16x32_bf16 v[72:75], v[24:27], a[80:83], v[72:75]
  v_cvt_pk_bf16_f32 v82, v68, v69
  v_mfma_f32_16x16x32_bf16 v[76:79], v[48:51], a[80:83], v[76:79]
  v_cvt_pk_bf16_f32 v83, v70, v71
  v_mfma_f32_16x16x32_bf16 v[72:75], v[28:31], a[84:87], v[72:75]
  buffer_store_dwordx4 v[80:83], v5, s[8:11], s58 offen sc1
  v_mfma_f32_16x16x32_bf16 v[76:79], v[52:55], a[84:87], v[76:79]
  s_add_u32 s58, s55, 786432
  v_mfma_f32_16x16x32_bf16 v[72:75], v[32:35], a[88:91], v[72:75]
  s_lshr_b32 s46, s58, 8
  v_mfma_f32_16x16x32_bf16 v[76:79], v[56:59], a[88:91], v[76:79]
  s_and_b32 s46, s46, 0x2000
  v_mfma_f32_16x16x32_bf16 v[72:75], v[36:39], a[92:95], v[72:75]
  s_xor_b32 s58, s58, s46
  s_waitcnt vmcnt(3)
  v_readfirstlane_b32 s56, v13
  v_mfma_f32_16x16x32_bf16 v[76:79], v[60:63], a[92:95], v[76:79]
  buffer_store_dword v8, v7, s[8:11], 0 offen sc1
  v_mfma_f32_16x16x32_bf16 v[64:67], v[16:19], a[96:99], 0
  s_cmp_lt_u32 s56, s57
  s_cbranch_scc1 u_slow
u_back:
  v_mfma_f32_16x16x32_bf16 v[68:71], v[40:43], a[96:99], 0
  s_add_u32 m0, s60, 0
  s_add_u32 s47, s54, 0
  buffer_load_dwordx4 v5, s[8:11], s47 offen sc1 lds
  v_mfma_f32_16x16x32_bf16 v[64:67], v[20:23], a[100:103], v[64:67]
  s_add_u32 m0, s60, 4096
  s_add_u32 s47, s54, 16777216
  buffer_load_dwordx4 v5, s[8:11], s47 offen sc1 lds
  v_cvt_pk_bf16_f32 v84, v72, v73
  v_mfma_f32_16x16x32_bf16 v[68:71], v[44:47], a[100:103], v[68:71]
  s_add_u32 m0, s60, 8192
  s_add_u32 s47, s54, 33554432
  buffer_load_dwordx4 v5, s[8:11], s47 offen sc1 lds
  v_cvt_pk_bf16_f32 v85, v74, v75
  v_mfma_f32_16x16x32_bf16 v[64:67], v[24:27], a[104:107], v[64:67]
  v_cvt_pk_bf16_f32 v86, v76, v77
  v_mfma_f32_16x16x32_bf16 v[68:71], v[48:51], a[104:107], v[68:71]
  v_cvt_pk_bf16_f32 v87, v78, v79
  v_mfma_f32_16x16x32_bf16 v[64:67], v[28:31], a[108:111], v[64:67]
  buffer_store_dwordx4 v[84:87], v5, s[8:11], s58 offen sc1
  v_mfma_f32_16x16x32_bf16 v[68:71], v[52:55], a[108:111], v[68:71]
  s_add_u32 s58, s55, 1048576
  v_mfma_f32_16x16x32_bf16 v[64:67], v[32:35], a[112:115], v[64:67]
  s_lshr_b32 s46, s58, 8
  v_mfma_f32_16x16x32_bf16 v[68:71], v[56:59], a[112:115], v[68:71]
  s_and_b32 s46, s46, 0x2000
  v_mfma_f32_16x16x32_bf16 v[64:67], v[36:39], a[116:119], v[64:67]
  s_xor_b32 s58, s58, s46
  v_mfma_f32_16x16x32_bf16 v[68:71], v[60:63], a[116:119], v[68:71]
  v_mfma_f32_16x16x32_bf16 v[72:75], v[16:19], a[120:123], 0
  v_mfma_f32_16x16x32_bf16 v[76:79], v[40:43], a[120:123], 0
  v_mfma_f32_16x16x32_bf16 v[72:75], v[20:23], a[124:127], v[72:75]
  v_cvt_pk_bf16_f32 v80, v64, v65
  v_mfma_f32_16x16x32_bf16 v[76:79], v[44:47], a[124:127], v[76:79]
  v_cvt_pk_bf16_f32 v81, v66, v67
  v_mfma_f32_16x16x32_bf16 v[72:75], v[24:27], a[128:131], v[72:75]
  v_cvt_pk_bf16_f32 v82, v68, v69
  v_mfma_f32_16x16x32_bf16 v[76:79], v[48:51], a[128:131], v[76:79]
  v_cvt_pk_bf16_f32 v83, v70, v71
  v_mfma_f32_16x16x32_bf16 v[72:75], v[28:31], a[132:135], v[72:75]
  buffer_store_dwordx4 v[80:83], v5, s[8:11], s58 offen sc1
  v_mfma_f32_16x16x32_bf16 v[76:79], v[52:55], a[132:135], v[76:79]
  s_add_u32 s58, s55, 1310720
  v_mfma_f32_16x16x32_bf16 v[72:75], v[32:35], a[136:139], v[72:75]
  s_lshr_b32 s46, s58, 8
  v_mfma_f32_16x16x32_bf16 v[76:79], v[56:59], a[136:139], v[76:79]
  s_and_b32 s46, s46, 0x2000
  v_mfma_f32_16x16x32_bf16 v[72:75], v[36:39], a[140:143], v[72:75]
  s_xor_b32 s58, s58, s46
  v_mfma_f32_16x16x32_bf16 v[76:79], v[60:63], a[140:143], v[76:79]
  v_mfma_f32_16x16x32_bf16 v[64:67], v[16:19], a[144:147], 0
  v_mfma_f32_16x16x32_bf16 v[68:71], v[40:43], a[144:147], 0
  v_mfma_f32_16x16x32_bf16 v[64:67], v[20:23], a[148:151], v[64:67]
  v_cvt_pk_bf16_f32 v84, v72, v73
  v_mfma_f32_16x16x32_bf16 v[68:71], v[44:47], a[148:151], v[68:71]
  v_cvt_pk_bf16_f32 v85, v74, v75
  v_mfma_f32_16x16x32_bf16 v[64:67], v[24:27], a[152:155], v[64:67]
  v_cvt_pk_bf16_f32 v86, v76, v77
  v_mfma_f32_16x16x32_bf16 v[68:71], v[48:51], a[152:155], v[68:71]
  v_cvt_pk_bf16_f32 v87, v78, v79
  v_mfma_f32_16x16x32_bf16 v[64:67], v[28:31], a[156:159], v[64:67]
  buffer_store_dwordx4 v[84:87], v5, s[8:11], s58 offen sc1
  v_mfma_f32_16x16x32_bf16 v[68:71], v[52:55], a[156:159], v[68:71]
  s_add_u32 s58, s55, 1572864
  v_mfma_f32_16x16x32_bf16 v[64:67], v[32:35], a[160:163], v[64:67]
  s_lshr_b32 s46, s58, 8
  v_mfma_f32_16x16x32_bf16 v[68:71], v[56:59], a[160:163], v[68:71]
  s_and_b32 s46, s46, 0x2000
  v_mfma_f32_16x16x32_bf16 v[64:67], v[36:39], a[164:167], v[64:67]
  s_xor_b32 s58, s58, s46
  v_mfma_f32_16x16x32_bf16 v[68:71], v[60:63], a[164:167], v[68:71]
  v_mfma_f32_16x16x32_bf16 v[72:75], v[16:19], a[168:171], 0
  v_mfma_f32_16x16x32_bf16 v[76:79], v[40:43], a[168:171], 0
  v_mfma_f32_16x16x32_bf16 v[72:75], v[20:23], a[172:175], v[72:75]
  v_cvt_pk_bf16_f32 v80, v64, v65
  v_mfma_f32_16x16x32_bf16 v[76:79], v[44:47], a[172:175], v[76:79]
  v_cvt_pk_bf16_f32 v81, v66, v67
  v_mfma_f32_16x16x32_bf16 v[72:75], v[24:27], a[176:179], v[72:75]
  v_cvt_pk_bf16_f32 v82, v68, v69
  v_mfma_f32_16x16x32_bf16 v[76:79], v[48:51], a[176:179], v[76:79]
  v_cvt_pk_bf16_f32 v83, v70, v71
  v_mfma_f32_16x16x32_bf16 v[72:75], v[28:31], a[180:183], v[72:75]
  buffer_store_dwordx4 v[80:83], v5, s[8:11], s58 offen sc1
  v_mfma_f32_16x16x32_bf16 v[76:79], v[52:55], a[180:183], v[76:79]
  s_add_u32 s58, s55, 1835008
  v_mfma_f32_16x16x32_bf16 v[72:75], v[32:35], a[184:187], v[72:75]
  s_lshr_b32 s46, s58, 8
  v_mfma_f32_16x16x32_bf16 v[76:79], v[56:59], a[184:187], v[76:79]
  s_and_b32 s46, s46, 0x2000
  v_mfma_f32_16x16x32_bf16 v[72:75], v[36:39], a[188:191], v[72:75]
  s_xor_b32 s58, s58, s46
  v_mfma_f32_16x16x32_bf16 v[76:79], v[60:63], a[188:191], v[76:79]
  v_mfma_f32_16x16x32_bf16 v[64:67], v[16:19], a[192:195], 0
  v_mfma_f32_16x16x32_bf16 v[68:71], v[40:43], a[192:195], 0
  v_mfma_f32_16x16x32_bf16 v[64:67], v[20:23], a[196:199], v[64:67]
  v_cvt_pk_bf16_f32 v84, v72, v73
  v_mfma_f32_16x16x32_bf16 v[68:71], v[44:47], a[196:199], v[68:71]
  v_cvt_pk_bf16_f32 v85, v74, v75
  v_mfma_f32_16x16x32_bf16 v[64:67], v[24:27], a[200:203], v[64:67]
  v_cvt_pk_bf16_f32 v86, v76, v77
  v_mfma_f32_16x16x32_bf16 v[68:71], v[48:51], a[200:203], v[68:71]
  v_cvt_pk_bf16_f32 v87, v78, v79
  v_mfma_f32_16x16x32_bf16 v[64:67], v[28:31], a[204:207], v[64:67]
  buffer_store_dwordx4 v[84:87], v5, s[8:11], s58 offen sc1
  v_mfma_f32_16x16x32_bf16 v[68:71], v[52:55], a[204:207], v[68:71]
  s_add_u32 s58, s55, 2097152
  v_mfma_f32_16x16x32_bf16 v[64:67], v[32:35], a[208:211], v[64:67]
  s_lshr_b32 s46, s58, 8
  v_mfma_f32_16x16x32_bf16 v[68:71], v[56:59], a[208:211], v[68:71]
  s_and_b32 s46, s46, 0x2000
  v_mfma_f32_16x16x32_bf16 v[64:67], v[36:39], a[212:215], v[64:67]
  s_xor_b32 s58, s58, s46
  s_waitcnt vmcnt(5)
  s_barrier
  v_mfma_f32_16x16x32_bf16 v[68:71], v[60:63], a[212:215], v[68:71]
  s_add_u32 s55, s55, 2621440
  v_mfma_f32_16x16x32_bf16 v[72:75], v[16:19], a[216:219], 0
  ds_read_b128 v[16:19], v12 offset:0
  v_mfma_f32_16x16x32_bf16 v[76:79], v[40:43], a[216:219], 0
  ds_read_b128 v[40:43], v12 offset:2048
  v_mfma_f32_16x16x32_bf16 v[72:75], v[20:23], a[220:223], v[72:75]
  ds_read_b128 v[20:23], v12 offset:1024
  v_cvt_pk_bf16_f32 v80, v64, v65
  v_mfma_f32_16x16x32_bf16 v[76:79], v[44:47], a[220:223], v[76:79]
  ds_read_b128 v[44:47], v12 offset:3072
  v_cvt_pk_bf16_f32 v81, v66, v67
  v_mfma_f32_16x16x32_bf16 v[72:75], v[24:27], a[224:227], v[72:75]
  ds_read_b128 v[24:27], v12 offset:4096
  v_cvt_pk_bf16_f32 v82, v68, v69
  v_mfma_f32_16x16x32_bf16 v[76:79], v[48:51], a[224:227], v[76:79]
  ds_read_b128 v[48:51], v12 offset:6144
  v_cvt_pk_bf16_f32 v83, v70, v71
  v_mfma_f32_16x16x32_bf16 v[72:75], v[28:31], a[228:231], v[72:75]
  buffer_store_dwordx4 v[80:83], v5, s[8:11], s58 offen sc1
  ds_read_b128 v[28:31], v12 offset:5120
  v_mfma_f32_16x16x32_bf16 v[76:79], v[52:55], a[228:231], v[76:79]
  ds_read_b128 v[52:55], v12 offset:7168
  s_cmp_ge_u32 s55, 165675008
  s_cselect_b32 s46, 83886080, 0
  v_mfma_f32_16x16x32_bf16 v[72:75], v[32:35], a[232:235], v[72:75]
  ds_read_b128 v[32:35], v12 offset:8192
  s_sub_u32 s55, s55, s46
  v_mfma_f32_16x16x32_bf16 v[76:79], v[56:59], a[232:235], v[76:79]
  ds_read_b128 v[56:59], v12 offset:10240
  s_add_u32 s52, s52, 1
  v_mfma_f32_16x16x32_bf16 v[72:75], v[36:39], a[236:239], v[72:75]
  ds_read_b128 v[36:39], v12 offset:9216
  s_cmp_lt_u32 s52, 64
  v_mfma_f32_16x16x32_bf16 v[76:79], v[60:63], a[236:239], v[76:79]
  ds_read_b128 v[60:63], v12 offset:11264
  s_cbranch_scc1 u_loop
  s_nop 2
  v_cvt_pk_bf16_f32 v84, v72, v73
  v_cvt_pk_bf16_f32 v85, v74, v75
  s_nop 0
  v_cvt_pk_bf16_f32 v86, v76, v77
  v_cvt_pk_bf16_f32 v87, v78, v79
  buffer_store_dwordx4 v[84:87], v5, s[8:11], s59 offen sc1
  v_mov_b32 v8, s52
  s_waitcnt vmcnt(0) lgkmcnt(0)
  buffer_store_dword v8, v7, s[8:11], 0 offen sc1
  s_branch u_done
u_slow:
  s_cmp_ge_u32 s56, s57
  s_cbranch_scc1 wf_done_10
  s_mov_b32 s50, 0
wf_loop_11:
  buffer_load_dword v13, v6, s[8:11], 0 offen sc1
  s_add_u32 s50, s50, 1
  s_cmp_gt_u32 s50, 131072
  s_cbranch_scc1 L_fail
  s_waitcnt vmcnt(0)
  v_readfirstlane_b32 s56, v13
  s_nop 0
  s_cmp_ge_u32 s56, s57
  s_cbranch_scc1 wf_done_10
  s_sleep 2
  s_branch wf_loop_11
wf_done_10:
  s_branch u_back
u_done:
L_parta:
  s_barrier
  s_lshl_b32 s65, s44, 2
  s_add_u32 s65, s65, s43
  s_sub_u32 s65, s65, 4
  s_cmp_ge_u32 s65, 120
  s_cbranch_scc1 pa_att
  s_mov_b32 s4, s18
  s_mov_b32 s5, s19
  s_mov_b32 s6, 2457600
  s_mov_b32 s7, 0x20000
  s_mov_b32 s12, s16
  s_mov_b32 s13, s17
  s_mov_b32 s14, 2621440
  s_mov_b32 s15, 0x20000
  s_mul_i32 s46, s65, 205
  s_lshr_b32 s46, s46, 11
  s_mul_i32 s47, s46, 10
  s_sub_u32 s47, s65, s47
  s_mul_i32 s60, s47, 384
  s_lshl_b32 s67, s47, 6
  s_mov_b32 s63, 132128768
  s_mul_i32 s61, s46, 6
  s_add_u32 s62, s61, 6
  s_mul_i32 s48, s46, 3
  s_add_u32 s49, s48, 31
  s_add_u32 s48, s48, 28
  s_min_u32 s61, s61, s48
  s_min_u32 s62, s62, s49
  s_add_u32 s67, s67, s61
  s_lshl_b32 s64, s65, 7
  s_add_u32 s64, s64, 1081344
  v_lshrrev_b32 v10, 3, v0
  v_lshrrev_b32 v11, 2, v10
  v_lshlrev_b32 v11, 3, v11
  v_and_b32 v1, 3, v10
  v_add_u32 v1, v1, v11
  s_and_b32 s46, s42, 1
  s_lshl_b32 s46, s46, 2
  s_lshr_b32 s47, s42, 1
  s_lshl_b32 s47, s47, 4
  s_add_u32 s46, s46, s47
  v_add_u32 v1, s46, v1
  v_mul_u32_u24 v1, 3840, v1
  v_lshrrev_b32 v10, 1, v10
  v_bfe_u32 v11, v0, 1, 2
  v_xor_b32 v10, v10, v11
  v_lshlrev_b32 v10, 5, v10
  v_and_b32 v11, 1, v0
  v_lshlrev_b32 v11, 4, v11
  v_add3_u32 v1, v1, v10, v11
  v_lshrrev_b32 v10, 5, v0
  v_lshlrev_b32 v2, 11, v10
  v_bfe_u32 v10, v0, 2, 3
  v_lshl_add_u32 v2, v10, 7, v2
  v_lshrrev_b32 v10, 1, v10
  v_xor_b32 v10, s42, v10
  v_lshl_add_u32 v2, v10, 5, v2
  v_and_b32 v10, 3, v0
  v_lshl_add_u32 v2, v10, 3, v2
  v_add_u32 v3, 0x10000, v2
  v_add_u32 v4, 0x20000, v2
  v_lshrrev_b32 v10, 3, v0
  s_lshl_b32 s46, s42, 3
  v_add_u32 v10, s46, v10
  v_mul_u32_u24 v5, 1280, v10
  v_bfe_u32 v10, v10, 1, 3
  v_and_b32 v11, 7, v0
  v_xor_b32 v10, v10, v11
  v_lshl_add_u32 v5, v10, 4, v5
  v_and_b32 v10, 15, v0
  v_lshlrev_b32 v6, 7, v10
  v_lshrrev_b32 v10, 1, v10
  v_lshrrev_b32 v11, 4, v0
  v_xor_b32 v10, v10, v11
  v_lshl_add_u32 v6, v10, 4, v6
  v_add_u32 v6, 122880, v6
  v_xor_b32 v7, 64, v6
  v_and_b32 v10, 15, v0
  v_lshlrev_b32 v8, 4, v10
  v_bfe_u32 v10, v0, 4, 1
  v_lshlrev_b32 v10, 11, v10
  v_lshrrev_b32 v11, 5, v0
  v_lshlrev_b32 v11, 8, v11
  v_add3_u32 v8, v8, v10, v11
  s_lshl_b32 s46, s42, 9
  v_add_u32 v8, s46, v8
  v_mov_b32 v9, s64
  v_mov_b32 v10, 2146435072
  s_cmp_eq_u32 s42, 0
  s_cselect_b64 vcc, 1, 0
  v_cndmask_b32 v9, v10, v9, vcc
  s_lshl_b32 s46, s43, 7
  s_add_u32 s46, s46, 1076736
  v_mov_b32 v14, s46
  s_mov_b32 s68, 0
  s_mov_b32 s52, s61
  s_mul_i32 s53, s52, 40960
  s_add_u32 s54, s51, 122880
  s_add_u32 m0, s54, 0
  s_nop 0
  buffer_load_dwordx4 v5, s[12:15], s53 offen offset:0 lds
  s_add_u32 m0, s54, 3968
  s_nop 0
  buffer_load_dwordx4 v5, s[12:15], s53 offen offset:128 lds
  s_add_u32 m0, s54, 7936
  s_nop 0
  buffer_load_dwordx4 v5, s[12:15], s53 offen offset:256 lds
  s_add_u32 m0, s54, 11904
  s_nop 0
  buffer_load_dwordx4 v5, s[12:15], s53 offen offset:384 lds
  s_add_u32 m0, s54, 15872
  s_nop 0
  buffer_load_dwordx4 v5, s[12:15], s53 offen offset:512 lds
  s_add_u32 m0, s54, 19840
  s_nop 0
  buffer_load_dwordx4 v5, s[12:15], s53 offen offset:640 lds
  s_add_u32 m0, s54, 23808
  s_nop 0
  buffer_load_dwordx4 v5, s[12:15], s53 offen offset:768 lds
  s_add_u32 m0, s54, 27776
  s_nop 0
  buffer_load_dwordx4 v5, s[12:15], s53 offen offset:896 lds
  s_add_u32 m0, s54, 31744
  s_nop 0
  buffer_load_dwordx4 v5, s[12:15], s53 offen offset:1024 lds
  s_add_u32 m0, s54, 35712
  s_nop 0
  buffer_load_dwordx4 v5, s[12:15], s53 offen offset:1152 lds
  s_add_u32 m0, s51, 0
  s_add_u32 s46, s60, 0
  buffer_load_dwordx4 v1, s[4:7], s46 offen lds
  s_add_u32 m0, s51, 4096
  s_add_u32 s46, s60, 128
  buffer_load_dwordx4 v1, s[4:7], s46 offen lds
  s_add_u32 m0, s51, 8192
  s_add_u32 s46, s60, 256
  buffer_load_dwordx4 v1, s[4:7], s46 offen lds
  s_add_u32 m0, s51, 12288
  s_add_u32 s46, s60, 122880
  buffer_load_dwordx4 v1, s[4:7], s46 offen lds
  s_add_u32 m0, s51, 16384
  s_add_u32 s46, s60, 123008
  buffer_load_dwordx4 v1, s[4:7], s46 offen lds
  s_add_u32 m0, s51, 20480
  s_add_u32 s46, s60, 123136
  buffer_load_dwordx4 v1, s[4:7], s46 offen lds
  s_add_u32 m0, s51, 24576
  s_add_u32 s46, s60, 245760
  buffer_load_dwordx4 v1, s[4:7], s46 offen lds
  s_add_u32 m0, s51, 28672
  s_add_u32 s46, s60, 245888
  buffer_load_dwordx4 v1, s[4:7], s46 offen lds
  s_add_u32 m0, s51, 32768
  s_add_u32 s46, s60, 246016
  buffer_load_dwordx4 v1, s[4:7], s46 offen lds
  s_add_u32 m0, s51, 36864
  s_add_u32 s46, s60, 368640
  buffer_load_dwordx4 v1, s[4:7], s46 offen lds
  s_add_u32 m0, s51, 40960
  s_add_u32 s46, s60, 368768
  buffer_load_dwordx4 v1, s[4:7], s46 offen lds
  s_add_u32 m0, s51, 45056
  s_add_u32 s46, s60, 368896
  buffer_load_dwordx4 v1, s[4:7], s46 offen lds
  s_add_u32 m0, s51, 49152
  s_add_u32 s46, s60, 491520
  buffer_load_dwordx4 v1, s[4:7], s46 offen lds
  s_add_u32 m0, s51, 53248
  s_add_u32 s46, s60, 491648
  buffer_load_dwordx4 v1, s[4:7], s46 offen lds
  s_add_u32 m0, s51, 57344
  s_add_u32 s46, s60, 491776
  buffer_load_dwordx4 v1, s[4:7], s46 offen lds
  s_add_u32 m0, s51, 61440
  s_add_u32 s46, s60, 614400
  buffer_load_dwordx4 v1, s[4:7], s46 offen lds
  s_add_u32 m0, s51, 65536
  s_add_u32 s46, s60, 614528
  buffer_load_dwordx4 v1, s[4:7], s46 offen lds
  s_add_u32 m0, s51, 69632
  s_add_u32 s46, s60, 614656
  buffer_load_dwordx4 v1, s[4:7], s46 offen lds
  s_add_u32 m0, s51, 73728
  s_add_u32 s46, s60, 737280
  buffer_load_dwordx4 v1, s[4:7], s46 offen lds
  s_add_u32 m0, s51, 77824
  s_add_u32 s46, s60, 737408
  buffer_load_dwordx4 v1, s[4:7], s46 offen lds
  s_add_u32 m0, s51, 81920
  s_add_u32 s46, s60, 737536
  buffer_load_dwordx4 v1, s[4:7], s46 offen lds
  s_add_u32 m0, s51, 86016
  s_add_u32 s46, s60, 860160
  buffer_load_dwordx4 v1, s[4:7], s46 offen lds
  s_add_u32 m0, s51, 90112
  s_add_u32 s46, s60, 860288
  buffer_load_dwordx4 v1, s[4:7], s46 offen lds
  s_add_u32 m0, s51, 94208
  s_add_u32 s46, s60, 860416
  buffer_load_dwordx4 v1, s[4:7], s46 offen lds
  s_waitcnt vmcnt(18)
  s_barrier
  s_add_u32 m0, s51, 98304
  s_add_u32 s46, s60, 983040
  buffer_load_dwordx4 v1, s[4:7], s46 offen lds
  s_add_u32 m0, s51, 102400
  s_add_u32 s46, s60, 983168
  buffer_load_dwordx4 v1, s[4:7], s46 offen lds
  s_add_u32 m0, s51, 106496
  s_add_u32 s46, s60, 983296
  buffer_load_dwordx4 v1, s[4:7], s46 offen lds
  s_add_u32 m0, s51, 110592
  s_add_u32 s46, s60, 1105920
  buffer_load_dwordx4 v1, s[4:7], s46 offen lds
  s_add_u32 m0, s51, 114688
  s_add_u32 s46, s60, 1106048
  buffer_load_dwordx4 v1, s[4:7], s46 offen lds
  s_add_u32 m0, s51, 118784
  s_add_u32 s46, s60, 1106176
  buffer_load_dwordx4 v1, s[4:7], s46 offen lds
  ds_read_b64_tr_b16 a[0:1], v2 offset:0
  ds_read_b64_tr_b16 a[2:3], v2 offset:1024
  ds_read_b64_tr_b16 a[4:5], v2 offset:4096
  ds_read_b64_tr_b16 a[6:7], v2 offset:5120
  ds_read_b64_tr_b16 a[8:9], v2 offset:8192
  ds_read_b64_tr_b16 a[10:11], v2 offset:9216
  ds_read_b64_tr_b16 a[12:13], v2 offset:12288
  ds_read_b64_tr_b16 a[14:15], v2 offset:13312
  ds_read_b64_tr_b16 a[16:17], v2 offset:16384
  ds_read_b64_tr_b16 a[18:19], v2 offset:17408
  ds_read_b64_tr_b16 a[20:21], v2 offset:20480
  ds_read_b64_tr_b16 a[22:23], v2 offset:21504
  s_waitcnt lgkmcnt(0)
  s_waitcnt vmcnt(18)
  s_barrier
  s_add_u32 m0, s51, 0
  s_add_u32 s46, s60, 1228800
  buffer_load_dwordx4 v1, s[4:7], s46 offen lds
  s_add_u32 m0, s51, 4096
  s_add_u32 s46, s60, 1228928
  buffer_load_dwordx4 v1, s[4:7], s46 offen lds
  s_add_u32 m0, s51, 8192
  s_add_u32 s46, s60, 1229056
  buffer_load_dwordx4 v1, s[4:7], s46 offen lds
  s_add_u32 m0, s51, 12288
  s_add_u32 s46, s60, 1351680
  buffer_load_dwordx4 v1, s[4:7], s46 offen lds
  s_add_u32 m0, s51, 16384
  s_add_u32 s46, s60, 1351808
  buffer_load_dwordx4 v1, s[4:7], s46 offen lds
  s_add_u32 m0, s51, 20480
  s_add_u32 s46, s60, 1351936
  buffer_load_dwordx4 v1, s[4:7], s46 offen lds
  ds_read_b64_tr_b16 a[24:25], v2 offset:24576
  ds_read_b64_tr_b16 a[26:27], v2 offset:25600
  ds_read_b64_tr_b16 a[28:29], v2 offset:28672
  ds_read_b64_tr_b16 a[30:31], v2 offset:29696
  ds_read_b64_tr_b16 a[32:33], v2 offset:32768
  ds_read_b64_tr_b16 a[34:35], v2 offset:33792
  ds_read_b64_tr_b16 a[36:37], v2 offset:36864
  ds_read_b64_tr_b16 a[38:39], v2 offset:37888
  ds_read_b64_tr_b16 a[40:41], v2 offset:40960
  ds_read_b64_tr_b16 a[42:43], v2 offset:41984
  ds_read_b64_tr_b16 a[44:45], v2 offset:45056
  ds_read_b64_tr_b16 a[46:47], v2 offset:46080
  s_waitcnt lgkmcnt(0)
  s_waitcnt vmcnt(18)
  s_barrier
  s_add_u32 m0, s51, 24576
  s_add_u32 s46, s60, 1474560
  buffer_load_dwordx4 v1, s[4:7], s46 offen lds
  s_add_u32 m0, s51, 28672
  s_add_u32 s46, s60, 1474688
  buffer_load_dwordx4 v1, s[4:7], s46 offen lds
  s_add_u32 m0, s51, 32768
  s_add_u32 s46, s60, 1474816
  buffer_load_dwordx4 v1, s[4:7], s46 offen lds
  s_add_u32 m0, s51, 36864
  s_add_u32 s46, s60, 1597440
  buffer_load_dwordx4 v1, s[4:7], s46 offen lds
  s_add_u32 m0, s51, 40960
  s_add_u32 s46, s60, 1597568
  buffer_load_dwordx4 v1, s[4:7], s46 offen lds
  s_add_u32 m0, s51, 45056
  s_add_u32 s46, s60, 1597696
  buffer_load_dwordx4 v1, s[4:7], s46 offen lds
  ds_read_b64_tr_b16 a[48:49], v2 offset:49152
  ds_read_b64_tr_b16 a[50:51], v2 offset:50176
  ds_read_b64_tr_b16 a[52:53], v2 offset:53248
  ds_read_b64_tr_b16 a[54:55], v2 offset:54272
  ds_read_b64_tr_b16 a[56:57], v2 offset:57344
  ds_read_b64_tr_b16 a[58:59], v2 offset:58368
  ds_read_b64_tr_b16 a[60:61], v2 offset:61440
  ds_read_b64_tr_b16 a[62:63], v2 offset:62464
  ds_read_b64_tr_b16 a[64:65], v3 offset:0
  ds_read_b64_tr_b16 a[66:67], v3 offset:1024
  ds_read_b64_tr_b16 a[68:69], v3 offset:4096
  ds_read_b64_tr_b16 a[70:71], v3 offset:5120
  s_waitcnt lgkmcnt(0)
  s_waitcnt vmcnt(18)
  s_barrier
  s_add_u32 m0, s51, 49152
  s_add_u32 s46, s60, 1720320
  buffer_load_dwordx4 v1, s[4:7], s46 offen lds
  s_add_u32 m0, s51, 53248
  s_add_u32 s46, s60, 1720448
  buffer_load_dwordx4 v1, s[4:7], s46 offen lds
  s_add_u32 m0, s51, 57344
  s_add_u32 s46, s60, 1720576
  buffer_load_dwordx4 v1, s[4:7], s46 offen lds
  s_add_u32 m0, s51, 61440
  s_add_u32 s46, s60, 1843200
  buffer_load_dwordx4 v1, s[4:7], s46 offen lds
  s_add_u32 m0, s51, 65536
  s_add_u32 s46, s60, 1843328
  buffer_load_dwordx4 v1, s[4:7], s46 offen lds
  s_add_u32 m0, s51, 69632
  s_add_u32 s46, s60, 1843456
  buffer_load_dwordx4 v1, s[4:7], s46 offen lds
  ds_read_b64_tr_b16 a[72:73], v3 offset:8192
  ds_read_b64_tr_b16 a[74:75], v3 offset:9216
  ds_read_b64_tr_b16 a[76:77], v3 offset:12288
  ds_read_b64_tr_b16 a[78:79], v3 offset:13312
  ds_read_b64_tr_b16 a[80:81], v3 offset:16384
  ds_read_b64_tr_b16 a[82:83], v3 offset:17408
  ds_read_b64_tr_b16 a[84:85], v3 offset:20480
  ds_read_b64_tr_b16 a[86:87], v3 offset:21504
  ds_read_b64_tr_b16 a[88:89], v3 offset:24576
  ds_read_b64_tr_b16 a[90:91], v3 offset:25600
  ds_read_b64_tr_b16 a[92:93], v3 offset:28672
  ds_read_b64_tr_b16 a[94:95], v3 offset:29696
  s_waitcnt lgkmcnt(0)
  s_waitcnt vmcnt(18)
  s_barrier
  s_add_u32 m0, s51, 73728
  s_add_u32 s46, s60, 1966080
  buffer_load_dwordx4 v1, s[4:7], s46 offen lds
  s_add_u32 m0, s51, 77824
  s_add_u32 s46, s60, 1966208
  buffer_load_dwordx4 v1, s[4:7], s46 offen lds
  s_add_u32 m0, s51, 81920
  s_add_u32 s46, s60, 1966336
  buffer_load_dwordx4 v1, s[4:7], s46 offen lds
  s_add_u32 m0, s51, 86016
  s_add_u32 s46, s60, 2088960
  buffer_load_dwordx4 v1, s[4:7], s46 offen lds
  s_add_u32 m0, s51, 90112
  s_add_u32 s46, s60, 2089088
  buffer_load_dwordx4 v1, s[4:7], s46 offen lds
  s_add_u32 m0, s51, 94208
  s_add_u32 s46, s60, 2089216
  buffer_load_dwordx4 v1, s[4:7], s46 offen lds
  ds_read_b64_tr_b16 a[96:97], v3 offset:32768
  ds_read_b64_tr_b16 a[98:99], v3 offset:33792
  ds_read_b64_tr_b16 a[100:101], v3 offset:36864
  ds_read_b64_tr_b16 a[102:103], v3 offset:37888
  ds_read_b64_tr_b16 a[104:105], v3 offset:40960
  ds_read_b64_tr_b16 a[106:107], v3 offset:41984
  ds_read_b64_tr_b16 a[108:109], v3 offset:45056
  ds_read_b64_tr_b16 a[110:111], v3 offset:46080
  ds_read_b64_tr_b16 a[112:113], v3 offset:49152
  ds_read_b64_tr_b16 a[114:115], v3 offset:50176
  ds_read_b64_tr_b16 a[116:117], v3 offset:53248
  ds_read_b64_tr_b16 a[118:119], v3 offset:54272
  s_waitcnt lgkmcnt(0)
  s_waitcnt vmcnt(18)
  s_barrier
  s_add_u32 m0, s51, 98304
  s_add_u32 s46, s60, 2211840
  buffer_load_dwordx4 v1, s[4:7], s46 offen lds
  s_add_u32 m0, s51, 102400
  s_add_u32 s46, s60, 2211968
  buffer_load_dwordx4 v1, s[4:7], s46 offen lds
  s_add_u32 m0, s51, 106496
  s_add_u32 s46, s60, 2212096
  buffer_load_dwordx4 v1, s[4:7], s46 offen lds
  s_add_u32 m0, s51, 110592
  s_add_u32 s46, s60, 2334720
  buffer_load_dwordx4 v1, s[4:7], s46 offen lds
  s_add_u32 m0, s51, 114688
  s_add_u32 s46, s60, 2334848
  buffer_load_dwordx4 v1, s[4:7], s46 offen lds
  s_add_u32 m0, s51, 118784
  s_add_u32 s46, s60, 2334976
  buffer_load_dwordx4 v1, s[4:7], s46 offen lds
  ds_read_b64_tr_b16 a[120:121], v2 offset:0
  ds_read_b64_tr_b16 a[122:123], v2 offset:1024
  ds_read_b64_tr_b16 a[124:125], v2 offset:4096
  ds_read_b64_tr_b16 a[126:127], v2 offset:5120
  ds_read_b64_tr_b16 a[128:129], v2 offset:8192
  ds_read_b64_tr_b16 a[130:131], v2 offset:9216
  ds_read_b64_tr_b16 a[132:133], v2 offset:12288
  ds_read_b64_tr_b16 a[134:135], v2 offset:13312
  ds_read_b64_tr_b16 a[136:137], v2 offset:16384
  ds_read_b64_tr_b16 a[138:139], v2 offset:17408
  ds_read_b64_tr_b16 a[140:141], v2 offset:20480
  ds_read_b64_tr_b16 a[142:143], v2 offset:21504
  s_waitcnt lgkmcnt(0)
  s_waitcnt vmcnt(18)
  s_barrier
  ds_read_b64_tr_b16 a[144:145], v2 offset:24576
  ds_read_b64_tr_b16 a[146:147], v2 offset:25600
  ds_read_b64_tr_b16 a[148:149], v2 offset:28672
  ds_read_b64_tr_b16 a[150:151], v2 offset:29696
  ds_read_b64_tr_b16 a[152:153], v2 offset:32768
  ds_read_b64_tr_b16 a[154:155], v2 offset:33792
  ds_read_b64_tr_b16 a[156:157], v2 offset:36864
  ds_read_b64_tr_b16 a[158:159], v2 offset:37888
  ds_read_b64_tr_b16 a[160:161], v2 offset:40960
  ds_read_b64_tr_b16 a[162:163], v2 offset:41984
  ds_read_b64_tr_b16 a[164:165], v2 offset:45056
  ds_read_b64_tr_b16 a[166:167], v2 offset:46080
  s_waitcnt lgkmcnt(0)
  s_waitcnt vmcnt(12)
  s_barrier
  ds_read_b64_tr_b16 a[168:169], v2 offset:49152
  ds_read_b64_tr_b16 a[170:171], v2 offset:50176
  ds_read_b64_tr_b16 a[172:173], v2 offset:53248
  ds_read_b64_tr_b16 a[174:175], v2 offset:54272
  ds_read_b64_tr_b16 a[176:177], v2 offset:57344
  ds_read_b64_tr_b16 a[178:179], v2 offset:58368
  ds_read_b64_tr_b16 a[180:181], v2 offset:61440
  ds_read_b64_tr_b16 a[182:183], v2 offset:62464
  ds_read_b64_tr_b16 a[184:185], v3 offset:0
  ds_read_b64_tr_b16 a[186:187], v3 offset:1024
  ds_read_b64_tr_b16 a[188:189], v3 offset:4096
  ds_read_b64_tr_b16 a[190:191], v3 offset:5120
  s_waitcnt lgkmcnt(0)
  s_waitcnt vmcnt(6)
  s_barrier
  ds_read_b64_tr_b16 a[192:193], v3 offset:8192
  ds_read_b64_tr_b16 a[194:195], v3 offset:9216
  ds_read_b64_tr_b16 a[196:197], v3 offset:12288
  ds_read_b64_tr_b16 a[198:199], v3 offset:13312
  ds_read_b64_tr_b16 a[200:201], v3 offset:16384
  ds_read_b64_tr_b16 a[202:203], v3 offset:17408
  ds_read_b64_tr_b16 a[204:205], v3 offset:20480
  ds_read_b64_tr_b16 a[206:207], v3 offset:21504
  ds_read_b64_tr_b16 a[208:209], v3 offset:24576
  ds_read_b64_tr_b16 a[210:211], v3 offset:25600
  ds_read_b64_tr_b16 a[212:213], v3 offset:28672
  ds_read_b64_tr_b16 a[214:215], v3 offset:29696
  s_waitcnt lgkmcnt(0)
  s_waitcnt vmcnt(0)
  s_barrier
  ds_read_b64_tr_b16 a[216:217], v3 offset:32768
  ds_read_b64_tr_b16 a[218:219], v3 offset:33792
  ds_read_b64_tr_b16 a[220:221], v3 offset:36864
  ds_read_b64_tr_b16 a[222:223], v3 offset:37888
  ds_read_b64_tr_b16 a[224:225], v3 offset:40960
  ds_read_b64_tr_b16 a[226:227], v3 offset:41984
  ds_read_b64_tr_b16 a[228:229], v3 offset:45056
  ds_read_b64_tr_b16 a[230:231], v3 offset:46080
  ds_read_b64_tr_b16 a[232:233], v3 offset:49152
  ds_read_b64_tr_b16 a[234:235], v3 offset:50176
  ds_read_b64_tr_b16 a[236:237], v3 offset:53248
  ds_read_b64_tr_b16 a[238:239], v3 offset:54272
  s_waitcnt lgkmcnt(0)
  s_barrier
  s_mov_b32 s54, s51
  s_add_u32 s53, s53, 40960
  s_add_u32 m0, s54, 0
  s_nop 0
  buffer_load_dwordx4 v5, s[12:15], s53 offen offset:0 lds
  s_add_u32 m0, s54, 3968
  s_nop 0
  buffer_load_dwordx4 v5, s[12:15], s53 offen offset:128 lds
  s_add_u32 m0, s54, 7936
  s_nop 0
  buffer_load_dwordx4 v5, s[12:15], s53 offen offset:256 lds
  s_add_u32 m0, s54, 11904
  s_nop 0
  buffer_load_dwordx4 v5, s[12:15], s53 offen offset:384 lds
  s_add_u32 m0, s54, 15872
  s_nop 0
  buffer_load_dwordx4 v5, s[12:15], s53 offen offset:512 lds
  s_add_u32 m0, s54, 19840
  s_nop 0
  buffer_load_dwordx4 v5, s[12:15], s53 offen offset:640 lds
  s_add_u32 m0, s54, 23808
  s_nop 0
  buffer_load_dwordx4 v5, s[12:15], s53 offen offset:768 lds
  s_add_u32 m0, s54, 27776
  s_nop 0
  buffer_load_dwordx4 v5, s[12:15], s53 offen offset:896 lds
  s_add_u32 m0, s54, 31744
  s_nop 0
  buffer_load_dwordx4 v5, s[12:15], s53 offen offset:1024 lds
  s_add_u32 m0, s54, 35712
  s_nop 0
  buffer_load_dwordx4 v5, s[12:15], s53 offen offset:1152 lds
  s_mov_b32 s55, 2146435072
  s_mov_b32 s56, 2146435072
  s_mov_b32 s57, 2146435072
  s_xor_b32 s63, s63, s3
  s_mov_b32 s58, 122880
  ds_read_b128 v[16:19], v6 offset:0
  ds_read_b128 v[20:23], v7 offset:0
  ds_read_b128 v[24:27], v6 offset:4096
  ds_read_b128 v[28:31], v7 offset:4096
  s_waitcnt lgkmcnt(3)
pa_loop_12:
  v_mfma_f32_16x16x32_bf16 v[40:43], a[0:3], v[16:19], 0
  ds_read_b128 v[32:35], v6 offset:8192
  v_mfma_f32_16x16x32_bf16 v[48:51], a[4:7], v[16:19], 0
  v_mfma_f32_16x16x32_bf16 v[56:59], a[8:11], v[16:19], 0
  s_waitcnt lgkmcnt(3)
  v_cvt_pk_bf16_f32 v66, v44, v45
  v_mfma_f32_16x16x32_bf16 v[40:43], a[12:15], v[20:23], v[40:43]
  ds_read_b128 v[16:19], v7 offset:8192
  v_cvt_pk_bf16_f32 v67, v46, v47
  v_mfma_f32_16x16x32_bf16 v[48:51], a[16:19], v[20:23], v[48:51]
  v_cvt_pk_bf16_f32 v70, v52, v53
  v_mfma_f32_16x16x32_bf16 v[56:59], a[20:23], v[20:23], v[56:59]
  s_waitcnt lgkmcnt(3)
  v_cvt_pk_bf16_f32 v71, v54, v55
  v_mfma_f32_16x16x32_bf16 v[40:43], a[24:27], v[24:27], v[40:43]
  ds_read_b128 v[20:23], v6 offset:12288
  v_cvt_pk_bf16_f32 v74, v60, v61
  v_mfma_f32_16x16x32_bf16 v[48:51], a[28:31], v[24:27], v[48:51]
  v_cvt_pk_bf16_f32 v75, v62, v63
  v_mfma_f32_16x16x32_bf16 v[56:59], a[32:35], v[24:27], v[56:59]
  s_waitcnt lgkmcnt(3)
  v_mfma_f32_16x16x32_bf16 v[40:43], a[36:39], v[28:31], v[40:43]
  ds_read_b128 v[24:27], v7 offset:12288
  v_permlane16_swap_b32 v64, v66
  v_mfma_f32_16x16x32_bf16 v[48:51], a[40:43], v[28:31], v[48:51]
  v_permlane16_swap_b32 v65, v67
  v_mfma_f32_16x16x32_bf16 v[56:59], a[44:47], v[28:31], v[56:59]
  buffer_store_dwordx4 v[64:67], v8, s[8:11], s55 offen sc1
  s_waitcnt lgkmcnt(3)
  v_mfma_f32_16x16x32_bf16 v[40:43], a[48:51], v[32:35], v[40:43]
  ds_read_b128 v[28:31], v6 offset:16384
  v_permlane16_swap_b32 v68, v70
  v_mfma_f32_16x16x32_bf16 v[48:51], a[52:55], v[32:35], v[48:51]
  v_permlane16_swap_b32 v69, v71
  v_mfma_f32_16x16x32_bf16 v[56:59], a[56:59], v[32:35], v[56:59]
  buffer_store_dwordx4 v[68:71], v8, s[8:11], s56 offen sc1
  s_waitcnt lgkmcnt(3)
  v_mfma_f32_16x16x32_bf16 v[40:43], a[60:63], v[16:19], v[40:43]
  ds_read_b128 v[32:35], v7 offset:16384
  v_permlane16_swap_b32 v72, v74
  v_mfma_f32_16x16x32_bf16 v[48:51], a[64:67], v[16:19], v[48:51]
  v_permlane16_swap_b32 v73, v75
  v_mfma_f32_16x16x32_bf16 v[56:59], a[68:71], v[16:19], v[56:59]
  buffer_store_dwordx4 v[72:75], v8, s[8:11], s57 offen sc1
  s_waitcnt lgkmcnt(3)
  v_mfma_f32_16x16x32_bf16 v[40:43], a[72:75], v[20:23], v[40:43]
  ds_read_b128 v[16:19], v6 offset:20480
  v_mfma_f32_16x16x32_bf16 v[48:51], a[76:79], v[20:23], v[48:51]
  v_mfma_f32_16x16x32_bf16 v[56:59], a[80:83], v[20:23], v[56:59]
  s_waitcnt lgkmcnt(3)
  v_mfma_f32_16x16x32_bf16 v[40:43], a[84:87], v[24:27], v[40:43]
  ds_read_b128 v[20:23], v7 offset:20480
  v_mfma_f32_16x16x32_bf16 v[48:51], a[88:91], v[24:27], v[48:51]
  v_mov_b32 v10, s52
  v_mfma_f32_16x16x32_bf16 v[56:59], a[92:95], v[24:27], v[56:59]
  s_waitcnt lgkmcnt(3)
  v_mfma_f32_16x16x32_bf16 v[40:43], a[96:99], v[28:31], v[40:43]
  ds_read_b128 v[24:27], v6 offset:24576
  v_mfma_f32_16x16x32_bf16 v[48:51], a[100:103], v[28:31], v[48:51]
  s_add_u32 s53, s53, 40960
  s_add_u32 s54, s54, 40960
  v_mfma_f32_16x16x32_bf16 v[56:59], a[104:107], v[28:31], v[56:59]
  s_waitcnt lgkmcnt(3)
  v_mfma_f32_16x16x32_bf16 v[40:43], a[108:111], v[32:35], v[40:43]
  ds_read_b128 v[28:31], v7 offset:24576
  v_mfma_f32_16x16x32_bf16 v[48:51], a[112:115], v[32:35], v[48:51]
  s_cmp_ge_u32 s54, 163840
  s_cselect_b32 s54, s51, s54
  v_mfma_f32_16x16x32_bf16 v[56:59], a[116:119], v[32:35], v[56:59]
  s_waitcnt lgkmcnt(3)
  v_mfma_f32_16x16x32_bf16 v[40:43], a[120:123], v[16:19], v[40:43]
  ds_read_b128 v[32:35], v6 offset:28672
  v_mfma_f32_16x16x32_bf16 v[48:51], a[124:127], v[16:19], v[48:51]
  s_cmp_eq_u32 s58, 122880
  s_cselect_b32 s59, 163840, 0
  v_mfma_f32_16x16x32_bf16 v[56:59], a[128:131], v[16:19], v[56:59]
  s_waitcnt lgkmcnt(3)
  v_mfma_f32_16x16x32_bf16 v[40:43], a[132:135], v[20:23], v[40:43]
  ds_read_b128 v[16:19], v7 offset:28672
  v_mfma_f32_16x16x32_bf16 v[48:51], a[136:139], v[20:23], v[48:51]
  s_sub_u32 s59, 40960, s59
  s_add_u32 s58, s58, s59
  v_mfma_f32_16x16x32_bf16 v[56:59], a[140:143], v[20:23], v[56:59]
  s_waitcnt lgkmcnt(3)
  v_mfma_f32_16x16x32_bf16 v[40:43], a[144:147], v[24:27], v[40:43]
  ds_read_b128 v[20:23], v6 offset:32768
  v_mfma_f32_16x16x32_bf16 v[48:51], a[148:151], v[24:27], v[48:51]
  s_lshr_b32 s55, s67, 1
  v_mfma_f32_16x16x32_bf16 v[56:59], a[152:155], v[24:27], v[56:59]
  s_lshl_b32 s55, s55, 14
  s_waitcnt lgkmcnt(3)
  v_mfma_f32_16x16x32_bf16 v[40:43], a[156:159], v[28:31], v[40:43]
  ds_read_b128 v[24:27], v7 offset:32768
  v_mfma_f32_16x16x32_bf16 v[48:51], a[160:163], v[28:31], v[48:51]
  s_and_b32 s56, s67, 1
  v_mfma_f32_16x16x32_bf16 v[56:59], a[164:167], v[28:31], v[56:59]
  s_lshl_b32 s56, s56, 12
  s_waitcnt lgkmcnt(3)
  v_mfma_f32_16x16x32_bf16 v[40:43], a[168:171], v[32:35], v[40:43]
  ds_read_b128 v[28:31], v6 offset:36864
  v_mfma_f32_16x16x32_bf16 v[48:51], a[172:175], v[32:35], v[48:51]
  s_add_u32 s55, s55, s56
  v_mfma_f32_16x16x32_bf16 v[56:59], a[176:179], v[32:35], v[56:59]
  s_add_u32 s55, s55, s63
  s_waitcnt lgkmcnt(3)
  v_mfma_f32_16x16x32_bf16 v[40:43], a[180:183], v[16:19], v[40:43]
  ds_read_b128 v[32:35], v7 offset:36864
  v_mfma_f32_16x16x32_bf16 v[48:51], a[184:187], v[16:19], v[48:51]
  s_lshr_b32 s56, s55, 8
  v_mfma_f32_16x16x32_bf16 v[56:59], a[188:191], v[16:19], v[56:59]
  s_and_b32 s56, s56, 0x2000
  s_waitcnt lgkmcnt(3)
  v_mfma_f32_16x16x32_bf16 v[40:43], a[192:195], v[20:23], v[40:43]
  ds_read_b128 v[16:19], v6 offset:2048
  v_mfma_f32_16x16x32_bf16 v[48:51], a[196:199], v[20:23], v[48:51]
  s_xor_b32 s55, s55, s56
  v_mfma_f32_16x16x32_bf16 v[56:59], a[200:203], v[20:23], v[56:59]
  s_add_u32 s67, s67, 1
  s_waitcnt lgkmcnt(3)
  v_mfma_f32_16x16x32_bf16 v[40:43], a[204:207], v[24:27], v[40:43]
  ds_read_b128 v[20:23], v7 offset:2048
  v_mfma_f32_16x16x32_bf16 v[48:51], a[208:211], v[24:27], v[48:51]
  s_add_u32 s56, s55, 16777216
  v_mfma_f32_16x16x32_bf16 v[56:59], a[212:215], v[24:27], v[56:59]
  s_add_u32 s57, s55, 33554432
  s_waitcnt lgkmcnt(3)
  v_mfma_f32_16x16x32_bf16 v[40:43], a[216:219], v[28:31], v[40:43]
  ds_read_b128 v[24:27], v6 offset:6144
  v_mfma_f32_16x16x32_bf16 v[48:51], a[220:223], v[28:31], v[48:51]
  v_mfma_f32_16x16x32_bf16 v[56:59], a[224:227], v[28:31], v[56:59]
  s_waitcnt lgkmcnt(3)
  v_mfma_f32_16x16x32_bf16 v[40:43], a[228:231], v[32:35], v[40:43]
  ds_read_b128 v[28:31], v7 offset:6144
  v_mfma_f32_16x16x32_bf16 v[48:51], a[232:235], v[32:35], v[48:51]
  v_mfma_f32_16x16x32_bf16 v[56:59], a[236:239], v[32:35], v[56:59]
  s_waitcnt lgkmcnt(3)
  v_mfma_f32_16x16x32_bf16 v[44:47], a[0:3], v[16:19], 0
  ds_read_b128 v[32:35], v6 offset:10240
  v_mfma_f32_16x16x32_bf16 v[52:55], a[4:7], v[16:19], 0
  v_mfma_f32_16x16x32_bf16 v[60:63], a[8:11], v[16:19], 0
  s_waitcnt lgkmcnt(3)
  v_cvt_pk_bf16_f32 v64, v40, v41
  v_mfma_f32_16x16x32_bf16 v[44:47], a[12:15], v[20:23], v[44:47]
  ds_read_b128 v[16:19], v7 offset:10240
  v_cvt_pk_bf16_f32 v65, v42, v43
  v_mfma_f32_16x16x32_bf16 v[52:55], a[16:19], v[20:23], v[52:55]
  v_cvt_pk_bf16_f32 v68, v48, v49
  v_mfma_f32_16x16x32_bf16 v[60:63], a[20:23], v[20:23], v[60:63]
  s_waitcnt lgkmcnt(3)
  v_cvt_pk_bf16_f32 v69, v50, v51
  v_mfma_f32_16x16x32_bf16 v[44:47], a[24:27], v[24:27], v[44:47]
  ds_read_b128 v[20:23], v6 offset:14336
  v_cvt_pk_bf16_f32 v72, v56, v57
  v_mfma_f32_16x16x32_bf16 v[52:55], a[28:31], v[24:27], v[52:55]
  v_cvt_pk_bf16_f32 v73, v58, v59
  v_mfma_f32_16x16x32_bf16 v[60:63], a[32:35], v[24:27], v[60:63]
  s_waitcnt lgkmcnt(3)
  v_mfma_f32_16x16x32_bf16 v[44:47], a[36:39], v[28:31], v[44:47]
  ds_read_b128 v[24:27], v7 offset:14336
  v_mfma_f32_16x16x32_bf16 v[52:55], a[40:43], v[28:31], v[52:55]
  s_waitcnt vmcnt(0)
  s_barrier
  v_mfma_f32_16x16x32_bf16 v[60:63], a[44:47], v[28:31], v[60:63]
  buffer_store_dword v10, v9, s[8:11], 0 offen sc1
  s_waitcnt lgkmcnt(3)
  v_mfma_f32_16x16x32_bf16 v[44:47], a[48:51], v[32:35], v[44:47]
  ds_read_b128 v[28:31], v6 offset:18432
  s_add_u32 m0, s54, 0
  v_mfma_f32_16x16x32_bf16 v[52:55], a[52:55], v[32:35], v[52:55]
  buffer_load_dwordx4 v5, s[12:15], s53 offen offset:0 lds
  v_mfma_f32_16x16x32_bf16 v[60:63], a[56:59], v[32:35], v[60:63]
  s_waitcnt lgkmcnt(3)
  v_mfma_f32_16x16x32_bf16 v[44:47], a[60:63], v[16:19], v[44:47]
  ds_read_b128 v[32:35], v7 offset:18432
  s_add_u32 m0, s54, 3968
  v_mfma_f32_16x16x32_bf16 v[52:55], a[64:67], v[16:19], v[52:55]
  buffer_load_dwordx4 v5, s[12:15], s53 offen offset:128 lds
  v_mfma_f32_16x16x32_bf16 v[60:63], a[68:71], v[16:19], v[60:63]
  s_waitcnt lgkmcnt(3)
  v_mfma_f32_16x16x32_bf16 v[44:47], a[72:75], v[20:23], v[44:47]
  ds_read_b128 v[16:19], v6 offset:22528
  s_add_u32 m0, s54, 7936
  v_mfma_f32_16x16x32_bf16 v[52:55], a[76:79], v[20:23], v[52:55]
  buffer_load_dwordx4 v5, s[12:15], s53 offen offset:256 lds
  v_mfma_f32_16x16x32_bf16 v[60:63], a[80:83], v[20:23], v[60:63]
  s_waitcnt lgkmcnt(3)
  v_mfma_f32_16x16x32_bf16 v[44:47], a[84:87], v[24:27], v[44:47]
  ds_read_b128 v[20:23], v7 offset:22528
  s_add_u32 m0, s54, 11904
  v_mfma_f32_16x16x32_bf16 v[52:55], a[88:91], v[24:27], v[52:55]
  buffer_load_dwordx4 v5, s[12:15], s53 offen offset:384 lds
  v_mfma_f32_16x16x32_bf16 v[60:63], a[92:95], v[24:27], v[60:63]
  s_waitcnt lgkmcnt(3)
  v_mfma_f32_16x16x32_bf16 v[44:47], a[96:99], v[28:31], v[44:47]
  ds_read_b128 v[24:27], v6 offset:26624
  s_add_u32 m0, s54, 15872
  v_mfma_f32_16x16x32_bf16 v[52:55], a[100:103], v[28:31], v[52:55]
  buffer_load_dwordx4 v5, s[12:15], s53 offen offset:512 lds
  v_mfma_f32_16x16x32_bf16 v[60:63], a[104:107], v[28:31], v[60:63]
  s_waitcnt lgkmcnt(3)
  v_mfma_f32_16x16x32_bf16 v[44:47], a[108:111], v[32:35], v[44:47]
  ds_read_b128 v[28:31], v7 offset:26624
  s_add_u32 m0, s54, 19840
  v_mfma_f32_16x16x32_bf16 v[52:55], a[112:115], v[32:35], v[52:55]
  buffer_load_dwordx4 v5, s[12:15], s53 offen offset:640 lds
  v_mfma_f32_16x16x32_bf16 v[60:63], a[116:119], v[32:35], v[60:63]
  s_waitcnt lgkmcnt(3)
  v_mfma_f32_16x16x32_bf16 v[44:47], a[120:123], v[16:19], v[44:47]
  ds_read_b128 v[32:35], v6 offset:30720
  s_add_u32 m0, s54, 23808
  v_mfma_f32_16x16x32_bf16 v[52:55], a[124:127], v[16:19], v[52:55]
  buffer_load_dwordx4 v5, s[12:15], s53 offen offset:768 lds
  v_mfma_f32_16x16x32_bf16 v[60:63], a[128:131], v[16:19], v[60:63]
  s_waitcnt lgkmcnt(3)
  v_mfma_f32_16x16x32_bf16 v[44:47], a[132:135], v[20:23], v[44:47]
  ds_read_b128 v[16:19], v7 offset:30720
  s_add_u32 m0, s54, 27776
  v_mfma_f32_16x16x32_bf16 v[52:55], a[136:139], v[20:23], v[52:55]
  buffer_load_dwordx4 v5, s[12:15], s53 offen offset:896 lds
  v_mfma_f32_16x16x32_bf16 v[60:63], a[140:143], v[20:23], v[60:63]
  s_waitcnt lgkmcnt(3)
  v_mfma_f32_16x16x32_bf16 v[44:47], a[144:147], v[24:27], v[44:47]
  ds_read_b128 v[20:23], v6 offset:34816
  s_add_u32 m0, s54, 31744
  v_mfma_f32_16x16x32_bf16 v[52:55], a[148:151], v[24:27], v[52:55]
  buffer_load_dwordx4 v5, s[12:15], s53 offen offset:1024 lds
  v_mfma_f32_16x16x32_bf16 v[60:63], a[152:155], v[24:27], v[60:63]
  s_waitcnt lgkmcnt(3)
  v_mfma_f32_16x16x32_bf16 v[44:47], a[156:159], v[28:31], v[44:47]
  ds_read_b128 v[24:27], v7 offset:34816
  s_add_u32 m0, s54, 35712
  v_mfma_f32_16x16x32_bf16 v[52:55], a[160:163], v[28:31], v[52:55]
  buffer_load_dwordx4 v5, s[12:15], s53 offen offset:1152 lds
  v_mfma_f32_16x16x32_bf16 v[60:63], a[164:167], v[28:31], v[60:63]
  s_waitcnt lgkmcnt(3)
  v_mfma_f32_16x16x32_bf16 v[44:47], a[168:171], v[32:35], v[44:47]
  ds_read_b128 v[28:31], v6 offset:38912
  v_mfma_f32_16x16x32_bf16 v[52:55], a[172:175], v[32:35], v[52:55]
  v_mfma_f32_16x16x32_bf16 v[60:63], a[176:179], v[32:35], v[60:63]
  s_waitcnt lgkmcnt(3)
  v_mfma_f32_16x16x32_bf16 v[44:47], a[180:183], v[16:19], v[44:47]
  ds_read_b128 v[32:35], v7 offset:38912
  v_mfma_f32_16x16x32_bf16 v[52:55], a[184:187], v[16:19], v[52:55]
  v_add_u32 v6, s59, v6
  v_add_u32 v7, s59, v7
  v_mfma_f32_16x16x32_bf16 v[60:63], a[188:191], v[16:19], v[60:63]
  s_waitcnt lgkmcnt(3)
  v_mfma_f32_16x16x32_bf16 v[44:47], a[192:195], v[20:23], v[44:47]
  ds_read_b128 v[16:19], v6 offset:0
  v_mfma_f32_16x16x32_bf16 v[52:55], a[196:199], v[20:23], v[52:55]
  v_mfma_f32_16x16x32_bf16 v[60:63], a[200:203], v[20:23], v[60:63]
  s_waitcnt lgkmcnt(3)
  v_mfma_f32_16x16x32_bf16 v[44:47], a[204:207], v[24:27], v[44:47]
  ds_read_b128 v[20:23], v7 offset:0
  v_mfma_f32_16x16x32_bf16 v[52:55], a[208:211], v[24:27], v[52:55]
  s_add_u32 s52, s52, 1
  v_mfma_f32_16x16x32_bf16 v[60:63], a[212:215], v[24:27], v[60:63]
  s_waitcnt lgkmcnt(3)
  v_mfma_f32_16x16x32_bf16 v[44:47], a[216:219], v[28:31], v[44:47]
  ds_read_b128 v[24:27], v6 offset:4096
  v_mfma_f32_16x16x32_bf16 v[52:55], a[220:223], v[28:31], v[52:55]
  v_mfma_f32_16x16x32_bf16 v[60:63], a[224:227], v[28:31], v[60:63]
  s_waitcnt lgkmcnt(3)
  v_mfma_f32_16x16x32_bf16 v[44:47], a[228:231], v[32:35], v[44:47]
  ds_read_b128 v[28:31], v7 offset:4096
  v_mfma_f32_16x16x32_bf16 v[52:55], a[232:235], v[32:35], v[52:55]
  s_cmp_lt_u32 s52, s62
  v_mfma_f32_16x16x32_bf16 v[60:63], a[236:239], v[32:35], v[60:63]
  s_waitcnt lgkmcnt(3)
  s_cbranch_scc1 pa_loop_12
  v_cvt_pk_bf16_f32 v66, v44, v45
  v_cvt_pk_bf16_f32 v67, v46, v47
  s_nop 1
  v_cvt_pk_bf16_f32 v70, v52, v53
  v_cvt_pk_bf16_f32 v71, v54, v55
  v_cvt_pk_bf16_f32 v74, v60, v61
  v_cvt_pk_bf16_f32 v75, v62, v63
  v_permlane16_swap_b32 v64, v66
  v_permlane16_swap_b32 v65, v67
  v_permlane16_swap_b32 v68, v70
  v_permlane16_swap_b32 v69, v71
  v_permlane16_swap_b32 v72, v74
  v_permlane16_swap_b32 v73, v75
  buffer_store_dwordx4 v[64:67], v8, s[8:11], s55 offen sc1
  buffer_store_dwordx4 v[68:71], v8, s[8:11], s56 offen sc1
  buffer_store_dwordx4 v[72:75], v8, s[8:11], s57 offen sc1
  v_mov_b32 v10, s52
  s_waitcnt vmcnt(0) lgkmcnt(0)
  s_barrier
  buffer_store_dword v10, v9, s[8:11], 0 offen sc1
pa_att:
  v_min_u32 v1, 19, v0
  v_cmp_lt_u32 vcc, 9, v1
  s_lshl_b32 s46, s65, 4
  s_max_u32 s47, s46, 14
  s_sub_u32 s47, s47, 14
  s_lshr_b32 s47, s47, 5
  s_lshr_b32 s48, s46, 5
  v_mov_b32 v2, s47
  v_mov_b32 v3, s48
  v_cndmask_b32 v2, v2, v3, vcc
  v_subrev_u32 v3, 10, v1
  v_cndmask_b32 v1, v1, v3, vcc
  v_mul_u32_u24 v3, 171, v2
  v_lshrrev_b32 v3, 10, v3
  v_max_u32 v4, 28, v2
  v_subrev_u32 v4, 28, v4
  v_mul_u32_u24 v4, 171, v4
  v_lshrrev_b32 v4, 9, v4
  v_max_u32 v3, v3, v4
  v_mul_u32_u24 v3, 10, v3
  v_add_u32 v1, v1, v3
  v_lshlrev_b32 v1, 7, v1
  v_add_u32 v1, 1081344, v1
  v_lshrrev_b32 v3, 4, v0
  s_lshl_b32 s47, s42, 2
  v_add_u32 v3, s47, v3
  v_mul_u32_u24 v3, 5, v3
  s_xor_b32 s47, s3, 132128768
  v_add_u32 v8, 0, v3
  v_mul_u32_u24 v4, 171, v8
  v_lshrrev_b32 v4, 12, v4
  v_mul_u32_u24 v5, 3, v4
  v_lshrrev_b32 v6, 3, v8
  v_sub_u32 v5, v6, v5
  v_and_b32 v8, 7, v8
  v_lshl_add_u32 v8, v8, 8, s47
  v_lshl_add_u32 v8, v4, 19, v8
  v_lshl_add_u32 v8, v5, 24, v8
  v_lshrrev_b32 v4, 8, v8
  v_and_b32 v4, 0x2000, v4
  v_xor_b32 v8, v8, v4
  v_add_u32 v9, 1, v3
  v_mul_u32_u24 v4, 171, v9
  v_lshrrev_b32 v4, 12, v4
  v_mul_u32_u24 v5, 3, v4
  v_lshrrev_b32 v6, 3, v9
  v_sub_u32 v5, v6, v5
  v_and_b32 v9, 7, v9
  v_lshl_add_u32 v9, v9, 8, s47
  v_lshl_add_u32 v9, v4, 19, v9
  v_lshl_add_u32 v9, v5, 24, v9
  v_lshrrev_b32 v4, 8, v9
  v_and_b32 v4, 0x2000, v4
  v_xor_b32 v9, v9, v4
  v_add_u32 v10, 2, v3
  v_mul_u32_u24 v4, 171, v10
  v_lshrrev_b32 v4, 12, v4
  v_mul_u32_u24 v5, 3, v4
  v_lshrrev_b32 v6, 3, v10
  v_sub_u32 v5, v6, v5
  v_and_b32 v10, 7, v10
  v_lshl_add_u32 v10, v10, 8, s47
  v_lshl_add_u32 v10, v4, 19, v10
  v_lshl_add_u32 v10, v5, 24, v10
  v_lshrrev_b32 v4, 8, v10
  v_and_b32 v4, 0x2000, v4
  v_xor_b32 v10, v10, v4
  v_add_u32 v11, 3, v3
  v_mul_u32_u24 v4, 171, v11
  v_lshrrev_b32 v4, 12, v4
  v_mul_u32_u24 v5, 3, v4
  v_lshrrev_b32 v6, 3, v11
  v_sub_u32 v5, v6, v5
  v_and_b32 v11, 7, v11
  v_lshl_add_u32 v11, v11, 8, s47
  v_lshl_add_u32 v11, v4, 19, v11
  v_lshl_add_u32 v11, v5, 24, v11
  v_lshrrev_b32 v4, 8, v11
  v_and_b32 v4, 0x2000, v4
  v_xor_b32 v11, v11, v4
  v_add_u32 v12, 4, v3
  v_mul_u32_u24 v4, 171, v12
  v_lshrrev_b32 v4, 12, v4
  v_mul_u32_u24 v5, 3, v4
  v_lshrrev_b32 v6, 3, v12
  v_sub_u32 v5, v6, v5
  v_and_b32 v12, 7, v12
  v_lshl_add_u32 v12, v12, 8, s47
  v_lshl_add_u32 v12, v4, 19, v12
  v_lshl_add_u32 v12, v5, 24, v12
  v_lshrrev_b32 v4, 8, v12
  v_and_b32 v4, 0x2000, v4
  v_xor_b32 v12, v12, v4
  v_add_u32 v13, 80, v3
  v_mul_u32_u24 v4, 171, v13
  v_lshrrev_b32 v4, 12, v4
  v_mul_u32_u24 v5, 3, v4
  v_lshrrev_b32 v6, 3, v13
  v_sub_u32 v5, v6, v5
  v_and_b32 v13, 7, v13
  v_lshl_add_u32 v13, v13, 8, s47
  v_lshl_add_u32 v13, v4, 19, v13
  v_lshl_add_u32 v13, v5, 24, v13
  v_lshrrev_b32 v4, 8, v13
  v_and_b32 v4, 0x2000, v4
  v_xor_b32 v13, v13, v4
  v_add_u32 v14, 81, v3
  v_mul_u32_u24 v4, 171, v14
  v_lshrrev_b32 v4, 12, v4
  v_mul_u32_u24 v5, 3, v4
  v_lshrrev_b32 v6, 3, v14
  v_sub_u32 v5, v6, v5
  v_and_b32 v14, 7, v14
  v_lshl_add_u32 v14, v14, 8, s47
  v_lshl_add_u32 v14, v4, 19, v14
  v_lshl_add_u32 v14, v5, 24, v14
  v_lshrrev_b32 v4, 8, v14
  v_and_b32 v4, 0x2000, v4
  v_xor_b32 v14, v14, v4
  v_add_u32 v15, 82, v3
  v_mul_u32_u24 v4, 171, v15
  v_lshrrev_b32 v4, 12, v4
  v_mul_u32_u24 v5, 3, v4
  v_lshrrev_b32 v6, 3, v15
  v_sub_u32 v5, v6, v5
  v_and_b32 v15, 7, v15
  v_lshl_add_u32 v15, v15, 8, s47
  v_lshl_add_u32 v15, v4, 19, v15
  v_lshl_add_u32 v15, v5, 24, v15
  v_lshrrev_b32 v4, 8, v15
  v_and_b32 v4, 0x2000, v4
  v_xor_b32 v15, v15, v4
  v_add_u32 v16, 83, v3
  v_mul_u32_u24 v4, 171, v16
  v_lshrrev_b32 v4, 12, v4
  v_mul_u32_u24 v5, 3, v4
  v_lshrrev_b32 v6, 3, v16
  v_sub_u32 v5, v6, v5
  v_and_b32 v16, 7, v16
  v_lshl_add_u32 v16, v16, 8, s47
  v_lshl_add_u32 v16, v4, 19, v16
  v_lshl_add_u32 v16, v5, 24, v16
  v_lshrrev_b32 v4, 8, v16
  v_and_b32 v4, 0x2000, v4
  v_xor_b32 v16, v16, v4
  v_add_u32 v17, 84, v3
  v_mul_u32_u24 v4, 171, v17
  v_lshrrev_b32 v4, 12, v4
  v_mul_u32_u24 v5, 3, v4
  v_lshrrev_b32 v6, 3, v17
  v_sub_u32 v5, v6, v5
  v_and_b32 v17, 7, v17
  v_lshl_add_u32 v17, v17, 8, s47
  v_lshl_add_u32 v17, v4, 19, v17
  v_lshl_add_u32 v17, v5, 24, v17
  v_lshrrev_b32 v4, 8, v17
  v_and_b32 v4, 0x2000, v4
  v_xor_b32 v17, v17, v4
  v_add_u32 v18, 160, v3
  v_mul_u32_u24 v4, 171, v18
  v_lshrrev_b32 v4, 12, v4
  v_mul_u32_u24 v5, 3, v4
  v_lshrrev_b32 v6, 3, v18
  v_sub_u32 v5, v6, v5
  v_and_b32 v18, 7, v18
  v_lshl_add_u32 v18, v18, 8, s47
  v_lshl_add_u32 v18, v4, 19, v18
  v_lshl_add_u32 v18, v5, 24, v18
  v_lshrrev_b32 v4, 8, v18
  v_and_b32 v4, 0x2000, v4
  v_xor_b32 v18, v18, v4
  v_add_u32 v19, 161, v3
  v_mul_u32_u24 v4, 171, v19
  v_lshrrev_b32 v4, 12, v4
  v_mul_u32_u24 v5, 3, v4
  v_lshrrev_b32 v6, 3, v19
  v_sub_u32 v5, v6, v5
  v_and_b32 v19, 7, v19
  v_lshl_add_u32 v19, v19, 8, s47
  v_lshl_add_u32 v19, v4, 19, v19
  v_lshl_add_u32 v19, v5, 24, v19
  v_lshrrev_b32 v4, 8, v19
  v_and_b32 v4, 0x2000, v4
  v_xor_b32 v19, v19, v4
  v_add_u32 v20, 162, v3
  v_mul_u32_u24 v4, 171, v20
  v_lshrrev_b32 v4, 12, v4
  v_mul_u32_u24 v5, 3, v4
  v_lshrrev_b32 v6, 3, v20
  v_sub_u32 v5, v6, v5
  v_and_b32 v20, 7, v20
  v_lshl_add_u32 v20, v20, 8, s47
  v_lshl_add_u32 v20, v4, 19, v20
  v_lshl_add_u32 v20, v5, 24, v20
  v_lshrrev_b32 v4, 8, v20
  v_and_b32 v4, 0x2000, v4
  v_xor_b32 v20, v20, v4
  v_add_u32 v21, 163, v3
  v_mul_u32_u24 v4, 171, v21
  v_lshrrev_b32 v4, 12, v4
  v_mul_u32_u24 v5, 3, v4
  v_lshrrev_b32 v6, 3, v21
  v_sub_u32 v5, v6, v5
  v_and_b32 v21, 7, v21
  v_lshl_add_u32 v21, v21, 8, s47
  v_lshl_add_u32 v21, v4, 19, v21
  v_lshl_add_u32 v21, v5, 24, v21
  v_lshrrev_b32 v4, 8, v21
  v_and_b32 v4, 0x2000, v4
  v_xor_b32 v21, v21, v4
  v_add_u32 v22, 164, v3
  v_mul_u32_u24 v4, 171, v22
  v_lshrrev_b32 v4, 12, v4
  v_mul_u32_u24 v5, 3, v4
  v_lshrrev_b32 v6, 3, v22
  v_sub_u32 v5, v6, v5
  v_and_b32 v22, 7, v22
  v_lshl_add_u32 v22, v22, 8, s47
  v_lshl_add_u32 v22, v4, 19, v22
  v_lshl_add_u32 v22, v5, 24, v22
  v_lshrrev_b32 v4, 8, v22
  v_and_b32 v4, 0x2000, v4
  v_xor_b32 v22, v22, v4
  v_and_b32 v5, 15, v0
  v_add_u32 v6, s46, v5
  v_subrev_u32 v4, 0, v6
  v_max_i32 v4, 0, v4
  v_and_b32 v23, 15, v4
  v_lshlrev_b32 v23, 4, v23
  v_bfe_u32 v7, v4, 4, 2
  v_lshl_add_u32 v23, v7, 11, v23
  v_lshrrev_b32 v4, 6, v4
  v_lshl_add_u32 v23, v4, 14, v23
  v_cmp_gt_u32 s[72:73], 0, v6
  v_subrev_u32 v4, 2, v6
  v_max_i32 v4, 0, v4
  v_and_b32 v24, 15, v4
  v_lshlrev_b32 v24, 4, v24
  v_bfe_u32 v7, v4, 4, 2
  v_lshl_add_u32 v24, v7, 11, v24
  v_lshrrev_b32 v4, 6, v4
  v_lshl_add_u32 v24, v4, 14, v24
  v_cmp_gt_u32 s[74:75], 2, v6
  v_subrev_u32 v4, 4, v6
  v_max_i32 v4, 0, v4
  v_and_b32 v25, 15, v4
  v_lshlrev_b32 v25, 4, v25
  v_bfe_u32 v7, v4, 4, 2
  v_lshl_add_u32 v25, v7, 11, v25
  v_lshrrev_b32 v4, 6, v4
  v_lshl_add_u32 v25, v4, 14, v25
  v_cmp_gt_u32 s[76:77], 4, v6
  v_subrev_u32 v4, 6, v6
  v_max_i32 v4, 0, v4
  v_and_b32 v26, 15, v4
  v_lshlrev_b32 v26, 4, v26
  v_bfe_u32 v7, v4, 4, 2
  v_lshl_add_u32 v26, v7, 11, v26
  v_lshrrev_b32 v4, 6, v4
  v_lshl_add_u32 v26, v4, 14, v26
  v_cmp_gt_u32 s[78:79], 6, v6
  v_subrev_u32 v4, 8, v6
  v_max_i32 v4, 0, v4
  v_and_b32 v27, 15, v4
  v_lshlrev_b32 v27, 4, v27
  v_bfe_u32 v7, v4, 4, 2
  v_lshl_add_u32 v27, v7, 11, v27
  v_lshrrev_b32 v4, 6, v4
  v_lshl_add_u32 v27, v4, 14, v27
  v_cmp_gt_u32 s[80:81], 8, v6
  v_subrev_u32 v4, 10, v6
  v_max_i32 v4, 0, v4
  v_and_b32 v28, 15, v4
  v_lshlrev_b32 v28, 4, v28
  v_bfe_u32 v7, v4, 4, 2
  v_lshl_add_u32 v28, v7, 11, v28
  v_lshrrev_b32 v4, 6, v4
  v_lshl_add_u32 v28, v4, 14, v28
  v_cmp_gt_u32 s[82:83], 10, v6
  v_subrev_u32 v4, 12, v6
  v_max_i32 v4, 0, v4
  v_and_b32 v29, 15, v4
  v_lshlrev_b32 v29, 4, v29
  v_bfe_u32 v7, v4, 4, 2
  v_lshl_add_u32 v29, v7, 11, v29
  v_lshrrev_b32 v4, 6, v4
  v_lshl_add_u32 v29, v4, 14, v29
  v_cmp_gt_u32 s[84:85], 12, v6
  v_subrev_u32 v4, 14, v6
  v_max_i32 v4, 0, v4
  v_and_b32 v30, 15, v4
  v_lshlrev_b32 v30, 4, v30
  v_bfe_u32 v7, v4, 4, 2
  v_lshl_add_u32 v30, v7, 11, v30
  v_lshrrev_b32 v4, 6, v4
  v_lshl_add_u32 v30, v4, 14, v30
  v_cmp_gt_u32 s[86:87], 14, v6
  s_mov_b32 s50, 0
  s_mov_b32 s66, 0
pa_wait:
  buffer_load_dword v4, v1, s[8:11], 0 offen sc1
  s_add_u32 s50, s50, 1
  s_cmp_gt_u32 s50, 131072
  s_cbranch_scc1 L_fail
  s_waitcnt vmcnt(0)
  v_cmp_le_u32 vcc, v4, v2
  s_cbranch_vccnz pa_wait
  v_add_u32 v232, v8, v23
  buffer_load_dwordx4 v[32:35], v232, s[8:11], s66 offen sc1
  v_add_u32 v233, v9, v23
  buffer_load_dwordx4 v[36:39], v233, s[8:11], s66 offen sc1
  v_add_u32 v234, v10, v23
  buffer_load_dwordx4 v[40:43], v234, s[8:11], s66 offen sc1
  v_add_u32 v235, v11, v23
  buffer_load_dwordx4 v[44:47], v235, s[8:11], s66 offen sc1
  v_add_u32 v236, v12, v23
  buffer_load_dwordx4 v[48:51], v236, s[8:11], s66 offen sc1
  v_add_u32 v232, v13, v23
  buffer_load_dwordx4 v[72:75], v232, s[8:11], s66 offen sc1
  v_add_u32 v233, v14, v23
  buffer_load_dwordx4 v[76:79], v233, s[8:11], s66 offen sc1
  v_add_u32 v234, v15, v23
  buffer_load_dwordx4 v[80:83], v234, s[8:11], s66 offen sc1
  v_add_u32 v235, v16, v23
  buffer_load_dwordx4 v[84:87], v235, s[8:11], s66 offen sc1
  v_add_u32 v236, v17, v23
  buffer_load_dwordx4 v[88:91], v236, s[8:11], s66 offen sc1
  v_add_u32 v232, v13, v24
  buffer_load_dwordx4 v[92:95], v232, s[8:11], s66 offen sc1
  v_add_u32 v233, v14, v24
  buffer_load_dwordx4 v[96:99], v233, s[8:11], s66 offen sc1
  v_add_u32 v234, v15, v24
  buffer_load_dwordx4 v[100:103], v234, s[8:11], s66 offen sc1
  v_add_u32 v235, v16, v24
  buffer_load_dwordx4 v[104:107], v235, s[8:11], s66 offen sc1
  v_add_u32 v236, v17, v24
  buffer_load_dwordx4 v[108:111], v236, s[8:11], s66 offen sc1
  v_add_u32 v232, v13, v25
  buffer_load_dwordx4 v[112:115], v232, s[8:11], s66 offen sc1
  v_add_u32 v233, v14, v25
  buffer_load_dwordx4 v[116:119], v233, s[8:11], s66 offen sc1
  v_add_u32 v234, v15, v25
  buffer_load_dwordx4 v[120:123], v234, s[8:11], s66 offen sc1
  v_add_u32 v235, v16, v25
  buffer_load_dwordx4 v[124:127], v235, s[8:11], s66 offen sc1
  v_add_u32 v236, v17, v25
  buffer_load_dwordx4 v[128:131], v236, s[8:11], s66 offen sc1
  v_add_u32 v232, v13, v26
  buffer_load_dwordx4 v[132:135], v232, s[8:11], s66 offen sc1
  v_add_u32 v233, v14, v26
  buffer_load_dwordx4 v[136:139], v233, s[8:11], s66 offen sc1
  v_add_u32 v234, v15, v26
  buffer_load_dwordx4 v[140:143], v234, s[8:11], s66 offen sc1
  v_add_u32 v235, v16, v26
  buffer_load_dwordx4 v[144:147], v235, s[8:11], s66 offen sc1
  v_add_u32 v236, v17, v26
  buffer_load_dwordx4 v[148:151], v236, s[8:11], s66 offen sc1
  v_add_u32 v232, v13, v27
  buffer_load_dwordx4 v[152:155], v232, s[8:11], s66 offen sc1
  v_add_u32 v233, v14, v27
  buffer_load_dwordx4 v[156:159], v233, s[8:11], s66 offen sc1
  v_add_u32 v234, v15, v27
  buffer_load_dwordx4 v[160:163], v234, s[8:11], s66 offen sc1
  v_add_u32 v235, v16, v27
  buffer_load_dwordx4 v[164:167], v235, s[8:11], s66 offen sc1
  v_add_u32 v236, v17, v27
  buffer_load_dwordx4 v[168:171], v236, s[8:11], s66 offen sc1
  v_add_u32 v232, v13, v28
  buffer_load_dwordx4 v[172:175], v232, s[8:11], s66 offen sc1
  v_add_u32 v233, v14, v28
  buffer_load_dwordx4 v[176:179], v233, s[8:11], s66 offen sc1
  v_add_u32 v234, v15, v28
  buffer_load_dwordx4 v[180:183], v234, s[8:11], s66 offen sc1
  v_add_u32 v235, v16, v28
  buffer_load_dwordx4 v[184:187], v235, s[8:11], s66 offen sc1
  v_add_u32 v236, v17, v28
  buffer_load_dwordx4 v[188:191], v236, s[8:11], s66 offen sc1
  v_add_u32 v232, v13, v29
  buffer_load_dwordx4 v[192:195], v232, s[8:11], s66 offen sc1
  v_add_u32 v233, v14, v29
  buffer_load_dwordx4 v[196:199], v233, s[8:11], s66 offen sc1
  v_add_u32 v234, v15, v29
  buffer_load_dwordx4 v[200:203], v234, s[8:11], s66 offen sc1
  v_add_u32 v235, v16, v29
  buffer_load_dwordx4 v[204:207], v235, s[8:11], s66 offen sc1
  v_add_u32 v236, v17, v29
  buffer_load_dwordx4 v[208:211], v236, s[8:11], s66 offen sc1
  v_add_u32 v232, v13, v30
  buffer_load_dwordx4 v[212:215], v232, s[8:11], s66 offen sc1
  v_add_u32 v233, v14, v30
  buffer_load_dwordx4 v[216:219], v233, s[8:11], s66 offen sc1
  v_add_u32 v234, v15, v30
  buffer_load_dwordx4 v[220:223], v234, s[8:11], s66 offen sc1
  v_add_u32 v235, v16, v30
  buffer_load_dwordx4 v[224:227], v235, s[8:11], s66 offen sc1
  v_add_u32 v236, v17, v30
  buffer_load_dwordx4 v[228:231], v236, s[8:11], s66 offen sc1
  s_waitcnt vmcnt(35)
  v_dot2_f32_bf16 v52, v32, v72, 0
  v_dot2_f32_bf16 v60, v42, v82, 0
  v_dot2_f32_bf16 v52, v33, v73, v52
  v_dot2_f32_bf16 v60, v43, v83, v60
  v_dot2_f32_bf16 v52, v34, v74, v52
  v_dot2_f32_bf16 v60, v44, v84, v60
  v_dot2_f32_bf16 v52, v35, v75, v52
  v_dot2_f32_bf16 v60, v45, v85, v60
  v_dot2_f32_bf16 v52, v36, v76, v52
  v_dot2_f32_bf16 v60, v46, v86, v60
  v_dot2_f32_bf16 v52, v37, v77, v52
  v_dot2_f32_bf16 v60, v47, v87, v60
  v_dot2_f32_bf16 v52, v38, v78, v52
  v_dot2_f32_bf16 v60, v48, v88, v60
  v_dot2_f32_bf16 v52, v39, v79, v52
  v_dot2_f32_bf16 v60, v49, v89, v60
  v_dot2_f32_bf16 v52, v40, v80, v52
  v_dot2_f32_bf16 v60, v50, v90, v60
  v_dot2_f32_bf16 v52, v41, v81, v52
  v_dot2_f32_bf16 v60, v51, v91, v60
  v_add_u32 v232, v18, v23
  buffer_load_dwordx4 v[72:75], v232, s[8:11], s66 offen sc1
  v_add_u32 v233, v19, v23
  buffer_load_dwordx4 v[76:79], v233, s[8:11], s66 offen sc1
  v_add_u32 v234, v20, v23
  buffer_load_dwordx4 v[80:83], v234, s[8:11], s66 offen sc1
  v_add_u32 v235, v21, v23
  buffer_load_dwordx4 v[84:87], v235, s[8:11], s66 offen sc1
  v_add_u32 v236, v22, v23
  buffer_load_dwordx4 v[88:91], v236, s[8:11], s66 offen sc1
  s_waitcnt vmcnt(35)
  v_dot2_f32_bf16 v53, v32, v92, 0
  v_dot2_f32_bf16 v61, v42, v102, 0
  v_dot2_f32_bf16 v53, v33, v93, v53
  v_dot2_f32_bf16 v61, v43, v103, v61
  v_dot2_f32_bf16 v53, v34, v94, v53
  v_dot2_f32_bf16 v61, v44, v104, v61
  v_dot2_f32_bf16 v53, v35, v95, v53
  v_dot2_f32_bf16 v61, v45, v105, v61
  v_dot2_f32_bf16 v53, v36, v96, v53
  v_dot2_f32_bf16 v61, v46, v106, v61
  v_dot2_f32_bf16 v53, v37, v97, v53
  v_dot2_f32_bf16 v61, v47, v107, v61
  v_dot2_f32_bf16 v53, v38, v98, v53
  v_dot2_f32_bf16 v61, v48, v108, v61
  v_dot2_f32_bf16 v53, v39, v99, v53
  v_dot2_f32_bf16 v61, v49, v109, v61
  v_dot2_f32_bf16 v53, v40, v100, v53
  v_dot2_f32_bf16 v61, v50, v110, v61
  v_dot2_f32_bf16 v53, v41, v101, v53
  v_dot2_f32_bf16 v61, v51, v111, v61
  v_add_u32 v232, v18, v24
  buffer_load_dwordx4 v[92:95], v232, s[8:11], s66 offen sc1
  v_add_u32 v233, v19, v24
  buffer_load_dwordx4 v[96:99], v233, s[8:11], s66 offen sc1
  v_add_u32 v234, v20, v24
  buffer_load_dwordx4 v[100:103], v234, s[8:11], s66 offen sc1
  v_add_u32 v235, v21, v24
  buffer_load_dwordx4 v[104:107], v235, s[8:11], s66 offen sc1
  v_add_u32 v236, v22, v24
  buffer_load_dwordx4 v[108:111], v236, s[8:11], s66 offen sc1
  s_waitcnt vmcnt(35)
  v_dot2_f32_bf16 v54, v32, v112, 0
  v_dot2_f32_bf16 v62, v42, v122, 0
  v_dot2_f32_bf16 v54, v33, v113, v54
  v_dot2_f32_bf16 v62, v43, v123, v62
  v_dot2_f32_bf16 v54, v34, v114, v54
  v_dot2_f32_bf16 v62, v44, v124, v62
  v_dot2_f32_bf16 v54, v35, v115, v54
  v_dot2_f32_bf16 v62, v45, v125, v62
  v_dot2_f32_bf16 v54, v36, v116, v54
  v_dot2_f32_bf16 v62, v46, v126, v62
  v_dot2_f32_bf16 v54, v37, v117, v54
  v_dot2_f32_bf16 v62, v47, v127, v62
  v_dot2_f32_bf16 v54, v38, v118, v54
  v_dot2_f32_bf16 v62, v48, v128, v62
  v_dot2_f32_bf16 v54, v39, v119, v54
  v_dot2_f32_bf16 v62, v49, v129, v62
  v_dot2_f32_bf16 v54, v40, v120, v54
  v_dot2_f32_bf16 v62, v50, v130, v62
  v_dot2_f32_bf16 v54, v41, v121, v54
  v_dot2_f32_bf16 v62, v51, v131, v62
  v_add_u32 v232, v18, v25
  buffer_load_dwordx4 v[112:115], v232, s[8:11], s66 offen sc1
  v_add_u32 v233, v19, v25
  buffer_load_dwordx4 v[116:119], v233, s[8:11], s66 offen sc1
  v_add_u32 v234, v20, v25
  buffer_load_dwordx4 v[120:123], v234, s[8:11], s66 offen sc1
  v_add_u32 v235, v21, v25
  buffer_load_dwordx4 v[124:127], v235, s[8:11], s66 offen sc1
  v_add_u32 v236, v22, v25
  buffer_load_dwordx4 v[128:131], v236, s[8:11], s66 offen sc1
  s_waitcnt vmcnt(35)
  v_dot2_f32_bf16 v55, v32, v132, 0
  v_dot2_f32_bf16 v63, v42, v142, 0
  v_dot2_f32_bf16 v55, v33, v133, v55
  v_dot2_f32_bf16 v63, v43, v143, v63
  v_dot2_f32_bf16 v55, v34, v134, v55
  v_dot2_f32_bf16 v63, v44, v144, v63
  v_dot2_f32_bf16 v55, v35, v135, v55
  v_dot2_f32_bf16 v63, v45, v145, v63
  v_dot2_f32_bf16 v55, v36, v136, v55
  v_dot2_f32_bf16 v63, v46, v146, v63
  v_dot2_f32_bf16 v55, v37, v137, v55
  v_dot2_f32_bf16 v63, v47, v147, v63
  v_dot2_f32_bf16 v55, v38, v138, v55
  v_dot2_f32_bf16 v63, v48, v148, v63
  v_dot2_f32_bf16 v55, v39, v139, v55
  v_dot2_f32_bf16 v63, v49, v149, v63
  v_dot2_f32_bf16 v55, v40, v140, v55
  v_dot2_f32_bf16 v63, v50, v150, v63
  v_dot2_f32_bf16 v55, v41, v141, v55
  v_dot2_f32_bf16 v63, v51, v151, v63
  v_add_u32 v232, v18, v26
  buffer_load_dwordx4 v[132:135], v232, s[8:11], s66 offen sc1
  v_add_u32 v233, v19, v26
  buffer_load_dwordx4 v[136:139], v233, s[8:11], s66 offen sc1
  v_add_u32 v234, v20, v26
  buffer_load_dwordx4 v[140:143], v234, s[8:11], s66 offen sc1
  v_add_u32 v235, v21, v26
  buffer_load_dwordx4 v[144:147], v235, s[8:11], s66 offen sc1
  v_add_u32 v236, v22, v26
  buffer_load_dwordx4 v[148:151], v236, s[8:11], s66 offen sc1
  s_waitcnt vmcnt(35)
  v_dot2_f32_bf16 v56, v32, v152, 0
  v_dot2_f32_bf16 v64, v42, v162, 0
  v_dot2_f32_bf16 v56, v33, v153, v56
  v_dot2_f32_bf16 v64, v43, v163, v64
  v_dot2_f32_bf16 v56, v34, v154, v56
  v_dot2_f32_bf16 v64, v44, v164, v64
  v_dot2_f32_bf16 v56, v35, v155, v56
  v_dot2_f32_bf16 v64, v45, v165, v64
  v_dot2_f32_bf16 v56, v36, v156, v56
  v_dot2_f32_bf16 v64, v46, v166, v64
  v_dot2_f32_bf16 v56, v37, v157, v56
  v_dot2_f32_bf16 v64, v47, v167, v64
  v_dot2_f32_bf16 v56, v38, v158, v56
  v_dot2_f32_bf16 v64, v48, v168, v64
  v_dot2_f32_bf16 v56, v39, v159, v56
  v_dot2_f32_bf16 v64, v49, v169, v64
  v_dot2_f32_bf16 v56, v40, v160, v56
  v_dot2_f32_bf16 v64, v50, v170, v64
  v_dot2_f32_bf16 v56, v41, v161, v56
  v_dot2_f32_bf16 v64, v51, v171, v64
  v_add_u32 v232, v18, v27
  buffer_load_dwordx4 v[152:155], v232, s[8:11], s66 offen sc1
  v_add_u32 v233, v19, v27
  buffer_load_dwordx4 v[156:159], v233, s[8:11], s66 offen sc1
  v_add_u32 v234, v20, v27
  buffer_load_dwordx4 v[160:163], v234, s[8:11], s66 offen sc1
  v_add_u32 v235, v21, v27
  buffer_load_dwordx4 v[164:167], v235, s[8:11], s66 offen sc1
  v_add_u32 v236, v22, v27
  buffer_load_dwordx4 v[168:171], v236, s[8:11], s66 offen sc1
  s_waitcnt vmcnt(35)
  v_dot2_f32_bf16 v57, v32, v172, 0
  v_dot2_f32_bf16 v65, v42, v182, 0
  v_dot2_f32_bf16 v57, v33, v173, v57
  v_dot2_f32_bf16 v65, v43, v183, v65
  v_dot2_f32_bf16 v57, v34, v174, v57
  v_dot2_f32_bf16 v65, v44, v184, v65
  v_dot2_f32_bf16 v57, v35, v175, v57
  v_dot2_f32_bf16 v65, v45, v185, v65
  v_dot2_f32_bf16 v57, v36, v176, v57
  v_dot2_f32_bf16 v65, v46, v186, v65
  v_dot2_f32_bf16 v57, v37, v177, v57
  v_dot2_f32_bf16 v65, v47, v187, v65
  v_dot2_f32_bf16 v57, v38, v178, v57
  v_dot2_f32_bf16 v65, v48, v188, v65
  v_dot2_f32_bf16 v57, v39, v179, v57
  v_dot2_f32_bf16 v65, v49, v189, v65
  v_dot2_f32_bf16 v57, v40, v180, v57
  v_dot2_f32_bf16 v65, v50, v190, v65
  v_dot2_f32_bf16 v57, v41, v181, v57
  v_dot2_f32_bf16 v65, v51, v191, v65
  v_add_u32 v232, v18, v28
  buffer_load_dwordx4 v[172:175], v232, s[8:11], s66 offen sc1
  v_add_u32 v233, v19, v28
  buffer_load_dwordx4 v[176:179], v233, s[8:11], s66 offen sc1
  v_add_u32 v234, v20, v28
  buffer_load_dwordx4 v[180:183], v234, s[8:11], s66 offen sc1
  v_add_u32 v235, v21, v28
  buffer_load_dwordx4 v[184:187], v235, s[8:11], s66 offen sc1
  v_add_u32 v236, v22, v28
  buffer_load_dwordx4 v[188:191], v236, s[8:11], s66 offen sc1
  s_waitcnt vmcnt(35)
  v_dot2_f32_bf16 v58, v32, v192, 0
  v_dot2_f32_bf16 v66, v42, v202, 0
  v_dot2_f32_bf16 v58, v33, v193, v58
  v_dot2_f32_bf16 v66, v43, v203, v66
  v_dot2_f32_bf16 v58, v34, v194, v58
  v_dot2_f32_bf16 v66, v44, v204, v66
  v_dot2_f32_bf16 v58, v35, v195, v58
  v_dot2_f32_bf16 v66, v45, v205, v66
  v_dot2_f32_bf16 v58, v36, v196, v58
  v_dot2_f32_bf16 v66, v46, v206, v66
  v_dot2_f32_bf16 v58, v37, v197, v58
  v_dot2_f32_bf16 v66, v47, v207, v66
  v_dot2_f32_bf16 v58, v38, v198, v58
  v_dot2_f32_bf16 v66, v48, v208, v66
  v_dot2_f32_bf16 v58, v39, v199, v58
  v_dot2_f32_bf16 v66, v49, v209, v66
  v_dot2_f32_bf16 v58, v40, v200, v58
  v_dot2_f32_bf16 v66, v50, v210, v66
  v_dot2_f32_bf16 v58, v41, v201, v58
  v_dot2_f32_bf16 v66, v51, v211, v66
  v_add_u32 v232, v18, v29
  buffer_load_dwordx4 v[192:195], v232, s[8:11], s66 offen sc1
  v_add_u32 v233, v19, v29
  buffer_load_dwordx4 v[196:199], v233, s[8:11], s66 offen sc1
  v_add_u32 v234, v20, v29
  buffer_load_dwordx4 v[200:203], v234, s[8:11], s66 offen sc1
  v_add_u32 v235, v21, v29
  buffer_load_dwordx4 v[204:207], v235, s[8:11], s66 offen sc1
  v_add_u32 v236, v22, v29
  buffer_load_dwordx4 v[208:211], v236, s[8:11], s66 offen sc1
  s_waitcnt vmcnt(35)
  v_dot2_f32_bf16 v59, v32, v212, 0
  v_dot2_f32_bf16 v67, v42, v222, 0
  v_dot2_f32_bf16 v59, v33, v213, v59
  v_dot2_f32_bf16 v67, v43, v223, v67
  v_dot2_f32_bf16 v59, v34, v214, v59
  v_dot2_f32_bf16 v67, v44, v224, v67
  v_dot2_f32_bf16 v59, v35, v215, v59
  v_dot2_f32_bf16 v67, v45, v225, v67
  v_dot2_f32_bf16 v59, v36, v216, v59
  v_dot2_f32_bf16 v67, v46, v226, v67
  v_dot2_f32_bf16 v59, v37, v217, v59
  v_dot2_f32_bf16 v67, v47, v227, v67
  v_dot2_f32_bf16 v59, v38, v218, v59
  v_dot2_f32_bf16 v67, v48, v228, v67
  v_dot2_f32_bf16 v59, v39, v219, v59
  v_dot2_f32_bf16 v67, v49, v229, v67
  v_dot2_f32_bf16 v59, v40, v220, v59
  v_dot2_f32_bf16 v67, v50, v230, v67
  v_dot2_f32_bf16 v59, v41, v221, v59
  v_dot2_f32_bf16 v67, v51, v231, v67
  v_add_u32 v232, v18, v30
  buffer_load_dwordx4 v[212:215], v232, s[8:11], s66 offen sc1
  v_add_u32 v233, v19, v30
  buffer_load_dwordx4 v[216:219], v233, s[8:11], s66 offen sc1
  v_add_u32 v234, v20, v30
  buffer_load_dwordx4 v[220:223], v234, s[8:11], s66 offen sc1
  v_add_u32 v235, v21, v30
  buffer_load_dwordx4 v[224:227], v235, s[8:11], s66 offen sc1
  v_add_u32 v236, v22, v30
  buffer_load_dwordx4 v[228:231], v236, s[8:11], s66 offen sc1
  s_mov_b32 s46, 1051011932
  v_mov_b32 v232, 3481618353
  v_cndmask_b32 v53, v53, v232, s[74:75]
  v_cndmask_b32 v54, v54, v232, s[76:77]
  v_cndmask_b32 v55, v55, v232, s[78:79]
  v_cndmask_b32 v56, v56, v232, s[80:81]
  v_cndmask_b32 v57, v57, v232, s[82:83]
  v_cndmask_b32 v58, v58, v232, s[84:85]
  v_cndmask_b32 v59, v59, v232, s[86:87]
  v_max_f32 v233, v52, v53
  v_max3_f32 v233, v233, v54, v55
  v_max3_f32 v233, v233, v56, v57
  v_max3_f32 v233, v233, v58, v59
  v_mul_f32 v233, s46, v233
  v_fma_f32 v52, v52, s46, -v233
  v_fma_f32 v53, v53, s46, -v233
  v_fma_f32 v54, v54, s46, -v233
  v_fma_f32 v55, v55, s46, -v233
  v_fma_f32 v56, v56, s46, -v233
  v_fma_f32 v57, v57, s46, -v233
  v_fma_f32 v58, v58, s46, -v233
  v_fma_f32 v59, v59, s46, -v233
  v_exp_f32 v52, v52
  v_exp_f32 v53, v53
  v_exp_f32 v54, v54
  v_exp_f32 v55, v55
  v_exp_f32 v56, v56
  v_exp_f32 v57, v57
  v_exp_f32 v58, v58
  v_exp_f32 v59, v59
  v_add_f32 v233, v52, v53
  v_add_f32 v233, v233, v54
  v_add_f32 v233, v233, v55
  v_add_f32 v233, v233, v56
  v_add_f32 v233, v233, v57
  v_add_f32 v233, v233, v58
  v_add_f32 v233, v233, v59
  v_rcp_f32 v233, v233
  s_nop 0
  v_mul_f32 v52, v52, v233
  v_mul_f32 v53, v53, v233
  v_mul_f32 v54, v54, v233
  v_mul_f32 v55, v55, v233
  v_mul_f32 v56, v56, v233
  v_mul_f32 v57, v57, v233
  v_mul_f32 v58, v58, v233
  v_mul_f32 v59, v59, v233
  v_cndmask_b32 v61, v61, v232, s[74:75]
  v_cndmask_b32 v62, v62, v232, s[76:77]
  v_cndmask_b32 v63, v63, v232, s[78:79]
  v_cndmask_b32 v64, v64, v232, s[80:81]
  v_cndmask_b32 v65, v65, v232, s[82:83]
  v_cndmask_b32 v66, v66, v232, s[84:85]
  v_cndmask_b32 v67, v67, v232, s[86:87]
  v_max_f32 v233, v60, v61
  v_max3_f32 v233, v233, v62, v63
  v_max3_f32 v233, v233, v64, v65
  v_max3_f32 v233, v233, v66, v67
  v_mul_f32 v233, s46, v233
  v_fma_f32 v60, v60, s46, -v233
  v_fma_f32 v61, v61, s46, -v233
  v_fma_f32 v62, v62, s46, -v233
  v_fma_f32 v63, v63, s46, -v233
  v_fma_f32 v64, v64, s46, -v233
  v_fma_f32 v65, v65, s46, -v233
  v_fma_f32 v66, v66, s46, -v233
  v_fma_f32 v67, v67, s46, -v233
  v_exp_f32 v60, v60
  v_exp_f32 v61, v61
  v_exp_f32 v62, v62
  v_exp_f32 v63, v63
  v_exp_f32 v64, v64
  v_exp_f32 v65, v65
  v_exp_f32 v66, v66
  v_exp_f32 v67, v67
  v_add_f32 v233, v60, v61
  v_add_f32 v233, v233, v62
  v_add_f32 v233, v233, v63
  v_add_f32 v233, v233, v64
  v_add_f32 v233, v233, v65
  v_add_f32 v233, v233, v66
  v_add_f32 v233, v233, v67
  v_rcp_f32 v233, v233
  s_nop 0
  v_mul_f32 v60, v60, v233
  v_mul_f32 v61, v61, v233
  v_mul_f32 v62, v62, v233
  v_mul_f32 v63, v63, v233
  v_mul_f32 v64, v64, v233
  v_mul_f32 v65, v65, v233
  v_mul_f32 v66, v66, v233
  v_mul_f32 v67, v67, v233
  v_cvt_pk_bf16_f32 v52, v52, 0
  v_lshlrev_b32 v236, 16, v52
  v_cvt_pk_bf16_f32 v53, v53, 0
  v_lshlrev_b32 v237, 16, v53
  v_cvt_pk_bf16_f32 v54, v54, 0
  v_lshlrev_b32 v238, 16, v54
  v_cvt_pk_bf16_f32 v55, v55, 0
  v_lshlrev_b32 v239, 16, v55
  v_cvt_pk_bf16_f32 v56, v56, 0
  v_lshlrev_b32 v240, 16, v56
  v_cvt_pk_bf16_f32 v57, v57, 0
  v_lshlrev_b32 v241, 16, v57
  v_cvt_pk_bf16_f32 v58, v58, 0
  v_lshlrev_b32 v242, 16, v58
  v_cvt_pk_bf16_f32 v59, v59, 0
  v_lshlrev_b32 v243, 16, v59
  v_cvt_pk_bf16_f32 v60, v60, 0
  v_lshlrev_b32 v244, 16, v60
  v_cvt_pk_bf16_f32 v61, v61, 0
  v_lshlrev_b32 v245, 16, v61
  v_cvt_pk_bf16_f32 v62, v62, 0
  v_lshlrev_b32 v246, 16, v62
  v_cvt_pk_bf16_f32 v63, v63, 0
  v_lshlrev_b32 v247, 16, v63
  v_cvt_pk_bf16_f32 v64, v64, 0
  v_lshlrev_b32 v248, 16, v64
  v_cvt_pk_bf16_f32 v65, v65, 0
  v_lshlrev_b32 v249, 16, v65
  v_cvt_pk_bf16_f32 v66, v66, 0
  v_lshlrev_b32 v250, 16, v66
  v_cvt_pk_bf16_f32 v67, v67, 0
  v_lshlrev_b32 v251, 16, v67
  s_waitcnt vmcnt(35)
  v_dot2_f32_bf16 v8, v72, v52, 0
  v_dot2_f32_bf16 v9, v72, v236, 0
  v_dot2_f32_bf16 v10, v73, v52, 0
  v_dot2_f32_bf16 v11, v73, v236, 0
  v_dot2_f32_bf16 v12, v74, v52, 0
  v_dot2_f32_bf16 v13, v74, v236, 0
  v_dot2_f32_bf16 v14, v75, v52, 0
  v_dot2_f32_bf16 v15, v75, v236, 0
  v_dot2_f32_bf16 v16, v76, v52, 0
  v_dot2_f32_bf16 v17, v76, v236, 0
  v_dot2_f32_bf16 v18, v77, v52, 0
  v_dot2_f32_bf16 v19, v77, v236, 0
  v_dot2_f32_bf16 v20, v78, v52, 0
  v_dot2_f32_bf16 v21, v78, v236, 0
  v_dot2_f32_bf16 v22, v79, v52, 0
  v_dot2_f32_bf16 v23, v79, v236, 0
  v_dot2_f32_bf16 v24, v80, v52, 0
  v_dot2_f32_bf16 v25, v80, v236, 0
  v_dot2_f32_bf16 v26, v81, v52, 0
  v_dot2_f32_bf16 v27, v81, v236, 0
  v_dot2_f32_bf16 v28, v82, v60, 0
  v_dot2_f32_bf16 v29, v82, v244, 0
  v_dot2_f32_bf16 v30, v83, v60, 0
  v_dot2_f32_bf16 v31, v83, v244, 0
  v_dot2_f32_bf16 v32, v84, v60, 0
  v_dot2_f32_bf16 v33, v84, v244, 0
  v_dot2_f32_bf16 v34, v85, v60, 0
  v_dot2_f32_bf16 v35, v85, v244, 0
  v_dot2_f32_bf16 v36, v86, v60, 0
  v_dot2_f32_bf16 v37, v86, v244, 0
  v_dot2_f32_bf16 v38, v87, v60, 0
  v_dot2_f32_bf16 v39, v87, v244, 0
  v_dot2_f32_bf16 v40, v88, v60, 0
  v_dot2_f32_bf16 v41, v88, v244, 0
  v_dot2_f32_bf16 v42, v89, v60, 0
  v_dot2_f32_bf16 v43, v89, v244, 0
  v_dot2_f32_bf16 v44, v90, v60, 0
  v_dot2_f32_bf16 v45, v90, v244, 0
  v_dot2_f32_bf16 v46, v91, v60, 0
  v_dot2_f32_bf16 v47, v91, v244, 0
  s_waitcnt vmcnt(30)
  v_dot2_f32_bf16 v8, v92, v53, v8
  v_dot2_f32_bf16 v9, v92, v237, v9
  v_dot2_f32_bf16 v10, v93, v53, v10
  v_dot2_f32_bf16 v11, v93, v237, v11
  v_dot2_f32_bf16 v12, v94, v53, v12
  v_dot2_f32_bf16 v13, v94, v237, v13
  v_dot2_f32_bf16 v14, v95, v53, v14
  v_dot2_f32_bf16 v15, v95, v237, v15
  v_dot2_f32_bf16 v16, v96, v53, v16
  v_dot2_f32_bf16 v17, v96, v237, v17
  v_dot2_f32_bf16 v18, v97, v53, v18
  v_dot2_f32_bf16 v19, v97, v237, v19
  v_dot2_f32_bf16 v20, v98, v53, v20
  v_dot2_f32_bf16 v21, v98, v237, v21
  v_dot2_f32_bf16 v22, v99, v53, v22
  v_dot2_f32_bf16 v23, v99, v237, v23
  v_dot2_f32_bf16 v24, v100, v53, v24
  v_dot2_f32_bf16 v25, v100, v237, v25
  v_dot2_f32_bf16 v26, v101, v53, v26
  v_dot2_f32_bf16 v27, v101, v237, v27
  v_dot2_f32_bf16 v28, v102, v61, v28
  v_dot2_f32_bf16 v29, v102, v245, v29
  v_dot2_f32_bf16 v30, v103, v61, v30
  v_dot2_f32_bf16 v31, v103, v245, v31
  v_dot2_f32_bf16 v32, v104, v61, v32
  v_dot2_f32_bf16 v33, v104, v245, v33
  v_dot2_f32_bf16 v34, v105, v61, v34
  v_dot2_f32_bf16 v35, v105, v245, v35
  v_dot2_f32_bf16 v36, v106, v61, v36
  v_dot2_f32_bf16 v37, v106, v245, v37
  v_dot2_f32_bf16 v38, v107, v61, v38
  v_dot2_f32_bf16 v39, v107, v245, v39
  v_dot2_f32_bf16 v40, v108, v61, v40
  v_dot2_f32_bf16 v41, v108, v245, v41
  v_dot2_f32_bf16 v42, v109, v61, v42
  v_dot2_f32_bf16 v43, v109, v245, v43
  v_dot2_f32_bf16 v44, v110, v61, v44
  v_dot2_f32_bf16 v45, v110, v245, v45
  v_dot2_f32_bf16 v46, v111, v61, v46
  v_dot2_f32_bf16 v47, v111, v245, v47
  s_waitcnt vmcnt(25)
  v_dot2_f32_bf16 v8, v112, v54, v8
  v_dot2_f32_bf16 v9, v112, v238, v9
  v_dot2_f32_bf16 v10, v113, v54, v10
  v_dot2_f32_bf16 v11, v113, v238, v11
  v_dot2_f32_bf16 v12, v114, v54, v12
  v_dot2_f32_bf16 v13, v114, v238, v13
  v_dot2_f32_bf16 v14, v115, v54, v14
  v_dot2_f32_bf16 v15, v115, v238, v15
  v_dot2_f32_bf16 v16, v116, v54, v16
  v_dot2_f32_bf16 v17, v116, v238, v17
  v_dot2_f32_bf16 v18, v117, v54, v18
  v_dot2_f32_bf16 v19, v117, v238, v19
  v_dot2_f32_bf16 v20, v118, v54, v20
  v_dot2_f32_bf16 v21, v118, v238, v21
  v_dot2_f32_bf16 v22, v119, v54, v22
  v_dot2_f32_bf16 v23, v119, v238, v23
  v_dot2_f32_bf16 v24, v120, v54, v24
  v_dot2_f32_bf16 v25, v120, v238, v25
  v_dot2_f32_bf16 v26, v121, v54, v26
  v_dot2_f32_bf16 v27, v121, v238, v27
  v_dot2_f32_bf16 v28, v122, v62, v28
  v_dot2_f32_bf16 v29, v122, v246, v29
  v_dot2_f32_bf16 v30, v123, v62, v30
  v_dot2_f32_bf16 v31, v123, v246, v31
  v_dot2_f32_bf16 v32, v124, v62, v32
  v_dot2_f32_bf16 v33, v124, v246, v33
  v_dot2_f32_bf16 v34, v125, v62, v34
  v_dot2_f32_bf16 v35, v125, v246, v35
  v_dot2_f32_bf16 v36, v126, v62, v36
  v_dot2_f32_bf16 v37, v126, v246, v37
  v_dot2_f32_bf16 v38, v127, v62, v38
  v_dot2_f32_bf16 v39, v127, v246, v39
  v_dot2_f32_bf16 v40, v128, v62, v40
  v_dot2_f32_bf16 v41, v128, v246, v41
  v_dot2_f32_bf16 v42, v129, v62, v42
  v_dot2_f32_bf16 v43, v129, v246, v43
  v_dot2_f32_bf16 v44, v130, v62, v44
  v_dot2_f32_bf16 v45, v130, v246, v45
  v_dot2_f32_bf16 v46, v131, v62, v46
  v_dot2_f32_bf16 v47, v131, v246, v47
  s_waitcnt vmcnt(20)
  v_dot2_f32_bf16 v8, v132, v55, v8
  v_dot2_f32_bf16 v9, v132, v239, v9
  v_dot2_f32_bf16 v10, v133, v55, v10
  v_dot2_f32_bf16 v11, v133, v239, v11
  v_dot2_f32_bf16 v12, v134, v55, v12
  v_dot2_f32_bf16 v13, v134, v239, v13
  v_dot2_f32_bf16 v14, v135, v55, v14
  v_dot2_f32_bf16 v15, v135, v239, v15
  v_dot2_f32_bf16 v16, v136, v55, v16
  v_dot2_f32_bf16 v17, v136, v239, v17
  v_dot2_f32_bf16 v18, v137, v55, v18
  v_dot2_f32_bf16 v19, v137, v239, v19
  v_dot2_f32_bf16 v20, v138, v55, v20
  v_dot2_f32_bf16 v21, v138, v239, v21
  v_dot2_f32_bf16 v22, v139, v55, v22
  v_dot2_f32_bf16 v23, v139, v239, v23
  v_dot2_f32_bf16 v24, v140, v55, v24
  v_dot2_f32_bf16 v25, v140, v239, v25
  v_dot2_f32_bf16 v26, v141, v55, v26
  v_dot2_f32_bf16 v27, v141, v239, v27
  v_dot2_f32_bf16 v28, v142, v63, v28
  v_dot2_f32_bf16 v29, v142, v247, v29
  v_dot2_f32_bf16 v30, v143, v63, v30
  v_dot2_f32_bf16 v31, v143, v247, v31
  v_dot2_f32_bf16 v32, v144, v63, v32
  v_dot2_f32_bf16 v33, v144, v247, v33
  v_dot2_f32_bf16 v34, v145, v63, v34
  v_dot2_f32_bf16 v35, v145, v247, v35
  v_dot2_f32_bf16 v36, v146, v63, v36
  v_dot2_f32_bf16 v37, v146, v247, v37
  v_dot2_f32_bf16 v38, v147, v63, v38
  v_dot2_f32_bf16 v39, v147, v247, v39
  v_dot2_f32_bf16 v40, v148, v63, v40
  v_dot2_f32_bf16 v41, v148, v247, v41
  v_dot2_f32_bf16 v42, v149, v63, v42
  v_dot2_f32_bf16 v43, v149, v247, v43
  v_dot2_f32_bf16 v44, v150, v63, v44
  v_dot2_f32_bf16 v45, v150, v247, v45
  v_dot2_f32_bf16 v46, v151, v63, v46
  v_dot2_f32_bf16 v47, v151, v247, v47
  s_waitcnt vmcnt(15)
  v_dot2_f32_bf16 v8, v152, v56, v8
  v_dot2_f32_bf16 v9, v152, v240, v9
  v_dot2_f32_bf16 v10, v153, v56, v10
  v_dot2_f32_bf16 v11, v153, v240, v11
  v_dot2_f32_bf16 v12, v154, v56, v12
  v_dot2_f32_bf16 v13, v154, v240, v13
  v_dot2_f32_bf16 v14, v155, v56, v14
  v_dot2_f32_bf16 v15, v155, v240, v15
  v_dot2_f32_bf16 v16, v156, v56, v16
  v_dot2_f32_bf16 v17, v156, v240, v17
  v_dot2_f32_bf16 v18, v157, v56, v18
  v_dot2_f32_bf16 v19, v157, v240, v19
  v_dot2_f32_bf16 v20, v158, v56, v20
  v_dot2_f32_bf16 v21, v158, v240, v21
  v_dot2_f32_bf16 v22, v159, v56, v22
  v_dot2_f32_bf16 v23, v159, v240, v23
  v_dot2_f32_bf16 v24, v160, v56, v24
  v_dot2_f32_bf16 v25, v160, v240, v25
  v_dot2_f32_bf16 v26, v161, v56, v26
  v_dot2_f32_bf16 v27, v161, v240, v27
  v_dot2_f32_bf16 v28, v162, v64, v28
  v_dot2_f32_bf16 v29, v162, v248, v29
  v_dot2_f32_bf16 v30, v163, v64, v30
  v_dot2_f32_bf16 v31, v163, v248, v31
  v_dot2_f32_bf16 v32, v164, v64, v32
  v_dot2_f32_bf16 v33, v164, v248, v33
  v_dot2_f32_bf16 v34, v165, v64, v34
  v_dot2_f32_bf16 v35, v165, v248, v35
  v_dot2_f32_bf16 v36, v166, v64, v36
  v_dot2_f32_bf16 v37, v166, v248, v37
  v_dot2_f32_bf16 v38, v167, v64, v38
  v_dot2_f32_bf16 v39, v167, v248, v39
  v_dot2_f32_bf16 v40, v168, v64, v40
  v_dot2_f32_bf16 v41, v168, v248, v41
  v_dot2_f32_bf16 v42, v169, v64, v42
  v_dot2_f32_bf16 v43, v169, v248, v43
  v_dot2_f32_bf16 v44, v170, v64, v44
  v_dot2_f32_bf16 v45, v170, v248, v45
  v_dot2_f32_bf16 v46, v171, v64, v46
  v_dot2_f32_bf16 v47, v171, v248, v47
  s_waitcnt vmcnt(10)
  v_dot2_f32_bf16 v8, v172, v57, v8
  v_dot2_f32_bf16 v9, v172, v241, v9
  v_dot2_f32_bf16 v10, v173, v57, v10
  v_dot2_f32_bf16 v11, v173, v241, v11
  v_dot2_f32_bf16 v12, v174, v57, v12
  v_dot2_f32_bf16 v13, v174, v241, v13
  v_dot2_f32_bf16 v14, v175, v57, v14
  v_dot2_f32_bf16 v15, v175, v241, v15
  v_dot2_f32_bf16 v16, v176, v57, v16
  v_dot2_f32_bf16 v17, v176, v241, v17
  v_dot2_f32_bf16 v18, v177, v57, v18
  v_dot2_f32_bf16 v19, v177, v241, v19
  v_dot2_f32_bf16 v20, v178, v57, v20
  v_dot2_f32_bf16 v21, v178, v241, v21
  v_dot2_f32_bf16 v22, v179, v57, v22
  v_dot2_f32_bf16 v23, v179, v241, v23
  v_dot2_f32_bf16 v24, v180, v57, v24
  v_dot2_f32_bf16 v25, v180, v241, v25
  v_dot2_f32_bf16 v26, v181, v57, v26
  v_dot2_f32_bf16 v27, v181, v241, v27
  v_dot2_f32_bf16 v28, v182, v65, v28
  v_dot2_f32_bf16 v29, v182, v249, v29
  v_dot2_f32_bf16 v30, v183, v65, v30
  v_dot2_f32_bf16 v31, v183, v249, v31
  v_dot2_f32_bf16 v32, v184, v65, v32
  v_dot2_f32_bf16 v33, v184, v249, v33
  v_dot2_f32_bf16 v34, v185, v65, v34
  v_dot2_f32_bf16 v35, v185, v249, v35
  v_dot2_f32_bf16 v36, v186, v65, v36
  v_dot2_f32_bf16 v37, v186, v249, v37
  v_dot2_f32_bf16 v38, v187, v65, v38
  v_dot2_f32_bf16 v39, v187, v249, v39
  v_dot2_f32_bf16 v40, v188, v65, v40
  v_dot2_f32_bf16 v41, v188, v249, v41
  v_dot2_f32_bf16 v42, v189, v65, v42
  v_dot2_f32_bf16 v43, v189, v249, v43
  v_dot2_f32_bf16 v44, v190, v65, v44
  v_dot2_f32_bf16 v45, v190, v249, v45
  v_dot2_f32_bf16 v46, v191, v65, v46
  v_dot2_f32_bf16 v47, v191, v249, v47
  s_waitcnt vmcnt(5)
  v_dot2_f32_bf16 v8, v192, v58, v8
  v_dot2_f32_bf16 v9, v192, v242, v9
  v_dot2_f32_bf16 v10, v193, v58, v10
  v_dot2_f32_bf16 v11, v193, v242, v11
  v_dot2_f32_bf16 v12, v194, v58, v12
  v_dot2_f32_bf16 v13, v194, v242, v13
  v_dot2_f32_bf16 v14, v195, v58, v14
  v_dot2_f32_bf16 v15, v195, v242, v15
  v_dot2_f32_bf16 v16, v196, v58, v16
  v_dot2_f32_bf16 v17, v196, v242, v17
  v_dot2_f32_bf16 v18, v197, v58, v18
  v_dot2_f32_bf16 v19, v197, v242, v19
  v_dot2_f32_bf16 v20, v198, v58, v20
  v_dot2_f32_bf16 v21, v198, v242, v21
  v_dot2_f32_bf16 v22, v199, v58, v22
  v_dot2_f32_bf16 v23, v199, v242, v23
  v_dot2_f32_bf16 v24, v200, v58, v24
  v_dot2_f32_bf16 v25, v200, v242, v25
  v_dot2_f32_bf16 v26, v201, v58, v26
  v_dot2_f32_bf16 v27, v201, v242, v27
  v_dot2_f32_bf16 v28, v202, v66, v28
  v_dot2_f32_bf16 v29, v202, v250, v29
  v_dot2_f32_bf16 v30, v203, v66, v30
  v_dot2_f32_bf16 v31, v203, v250, v31
  v_dot2_f32_bf16 v32, v204, v66, v32
  v_dot2_f32_bf16 v33, v204, v250, v33
  v_dot2_f32_bf16 v34, v205, v66, v34
  v_dot2_f32_bf16 v35, v205, v250, v35
  v_dot2_f32_bf16 v36, v206, v66, v36
  v_dot2_f32_bf16 v37, v206, v250, v37
  v_dot2_f32_bf16 v38, v207, v66, v38
  v_dot2_f32_bf16 v39, v207, v250, v39
  v_dot2_f32_bf16 v40, v208, v66, v40
  v_dot2_f32_bf16 v41, v208, v250, v41
  v_dot2_f32_bf16 v42, v209, v66, v42
  v_dot2_f32_bf16 v43, v209, v250, v43
  v_dot2_f32_bf16 v44, v210, v66, v44
  v_dot2_f32_bf16 v45, v210, v250, v45
  v_dot2_f32_bf16 v46, v211, v66, v46
  v_dot2_f32_bf16 v47, v211, v250, v47
  s_waitcnt vmcnt(0)
  v_dot2_f32_bf16 v8, v212, v59, v8
  v_dot2_f32_bf16 v9, v212, v243, v9
  v_dot2_f32_bf16 v10, v213, v59, v10
  v_dot2_f32_bf16 v11, v213, v243, v11
  v_dot2_f32_bf16 v12, v214, v59, v12
  v_dot2_f32_bf16 v13, v214, v243, v13
  v_dot2_f32_bf16 v14, v215, v59, v14
  v_dot2_f32_bf16 v15, v215, v243, v15
  v_dot2_f32_bf16 v16, v216, v59, v16
  v_dot2_f32_bf16 v17, v216, v243, v17
  v_dot2_f32_bf16 v18, v217, v59, v18
  v_dot2_f32_bf16 v19, v217, v243, v19
  v_dot2_f32_bf16 v20, v218, v59, v20
  v_dot2_f32_bf16 v21, v218, v243, v21
  v_dot2_f32_bf16 v22, v219, v59, v22
  v_dot2_f32_bf16 v23, v219, v243, v23
  v_dot2_f32_bf16 v24, v220, v59, v24
  v_dot2_f32_bf16 v25, v220, v243, v25
  v_dot2_f32_bf16 v26, v221, v59, v26
  v_dot2_f32_bf16 v27, v221, v243, v27
  v_dot2_f32_bf16 v28, v222, v67, v28
  v_dot2_f32_bf16 v29, v222, v251, v29
  v_dot2_f32_bf16 v30, v223, v67, v30
  v_dot2_f32_bf16 v31, v223, v251, v31
  v_dot2_f32_bf16 v32, v224, v67, v32
  v_dot2_f32_bf16 v33, v224, v251, v33
  v_dot2_f32_bf16 v34, v225, v67, v34
  v_dot2_f32_bf16 v35, v225, v251, v35
  v_dot2_f32_bf16 v36, v226, v67, v36
  v_dot2_f32_bf16 v37, v226, v251, v37
  v_dot2_f32_bf16 v38, v227, v67, v38
  v_dot2_f32_bf16 v39, v227, v251, v39
  v_dot2_f32_bf16 v40, v228, v67, v40
  v_dot2_f32_bf16 v41, v228, v251, v41
  v_dot2_f32_bf16 v42, v229, v67, v42
  v_dot2_f32_bf16 v43, v229, v251, v43
  v_dot2_f32_bf16 v44, v230, v67, v44
  v_dot2_f32_bf16 v45, v230, v251, v45
  v_dot2_f32_bf16 v46, v231, v67, v46
  v_dot2_f32_bf16 v47, v231, v251, v47
  v_cvt_pk_bf16_f32 v72, v8, v9
  v_cvt_pk_bf16_f32 v73, v10, v11
  v_cvt_pk_bf16_f32 v74, v12, v13
  v_cvt_pk_bf16_f32 v75, v14, v15
  v_cvt_pk_bf16_f32 v76, v16, v17
  v_cvt_pk_bf16_f32 v77, v18, v19
  v_cvt_pk_bf16_f32 v78, v20, v21
  v_cvt_pk_bf16_f32 v79, v22, v23
  v_cvt_pk_bf16_f32 v80, v24, v25
  v_cvt_pk_bf16_f32 v81, v26, v27
  v_cvt_pk_bf16_f32 v82, v28, v29
  v_cvt_pk_bf16_f32 v83, v30, v31
  v_cvt_pk_bf16_f32 v84, v32, v33
  v_cvt_pk_bf16_f32 v85, v34, v35
  v_cvt_pk_bf16_f32 v86, v36, v37
  v_cvt_pk_bf16_f32 v87, v38, v39
  v_cvt_pk_bf16_f32 v88, v40, v41
  v_cvt_pk_bf16_f32 v89, v42, v43
  v_cvt_pk_bf16_f32 v90, v44, v45
  v_cvt_pk_bf16_f32 v91, v46, v47
  v_lshlrev_b32 v3, 8, v3
  v_lshl_add_u32 v3, v5, 4, v3
  v_add_u32 v3, 122880, v3
  ds_write_b128 v3, v[72:75] offset:0
  ds_write_b128 v3, v[76:79] offset:256
  ds_write_b128 v3, v[80:83] offset:512
  ds_write_b128 v3, v[84:87] offset:768
  ds_write_b128 v3, v[88:91] offset:1024
  s_waitcnt lgkmcnt(0)
  s_barrier
  v_lshlrev_b32 v13, 4, v0
  v_add_u32 v13, 122880, v13
  ds_read_b128 v[20:23], v13 offset:0
  ds_read_b128 v[24:27], v13 offset:1024
  ds_read_b128 v[28:31], v13 offset:2048
  ds_read_b128 v[32:35], v13 offset:3072
  ds_read_b128 v[36:39], v13 offset:4096
  ds_read_b128 v[40:43], v13 offset:5120
  ds_read_b128 v[44:47], v13 offset:6144
  ds_read_b128 v[48:51], v13 offset:7168
  ds_read_b128 v[52:55], v13 offset:8192
  ds_read_b128 v[56:59], v13 offset:9216
  ds_read_b128 v[60:63], v13 offset:10240
  ds_read_b128 v[64:67], v13 offset:11264
  s_waitcnt lgkmcnt(4)
  ds_read_b128 v[68:71], v13 offset:12288
  ds_read_b128 v[72:75], v13 offset:13312
  ds_read_b128 v[76:79], v13 offset:14336
  ds_read_b128 v[80:83], v13 offset:15360
  ds_read_b128 v[84:87], v13 offset:16384
  ds_read_b128 v[88:91], v13 offset:17408
  ds_read_b128 v[92:95], v13 offset:18432
  ds_read_b128 v[96:99], v13 offset:19456
  s_mov_b32 s4, s20
  s_mov_b32 s5, s21
  s_mov_b32 s6, 819200
  s_mov_b32 s7, 0x20000
  s_mov_b32 s12, s36
  s_mov_b32 s13, s37
  s_mov_b32 s14, 5242880
  s_mov_b32 s15, 0x20000
  v_mul_u32_u24 v12, 2560, v6
  v_lshrrev_b32 v14, 4, v0
  v_lshl_add_u32 v12, v14, 3, v12
  s_lshl_b32 s46, s42, 5
  v_add_u32 v12, s46, v12
  s_mov_b32 s66, 0
  s_waitcnt lgkmcnt(0)
  v_lshrrev_b32 v13, 3, v0
  v_lshrrev_b32 v14, 2, v13
  v_lshlrev_b32 v14, 3, v14
  v_and_b32 v8, 3, v13
  v_add_u32 v8, v8, v14
  s_and_b32 s46, s42, 1
  s_lshl_b32 s46, s46, 2
  s_lshr_b32 s47, s42, 1
  s_lshl_b32 s47, s47, 4
  s_add_u32 s46, s46, s47
  v_add_u32 v8, s46, v8
  v_mul_u32_u24 v8, 1280, v8
  v_lshrrev_b32 v13, 1, v13
  v_bfe_u32 v14, v0, 1, 2
  v_xor_b32 v13, v13, v14
  v_lshlrev_b32 v13, 5, v13
  v_and_b32 v14, 1, v0
  v_lshlrev_b32 v14, 4, v14
  v_add3_u32 v8, v8, v13, v14
  v_lshrrev_b32 v13, 5, v0
  v_lshlrev_b32 v9, 11, v13
  v_bfe_u32 v13, v0, 2, 3
  v_lshl_add_u32 v9, v13, 7, v9
  v_lshrrev_b32 v13, 1, v13
  v_xor_b32 v13, s42, v13
  v_lshl_add_u32 v9, v13, 5, v9
  v_and_b32 v13, 3, v0
  v_lshl_add_u32 v9, v13, 3, v9
  v_add_u32 v10, 0x10000, v9
  v_add_u32 v11, 0x20000, v9
  s_add_u32 m0, s51, 0
  s_add_u32 s46, s66, 0
  buffer_load_dwordx4 v8, s[4:7], s46 offen lds
  s_add_u32 m0, s51, 4096
  s_add_u32 s46, s66, 128
  buffer_load_dwordx4 v8, s[4:7], s46 offen lds
  s_add_u32 m0, s51, 8192
  s_add_u32 s46, s66, 256
  buffer_load_dwordx4 v8, s[4:7], s46 offen lds
  s_add_u32 m0, s51, 12288
  s_add_u32 s46, s66, 384
  buffer_load_dwordx4 v8, s[4:7], s46 offen lds
  s_add_u32 m0, s51, 16384
  s_add_u32 s46, s66, 512
  buffer_load_dwordx4 v8, s[4:7], s46 offen lds
  s_add_u32 m0, s51, 20480
  s_add_u32 s46, s66, 640
  buffer_load_dwordx4 v8, s[4:7], s46 offen lds
  s_add_u32 m0, s51, 24576
  s_add_u32 s46, s66, 768
  buffer_load_dwordx4 v8, s[4:7], s46 offen lds
  s_add_u32 m0, s51, 28672
  s_add_u32 s46, s66, 896
  buffer_load_dwordx4 v8, s[4:7], s46 offen lds
  s_add_u32 m0, s51, 32768
  s_add_u32 s46, s66, 1024
  buffer_load_dwordx4 v8, s[4:7], s46 offen lds
  s_add_u32 m0, s51, 36864
  s_add_u32 s46, s66, 1152
  buffer_load_dwordx4 v8, s[4:7], s46 offen lds
  s_add_u32 m0, s51, 40960
  s_add_u32 s46, s66, 40960
  buffer_load_dwordx4 v8, s[4:7], s46 offen lds
  s_add_u32 m0, s51, 45056
  s_add_u32 s46, s66, 41088
  buffer_load_dwordx4 v8, s[4:7], s46 offen lds
  s_add_u32 m0, s51, 49152
  s_add_u32 s46, s66, 41216
  buffer_load_dwordx4 v8, s[4:7], s46 offen lds
  s_add_u32 m0, s51, 53248
  s_add_u32 s46, s66, 41344
  buffer_load_dwordx4 v8, s[4:7], s46 offen lds
  s_add_u32 m0, s51, 57344
  s_add_u32 s46, s66, 41472
  buffer_load_dwordx4 v8, s[4:7], s46 offen lds
  s_add_u32 m0, s51, 61440
  s_add_u32 s46, s66, 41600
  buffer_load_dwordx4 v8, s[4:7], s46 offen lds
  s_add_u32 m0, s51, 65536
  s_add_u32 s46, s66, 41728
  buffer_load_dwordx4 v8, s[4:7], s46 offen lds
  s_add_u32 m0, s51, 69632
  s_add_u32 s46, s66, 41856
  buffer_load_dwordx4 v8, s[4:7], s46 offen lds
  s_add_u32 m0, s51, 73728
  s_add_u32 s46, s66, 41984
  buffer_load_dwordx4 v8, s[4:7], s46 offen lds
  s_add_u32 m0, s51, 77824
  s_add_u32 s46, s66, 42112
  buffer_load_dwordx4 v8, s[4:7], s46 offen lds
  s_add_u32 m0, s51, 81920
  s_add_u32 s46, s66, 81920
  buffer_load_dwordx4 v8, s[4:7], s46 offen lds
  s_add_u32 m0, s51, 86016
  s_add_u32 s46, s66, 82048
  buffer_load_dwordx4 v8, s[4:7], s46 offen lds
  s_add_u32 m0, s51, 90112
  s_add_u32 s46, s66, 82176
  buffer_load_dwordx4 v8, s[4:7], s46 offen lds
  s_add_u32 m0, s51, 94208
  s_add_u32 s46, s66, 82304
  buffer_load_dwordx4 v8, s[4:7], s46 offen lds
  s_add_u32 m0, s51, 98304
  s_add_u32 s46, s66, 82432
  buffer_load_dwordx4 v8, s[4:7], s46 offen lds
  s_waitcnt vmcnt(20)
  s_barrier
  s_add_u32 m0, s51, 102400
  s_add_u32 s46, s66, 82560
  buffer_load_dwordx4 v8, s[4:7], s46 offen lds
  s_add_u32 m0, s51, 106496
  s_add_u32 s46, s66, 82688
  buffer_load_dwordx4 v8, s[4:7], s46 offen lds
  s_add_u32 m0, s51, 110592
  s_add_u32 s46, s66, 82816
  buffer_load_dwordx4 v8, s[4:7], s46 offen lds
  s_add_u32 m0, s51, 114688
  s_add_u32 s46, s66, 82944
  buffer_load_dwordx4 v8, s[4:7], s46 offen lds
  s_add_u32 m0, s51, 118784
  s_add_u32 s46, s66, 83072
  buffer_load_dwordx4 v8, s[4:7], s46 offen lds
  ds_read_b64_tr_b16 v[100:101], v9 offset:0
  ds_read_b64_tr_b16 v[102:103], v9 offset:1024
  ds_read_b64_tr_b16 v[104:105], v9 offset:4096
  ds_read_b64_tr_b16 v[106:107], v9 offset:5120
  ds_read_b64_tr_b16 v[108:109], v9 offset:8192
  ds_read_b64_tr_b16 v[110:111], v9 offset:9216
  ds_read_b64_tr_b16 v[112:113], v9 offset:12288
  ds_read_b64_tr_b16 v[114:115], v9 offset:13312
  ds_read_b64_tr_b16 v[116:117], v9 offset:16384
  ds_read_b64_tr_b16 v[118:119], v9 offset:17408
  s_waitcnt lgkmcnt(0)
  v_mfma_f32_16x16x32_bf16 v[140:143], v[100:103], v[20:23], 0
  v_mfma_f32_16x16x32_bf16 v[144:147], v[104:107], v[20:23], 0
  v_mfma_f32_16x16x32_bf16 v[148:151], v[108:111], v[20:23], 0
  v_mfma_f32_16x16x32_bf16 v[152:155], v[112:115], v[20:23], 0
  v_mfma_f32_16x16x32_bf16 v[156:159], v[116:119], v[20:23], 0
  s_waitcnt vmcnt(20)
  s_barrier
  s_add_u32 m0, s51, 0
  s_add_u32 s46, s66, 122880
  buffer_load_dwordx4 v8, s[4:7], s46 offen lds
  s_add_u32 m0, s51, 4096
  s_add_u32 s46, s66, 123008
  buffer_load_dwordx4 v8, s[4:7], s46 offen lds
  s_add_u32 m0, s51, 8192
  s_add_u32 s46, s66, 123136
  buffer_load_dwordx4 v8, s[4:7], s46 offen lds
  s_add_u32 m0, s51, 12288
  s_add_u32 s46, s66, 123264
  buffer_load_dwordx4 v8, s[4:7], s46 offen lds
  s_add_u32 m0, s51, 16384
  s_add_u32 s46, s66, 123392
  buffer_load_dwordx4 v8, s[4:7], s46 offen lds
  ds_read_b64_tr_b16 v[120:121], v9 offset:20480
  ds_read_b64_tr_b16 v[122:123], v9 offset:21504
  ds_read_b64_tr_b16 v[124:125], v9 offset:24576
  ds_read_b64_tr_b16 v[126:127], v9 offset:25600
  ds_read_b64_tr_b16 v[128:129], v9 offset:28672
  ds_read_b64_tr_b16 v[130:131], v9 offset:29696
  ds_read_b64_tr_b16 v[132:133], v9 offset:32768
  ds_read_b64_tr_b16 v[134:135], v9 offset:33792
  ds_read_b64_tr_b16 v[136:137], v9 offset:36864
  ds_read_b64_tr_b16 v[138:139], v9 offset:37888
  s_waitcnt lgkmcnt(0)
  v_mfma_f32_16x16x32_bf16 v[160:163], v[120:123], v[20:23], 0
  v_mfma_f32_16x16x32_bf16 v[164:167], v[124:127], v[20:23], 0
  v_mfma_f32_16x16x32_bf16 v[168:171], v[128:131], v[20:23], 0
  v_mfma_f32_16x16x32_bf16 v[172:175], v[132:135], v[20:23], 0
  v_mfma_f32_16x16x32_bf16 v[176:179], v[136:139], v[20:23], 0
  s_waitcnt vmcnt(20)
  s_barrier
  s_add_u32 m0, s51, 20480
  s_add_u32 s46, s66, 123520
  buffer_load_dwordx4 v8, s[4:7], s46 offen lds
  s_add_u32 m0, s51, 24576
  s_add_u32 s46, s66, 123648
  buffer_load_dwordx4 v8, s[4:7], s46 offen lds
  s_add_u32 m0, s51, 28672
  s_add_u32 s46, s66, 123776
  buffer_load_dwordx4 v8, s[4:7], s46 offen lds
  s_add_u32 m0, s51, 32768
  s_add_u32 s46, s66, 123904
  buffer_load_dwordx4 v8, s[4:7], s46 offen lds
  s_add_u32 m0, s51, 36864
  s_add_u32 s46, s66, 124032
  buffer_load_dwordx4 v8, s[4:7], s46 offen lds
  ds_read_b64_tr_b16 v[100:101], v9 offset:40960
  ds_read_b64_tr_b16 v[102:103], v9 offset:41984
  ds_read_b64_tr_b16 v[104:105], v9 offset:45056
  ds_read_b64_tr_b16 v[106:107], v9 offset:46080
  ds_read_b64_tr_b16 v[108:109], v9 offset:49152
  ds_read_b64_tr_b16 v[110:111], v9 offset:50176
  ds_read_b64_tr_b16 v[112:113], v9 offset:53248
  ds_read_b64_tr_b16 v[114:115], v9 offset:54272
  ds_read_b64_tr_b16 v[116:117], v9 offset:57344
  ds_read_b64_tr_b16 v[118:119], v9 offset:58368
  s_waitcnt lgkmcnt(0)
  v_mfma_f32_16x16x32_bf16 v[140:143], v[100:103], v[24:27], v[140:143]
  v_mfma_f32_16x16x32_bf16 v[144:147], v[104:107], v[24:27], v[144:147]
  v_mfma_f32_16x16x32_bf16 v[148:151], v[108:111], v[24:27], v[148:151]
  v_mfma_f32_16x16x32_bf16 v[152:155], v[112:115], v[24:27], v[152:155]
  v_mfma_f32_16x16x32_bf16 v[156:159], v[116:119], v[24:27], v[156:159]
  s_waitcnt vmcnt(20)
  s_barrier
  s_add_u32 m0, s51, 40960
  s_add_u32 s46, s66, 163840
  buffer_load_dwordx4 v8, s[4:7], s46 offen lds
  s_add_u32 m0, s51, 45056
  s_add_u32 s46, s66, 163968
  buffer_load_dwordx4 v8, s[4:7], s46 offen lds
  s_add_u32 m0, s51, 49152
  s_add_u32 s46, s66, 164096
  buffer_load_dwordx4 v8, s[4:7], s46 offen lds
  s_add_u32 m0, s51, 53248
  s_add_u32 s46, s66, 164224
  buffer_load_dwordx4 v8, s[4:7], s46 offen lds
  s_add_u32 m0, s51, 57344
  s_add_u32 s46, s66, 164352
  buffer_load_dwordx4 v8, s[4:7], s46 offen lds
  ds_read_b64_tr_b16 v[120:121], v9 offset:61440
  ds_read_b64_tr_b16 v[122:123], v9 offset:62464
  ds_read_b64_tr_b16 v[124:125], v10 offset:0
  ds_read_b64_tr_b16 v[126:127], v10 offset:1024
  ds_read_b64_tr_b16 v[128:129], v10 offset:4096
  ds_read_b64_tr_b16 v[130:131], v10 offset:5120
  ds_read_b64_tr_b16 v[132:133], v10 offset:8192
  ds_read_b64_tr_b16 v[134:135], v10 offset:9216
  ds_read_b64_tr_b16 v[136:137], v10 offset:12288
  ds_read_b64_tr_b16 v[138:139], v10 offset:13312
  s_waitcnt lgkmcnt(0)
  v_mfma_f32_16x16x32_bf16 v[160:163], v[120:123], v[24:27], v[160:163]
  v_mfma_f32_16x16x32_bf16 v[164:167], v[124:127], v[24:27], v[164:167]
  v_mfma_f32_16x16x32_bf16 v[168:171], v[128:131], v[24:27], v[168:171]
  v_mfma_f32_16x16x32_bf16 v[172:175], v[132:135], v[24:27], v[172:175]
  v_mfma_f32_16x16x32_bf16 v[176:179], v[136:139], v[24:27], v[176:179]
  s_waitcnt vmcnt(20)
  s_barrier
  s_add_u32 m0, s51, 61440
  s_add_u32 s46, s66, 164480
  buffer_load_dwordx4 v8, s[4:7], s46 offen lds
  s_add_u32 m0, s51, 65536
  s_add_u32 s46, s66, 164608
  buffer_load_dwordx4 v8, s[4:7], s46 offen lds
  s_add_u32 m0, s51, 69632
  s_add_u32 s46, s66, 164736
  buffer_load_dwordx4 v8, s[4:7], s46 offen lds
  s_add_u32 m0, s51, 73728
  s_add_u32 s46, s66, 164864
  buffer_load_dwordx4 v8, s[4:7], s46 offen lds
  s_add_u32 m0, s51, 77824
  s_add_u32 s46, s66, 164992
  buffer_load_dwordx4 v8, s[4:7], s46 offen lds
  ds_read_b64_tr_b16 v[100:101], v10 offset:16384
  ds_read_b64_tr_b16 v[102:103], v10 offset:17408
  ds_read_b64_tr_b16 v[104:105], v10 offset:20480
  ds_read_b64_tr_b16 v[106:107], v10 offset:21504
  ds_read_b64_tr_b16 v[108:109], v10 offset:24576
  ds_read_b64_tr_b16 v[110:111], v10 offset:25600
  ds_read_b64_tr_b16 v[112:113], v10 offset:28672
  ds_read_b64_tr_b16 v[114:115], v10 offset:29696
  ds_read_b64_tr_b16 v[116:117], v10 offset:32768
  ds_read_b64_tr_b16 v[118:119], v10 offset:33792
  s_waitcnt lgkmcnt(0)
  v_mfma_f32_16x16x32_bf16 v[140:143], v[100:103], v[28:31], v[140:143]
  v_mfma_f32_16x16x32_bf16 v[144:147], v[104:107], v[28:31], v[144:147]
  v_mfma_f32_16x16x32_bf16 v[148:151], v[108:111], v[28:31], v[148:151]
  v_mfma_f32_16x16x32_bf16 v[152:155], v[112:115], v[28:31], v[152:155]
  v_mfma_f32_16x16x32_bf16 v[156:159], v[116:119], v[28:31], v[156:159]
  s_waitcnt vmcnt(20)
  s_barrier
  s_add_u32 m0, s51, 81920
  s_add_u32 s46, s66, 204800
  buffer_load_dwordx4 v8, s[4:7], s46 offen lds
  s_add_u32 m0, s51, 86016
  s_add_u32 s46, s66, 204928
  buffer_load_dwordx4 v8, s[4:7], s46 offen lds
  s_add_u32 m0, s51, 90112
  s_add_u32 s46, s66, 205056
  buffer_load_dwordx4 v8, s[4:7], s46 offen lds
  s_add_u32 m0, s51, 94208
  s_add_u32 s46, s66, 205184
  buffer_load_dwordx4 v8, s[4:7], s46 offen lds
  s_add_u32 m0, s51, 98304
  s_add_u32 s46, s66, 205312
  buffer_load_dwordx4 v8, s[4:7], s46 offen lds
  ds_read_b64_tr_b16 v[120:121], v10 offset:36864
  ds_read_b64_tr_b16 v[122:123], v10 offset:37888
  ds_read_b64_tr_b16 v[124:125], v10 offset:40960
  ds_read_b64_tr_b16 v[126:127], v10 offset:41984
  ds_read_b64_tr_b16 v[128:129], v10 offset:45056
  ds_read_b64_tr_b16 v[130:131], v10 offset:46080
  ds_read_b64_tr_b16 v[132:133], v10 offset:49152
  ds_read_b64_tr_b16 v[134:135], v10 offset:50176
  ds_read_b64_tr_b16 v[136:137], v10 offset:53248
  ds_read_b64_tr_b16 v[138:139], v10 offset:54272
  s_waitcnt lgkmcnt(0)
  v_mfma_f32_16x16x32_bf16 v[160:163], v[120:123], v[28:31], v[160:163]
  v_mfma_f32_16x16x32_bf16 v[164:167], v[124:127], v[28:31], v[164:167]
  v_mfma_f32_16x16x32_bf16 v[168:171], v[128:131], v[28:31], v[168:171]
  v_mfma_f32_16x16x32_bf16 v[172:175], v[132:135], v[28:31], v[172:175]
  v_mfma_f32_16x16x32_bf16 v[176:179], v[136:139], v[28:31], v[176:179]
  s_waitcnt vmcnt(20)
  s_barrier
  s_add_u32 m0, s51, 102400
  s_add_u32 s46, s66, 205440
  buffer_load_dwordx4 v8, s[4:7], s46 offen lds
  s_add_u32 m0, s51, 106496
  s_add_u32 s46, s66, 205568
  buffer_load_dwordx4 v8, s[4:7], s46 offen lds
  s_add_u32 m0, s51, 110592
  s_add_u32 s46, s66, 205696
  buffer_load_dwordx4 v8, s[4:7], s46 offen lds
  s_add_u32 m0, s51, 114688
  s_add_u32 s46, s66, 205824
  buffer_load_dwordx4 v8, s[4:7], s46 offen lds
  s_add_u32 m0, s51, 118784
  s_add_u32 s46, s66, 205952
  buffer_load_dwordx4 v8, s[4:7], s46 offen lds
  ds_read_b64_tr_b16 v[100:101], v9 offset:0
  ds_read_b64_tr_b16 v[102:103], v9 offset:1024
  ds_read_b64_tr_b16 v[104:105], v9 offset:4096
  ds_read_b64_tr_b16 v[106:107], v9 offset:5120
  ds_read_b64_tr_b16 v[108:109], v9 offset:8192
  ds_read_b64_tr_b16 v[110:111], v9 offset:9216
  ds_read_b64_tr_b16 v[112:113], v9 offset:12288
  ds_read_b64_tr_b16 v[114:115], v9 offset:13312
  ds_read_b64_tr_b16 v[116:117], v9 offset:16384
  ds_read_b64_tr_b16 v[118:119], v9 offset:17408
  s_waitcnt lgkmcnt(0)
  v_mfma_f32_16x16x32_bf16 v[140:143], v[100:103], v[32:35], v[140:143]
  v_mfma_f32_16x16x32_bf16 v[144:147], v[104:107], v[32:35], v[144:147]
  v_mfma_f32_16x16x32_bf16 v[148:151], v[108:111], v[32:35], v[148:151]
  v_mfma_f32_16x16x32_bf16 v[152:155], v[112:115], v[32:35], v[152:155]
  v_mfma_f32_16x16x32_bf16 v[156:159], v[116:119], v[32:35], v[156:159]
  s_waitcnt vmcnt(20)
  s_barrier
  s_add_u32 m0, s51, 0
  s_add_u32 s46, s66, 245760
  buffer_load_dwordx4 v8, s[4:7], s46 offen lds
  s_add_u32 m0, s51, 4096
  s_add_u32 s46, s66, 245888
  buffer_load_dwordx4 v8, s[4:7], s46 offen lds
  s_add_u32 m0, s51, 8192
  s_add_u32 s46, s66, 246016
  buffer_load_dwordx4 v8, s[4:7], s46 offen lds
  s_add_u32 m0, s51, 12288
  s_add_u32 s46, s66, 246144
  buffer_load_dwordx4 v8, s[4:7], s46 offen lds
  s_add_u32 m0, s51, 16384
  s_add_u32 s46, s66, 246272
  buffer_load_dwordx4 v8, s[4:7], s46 offen lds
  ds_read_b64_tr_b16 v[120:121], v9 offset:20480
  ds_read_b64_tr_b16 v[122:123], v9 offset:21504
  ds_read_b64_tr_b16 v[124:125], v9 offset:24576
  ds_read_b64_tr_b16 v[126:127], v9 offset:25600
  ds_read_b64_tr_b16 v[128:129], v9 offset:28672
  ds_read_b64_tr_b16 v[130:131], v9 offset:29696
  ds_read_b64_tr_b16 v[132:133], v9 offset:32768
  ds_read_b64_tr_b16 v[134:135], v9 offset:33792
  ds_read_b64_tr_b16 v[136:137], v9 offset:36864
  ds_read_b64_tr_b16 v[138:139], v9 offset:37888
  s_waitcnt lgkmcnt(0)
  v_mfma_f32_16x16x32_bf16 v[160:163], v[120:123], v[32:35], v[160:163]
  v_mfma_f32_16x16x32_bf16 v[164:167], v[124:127], v[32:35], v[164:167]
  v_mfma_f32_16x16x32_bf16 v[168:171], v[128:131], v[32:35], v[168:171]
  v_mfma_f32_16x16x32_bf16 v[172:175], v[132:135], v[32:35], v[172:175]
  v_mfma_f32_16x16x32_bf16 v[176:179], v[136:139], v[32:35], v[176:179]
  s_waitcnt vmcnt(20)
  s_barrier
  s_add_u32 m0, s51, 20480
  s_add_u32 s46, s66, 246400
  buffer_load_dwordx4 v8, s[4:7], s46 offen lds
  s_add_u32 m0, s51, 24576
  s_add_u32 s46, s66, 246528
  buffer_load_dwordx4 v8, s[4:7], s46 offen lds
  s_add_u32 m0, s51, 28672
  s_add_u32 s46, s66, 246656
  buffer_load_dwordx4 v8, s[4:7], s46 offen lds
  s_add_u32 m0, s51, 32768
  s_add_u32 s46, s66, 246784
  buffer_load_dwordx4 v8, s[4:7], s46 offen lds
  s_add_u32 m0, s51, 36864
  s_add_u32 s46, s66, 246912
  buffer_load_dwordx4 v8, s[4:7], s46 offen lds
  ds_read_b64_tr_b16 v[100:101], v9 offset:40960
  ds_read_b64_tr_b16 v[102:103], v9 offset:41984
  ds_read_b64_tr_b16 v[104:105], v9 offset:45056
  ds_read_b64_tr_b16 v[106:107], v9 offset:46080
  ds_read_b64_tr_b16 v[108:109], v9 offset:49152
  ds_read_b64_tr_b16 v[110:111], v9 offset:50176
  ds_read_b64_tr_b16 v[112:113], v9 offset:53248
  ds_read_b64_tr_b16 v[114:115], v9 offset:54272
  ds_read_b64_tr_b16 v[116:117], v9 offset:57344
  ds_read_b64_tr_b16 v[118:119], v9 offset:58368
  s_waitcnt lgkmcnt(0)
  v_mfma_f32_16x16x32_bf16 v[140:143], v[100:103], v[36:39], v[140:143]
  v_mfma_f32_16x16x32_bf16 v[144:147], v[104:107], v[36:39], v[144:147]
  v_mfma_f32_16x16x32_bf16 v[148:151], v[108:111], v[36:39], v[148:151]
  v_mfma_f32_16x16x32_bf16 v[152:155], v[112:115], v[36:39], v[152:155]
  v_mfma_f32_16x16x32_bf16 v[156:159], v[116:119], v[36:39], v[156:159]
  s_waitcnt vmcnt(20)
  s_barrier
  s_add_u32 m0, s51, 40960
  s_add_u32 s46, s66, 286720
  buffer_load_dwordx4 v8, s[4:7], s46 offen lds
  s_add_u32 m0, s51, 45056
  s_add_u32 s46, s66, 286848
  buffer_load_dwordx4 v8, s[4:7], s46 offen lds
  s_add_u32 m0, s51, 49152
  s_add_u32 s46, s66, 286976
  buffer_load_dwordx4 v8, s[4:7], s46 offen lds
  s_add_u32 m0, s51, 53248
  s_add_u32 s46, s66, 287104
  buffer_load_dwordx4 v8, s[4:7], s46 offen lds
  s_add_u32 m0, s51, 57344
  s_add_u32 s46, s66, 287232
  buffer_load_dwordx4 v8, s[4:7], s46 offen lds
  ds_read_b64_tr_b16 v[120:121], v9 offset:61440
  ds_read_b64_tr_b16 v[122:123], v9 offset:62464
  ds_read_b64_tr_b16 v[124:125], v10 offset:0
  ds_read_b64_tr_b16 v[126:127], v10 offset:1024
  ds_read_b64_tr_b16 v[128:129], v10 offset:4096
  ds_read_b64_tr_b16 v[130:131], v10 offset:5120
  ds_read_b64_tr_b16 v[132:133], v10 offset:8192
  ds_read_b64_tr_b16 v[134:135], v10 offset:9216
  ds_read_b64_tr_b16 v[136:137], v10 offset:12288
  ds_read_b64_tr_b16 v[138:139], v10 offset:13312
  s_waitcnt lgkmcnt(0)
  v_mfma_f32_16x16x32_bf16 v[160:163], v[120:123], v[36:39], v[160:163]
  v_mfma_f32_16x16x32_bf16 v[164:167], v[124:127], v[36:39], v[164:167]
  v_mfma_f32_16x16x32_bf16 v[168:171], v[128:131], v[36:39], v[168:171]
  v_mfma_f32_16x16x32_bf16 v[172:175], v[132:135], v[36:39], v[172:175]
  v_mfma_f32_16x16x32_bf16 v[176:179], v[136:139], v[36:39], v[176:179]
  s_waitcnt vmcnt(20)
  s_barrier
  s_add_u32 m0, s51, 61440
  s_add_u32 s46, s66, 287360
  buffer_load_dwordx4 v8, s[4:7], s46 offen lds
  s_add_u32 m0, s51, 65536
  s_add_u32 s46, s66, 287488
  buffer_load_dwordx4 v8, s[4:7], s46 offen lds
  s_add_u32 m0, s51, 69632
  s_add_u32 s46, s66, 287616
  buffer_load_dwordx4 v8, s[4:7], s46 offen lds
  s_add_u32 m0, s51, 73728
  s_add_u32 s46, s66, 287744
  buffer_load_dwordx4 v8, s[4:7], s46 offen lds
  s_add_u32 m0, s51, 77824
  s_add_u32 s46, s66, 287872
  buffer_load_dwordx4 v8, s[4:7], s46 offen lds
  ds_read_b64_tr_b16 v[100:101], v10 offset:16384
  ds_read_b64_tr_b16 v[102:103], v10 offset:17408
  ds_read_b64_tr_b16 v[104:105], v10 offset:20480
  ds_read_b64_tr_b16 v[106:107], v10 offset:21504
  ds_read_b64_tr_b16 v[108:109], v10 offset:24576
  ds_read_b64_tr_b16 v[110:111], v10 offset:25600
  ds_read_b64_tr_b16 v[112:113], v10 offset:28672
  ds_read_b64_tr_b16 v[114:115], v10 offset:29696
  ds_read_b64_tr_b16 v[116:117], v10 offset:32768
  ds_read_b64_tr_b16 v[118:119], v10 offset:33792
  s_waitcnt lgkmcnt(0)
  v_mfma_f32_16x16x32_bf16 v[140:143], v[100:103], v[40:43], v[140:143]
  v_mfma_f32_16x16x32_bf16 v[144:147], v[104:107], v[40:43], v[144:147]
  v_mfma_f32_16x16x32_bf16 v[148:151], v[108:111], v[40:43], v[148:151]
  v_mfma_f32_16x16x32_bf16 v[152:155], v[112:115], v[40:43], v[152:155]
  v_mfma_f32_16x16x32_bf16 v[156:159], v[116:119], v[40:43], v[156:159]
  s_waitcnt vmcnt(20)
  s_barrier
  s_add_u32 m0, s51, 81920
  s_add_u32 s46, s66, 327680
  buffer_load_dwordx4 v8, s[4:7], s46 offen lds
  s_add_u32 m0, s51, 86016
  s_add_u32 s46, s66, 327808
  buffer_load_dwordx4 v8, s[4:7], s46 offen lds
  s_add_u32 m0, s51, 90112
  s_add_u32 s46, s66, 327936
  buffer_load_dwordx4 v8, s[4:7], s46 offen lds
  s_add_u32 m0, s51, 94208
  s_add_u32 s46, s66, 328064
  buffer_load_dwordx4 v8, s[4:7], s46 offen lds
  s_add_u32 m0, s51, 98304
  s_add_u32 s46, s66, 328192
  buffer_load_dwordx4 v8, s[4:7], s46 offen lds
  ds_read_b64_tr_b16 v[120:121], v10 offset:36864
  ds_read_b64_tr_b16 v[122:123], v10 offset:37888
  ds_read_b64_tr_b16 v[124:125], v10 offset:40960
  ds_read_b64_tr_b16 v[126:127], v10 offset:41984
  ds_read_b64_tr_b16 v[128:129], v10 offset:45056
  ds_read_b64_tr_b16 v[130:131], v10 offset:46080
  ds_read_b64_tr_b16 v[132:133], v10 offset:49152
  ds_read_b64_tr_b16 v[134:135], v10 offset:50176
  ds_read_b64_tr_b16 v[136:137], v10 offset:53248
  ds_read_b64_tr_b16 v[138:139], v10 offset:54272
  s_waitcnt lgkmcnt(0)
  v_mfma_f32_16x16x32_bf16 v[160:163], v[120:123], v[40:43], v[160:163]
  v_mfma_f32_16x16x32_bf16 v[164:167], v[124:127], v[40:43], v[164:167]
  v_mfma_f32_16x16x32_bf16 v[168:171], v[128:131], v[40:43], v[168:171]
  v_mfma_f32_16x16x32_bf16 v[172:175], v[132:135], v[40:43], v[172:175]
  v_mfma_f32_16x16x32_bf16 v[176:179], v[136:139], v[40:43], v[176:179]
  s_waitcnt vmcnt(20)
  s_barrier
  s_add_u32 m0, s51, 102400
  s_add_u32 s46, s66, 328320
  buffer_load_dwordx4 v8, s[4:7], s46 offen lds
  s_add_u32 m0, s51, 106496
  s_add_u32 s46, s66, 328448
  buffer_load_dwordx4 v8, s[4:7], s46 offen lds
  s_add_u32 m0, s51, 110592
  s_add_u32 s46, s66, 328576
  buffer_load_dwordx4 v8, s[4:7], s46 offen lds
  s_add_u32 m0, s51, 114688
  s_add_u32 s46, s66, 328704
  buffer_load_dwordx4 v8, s[4:7], s46 offen lds
  s_add_u32 m0, s51, 118784
  s_add_u32 s46, s66, 328832
  buffer_load_dwordx4 v8, s[4:7], s46 offen lds
  ds_read_b64_tr_b16 v[100:101], v9 offset:0
  ds_read_b64_tr_b16 v[102:103], v9 offset:1024
  ds_read_b64_tr_b16 v[104:105], v9 offset:4096
  ds_read_b64_tr_b16 v[106:107], v9 offset:5120
  ds_read_b64_tr_b16 v[108:109], v9 offset:8192
  ds_read_b64_tr_b16 v[110:111], v9 offset:9216
  ds_read_b64_tr_b16 v[112:113], v9 offset:12288
  ds_read_b64_tr_b16 v[114:115], v9 offset:13312
  ds_read_b64_tr_b16 v[116:117], v9 offset:16384
  ds_read_b64_tr_b16 v[118:119], v9 offset:17408
  s_waitcnt lgkmcnt(0)
  v_mfma_f32_16x16x32_bf16 v[140:143], v[100:103], v[44:47], v[140:143]
  v_mfma_f32_16x16x32_bf16 v[144:147], v[104:107], v[44:47], v[144:147]
  v_mfma_f32_16x16x32_bf16 v[148:151], v[108:111], v[44:47], v[148:151]
  v_mfma_f32_16x16x32_bf16 v[152:155], v[112:115], v[44:47], v[152:155]
  v_mfma_f32_16x16x32_bf16 v[156:159], v[116:119], v[44:47], v[156:159]
  s_waitcnt vmcnt(20)
  s_barrier
  s_add_u32 m0, s51, 0
  s_add_u32 s46, s66, 368640
  buffer_load_dwordx4 v8, s[4:7], s46 offen lds
  s_add_u32 m0, s51, 4096
  s_add_u32 s46, s66, 368768
  buffer_load_dwordx4 v8, s[4:7], s46 offen lds
  s_add_u32 m0, s51, 8192
  s_add_u32 s46, s66, 368896
  buffer_load_dwordx4 v8, s[4:7], s46 offen lds
  s_add_u32 m0, s51, 12288
  s_add_u32 s46, s66, 369024
  buffer_load_dwordx4 v8, s[4:7], s46 offen lds
  s_add_u32 m0, s51, 16384
  s_add_u32 s46, s66, 369152
  buffer_load_dwordx4 v8, s[4:7], s46 offen lds
  ds_read_b64_tr_b16 v[120:121], v9 offset:20480
  ds_read_b64_tr_b16 v[122:123], v9 offset:21504
  ds_read_b64_tr_b16 v[124:125], v9 offset:24576
  ds_read_b64_tr_b16 v[126:127], v9 offset:25600
  ds_read_b64_tr_b16 v[128:129], v9 offset:28672
  ds_read_b64_tr_b16 v[130:131], v9 offset:29696
  ds_read_b64_tr_b16 v[132:133], v9 offset:32768
  ds_read_b64_tr_b16 v[134:135], v9 offset:33792
  ds_read_b64_tr_b16 v[136:137], v9 offset:36864
  ds_read_b64_tr_b16 v[138:139], v9 offset:37888
  s_waitcnt lgkmcnt(0)
  v_mfma_f32_16x16x32_bf16 v[160:163], v[120:123], v[44:47], v[160:163]
  v_mfma_f32_16x16x32_bf16 v[164:167], v[124:127], v[44:47], v[164:167]
  v_mfma_f32_16x16x32_bf16 v[168:171], v[128:131], v[44:47], v[168:171]
  v_mfma_f32_16x16x32_bf16 v[172:175], v[132:135], v[44:47], v[172:175]
  v_mfma_f32_16x16x32_bf16 v[176:179], v[136:139], v[44:47], v[176:179]
  s_waitcnt vmcnt(20)
  s_barrier
  s_add_u32 m0, s51, 20480
  s_add_u32 s46, s66, 369280
  buffer_load_dwordx4 v8, s[4:7], s46 offen lds
  s_add_u32 m0, s51, 24576
  s_add_u32 s46, s66, 369408
  buffer_load_dwordx4 v8, s[4:7], s46 offen lds
  s_add_u32 m0, s51, 28672
  s_add_u32 s46, s66, 369536
  buffer_load_dwordx4 v8, s[4:7], s46 offen lds
  s_add_u32 m0, s51, 32768
  s_add_u32 s46, s66, 369664
  buffer_load_dwordx4 v8, s[4:7], s46 offen lds
  s_add_u32 m0, s51, 36864
  s_add_u32 s46, s66, 369792
  buffer_load_dwordx4 v8, s[4:7], s46 offen lds
  ds_read_b64_tr_b16 v[100:101], v9 offset:40960
  ds_read_b64_tr_b16 v[102:103], v9 offset:41984
  ds_read_b64_tr_b16 v[104:105], v9 offset:45056
  ds_read_b64_tr_b16 v[106:107], v9 offset:46080
  ds_read_b64_tr_b16 v[108:109], v9 offset:49152
  ds_read_b64_tr_b16 v[110:111], v9 offset:50176
  ds_read_b64_tr_b16 v[112:113], v9 offset:53248
  ds_read_b64_tr_b16 v[114:115], v9 offset:54272
  ds_read_b64_tr_b16 v[116:117], v9 offset:57344
  ds_read_b64_tr_b16 v[118:119], v9 offset:58368
  s_waitcnt lgkmcnt(0)
  v_mfma_f32_16x16x32_bf16 v[140:143], v[100:103], v[48:51], v[140:143]
  v_mfma_f32_16x16x32_bf16 v[144:147], v[104:107], v[48:51], v[144:147]
  v_mfma_f32_16x16x32_bf16 v[148:151], v[108:111], v[48:51], v[148:151]
  v_mfma_f32_16x16x32_bf16 v[152:155], v[112:115], v[48:51], v[152:155]
  v_mfma_f32_16x16x32_bf16 v[156:159], v[116:119], v[48:51], v[156:159]
  s_waitcnt vmcnt(20)
  s_barrier
  s_add_u32 m0, s51, 40960
  s_add_u32 s46, s66, 409600
  buffer_load_dwordx4 v8, s[4:7], s46 offen lds
  s_add_u32 m0, s51, 45056
  s_add_u32 s46, s66, 409728
  buffer_load_dwordx4 v8, s[4:7], s46 offen lds
  s_add_u32 m0, s51, 49152
  s_add_u32 s46, s66, 409856
  buffer_load_dwordx4 v8, s[4:7], s46 offen lds
  s_add_u32 m0, s51, 53248
  s_add_u32 s46, s66, 409984
  buffer_load_dwordx4 v8, s[4:7], s46 offen lds
  s_add_u32 m0, s51, 57344
  s_add_u32 s46, s66, 410112
  buffer_load_dwordx4 v8, s[4:7], s46 offen lds
  ds_read_b64_tr_b16 v[120:121], v9 offset:61440
  ds_read_b64_tr_b16 v[122:123], v9 offset:62464
  ds_read_b64_tr_b16 v[124:125], v10 offset:0
  ds_read_b64_tr_b16 v[126:127], v10 offset:1024
  ds_read_b64_tr_b16 v[128:129], v10 offset:4096
  ds_read_b64_tr_b16 v[130:131], v10 offset:5120
  ds_read_b64_tr_b16 v[132:133], v10 offset:8192
  ds_read_b64_tr_b16 v[134:135], v10 offset:9216
  ds_read_b64_tr_b16 v[136:137], v10 offset:12288
  ds_read_b64_tr_b16 v[138:139], v10 offset:13312
  s_waitcnt lgkmcnt(0)
  v_mfma_f32_16x16x32_bf16 v[160:163], v[120:123], v[48:51], v[160:163]
  v_mfma_f32_16x16x32_bf16 v[164:167], v[124:127], v[48:51], v[164:167]
  v_mfma_f32_16x16x32_bf16 v[168:171], v[128:131], v[48:51], v[168:171]
  v_mfma_f32_16x16x32_bf16 v[172:175], v[132:135], v[48:51], v[172:175]
  v_mfma_f32_16x16x32_bf16 v[176:179], v[136:139], v[48:51], v[176:179]
  s_waitcnt vmcnt(20)
  s_barrier
  s_add_u32 m0, s51, 61440
  s_add_u32 s46, s66, 410240
  buffer_load_dwordx4 v8, s[4:7], s46 offen lds
  s_add_u32 m0, s51, 65536
  s_add_u32 s46, s66, 410368
  buffer_load_dwordx4 v8, s[4:7], s46 offen lds
  s_add_u32 m0, s51, 69632
  s_add_u32 s46, s66, 410496
  buffer_load_dwordx4 v8, s[4:7], s46 offen lds
  s_add_u32 m0, s51, 73728
  s_add_u32 s46, s66, 410624
  buffer_load_dwordx4 v8, s[4:7], s46 offen lds
  s_add_u32 m0, s51, 77824
  s_add_u32 s46, s66, 410752
  buffer_load_dwordx4 v8, s[4:7], s46 offen lds
  ds_read_b64_tr_b16 v[100:101], v10 offset:16384
  ds_read_b64_tr_b16 v[102:103], v10 offset:17408
  ds_read_b64_tr_b16 v[104:105], v10 offset:20480
  ds_read_b64_tr_b16 v[106:107], v10 offset:21504
  ds_read_b64_tr_b16 v[108:109], v10 offset:24576
  ds_read_b64_tr_b16 v[110:111], v10 offset:25600
  ds_read_b64_tr_b16 v[112:113], v10 offset:28672
  ds_read_b64_tr_b16 v[114:115], v10 offset:29696
  ds_read_b64_tr_b16 v[116:117], v10 offset:32768
  ds_read_b64_tr_b16 v[118:119], v10 offset:33792
  s_waitcnt lgkmcnt(0)
  v_mfma_f32_16x16x32_bf16 v[140:143], v[100:103], v[52:55], v[140:143]
  v_mfma_f32_16x16x32_bf16 v[144:147], v[104:107], v[52:55], v[144:147]
  v_mfma_f32_16x16x32_bf16 v[148:151], v[108:111], v[52:55], v[148:151]
  v_mfma_f32_16x16x32_bf16 v[152:155], v[112:115], v[52:55], v[152:155]
  v_mfma_f32_16x16x32_bf16 v[156:159], v[116:119], v[52:55], v[156:159]
  s_waitcnt vmcnt(20)
  s_barrier
  s_add_u32 m0, s51, 81920
  s_add_u32 s46, s66, 450560
  buffer_load_dwordx4 v8, s[4:7], s46 offen lds
  s_add_u32 m0, s51, 86016
  s_add_u32 s46, s66, 450688
  buffer_load_dwordx4 v8, s[4:7], s46 offen lds
  s_add_u32 m0, s51, 90112
  s_add_u32 s46, s66, 450816
  buffer_load_dwordx4 v8, s[4:7], s46 offen lds
  s_add_u32 m0, s51, 94208
  s_add_u32 s46, s66, 450944
  buffer_load_dwordx4 v8, s[4:7], s46 offen lds
  s_add_u32 m0, s51, 98304
  s_add_u32 s46, s66, 451072
  buffer_load_dwordx4 v8, s[4:7], s46 offen lds
  ds_read_b64_tr_b16 v[120:121], v10 offset:36864
  ds_read_b64_tr_b16 v[122:123], v10 offset:37888
  ds_read_b64_tr_b16 v[124:125], v10 offset:40960
  ds_read_b64_tr_b16 v[126:127], v10 offset:41984
  ds_read_b64_tr_b16 v[128:129], v10 offset:45056
  ds_read_b64_tr_b16 v[130:131], v10 offset:46080
  ds_read_b64_tr_b16 v[132:133], v10 offset:49152
  ds_read_b64_tr_b16 v[134:135], v10 offset:50176
  ds_read_b64_tr_b16 v[136:137], v10 offset:53248
  ds_read_b64_tr_b16 v[138:139], v10 offset:54272
  s_waitcnt lgkmcnt(0)
  v_mfma_f32_16x16x32_bf16 v[160:163], v[120:123], v[52:55], v[160:163]
  v_mfma_f32_16x16x32_bf16 v[164:167], v[124:127], v[52:55], v[164:167]
  v_mfma_f32_16x16x32_bf16 v[168:171], v[128:131], v[52:55], v[168:171]
  v_mfma_f32_16x16x32_bf16 v[172:175], v[132:135], v[52:55], v[172:175]
  v_mfma_f32_16x16x32_bf16 v[176:179], v[136:139], v[52:55], v[176:179]
  s_waitcnt vmcnt(20)
  s_barrier
  s_add_u32 m0, s51, 102400
  s_add_u32 s46, s66, 451200
  buffer_load_dwordx4 v8, s[4:7], s46 offen lds
  s_add_u32 m0, s51, 106496
  s_add_u32 s46, s66, 451328
  buffer_load_dwordx4 v8, s[4:7], s46 offen lds
  s_add_u32 m0, s51, 110592
  s_add_u32 s46, s66, 451456
  buffer_load_dwordx4 v8, s[4:7], s46 offen lds
  s_add_u32 m0, s51, 114688
  s_add_u32 s46, s66, 451584
  buffer_load_dwordx4 v8, s[4:7], s46 offen lds
  s_add_u32 m0, s51, 118784
  s_add_u32 s46, s66, 451712
  buffer_load_dwordx4 v8, s[4:7], s46 offen lds
  ds_read_b64_tr_b16 v[100:101], v9 offset:0
  ds_read_b64_tr_b16 v[102:103], v9 offset:1024
  ds_read_b64_tr_b16 v[104:105], v9 offset:4096
  ds_read_b64_tr_b16 v[106:107], v9 offset:5120
  ds_read_b64_tr_b16 v[108:109], v9 offset:8192
  ds_read_b64_tr_b16 v[110:111], v9 offset:9216
  ds_read_b64_tr_b16 v[112:113], v9 offset:12288
  ds_read_b64_tr_b16 v[114:115], v9 offset:13312
  ds_read_b64_tr_b16 v[116:117], v9 offset:16384
  ds_read_b64_tr_b16 v[118:119], v9 offset:17408
  s_waitcnt lgkmcnt(0)
  v_mfma_f32_16x16x32_bf16 v[140:143], v[100:103], v[56:59], v[140:143]
  v_mfma_f32_16x16x32_bf16 v[144:147], v[104:107], v[56:59], v[144:147]
  v_mfma_f32_16x16x32_bf16 v[148:151], v[108:111], v[56:59], v[148:151]
  v_mfma_f32_16x16x32_bf16 v[152:155], v[112:115], v[56:59], v[152:155]
  v_mfma_f32_16x16x32_bf16 v[156:159], v[116:119], v[56:59], v[156:159]
  s_waitcnt vmcnt(20)
  s_barrier
  s_add_u32 m0, s51, 0
  s_add_u32 s46, s66, 491520
  buffer_load_dwordx4 v8, s[4:7], s46 offen lds
  s_add_u32 m0, s51, 4096
  s_add_u32 s46, s66, 491648
  buffer_load_dwordx4 v8, s[4:7], s46 offen lds
  s_add_u32 m0, s51, 8192
  s_add_u32 s46, s66, 491776
  buffer_load_dwordx4 v8, s[4:7], s46 offen lds
  s_add_u32 m0, s51, 12288
  s_add_u32 s46, s66, 491904
  buffer_load_dwordx4 v8, s[4:7], s46 offen lds
  s_add_u32 m0, s51, 16384
  s_add_u32 s46, s66, 492032
  buffer_load_dwordx4 v8, s[4:7], s46 offen lds
  ds_read_b64_tr_b16 v[120:121], v9 offset:20480
  ds_read_b64_tr_b16 v[122:123], v9 offset:21504
  ds_read_b64_tr_b16 v[124:125], v9 offset:24576
  ds_read_b64_tr_b16 v[126:127], v9 offset:25600
  ds_read_b64_tr_b16 v[128:129], v9 offset:28672
  ds_read_b64_tr_b16 v[130:131], v9 offset:29696
  ds_read_b64_tr_b16 v[132:133], v9 offset:32768
  ds_read_b64_tr_b16 v[134:135], v9 offset:33792
  ds_read_b64_tr_b16 v[136:137], v9 offset:36864
  ds_read_b64_tr_b16 v[138:139], v9 offset:37888
  s_waitcnt lgkmcnt(0)
  v_mfma_f32_16x16x32_bf16 v[160:163], v[120:123], v[56:59], v[160:163]
  v_mfma_f32_16x16x32_bf16 v[164:167], v[124:127], v[56:59], v[164:167]
  v_mfma_f32_16x16x32_bf16 v[168:171], v[128:131], v[56:59], v[168:171]
  v_mfma_f32_16x16x32_bf16 v[172:175], v[132:135], v[56:59], v[172:175]
  v_mfma_f32_16x16x32_bf16 v[176:179], v[136:139], v[56:59], v[176:179]
  s_waitcnt vmcnt(20)
  s_barrier
  s_add_u32 m0, s51, 20480
  s_add_u32 s46, s66, 492160
  buffer_load_dwordx4 v8, s[4:7], s46 offen lds
  s_add_u32 m0, s51, 24576
  s_add_u32 s46, s66, 492288
  buffer_load_dwordx4 v8, s[4:7], s46 offen lds
  s_add_u32 m0, s51, 28672
  s_add_u32 s46, s66, 492416
  buffer_load_dwordx4 v8, s[4:7], s46 offen lds
  s_add_u32 m0, s51, 32768
  s_add_u32 s46, s66, 492544
  buffer_load_dwordx4 v8, s[4:7], s46 offen lds
  s_add_u32 m0, s51, 36864
  s_add_u32 s46, s66, 492672
  buffer_load_dwordx4 v8, s[4:7], s46 offen lds
  ds_read_b64_tr_b16 v[100:101], v9 offset:40960
  ds_read_b64_tr_b16 v[102:103], v9 offset:41984
  ds_read_b64_tr_b16 v[104:105], v9 offset:45056
  ds_read_b64_tr_b16 v[106:107], v9 offset:46080
  ds_read_b64_tr_b16 v[108:109], v9 offset:49152
  ds_read_b64_tr_b16 v[110:111], v9 offset:50176
  ds_read_b64_tr_b16 v[112:113], v9 offset:53248
  ds_read_b64_tr_b16 v[114:115], v9 offset:54272
  ds_read_b64_tr_b16 v[116:117], v9 offset:57344
  ds_read_b64_tr_b16 v[118:119], v9 offset:58368
  s_waitcnt lgkmcnt(0)
  v_mfma_f32_16x16x32_bf16 v[140:143], v[100:103], v[60:63], v[140:143]
  v_mfma_f32_16x16x32_bf16 v[144:147], v[104:107], v[60:63], v[144:147]
  v_mfma_f32_16x16x32_bf16 v[148:151], v[108:111], v[60:63], v[148:151]
  v_mfma_f32_16x16x32_bf16 v[152:155], v[112:115], v[60:63], v[152:155]
  v_mfma_f32_16x16x32_bf16 v[156:159], v[116:119], v[60:63], v[156:159]
  s_waitcnt vmcnt(20)
  s_barrier
  s_add_u32 m0, s51, 40960
  s_add_u32 s46, s66, 532480
  buffer_load_dwordx4 v8, s[4:7], s46 offen lds
  s_add_u32 m0, s51, 45056
  s_add_u32 s46, s66, 532608
  buffer_load_dwordx4 v8, s[4:7], s46 offen lds
  s_add_u32 m0, s51, 49152
  s_add_u32 s46, s66, 532736
  buffer_load_dwordx4 v8, s[4:7], s46 offen lds
  s_add_u32 m0, s51, 53248
  s_add_u32 s46, s66, 532864
  buffer_load_dwordx4 v8, s[4:7], s46 offen lds
  s_add_u32 m0, s51, 57344
  s_add_u32 s46, s66, 532992
  buffer_load_dwordx4 v8, s[4:7], s46 offen lds
  ds_read_b64_tr_b16 v[120:121], v9 offset:61440
  ds_read_b64_tr_b16 v[122:123], v9 offset:62464
  ds_read_b64_tr_b16 v[124:125], v10 offset:0
  ds_read_b64_tr_b16 v[126:127], v10 offset:1024
  ds_read_b64_tr_b16 v[128:129], v10 offset:4096
  ds_read_b64_tr_b16 v[130:131], v10 offset:5120
  ds_read_b64_tr_b16 v[132:133], v10 offset:8192
  ds_read_b64_tr_b16 v[134:135], v10 offset:9216
  ds_read_b64_tr_b16 v[136:137], v10 offset:12288
  ds_read_b64_tr_b16 v[138:139], v10 offset:13312
  s_waitcnt lgkmcnt(0)
  v_mfma_f32_16x16x32_bf16 v[160:163], v[120:123], v[60:63], v[160:163]
  v_mfma_f32_16x16x32_bf16 v[164:167], v[124:127], v[60:63], v[164:167]
  v_mfma_f32_16x16x32_bf16 v[168:171], v[128:131], v[60:63], v[168:171]
  v_mfma_f32_16x16x32_bf16 v[172:175], v[132:135], v[60:63], v[172:175]
  v_mfma_f32_16x16x32_bf16 v[176:179], v[136:139], v[60:63], v[176:179]
  s_waitcnt vmcnt(20)
  s_barrier
  s_add_u32 m0, s51, 61440
  s_add_u32 s46, s66, 533120
  buffer_load_dwordx4 v8, s[4:7], s46 offen lds
  s_add_u32 m0, s51, 65536
  s_add_u32 s46, s66, 533248
  buffer_load_dwordx4 v8, s[4:7], s46 offen lds
  s_add_u32 m0, s51, 69632
  s_add_u32 s46, s66, 533376
  buffer_load_dwordx4 v8, s[4:7], s46 offen lds
  s_add_u32 m0, s51, 73728
  s_add_u32 s46, s66, 533504
  buffer_load_dwordx4 v8, s[4:7], s46 offen lds
  s_add_u32 m0, s51, 77824
  s_add_u32 s46, s66, 533632
  buffer_load_dwordx4 v8, s[4:7], s46 offen lds
  ds_read_b64_tr_b16 v[100:101], v10 offset:16384
  ds_read_b64_tr_b16 v[102:103], v10 offset:17408
  ds_read_b64_tr_b16 v[104:105], v10 offset:20480
  ds_read_b64_tr_b16 v[106:107], v10 offset:21504
  ds_read_b64_tr_b16 v[108:109], v10 offset:24576
  ds_read_b64_tr_b16 v[110:111], v10 offset:25600
  ds_read_b64_tr_b16 v[112:113], v10 offset:28672
  ds_read_b64_tr_b16 v[114:115], v10 offset:29696
  ds_read_b64_tr_b16 v[116:117], v10 offset:32768
  ds_read_b64_tr_b16 v[118:119], v10 offset:33792
  s_waitcnt lgkmcnt(0)
  v_mfma_f32_16x16x32_bf16 v[140:143], v[100:103], v[64:67], v[140:143]
  v_mfma_f32_16x16x32_bf16 v[144:147], v[104:107], v[64:67], v[144:147]
  v_mfma_f32_16x16x32_bf16 v[148:151], v[108:111], v[64:67], v[148:151]
  v_mfma_f32_16x16x32_bf16 v[152:155], v[112:115], v[64:67], v[152:155]
  v_mfma_f32_16x16x32_bf16 v[156:159], v[116:119], v[64:67], v[156:159]
  s_waitcnt vmcnt(20)
  s_barrier
  s_add_u32 m0, s51, 81920
  s_add_u32 s46, s66, 573440
  buffer_load_dwordx4 v8, s[4:7], s46 offen lds
  s_add_u32 m0, s51, 86016
  s_add_u32 s46, s66, 573568
  buffer_load_dwordx4 v8, s[4:7], s46 offen lds
  s_add_u32 m0, s51, 90112
  s_add_u32 s46, s66, 573696
  buffer_load_dwordx4 v8, s[4:7], s46 offen lds
  s_add_u32 m0, s51, 94208
  s_add_u32 s46, s66, 573824
  buffer_load_dwordx4 v8, s[4:7], s46 offen lds
  s_add_u32 m0, s51, 98304
  s_add_u32 s46, s66, 573952
  buffer_load_dwordx4 v8, s[4:7], s46 offen lds
  ds_read_b64_tr_b16 v[120:121], v10 offset:36864
  ds_read_b64_tr_b16 v[122:123], v10 offset:37888
  ds_read_b64_tr_b16 v[124:125], v10 offset:40960
  ds_read_b64_tr_b16 v[126:127], v10 offset:41984
  ds_read_b64_tr_b16 v[128:129], v10 offset:45056
  ds_read_b64_tr_b16 v[130:131], v10 offset:46080
  ds_read_b64_tr_b16 v[132:133], v10 offset:49152
  ds_read_b64_tr_b16 v[134:135], v10 offset:50176
  ds_read_b64_tr_b16 v[136:137], v10 offset:53248
  ds_read_b64_tr_b16 v[138:139], v10 offset:54272
  s_waitcnt lgkmcnt(0)
  v_mfma_f32_16x16x32_bf16 v[160:163], v[120:123], v[64:67], v[160:163]
  v_mfma_f32_16x16x32_bf16 v[164:167], v[124:127], v[64:67], v[164:167]
  v_mfma_f32_16x16x32_bf16 v[168:171], v[128:131], v[64:67], v[168:171]
  v_mfma_f32_16x16x32_bf16 v[172:175], v[132:135], v[64:67], v[172:175]
  v_mfma_f32_16x16x32_bf16 v[176:179], v[136:139], v[64:67], v[176:179]
  s_waitcnt vmcnt(20)
  s_barrier
  s_add_u32 m0, s51, 102400
  s_add_u32 s46, s66, 574080
  buffer_load_dwordx4 v8, s[4:7], s46 offen lds
  s_add_u32 m0, s51, 106496
  s_add_u32 s46, s66, 574208
  buffer_load_dwordx4 v8, s[4:7], s46 offen lds
  s_add_u32 m0, s51, 110592
  s_add_u32 s46, s66, 574336
  buffer_load_dwordx4 v8, s[4:7], s46 offen lds
  s_add_u32 m0, s51, 114688
  s_add_u32 s46, s66, 574464
  buffer_load_dwordx4 v8, s[4:7], s46 offen lds
  s_add_u32 m0, s51, 118784
  s_add_u32 s46, s66, 574592
  buffer_load_dwordx4 v8, s[4:7], s46 offen lds
  ds_read_b64_tr_b16 v[100:101], v9 offset:0
  ds_read_b64_tr_b16 v[102:103], v9 offset:1024
  ds_read_b64_tr_b16 v[104:105], v9 offset:4096
  ds_read_b64_tr_b16 v[106:107], v9 offset:5120
  ds_read_b64_tr_b16 v[108:109], v9 offset:8192
  ds_read_b64_tr_b16 v[110:111], v9 offset:9216
  ds_read_b64_tr_b16 v[112:113], v9 offset:12288
  ds_read_b64_tr_b16 v[114:115], v9 offset:13312
  ds_read_b64_tr_b16 v[116:117], v9 offset:16384
  ds_read_b64_tr_b16 v[118:119], v9 offset:17408
  s_waitcnt lgkmcnt(0)
  v_mfma_f32_16x16x32_bf16 v[140:143], v[100:103], v[68:71], v[140:143]
  v_mfma_f32_16x16x32_bf16 v[144:147], v[104:107], v[68:71], v[144:147]
  v_mfma_f32_16x16x32_bf16 v[148:151], v[108:111], v[68:71], v[148:151]
  v_mfma_f32_16x16x32_bf16 v[152:155], v[112:115], v[68:71], v[152:155]
  v_mfma_f32_16x16x32_bf16 v[156:159], v[116:119], v[68:71], v[156:159]
  s_waitcnt vmcnt(20)
  s_barrier
  s_add_u32 m0, s51, 0
  s_add_u32 s46, s66, 614400
  buffer_load_dwordx4 v8, s[4:7], s46 offen lds
  s_add_u32 m0, s51, 4096
  s_add_u32 s46, s66, 614528
  buffer_load_dwordx4 v8, s[4:7], s46 offen lds
  s_add_u32 m0, s51, 8192
  s_add_u32 s46, s66, 614656
  buffer_load_dwordx4 v8, s[4:7], s46 offen lds
  s_add_u32 m0, s51, 12288
  s_add_u32 s46, s66, 614784
  buffer_load_dwordx4 v8, s[4:7], s46 offen lds
  s_add_u32 m0, s51, 16384
  s_add_u32 s46, s66, 614912
  buffer_load_dwordx4 v8, s[4:7], s46 offen lds
  ds_read_b64_tr_b16 v[120:121], v9 offset:20480
  ds_read_b64_tr_b16 v[122:123], v9 offset:21504
  ds_read_b64_tr_b16 v[124:125], v9 offset:24576
  ds_read_b64_tr_b16 v[126:127], v9 offset:25600
  ds_read_b64_tr_b16 v[128:129], v9 offset:28672
  ds_read_b64_tr_b16 v[130:131], v9 offset:29696
  ds_read_b64_tr_b16 v[132:133], v9 offset:32768
  ds_read_b64_tr_b16 v[134:135], v9 offset:33792
  ds_read_b64_tr_b16 v[136:137], v9 offset:36864
  ds_read_b64_tr_b16 v[138:139], v9 offset:37888
  s_waitcnt lgkmcnt(0)
  v_mfma_f32_16x16x32_bf16 v[160:163], v[120:123], v[68:71], v[160:163]
  v_mfma_f32_16x16x32_bf16 v[164:167], v[124:127], v[68:71], v[164:167]
  v_mfma_f32_16x16x32_bf16 v[168:171], v[128:131], v[68:71], v[168:171]
  v_mfma_f32_16x16x32_bf16 v[172:175], v[132:135], v[68:71], v[172:175]
  v_mfma_f32_16x16x32_bf16 v[176:179], v[136:139], v[68:71], v[176:179]
  s_waitcnt vmcnt(20)
  s_barrier
  s_add_u32 m0, s51, 20480
  s_add_u32 s46, s66, 615040
  buffer_load_dwordx4 v8, s[4:7], s46 offen lds
  s_add_u32 m0, s51, 24576
  s_add_u32 s46, s66, 615168
  buffer_load_dwordx4 v8, s[4:7], s46 offen lds
  s_add_u32 m0, s51, 28672
  s_add_u32 s46, s66, 615296
  buffer_load_dwordx4 v8, s[4:7], s46 offen lds
  s_add_u32 m0, s51, 32768
  s_add_u32 s46, s66, 615424
  buffer_load_dwordx4 v8, s[4:7], s46 offen lds
  s_add_u32 m0, s51, 36864
  s_add_u32 s46, s66, 615552
  buffer_load_dwordx4 v8, s[4:7], s46 offen lds
  ds_read_b64_tr_b16 v[100:101], v9 offset:40960
  ds_read_b64_tr_b16 v[102:103], v9 offset:41984
  ds_read_b64_tr_b16 v[104:105], v9 offset:45056
  ds_read_b64_tr_b16 v[106:107], v9 offset:46080
  ds_read_b64_tr_b16 v[108:109], v9 offset:49152
  ds_read_b64_tr_b16 v[110:111], v9 offset:50176
  ds_read_b64_tr_b16 v[112:113], v9 offset:53248
  ds_read_b64_tr_b16 v[114:115], v9 offset:54272
  ds_read_b64_tr_b16 v[116:117], v9 offset:57344
  ds_read_b64_tr_b16 v[118:119], v9 offset:58368
  s_waitcnt lgkmcnt(0)
  v_mfma_f32_16x16x32_bf16 v[140:143], v[100:103], v[72:75], v[140:143]
  v_mfma_f32_16x16x32_bf16 v[144:147], v[104:107], v[72:75], v[144:147]
  v_mfma_f32_16x16x32_bf16 v[148:151], v[108:111], v[72:75], v[148:151]
  v_mfma_f32_16x16x32_bf16 v[152:155], v[112:115], v[72:75], v[152:155]
  v_mfma_f32_16x16x32_bf16 v[156:159], v[116:119], v[72:75], v[156:159]
  s_waitcnt vmcnt(20)
  s_barrier
  s_add_u32 m0, s51, 40960
  s_add_u32 s46, s66, 655360
  buffer_load_dwordx4 v8, s[4:7], s46 offen lds
  s_add_u32 m0, s51, 45056
  s_add_u32 s46, s66, 655488
  buffer_load_dwordx4 v8, s[4:7], s46 offen lds
  s_add_u32 m0, s51, 49152
  s_add_u32 s46, s66, 655616
  buffer_load_dwordx4 v8, s[4:7], s46 offen lds
  s_add_u32 m0, s51, 53248
  s_add_u32 s46, s66, 655744
  buffer_load_dwordx4 v8, s[4:7], s46 offen lds
  s_add_u32 m0, s51, 57344
  s_add_u32 s46, s66, 655872
  buffer_load_dwordx4 v8, s[4:7], s46 offen lds
  ds_read_b64_tr_b16 v[120:121], v9 offset:61440
  ds_read_b64_tr_b16 v[122:123], v9 offset:62464
  ds_read_b64_tr_b16 v[124:125], v10 offset:0
  ds_read_b64_tr_b16 v[126:127], v10 offset:1024
  ds_read_b64_tr_b16 v[128:129], v10 offset:4096
  ds_read_b64_tr_b16 v[130:131], v10 offset:5120
  ds_read_b64_tr_b16 v[132:133], v10 offset:8192
  ds_read_b64_tr_b16 v[134:135], v10 offset:9216
  ds_read_b64_tr_b16 v[136:137], v10 offset:12288
  ds_read_b64_tr_b16 v[138:139], v10 offset:13312
  s_waitcnt lgkmcnt(0)
  v_mfma_f32_16x16x32_bf16 v[160:163], v[120:123], v[72:75], v[160:163]
  v_mfma_f32_16x16x32_bf16 v[164:167], v[124:127], v[72:75], v[164:167]
  v_mfma_f32_16x16x32_bf16 v[168:171], v[128:131], v[72:75], v[168:171]
  v_mfma_f32_16x16x32_bf16 v[172:175], v[132:135], v[72:75], v[172:175]
  v_mfma_f32_16x16x32_bf16 v[176:179], v[136:139], v[72:75], v[176:179]
  s_waitcnt vmcnt(20)
  s_barrier
  s_add_u32 m0, s51, 61440
  s_add_u32 s46, s66, 656000
  buffer_load_dwordx4 v8, s[4:7], s46 offen lds
  s_add_u32 m0, s51, 65536
  s_add_u32 s46, s66, 656128
  buffer_load_dwordx4 v8, s[4:7], s46 offen lds
  s_add_u32 m0, s51, 69632
  s_add_u32 s46, s66, 656256
  buffer_load_dwordx4 v8, s[4:7], s46 offen lds
  s_add_u32 m0, s51, 73728
  s_add_u32 s46, s66, 656384
  buffer_load_dwordx4 v8, s[4:7], s46 offen lds
  s_add_u32 m0, s51, 77824
  s_add_u32 s46, s66, 656512
  buffer_load_dwordx4 v8, s[4:7], s46 offen lds
  ds_read_b64_tr_b16 v[100:101], v10 offset:16384
  ds_read_b64_tr_b16 v[102:103], v10 offset:17408
  ds_read_b64_tr_b16 v[104:105], v10 offset:20480
  ds_read_b64_tr_b16 v[106:107], v10 offset:21504
  ds_read_b64_tr_b16 v[108:109], v10 offset:24576
  ds_read_b64_tr_b16 v[110:111], v10 offset:25600
  ds_read_b64_tr_b16 v[112:113], v10 offset:28672
  ds_read_b64_tr_b16 v[114:115], v10 offset:29696
  ds_read_b64_tr_b16 v[116:117], v10 offset:32768
  ds_read_b64_tr_b16 v[118:119], v10 offset:33792
  s_waitcnt lgkmcnt(0)
  v_mfma_f32_16x16x32_bf16 v[140:143], v[100:103], v[76:79], v[140:143]
  v_mfma_f32_16x16x32_bf16 v[144:147], v[104:107], v[76:79], v[144:147]
  v_mfma_f32_16x16x32_bf16 v[148:151], v[108:111], v[76:79], v[148:151]
  v_mfma_f32_16x16x32_bf16 v[152:155], v[112:115], v[76:79], v[152:155]
  v_mfma_f32_16x16x32_bf16 v[156:159], v[116:119], v[76:79], v[156:159]
  s_waitcnt vmcnt(20)
  s_barrier
  s_add_u32 m0, s51, 81920
  s_add_u32 s46, s66, 696320
  buffer_load_dwordx4 v8, s[4:7], s46 offen lds
  s_add_u32 m0, s51, 86016
  s_add_u32 s46, s66, 696448
  buffer_load_dwordx4 v8, s[4:7], s46 offen lds
  s_add_u32 m0, s51, 90112
  s_add_u32 s46, s66, 696576
  buffer_load_dwordx4 v8, s[4:7], s46 offen lds
  s_add_u32 m0, s51, 94208
  s_add_u32 s46, s66, 696704
  buffer_load_dwordx4 v8, s[4:7], s46 offen lds
  s_add_u32 m0, s51, 98304
  s_add_u32 s46, s66, 696832
  buffer_load_dwordx4 v8, s[4:7], s46 offen lds
  ds_read_b64_tr_b16 v[120:121], v10 offset:36864
  ds_read_b64_tr_b16 v[122:123], v10 offset:37888
  ds_read_b64_tr_b16 v[124:125], v10 offset:40960
  ds_read_b64_tr_b16 v[126:127], v10 offset:41984
  ds_read_b64_tr_b16 v[128:129], v10 offset:45056
  ds_read_b64_tr_b16 v[130:131], v10 offset:46080
  ds_read_b64_tr_b16 v[132:133], v10 offset:49152
  ds_read_b64_tr_b16 v[134:135], v10 offset:50176
  ds_read_b64_tr_b16 v[136:137], v10 offset:53248
  ds_read_b64_tr_b16 v[138:139], v10 offset:54272
  s_waitcnt lgkmcnt(0)
  v_mfma_f32_16x16x32_bf16 v[160:163], v[120:123], v[76:79], v[160:163]
  v_mfma_f32_16x16x32_bf16 v[164:167], v[124:127], v[76:79], v[164:167]
  v_mfma_f32_16x16x32_bf16 v[168:171], v[128:131], v[76:79], v[168:171]
  v_mfma_f32_16x16x32_bf16 v[172:175], v[132:135], v[76:79], v[172:175]
  v_mfma_f32_16x16x32_bf16 v[176:179], v[136:139], v[76:79], v[176:179]
  s_waitcnt vmcnt(20)
  s_barrier
  s_add_u32 m0, s51, 102400
  s_add_u32 s46, s66, 696960
  buffer_load_dwordx4 v8, s[4:7], s46 offen lds
  s_add_u32 m0, s51, 106496
  s_add_u32 s46, s66, 697088
  buffer_load_dwordx4 v8, s[4:7], s46 offen lds
  s_add_u32 m0, s51, 110592
  s_add_u32 s46, s66, 697216
  buffer_load_dwordx4 v8, s[4:7], s46 offen lds
  s_add_u32 m0, s51, 114688
  s_add_u32 s46, s66, 697344
  buffer_load_dwordx4 v8, s[4:7], s46 offen lds
  s_add_u32 m0, s51, 118784
  s_add_u32 s46, s66, 697472
  buffer_load_dwordx4 v8, s[4:7], s46 offen lds
  ds_read_b64_tr_b16 v[100:101], v9 offset:0
  ds_read_b64_tr_b16 v[102:103], v9 offset:1024
  ds_read_b64_tr_b16 v[104:105], v9 offset:4096
  ds_read_b64_tr_b16 v[106:107], v9 offset:5120
  ds_read_b64_tr_b16 v[108:109], v9 offset:8192
  ds_read_b64_tr_b16 v[110:111], v9 offset:9216
  ds_read_b64_tr_b16 v[112:113], v9 offset:12288
  ds_read_b64_tr_b16 v[114:115], v9 offset:13312
  ds_read_b64_tr_b16 v[116:117], v9 offset:16384
  ds_read_b64_tr_b16 v[118:119], v9 offset:17408
  s_waitcnt lgkmcnt(0)
  v_mfma_f32_16x16x32_bf16 v[140:143], v[100:103], v[80:83], v[140:143]
  v_mfma_f32_16x16x32_bf16 v[144:147], v[104:107], v[80:83], v[144:147]
  v_mfma_f32_16x16x32_bf16 v[148:151], v[108:111], v[80:83], v[148:151]
  v_mfma_f32_16x16x32_bf16 v[152:155], v[112:115], v[80:83], v[152:155]
  v_mfma_f32_16x16x32_bf16 v[156:159], v[116:119], v[80:83], v[156:159]
  s_waitcnt vmcnt(20)
  s_barrier
  s_add_u32 m0, s51, 0
  s_add_u32 s46, s66, 737280
  buffer_load_dwordx4 v8, s[4:7], s46 offen lds
  s_add_u32 m0, s51, 4096
  s_add_u32 s46, s66, 737408
  buffer_load_dwordx4 v8, s[4:7], s46 offen lds
  s_add_u32 m0, s51, 8192
  s_add_u32 s46, s66, 737536
  buffer_load_dwordx4 v8, s[4:7], s46 offen lds
  s_add_u32 m0, s51, 12288
  s_add_u32 s46, s66, 737664
  buffer_load_dwordx4 v8, s[4:7], s46 offen lds
  s_add_u32 m0, s51, 16384
  s_add_u32 s46, s66, 737792
  buffer_load_dwordx4 v8, s[4:7], s46 offen lds
  ds_read_b64_tr_b16 v[120:121], v9 offset:20480
  ds_read_b64_tr_b16 v[122:123], v9 offset:21504
  ds_read_b64_tr_b16 v[124:125], v9 offset:24576
  ds_read_b64_tr_b16 v[126:127], v9 offset:25600
  ds_read_b64_tr_b16 v[128:129], v9 offset:28672
  ds_read_b64_tr_b16 v[130:131], v9 offset:29696
  ds_read_b64_tr_b16 v[132:133], v9 offset:32768
  ds_read_b64_tr_b16 v[134:135], v9 offset:33792
  ds_read_b64_tr_b16 v[136:137], v9 offset:36864
  ds_read_b64_tr_b16 v[138:139], v9 offset:37888
  s_waitcnt lgkmcnt(0)
  v_mfma_f32_16x16x32_bf16 v[160:163], v[120:123], v[80:83], v[160:163]
  v_mfma_f32_16x16x32_bf16 v[164:167], v[124:127], v[80:83], v[164:167]
  v_mfma_f32_16x16x32_bf16 v[168:171], v[128:131], v[80:83], v[168:171]
  v_mfma_f32_16x16x32_bf16 v[172:175], v[132:135], v[80:83], v[172:175]
  v_mfma_f32_16x16x32_bf16 v[176:179], v[136:139], v[80:83], v[176:179]
  s_waitcnt vmcnt(20)
  s_barrier
  s_add_u32 m0, s51, 20480
  s_add_u32 s46, s66, 737920
  buffer_load_dwordx4 v8, s[4:7], s46 offen lds
  s_add_u32 m0, s51, 24576
  s_add_u32 s46, s66, 738048
  buffer_load_dwordx4 v8, s[4:7], s46 offen lds
  s_add_u32 m0, s51, 28672
  s_add_u32 s46, s66, 738176
  buffer_load_dwordx4 v8, s[4:7], s46 offen lds
  s_add_u32 m0, s51, 32768
  s_add_u32 s46, s66, 738304
  buffer_load_dwordx4 v8, s[4:7], s46 offen lds
  s_add_u32 m0, s51, 36864
  s_add_u32 s46, s66, 738432
  buffer_load_dwordx4 v8, s[4:7], s46 offen lds
  ds_read_b64_tr_b16 v[100:101], v9 offset:40960
  ds_read_b64_tr_b16 v[102:103], v9 offset:41984
  ds_read_b64_tr_b16 v[104:105], v9 offset:45056
  ds_read_b64_tr_b16 v[106:107], v9 offset:46080
  ds_read_b64_tr_b16 v[108:109], v9 offset:49152
  ds_read_b64_tr_b16 v[110:111], v9 offset:50176
  ds_read_b64_tr_b16 v[112:113], v9 offset:53248
  ds_read_b64_tr_b16 v[114:115], v9 offset:54272
  ds_read_b64_tr_b16 v[116:117], v9 offset:57344
  ds_read_b64_tr_b16 v[118:119], v9 offset:58368
  s_waitcnt lgkmcnt(0)
  v_mfma_f32_16x16x32_bf16 v[140:143], v[100:103], v[84:87], v[140:143]
  v_mfma_f32_16x16x32_bf16 v[144:147], v[104:107], v[84:87], v[144:147]
  v_mfma_f32_16x16x32_bf16 v[148:151], v[108:111], v[84:87], v[148:151]
  v_mfma_f32_16x16x32_bf16 v[152:155], v[112:115], v[84:87], v[152:155]
  v_mfma_f32_16x16x32_bf16 v[156:159], v[116:119], v[84:87], v[156:159]
  s_waitcnt vmcnt(20)
  s_barrier
  s_add_u32 m0, s51, 40960
  s_add_u32 s46, s66, 778240
  buffer_load_dwordx4 v8, s[4:7], s46 offen lds
  s_add_u32 m0, s51, 45056
  s_add_u32 s46, s66, 778368
  buffer_load_dwordx4 v8, s[4:7], s46 offen lds
  s_add_u32 m0, s51, 49152
  s_add_u32 s46, s66, 778496
  buffer_load_dwordx4 v8, s[4:7], s46 offen lds
  s_add_u32 m0, s51, 53248
  s_add_u32 s46, s66, 778624
  buffer_load_dwordx4 v8, s[4:7], s46 offen lds
  s_add_u32 m0, s51, 57344
  s_add_u32 s46, s66, 778752
  buffer_load_dwordx4 v8, s[4:7], s46 offen lds
  ds_read_b64_tr_b16 v[120:121], v9 offset:61440
  ds_read_b64_tr_b16 v[122:123], v9 offset:62464
  ds_read_b64_tr_b16 v[124:125], v10 offset:0
  ds_read_b64_tr_b16 v[126:127], v10 offset:1024
  ds_read_b64_tr_b16 v[128:129], v10 offset:4096
  ds_read_b64_tr_b16 v[130:131], v10 offset:5120
  ds_read_b64_tr_b16 v[132:133], v10 offset:8192
  ds_read_b64_tr_b16 v[134:135], v10 offset:9216
  ds_read_b64_tr_b16 v[136:137], v10 offset:12288
  ds_read_b64_tr_b16 v[138:139], v10 offset:13312
  s_waitcnt lgkmcnt(0)
  v_mfma_f32_16x16x32_bf16 v[160:163], v[120:123], v[84:87], v[160:163]
  v_mfma_f32_16x16x32_bf16 v[164:167], v[124:127], v[84:87], v[164:167]
  v_mfma_f32_16x16x32_bf16 v[168:171], v[128:131], v[84:87], v[168:171]
  v_mfma_f32_16x16x32_bf16 v[172:175], v[132:135], v[84:87], v[172:175]
  v_mfma_f32_16x16x32_bf16 v[176:179], v[136:139], v[84:87], v[176:179]
  s_waitcnt vmcnt(20)
  s_barrier
  s_add_u32 m0, s51, 61440
  s_add_u32 s46, s66, 778880
  buffer_load_dwordx4 v8, s[4:7], s46 offen lds
  s_add_u32 m0, s51, 65536
  s_add_u32 s46, s66, 779008
  buffer_load_dwordx4 v8, s[4:7], s46 offen lds
  s_add_u32 m0, s51, 69632
  s_add_u32 s46, s66, 779136
  buffer_load_dwordx4 v8, s[4:7], s46 offen lds
  s_add_u32 m0, s51, 73728
  s_add_u32 s46, s66, 779264
  buffer_load_dwordx4 v8, s[4:7], s46 offen lds
  s_add_u32 m0, s51, 77824
  s_add_u32 s46, s66, 779392
  buffer_load_dwordx4 v8, s[4:7], s46 offen lds
  ds_read_b64_tr_b16 v[100:101], v10 offset:16384
  ds_read_b64_tr_b16 v[102:103], v10 offset:17408
  ds_read_b64_tr_b16 v[104:105], v10 offset:20480
  ds_read_b64_tr_b16 v[106:107], v10 offset:21504
  ds_read_b64_tr_b16 v[108:109], v10 offset:24576
  ds_read_b64_tr_b16 v[110:111], v10 offset:25600
  ds_read_b64_tr_b16 v[112:113], v10 offset:28672
  ds_read_b64_tr_b16 v[114:115], v10 offset:29696
  ds_read_b64_tr_b16 v[116:117], v10 offset:32768
  ds_read_b64_tr_b16 v[118:119], v10 offset:33792
  s_waitcnt lgkmcnt(0)
  v_mfma_f32_16x16x32_bf16 v[140:143], v[100:103], v[88:91], v[140:143]
  v_mfma_f32_16x16x32_bf16 v[144:147], v[104:107], v[88:91], v[144:147]
  v_mfma_f32_16x16x32_bf16 v[148:151], v[108:111], v[88:91], v[148:151]
  v_mfma_f32_16x16x32_bf16 v[152:155], v[112:115], v[88:91], v[152:155]
  v_mfma_f32_16x16x32_bf16 v[156:159], v[116:119], v[88:91], v[156:159]
  s_waitcnt vmcnt(20)
  s_barrier
  ds_read_b64_tr_b16 v[120:121], v10 offset:36864
  ds_read_b64_tr_b16 v[122:123], v10 offset:37888
  ds_read_b64_tr_b16 v[124:125], v10 offset:40960
  ds_read_b64_tr_b16 v[126:127], v10 offset:41984
  ds_read_b64_tr_b16 v[128:129], v10 offset:45056
  ds_read_b64_tr_b16 v[130:131], v10 offset:46080
  ds_read_b64_tr_b16 v[132:133], v10 offset:49152
  ds_read_b64_tr_b16 v[134:135], v10 offset:50176
  ds_read_b64_tr_b16 v[136:137], v10 offset:53248
  ds_read_b64_tr_b16 v[138:139], v10 offset:54272
  s_waitcnt lgkmcnt(0)
  v_mfma_f32_16x16x32_bf16 v[160:163], v[120:123], v[88:91], v[160:163]
  v_mfma_f32_16x16x32_bf16 v[164:167], v[124:127], v[88:91], v[164:167]
  v_mfma_f32_16x16x32_bf16 v[168:171], v[128:131], v[88:91], v[168:171]
  v_mfma_f32_16x16x32_bf16 v[172:175], v[132:135], v[88:91], v[172:175]
  v_mfma_f32_16x16x32_bf16 v[176:179], v[136:139], v[88:91], v[176:179]
  s_waitcnt vmcnt(15)
  s_barrier
  ds_read_b64_tr_b16 v[100:101], v9 offset:0
  ds_read_b64_tr_b16 v[102:103], v9 offset:1024
  ds_read_b64_tr_b16 v[104:105], v9 offset:4096
  ds_read_b64_tr_b16 v[106:107], v9 offset:5120
  ds_read_b64_tr_b16 v[108:109], v9 offset:8192
  ds_read_b64_tr_b16 v[110:111], v9 offset:9216
  ds_read_b64_tr_b16 v[112:113], v9 offset:12288
  ds_read_b64_tr_b16 v[114:115], v9 offset:13312
  ds_read_b64_tr_b16 v[116:117], v9 offset:16384
  ds_read_b64_tr_b16 v[118:119], v9 offset:17408
  s_waitcnt lgkmcnt(0)
  v_mfma_f32_16x16x32_bf16 v[140:143], v[100:103], v[92:95], v[140:143]
  v_mfma_f32_16x16x32_bf16 v[144:147], v[104:107], v[92:95], v[144:147]
  v_mfma_f32_16x16x32_bf16 v[148:151], v[108:111], v[92:95], v[148:151]
  v_mfma_f32_16x16x32_bf16 v[152:155], v[112:115], v[92:95], v[152:155]
  v_mfma_f32_16x16x32_bf16 v[156:159], v[116:119], v[92:95], v[156:159]
  s_waitcnt vmcnt(10)
  s_barrier
  ds_read_b64_tr_b16 v[120:121], v9 offset:20480
  ds_read_b64_tr_b16 v[122:123], v9 offset:21504
  ds_read_b64_tr_b16 v[124:125], v9 offset:24576
  ds_read_b64_tr_b16 v[126:127], v9 offset:25600
  ds_read_b64_tr_b16 v[128:129], v9 offset:28672
  ds_read_b64_tr_b16 v[130:131], v9 offset:29696
  ds_read_b64_tr_b16 v[132:133], v9 offset:32768
  ds_read_b64_tr_b16 v[134:135], v9 offset:33792
  ds_read_b64_tr_b16 v[136:137], v9 offset:36864
  ds_read_b64_tr_b16 v[138:139], v9 offset:37888
  s_waitcnt lgkmcnt(0)
  v_mfma_f32_16x16x32_bf16 v[160:163], v[120:123], v[92:95], v[160:163]
  v_mfma_f32_16x16x32_bf16 v[164:167], v[124:127], v[92:95], v[164:167]
  v_mfma_f32_16x16x32_bf16 v[168:171], v[128:131], v[92:95], v[168:171]
  v_mfma_f32_16x16x32_bf16 v[172:175], v[132:135], v[92:95], v[172:175]
  v_mfma_f32_16x16x32_bf16 v[176:179], v[136:139], v[92:95], v[176:179]
  s_waitcnt vmcnt(5)
  s_barrier
  ds_read_b64_tr_b16 v[100:101], v9 offset:40960
  ds_read_b64_tr_b16 v[102:103], v9 offset:41984
  ds_read_b64_tr_b16 v[104:105], v9 offset:45056
  ds_read_b64_tr_b16 v[106:107], v9 offset:46080
  ds_read_b64_tr_b16 v[108:109], v9 offset:49152
  ds_read_b64_tr_b16 v[110:111], v9 offset:50176
  ds_read_b64_tr_b16 v[112:113], v9 offset:53248
  ds_read_b64_tr_b16 v[114:115], v9 offset:54272
  ds_read_b64_tr_b16 v[116:117], v9 offset:57344
  ds_read_b64_tr_b16 v[118:119], v9 offset:58368
  s_waitcnt lgkmcnt(0)
  v_mfma_f32_16x16x32_bf16 v[140:143], v[100:103], v[96:99], v[140:143]
  v_mfma_f32_16x16x32_bf16 v[144:147], v[104:107], v[96:99], v[144:147]
  v_mfma_f32_16x16x32_bf16 v[148:151], v[108:111], v[96:99], v[148:151]
  v_mfma_f32_16x16x32_bf16 v[152:155], v[112:115], v[96:99], v[152:155]
  v_mfma_f32_16x16x32_bf16 v[156:159], v[116:119], v[96:99], v[156:159]
  s_waitcnt vmcnt(0)
  s_barrier
  ds_read_b64_tr_b16 v[120:121], v9 offset:61440
  ds_read_b64_tr_b16 v[122:123], v9 offset:62464
  ds_read_b64_tr_b16 v[124:125], v10 offset:0
  ds_read_b64_tr_b16 v[126:127], v10 offset:1024
  ds_read_b64_tr_b16 v[128:129], v10 offset:4096
  ds_read_b64_tr_b16 v[130:131], v10 offset:5120
  ds_read_b64_tr_b16 v[132:133], v10 offset:8192
  ds_read_b64_tr_b16 v[134:135], v10 offset:9216
  ds_read_b64_tr_b16 v[136:137], v10 offset:12288
  ds_read_b64_tr_b16 v[138:139], v10 offset:13312
  s_waitcnt lgkmcnt(0)
  v_mfma_f32_16x16x32_bf16 v[160:163], v[120:123], v[96:99], v[160:163]
  v_mfma_f32_16x16x32_bf16 v[164:167], v[124:127], v[96:99], v[164:167]
  v_mfma_f32_16x16x32_bf16 v[168:171], v[128:131], v[96:99], v[168:171]
  v_mfma_f32_16x16x32_bf16 v[172:175], v[132:135], v[96:99], v[172:175]
  v_mfma_f32_16x16x32_bf16 v[176:179], v[136:139], v[96:99], v[176:179]
  s_barrier
  v_cvt_pk_bf16_f32 v140, v140, v141
  v_cvt_pk_bf16_f32 v141, v142, v143
  buffer_store_dwordx2 v[140:141], v12, s[12:15], 0 offen offset:0
  v_cvt_pk_bf16_f32 v144, v144, v145
  v_cvt_pk_bf16_f32 v145, v146, v147
  buffer_store_dwordx2 v[144:145], v12, s[12:15], 0 offen offset:128
  v_cvt_pk_bf16_f32 v148, v148, v149
  v_cvt_pk_bf16_f32 v149, v150, v151
  buffer_store_dwordx2 v[148:149], v12, s[12:15], 0 offen offset:256
  v_cvt_pk_bf16_f32 v152, v152, v153
  v_cvt_pk_bf16_f32 v153, v154, v155
  buffer_store_dwordx2 v[152:153], v12, s[12:15], 0 offen offset:384
  v_cvt_pk_bf16_f32 v156, v156, v157
  v_cvt_pk_bf16_f32 v157, v158, v159
  buffer_store_dwordx2 v[156:157], v12, s[12:15], 0 offen offset:512
  v_cvt_pk_bf16_f32 v160, v160, v161
  v_cvt_pk_bf16_f32 v161, v162, v163
  buffer_store_dwordx2 v[160:161], v12, s[12:15], 0 offen offset:640
  v_cvt_pk_bf16_f32 v164, v164, v165
  v_cvt_pk_bf16_f32 v165, v166, v167
  buffer_store_dwordx2 v[164:165], v12, s[12:15], 0 offen offset:768
  v_cvt_pk_bf16_f32 v168, v168, v169
  v_cvt_pk_bf16_f32 v169, v170, v171
  buffer_store_dwordx2 v[168:169], v12, s[12:15], 0 offen offset:896
  v_cvt_pk_bf16_f32 v172, v172, v173
  v_cvt_pk_bf16_f32 v173, v174, v175
  buffer_store_dwordx2 v[172:173], v12, s[12:15], 0 offen offset:1024
  v_cvt_pk_bf16_f32 v176, v176, v177
  v_cvt_pk_bf16_f32 v177, v178, v179
  buffer_store_dwordx2 v[176:177], v12, s[12:15], 0 offen offset:1152
  s_endpgm
L_recur:
  s_cmp_lt_u32 s44, 8
  s_cbranch_scc1 L_score
  s_cmp_lt_u32 s44, 16
  s_cbranch_scc1 L_value
  v_and_b32 v3, 3, v0
  v_lshlrev_b32 v3, 2, v3
  s_mov_b32 s50, 0
ss_13:
  global_load_dword v2, v3, s[38:39] sc1
  s_add_u32 s50, s50, 1
  s_cmp_gt_u32 s50, 131072
  s_cbranch_scc1 L_fail
  s_waitcnt vmcnt(0)
  v_readlane_b32 s46, v2, 0
  v_readlane_b32 s47, v2, 0
  s_cmp_lg_u32 s46, 0
  s_cselect_b32 s48, 7, 0
  s_add_u32 s46, s46, s2
  s_xor_b32 s49, s46, s43
  s_and_b32 s49, s49, s48
  s_cbranch_scc1 L_reroll
  s_cmp_lg_u32 s47, 0
  s_cbranch_scc1 ss_ok_14
  s_sleep 10
  s_branch ss_13
ss_ok_14:
  s_cmp_lt_u32 s42, 2
  s_cbranch_scc1 rc_nowarm
  s_lshl_b32 s46, s44, 2
  s_add_u32 s46, s46, s43
  s_lshl_b32 s46, s46, 1
  s_add_u32 s46, s46, s42
  s_sub_u32 s46, s46, 130
  s_mul_i32 s46, s46, 20480
  v_lshlrev_b32 v1, 7, v0
  s_add_u32 s47, s46, 0
  buffer_load_dword v2, v1, s[12:15], s47 offen
  s_add_u32 s47, s46, 8192
  buffer_load_dword v2, v1, s[12:15], s47 offen
  s_add_u32 s47, s46, 12288
  buffer_load_dword v2, v1, s[12:15], s47 offen
  s_waitcnt vmcnt(0)
rc_nowarm:
  s_cmp_lt_u32 s44, 26
  s_cbranch_scc1 L_owner
  s_branch L_xowner
L_score:
  s_mov_b32 s4, s26
  s_mov_b32 s5, s27
  s_mov_b32 s6, 7864320
  s_mov_b32 s7, 0x20000
  s_mov_b32 s12, s28
  s_mov_b32 s13, s29
  s_mov_b32 s14, 7864320
  s_mov_b32 s15, 0x20000
  v_lshrrev_b32 v136, 3, v0
  v_lshrrev_b32 v137, 2, v136
  v_lshlrev_b32 v137, 3, v137
  v_and_b32 v64, 3, v136
  v_add_u32 v64, v64, v137
  s_and_b32 s46, s42, 1
  s_lshl_b32 s46, s46, 2
  s_lshr_b32 s47, s42, 1
  s_lshl_b32 s47, s47, 4
  s_add_u32 s46, s46, s47
  v_add_u32 v64, s46, v64
  v_mul_u32_u24 v64, 12288, v64
  v_lshrrev_b32 v136, 1, v136
  v_bfe_u32 v137, v0, 1, 2
  v_xor_b32 v136, v136, v137
  v_lshlrev_b32 v136, 5, v136
  v_and_b32 v137, 1, v0
  v_lshlrev_b32 v137, 4, v137
  v_add3_u32 v64, v64, v136, v137
  v_lshrrev_b32 v136, 5, v0
  v_lshlrev_b32 v65, 11, v136
  v_bfe_u32 v136, v0, 2, 3
  v_lshl_add_u32 v65, v136, 7, v65
  v_lshrrev_b32 v136, 1, v136
  v_xor_b32 v136, s42, v136
  v_lshl_add_u32 v65, v136, 5, v65
  v_and_b32 v136, 3, v0
  v_lshl_add_u32 v65, v136, 3, v65
  v_add_u32 v66, 0x10000, v65
  v_add_u32 v67, 0x20000, v65
  v_lshlrev_b32 v1, 4, v0
  v_add_u32 v2, s51, v1
  v_add_u32 v3, 0x10000, v2
  s_mul_i32 s62, s45, 384
  s_mov_b32 s24, 4096
  s_mov_b32 s25, 49152
  s_add_u32 m0, s51, 73728
  s_add_u32 s46, s62, 0
  buffer_load_dwordx4 v64, s[12:15], s46 offen lds
  s_add_u32 m0, s51, 77824
  s_add_u32 s46, s62, 393216
  buffer_load_dwordx4 v64, s[12:15], s46 offen lds
  s_add_u32 m0, s51, 81920
  s_add_u32 s46, s62, 128
  buffer_load_dwordx4 v64, s[12:15], s46 offen lds
  s_add_u32 m0, s51, 86016
  s_add_u32 s46, s62, 393344
  buffer_load_dwordx4 v64, s[12:15], s46 offen lds
  s_add_u32 m0, s51, 90112
  s_add_u32 s46, s62, 256
  buffer_load_dwordx4 v64, s[12:15], s46 offen lds
  s_add_u32 m0, s51, 94208
  s_add_u32 s46, s62, 393472
  buffer_load_dwordx4 v64, s[12:15], s46 offen lds
  s_add_u32 m0, s51, 98304
  s_add_u32 s46, s62, 786432
  buffer_load_dwordx4 v64, s[12:15], s46 offen lds
  s_add_u32 m0, s51, 102400
  s_add_u32 s46, s62, 1179648
  buffer_load_dwordx4 v64, s[12:15], s46 offen lds
  s_add_u32 m0, s51, 106496
  s_add_u32 s46, s62, 786560
  buffer_load_dwordx4 v64, s[12:15], s46 offen lds
  s_add_u32 m0, s51, 110592
  s_add_u32 s46, s62, 1179776
  buffer_load_dwordx4 v64, s[12:15], s46 offen lds
  s_add_u32 m0, s51, 114688
  s_add_u32 s46, s62, 786688
  buffer_load_dwordx4 v64, s[12:15], s46 offen lds
  s_add_u32 m0, s51, 118784
  s_add_u32 s46, s62, 1179904
  buffer_load_dwordx4 v64, s[12:15], s46 offen lds
  s_add_u32 m0, s51, 122880
  s_add_u32 s46, s62, 1572864
  buffer_load_dwordx4 v64, s[12:15], s46 offen lds
  s_add_u32 m0, s51, 126976
  s_add_u32 s46, s62, 1966080
  buffer_load_dwordx4 v64, s[12:15], s46 offen lds
  s_add_u32 m0, s51, 131072
  s_add_u32 s46, s62, 1572992
  buffer_load_dwordx4 v64, s[12:15], s46 offen lds
  s_add_u32 m0, s51, 135168
  s_add_u32 s46, s62, 1966208
  buffer_load_dwordx4 v64, s[12:15], s46 offen lds
  s_add_u32 m0, s51, 139264
  s_add_u32 s46, s62, 1573120
  buffer_load_dwordx4 v64, s[12:15], s46 offen lds
  s_add_u32 m0, s51, 143360
  s_add_u32 s46, s62, 1966336
  buffer_load_dwordx4 v64, s[12:15], s46 offen lds
  s_add_u32 m0, s51, 0
  s_add_u32 s46, s62, 2359296
  buffer_load_dwordx4 v64, s[12:15], s46 offen lds
  s_add_u32 m0, s51, 4096
  s_add_u32 s46, s62, 2752512
  buffer_load_dwordx4 v64, s[12:15], s46 offen lds
  s_add_u32 m0, s51, 8192
  s_add_u32 s46, s62, 2359424
  buffer_load_dwordx4 v64, s[12:15], s46 offen lds
  s_add_u32 m0, s51, 12288
  s_add_u32 s46, s62, 2752640
  buffer_load_dwordx4 v64, s[12:15], s46 offen lds
  s_add_u32 m0, s51, 16384
  s_add_u32 s46, s62, 2359552
  buffer_load_dwordx4 v64, s[12:15], s46 offen lds
  s_add_u32 m0, s51, 20480
  s_add_u32 s46, s62, 2752768
  buffer_load_dwordx4 v64, s[12:15], s46 offen lds
  s_add_u32 m0, s51, 24576
  s_add_u32 s46, s62, 3932160
  buffer_load_dwordx4 v64, s[12:15], s46 offen lds
  s_add_u32 m0, s51, 28672
  s_add_u32 s46, s62, 4325376
  buffer_load_dwordx4 v64, s[12:15], s46 offen lds
  s_add_u32 m0, s51, 32768
  s_add_u32 s46, s62, 3932288
  buffer_load_dwordx4 v64, s[12:15], s46 offen lds
  s_add_u32 m0, s51, 36864
  s_add_u32 s46, s62, 4325504
  buffer_load_dwordx4 v64, s[12:15], s46 offen lds
  s_add_u32 m0, s51, 40960
  s_add_u32 s46, s62, 3932416
  buffer_load_dwordx4 v64, s[12:15], s46 offen lds
  s_add_u32 m0, s51, 45056
  s_add_u32 s46, s62, 4325632
  buffer_load_dwordx4 v64, s[12:15], s46 offen lds
  s_waitcnt vmcnt(24)
  s_barrier
  s_add_u32 m0, s51, 49152
  s_add_u32 s46, s62, 4718592
  buffer_load_dwordx4 v64, s[12:15], s46 offen lds
  s_add_u32 m0, s51, 53248
  s_add_u32 s46, s62, 5111808
  buffer_load_dwordx4 v64, s[12:15], s46 offen lds
  s_add_u32 m0, s51, 57344
  s_add_u32 s46, s62, 4718720
  buffer_load_dwordx4 v64, s[12:15], s46 offen lds
  s_add_u32 m0, s51, 61440
  s_add_u32 s46, s62, 5111936
  buffer_load_dwordx4 v64, s[12:15], s46 offen lds
  s_add_u32 m0, s51, 65536
  s_add_u32 s46, s62, 4718848
  buffer_load_dwordx4 v64, s[12:15], s46 offen lds
  s_add_u32 m0, s51, 69632
  s_add_u32 s46, s62, 5112064
  buffer_load_dwordx4 v64, s[12:15], s46 offen lds
  ds_read_b64_tr_b16 a[0:1], v66 offset:8192
  ds_read_b64_tr_b16 a[2:3], v66 offset:9216
  ds_read_b64_tr_b16 a[4:5], v66 offset:12288
  ds_read_b64_tr_b16 a[6:7], v66 offset:13312
  ds_read_b64_tr_b16 a[8:9], v66 offset:16384
  ds_read_b64_tr_b16 a[10:11], v66 offset:17408
  ds_read_b64_tr_b16 a[12:13], v66 offset:20480
  ds_read_b64_tr_b16 a[14:15], v66 offset:21504
  ds_read_b64_tr_b16 a[16:17], v66 offset:24576
  ds_read_b64_tr_b16 a[18:19], v66 offset:25600
  ds_read_b64_tr_b16 a[20:21], v66 offset:28672
  ds_read_b64_tr_b16 a[22:23], v66 offset:29696
  s_waitcnt lgkmcnt(0)
  s_waitcnt vmcnt(24)
  s_barrier
  s_add_u32 m0, s51, 73728
  s_add_u32 s46, s62, 6291456
  buffer_load_dwordx4 v64, s[12:15], s46 offen lds
  s_add_u32 m0, s51, 77824
  s_add_u32 s46, s62, 6684672
  buffer_load_dwordx4 v64, s[12:15], s46 offen lds
  s_add_u32 m0, s51, 81920
  s_add_u32 s46, s62, 6291584
  buffer_load_dwordx4 v64, s[12:15], s46 offen lds
  s_add_u32 m0, s51, 86016
  s_add_u32 s46, s62, 6684800
  buffer_load_dwordx4 v64, s[12:15], s46 offen lds
  s_add_u32 m0, s51, 90112
  s_add_u32 s46, s62, 6291712
  buffer_load_dwordx4 v64, s[12:15], s46 offen lds
  s_add_u32 m0, s51, 94208
  s_add_u32 s46, s62, 6684928
  buffer_load_dwordx4 v64, s[12:15], s46 offen lds
  ds_read_b64_tr_b16 a[24:25], v66 offset:32768
  ds_read_b64_tr_b16 a[26:27], v66 offset:33792
  ds_read_b64_tr_b16 a[28:29], v66 offset:36864
  ds_read_b64_tr_b16 a[30:31], v66 offset:37888
  ds_read_b64_tr_b16 a[32:33], v66 offset:40960
  ds_read_b64_tr_b16 a[34:35], v66 offset:41984
  ds_read_b64_tr_b16 a[36:37], v66 offset:45056
  ds_read_b64_tr_b16 a[38:39], v66 offset:46080
  ds_read_b64_tr_b16 a[40:41], v66 offset:49152
  ds_read_b64_tr_b16 a[42:43], v66 offset:50176
  ds_read_b64_tr_b16 a[44:45], v66 offset:53248
  ds_read_b64_tr_b16 a[46:47], v66 offset:54272
  s_waitcnt lgkmcnt(0)
  s_waitcnt vmcnt(24)
  s_barrier
  s_add_u32 m0, s51, 98304
  s_add_u32 s46, s62, 7077888
  buffer_load_dwordx4 v64, s[12:15], s46 offen lds
  s_add_u32 m0, s51, 102400
  s_add_u32 s46, s62, 7471104
  buffer_load_dwordx4 v64, s[12:15], s46 offen lds
  s_add_u32 m0, s51, 106496
  s_add_u32 s46, s62, 7078016
  buffer_load_dwordx4 v64, s[12:15], s46 offen lds
  s_add_u32 m0, s51, 110592
  s_add_u32 s46, s62, 7471232
  buffer_load_dwordx4 v64, s[12:15], s46 offen lds
  s_add_u32 m0, s51, 114688
  s_add_u32 s46, s62, 7078144
  buffer_load_dwordx4 v64, s[12:15], s46 offen lds
  s_add_u32 m0, s51, 118784
  s_add_u32 s46, s62, 7471360
  buffer_load_dwordx4 v64, s[12:15], s46 offen lds
  ds_read_b64_tr_b16 a[48:49], v66 offset:57344
  ds_read_b64_tr_b16 a[50:51], v66 offset:58368
  ds_read_b64_tr_b16 a[52:53], v66 offset:61440
  ds_read_b64_tr_b16 a[54:55], v66 offset:62464
  ds_read_b64_tr_b16 a[56:57], v67 offset:0
  ds_read_b64_tr_b16 a[58:59], v67 offset:1024
  ds_read_b64_tr_b16 a[60:61], v67 offset:4096
  ds_read_b64_tr_b16 a[62:63], v67 offset:5120
  ds_read_b64_tr_b16 a[64:65], v67 offset:8192
  ds_read_b64_tr_b16 a[66:67], v67 offset:9216
  ds_read_b64_tr_b16 a[68:69], v67 offset:12288
  ds_read_b64_tr_b16 a[70:71], v67 offset:13312
  s_waitcnt lgkmcnt(0)
  s_waitcnt vmcnt(24)
  s_barrier
  s_add_u32 m0, s51, 122880
  s_add_u32 s46, s62, 0
  buffer_load_dwordx4 v64, s[4:7], s46 offen lds
  s_add_u32 m0, s51, 126976
  s_add_u32 s46, s62, 393216
  buffer_load_dwordx4 v64, s[4:7], s46 offen lds
  s_add_u32 m0, s51, 131072
  s_add_u32 s46, s62, 128
  buffer_load_dwordx4 v64, s[4:7], s46 offen lds
  s_add_u32 m0, s51, 135168
  s_add_u32 s46, s62, 393344
  buffer_load_dwordx4 v64, s[4:7], s46 offen lds
  s_add_u32 m0, s51, 139264
  s_add_u32 s46, s62, 256
  buffer_load_dwordx4 v64, s[4:7], s46 offen lds
  s_add_u32 m0, s51, 143360
  s_add_u32 s46, s62, 393472
  buffer_load_dwordx4 v64, s[4:7], s46 offen lds
  ds_read_b64_tr_b16 a[72:73], v65 offset:0
  ds_read_b64_tr_b16 a[74:75], v65 offset:1024
  ds_read_b64_tr_b16 a[76:77], v65 offset:4096
  ds_read_b64_tr_b16 a[78:79], v65 offset:5120
  ds_read_b64_tr_b16 a[80:81], v65 offset:8192
  ds_read_b64_tr_b16 a[82:83], v65 offset:9216
  ds_read_b64_tr_b16 a[84:85], v65 offset:12288
  ds_read_b64_tr_b16 a[86:87], v65 offset:13312
  ds_read_b64_tr_b16 a[88:89], v65 offset:16384
  ds_read_b64_tr_b16 a[90:91], v65 offset:17408
  ds_read_b64_tr_b16 a[92:93], v65 offset:20480
  ds_read_b64_tr_b16 a[94:95], v65 offset:21504
  s_waitcnt lgkmcnt(0)
  s_waitcnt vmcnt(24)
  s_barrier
  s_add_u32 m0, s51, 0
  s_add_u32 s46, s62, 786432
  buffer_load_dwordx4 v64, s[4:7], s46 offen lds
  s_add_u32 m0, s51, 4096
  s_add_u32 s46, s62, 1179648
  buffer_load_dwordx4 v64, s[4:7], s46 offen lds
  s_add_u32 m0, s51, 8192
  s_add_u32 s46, s62, 786560
  buffer_load_dwordx4 v64, s[4:7], s46 offen lds
  s_add_u32 m0, s51, 12288
  s_add_u32 s46, s62, 1179776
  buffer_load_dwordx4 v64, s[4:7], s46 offen lds
  s_add_u32 m0, s51, 16384
  s_add_u32 s46, s62, 786688
  buffer_load_dwordx4 v64, s[4:7], s46 offen lds
  s_add_u32 m0, s51, 20480
  s_add_u32 s46, s62, 1179904
  buffer_load_dwordx4 v64, s[4:7], s46 offen lds
  ds_read_b64_tr_b16 a[96:97], v65 offset:24576
  ds_read_b64_tr_b16 a[98:99], v65 offset:25600
  ds_read_b64_tr_b16 a[100:101], v65 offset:28672
  ds_read_b64_tr_b16 a[102:103], v65 offset:29696
  ds_read_b64_tr_b16 a[104:105], v65 offset:32768
  ds_read_b64_tr_b16 a[106:107], v65 offset:33792
  ds_read_b64_tr_b16 a[108:109], v65 offset:36864
  ds_read_b64_tr_b16 a[110:111], v65 offset:37888
  ds_read_b64_tr_b16 a[112:113], v65 offset:40960
  ds_read_b64_tr_b16 a[114:115], v65 offset:41984
  ds_read_b64_tr_b16 a[116:117], v65 offset:45056
  ds_read_b64_tr_b16 a[118:119], v65 offset:46080
  s_waitcnt lgkmcnt(0)
  s_waitcnt vmcnt(24)
  s_barrier
  s_add_u32 m0, s51, 24576
  s_add_u32 s46, s62, 2359296
  buffer_load_dwordx4 v64, s[4:7], s46 offen lds
  s_add_u32 m0, s51, 28672
  s_add_u32 s46, s62, 2752512
  buffer_load_dwordx4 v64, s[4:7], s46 offen lds
  s_add_u32 m0, s51, 32768
  s_add_u32 s46, s62, 2359424
  buffer_load_dwordx4 v64, s[4:7], s46 offen lds
  s_add_u32 m0, s51, 36864
  s_add_u32 s46, s62, 2752640
  buffer_load_dwordx4 v64, s[4:7], s46 offen lds
  s_add_u32 m0, s51, 40960
  s_add_u32 s46, s62, 2359552
  buffer_load_dwordx4 v64, s[4:7], s46 offen lds
  s_add_u32 m0, s51, 45056
  s_add_u32 s46, s62, 2752768
  buffer_load_dwordx4 v64, s[4:7], s46 offen lds
  ds_read_b64_tr_b16 a[120:121], v65 offset:49152
  ds_read_b64_tr_b16 a[122:123], v65 offset:50176
  ds_read_b64_tr_b16 a[124:125], v65 offset:53248
  ds_read_b64_tr_b16 a[126:127], v65 offset:54272
  ds_read_b64_tr_b16 a[128:129], v65 offset:57344
  ds_read_b64_tr_b16 a[130:131], v65 offset:58368
  ds_read_b64_tr_b16 a[132:133], v65 offset:61440
  ds_read_b64_tr_b16 a[134:135], v65 offset:62464
  ds_read_b64_tr_b16 a[136:137], v66 offset:0
  ds_read_b64_tr_b16 a[138:139], v66 offset:1024
  ds_read_b64_tr_b16 a[140:141], v66 offset:4096
  ds_read_b64_tr_b16 a[142:143], v66 offset:5120
  s_waitcnt lgkmcnt(0)
  s_waitcnt vmcnt(24)
  s_barrier
  s_add_u32 m0, s51, 49152
  s_add_u32 s46, s62, 3145728
  buffer_load_dwordx4 v64, s[4:7], s46 offen lds
  s_add_u32 m0, s51, 53248
  s_add_u32 s46, s62, 3538944
  buffer_load_dwordx4 v64, s[4:7], s46 offen lds
  s_add_u32 m0, s51, 57344
  s_add_u32 s46, s62, 3145856
  buffer_load_dwordx4 v64, s[4:7], s46 offen lds
  s_add_u32 m0, s51, 61440
  s_add_u32 s46, s62, 3539072
  buffer_load_dwordx4 v64, s[4:7], s46 offen lds
  s_add_u32 m0, s51, 65536
  s_add_u32 s46, s62, 3145984
  buffer_load_dwordx4 v64, s[4:7], s46 offen lds
  s_add_u32 m0, s51, 69632
  s_add_u32 s46, s62, 3539200
  buffer_load_dwordx4 v64, s[4:7], s46 offen lds
  ds_read_b64_tr_b16 a[144:145], v66 offset:8192
  ds_read_b64_tr_b16 a[146:147], v66 offset:9216
  ds_read_b64_tr_b16 a[148:149], v66 offset:12288
  ds_read_b64_tr_b16 a[150:151], v66 offset:13312
  ds_read_b64_tr_b16 a[152:153], v66 offset:16384
  ds_read_b64_tr_b16 a[154:155], v66 offset:17408
  ds_read_b64_tr_b16 a[156:157], v66 offset:20480
  ds_read_b64_tr_b16 a[158:159], v66 offset:21504
  ds_read_b64_tr_b16 a[160:161], v66 offset:24576
  ds_read_b64_tr_b16 a[162:163], v66 offset:25600
  ds_read_b64_tr_b16 a[164:165], v66 offset:28672
  ds_read_b64_tr_b16 a[166:167], v66 offset:29696
  s_waitcnt lgkmcnt(0)
  s_waitcnt vmcnt(24)
  s_barrier
  s_add_u32 m0, s51, 73728
  s_add_u32 s46, s62, 4718592
  buffer_load_dwordx4 v64, s[4:7], s46 offen lds
  s_add_u32 m0, s51, 77824
  s_add_u32 s46, s62, 5111808
  buffer_load_dwordx4 v64, s[4:7], s46 offen lds
  s_add_u32 m0, s51, 81920
  s_add_u32 s46, s62, 4718720
  buffer_load_dwordx4 v64, s[4:7], s46 offen lds
  s_add_u32 m0, s51, 86016
  s_add_u32 s46, s62, 5111936
  buffer_load_dwordx4 v64, s[4:7], s46 offen lds
  s_add_u32 m0, s51, 90112
  s_add_u32 s46, s62, 4718848
  buffer_load_dwordx4 v64, s[4:7], s46 offen lds
  s_add_u32 m0, s51, 94208
  s_add_u32 s46, s62, 5112064
  buffer_load_dwordx4 v64, s[4:7], s46 offen lds
  ds_read_b64_tr_b16 a[168:169], v66 offset:32768
  ds_read_b64_tr_b16 a[170:171], v66 offset:33792
  ds_read_b64_tr_b16 a[172:173], v66 offset:36864
  ds_read_b64_tr_b16 a[174:175], v66 offset:37888
  ds_read_b64_tr_b16 a[176:177], v66 offset:40960
  ds_read_b64_tr_b16 a[178:179], v66 offset:41984
  ds_read_b64_tr_b16 a[180:181], v66 offset:45056
  ds_read_b64_tr_b16 a[182:183], v66 offset:46080
  ds_read_b64_tr_b16 a[184:185], v66 offset:49152
  ds_read_b64_tr_b16 a[186:187], v66 offset:50176
  ds_read_b64_tr_b16 a[188:189], v66 offset:53248
  ds_read_b64_tr_b16 a[190:191], v66 offset:54272
  s_waitcnt lgkmcnt(0)
  s_waitcnt vmcnt(24)
  s_barrier
  s_add_u32 m0, s51, 98304
  s_add_u32 s46, s62, 5505024
  buffer_load_dwordx4 v64, s[4:7], s46 offen lds
  s_add_u32 m0, s51, 102400
  s_add_u32 s46, s62, 5898240
  buffer_load_dwordx4 v64, s[4:7], s46 offen lds
  s_add_u32 m0, s51, 106496
  s_add_u32 s46, s62, 5505152
  buffer_load_dwordx4 v64, s[4:7], s46 offen lds
  s_add_u32 m0, s51, 110592
  s_add_u32 s46, s62, 5898368
  buffer_load_dwordx4 v64, s[4:7], s46 offen lds
  s_add_u32 m0, s51, 114688
  s_add_u32 s46, s62, 5505280
  buffer_load_dwordx4 v64, s[4:7], s46 offen lds
  s_add_u32 m0, s51, 118784
  s_add_u32 s46, s62, 5898496
  buffer_load_dwordx4 v64, s[4:7], s46 offen lds
  ds_read_b64_tr_b16 a[192:193], v66 offset:57344
  ds_read_b64_tr_b16 a[194:195], v66 offset:58368
  ds_read_b64_tr_b16 a[196:197], v66 offset:61440
  ds_read_b64_tr_b16 a[198:199], v66 offset:62464
  ds_read_b64_tr_b16 a[200:201], v67 offset:0
  ds_read_b64_tr_b16 a[202:203], v67 offset:1024
  ds_read_b64_tr_b16 a[204:205], v67 offset:4096
  ds_read_b64_tr_b16 a[206:207], v67 offset:5120
  ds_read_b64_tr_b16 a[208:209], v67 offset:8192
  ds_read_b64_tr_b16 a[210:211], v67 offset:9216
  ds_read_b64_tr_b16 a[212:213], v67 offset:12288
  ds_read_b64_tr_b16 a[214:215], v67 offset:13312
  s_waitcnt lgkmcnt(0)
  s_waitcnt vmcnt(24)
  s_barrier
  s_add_u32 m0, s51, 122880
  s_add_u32 s46, s62, 7077888
  buffer_load_dwordx4 v64, s[4:7], s46 offen lds
  s_add_u32 m0, s51, 126976
  s_add_u32 s46, s62, 7471104
  buffer_load_dwordx4 v64, s[4:7], s46 offen lds
  s_add_u32 m0, s51, 131072
  s_add_u32 s46, s62, 7078016
  buffer_load_dwordx4 v64, s[4:7], s46 offen lds
  s_add_u32 m0, s51, 135168
  s_add_u32 s46, s62, 7471232
  buffer_load_dwordx4 v64, s[4:7], s46 offen lds
  s_add_u32 m0, s51, 139264
  s_add_u32 s46, s62, 7078144
  buffer_load_dwordx4 v64, s[4:7], s46 offen lds
  s_add_u32 m0, s51, 143360
  s_add_u32 s46, s62, 7471360
  buffer_load_dwordx4 v64, s[4:7], s46 offen lds
  ds_read_b64_tr_b16 a[216:217], v65 offset:0
  ds_read_b64_tr_b16 a[218:219], v65 offset:1024
  ds_read_b64_tr_b16 a[220:221], v65 offset:4096
  ds_read_b64_tr_b16 a[222:223], v65 offset:5120
  ds_read_b64_tr_b16 a[224:225], v65 offset:8192
  ds_read_b64_tr_b16 a[226:227], v65 offset:9216
  ds_read_b64_tr_b16 a[228:229], v65 offset:12288
  ds_read_b64_tr_b16 a[230:231], v65 offset:13312
  ds_read_b64_tr_b16 a[232:233], v65 offset:16384
  ds_read_b64_tr_b16 a[234:235], v65 offset:17408
  ds_read_b64_tr_b16 a[236:237], v65 offset:20480
  ds_read_b64_tr_b16 a[238:239], v65 offset:21504
  s_waitcnt lgkmcnt(0)
  s_waitcnt vmcnt(24)
  s_barrier
  s_add_u32 m0, s51, 0
  s_add_u32 s46, s62, 1572864
  buffer_load_dwordx4 v64, s[4:7], s46 offen lds
  s_add_u32 m0, s51, 4096
  s_add_u32 s46, s62, 1966080
  buffer_load_dwordx4 v64, s[4:7], s46 offen lds
  s_add_u32 m0, s51, 8192
  s_add_u32 s46, s62, 1572992
  buffer_load_dwordx4 v64, s[4:7], s46 offen lds
  s_add_u32 m0, s51, 12288
  s_add_u32 s46, s62, 1966208
  buffer_load_dwordx4 v64, s[4:7], s46 offen lds
  s_add_u32 m0, s51, 16384
  s_add_u32 s46, s62, 1573120
  buffer_load_dwordx4 v64, s[4:7], s46 offen lds
  s_add_u32 m0, s51, 20480
  s_add_u32 s46, s62, 1966336
  buffer_load_dwordx4 v64, s[4:7], s46 offen lds
  ds_read_b64_tr_b16 a[240:241], v65 offset:24576
  ds_read_b64_tr_b16 a[242:243], v65 offset:25600
  ds_read_b64_tr_b16 a[244:245], v65 offset:28672
  ds_read_b64_tr_b16 a[246:247], v65 offset:29696
  ds_read_b64_tr_b16 a[248:249], v65 offset:32768
  ds_read_b64_tr_b16 a[250:251], v65 offset:33792
  ds_read_b64_tr_b16 a[252:253], v65 offset:36864
  ds_read_b64_tr_b16 a[254:255], v65 offset:37888
  ds_read_b64_tr_b16 v[152:153], v65 offset:40960
  ds_read_b64_tr_b16 v[154:155], v65 offset:41984
  ds_read_b64_tr_b16 v[156:157], v65 offset:45056
  ds_read_b64_tr_b16 v[158:159], v65 offset:46080
  s_waitcnt lgkmcnt(0)
  s_waitcnt vmcnt(24)
  s_barrier
  s_add_u32 m0, s51, 24576
  s_add_u32 s46, s62, 3145728
  buffer_load_dwordx4 v64, s[12:15], s46 offen lds
  s_add_u32 m0, s51, 28672
  s_add_u32 s46, s62, 3538944
  buffer_load_dwordx4 v64, s[12:15], s46 offen lds
  s_add_u32 m0, s51, 32768
  s_add_u32 s46, s62, 3145856
  buffer_load_dwordx4 v64, s[12:15], s46 offen lds
  s_add_u32 m0, s51, 36864
  s_add_u32 s46, s62, 3539072
  buffer_load_dwordx4 v64, s[12:15], s46 offen lds
  s_add_u32 m0, s51, 40960
  s_add_u32 s46, s62, 3145984
  buffer_load_dwordx4 v64, s[12:15], s46 offen lds
  s_add_u32 m0, s51, 45056
  s_add_u32 s46, s62, 3539200
  buffer_load_dwordx4 v64, s[12:15], s46 offen lds
  ds_read_b64_tr_b16 v[160:161], v65 offset:49152
  ds_read_b64_tr_b16 v[162:163], v65 offset:50176
  ds_read_b64_tr_b16 v[164:165], v65 offset:53248
  ds_read_b64_tr_b16 v[166:167], v65 offset:54272
  ds_read_b64_tr_b16 v[168:169], v65 offset:57344
  ds_read_b64_tr_b16 v[170:171], v65 offset:58368
  ds_read_b64_tr_b16 v[172:173], v65 offset:61440
  ds_read_b64_tr_b16 v[174:175], v65 offset:62464
  ds_read_b64_tr_b16 v[176:177], v66 offset:0
  ds_read_b64_tr_b16 v[178:179], v66 offset:1024
  ds_read_b64_tr_b16 v[180:181], v66 offset:4096
  ds_read_b64_tr_b16 v[182:183], v66 offset:5120
  s_waitcnt lgkmcnt(0)
  s_waitcnt vmcnt(24)
  s_barrier
  s_add_u32 m0, s51, 49152
  s_add_u32 s46, s62, 3932160
  buffer_load_dwordx4 v64, s[4:7], s46 offen lds
  s_add_u32 m0, s51, 53248
  s_add_u32 s46, s62, 4325376
  buffer_load_dwordx4 v64, s[4:7], s46 offen lds
  s_add_u32 m0, s51, 57344
  s_add_u32 s46, s62, 3932288
  buffer_load_dwordx4 v64, s[4:7], s46 offen lds
  s_add_u32 m0, s51, 61440
  s_add_u32 s46, s62, 4325504
  buffer_load_dwordx4 v64, s[4:7], s46 offen lds
  s_add_u32 m0, s51, 65536
  s_add_u32 s46, s62, 3932416
  buffer_load_dwordx4 v64, s[4:7], s46 offen lds
  s_add_u32 m0, s51, 69632
  s_add_u32 s46, s62, 4325632
  buffer_load_dwordx4 v64, s[4:7], s46 offen lds
  ds_read_b64_tr_b16 v[184:185], v66 offset:8192
  ds_read_b64_tr_b16 v[186:187], v66 offset:9216
  ds_read_b64_tr_b16 v[188:189], v66 offset:12288
  ds_read_b64_tr_b16 v[190:191], v66 offset:13312
  ds_read_b64_tr_b16 v[192:193], v66 offset:16384
  ds_read_b64_tr_b16 v[194:195], v66 offset:17408
  ds_read_b64_tr_b16 v[196:197], v66 offset:20480
  ds_read_b64_tr_b16 v[198:199], v66 offset:21504
  ds_read_b64_tr_b16 v[200:201], v66 offset:24576
  ds_read_b64_tr_b16 v[202:203], v66 offset:25600
  ds_read_b64_tr_b16 v[204:205], v66 offset:28672
  ds_read_b64_tr_b16 v[206:207], v66 offset:29696
  s_waitcnt lgkmcnt(0)
  s_waitcnt vmcnt(24)
  s_barrier
  s_add_u32 m0, s51, 73728
  s_add_u32 s46, s62, 5505024
  buffer_load_dwordx4 v64, s[12:15], s46 offen lds
  s_add_u32 m0, s51, 77824
  s_add_u32 s46, s62, 5898240
  buffer_load_dwordx4 v64, s[12:15], s46 offen lds
  s_add_u32 m0, s51, 81920
  s_add_u32 s46, s62, 5505152
  buffer_load_dwordx4 v64, s[12:15], s46 offen lds
  s_add_u32 m0, s51, 86016
  s_add_u32 s46, s62, 5898368
  buffer_load_dwordx4 v64, s[12:15], s46 offen lds
  s_add_u32 m0, s51, 90112
  s_add_u32 s46, s62, 5505280
  buffer_load_dwordx4 v64, s[12:15], s46 offen lds
  s_add_u32 m0, s51, 94208
  s_add_u32 s46, s62, 5898496
  buffer_load_dwordx4 v64, s[12:15], s46 offen lds
  ds_read_b64_tr_b16 v[208:209], v66 offset:32768
  ds_read_b64_tr_b16 v[210:211], v66 offset:33792
  ds_read_b64_tr_b16 v[212:213], v66 offset:36864
  ds_read_b64_tr_b16 v[214:215], v66 offset:37888
  ds_read_b64_tr_b16 v[216:217], v66 offset:40960
  ds_read_b64_tr_b16 v[218:219], v66 offset:41984
  ds_read_b64_tr_b16 v[220:221], v66 offset:45056
  ds_read_b64_tr_b16 v[222:223], v66 offset:46080
  ds_read_b64_tr_b16 v[224:225], v66 offset:49152
  ds_read_b64_tr_b16 v[226:227], v66 offset:50176
  ds_read_b64_tr_b16 v[228:229], v66 offset:53248
  ds_read_b64_tr_b16 v[230:231], v66 offset:54272
  s_waitcnt lgkmcnt(0)
  s_waitcnt vmcnt(24)
  s_barrier
  s_add_u32 m0, s51, 98304
  s_add_u32 s46, s62, 6291456
  buffer_load_dwordx4 v64, s[4:7], s46 offen lds
  s_add_u32 m0, s51, 102400
  s_add_u32 s46, s62, 6684672
  buffer_load_dwordx4 v64, s[4:7], s46 offen lds
  s_add_u32 m0, s51, 106496
  s_add_u32 s46, s62, 6291584
  buffer_load_dwordx4 v64, s[4:7], s46 offen lds
  s_add_u32 m0, s51, 110592
  s_add_u32 s46, s62, 6684800
  buffer_load_dwordx4 v64, s[4:7], s46 offen lds
  s_add_u32 m0, s51, 114688
  s_add_u32 s46, s62, 6291712
  buffer_load_dwordx4 v64, s[4:7], s46 offen lds
  s_add_u32 m0, s51, 118784
  s_add_u32 s46, s62, 6684928
  buffer_load_dwordx4 v64, s[4:7], s46 offen lds
  ds_read_b64_tr_b16 v[232:233], v66 offset:57344
  ds_read_b64_tr_b16 v[234:235], v66 offset:58368
  ds_read_b64_tr_b16 v[236:237], v66 offset:61440
  ds_read_b64_tr_b16 v[238:239], v66 offset:62464
  ds_read_b64_tr_b16 v[240:241], v67 offset:0
  ds_read_b64_tr_b16 v[242:243], v67 offset:1024
  ds_read_b64_tr_b16 v[244:245], v67 offset:4096
  ds_read_b64_tr_b16 v[246:247], v67 offset:5120
  ds_read_b64_tr_b16 v[248:249], v67 offset:8192
  ds_read_b64_tr_b16 v[250:251], v67 offset:9216
  ds_read_b64_tr_b16 v[252:253], v67 offset:12288
  ds_read_b64_tr_b16 v[254:255], v67 offset:13312
  s_waitcnt lgkmcnt(0)
  s_waitcnt vmcnt(24)
  s_barrier
  ds_read_b64_tr_b16 v[40:41], v65 offset:0
  ds_read_b64_tr_b16 v[42:43], v65 offset:1024
  ds_read_b64_tr_b16 v[44:45], v65 offset:4096
  ds_read_b64_tr_b16 v[46:47], v65 offset:5120
  ds_read_b64_tr_b16 v[48:49], v65 offset:8192
  ds_read_b64_tr_b16 v[50:51], v65 offset:9216
  ds_read_b64_tr_b16 v[52:53], v65 offset:12288
  ds_read_b64_tr_b16 v[54:55], v65 offset:13312
  ds_read_b64_tr_b16 v[56:57], v65 offset:16384
  ds_read_b64_tr_b16 v[58:59], v65 offset:17408
  ds_read_b64_tr_b16 v[60:61], v65 offset:20480
  ds_read_b64_tr_b16 v[62:63], v65 offset:21504
  s_waitcnt lgkmcnt(0)
  s_waitcnt vmcnt(18)
  s_barrier
  ds_write_b128 v2, v[40:43] offset:0
  ds_write_b128 v2, v[44:47] offset:4096
  ds_write_b128 v2, v[48:51] offset:8192
  ds_write_b128 v2, v[52:55] offset:12288
  ds_write_b128 v2, v[56:59] offset:16384
  ds_write_b128 v2, v[60:63] offset:20480
  ds_read_b64_tr_b16 v[16:17], v65 offset:24576
  ds_read_b64_tr_b16 v[18:19], v65 offset:25600
  ds_read_b64_tr_b16 v[20:21], v65 offset:28672
  ds_read_b64_tr_b16 v[22:23], v65 offset:29696
  ds_read_b64_tr_b16 v[24:25], v65 offset:32768
  ds_read_b64_tr_b16 v[26:27], v65 offset:33792
  ds_read_b64_tr_b16 v[28:29], v65 offset:36864
  ds_read_b64_tr_b16 v[30:31], v65 offset:37888
  ds_read_b64_tr_b16 v[32:33], v65 offset:40960
  ds_read_b64_tr_b16 v[34:35], v65 offset:41984
  ds_read_b64_tr_b16 v[36:37], v65 offset:45056
  ds_read_b64_tr_b16 v[38:39], v65 offset:46080
  s_waitcnt lgkmcnt(0)
  s_waitcnt vmcnt(12)
  s_barrier
  ds_write_b128 v2, v[16:19] offset:24576
  ds_write_b128 v2, v[20:23] offset:28672
  ds_write_b128 v2, v[24:27] offset:32768
  ds_write_b128 v2, v[28:31] offset:36864
  ds_write_b128 v2, v[32:35] offset:40960
  ds_write_b128 v2, v[36:39] offset:45056
  ds_read_b64_tr_b16 v[40:41], v65 offset:49152
  ds_read_b64_tr_b16 v[42:43], v65 offset:50176
  ds_read_b64_tr_b16 v[44:45], v65 offset:53248
  ds_read_b64_tr_b16 v[46:47], v65 offset:54272
  ds_read_b64_tr_b16 v[48:49], v65 offset:57344
  ds_read_b64_tr_b16 v[50:51], v65 offset:58368
  ds_read_b64_tr_b16 v[52:53], v65 offset:61440
  ds_read_b64_tr_b16 v[54:55], v65 offset:62464
  ds_read_b64_tr_b16 v[56:57], v66 offset:0
  ds_read_b64_tr_b16 v[58:59], v66 offset:1024
  ds_read_b64_tr_b16 v[60:61], v66 offset:4096
  ds_read_b64_tr_b16 v[62:63], v66 offset:5120
  s_waitcnt lgkmcnt(0)
  s_waitcnt vmcnt(6)
  s_barrier
  ds_write_b128 v2, v[40:43] offset:49152
  ds_write_b128 v2, v[44:47] offset:53248
  ds_write_b128 v2, v[48:51] offset:57344
  ds_write_b128 v2, v[52:55] offset:61440
  ds_write_b128 v3, v[56:59] offset:0
  ds_write_b128 v3, v[60:63] offset:4096
  ds_read_b64_tr_b16 v[16:17], v66 offset:8192
  ds_read_b64_tr_b16 v[18:19], v66 offset:9216
  ds_read_b64_tr_b16 v[20:21], v66 offset:12288
  ds_read_b64_tr_b16 v[22:23], v66 offset:13312
  ds_read_b64_tr_b16 v[24:25], v66 offset:16384
  ds_read_b64_tr_b16 v[26:27], v66 offset:17408
  ds_read_b64_tr_b16 v[28:29], v66 offset:20480
  ds_read_b64_tr_b16 v[30:31], v66 offset:21504
  ds_read_b64_tr_b16 v[32:33], v66 offset:24576
  ds_read_b64_tr_b16 v[34:35], v66 offset:25600
  ds_read_b64_tr_b16 v[36:37], v66 offset:28672
  ds_read_b64_tr_b16 v[38:39], v66 offset:29696
  s_waitcnt lgkmcnt(0)
  s_waitcnt vmcnt(0)
  s_barrier
  ds_write_b128 v3, v[16:19] offset:8192
  ds_write_b128 v3, v[20:23] offset:12288
  ds_write_b128 v3, v[24:27] offset:16384
  ds_write_b128 v3, v[28:31] offset:20480
  ds_write_b128 v3, v[32:35] offset:24576
  ds_write_b128 v3, v[36:39] offset:28672
  ds_read_b64_tr_b16 v[40:41], v66 offset:32768
  ds_read_b64_tr_b16 v[42:43], v66 offset:33792
  ds_read_b64_tr_b16 v[44:45], v66 offset:36864
  ds_read_b64_tr_b16 v[46:47], v66 offset:37888
  ds_read_b64_tr_b16 v[48:49], v66 offset:40960
  ds_read_b64_tr_b16 v[50:51], v66 offset:41984
  ds_read_b64_tr_b16 v[52:53], v66 offset:45056
  ds_read_b64_tr_b16 v[54:55], v66 offset:46080
  ds_read_b64_tr_b16 v[56:57], v66 offset:49152
  ds_read_b64_tr_b16 v[58:59], v66 offset:50176
  ds_read_b64_tr_b16 v[60:61], v66 offset:53248
  ds_read_b64_tr_b16 v[62:63], v66 offset:54272
  s_waitcnt lgkmcnt(0)
  s_barrier
  ds_write_b128 v3, v[40:43] offset:32768
  ds_write_b128 v3, v[44:47] offset:36864
  ds_write_b128 v3, v[48:51] offset:40960
  ds_write_b128 v3, v[52:55] offset:45056
  ds_write_b128 v3, v[56:59] offset:49152
  ds_write_b128 v3, v[60:63] offset:53248
  s_waitcnt lgkmcnt(0)
  v_and_b32 v137, 3, v0
  v_lshlrev_b32 v137, 2, v137
  s_mov_b32 s50, 0
ss_15:
  global_load_dword v136, v137, s[38:39] sc1
  s_add_u32 s50, s50, 1
  s_cmp_gt_u32 s50, 131072
  s_cbranch_scc1 L_fail
  s_waitcnt vmcnt(0)
  v_readlane_b32 s46, v136, 0
  v_readlane_b32 s47, v136, 2
  s_cmp_lg_u32 s46, 0
  s_cselect_b32 s48, 7, 0
  s_add_u32 s46, s46, s2
  s_xor_b32 s49, s46, s43
  s_and_b32 s49, s49, s48
  s_cbranch_scc1 L_reroll
  s_cmp_lg_u32 s47, 0
  s_cbranch_scc1 ss_ok_16
  s_sleep 10
  s_branch ss_15
ss_ok_16:
  v_readlane_b32 s3, v136, 1
  s_nop 0
  s_and_b32 s3, s3, 0x2000
  v_and_b32 v136, 3, v0
  s_lshl_b32 s46, s43, 9
  s_add_u32 s46, s46, s3
  s_add_u32 s46, s46, 13369344
  v_lshl_add_u32 v10, v136, 7, s46
  s_lshl_b32 s46, s43, 7
  s_add_u32 s46, s46, s3
  s_add_u32 s46, s46, 13371392
  v_lshl_add_u32 v11, v136, 9, s46
  v_mov_b32 v7, 0x44444444
  v_mov_b32 v136, 0xeeeeeeee
  v_and_b32 v137, 2, v0
  v_cmp_ne_u32 vcc, 0, v137
  s_nop 1
  v_cndmask_b32 v7, v7, v136, vcc
  s_mov_b32 s69, 1037384597
  s_mov_b32 s70, 3494803967
  v_and_b32 v136, 15, v0
  v_lshrrev_b32 v138, 4, v0
  v_lshlrev_b32 v4, 4, v136
  v_lshl_add_u32 v4, v138, 2, v4
  s_lshl_b32 s46, s42, 8
  s_add_u32 s46, s46, 147456
  v_add_u32 v4, s46, v4
  v_lshlrev_b32 v5, 7, v138
  v_bfe_u32 v137, v0, 2, 2
  v_lshl_add_u32 v5, v137, 4, v5
  v_and_b32 v137, 1, v0
  v_lshl_add_u32 v5, v137, 3, v5
  v_add_u32 v5, 147456, v5
  v_add_u32 v13, 122880, v1
  v_bfe_u32 v140, v0, 1, 2
  v_lshl_add_u32 v140, v140, 2, v137
  v_bfe_u32 v137, v0, 3, 1
  v_lshl_add_u32 v140, v137, 1, v140
  v_cmp_eq_u32 s[18:19], 1, v137
  s_add_u32 s46, s3, 12582912
  s_lshr_b32 s47, s45, 4
  s_add_u32 s47, s47, 1
  s_lshl_b32 s47, s47, 14
  s_and_b32 s48, s45, 15
  s_lshl_b32 s48, s48, 9
  s_add_u32 s47, s47, s48
  s_add_u32 s47, s47, s46
  v_lshrrev_b32 v137, 1, v138
  v_and_b32 v139, 1, v138
  v_lshl_add_u32 v8, v137, 4, v140
  v_lshlrev_b32 v8, 4, v8
  v_lshl_add_u32 v8, v139, 3, v8
  v_add_u32 v8, s47, v8
  s_lshl_b32 s47, s45, 7
  s_add_u32 s47, s47, s46
  s_add_u32 s47, s47, 51200
  v_lshlrev_b32 v9, 3, v140
  v_lshl_add_u32 v9, v139, 2, v9
  v_add_u32 v9, s47, v9
  v_lshl_add_u32 v9, v137, 30, v9
  v_mov_b32 v140, 2146435072
  s_cmp_eq_u32 s44, 0
  s_cselect_b64 vcc, 15, 0
  v_cndmask_b32 v11, v140, v11, vcc
  v_lshlrev_b32 v14, 4, v136
  v_lshl_add_u32 v14, v139, 3, v14
  v_lshl_add_u32 v14, v137, 2, v14
  s_lshl_b32 s47, s45, 8
  s_add_u32 s47, s47, 65536
  v_add_u32 v14, s47, v14
  s_lshl_b32 s47, s42, 4
  v_add_u32 v136, s47, v136
  v_lshlrev_b32 v138, 2, v138
  v_sub_u32 v136, v136, v138
  v_cmp_gt_i32 s[72:73], 0, v136
  v_cmp_gt_i32 s[74:75], 1, v136
  v_cmp_gt_i32 s[76:77], 2, v136
  v_cmp_gt_i32 s[78:79], 3, v136
  v_cmp_gt_i32 s[80:81], 16, v136
  v_cmp_gt_i32 s[82:83], 17, v136
  v_cmp_gt_i32 s[84:85], 18, v136
  v_cmp_gt_i32 s[86:87], 19, v136
  s_lshl_b32 s46, s45, 7
  s_lshl_b32 s47, s42, 2
  s_add_u32 s47, s47, s46
  s_add_u32 s47, s47, 1069056
  v_mov_b32 v15, s47
  s_cmp_lg_u32 s42, 2
  s_cbranch_scc1 sc_fl
  v_and_b32 v15, 1, v0
  v_lshlrev_b32 v15, 12, v15
  s_add_u32 s46, s46, 1048576
  v_add_u32 v15, s46, v15
sc_fl:
  s_mov_b32 s23, s45
  s_lshl_b32 s20, s42, 24
  s_add_u32 s20, s20, s3
  s_add_u32 s20, s20, 31457280
  s_lshl_b32 s26, s42, 11
  s_lshl_b32 s46, s42, 24
  s_sub_u32 s26, s26, s46
  s_cmp_eq_u32 s42, 2
  s_cselect_b32 s26, 2012217344, s26
  s_lshl_b32 s21, s42, 12
  s_add_u32 s21, s21, 122880
  s_mov_b32 s22, 12288
  s_mul_i32 s64, s42, 81920
  s_add_u32 s64, s64, s3
  s_add_u32 s64, s64, 14680064
  s_lshr_b32 s27, s45, 3
  s_lshl_b32 s27, s27, 14
  s_and_b32 s46, s45, 7
  s_lshl_b32 s46, s46, 10
  s_add_u32 s27, s27, s46
  s_mov_b32 s61, 0
  s_mov_b32 s52, 0
  s_mov_b32 s58, 0
  s_mov_b32 s65, 524288
  s_mov_b32 s100, 0
  s_cmp_lg_u32 s42, 2
  s_cbranch_scc1 sc_k0
  s_mov_b32 s53, 1
  s_cmp_ge_u32 s61, s53
  s_cbranch_scc1 wf_done_17
  s_mov_b32 s50, 0
wf_loop_18:
  buffer_load_dword v136, v15, s[8:11], 0 offen sc1
  s_add_u32 s50, s50, 1
  s_cmp_gt_u32 s50, 131072
  s_cbranch_scc1 L_fail
  s_waitcnt vmcnt(0)
  v_min_u32_dpp v136, v136, v136 row_ror:8 row_mask:0xf bank_mask:0xf
  s_nop 1
  v_min_u32_dpp v136, v136, v136 row_ror:4 row_mask:0xf bank_mask:0xf
  s_nop 1
  v_min_u32_dpp v136, v136, v136 row_ror:2 row_mask:0xf bank_mask:0xf
  s_nop 1
  v_min_u32_dpp v136, v136, v136 row_ror:1 row_mask:0xf bank_mask:0xf
  v_mov_b32 v137, v136
  s_nop 1
  v_permlane16_swap_b32 v137, v136
  v_min_u32 v136, v136, v137
  v_mov_b32 v137, v136
  s_nop 1
  v_permlane32_swap_b32 v137, v136
  v_min_u32 v136, v136, v137
  s_nop 0
  v_readfirstlane_b32 s61, v136
  s_nop 0
  s_cmp_ge_u32 s61, s53
  s_cbranch_scc1 wf_done_17
  s_sleep 2
  s_branch wf_loop_18
wf_done_17:
sc_k0:
  s_barrier
  s_cmp_eq_u32 s42, 3
  s_cbranch_scc1 scs_loop
  s_mov_b32 m0, s21
  s_lshr_b32 s63, s23, 1
  s_lshl_b32 s63, s63, 14
  s_and_b32 s46, s23, 1
  s_lshl_b32 s46, s46, 12
  s_add_u32 s63, s63, s46
  s_add_u32 s63, s63, s20
  s_lshr_b32 s46, s63, 8
  s_and_b32 s46, s46, 0x2000
  s_xor_b32 s63, s63, s46
  buffer_load_dwordx4 v1, s[8:11], s63 offen offset:0 sc1 lds
  buffer_load_dwordx4 v1, s[8:11], s63 offen offset:1024 sc1 lds
  buffer_load_dwordx4 v1, s[8:11], s63 offen offset:2048 sc1 lds
  buffer_load_dwordx4 v1, s[8:11], s63 offen offset:3072 sc1 lds
  s_waitcnt vmcnt(0)
  s_branch sch_loop
scs_loop:
  s_add_u32 s53, s52, 1
  s_lshl_b32 s56, s58, 2
  s_add_u32 s56, s56, s43
  s_lshl_b32 s56, s56, 16
  s_add_u32 s56, s56, s3
  s_add_u32 s56, s56, 12582912
  v_add_u32 v12, s56, v1
  s_lshl_b32 s66, s58, 18
  s_mov_b64 s[16:17], -1
  s_mov_b32 s71, 0
  ds_read_b128 v[56:59], v2 offset:0
  ds_read_b128 v[60:63], v2 offset:4096
  ds_read_b128 v[64:67], v2 offset:8192
  ds_read_b128 v[68:71], v2 offset:12288
  ds_read_b128 v[72:75], v2 offset:16384
  ds_read_b128 v[76:79], v2 offset:20480
  ds_read_b128 v[80:83], v2 offset:24576
  ds_read_b128 v[84:87], v2 offset:28672
  v_mov_b32 v88, 0
  v_mov_b32 v89, 0
  v_mov_b32 v90, 0
  v_mov_b32 v91, 0
  v_mov_b32 v92, 0
  v_mov_b32 v93, 0
  v_mov_b32 v94, 0
  v_mov_b32 v95, 0
  v_mov_b32 v96, 0
  v_mov_b32 v97, 0
  v_mov_b32 v98, 0
  v_mov_b32 v99, 0
  v_mov_b32 v100, 0
  v_mov_b32 v101, 0
  v_mov_b32 v102, 0
  v_mov_b32 v103, 0
  v_mov_b32 v104, 0
  v_mov_b32 v105, 0
  v_mov_b32 v106, 0
  v_mov_b32 v107, 0
  v_mov_b32 v108, 0
  v_mov_b32 v109, 0
  v_mov_b32 v110, 0
  v_mov_b32 v111, 0
  v_mov_b32 v6, s53
  s_waitcnt lgkmcnt(0)
  s_barrier
  buffer_load_dwordx4 v[16:19], v12, s[8:11], 0 offen offset:0 sc1
  s_barrier
  buffer_load_dwordx4 v[20:23], v12, s[8:11], 0 offen offset:1024 sc1
  s_barrier
  buffer_load_dwordx4 v[24:27], v12, s[8:11], 0 offen offset:2048 sc1
  s_barrier
  buffer_load_dwordx4 v[28:31], v12, s[8:11], 0 offen offset:3072 sc1
  s_barrier
  buffer_load_dwordx4 v[32:35], v12, s[8:11], s24 offen offset:0 sc1
  s_barrier
  buffer_load_dwordx4 v[36:39], v12, s[8:11], s24 offen offset:1024 sc1
  s_barrier
  buffer_load_dwordx4 v[40:43], v12, s[8:11], s24 offen offset:2048 sc1
  s_barrier
  buffer_load_dwordx4 v[44:47], v12, s[8:11], s24 offen offset:3072 sc1
  s_barrier
  buffer_load_dwordx4 v[48:51], v12, s[8:11], s25 offen offset:0 sc1
  s_barrier
  buffer_load_dwordx4 v[52:55], v12, s[8:11], s25 offen offset:1024 sc1
scs_go_19:
  s_waitcnt vmcnt(9)
  v_smfmac_f32_16x16x64_bf16 v[88:91], v[16:19], a[192:199], v7
  v_smfmac_f32_16x16x64_bf16 v[92:95], v[16:19], a[200:207], v7
  v_smfmac_f32_16x16x64_bf16 v[96:99], v[16:19], a[208:215], v7
  v_smfmac_f32_16x16x64_bf16 v[100:103], v[16:19], a[0:7], v7
  s_waitcnt vmcnt(8)
  v_smfmac_f32_16x16x64_bf16 v[88:91], v[20:23], a[216:223], v7
  v_smfmac_f32_16x16x64_bf16 v[92:95], v[20:23], a[224:231], v7
  v_smfmac_f32_16x16x64_bf16 v[96:99], v[20:23], a[232:239], v7
  v_smfmac_f32_16x16x64_bf16 v[100:103], v[20:23], a[24:31], v7
  s_waitcnt vmcnt(7)
  v_smfmac_f32_16x16x64_bf16 v[88:91], v[24:27], v[56:63], v7
  v_smfmac_f32_16x16x64_bf16 v[92:95], v[24:27], v[64:71], v7
  ds_read_b128 v[56:59], v2 offset:49152
  v_smfmac_f32_16x16x64_bf16 v[96:99], v[24:27], v[72:79], v7
  ds_read_b128 v[60:63], v2 offset:53248
  v_smfmac_f32_16x16x64_bf16 v[100:103], v[24:27], a[48:55], v7
  ds_read_b128 v[64:67], v2 offset:57344
  s_waitcnt vmcnt(6)
  v_smfmac_f32_16x16x64_bf16 v[88:91], v[28:31], a[240:247], v7
  ds_read_b128 v[68:71], v2 offset:61440
  v_smfmac_f32_16x16x64_bf16 v[92:95], v[28:31], a[248:255], v7
  ds_read_b128 v[72:75], v3 offset:0
  v_smfmac_f32_16x16x64_bf16 v[96:99], v[28:31], v[152:159], v7
  ds_read_b128 v[76:79], v3 offset:4096
  v_smfmac_f32_16x16x64_bf16 v[100:103], v[28:31], a[72:79], v7
  s_waitcnt vmcnt(5)
  v_smfmac_f32_16x16x64_bf16 v[88:91], v[32:35], v[160:167], v7
  v_smfmac_f32_16x16x64_bf16 v[92:95], v[32:35], v[168:175], v7
  v_smfmac_f32_16x16x64_bf16 v[96:99], v[32:35], v[176:183], v7
  v_smfmac_f32_16x16x64_bf16 v[100:103], v[32:35], v[80:87], v7
  ds_read_b128 v[80:83], v3 offset:8192
  s_waitcnt vmcnt(4)
  s_waitcnt lgkmcnt(5)
  v_smfmac_f32_16x16x64_bf16 v[88:91], v[36:39], v[56:63], v7
  ds_read_b128 v[84:87], v3 offset:12288
  s_waitcnt lgkmcnt(4)
  v_smfmac_f32_16x16x64_bf16 v[92:95], v[36:39], v[64:71], v7
  ds_read_b128 v[56:59], v3 offset:32768
  s_waitcnt lgkmcnt(3)
  v_smfmac_f32_16x16x64_bf16 v[96:99], v[36:39], v[72:79], v7
  ds_read_b128 v[60:63], v3 offset:36864
  v_smfmac_f32_16x16x64_bf16 v[100:103], v[36:39], a[96:103], v7
  ds_read_b128 v[64:67], v3 offset:40960
  s_waitcnt vmcnt(3)
  v_smfmac_f32_16x16x64_bf16 v[88:91], v[40:43], v[184:191], v7
  ds_read_b128 v[68:71], v3 offset:45056
  v_smfmac_f32_16x16x64_bf16 v[92:95], v[40:43], v[192:199], v7
  ds_read_b128 v[72:75], v3 offset:49152
  v_smfmac_f32_16x16x64_bf16 v[96:99], v[40:43], v[200:207], v7
  ds_read_b128 v[76:79], v3 offset:53248
  v_smfmac_f32_16x16x64_bf16 v[100:103], v[40:43], a[120:127], v7
  s_waitcnt vmcnt(2)
  v_smfmac_f32_16x16x64_bf16 v[88:91], v[44:47], v[208:215], v7
  v_smfmac_f32_16x16x64_bf16 v[92:95], v[44:47], v[216:223], v7
  v_smfmac_f32_16x16x64_bf16 v[96:99], v[44:47], v[224:231], v7
  s_waitcnt lgkmcnt(6)
  v_smfmac_f32_16x16x64_bf16 v[100:103], v[44:47], v[80:87], v7
  ds_read_b128 v[80:83], v2 offset:32768
  s_waitcnt vmcnt(1)
  s_waitcnt lgkmcnt(5)
  v_smfmac_f32_16x16x64_bf16 v[88:91], v[48:51], v[56:63], v7
  ds_read_b128 v[84:87], v2 offset:36864
  s_waitcnt lgkmcnt(4)
  v_smfmac_f32_16x16x64_bf16 v[92:95], v[48:51], v[64:71], v7
  ds_read_b128 v[56:59], v3 offset:16384
  s_waitcnt lgkmcnt(3)
  v_smfmac_f32_16x16x64_bf16 v[96:99], v[48:51], v[72:79], v7
  ds_read_b128 v[60:63], v3 offset:20480
  v_smfmac_f32_16x16x64_bf16 v[100:103], v[48:51], a[144:151], v7
  ds_read_b128 v[64:67], v2 offset:40960
  s_waitcnt vmcnt(0)
  v_smfmac_f32_16x16x64_bf16 v[88:91], v[52:55], v[232:239], v7
  ds_read_b128 v[68:71], v2 offset:45056
  v_smfmac_f32_16x16x64_bf16 v[92:95], v[52:55], v[240:247], v7
  ds_read_b128 v[72:75], v3 offset:24576
  v_smfmac_f32_16x16x64_bf16 v[96:99], v[52:55], v[248:255], v7
  ds_read_b128 v[76:79], v3 offset:28672
  v_smfmac_f32_16x16x64_bf16 v[100:103], v[52:55], a[168:175], v7
  v_smfmac_f32_16x16x64_bf16 v[104:107], v[16:19], a[8:15], v7
  v_add_f32 v88, v88, v90
  v_smfmac_f32_16x16x64_bf16 v[104:107], v[20:23], a[32:39], v7
  v_add_f32 v89, v89, v91
  v_smfmac_f32_16x16x64_bf16 v[104:107], v[24:27], a[56:63], v7
  v_cmp_u_f32 vcc, v88, v89
  v_smfmac_f32_16x16x64_bf16 v[104:107], v[28:31], a[80:87], v7
  v_cvt_pk_bf16_f32 v136, v88, v89
  v_smfmac_f32_16x16x64_bf16 v[104:107], v[36:39], a[104:111], v7
  s_and_b64 vcc, vcc, s[16:17]
  s_cbranch_scc1 scs_redo_20
  v_add_f32 v92, v92, v94
  v_smfmac_f32_16x16x64_bf16 v[104:107], v[40:43], a[128:135], v7
  ds_write_b32 v4, v136 offset:0
  v_add_f32 v93, v93, v95
  v_smfmac_f32_16x16x64_bf16 v[104:107], v[48:51], a[152:159], v7
  s_waitcnt lgkmcnt(1)
  v_cvt_pk_bf16_f32 v137, v92, v93
  v_smfmac_f32_16x16x64_bf16 v[104:107], v[52:55], a[176:183], v7
  ds_write_b32 v4, v137 offset:1024
  v_add_f32 v96, v96, v98
  v_smfmac_f32_16x16x64_bf16 v[104:107], v[32:35], v[80:87], v7
  v_add_f32 v97, v97, v99
  v_smfmac_f32_16x16x64_bf16 v[104:107], v[44:47], v[56:63], v7
  ds_read_b128 v[80:83], v13 offset:5120
  v_cvt_pk_bf16_f32 v138, v96, v97
  v_smfmac_f32_16x16x64_bf16 v[108:111], v[32:35], v[64:71], v7
  ds_write_b32 v4, v138 offset:2048
  v_add_f32 v100, v100, v102
  v_smfmac_f32_16x16x64_bf16 v[108:111], v[44:47], v[72:79], v7
  ds_read_b128 v[56:59], v13 offset:0
  v_add_f32 v101, v101, v103
  v_smfmac_f32_16x16x64_bf16 v[108:111], v[16:19], a[16:23], v7
  ds_read_b128 v[60:63], v13 offset:2048
  v_cvt_pk_bf16_f32 v139, v100, v101
  v_smfmac_f32_16x16x64_bf16 v[108:111], v[20:23], a[40:47], v7
  ds_write_b32 v4, v139 offset:3072
  v_add_f32 v104, v104, v106
  v_smfmac_f32_16x16x64_bf16 v[108:111], v[24:27], a[64:71], v7
  s_waitcnt lgkmcnt(3)
  s_barrier
  v_add_f32 v105, v105, v107
  v_smfmac_f32_16x16x64_bf16 v[108:111], v[28:31], a[88:95], v7
  ds_read_b64_tr_b16 v[112:113], v5 offset:0
  ds_read_b64_tr_b16 v[114:115], v5 offset:64
  v_cvt_pk_bf16_f32 v140, v104, v105
  v_smfmac_f32_16x16x64_bf16 v[108:111], v[36:39], a[112:119], v7
  ds_write_b32 v4, v140 offset:4096
  ds_read_b64_tr_b16 v[116:117], v5 offset:512
  v_smfmac_f32_16x16x64_bf16 v[108:111], v[40:43], a[136:143], v7
  ds_read_b64_tr_b16 v[118:119], v5 offset:576
  ds_read_b128 v[64:67], v13 offset:1024
  v_smfmac_f32_16x16x64_bf16 v[108:111], v[48:51], a[160:167], v7
  ds_read_b64_tr_b16 v[120:121], v5 offset:1024
  ds_read_b128 v[68:71], v13 offset:3072
  v_smfmac_f32_16x16x64_bf16 v[108:111], v[52:55], a[184:191], v7
  ds_read_b64_tr_b16 v[122:123], v5 offset:1088
  ds_read_b128 v[72:75], v13 offset:4096
  s_waitcnt lgkmcnt(8)
  v_mfma_f32_16x16x32_bf16 v[88:91], v[56:59], v[112:115], 0
  ds_read_b128 v[76:79], v13 offset:6144
  ds_read_b128 v[84:87], v13 offset:7168
  v_mfma_f32_16x16x32_bf16 v[92:95], v[60:63], v[112:115], 0
  ds_read_b64_tr_b16 v[124:125], v5 offset:1536
  ds_read_b64_tr_b16 v[126:127], v5 offset:1600
  s_waitcnt lgkmcnt(8)
  v_add_f32 v108, v108, v110
  v_mfma_f32_16x16x32_bf16 v[88:91], v[64:67], v[116:119], v[88:91]
  s_waitcnt lgkmcnt(6)
  v_add_f32 v109, v109, v111
  v_cvt_pk_bf16_f32 v141, v108, v109
  v_mfma_f32_16x16x32_bf16 v[92:95], v[68:71], v[116:119], v[92:95]
  ds_write_b32 v4, v141 offset:5120
  ds_read_b128 v[56:59], v13 offset:8192
  s_waitcnt lgkmcnt(6)
  v_mfma_f32_16x16x32_bf16 v[88:91], v[72:75], v[120:123], v[88:91]
  ds_read_b64_tr_b16 v[128:129], v5 offset:2048
  ds_read_b64_tr_b16 v[130:131], v5 offset:2112
  buffer_store_dword v6, v11, s[8:11], 0 offen sc1
  s_waitcnt lgkmcnt(7)
  v_mfma_f32_16x16x32_bf16 v[92:95], v[76:79], v[120:123], v[92:95]
  ds_read_b128 v[60:63], v13 offset:10240
  ds_read_b128 v[64:67], v13 offset:9216
  s_waitcnt lgkmcnt(6)
  v_mfma_f32_16x16x32_bf16 v[88:91], v[80:83], v[124:127], v[88:91]
  ds_read_b64_tr_b16 v[132:133], v5 offset:2560
  ds_read_b64_tr_b16 v[134:135], v5 offset:2624
  v_mfma_f32_16x16x32_bf16 v[92:95], v[84:87], v[124:127], v[92:95]
  ds_read_b128 v[68:71], v13 offset:11264
  s_waitcnt lgkmcnt(8)
  s_barrier
  s_waitcnt lgkmcnt(5)
  v_mfma_f32_16x16x32_bf16 v[88:91], v[56:59], v[128:131], v[88:91]
  ds_read_b64_tr_b16 v[16:17], v5 offset:3072
  ds_read_b64_tr_b16 v[18:19], v5 offset:3136
  s_waitcnt lgkmcnt(6)
  v_mfma_f32_16x16x32_bf16 v[92:95], v[60:63], v[128:131], v[92:95]
  ds_read_b64_tr_b16 v[20:21], v5 offset:3584
  ds_read_b64_tr_b16 v[22:23], v5 offset:3648
  s_waitcnt lgkmcnt(5)
  v_mfma_f32_16x16x32_bf16 v[88:91], v[64:67], v[132:135], v[88:91]
  ds_read_b64_tr_b16 v[24:25], v5 offset:4096
  ds_read_b64_tr_b16 v[26:27], v5 offset:4160
  s_waitcnt lgkmcnt(6)
  v_mfma_f32_16x16x32_bf16 v[92:95], v[68:71], v[132:135], v[92:95]
  ds_read_b64_tr_b16 v[28:29], v5 offset:4608
  ds_read_b64_tr_b16 v[30:31], v5 offset:4672
  s_waitcnt lgkmcnt(6)
  v_mfma_f32_16x16x32_bf16 v[96:99], v[16:19], v[112:115], 0
  ds_read_b64_tr_b16 v[32:33], v5 offset:5120
  ds_read_b64_tr_b16 v[34:35], v5 offset:5184
  s_waitcnt lgkmcnt(6)
  v_mfma_f32_16x16x32_bf16 v[96:99], v[20:23], v[116:119], v[96:99]
  ds_read_b64_tr_b16 v[36:37], v5 offset:5632
  ds_read_b64_tr_b16 v[38:39], v5 offset:5696
  s_waitcnt lgkmcnt(6)
  v_cndmask_b32 v136, v88, v90, s[18:19]
  v_mfma_f32_16x16x32_bf16 v[96:99], v[24:27], v[120:123], v[96:99]
  s_barrier
  s_waitcnt lgkmcnt(4)
  v_cndmask_b32 v137, v89, v91, s[18:19]
  v_cndmask_b32 v138, v92, v94, s[18:19]
  v_mfma_f32_16x16x32_bf16 v[96:99], v[28:31], v[124:127], v[96:99]
  s_waitcnt lgkmcnt(2)
  v_cndmask_b32 v139, v93, v95, s[18:19]
  v_max3_f32 v142, v136, v137, v138
  v_mfma_f32_16x16x32_bf16 v[96:99], v[32:35], v[128:131], v[96:99]
  s_waitcnt lgkmcnt(0)
  v_max_f32 v142, v142, v139
  v_mov_b32 v143, v142
  v_mfma_f32_16x16x32_bf16 v[96:99], v[36:39], v[132:135], v[96:99]
  s_nop 0
  v_permlane32_swap_b32 v143, v142
  v_max_f32 v142, v142, v143
  s_nop 4
  v_cndmask_b32 v140, v96, v98, s[18:19]
  v_cndmask_b32 v141, v97, v99, s[18:19]
  v_max3_f32 v142, v142, v140, v141
  s_nop 1
  v_max_f32_dpp v142, v142, v142 row_ror:8 row_mask:0xf bank_mask:0xf
  v_mov_b32 v143, v142
  s_nop 1
  v_permlane16_swap_b32 v143, v142
  v_max_f32 v142, v142, v143
  v_mul_f32 v142, s69, v142
  v_fma_f32 v136, v136, s69, -v142
  v_fma_f32 v137, v137, s69, -v142
  v_fma_f32 v138, v138, s69, -v142
  v_fma_f32 v139, v139, s69, -v142
  v_fma_f32 v140, v140, s69, -v142
  v_fma_f32 v141, v141, s69, -v142
  v_exp_f32 v136, v136
  v_exp_f32 v137, v137
  v_exp_f32 v138, v138
  v_exp_f32 v139, v139
  v_add_f32 v142, v136, v137
  v_add_f32 v143, v138, v139
  v_add_f32 v142, v142, v143
  v_mov_b32 v143, v142
  v_exp_f32 v140, v140
  v_exp_f32 v141, v141
  v_permlane32_swap_b32 v143, v142
  v_add_f32 v144, v140, v141
  v_add_f32 v142, v142, v143
  v_add_f32 v142, v142, v144
  s_nop 1
  v_add_f32_dpp v142, v142, v142 row_ror:8 row_mask:0xf bank_mask:0xf
  v_mov_b32 v143, v142
  s_nop 1
  v_permlane16_swap_b32 v143, v142
  v_add_f32 v142, v142, v143
  v_rcp_f32 v142, v142
  s_nop 0
  v_mul_f32 v136, v136, v142
  v_mul_f32 v137, v137, v142
  v_mul_f32 v138, v138, v142
  v_mul_f32 v139, v139, v142
  v_cvt_pk_bf16_f32 v146, v136, v137
  v_cvt_pk_bf16_f32 v147, v138, v139
  buffer_store_dwordx2 v[146:147], v8, s[8:11], s66 offen sc1
  v_mul_f32 v140, v140, v142
  v_mul_f32 v141, v141, v142
  v_cvt_pk_bf16_f32 v148, v140, v141
  buffer_store_dword v148, v9, s[8:11], s66 offen sc1
  v_mov_b32 v150, -1
  v_mov_b32 v151, -1
  s_add_u32 s46, s65, 0
  buffer_store_dwordx2 v[150:151], v8, s[8:11], s46 offen sc1
  buffer_store_dword v150, v9, s[8:11], s46 offen sc1
  s_mov_b32 s65, s66
  v_add_u32 v13, s22, v13
  s_sub_u32 s22, 0, s22
  s_add_u32 s58, s58, 1
  s_cmp_eq_u32 s58, 3
  s_cselect_b32 s58, 0, s58
  s_mov_b32 s52, s53
  s_cmp_lt_u32 s52, 64
  s_cbranch_scc1 scs_loop
  s_endpgm
sch_loop:
  s_add_u32 s53, s52, 1
  s_lshl_b32 s56, s58, 2
  s_add_u32 s56, s56, s43
  s_lshl_b32 s56, s56, 16
  s_add_u32 s56, s56, s3
  s_add_u32 s56, s56, 12582912
  v_add_u32 v12, s56, v1
  s_lshl_b32 s66, s58, 18
  s_mov_b64 s[16:17], -1
  s_mov_b32 s71, 0
  ds_read_b128 v[56:59], v2 offset:0
  ds_read_b128 v[60:63], v2 offset:4096
  ds_read_b128 v[64:67], v2 offset:8192
  ds_read_b128 v[68:71], v2 offset:12288
  ds_read_b128 v[72:75], v2 offset:16384
  ds_read_b128 v[76:79], v2 offset:20480
  ds_read_b128 v[80:83], v2 offset:24576
  ds_read_b128 v[84:87], v2 offset:28672
  v_mov_b32 v88, 0
  v_mov_b32 v89, 0
  v_mov_b32 v90, 0
  v_mov_b32 v91, 0
  v_mov_b32 v92, 0
  v_mov_b32 v93, 0
  v_mov_b32 v94, 0
  v_mov_b32 v95, 0
  v_mov_b32 v96, 0
  v_mov_b32 v97, 0
  v_mov_b32 v98, 0
  v_mov_b32 v99, 0
  v_mov_b32 v100, 0
  v_mov_b32 v101, 0
  v_mov_b32 v102, 0
  v_mov_b32 v103, 0
  v_mov_b32 v104, 0
  v_mov_b32 v105, 0
  v_mov_b32 v106, 0
  v_mov_b32 v107, 0
  v_mov_b32 v108, 0
  v_mov_b32 v109, 0
  v_mov_b32 v110, 0
  v_mov_b32 v111, 0
  s_xor_b32 s28, s63, 0x2000
  s_add_u32 s28, s28, s26
  s_add_u32 s29, s28, 16777216
  s_add_u32 s30, s28, 33554432
  s_add_u32 s23, s23, 32
  s_cmp_ge_u32 s23, 1024
  s_cselect_b32 s46, 1024, 0
  s_sub_u32 s23, s23, s46
  s_lshr_b32 s63, s23, 1
  s_lshl_b32 s63, s63, 14
  s_and_b32 s46, s23, 1
  s_lshl_b32 s46, s46, 12
  s_add_u32 s63, s63, s46
  s_add_u32 s63, s63, s20
  s_lshr_b32 s46, s63, 8
  s_and_b32 s46, s46, 0x2000
  s_xor_b32 s63, s63, s46
  s_add_u32 s21, s21, s22
  s_mov_b32 m0, s21
  s_cmp_lg_u32 s42, 2
  s_cbranch_scc1 sc_nobell
  s_add_u32 s49, s52, 2
  s_min_u32 s49, s49, 64
  s_cmp_ge_u32 s61, s49
  s_cbranch_scc1 wf_done_21
  s_mov_b32 s50, 0
wf_loop_22:
  buffer_load_dword v136, v15, s[8:11], 0 offen sc1
  s_add_u32 s50, s50, 1
  s_cmp_gt_u32 s50, 131072
  s_cbranch_scc1 L_fail
  s_waitcnt vmcnt(0)
  v_min_u32_dpp v136, v136, v136 row_ror:8 row_mask:0xf bank_mask:0xf
  s_nop 1
  v_min_u32_dpp v136, v136, v136 row_ror:4 row_mask:0xf bank_mask:0xf
  s_nop 1
  v_min_u32_dpp v136, v136, v136 row_ror:2 row_mask:0xf bank_mask:0xf
  s_nop 1
  v_min_u32_dpp v136, v136, v136 row_ror:1 row_mask:0xf bank_mask:0xf
  v_mov_b32 v137, v136
  s_nop 1
  v_permlane16_swap_b32 v137, v136
  v_min_u32 v136, v136, v137
  v_mov_b32 v137, v136
  s_nop 1
  v_permlane32_swap_b32 v137, v136
  v_min_u32 v136, v136, v137
  s_nop 0
  v_readfirstlane_b32 s61, v136
  s_nop 0
  s_cmp_ge_u32 s61, s49
  s_cbranch_scc1 wf_done_21
  s_sleep 2
  s_branch wf_loop_22
wf_done_21:
  s_mov_b32 s50, 0
  s_mov_b64 exec, 15
  buffer_load_dword v112, v10, s[8:11], 0 offen sc1
  s_nop 11
  buffer_load_dword v113, v10, s[8:11], 0 offen sc1
  s_nop 11
  buffer_load_dword v114, v10, s[8:11], 0 offen sc1
  s_nop 11
  buffer_load_dword v115, v10, s[8:11], 0 offen sc1
  s_nop 11
  buffer_load_dword v116, v10, s[8:11], 0 offen sc1
  s_nop 11
  buffer_load_dword v117, v10, s[8:11], 0 offen sc1
  s_nop 11
  buffer_load_dword v118, v10, s[8:11], 0 offen sc1
  s_nop 11
  buffer_load_dword v119, v10, s[8:11], 0 offen sc1
  s_nop 11
  buffer_load_dword v120, v10, s[8:11], 0 offen sc1
  s_nop 11
bell_23:
  buffer_load_dword v121, v10, s[8:11], 0 offen sc1
  s_waitcnt vmcnt(9)
  v_cmp_gt_u32 vcc, s53, v112
  s_cbranch_vccz bell_x_24
  s_nop 7
  buffer_load_dword v112, v10, s[8:11], 0 offen sc1
  s_waitcnt vmcnt(9)
  v_cmp_gt_u32 vcc, s53, v113
  s_cbranch_vccz bell_x_24
  s_nop 7
  buffer_load_dword v113, v10, s[8:11], 0 offen sc1
  s_waitcnt vmcnt(9)
  v_cmp_gt_u32 vcc, s53, v114
  s_cbranch_vccz bell_x_24
  s_nop 7
  buffer_load_dword v114, v10, s[8:11], 0 offen sc1
  s_waitcnt vmcnt(9)
  v_cmp_gt_u32 vcc, s53, v115
  s_cbranch_vccz bell_x_24
  s_nop 7
  buffer_load_dword v115, v10, s[8:11], 0 offen sc1
  s_waitcnt vmcnt(9)
  v_cmp_gt_u32 vcc, s53, v116
  s_cbranch_vccz bell_x_24
  s_nop 7
  buffer_load_dword v116, v10, s[8:11], 0 offen sc1
  s_waitcnt vmcnt(9)
  v_cmp_gt_u32 vcc, s53, v117
  s_cbranch_vccz bell_x_24
  s_nop 7
  buffer_load_dword v117, v10, s[8:11], 0 offen sc1
  s_waitcnt vmcnt(9)
  v_cmp_gt_u32 vcc, s53, v118
  s_cbranch_vccz bell_x_24
  s_nop 7
  buffer_load_dword v118, v10, s[8:11], 0 offen sc1
  s_waitcnt vmcnt(9)
  v_cmp_gt_u32 vcc, s53, v119
  s_cbranch_vccz bell_x_24
  s_nop 7
  buffer_load_dword v119, v10, s[8:11], 0 offen sc1
  s_waitcnt vmcnt(9)
  v_cmp_gt_u32 vcc, s53, v120
  s_cbranch_vccz bell_x_24
  s_nop 7
  buffer_load_dword v120, v10, s[8:11], 0 offen sc1
  s_waitcnt vmcnt(9)
  v_cmp_gt_u32 vcc, s53, v121
  s_cbranch_vccz bell_x_24
  s_add_u32 s50, s50, 1
  s_cmp_gt_u32 s50, 131072
  s_cbranch_scc1 L_fail
  s_branch bell_23
bell_x_24:
  s_mov_b64 exec, -1
sc_nobell:
  s_waitcnt lgkmcnt(0)
  s_barrier
  buffer_load_dwordx4 v[16:19], v12, s[8:11], 0 offen offset:0 sc1
  s_barrier
  buffer_load_dwordx4 v[20:23], v12, s[8:11], 0 offen offset:1024 sc1
  s_barrier
  buffer_load_dwordx4 v[24:27], v12, s[8:11], 0 offen offset:2048 sc1
  s_barrier
  buffer_load_dwordx4 v[28:31], v12, s[8:11], 0 offen offset:3072 sc1
  s_barrier
  buffer_load_dwordx4 v[32:35], v12, s[8:11], s24 offen offset:0 sc1
  s_barrier
  buffer_load_dwordx4 v[36:39], v12, s[8:11], s24 offen offset:1024 sc1
  s_barrier
  buffer_load_dwordx4 v[40:43], v12, s[8:11], s24 offen offset:2048 sc1
  s_barrier
  buffer_load_dwordx4 v[44:47], v12, s[8:11], s24 offen offset:3072 sc1
  s_barrier
  buffer_load_dwordx4 v[48:51], v12, s[8:11], s25 offen offset:0 sc1
  s_barrier
  buffer_load_dwordx4 v[52:55], v12, s[8:11], s25 offen offset:1024 sc1
sch_go_25:
  s_waitcnt vmcnt(9)
  v_smfmac_f32_16x16x64_bf16 v[88:91], v[16:19], a[192:199], v7
  v_smfmac_f32_16x16x64_bf16 v[92:95], v[16:19], a[200:207], v7
  v_smfmac_f32_16x16x64_bf16 v[96:99], v[16:19], a[208:215], v7
  v_smfmac_f32_16x16x64_bf16 v[100:103], v[16:19], a[0:7], v7
  s_waitcnt vmcnt(8)
  v_smfmac_f32_16x16x64_bf16 v[88:91], v[20:23], a[216:223], v7
  v_smfmac_f32_16x16x64_bf16 v[92:95], v[20:23], a[224:231], v7
  v_smfmac_f32_16x16x64_bf16 v[96:99], v[20:23], a[232:239], v7
  v_smfmac_f32_16x16x64_bf16 v[100:103], v[20:23], a[24:31], v7
  s_waitcnt vmcnt(7)
  v_smfmac_f32_16x16x64_bf16 v[88:91], v[24:27], v[56:63], v7
  buffer_load_dwordx4 v[112:115], v1, s[8:11], s28 offen offset:0 sc1
  v_smfmac_f32_16x16x64_bf16 v[92:95], v[24:27], v[64:71], v7
  ds_read_b128 v[56:59], v2 offset:49152
  v_smfmac_f32_16x16x64_bf16 v[96:99], v[24:27], v[72:79], v7
  ds_read_b128 v[60:63], v2 offset:53248
  v_smfmac_f32_16x16x64_bf16 v[100:103], v[24:27], a[48:55], v7
  ds_read_b128 v[64:67], v2 offset:57344
  buffer_load_dwordx4 v[116:119], v1, s[8:11], s28 offen offset:1024 sc1
  s_waitcnt vmcnt(8)
  v_smfmac_f32_16x16x64_bf16 v[88:91], v[28:31], a[240:247], v7
  ds_read_b128 v[68:71], v2 offset:61440
  v_smfmac_f32_16x16x64_bf16 v[92:95], v[28:31], a[248:255], v7
  ds_read_b128 v[72:75], v3 offset:0
  v_smfmac_f32_16x16x64_bf16 v[96:99], v[28:31], v[152:159], v7
  ds_read_b128 v[76:79], v3 offset:4096
  buffer_load_dwordx4 v[120:123], v1, s[8:11], s29 offen offset:0 sc1
  v_smfmac_f32_16x16x64_bf16 v[100:103], v[28:31], a[72:79], v7
  s_waitcnt vmcnt(8)
  v_smfmac_f32_16x16x64_bf16 v[88:91], v[32:35], v[160:167], v7
  v_smfmac_f32_16x16x64_bf16 v[92:95], v[32:35], v[168:175], v7
  buffer_load_dwordx4 v[124:127], v1, s[8:11], s29 offen offset:1024 sc1
  v_smfmac_f32_16x16x64_bf16 v[96:99], v[32:35], v[176:183], v7
  v_smfmac_f32_16x16x64_bf16 v[100:103], v[32:35], v[80:87], v7
  ds_read_b128 v[80:83], v3 offset:8192
  s_waitcnt vmcnt(8)
  s_waitcnt lgkmcnt(5)
  v_smfmac_f32_16x16x64_bf16 v[88:91], v[36:39], v[56:63], v7
  ds_read_b128 v[84:87], v3 offset:12288
  buffer_load_dwordx4 v[128:131], v1, s[8:11], s30 offen offset:0 sc1
  s_waitcnt lgkmcnt(4)
  v_smfmac_f32_16x16x64_bf16 v[92:95], v[36:39], v[64:71], v7
  ds_read_b128 v[56:59], v3 offset:32768
  s_waitcnt lgkmcnt(3)
  v_smfmac_f32_16x16x64_bf16 v[96:99], v[36:39], v[72:79], v7
  ds_read_b128 v[60:63], v3 offset:36864
  v_smfmac_f32_16x16x64_bf16 v[100:103], v[36:39], a[96:103], v7
  ds_read_b128 v[64:67], v3 offset:40960
  buffer_load_dwordx4 v[132:135], v1, s[8:11], s30 offen offset:1024 sc1
  s_waitcnt vmcnt(9)
  v_smfmac_f32_16x16x64_bf16 v[88:91], v[40:43], v[184:191], v7
  ds_read_b128 v[68:71], v3 offset:45056
  v_smfmac_f32_16x16x64_bf16 v[92:95], v[40:43], v[192:199], v7
  ds_read_b128 v[72:75], v3 offset:49152
  v_smfmac_f32_16x16x64_bf16 v[96:99], v[40:43], v[200:207], v7
  ds_read_b128 v[76:79], v3 offset:53248
  buffer_load_dwordx4 v1, s[8:11], s63 offen offset:0 sc1 lds
  v_smfmac_f32_16x16x64_bf16 v[100:103], v[40:43], a[120:127], v7
  s_waitcnt vmcnt(9)
  v_smfmac_f32_16x16x64_bf16 v[88:91], v[44:47], v[208:215], v7
  v_smfmac_f32_16x16x64_bf16 v[92:95], v[44:47], v[216:223], v7
  buffer_load_dwordx4 v1, s[8:11], s63 offen offset:1024 sc1 lds
  v_smfmac_f32_16x16x64_bf16 v[96:99], v[44:47], v[224:231], v7
  s_waitcnt lgkmcnt(6)
  v_smfmac_f32_16x16x64_bf16 v[100:103], v[44:47], v[80:87], v7
  ds_read_b128 v[80:83], v2 offset:32768
  s_waitcnt vmcnt(9)
  s_waitcnt lgkmcnt(5)
  v_smfmac_f32_16x16x64_bf16 v[88:91], v[48:51], v[56:63], v7
  ds_read_b128 v[84:87], v2 offset:36864
  buffer_load_dwordx4 v1, s[8:11], s63 offen offset:2048 sc1 lds
  s_waitcnt lgkmcnt(4)
  v_smfmac_f32_16x16x64_bf16 v[92:95], v[48:51], v[64:71], v7
  ds_read_b128 v[56:59], v3 offset:16384
  s_waitcnt lgkmcnt(3)
  v_smfmac_f32_16x16x64_bf16 v[96:99], v[48:51], v[72:79], v7
  ds_read_b128 v[60:63], v3 offset:20480
  v_smfmac_f32_16x16x64_bf16 v[100:103], v[48:51], a[144:151], v7
  ds_read_b128 v[64:67], v2 offset:40960
  buffer_load_dwordx4 v1, s[8:11], s63 offen offset:3072 sc1 lds
  s_waitcnt vmcnt(10)
  v_smfmac_f32_16x16x64_bf16 v[88:91], v[52:55], v[232:239], v7
  ds_read_b128 v[68:71], v2 offset:45056
  v_smfmac_f32_16x16x64_bf16 v[92:95], v[52:55], v[240:247], v7
  ds_read_b128 v[72:75], v3 offset:24576
  v_smfmac_f32_16x16x64_bf16 v[96:99], v[52:55], v[248:255], v7
  ds_read_b128 v[76:79], v3 offset:28672
  v_smfmac_f32_16x16x64_bf16 v[100:103], v[52:55], a[168:175], v7
  v_smfmac_f32_16x16x64_bf16 v[104:107], v[16:19], a[8:15], v7
  v_add_f32 v88, v88, v90
  v_smfmac_f32_16x16x64_bf16 v[104:107], v[20:23], a[32:39], v7
  v_add_f32 v89, v89, v91
  v_smfmac_f32_16x16x64_bf16 v[104:107], v[24:27], a[56:63], v7
  v_cmp_u_f32 vcc, v88, v89
  v_smfmac_f32_16x16x64_bf16 v[104:107], v[28:31], a[80:87], v7
  v_cvt_pk_bf16_f32 v136, v88, v89
  v_smfmac_f32_16x16x64_bf16 v[104:107], v[36:39], a[104:111], v7
  s_and_b64 vcc, vcc, s[16:17]
  s_cbranch_scc1 sch_redo_26
  v_add_f32 v92, v92, v94
  v_smfmac_f32_16x16x64_bf16 v[104:107], v[40:43], a[128:135], v7
  ds_write_b32 v4, v136 offset:0
  v_add_f32 v93, v93, v95
  v_smfmac_f32_16x16x64_bf16 v[104:107], v[48:51], a[152:159], v7
  s_waitcnt lgkmcnt(1)
  v_cvt_pk_bf16_f32 v137, v92, v93
  v_smfmac_f32_16x16x64_bf16 v[104:107], v[52:55], a[176:183], v7
  ds_write_b32 v4, v137 offset:1024
  v_add_f32 v96, v96, v98
  v_smfmac_f32_16x16x64_bf16 v[104:107], v[32:35], v[80:87], v7
  v_add_f32 v97, v97, v99
  v_smfmac_f32_16x16x64_bf16 v[104:107], v[44:47], v[56:63], v7
  v_cvt_pk_bf16_f32 v138, v96, v97
  v_smfmac_f32_16x16x64_bf16 v[108:111], v[32:35], v[64:71], v7
  ds_write_b32 v4, v138 offset:2048
  v_add_f32 v100, v100, v102
  v_smfmac_f32_16x16x64_bf16 v[108:111], v[44:47], v[72:79], v7
  v_add_f32 v101, v101, v103
  v_smfmac_f32_16x16x64_bf16 v[108:111], v[16:19], a[16:23], v7
  v_cvt_pk_bf16_f32 v139, v100, v101
  v_smfmac_f32_16x16x64_bf16 v[108:111], v[20:23], a[40:47], v7
  ds_write_b32 v4, v139 offset:3072
  v_add_f32 v104, v104, v106
  v_smfmac_f32_16x16x64_bf16 v[108:111], v[24:27], a[64:71], v7
  s_waitcnt lgkmcnt(1)
  s_barrier
  v_add_f32 v105, v105, v107
  v_smfmac_f32_16x16x64_bf16 v[108:111], v[28:31], a[88:95], v7
  v_cvt_pk_bf16_f32 v140, v104, v105
  v_smfmac_f32_16x16x64_bf16 v[108:111], v[36:39], a[112:119], v7
  ds_write_b32 v4, v140 offset:4096
  v_smfmac_f32_16x16x64_bf16 v[108:111], v[40:43], a[136:143], v7
  v_smfmac_f32_16x16x64_bf16 v[108:111], v[48:51], a[160:167], v7
  v_smfmac_f32_16x16x64_bf16 v[108:111], v[52:55], a[184:191], v7
  s_nop 7
  v_add_f32 v108, v108, v110
  v_add_f32 v109, v109, v111
  v_cvt_pk_bf16_f32 v141, v108, v109
  ds_write_b32 v4, v141 offset:5120
  s_waitcnt lgkmcnt(0)
  s_barrier
  s_barrier
  s_cmp_ge_u32 s42, 2
  s_cbranch_scc1 sc_nox
  ds_read_b128 v[56:59], v13 offset:0
  ds_read_b128 v[60:63], v13 offset:2048
  ds_read_b128 v[64:67], v13 offset:1024
  ds_read_b128 v[68:71], v13 offset:3072
  ds_read_b128 v[72:75], v13 offset:4096
  ds_read_b128 v[76:79], v13 offset:6144
  ds_read_b128 v[80:83], v13 offset:5120
  ds_read_b128 v[84:87], v13 offset:7168
  s_waitcnt vmcnt(0)
  s_waitcnt lgkmcnt(7)
  v_mfma_f32_16x16x32_bf16 v[88:91], v[56:59], v[112:115], 0
  ds_read_b128 v[56:59], v13 offset:8192
  s_waitcnt lgkmcnt(7)
  v_mfma_f32_16x16x32_bf16 v[92:95], v[60:63], v[112:115], 0
  ds_read_b128 v[60:63], v13 offset:10240
  s_waitcnt lgkmcnt(7)
  v_mfma_f32_16x16x32_bf16 v[88:91], v[64:67], v[116:119], v[88:91]
  ds_read_b128 v[64:67], v13 offset:9216
  s_waitcnt lgkmcnt(7)
  v_mfma_f32_16x16x32_bf16 v[92:95], v[68:71], v[116:119], v[92:95]
  ds_read_b128 v[68:71], v13 offset:11264
  s_waitcnt lgkmcnt(7)
  v_mfma_f32_16x16x32_bf16 v[88:91], v[72:75], v[120:123], v[88:91]
  ds_read_b64_tr_b16 v[16:17], v5 offset:3072
  ds_read_b64_tr_b16 v[18:19], v5 offset:3136
  s_waitcnt lgkmcnt(8)
  v_mfma_f32_16x16x32_bf16 v[92:95], v[76:79], v[120:123], v[92:95]
  ds_read_b64_tr_b16 v[20:21], v5 offset:3584
  ds_read_b64_tr_b16 v[22:23], v5 offset:3648
  s_waitcnt lgkmcnt(9)
  v_mfma_f32_16x16x32_bf16 v[88:91], v[80:83], v[124:127], v[88:91]
  ds_read_b64_tr_b16 v[24:25], v5 offset:4096
  ds_read_b64_tr_b16 v[26:27], v5 offset:4160
  s_waitcnt lgkmcnt(10)
  v_mfma_f32_16x16x32_bf16 v[92:95], v[84:87], v[124:127], v[92:95]
  ds_read_b64_tr_b16 v[28:29], v5 offset:4608
  ds_read_b64_tr_b16 v[30:31], v5 offset:4672
  s_waitcnt lgkmcnt(11)
  v_mfma_f32_16x16x32_bf16 v[88:91], v[56:59], v[128:131], v[88:91]
  ds_read_b64_tr_b16 v[32:33], v5 offset:5120
  ds_read_b64_tr_b16 v[34:35], v5 offset:5184
  s_waitcnt lgkmcnt(12)
  v_mfma_f32_16x16x32_bf16 v[92:95], v[60:63], v[128:131], v[92:95]
  ds_read_b64_tr_b16 v[36:37], v5 offset:5632
  ds_read_b64_tr_b16 v[38:39], v5 offset:5696
  s_waitcnt lgkmcnt(13)
  v_mfma_f32_16x16x32_bf16 v[88:91], v[64:67], v[132:135], v[88:91]
  s_waitcnt lgkmcnt(12)
  v_mfma_f32_16x16x32_bf16 v[92:95], v[68:71], v[132:135], v[92:95]
  s_waitcnt lgkmcnt(10)
  v_mfma_f32_16x16x32_bf16 v[96:99], v[16:19], v[112:115], 0
  s_waitcnt lgkmcnt(8)
  v_mfma_f32_16x16x32_bf16 v[96:99], v[20:23], v[116:119], v[96:99]
  s_waitcnt lgkmcnt(6)
  v_mfma_f32_16x16x32_bf16 v[96:99], v[24:27], v[120:123], v[96:99]
  s_waitcnt lgkmcnt(4)
  v_mfma_f32_16x16x32_bf16 v[96:99], v[28:31], v[124:127], v[96:99]
  s_waitcnt lgkmcnt(2)
  v_mfma_f32_16x16x32_bf16 v[96:99], v[32:35], v[128:131], v[96:99]
  s_waitcnt lgkmcnt(0)
  v_mfma_f32_16x16x32_bf16 v[96:99], v[36:39], v[132:135], v[96:99]
  v_mov_b32 v143, s70
  v_cndmask_b32 v88, v88, v143, s[72:73]
  v_cndmask_b32 v89, v89, v143, s[74:75]
  v_cndmask_b32 v90, v90, v143, s[76:77]
  v_cndmask_b32 v91, v91, v143, s[78:79]
  v_cndmask_b32 v92, v92, v143, s[80:81]
  v_cndmask_b32 v93, v93, v143, s[82:83]
  v_cndmask_b32 v94, v94, v143, s[84:85]
  v_cndmask_b32 v95, v95, v143, s[86:87]
  s_mov_b32 vcc_lo, 0
  s_mov_b32 vcc_hi, -1
  v_cndmask_b32 v96, v96, v98, vcc
  v_cndmask_b32 v97, v97, v99, vcc
  v_max_f32 v142, v88, v89
  v_max3_f32 v142, v142, v90, v91
  v_max3_f32 v142, v142, v92, v93
  v_max3_f32 v142, v142, v94, v95
  v_max3_f32 v142, v142, v96, v97
  v_mov_b32 v143, v142
  s_nop 1
  v_permlane16_swap_b32 v143, v142
  v_max_f32 v142, v142, v143
  v_mov_b32 v143, v142
  s_nop 1
  v_permlane32_swap_b32 v143, v142
  v_max_f32 v142, v142, v143
  v_mul_f32 v142, s69, v142
  v_fma_f32 v88, v88, s69, -v142
  v_fma_f32 v89, v89, s69, -v142
  v_fma_f32 v90, v90, s69, -v142
  v_fma_f32 v91, v91, s69, -v142
  v_fma_f32 v92, v92, s69, -v142
  v_fma_f32 v93, v93, s69, -v142
  v_fma_f32 v94, v94, s69, -v142
  v_fma_f32 v95, v95, s69, -v142
  v_fma_f32 v96, v96, s69, -v142
  v_fma_f32 v97, v97, s69, -v142
  v_exp_f32 v88, v88
  v_exp_f32 v89, v89
  v_exp_f32 v90, v90
  v_exp_f32 v91, v91
  v_exp_f32 v92, v92
  v_exp_f32 v93, v93
  v_exp_f32 v94, v94
  v_exp_f32 v95, v95
  v_exp_f32 v96, v96
  v_exp_f32 v97, v97
  v_add_f32 v142, v88, v89
  v_add_f32 v142, v142, v90
  v_add_f32 v142, v142, v91
  v_add_f32 v142, v142, v92
  v_add_f32 v142, v142, v93
  v_add_f32 v142, v142, v94
  v_add_f32 v142, v142, v95
  v_add_f32 v142, v142, v96
  v_add_f32 v142, v142, v97
  v_mov_b32 v143, v142
  s_nop 1
  v_permlane16_swap_b32 v143, v142
  v_add_f32 v142, v142, v143
  v_mov_b32 v143, v142
  s_nop 1
  v_permlane32_swap_b32 v143, v142
  v_add_f32 v142, v142, v143
  v_rcp_f32 v142, v142
  s_nop 0
  v_mul_f32 v88, v88, v142
  v_mul_f32 v89, v89, v142
  v_mul_f32 v90, v90, v142
  v_mul_f32 v91, v91, v142
  v_mul_f32 v92, v92, v142
  v_mul_f32 v93, v93, v142
  v_mul_f32 v94, v94, v142
  v_mul_f32 v95, v95, v142
  v_mul_f32 v96, v96, v142
  v_mul_f32 v97, v97, v142
  v_cvt_pk_bf16_f32 v144, v88, v89
  v_cvt_pk_bf16_f32 v145, v90, v91
  v_cvt_pk_bf16_f32 v146, v92, v93
  v_cvt_pk_bf16_f32 v147, v94, v95
  v_cvt_pk_bf16_f32 v148, v96, v97
  s_mov_b32 s47, s64
  s_lshr_b32 s46, s47, 8
  s_and_b32 s46, s46, 0x2000
  s_xor_b32 s47, s47, s46
  s_add_u32 s46, s47, s27
  buffer_store_dwordx4 v[144:147], v1, s[8:11], s46 offen sc1
  buffer_store_dword v148, v14, s[8:11], s47 offen sc1
  s_add_u32 s64, s64, 262144
  s_cmp_ge_u32 s64, 16777216
  s_cselect_b32 s46, 2097152, 0
  s_sub_u32 s64, s64, s46
  s_branch sc_join
sc_nox:
  s_waitcnt vmcnt(0)
sc_join:
  v_add_u32 v13, s22, v13
  s_sub_u32 s22, 0, s22
  s_add_u32 s58, s58, 1
  s_cmp_eq_u32 s58, 3
  s_cselect_b32 s58, 0, s58
  s_mov_b32 s52, s53
  s_cmp_lt_u32 s52, 64
  s_cbranch_scc1 sch_loop
  s_waitcnt vmcnt(0)
  s_cmp_ge_u32 s42, 2
  s_cbranch_scc1 L_end
  v_mov_b32 v136, s52
  s_mov_b64 exec, 1
  buffer_store_dword v136, v15, s[8:11], 0 offen sc1
  s_mov_b64 exec, -1
  s_endpgm
scs_redo_20:
  s_mov_b32 s50, 0
scs_poll_27:
  buffer_load_dwordx4 v[16:19], v12, s[8:11], 0 offen offset:0 sc1
  buffer_load_dwordx4 v[20:23], v12, s[8:11], 0 offen offset:1024 sc1
  buffer_load_dwordx4 v[24:27], v12, s[8:11], 0 offen offset:2048 sc1
  buffer_load_dwordx4 v[28:31], v12, s[8:11], 0 offen offset:3072 sc1
  buffer_load_dwordx4 v[32:35], v12, s[8:11], s24 offen offset:0 sc1
  buffer_load_dwordx4 v[36:39], v12, s[8:11], s24 offen offset:1024 sc1
  buffer_load_dwordx4 v[40:43], v12, s[8:11], s24 offen offset:2048 sc1
  buffer_load_dwordx4 v[44:47], v12, s[8:11], s24 offen offset:3072 sc1
  buffer_load_dwordx4 v[48:51], v12, s[8:11], s25 offen offset:0 sc1
  buffer_load_dwordx4 v[52:55], v12, s[8:11], s25 offen offset:1024 sc1
  s_add_u32 s71, s71, 1
  s_cmp_le_u32 s71, 2
  s_cbranch_scc1 scs_again_28
  s_add_u32 s50, s50, 1
  s_cmp_gt_u32 s50, 131072
  s_cbranch_scc1 L_fail
  s_waitcnt vmcnt(0)
  v_max_u32 v149, v16, v17
  v_max3_u32 v149, v18, v19, v149
  v_max3_u32 v149, v20, v21, v149
  v_max3_u32 v149, v22, v23, v149
  v_max3_u32 v149, v24, v25, v149
  v_max3_u32 v149, v26, v27, v149
  v_max3_u32 v149, v28, v29, v149
  v_max3_u32 v149, v30, v31, v149
  v_max3_u32 v149, v32, v33, v149
  v_max3_u32 v149, v34, v35, v149
  v_max3_u32 v149, v36, v37, v149
  v_max3_u32 v149, v38, v39, v149
  v_max3_u32 v149, v40, v41, v149
  v_max3_u32 v149, v42, v43, v149
  v_max3_u32 v149, v44, v45, v149
  v_max3_u32 v149, v46, v47, v149
  v_max3_u32 v149, v48, v49, v149
  v_max3_u32 v149, v50, v51, v149
  v_max3_u32 v149, v52, v53, v149
  v_max3_u32 v149, v54, v55, v149
  v_cmp_eq_u32 vcc, -1, v149
  s_cbranch_vccnz scs_poll_27
  s_mov_b64 s[16:17], 0
scs_again_28:
  s_waitcnt lgkmcnt(0)
  ds_read_b128 v[56:59], v2 offset:0
  ds_read_b128 v[60:63], v2 offset:4096
  ds_read_b128 v[64:67], v2 offset:8192
  ds_read_b128 v[68:71], v2 offset:12288
  ds_read_b128 v[72:75], v2 offset:16384
  ds_read_b128 v[76:79], v2 offset:20480
  ds_read_b128 v[80:83], v2 offset:24576
  ds_read_b128 v[84:87], v2 offset:28672
  v_mov_b32 v88, 0
  v_mov_b32 v89, 0
  v_mov_b32 v90, 0
  v_mov_b32 v91, 0
  v_mov_b32 v92, 0
  v_mov_b32 v93, 0
  v_mov_b32 v94, 0
  v_mov_b32 v95, 0
  v_mov_b32 v96, 0
  v_mov_b32 v97, 0
  v_mov_b32 v98, 0
  v_mov_b32 v99, 0
  v_mov_b32 v100, 0
  v_mov_b32 v101, 0
  v_mov_b32 v102, 0
  v_mov_b32 v103, 0
  v_mov_b32 v104, 0
  v_mov_b32 v105, 0
  v_mov_b32 v106, 0
  v_mov_b32 v107, 0
  v_mov_b32 v108, 0
  v_mov_b32 v109, 0
  v_mov_b32 v110, 0
  v_mov_b32 v111, 0
  s_waitcnt lgkmcnt(0)
  s_branch scs_go_19
sch_redo_26:
  s_mov_b32 s50, 0
sch_poll_29:
  buffer_load_dwordx4 v[16:19], v12, s[8:11], 0 offen offset:0 sc1
  buffer_load_dwordx4 v[20:23], v12, s[8:11], 0 offen offset:1024 sc1
  buffer_load_dwordx4 v[24:27], v12, s[8:11], 0 offen offset:2048 sc1
  buffer_load_dwordx4 v[28:31], v12, s[8:11], 0 offen offset:3072 sc1
  buffer_load_dwordx4 v[32:35], v12, s[8:11], s24 offen offset:0 sc1
  buffer_load_dwordx4 v[36:39], v12, s[8:11], s24 offen offset:1024 sc1
  buffer_load_dwordx4 v[40:43], v12, s[8:11], s24 offen offset:2048 sc1
  buffer_load_dwordx4 v[44:47], v12, s[8:11], s24 offen offset:3072 sc1
  buffer_load_dwordx4 v[48:51], v12, s[8:11], s25 offen offset:0 sc1
  buffer_load_dwordx4 v[52:55], v12, s[8:11], s25 offen offset:1024 sc1
  s_add_u32 s71, s71, 1
  s_cmp_le_u32 s71, 2
  s_cbranch_scc1 sch_again_30
  s_add_u32 s50, s50, 1
  s_cmp_gt_u32 s50, 131072
  s_cbranch_scc1 L_fail
  s_waitcnt vmcnt(0)
  v_max_u32 v149, v16, v17
  v_max3_u32 v149, v18, v19, v149
  v_max3_u32 v149, v20, v21, v149
  v_max3_u32 v149, v22, v23, v149
  v_max3_u32 v149, v24, v25, v149
  v_max3_u32 v149, v26, v27, v149
  v_max3_u32 v149, v28, v29, v149
  v_max3_u32 v149, v30, v31, v149
  v_max3_u32 v149, v32, v33, v149
  v_max3_u32 v149, v34, v35, v149
  v_max3_u32 v149, v36, v37, v149
  v_max3_u32 v149, v38, v39, v149
  v_max3_u32 v149, v40, v41, v149
  v_max3_u32 v149, v42, v43, v149
  v_max3_u32 v149, v44, v45, v149
  v_max3_u32 v149, v46, v47, v149
  v_max3_u32 v149, v48, v49, v149
  v_max3_u32 v149, v50, v51, v149
  v_max3_u32 v149, v52, v53, v149
  v_max3_u32 v149, v54, v55, v149
  v_cmp_eq_u32 vcc, -1, v149
  s_cbranch_vccnz sch_poll_29
  s_mov_b64 s[16:17], 0
sch_again_30:
  s_waitcnt lgkmcnt(0)
  ds_read_b128 v[56:59], v2 offset:0
  ds_read_b128 v[60:63], v2 offset:4096
  ds_read_b128 v[64:67], v2 offset:8192
  ds_read_b128 v[68:71], v2 offset:12288
  ds_read_b128 v[72:75], v2 offset:16384
  ds_read_b128 v[76:79], v2 offset:20480
  ds_read_b128 v[80:83], v2 offset:24576
  ds_read_b128 v[84:87], v2 offset:28672
  v_mov_b32 v88, 0
  v_mov_b32 v89, 0
  v_mov_b32 v90, 0
  v_mov_b32 v91, 0
  v_mov_b32 v92, 0
  v_mov_b32 v93, 0
  v_mov_b32 v94, 0
  v_mov_b32 v95, 0
  v_mov_b32 v96, 0
  v_mov_b32 v97, 0
  v_mov_b32 v98, 0
  v_mov_b32 v99, 0
  v_mov_b32 v100, 0
  v_mov_b32 v101, 0
  v_mov_b32 v102, 0
  v_mov_b32 v103, 0
  v_mov_b32 v104, 0
  v_mov_b32 v105, 0
  v_mov_b32 v106, 0
  v_mov_b32 v107, 0
  v_mov_b32 v108, 0
  v_mov_b32 v109, 0
  v_mov_b32 v110, 0
  v_mov_b32 v111, 0
  s_waitcnt lgkmcnt(0)
  s_branch sch_go_25
L_value:
  s_mov_b32 s4, s30
  s_mov_b32 s5, s31
  s_mov_b32 s6, 7864320
  s_mov_b32 s7, 0x20000
  s_mov_b32 s12, s32
  s_mov_b32 s13, s33
  s_mov_b32 s14, 7864320
  s_mov_b32 s15, 0x20000
  v_lshrrev_b32 v140, 3, v0
  v_lshrrev_b32 v141, 2, v140
  v_lshlrev_b32 v141, 3, v141
  v_and_b32 v64, 3, v140
  v_add_u32 v64, v64, v141
  s_and_b32 s46, s42, 1
  s_lshl_b32 s46, s46, 2
  s_lshr_b32 s47, s42, 1
  s_lshl_b32 s47, s47, 4
  s_add_u32 s46, s46, s47
  v_add_u32 v64, s46, v64
  v_mul_u32_u24 v64, 12288, v64
  v_lshrrev_b32 v140, 1, v140
  v_bfe_u32 v141, v0, 1, 2
  v_xor_b32 v140, v140, v141
  v_lshlrev_b32 v140, 5, v140
  v_and_b32 v141, 1, v0
  v_lshlrev_b32 v141, 4, v141
  v_add3_u32 v64, v64, v140, v141
  v_lshrrev_b32 v140, 3, v0
  v_lshrrev_b32 v141, 2, v140
  v_lshlrev_b32 v141, 3, v141
  v_and_b32 v65, 3, v140
  v_add_u32 v65, v65, v141
  s_and_b32 s46, s42, 1
  s_lshl_b32 s46, s46, 2
  s_lshr_b32 s47, s42, 1
  s_lshl_b32 s47, s47, 4
  s_add_u32 s46, s46, s47
  v_add_u32 v65, s46, v65
  v_mul_u32_u24 v65, 1280, v65
  v_lshrrev_b32 v140, 1, v140
  v_bfe_u32 v141, v0, 1, 2
  v_xor_b32 v140, v140, v141
  v_lshlrev_b32 v140, 5, v140
  v_and_b32 v141, 1, v0
  v_lshlrev_b32 v141, 4, v141
  v_add3_u32 v65, v65, v140, v141
  v_lshrrev_b32 v140, 5, v0
  v_lshlrev_b32 v66, 11, v140
  v_bfe_u32 v140, v0, 2, 3
  v_lshl_add_u32 v66, v140, 7, v66
  v_lshrrev_b32 v140, 1, v140
  v_xor_b32 v140, s42, v140
  v_lshl_add_u32 v66, v140, 5, v66
  v_and_b32 v140, 3, v0
  v_lshl_add_u32 v66, v140, 3, v66
  v_add_u32 v67, 0x10000, v66
  v_add_u32 v68, 0x20000, v66
  v_lshlrev_b32 v1, 4, v0
  v_add_u32 v2, s51, v1
  v_add_u32 v3, 0x10000, v2
  s_mul_i32 s62, s45, 384
  s_mul_i32 s63, s45, 245760
  s_mov_b32 s24, 4096
  s_mov_b32 s25, 49152
  s_add_u32 m0, s51, 73728
  s_add_u32 s46, s62, 0
  buffer_load_dwordx4 v64, s[4:7], s46 offen lds
  s_add_u32 m0, s51, 77824
  s_add_u32 s46, s62, 393216
  buffer_load_dwordx4 v64, s[4:7], s46 offen lds
  s_add_u32 m0, s51, 81920
  s_add_u32 s46, s62, 128
  buffer_load_dwordx4 v64, s[4:7], s46 offen lds
  s_add_u32 m0, s51, 86016
  s_add_u32 s46, s62, 393344
  buffer_load_dwordx4 v64, s[4:7], s46 offen lds
  s_add_u32 m0, s51, 90112
  s_add_u32 s46, s62, 256
  buffer_load_dwordx4 v64, s[4:7], s46 offen lds
  s_add_u32 m0, s51, 94208
  s_add_u32 s46, s62, 393472
  buffer_load_dwordx4 v64, s[4:7], s46 offen lds
  s_add_u32 m0, s51, 98304
  s_add_u32 s46, s62, 1572864
  buffer_load_dwordx4 v64, s[4:7], s46 offen lds
  s_add_u32 m0, s51, 102400
  s_add_u32 s46, s62, 1966080
  buffer_load_dwordx4 v64, s[4:7], s46 offen lds
  s_add_u32 m0, s51, 106496
  s_add_u32 s46, s62, 1572992
  buffer_load_dwordx4 v64, s[4:7], s46 offen lds
  s_add_u32 m0, s51, 110592
  s_add_u32 s46, s62, 1966208
  buffer_load_dwordx4 v64, s[4:7], s46 offen lds
  s_add_u32 m0, s51, 114688
  s_add_u32 s46, s62, 1573120
  buffer_load_dwordx4 v64, s[4:7], s46 offen lds
  s_add_u32 m0, s51, 118784
  s_add_u32 s46, s62, 1966336
  buffer_load_dwordx4 v64, s[4:7], s46 offen lds
  s_add_u32 m0, s51, 122880
  s_add_u32 s46, s62, 3145728
  buffer_load_dwordx4 v64, s[4:7], s46 offen lds
  s_add_u32 m0, s51, 126976
  s_add_u32 s46, s62, 3538944
  buffer_load_dwordx4 v64, s[4:7], s46 offen lds
  s_add_u32 m0, s51, 131072
  s_add_u32 s46, s62, 3145856
  buffer_load_dwordx4 v64, s[4:7], s46 offen lds
  s_add_u32 m0, s51, 135168
  s_add_u32 s46, s62, 3539072
  buffer_load_dwordx4 v64, s[4:7], s46 offen lds
  s_add_u32 m0, s51, 139264
  s_add_u32 s46, s62, 3145984
  buffer_load_dwordx4 v64, s[4:7], s46 offen lds
  s_add_u32 m0, s51, 143360
  s_add_u32 s46, s62, 3539200
  buffer_load_dwordx4 v64, s[4:7], s46 offen lds
  s_add_u32 m0, s51, 0
  s_add_u32 s46, s62, 4718592
  buffer_load_dwordx4 v64, s[4:7], s46 offen lds
  s_add_u32 m0, s51, 4096
  s_add_u32 s46, s62, 5111808
  buffer_load_dwordx4 v64, s[4:7], s46 offen lds
  s_add_u32 m0, s51, 8192
  s_add_u32 s46, s62, 4718720
  buffer_load_dwordx4 v64, s[4:7], s46 offen lds
  s_add_u32 m0, s51, 12288
  s_add_u32 s46, s62, 5111936
  buffer_load_dwordx4 v64, s[4:7], s46 offen lds
  s_add_u32 m0, s51, 16384
  s_add_u32 s46, s62, 4718848
  buffer_load_dwordx4 v64, s[4:7], s46 offen lds
  s_add_u32 m0, s51, 20480
  s_add_u32 s46, s62, 5112064
  buffer_load_dwordx4 v64, s[4:7], s46 offen lds
  s_add_u32 m0, s51, 24576
  s_add_u32 s46, s62, 6291456
  buffer_load_dwordx4 v64, s[4:7], s46 offen lds
  s_add_u32 m0, s51, 28672
  s_add_u32 s46, s62, 6684672
  buffer_load_dwordx4 v64, s[4:7], s46 offen lds
  s_add_u32 m0, s51, 32768
  s_add_u32 s46, s62, 6291584
  buffer_load_dwordx4 v64, s[4:7], s46 offen lds
  s_add_u32 m0, s51, 36864
  s_add_u32 s46, s62, 6684800
  buffer_load_dwordx4 v64, s[4:7], s46 offen lds
  s_add_u32 m0, s51, 40960
  s_add_u32 s46, s62, 6291712
  buffer_load_dwordx4 v64, s[4:7], s46 offen lds
  s_add_u32 m0, s51, 45056
  s_add_u32 s46, s62, 6684928
  buffer_load_dwordx4 v64, s[4:7], s46 offen lds
  s_waitcnt vmcnt(24)
  s_barrier
  s_add_u32 m0, s51, 49152
  s_add_u32 s46, s63, 0
  buffer_load_dwordx4 v65, s[12:15], s46 offen lds
  s_add_u32 m0, s51, 53248
  s_add_u32 s46, s63, 128
  buffer_load_dwordx4 v65, s[12:15], s46 offen lds
  s_add_u32 m0, s51, 57344
  s_add_u32 s46, s63, 256
  buffer_load_dwordx4 v65, s[12:15], s46 offen lds
  s_add_u32 m0, s51, 61440
  s_add_u32 s46, s63, 384
  buffer_load_dwordx4 v65, s[12:15], s46 offen lds
  s_add_u32 m0, s51, 65536
  s_add_u32 s46, s63, 512
  buffer_load_dwordx4 v65, s[12:15], s46 offen lds
  s_add_u32 m0, s51, 69632
  s_add_u32 s46, s63, 640
  buffer_load_dwordx4 v65, s[12:15], s46 offen lds
  ds_read_b64_tr_b16 a[240:241], v67 offset:8192
  ds_read_b64_tr_b16 a[242:243], v67 offset:9216
  ds_read_b64_tr_b16 a[244:245], v67 offset:12288
  ds_read_b64_tr_b16 a[246:247], v67 offset:13312
  ds_read_b64_tr_b16 a[248:249], v67 offset:16384
  ds_read_b64_tr_b16 a[250:251], v67 offset:17408
  ds_read_b64_tr_b16 a[252:253], v67 offset:20480
  ds_read_b64_tr_b16 a[254:255], v67 offset:21504
  ds_read_b64_tr_b16 v[152:153], v67 offset:24576
  ds_read_b64_tr_b16 v[154:155], v67 offset:25600
  ds_read_b64_tr_b16 v[156:157], v67 offset:28672
  ds_read_b64_tr_b16 v[158:159], v67 offset:29696
  s_waitcnt lgkmcnt(0)
  s_waitcnt vmcnt(24)
  s_barrier
  s_add_u32 m0, s51, 73728
  s_add_u32 s46, s63, 768
  buffer_load_dwordx4 v65, s[12:15], s46 offen lds
  s_add_u32 m0, s51, 77824
  s_add_u32 s46, s63, 896
  buffer_load_dwordx4 v65, s[12:15], s46 offen lds
  s_add_u32 m0, s51, 81920
  s_add_u32 s46, s63, 1024
  buffer_load_dwordx4 v65, s[12:15], s46 offen lds
  s_add_u32 m0, s51, 86016
  s_add_u32 s46, s63, 1152
  buffer_load_dwordx4 v65, s[12:15], s46 offen lds
  s_add_u32 m0, s51, 90112
  s_add_u32 s46, s63, 40960
  buffer_load_dwordx4 v65, s[12:15], s46 offen lds
  s_add_u32 m0, s51, 94208
  s_add_u32 s46, s63, 41088
  buffer_load_dwordx4 v65, s[12:15], s46 offen lds
  ds_read_b64_tr_b16 v[160:161], v67 offset:32768
  ds_read_b64_tr_b16 v[162:163], v67 offset:33792
  ds_read_b64_tr_b16 v[164:165], v67 offset:36864
  ds_read_b64_tr_b16 v[166:167], v67 offset:37888
  ds_read_b64_tr_b16 v[168:169], v67 offset:40960
  ds_read_b64_tr_b16 v[170:171], v67 offset:41984
  ds_read_b64_tr_b16 v[172:173], v67 offset:45056
  ds_read_b64_tr_b16 v[174:175], v67 offset:46080
  ds_read_b64_tr_b16 v[176:177], v67 offset:49152
  ds_read_b64_tr_b16 v[178:179], v67 offset:50176
  ds_read_b64_tr_b16 v[180:181], v67 offset:53248
  ds_read_b64_tr_b16 v[182:183], v67 offset:54272
  s_waitcnt lgkmcnt(0)
  s_waitcnt vmcnt(24)
  s_barrier
  s_add_u32 m0, s51, 98304
  s_add_u32 s46, s63, 41216
  buffer_load_dwordx4 v65, s[12:15], s46 offen lds
  s_add_u32 m0, s51, 102400
  s_add_u32 s46, s63, 41344
  buffer_load_dwordx4 v65, s[12:15], s46 offen lds
  s_add_u32 m0, s51, 106496
  s_add_u32 s46, s63, 41472
  buffer_load_dwordx4 v65, s[12:15], s46 offen lds
  s_add_u32 m0, s51, 110592
  s_add_u32 s46, s63, 41600
  buffer_load_dwordx4 v65, s[12:15], s46 offen lds
  s_add_u32 m0, s51, 114688
  s_add_u32 s46, s63, 41728
  buffer_load_dwordx4 v65, s[12:15], s46 offen lds
  s_add_u32 m0, s51, 118784
  s_add_u32 s46, s63, 41856
  buffer_load_dwordx4 v65, s[12:15], s46 offen lds
  ds_read_b64_tr_b16 v[184:185], v67 offset:57344
  ds_read_b64_tr_b16 v[186:187], v67 offset:58368
  ds_read_b64_tr_b16 v[188:189], v67 offset:61440
  ds_read_b64_tr_b16 v[190:191], v67 offset:62464
  ds_read_b64_tr_b16 v[192:193], v68 offset:0
  ds_read_b64_tr_b16 v[194:195], v68 offset:1024
  ds_read_b64_tr_b16 v[196:197], v68 offset:4096
  ds_read_b64_tr_b16 v[198:199], v68 offset:5120
  ds_read_b64_tr_b16 v[200:201], v68 offset:8192
  ds_read_b64_tr_b16 v[202:203], v68 offset:9216
  ds_read_b64_tr_b16 v[204:205], v68 offset:12288
  ds_read_b64_tr_b16 v[206:207], v68 offset:13312
  s_waitcnt lgkmcnt(0)
  s_waitcnt vmcnt(24)
  s_barrier
  s_add_u32 m0, s51, 122880
  s_add_u32 s46, s63, 41984
  buffer_load_dwordx4 v65, s[12:15], s46 offen lds
  s_add_u32 m0, s51, 126976
  s_add_u32 s46, s63, 42112
  buffer_load_dwordx4 v65, s[12:15], s46 offen lds
  s_add_u32 m0, s51, 131072
  s_add_u32 s46, s63, 81920
  buffer_load_dwordx4 v65, s[12:15], s46 offen lds
  s_add_u32 m0, s51, 135168
  s_add_u32 s46, s63, 82048
  buffer_load_dwordx4 v65, s[12:15], s46 offen lds
  s_add_u32 m0, s51, 139264
  s_add_u32 s46, s63, 82176
  buffer_load_dwordx4 v65, s[12:15], s46 offen lds
  s_add_u32 m0, s51, 143360
  s_add_u32 s46, s63, 82304
  buffer_load_dwordx4 v65, s[12:15], s46 offen lds
  ds_read_b64_tr_b16 v[208:209], v66 offset:0
  ds_read_b64_tr_b16 v[210:211], v66 offset:1024
  ds_read_b64_tr_b16 v[212:213], v66 offset:4096
  ds_read_b64_tr_b16 v[214:215], v66 offset:5120
  ds_read_b64_tr_b16 v[216:217], v66 offset:8192
  ds_read_b64_tr_b16 v[218:219], v66 offset:9216
  ds_read_b64_tr_b16 v[220:221], v66 offset:12288
  ds_read_b64_tr_b16 v[222:223], v66 offset:13312
  ds_read_b64_tr_b16 v[224:225], v66 offset:16384
  ds_read_b64_tr_b16 v[226:227], v66 offset:17408
  ds_read_b64_tr_b16 v[228:229], v66 offset:20480
  ds_read_b64_tr_b16 v[230:231], v66 offset:21504
  s_waitcnt lgkmcnt(0)
  s_waitcnt vmcnt(24)
  s_barrier
  s_add_u32 m0, s51, 0
  s_add_u32 s46, s63, 82432
  buffer_load_dwordx4 v65, s[12:15], s46 offen lds
  s_add_u32 m0, s51, 4096
  s_add_u32 s46, s63, 82560
  buffer_load_dwordx4 v65, s[12:15], s46 offen lds
  s_add_u32 m0, s51, 8192
  s_add_u32 s46, s63, 82688
  buffer_load_dwordx4 v65, s[12:15], s46 offen lds
  s_add_u32 m0, s51, 12288
  s_add_u32 s46, s63, 82816
  buffer_load_dwordx4 v65, s[12:15], s46 offen lds
  s_add_u32 m0, s51, 16384
  s_add_u32 s46, s63, 82944
  buffer_load_dwordx4 v65, s[12:15], s46 offen lds
  s_add_u32 m0, s51, 20480
  s_add_u32 s46, s63, 83072
  buffer_load_dwordx4 v65, s[12:15], s46 offen lds
  ds_read_b64_tr_b16 v[232:233], v66 offset:24576
  ds_read_b64_tr_b16 v[234:235], v66 offset:25600
  ds_read_b64_tr_b16 v[236:237], v66 offset:28672
  ds_read_b64_tr_b16 v[238:239], v66 offset:29696
  ds_read_b64_tr_b16 v[240:241], v66 offset:32768
  ds_read_b64_tr_b16 v[242:243], v66 offset:33792
  ds_read_b64_tr_b16 v[244:245], v66 offset:36864
  ds_read_b64_tr_b16 v[246:247], v66 offset:37888
  ds_read_b64_tr_b16 v[248:249], v66 offset:40960
  ds_read_b64_tr_b16 v[250:251], v66 offset:41984
  ds_read_b64_tr_b16 v[252:253], v66 offset:45056
  ds_read_b64_tr_b16 v[254:255], v66 offset:46080
  s_waitcnt lgkmcnt(0)
  s_waitcnt vmcnt(24)
  s_barrier
  s_add_u32 m0, s51, 24576
  s_add_u32 s46, s63, 122880
  buffer_load_dwordx4 v65, s[12:15], s46 offen lds
  s_add_u32 m0, s51, 28672
  s_add_u32 s46, s63, 123008
  buffer_load_dwordx4 v65, s[12:15], s46 offen lds
  s_add_u32 m0, s51, 32768
  s_add_u32 s46, s63, 123136
  buffer_load_dwordx4 v65, s[12:15], s46 offen lds
  s_add_u32 m0, s51, 36864
  s_add_u32 s46, s63, 123264
  buffer_load_dwordx4 v65, s[12:15], s46 offen lds
  s_add_u32 m0, s51, 40960
  s_add_u32 s46, s63, 123392
  buffer_load_dwordx4 v65, s[12:15], s46 offen lds
  s_add_u32 m0, s51, 45056
  s_add_u32 s46, s63, 123520
  buffer_load_dwordx4 v65, s[12:15], s46 offen lds
  ds_read_b64_tr_b16 a[0:1], v66 offset:49152
  ds_read_b64_tr_b16 a[2:3], v66 offset:50176
  ds_read_b64_tr_b16 a[24:25], v66 offset:53248
  ds_read_b64_tr_b16 a[26:27], v66 offset:54272
  ds_read_b64_tr_b16 a[48:49], v66 offset:57344
  ds_read_b64_tr_b16 a[50:51], v66 offset:58368
  ds_read_b64_tr_b16 a[72:73], v66 offset:61440
  ds_read_b64_tr_b16 a[74:75], v66 offset:62464
  ds_read_b64_tr_b16 a[96:97], v67 offset:0
  ds_read_b64_tr_b16 a[98:99], v67 offset:1024
  ds_read_b64_tr_b16 a[120:121], v67 offset:4096
  ds_read_b64_tr_b16 a[122:123], v67 offset:5120
  s_waitcnt lgkmcnt(0)
  s_waitcnt vmcnt(24)
  s_barrier
  s_add_u32 m0, s51, 49152
  s_add_u32 s46, s63, 123648
  buffer_load_dwordx4 v65, s[12:15], s46 offen lds
  s_add_u32 m0, s51, 53248
  s_add_u32 s46, s63, 123776
  buffer_load_dwordx4 v65, s[12:15], s46 offen lds
  s_add_u32 m0, s51, 57344
  s_add_u32 s46, s63, 123904
  buffer_load_dwordx4 v65, s[12:15], s46 offen lds
  s_add_u32 m0, s51, 61440
  s_add_u32 s46, s63, 124032
  buffer_load_dwordx4 v65, s[12:15], s46 offen lds
  s_add_u32 m0, s51, 65536
  s_add_u32 s46, s63, 163840
  buffer_load_dwordx4 v65, s[12:15], s46 offen lds
  s_add_u32 m0, s51, 69632
  s_add_u32 s46, s63, 163968
  buffer_load_dwordx4 v65, s[12:15], s46 offen lds
  ds_read_b64_tr_b16 a[144:145], v67 offset:8192
  ds_read_b64_tr_b16 a[146:147], v67 offset:9216
  ds_read_b64_tr_b16 a[168:169], v67 offset:12288
  ds_read_b64_tr_b16 a[170:171], v67 offset:13312
  ds_read_b64_tr_b16 a[192:193], v67 offset:16384
  ds_read_b64_tr_b16 a[194:195], v67 offset:17408
  ds_read_b64_tr_b16 a[216:217], v67 offset:20480
  ds_read_b64_tr_b16 a[218:219], v67 offset:21504
  ds_read_b64_tr_b16 a[4:5], v67 offset:24576
  ds_read_b64_tr_b16 a[6:7], v67 offset:25600
  ds_read_b64_tr_b16 a[28:29], v67 offset:28672
  ds_read_b64_tr_b16 a[30:31], v67 offset:29696
  s_waitcnt lgkmcnt(0)
  s_waitcnt vmcnt(24)
  s_barrier
  s_add_u32 m0, s51, 73728
  s_add_u32 s46, s63, 164096
  buffer_load_dwordx4 v65, s[12:15], s46 offen lds
  s_add_u32 m0, s51, 77824
  s_add_u32 s46, s63, 164224
  buffer_load_dwordx4 v65, s[12:15], s46 offen lds
  s_add_u32 m0, s51, 81920
  s_add_u32 s46, s63, 164352
  buffer_load_dwordx4 v65, s[12:15], s46 offen lds
  s_add_u32 m0, s51, 86016
  s_add_u32 s46, s63, 164480
  buffer_load_dwordx4 v65, s[12:15], s46 offen lds
  s_add_u32 m0, s51, 90112
  s_add_u32 s46, s63, 164608
  buffer_load_dwordx4 v65, s[12:15], s46 offen lds
  s_add_u32 m0, s51, 94208
  s_add_u32 s46, s63, 164736
  buffer_load_dwordx4 v65, s[12:15], s46 offen lds
  ds_read_b64_tr_b16 a[52:53], v67 offset:32768
  ds_read_b64_tr_b16 a[54:55], v67 offset:33792
  ds_read_b64_tr_b16 a[76:77], v67 offset:36864
  ds_read_b64_tr_b16 a[78:79], v67 offset:37888
  ds_read_b64_tr_b16 a[100:101], v67 offset:40960
  ds_read_b64_tr_b16 a[102:103], v67 offset:41984
  ds_read_b64_tr_b16 a[124:125], v67 offset:45056
  ds_read_b64_tr_b16 a[126:127], v67 offset:46080
  ds_read_b64_tr_b16 a[148:149], v67 offset:49152
  ds_read_b64_tr_b16 a[150:151], v67 offset:50176
  ds_read_b64_tr_b16 a[172:173], v67 offset:53248
  ds_read_b64_tr_b16 a[174:175], v67 offset:54272
  s_waitcnt lgkmcnt(0)
  s_waitcnt vmcnt(24)
  s_barrier
  s_add_u32 m0, s51, 98304
  s_add_u32 s46, s63, 164864
  buffer_load_dwordx4 v65, s[12:15], s46 offen lds
  s_add_u32 m0, s51, 102400
  s_add_u32 s46, s63, 164992
  buffer_load_dwordx4 v65, s[12:15], s46 offen lds
  s_add_u32 m0, s51, 106496
  s_add_u32 s46, s63, 204800
  buffer_load_dwordx4 v65, s[12:15], s46 offen lds
  s_add_u32 m0, s51, 110592
  s_add_u32 s46, s63, 204928
  buffer_load_dwordx4 v65, s[12:15], s46 offen lds
  s_add_u32 m0, s51, 114688
  s_add_u32 s46, s63, 205056
  buffer_load_dwordx4 v65, s[12:15], s46 offen lds
  s_add_u32 m0, s51, 118784
  s_add_u32 s46, s63, 205184
  buffer_load_dwordx4 v65, s[12:15], s46 offen lds
  ds_read_b64_tr_b16 a[196:197], v67 offset:57344
  ds_read_b64_tr_b16 a[198:199], v67 offset:58368
  ds_read_b64_tr_b16 a[220:221], v67 offset:61440
  ds_read_b64_tr_b16 a[222:223], v67 offset:62464
  ds_read_b64_tr_b16 a[8:9], v68 offset:0
  ds_read_b64_tr_b16 a[10:11], v68 offset:1024
  ds_read_b64_tr_b16 a[32:33], v68 offset:4096
  ds_read_b64_tr_b16 a[34:35], v68 offset:5120
  ds_read_b64_tr_b16 a[56:57], v68 offset:8192
  ds_read_b64_tr_b16 a[58:59], v68 offset:9216
  ds_read_b64_tr_b16 a[80:81], v68 offset:12288
  ds_read_b64_tr_b16 a[82:83], v68 offset:13312
  s_waitcnt lgkmcnt(0)
  s_waitcnt vmcnt(24)
  s_barrier
  s_add_u32 m0, s51, 122880
  s_add_u32 s46, s63, 205312
  buffer_load_dwordx4 v65, s[12:15], s46 offen lds
  s_add_u32 m0, s51, 126976
  s_add_u32 s46, s63, 205440
  buffer_load_dwordx4 v65, s[12:15], s46 offen lds
  s_add_u32 m0, s51, 131072
  s_add_u32 s46, s63, 205568
  buffer_load_dwordx4 v65, s[12:15], s46 offen lds
  s_add_u32 m0, s51, 135168
  s_add_u32 s46, s63, 205696
  buffer_load_dwordx4 v65, s[12:15], s46 offen lds
  s_add_u32 m0, s51, 139264
  s_add_u32 s46, s63, 205824
  buffer_load_dwordx4 v65, s[12:15], s46 offen lds
  s_add_u32 m0, s51, 143360
  s_add_u32 s46, s63, 205952
  buffer_load_dwordx4 v65, s[12:15], s46 offen lds
  ds_read_b64_tr_b16 a[104:105], v66 offset:0
  ds_read_b64_tr_b16 a[106:107], v66 offset:1024
  ds_read_b64_tr_b16 a[128:129], v66 offset:4096
  ds_read_b64_tr_b16 a[130:131], v66 offset:5120
  ds_read_b64_tr_b16 a[152:153], v66 offset:8192
  ds_read_b64_tr_b16 a[154:155], v66 offset:9216
  ds_read_b64_tr_b16 a[176:177], v66 offset:12288
  ds_read_b64_tr_b16 a[178:179], v66 offset:13312
  ds_read_b64_tr_b16 a[200:201], v66 offset:16384
  ds_read_b64_tr_b16 a[202:203], v66 offset:17408
  ds_read_b64_tr_b16 a[224:225], v66 offset:20480
  ds_read_b64_tr_b16 a[226:227], v66 offset:21504
  s_waitcnt lgkmcnt(0)
  s_waitcnt vmcnt(24)
  s_barrier
  s_add_u32 m0, s51, 0
  s_add_u32 s46, s62, 786432
  buffer_load_dwordx4 v64, s[4:7], s46 offen lds
  s_add_u32 m0, s51, 4096
  s_add_u32 s46, s62, 1179648
  buffer_load_dwordx4 v64, s[4:7], s46 offen lds
  s_add_u32 m0, s51, 8192
  s_add_u32 s46, s62, 786560
  buffer_load_dwordx4 v64, s[4:7], s46 offen lds
  s_add_u32 m0, s51, 12288
  s_add_u32 s46, s62, 1179776
  buffer_load_dwordx4 v64, s[4:7], s46 offen lds
  s_add_u32 m0, s51, 16384
  s_add_u32 s46, s62, 786688
  buffer_load_dwordx4 v64, s[4:7], s46 offen lds
  s_add_u32 m0, s51, 20480
  s_add_u32 s46, s62, 1179904
  buffer_load_dwordx4 v64, s[4:7], s46 offen lds
  ds_read_b64_tr_b16 a[12:13], v66 offset:24576
  ds_read_b64_tr_b16 a[14:15], v66 offset:25600
  ds_read_b64_tr_b16 a[36:37], v66 offset:28672
  ds_read_b64_tr_b16 a[38:39], v66 offset:29696
  ds_read_b64_tr_b16 a[60:61], v66 offset:32768
  ds_read_b64_tr_b16 a[62:63], v66 offset:33792
  ds_read_b64_tr_b16 a[84:85], v66 offset:36864
  ds_read_b64_tr_b16 a[86:87], v66 offset:37888
  ds_read_b64_tr_b16 a[108:109], v66 offset:40960
  ds_read_b64_tr_b16 a[110:111], v66 offset:41984
  ds_read_b64_tr_b16 a[132:133], v66 offset:45056
  ds_read_b64_tr_b16 a[134:135], v66 offset:46080
  s_waitcnt lgkmcnt(0)
  s_waitcnt vmcnt(24)
  s_barrier
  s_add_u32 m0, s51, 24576
  s_add_u32 s46, s62, 2359296
  buffer_load_dwordx4 v64, s[4:7], s46 offen lds
  s_add_u32 m0, s51, 28672
  s_add_u32 s46, s62, 2752512
  buffer_load_dwordx4 v64, s[4:7], s46 offen lds
  s_add_u32 m0, s51, 32768
  s_add_u32 s46, s62, 2359424
  buffer_load_dwordx4 v64, s[4:7], s46 offen lds
  s_add_u32 m0, s51, 36864
  s_add_u32 s46, s62, 2752640
  buffer_load_dwordx4 v64, s[4:7], s46 offen lds
  s_add_u32 m0, s51, 40960
  s_add_u32 s46, s62, 2359552
  buffer_load_dwordx4 v64, s[4:7], s46 offen lds
  s_add_u32 m0, s51, 45056
  s_add_u32 s46, s62, 2752768
  buffer_load_dwordx4 v64, s[4:7], s46 offen lds
  ds_read_b64_tr_b16 a[156:157], v66 offset:49152
  ds_read_b64_tr_b16 a[158:159], v66 offset:50176
  ds_read_b64_tr_b16 a[180:181], v66 offset:53248
  ds_read_b64_tr_b16 a[182:183], v66 offset:54272
  ds_read_b64_tr_b16 a[204:205], v66 offset:57344
  ds_read_b64_tr_b16 a[206:207], v66 offset:58368
  ds_read_b64_tr_b16 a[228:229], v66 offset:61440
  ds_read_b64_tr_b16 a[230:231], v66 offset:62464
  ds_read_b64_tr_b16 a[16:17], v67 offset:0
  ds_read_b64_tr_b16 a[18:19], v67 offset:1024
  ds_read_b64_tr_b16 a[40:41], v67 offset:4096
  ds_read_b64_tr_b16 a[42:43], v67 offset:5120
  s_waitcnt lgkmcnt(0)
  s_waitcnt vmcnt(24)
  s_barrier
  s_add_u32 m0, s51, 49152
  s_add_u32 s46, s62, 3932160
  buffer_load_dwordx4 v64, s[4:7], s46 offen lds
  s_add_u32 m0, s51, 53248
  s_add_u32 s46, s62, 4325376
  buffer_load_dwordx4 v64, s[4:7], s46 offen lds
  s_add_u32 m0, s51, 57344
  s_add_u32 s46, s62, 3932288
  buffer_load_dwordx4 v64, s[4:7], s46 offen lds
  s_add_u32 m0, s51, 61440
  s_add_u32 s46, s62, 4325504
  buffer_load_dwordx4 v64, s[4:7], s46 offen lds
  s_add_u32 m0, s51, 65536
  s_add_u32 s46, s62, 3932416
  buffer_load_dwordx4 v64, s[4:7], s46 offen lds
  s_add_u32 m0, s51, 69632
  s_add_u32 s46, s62, 4325632
  buffer_load_dwordx4 v64, s[4:7], s46 offen lds
  ds_read_b64_tr_b16 a[64:65], v67 offset:8192
  ds_read_b64_tr_b16 a[66:67], v67 offset:9216
  ds_read_b64_tr_b16 a[88:89], v67 offset:12288
  ds_read_b64_tr_b16 a[90:91], v67 offset:13312
  ds_read_b64_tr_b16 a[112:113], v67 offset:16384
  ds_read_b64_tr_b16 a[114:115], v67 offset:17408
  ds_read_b64_tr_b16 a[136:137], v67 offset:20480
  ds_read_b64_tr_b16 a[138:139], v67 offset:21504
  ds_read_b64_tr_b16 a[160:161], v67 offset:24576
  ds_read_b64_tr_b16 a[162:163], v67 offset:25600
  ds_read_b64_tr_b16 a[184:185], v67 offset:28672
  ds_read_b64_tr_b16 a[186:187], v67 offset:29696
  s_waitcnt lgkmcnt(0)
  s_waitcnt vmcnt(24)
  s_barrier
  s_add_u32 m0, s51, 73728
  s_add_u32 s46, s62, 5505024
  buffer_load_dwordx4 v64, s[4:7], s46 offen lds
  s_add_u32 m0, s51, 77824
  s_add_u32 s46, s62, 5898240
  buffer_load_dwordx4 v64, s[4:7], s46 offen lds
  s_add_u32 m0, s51, 81920
  s_add_u32 s46, s62, 5505152
  buffer_load_dwordx4 v64, s[4:7], s46 offen lds
  s_add_u32 m0, s51, 86016
  s_add_u32 s46, s62, 5898368
  buffer_load_dwordx4 v64, s[4:7], s46 offen lds
  s_add_u32 m0, s51, 90112
  s_add_u32 s46, s62, 5505280
  buffer_load_dwordx4 v64, s[4:7], s46 offen lds
  s_add_u32 m0, s51, 94208
  s_add_u32 s46, s62, 5898496
  buffer_load_dwordx4 v64, s[4:7], s46 offen lds
  ds_read_b64_tr_b16 a[208:209], v67 offset:32768
  ds_read_b64_tr_b16 a[210:211], v67 offset:33792
  ds_read_b64_tr_b16 a[232:233], v67 offset:36864
  ds_read_b64_tr_b16 a[234:235], v67 offset:37888
  ds_read_b64_tr_b16 a[20:21], v67 offset:40960
  ds_read_b64_tr_b16 a[22:23], v67 offset:41984
  ds_read_b64_tr_b16 a[44:45], v67 offset:45056
  ds_read_b64_tr_b16 a[46:47], v67 offset:46080
  ds_read_b64_tr_b16 a[68:69], v67 offset:49152
  ds_read_b64_tr_b16 a[70:71], v67 offset:50176
  ds_read_b64_tr_b16 a[92:93], v67 offset:53248
  ds_read_b64_tr_b16 a[94:95], v67 offset:54272
  s_waitcnt lgkmcnt(0)
  s_waitcnt vmcnt(24)
  s_barrier
  s_add_u32 m0, s51, 98304
  s_add_u32 s46, s62, 7077888
  buffer_load_dwordx4 v64, s[4:7], s46 offen lds
  s_add_u32 m0, s51, 102400
  s_add_u32 s46, s62, 7471104
  buffer_load_dwordx4 v64, s[4:7], s46 offen lds
  s_add_u32 m0, s51, 106496
  s_add_u32 s46, s62, 7078016
  buffer_load_dwordx4 v64, s[4:7], s46 offen lds
  s_add_u32 m0, s51, 110592
  s_add_u32 s46, s62, 7471232
  buffer_load_dwordx4 v64, s[4:7], s46 offen lds
  s_add_u32 m0, s51, 114688
  s_add_u32 s46, s62, 7078144
  buffer_load_dwordx4 v64, s[4:7], s46 offen lds
  s_add_u32 m0, s51, 118784
  s_add_u32 s46, s62, 7471360
  buffer_load_dwordx4 v64, s[4:7], s46 offen lds
  ds_read_b64_tr_b16 a[116:117], v67 offset:57344
  ds_read_b64_tr_b16 a[118:119], v67 offset:58368
  ds_read_b64_tr_b16 a[140:141], v67 offset:61440
  ds_read_b64_tr_b16 a[142:143], v67 offset:62464
  ds_read_b64_tr_b16 a[164:165], v68 offset:0
  ds_read_b64_tr_b16 a[166:167], v68 offset:1024
  ds_read_b64_tr_b16 a[188:189], v68 offset:4096
  ds_read_b64_tr_b16 a[190:191], v68 offset:5120
  ds_read_b64_tr_b16 a[212:213], v68 offset:8192
  ds_read_b64_tr_b16 a[214:215], v68 offset:9216
  ds_read_b64_tr_b16 a[236:237], v68 offset:12288
  ds_read_b64_tr_b16 a[238:239], v68 offset:13312
  s_waitcnt lgkmcnt(0)
  s_waitcnt vmcnt(24)
  s_barrier
  ds_read_b64_tr_b16 v[40:41], v66 offset:0
  ds_read_b64_tr_b16 v[42:43], v66 offset:1024
  ds_read_b64_tr_b16 v[44:45], v66 offset:4096
  ds_read_b64_tr_b16 v[46:47], v66 offset:5120
  ds_read_b64_tr_b16 v[48:49], v66 offset:8192
  ds_read_b64_tr_b16 v[50:51], v66 offset:9216
  ds_read_b64_tr_b16 v[52:53], v66 offset:12288
  ds_read_b64_tr_b16 v[54:55], v66 offset:13312
  ds_read_b64_tr_b16 v[56:57], v66 offset:16384
  ds_read_b64_tr_b16 v[58:59], v66 offset:17408
  ds_read_b64_tr_b16 v[60:61], v66 offset:20480
  ds_read_b64_tr_b16 v[62:63], v66 offset:21504
  s_waitcnt lgkmcnt(0)
  s_waitcnt vmcnt(18)
  s_barrier
  ds_write_b128 v2, v[40:43] offset:0
  ds_write_b128 v2, v[44:47] offset:4096
  ds_write_b128 v2, v[48:51] offset:8192
  ds_write_b128 v2, v[52:55] offset:12288
  ds_write_b128 v2, v[56:59] offset:16384
  ds_write_b128 v2, v[60:63] offset:20480
  ds_read_b64_tr_b16 v[16:17], v66 offset:24576
  ds_read_b64_tr_b16 v[18:19], v66 offset:25600
  ds_read_b64_tr_b16 v[20:21], v66 offset:28672
  ds_read_b64_tr_b16 v[22:23], v66 offset:29696
  ds_read_b64_tr_b16 v[24:25], v66 offset:32768
  ds_read_b64_tr_b16 v[26:27], v66 offset:33792
  ds_read_b64_tr_b16 v[28:29], v66 offset:36864
  ds_read_b64_tr_b16 v[30:31], v66 offset:37888
  ds_read_b64_tr_b16 v[32:33], v66 offset:40960
  ds_read_b64_tr_b16 v[34:35], v66 offset:41984
  ds_read_b64_tr_b16 v[36:37], v66 offset:45056
  ds_read_b64_tr_b16 v[38:39], v66 offset:46080
  s_waitcnt lgkmcnt(0)
  s_waitcnt vmcnt(12)
  s_barrier
  ds_write_b128 v2, v[16:19] offset:24576
  ds_write_b128 v2, v[20:23] offset:28672
  ds_write_b128 v2, v[24:27] offset:32768
  ds_write_b128 v2, v[28:31] offset:36864
  ds_write_b128 v2, v[32:35] offset:40960
  ds_write_b128 v2, v[36:39] offset:45056
  ds_read_b64_tr_b16 v[40:41], v66 offset:49152
  ds_read_b64_tr_b16 v[42:43], v66 offset:50176
  ds_read_b64_tr_b16 v[44:45], v66 offset:53248
  ds_read_b64_tr_b16 v[46:47], v66 offset:54272
  ds_read_b64_tr_b16 v[48:49], v66 offset:57344
  ds_read_b64_tr_b16 v[50:51], v66 offset:58368
  ds_read_b64_tr_b16 v[52:53], v66 offset:61440
  ds_read_b64_tr_b16 v[54:55], v66 offset:62464
  ds_read_b64_tr_b16 v[56:57], v67 offset:0
  ds_read_b64_tr_b16 v[58:59], v67 offset:1024
  ds_read_b64_tr_b16 v[60:61], v67 offset:4096
  ds_read_b64_tr_b16 v[62:63], v67 offset:5120
  s_waitcnt lgkmcnt(0)
  s_waitcnt vmcnt(6)
  s_barrier
  ds_write_b128 v2, v[40:43] offset:49152
  ds_write_b128 v2, v[44:47] offset:53248
  ds_write_b128 v2, v[48:51] offset:57344
  ds_write_b128 v2, v[52:55] offset:61440
  ds_write_b128 v3, v[56:59] offset:0
  ds_write_b128 v3, v[60:63] offset:4096
  ds_read_b64_tr_b16 v[16:17], v67 offset:8192
  ds_read_b64_tr_b16 v[18:19], v67 offset:9216
  ds_read_b64_tr_b16 v[20:21], v67 offset:12288
  ds_read_b64_tr_b16 v[22:23], v67 offset:13312
  ds_read_b64_tr_b16 v[24:25], v67 offset:16384
  ds_read_b64_tr_b16 v[26:27], v67 offset:17408
  ds_read_b64_tr_b16 v[28:29], v67 offset:20480
  ds_read_b64_tr_b16 v[30:31], v67 offset:21504
  ds_read_b64_tr_b16 v[32:33], v67 offset:24576
  ds_read_b64_tr_b16 v[34:35], v67 offset:25600
  ds_read_b64_tr_b16 v[36:37], v67 offset:28672
  ds_read_b64_tr_b16 v[38:39], v67 offset:29696
  s_waitcnt lgkmcnt(0)
  s_waitcnt vmcnt(0)
  s_barrier
  ds_write_b128 v3, v[16:19] offset:8192
  ds_write_b128 v3, v[20:23] offset:12288
  ds_write_b128 v3, v[24:27] offset:16384
  ds_write_b128 v3, v[28:31] offset:20480
  ds_write_b128 v3, v[32:35] offset:24576
  ds_write_b128 v3, v[36:39] offset:28672
  ds_read_b64_tr_b16 v[40:41], v67 offset:32768
  ds_read_b64_tr_b16 v[42:43], v67 offset:33792
  ds_read_b64_tr_b16 v[44:45], v67 offset:36864
  ds_read_b64_tr_b16 v[46:47], v67 offset:37888
  ds_read_b64_tr_b16 v[48:49], v67 offset:40960
  ds_read_b64_tr_b16 v[50:51], v67 offset:41984
  ds_read_b64_tr_b16 v[52:53], v67 offset:45056
  ds_read_b64_tr_b16 v[54:55], v67 offset:46080
  ds_read_b64_tr_b16 v[56:57], v67 offset:49152
  ds_read_b64_tr_b16 v[58:59], v67 offset:50176
  ds_read_b64_tr_b16 v[60:61], v67 offset:53248
  ds_read_b64_tr_b16 v[62:63], v67 offset:54272
  s_waitcnt lgkmcnt(0)
  s_barrier
  ds_write_b128 v3, v[40:43] offset:32768
  ds_write_b128 v3, v[44:47] offset:36864
  ds_write_b128 v3, v[48:51] offset:40960
  ds_write_b128 v3, v[52:55] offset:45056
  ds_write_b128 v3, v[56:59] offset:49152
  ds_write_b128 v3, v[60:63] offset:53248
  s_waitcnt lgkmcnt(0)
  v_and_b32 v141, 3, v0
  v_lshlrev_b32 v141, 2, v141
  s_mov_b32 s50, 0
ss_31:
  global_load_dword v140, v141, s[38:39] sc1
  s_add_u32 s50, s50, 1
  s_cmp_gt_u32 s50, 131072
  s_cbranch_scc1 L_fail
  s_waitcnt vmcnt(0)
  v_readlane_b32 s46, v140, 0
  v_readlane_b32 s47, v140, 2
  s_cmp_lg_u32 s46, 0
  s_cselect_b32 s48, 7, 0
  s_add_u32 s46, s46, s2
  s_xor_b32 s49, s46, s43
  s_and_b32 s49, s49, s48
  s_cbranch_scc1 L_reroll
  s_cmp_lg_u32 s47, 0
  s_cbranch_scc1 ss_ok_32
  s_sleep 10
  s_branch ss_31
ss_ok_32:
  v_readlane_b32 s3, v140, 1
  s_nop 0
  s_and_b32 s3, s3, 0x2000
  v_and_b32 v140, 3, v0
  s_lshl_b32 s46, s43, 9
  s_add_u32 s46, s46, s3
  s_add_u32 s46, s46, 13369344
  v_lshl_add_u32 v10, v140, 7, s46
  v_mov_b32 v7, 0x44444444
  v_mov_b32 v140, 0xeeeeeeee
  v_and_b32 v141, 2, v0
  v_cmp_ne_u32 vcc, 0, v141
  s_nop 1
  v_cndmask_b32 v7, v7, v140, vcc
  v_and_b32 v140, 15, v0
  v_lshrrev_b32 v141, 4, v0
  v_lshlrev_b32 v8, 4, v140
  v_lshrrev_b32 v142, 1, v141
  v_lshl_add_u32 v8, v142, 3, v8
  v_and_b32 v143, 1, v141
  v_lshrrev_b32 v142, 2, v140
  v_lshlrev_b32 v4, 6, v142
  v_and_b32 v142, 1, v140
  v_lshl_add_u32 v4, v142, 5, v4
  v_lshl_add_u32 v4, v141, 3, v4
  v_bfe_u32 v142, v140, 1, 1
  v_lshl_add_u32 v4, v142, 2, v4
  s_and_b32 s46, s42, 1
  s_lshl_b32 s46, s46, 7
  v_xor_b32 v4, s46, v4
  s_lshl_b32 s46, s42, 8
  s_add_u32 s46, s46, 122880
  v_add_u32 v4, s46, v4
  s_lshl_b32 s46, s45, 8
  s_lshl_b32 s47, s42, 14
  s_add_u32 s47, s47, s46
  v_lshl_add_u32 v8, v143, 16, v8
  v_add_u32 v8, s47, v8
  v_lshlrev_b32 v5, 8, v141
  v_and_b32 v142, 1, v141
  v_lshl_add_u32 v5, v142, 7, v5
  v_lshl_add_u32 v5, v140, 3, v5
  v_xor_b32 v6, 0x80, v5
  v_add_u32 v5, 122880, v5
  v_add_u32 v6, 122880, v6
  s_lshl_b32 s46, s45, 7
  s_lshl_b32 s47, s42, 2
  s_add_u32 s47, s47, s46
  s_add_u32 s47, s47, 1064960
  v_mov_b32 v15, s47
  s_mov_b32 s52, 0
  s_mov_b32 s58, 0
  s_mov_b32 s54, 0
  s_mov_b32 s100, 0
va_loop:
  s_add_u32 s53, s52, 1
  s_lshl_b32 s56, s58, 2
  s_add_u32 s56, s56, s43
  s_lshl_b32 s56, s56, 16
  s_add_u32 s56, s56, s3
  s_add_u32 s56, s56, 12582912
  s_lshl_b32 s66, s54, 21
  s_mul_i32 s46, s58, 655360
  s_add_u32 s66, s66, s46
  s_add_u32 s66, s66, s3
  s_add_u32 s66, s66, 4194304
  s_lshr_b32 s46, s66, 8
  s_and_b32 s46, s46, 0x2000
  s_xor_b32 s66, s66, s46
  v_add_u32 v11, s56, v1
  s_mov_b64 s[16:17], -1
  s_mov_b32 s71, 0
  ds_read_b128 v[56:59], v2 offset:0
  ds_read_b128 v[60:63], v2 offset:4096
  ds_read_b128 v[64:67], v2 offset:8192
  ds_read_b128 v[68:71], v2 offset:12288
  ds_read_b128 v[72:75], v2 offset:16384
  ds_read_b128 v[76:79], v2 offset:20480
  ds_read_b128 v[80:83], v2 offset:24576
  ds_read_b128 v[84:87], v2 offset:28672
  ds_read_b128 v[88:91], v2 offset:32768
  ds_read_b128 v[92:95], v2 offset:36864
  ds_read_b128 v[96:99], v2 offset:40960
  ds_read_b128 v[100:103], v2 offset:45056
  v_mov_b32 v104, 0
  v_mov_b32 v105, 0
  v_mov_b32 v106, 0
  v_mov_b32 v107, 0
  v_mov_b32 v108, 0
  v_mov_b32 v109, 0
  v_mov_b32 v110, 0
  v_mov_b32 v111, 0
  v_mov_b32 v112, 0
  v_mov_b32 v113, 0
  v_mov_b32 v114, 0
  v_mov_b32 v115, 0
  s_cmp_lg_u32 s42, 3
  s_cbranch_scc1 va_nobell
  s_mov_b32 s50, 0
  s_mov_b64 exec, 15
  buffer_load_dword v116, v10, s[8:11], 0 offen sc1
  s_nop 11
  buffer_load_dword v117, v10, s[8:11], 0 offen sc1
  s_nop 11
  buffer_load_dword v118, v10, s[8:11], 0 offen sc1
  s_nop 11
  buffer_load_dword v119, v10, s[8:11], 0 offen sc1
  s_nop 11
  buffer_load_dword v120, v10, s[8:11], 0 offen sc1
  s_nop 11
  buffer_load_dword v121, v10, s[8:11], 0 offen sc1
  s_nop 11
  buffer_load_dword v122, v10, s[8:11], 0 offen sc1
  s_nop 11
  buffer_load_dword v123, v10, s[8:11], 0 offen sc1
  s_nop 11
  buffer_load_dword v124, v10, s[8:11], 0 offen sc1
  s_nop 11
bell_33:
  buffer_load_dword v125, v10, s[8:11], 0 offen sc1
  s_waitcnt vmcnt(9)
  v_cmp_gt_u32 vcc, s53, v116
  s_cbranch_vccz bell_x_34
  s_nop 7
  buffer_load_dword v116, v10, s[8:11], 0 offen sc1
  s_waitcnt vmcnt(9)
  v_cmp_gt_u32 vcc, s53, v117
  s_cbranch_vccz bell_x_34
  s_nop 7
  buffer_load_dword v117, v10, s[8:11], 0 offen sc1
  s_waitcnt vmcnt(9)
  v_cmp_gt_u32 vcc, s53, v118
  s_cbranch_vccz bell_x_34
  s_nop 7
  buffer_load_dword v118, v10, s[8:11], 0 offen sc1
  s_waitcnt vmcnt(9)
  v_cmp_gt_u32 vcc, s53, v119
  s_cbranch_vccz bell_x_34
  s_nop 7
  buffer_load_dword v119, v10, s[8:11], 0 offen sc1
  s_waitcnt vmcnt(9)
  v_cmp_gt_u32 vcc, s53, v120
  s_cbranch_vccz bell_x_34
  s_nop 7
  buffer_load_dword v120, v10, s[8:11], 0 offen sc1
  s_waitcnt vmcnt(9)
  v_cmp_gt_u32 vcc, s53, v121
  s_cbranch_vccz bell_x_34
  s_nop 7
  buffer_load_dword v121, v10, s[8:11], 0 offen sc1
  s_waitcnt vmcnt(9)
  v_cmp_gt_u32 vcc, s53, v122
  s_cbranch_vccz bell_x_34
  s_nop 7
  buffer_load_dword v122, v10, s[8:11], 0 offen sc1
  s_waitcnt vmcnt(9)
  v_cmp_gt_u32 vcc, s53, v123
  s_cbranch_vccz bell_x_34
  s_nop 7
  buffer_load_dword v123, v10, s[8:11], 0 offen sc1
  s_waitcnt vmcnt(9)
  v_cmp_gt_u32 vcc, s53, v124
  s_cbranch_vccz bell_x_34
  s_nop 7
  buffer_load_dword v124, v10, s[8:11], 0 offen sc1
  s_waitcnt vmcnt(9)
  v_cmp_gt_u32 vcc, s53, v125
  s_cbranch_vccz bell_x_34
  s_add_u32 s50, s50, 1
  s_cmp_gt_u32 s50, 131072
  s_cbranch_scc1 L_fail
  s_branch bell_33
bell_x_34:
  s_mov_b64 exec, -1
va_nobell:
  s_waitcnt lgkmcnt(0)
  s_barrier
  buffer_load_dwordx4 v[16:19], v11, s[8:11], 0 offen offset:0 sc1
  s_barrier
  buffer_load_dwordx4 v[20:23], v11, s[8:11], 0 offen offset:1024 sc1
  s_barrier
  buffer_load_dwordx4 v[24:27], v11, s[8:11], 0 offen offset:2048 sc1
  s_barrier
  buffer_load_dwordx4 v[28:31], v11, s[8:11], 0 offen offset:3072 sc1
  s_barrier
  buffer_load_dwordx4 v[32:35], v11, s[8:11], s24 offen offset:0 sc1
  s_barrier
  buffer_load_dwordx4 v[36:39], v11, s[8:11], s24 offen offset:1024 sc1
  s_barrier
  buffer_load_dwordx4 v[40:43], v11, s[8:11], s24 offen offset:2048 sc1
  s_barrier
  buffer_load_dwordx4 v[44:47], v11, s[8:11], s24 offen offset:3072 sc1
  s_barrier
  buffer_load_dwordx4 v[48:51], v11, s[8:11], s25 offen offset:0 sc1
  s_barrier
  buffer_load_dwordx4 v[52:55], v11, s[8:11], s25 offen offset:1024 sc1
va_go_35:
  s_waitcnt vmcnt(9)
  v_smfmac_f32_16x16x64_bf16 v[104:107], v[16:19], a[240:247], v7
  v_smfmac_f32_16x16x64_bf16 v[108:111], v[16:19], a[248:255], v7
  v_smfmac_f32_16x16x64_bf16 v[112:115], v[16:19], v[152:159], v7
  s_waitcnt vmcnt(8)
  v_smfmac_f32_16x16x64_bf16 v[104:107], v[20:23], v[56:63], v7
  v_mov_b32 v16, 0
  v_smfmac_f32_16x16x64_bf16 v[108:111], v[20:23], v[64:71], v7
  ds_read_b128 v[56:59], v2 offset:49152
  v_mov_b32 v17, 0
  v_smfmac_f32_16x16x64_bf16 v[112:115], v[20:23], v[72:79], v7
  ds_read_b128 v[60:63], v2 offset:53248
  v_mov_b32 v18, 0
  v_mov_b32 v19, 0
  s_waitcnt vmcnt(7)
  v_smfmac_f32_16x16x64_bf16 v[104:107], v[24:27], v[160:167], v7
  ds_read_b128 v[64:67], v2 offset:57344
  v_mov_b32 v20, 0
  v_smfmac_f32_16x16x64_bf16 v[108:111], v[24:27], v[168:175], v7
  ds_read_b128 v[68:71], v2 offset:61440
  v_mov_b32 v21, 0
  v_smfmac_f32_16x16x64_bf16 v[112:115], v[24:27], v[176:183], v7
  ds_read_b128 v[72:75], v3 offset:0
  v_mov_b32 v22, 0
  v_mov_b32 v23, 0
  s_waitcnt vmcnt(6)
  v_smfmac_f32_16x16x64_bf16 v[104:107], v[28:31], v[80:87], v7
  ds_read_b128 v[76:79], v3 offset:4096
  v_mov_b32 v24, 0
  v_smfmac_f32_16x16x64_bf16 v[108:111], v[28:31], v[88:95], v7
  ds_read_b128 v[80:83], v3 offset:8192
  v_mov_b32 v25, 0
  v_smfmac_f32_16x16x64_bf16 v[112:115], v[28:31], v[96:103], v7
  ds_read_b128 v[84:87], v3 offset:12288
  v_mov_b32 v26, 0
  v_mov_b32 v27, 0
  s_waitcnt vmcnt(5)
  v_smfmac_f32_16x16x64_bf16 v[104:107], v[32:35], v[184:191], v7
  ds_read_b128 v[88:91], v3 offset:16384
  v_mov_b32 v28, 0
  v_smfmac_f32_16x16x64_bf16 v[108:111], v[32:35], v[192:199], v7
  ds_read_b128 v[92:95], v3 offset:20480
  v_mov_b32 v29, 0
  v_smfmac_f32_16x16x64_bf16 v[112:115], v[32:35], v[200:207], v7
  ds_read_b128 v[96:99], v3 offset:24576
  v_mov_b32 v30, 0
  v_mov_b32 v31, 0
  s_waitcnt vmcnt(4)
  s_waitcnt lgkmcnt(9)
  v_smfmac_f32_16x16x64_bf16 v[104:107], v[36:39], v[56:63], v7
  ds_read_b128 v[100:103], v3 offset:28672
  v_mov_b32 v32, 0
  s_waitcnt lgkmcnt(8)
  v_smfmac_f32_16x16x64_bf16 v[108:111], v[36:39], v[64:71], v7
  ds_read_b128 v[56:59], v3 offset:32768
  v_mov_b32 v33, 0
  s_waitcnt lgkmcnt(7)
  v_smfmac_f32_16x16x64_bf16 v[112:115], v[36:39], v[72:79], v7
  ds_read_b128 v[60:63], v3 offset:36864
  v_mov_b32 v34, 0
  v_mov_b32 v35, 0
  s_waitcnt vmcnt(3)
  v_smfmac_f32_16x16x64_bf16 v[104:107], v[40:43], v[208:215], v7
  ds_read_b128 v[64:67], v3 offset:40960
  v_mov_b32 v36, 0
  v_smfmac_f32_16x16x64_bf16 v[108:111], v[40:43], v[216:223], v7
  ds_read_b128 v[68:71], v3 offset:45056
  v_mov_b32 v37, 0
  v_smfmac_f32_16x16x64_bf16 v[112:115], v[40:43], v[224:231], v7
  ds_read_b128 v[72:75], v3 offset:49152
  v_mov_b32 v38, 0
  v_mov_b32 v39, 0
  s_waitcnt vmcnt(2)
  s_waitcnt lgkmcnt(9)
  v_smfmac_f32_16x16x64_bf16 v[104:107], v[44:47], v[80:87], v7
  ds_read_b128 v[76:79], v3 offset:53248
  v_mov_b32 v40, 0
  s_waitcnt lgkmcnt(8)
  v_smfmac_f32_16x16x64_bf16 v[108:111], v[44:47], v[88:95], v7
  v_mov_b32 v41, 0
  s_waitcnt lgkmcnt(6)
  v_smfmac_f32_16x16x64_bf16 v[112:115], v[44:47], v[96:103], v7
  v_mov_b32 v42, 0
  v_mov_b32 v43, 0
  s_waitcnt vmcnt(1)
  v_smfmac_f32_16x16x64_bf16 v[104:107], v[48:51], v[232:239], v7
  v_mov_b32 v44, 0
  v_smfmac_f32_16x16x64_bf16 v[108:111], v[48:51], v[240:247], v7
  v_mov_b32 v45, 0
  v_smfmac_f32_16x16x64_bf16 v[112:115], v[48:51], v[248:255], v7
  v_mov_b32 v46, 0
  v_mov_b32 v47, 0
  s_waitcnt vmcnt(0)
  s_waitcnt lgkmcnt(4)
  v_smfmac_f32_16x16x64_bf16 v[104:107], v[52:55], v[56:63], v7
  v_mov_b32 v48, 0
  s_waitcnt lgkmcnt(2)
  v_smfmac_f32_16x16x64_bf16 v[108:111], v[52:55], v[64:71], v7
  v_mov_b32 v49, 0
  s_waitcnt lgkmcnt(0)
  v_smfmac_f32_16x16x64_bf16 v[112:115], v[52:55], v[72:79], v7
  v_mov_b32 v50, 0
  v_mov_b32 v51, 0
  v_add_f32 v104, v104, v106
  v_add_f32 v105, v105, v107
  v_cmp_u_f32 vcc, v104, v105
  v_cvt_pk_bf16_f32 v106, v104, v105
  v_add_f32 v108, v108, v110
  v_add_f32 v109, v109, v111
  v_cvt_pk_bf16_f32 v110, v108, v109
  v_add_f32 v112, v112, v114
  v_add_f32 v113, v113, v115
  v_cvt_pk_bf16_f32 v114, v112, v113
  s_and_b64 vcc, vcc, s[16:17]
  s_cbranch_scc1 va_redo_36
  ds_write_b32 v4, v106 offset:0
  ds_write_b32 v4, v110 offset:1024
  ds_write_b32 v4, v114 offset:2048
  v_mov_b32 v52, 0
  v_mov_b32 v53, 0
  v_mov_b32 v54, 0
  v_mov_b32 v55, 0
  s_waitcnt lgkmcnt(0)
  s_barrier
  ds_read_b64_tr_b16 v[116:117], v5 offset:0
  ds_read_b64_tr_b16 v[118:119], v6 offset:0
  ds_read_b64_tr_b16 v[120:121], v5 offset:1024
  ds_read_b64_tr_b16 v[122:123], v6 offset:1024
  ds_read_b64_tr_b16 v[124:125], v5 offset:2048
  ds_read_b64_tr_b16 v[126:127], v6 offset:2048
  s_waitcnt lgkmcnt(4)
  v_smfmac_f32_16x16x64_bf16 v[16:19], v[116:119], a[0:7], v7
  s_waitcnt lgkmcnt(2)
  v_smfmac_f32_16x16x64_bf16 v[16:19], v[120:123], a[8:15], v7
  s_waitcnt lgkmcnt(0)
  v_smfmac_f32_16x16x64_bf16 v[16:19], v[124:127], a[16:23], v7
  v_smfmac_f32_16x16x64_bf16 v[20:23], v[116:119], a[24:31], v7
  v_smfmac_f32_16x16x64_bf16 v[20:23], v[120:123], a[32:39], v7
  v_add_f32 v16, v16, v18
  v_smfmac_f32_16x16x64_bf16 v[20:23], v[124:127], a[40:47], v7
  v_add_f32 v17, v17, v19
  v_smfmac_f32_16x16x64_bf16 v[24:27], v[116:119], a[48:55], v7
  v_cvt_pk_bf16_f32 v128, v16, v17
  v_smfmac_f32_16x16x64_bf16 v[24:27], v[120:123], a[56:63], v7
  v_add_f32 v20, v20, v22
  v_smfmac_f32_16x16x64_bf16 v[24:27], v[124:127], a[64:71], v7
  v_add_f32 v21, v21, v23
  v_smfmac_f32_16x16x64_bf16 v[28:31], v[116:119], a[72:79], v7
  s_add_u32 s46, s66, 0
  v_cvt_pk_bf16_f32 v129, v20, v21
  v_smfmac_f32_16x16x64_bf16 v[28:31], v[120:123], a[80:87], v7
  v_add_f32 v24, v24, v26
  v_smfmac_f32_16x16x64_bf16 v[28:31], v[124:127], a[88:95], v7
  v_permlane16_swap_b32 v128, v129
  v_add_f32 v25, v25, v27
  v_smfmac_f32_16x16x64_bf16 v[32:35], v[116:119], a[96:103], v7
  buffer_store_dwordx2 v[128:129], v8, s[8:11], s46 offen sc1
  v_cvt_pk_bf16_f32 v130, v24, v25
  v_smfmac_f32_16x16x64_bf16 v[32:35], v[120:123], a[104:111], v7
  v_add_f32 v28, v28, v30
  v_smfmac_f32_16x16x64_bf16 v[32:35], v[124:127], a[112:119], v7
  v_add_f32 v29, v29, v31
  v_smfmac_f32_16x16x64_bf16 v[36:39], v[116:119], a[120:127], v7
  s_add_u32 s46, s66, 131072
  v_cvt_pk_bf16_f32 v131, v28, v29
  v_smfmac_f32_16x16x64_bf16 v[36:39], v[120:123], a[128:135], v7
  v_add_f32 v32, v32, v34
  v_smfmac_f32_16x16x64_bf16 v[36:39], v[124:127], a[136:143], v7
  v_permlane16_swap_b32 v130, v131
  v_add_f32 v33, v33, v35
  v_smfmac_f32_16x16x64_bf16 v[40:43], v[116:119], a[144:151], v7
  buffer_store_dwordx2 v[130:131], v8, s[8:11], s46 offen sc1
  v_cvt_pk_bf16_f32 v132, v32, v33
  v_smfmac_f32_16x16x64_bf16 v[40:43], v[120:123], a[152:159], v7
  v_add_f32 v36, v36, v38
  v_smfmac_f32_16x16x64_bf16 v[40:43], v[124:127], a[160:167], v7
  v_add_f32 v37, v37, v39
  v_smfmac_f32_16x16x64_bf16 v[44:47], v[116:119], a[168:175], v7
  s_add_u32 s46, s66, 262144
  v_cvt_pk_bf16_f32 v133, v36, v37
  v_smfmac_f32_16x16x64_bf16 v[44:47], v[120:123], a[176:183], v7
  v_add_f32 v40, v40, v42
  v_smfmac_f32_16x16x64_bf16 v[44:47], v[124:127], a[184:191], v7
  v_permlane16_swap_b32 v132, v133
  v_add_f32 v41, v41, v43
  v_smfmac_f32_16x16x64_bf16 v[48:51], v[116:119], a[192:199], v7
  buffer_store_dwordx2 v[132:133], v8, s[8:11], s46 offen sc1
  v_cvt_pk_bf16_f32 v134, v40, v41
  v_smfmac_f32_16x16x64_bf16 v[48:51], v[120:123], a[200:207], v7
  v_add_f32 v44, v44, v46
  v_smfmac_f32_16x16x64_bf16 v[48:51], v[124:127], a[208:215], v7
  v_add_f32 v45, v45, v47
  v_smfmac_f32_16x16x64_bf16 v[52:55], v[116:119], a[216:223], v7
  s_add_u32 s46, s66, 393216
  v_cvt_pk_bf16_f32 v135, v44, v45
  v_smfmac_f32_16x16x64_bf16 v[52:55], v[120:123], a[224:231], v7
  v_add_f32 v48, v48, v50
  v_smfmac_f32_16x16x64_bf16 v[52:55], v[124:127], a[232:239], v7
  v_permlane16_swap_b32 v134, v135
  buffer_store_dwordx2 v[134:135], v8, s[8:11], s46 offen sc1
  v_add_f32 v49, v49, v51
  v_cvt_pk_bf16_f32 v136, v48, v49
  s_nop 3
  v_add_f32 v52, v52, v54
  v_add_f32 v53, v53, v55
  v_cvt_pk_bf16_f32 v137, v52, v53
  s_add_u32 s46, s66, 524288
  s_nop 0
  v_permlane16_swap_b32 v136, v137
  buffer_store_dwordx2 v[136:137], v8, s[8:11], s46 offen sc1
  s_add_u32 s58, s58, 1
  s_cmp_eq_u32 s58, 3
  s_cselect_b32 s58, 0, s58
  s_cmp_eq_u32 s58, 0
  s_addc_u32 s54, s54, 0
  s_cmp_eq_u32 s54, 3
  s_cselect_b32 s54, 0, s54
  s_mov_b32 s52, s53
  s_cmp_lt_u32 s52, 64
  s_cbranch_scc1 va_loop
  s_waitcnt vmcnt(0)
  v_mov_b32 v140, s52
  s_mov_b64 exec, 1
  buffer_store_dword v140, v15, s[8:11], 0 offen sc1
  s_mov_b64 exec, -1
  s_endpgm
va_redo_36:
  s_mov_b32 s50, 0
va_poll_37:
  buffer_load_dwordx4 v[16:19], v11, s[8:11], 0 offen offset:0 sc1
  buffer_load_dwordx4 v[20:23], v11, s[8:11], 0 offen offset:1024 sc1
  buffer_load_dwordx4 v[24:27], v11, s[8:11], 0 offen offset:2048 sc1
  buffer_load_dwordx4 v[28:31], v11, s[8:11], 0 offen offset:3072 sc1
  buffer_load_dwordx4 v[32:35], v11, s[8:11], s24 offen offset:0 sc1
  buffer_load_dwordx4 v[36:39], v11, s[8:11], s24 offen offset:1024 sc1
  buffer_load_dwordx4 v[40:43], v11, s[8:11], s24 offen offset:2048 sc1
  buffer_load_dwordx4 v[44:47], v11, s[8:11], s24 offen offset:3072 sc1
  buffer_load_dwordx4 v[48:51], v11, s[8:11], s25 offen offset:0 sc1
  buffer_load_dwordx4 v[52:55], v11, s[8:11], s25 offen offset:1024 sc1
  s_add_u32 s71, s71, 1
  s_cmp_le_u32 s71, 2
  s_cbranch_scc1 va_again_38
  s_add_u32 s50, s50, 1
  s_cmp_gt_u32 s50, 131072
  s_cbranch_scc1 L_fail
  s_waitcnt vmcnt(0)
  v_max_u32 v12, v16, v17
  v_max3_u32 v12, v18, v19, v12
  v_max3_u32 v12, v20, v21, v12
  v_max3_u32 v12, v22, v23, v12
  v_max3_u32 v12, v24, v25, v12
  v_max3_u32 v12, v26, v27, v12
  v_max3_u32 v12, v28, v29, v12
  v_max3_u32 v12, v30, v31, v12
  v_max3_u32 v12, v32, v33, v12
  v_max3_u32 v12, v34, v35, v12
  v_max3_u32 v12, v36, v37, v12
  v_max3_u32 v12, v38, v39, v12
  v_max3_u32 v12, v40, v41, v12
  v_max3_u32 v12, v42, v43, v12
  v_max3_u32 v12, v44, v45, v12
  v_max3_u32 v12, v46, v47, v12
  v_max3_u32 v12, v48, v49, v12
  v_max3_u32 v12, v50, v51, v12
  v_max3_u32 v12, v52, v53, v12
  v_max3_u32 v12, v54, v55, v12
  v_cmp_eq_u32 vcc, -1, v12
  s_cbranch_vccnz va_poll_37
  s_mov_b64 s[16:17], 0
va_again_38:
  s_waitcnt lgkmcnt(0)
  ds_read_b128 v[56:59], v2 offset:0
  ds_read_b128 v[60:63], v2 offset:4096
  ds_read_b128 v[64:67], v2 offset:8192
  ds_read_b128 v[68:71], v2 offset:12288
  ds_read_b128 v[72:75], v2 offset:16384
  ds_read_b128 v[76:79], v2 offset:20480
  ds_read_b128 v[80:83], v2 offset:24576
  ds_read_b128 v[84:87], v2 offset:28672
  ds_read_b128 v[88:91], v2 offset:32768
  ds_read_b128 v[92:95], v2 offset:36864
  ds_read_b128 v[96:99], v2 offset:40960
  ds_read_b128 v[100:103], v2 offset:45056
  v_mov_b32 v104, 0
  v_mov_b32 v105, 0
  v_mov_b32 v106, 0
  v_mov_b32 v107, 0
  v_mov_b32 v108, 0
  v_mov_b32 v109, 0
  v_mov_b32 v110, 0
  v_mov_b32 v111, 0
  v_mov_b32 v112, 0
  v_mov_b32 v113, 0
  v_mov_b32 v114, 0
  v_mov_b32 v115, 0
  s_waitcnt lgkmcnt(0)
  s_branch va_go_35
L_owner:
  s_cmp_ge_u32 s42, 2
  s_cbranch_scc1 L_end
  s_mul_i32 s62, s43, 10
  s_add_u32 s62, s62, s44
  s_sub_u32 s62, s62, 16
  s_mov_b32 s12, s24
  s_mov_b32 s13, s25
  s_mov_b32 s14, 10240
  s_mov_b32 s15, 0x20000
  v_and_b32 v11, 3, v0
  v_lshlrev_b32 v11, 2, v11
  s_mov_b32 s50, 0
ss_39:
  global_load_dword v10, v11, s[38:39] sc1
  s_add_u32 s50, s50, 1
  s_cmp_gt_u32 s50, 131072
  s_cbranch_scc1 L_fail
  s_waitcnt vmcnt(0)
  v_readlane_b32 s46, v10, 0
  v_readlane_b32 s47, v10, 1
  s_cmp_lg_u32 s46, 0
  s_cselect_b32 s48, 7, 0
  s_add_u32 s46, s46, s2
  s_xor_b32 s49, s46, s43
  s_and_b32 s49, s49, s48
  s_cbranch_scc1 L_reroll
  s_cmp_lg_u32 s47, 0
  s_cbranch_scc1 ss_ok_40
  s_sleep 10
  s_branch ss_39
ss_ok_40:
  v_readlane_b32 s3, v10, 1
  s_nop 0
  s_and_b32 s3, s3, 0x2000
  v_and_b32 v10, 3, v0
  s_lshl_b32 s46, s43, 9
  s_add_u32 s46, s46, s3
  s_add_u32 s46, s46, 13371392
  v_lshl_add_u32 v6, v10, 7, s46
  s_lshl_b32 s46, s43, 7
  s_add_u32 s46, s46, s3
  s_add_u32 s46, s46, 13369344
  v_lshl_add_u32 v7, v10, 9, s46
  s_cmp_eq_u32 s42, 0
  s_cbranch_scc1 ow_main
  v_mov_b32 v14, 2146435072
  s_lshl_b32 s46, s43, 7
  s_add_u32 s46, s46, s3
  s_add_u32 s46, s46, 13373440
  v_mov_b32 v19, s46
  s_lshl_b32 s46, s43, 7
  s_add_u32 s46, s46, 1077248
  v_writelane_b32 v19, s46, 1
  s_cmp_eq_u32 s44, 17
  s_cselect_b64 vcc, 3, 0
  v_cndmask_b32 v19, v14, v19, vcc
  s_barrier
  s_mov_b32 s53, 1
ow_listen:
  s_mov_b32 s50, 0
  s_mov_b64 exec, 15
  buffer_load_dword v136, v6, s[8:11], 0 offen sc1
  s_nop 11
  buffer_load_dword v137, v6, s[8:11], 0 offen sc1
  s_nop 11
  buffer_load_dword v138, v6, s[8:11], 0 offen sc1
  s_nop 11
  buffer_load_dword v139, v6, s[8:11], 0 offen sc1
  s_nop 11
  buffer_load_dword v140, v6, s[8:11], 0 offen sc1
  s_nop 11
  buffer_load_dword v141, v6, s[8:11], 0 offen sc1
  s_nop 11
  buffer_load_dword v142, v6, s[8:11], 0 offen sc1
  s_nop 11
  buffer_load_dword v143, v6, s[8:11], 0 offen sc1
  s_nop 11
  buffer_load_dword v144, v6, s[8:11], 0 offen sc1
  s_nop 11
bell_41:
  buffer_load_dword v145, v6, s[8:11], 0 offen sc1
  s_waitcnt vmcnt(9)
  v_cmp_gt_u32 vcc, s53, v136
  s_cbranch_vccz bell_x_42
  s_nop 7
  buffer_load_dword v136, v6, s[8:11], 0 offen sc1
  s_waitcnt vmcnt(9)
  v_cmp_gt_u32 vcc, s53, v137
  s_cbranch_vccz bell_x_42
  s_nop 7
  buffer_load_dword v137, v6, s[8:11], 0 offen sc1
  s_waitcnt vmcnt(9)
  v_cmp_gt_u32 vcc, s53, v138
  s_cbranch_vccz bell_x_42
  s_nop 7
  buffer_load_dword v138, v6, s[8:11], 0 offen sc1
  s_waitcnt vmcnt(9)
  v_cmp_gt_u32 vcc, s53, v139
  s_cbranch_vccz bell_x_42
  s_nop 7
  buffer_load_dword v139, v6, s[8:11], 0 offen sc1
  s_waitcnt vmcnt(9)
  v_cmp_gt_u32 vcc, s53, v140
  s_cbranch_vccz bell_x_42
  s_nop 7
  buffer_load_dword v140, v6, s[8:11], 0 offen sc1
  s_waitcnt vmcnt(9)
  v_cmp_gt_u32 vcc, s53, v141
  s_cbranch_vccz bell_x_42
  s_nop 7
  buffer_load_dword v141, v6, s[8:11], 0 offen sc1
  s_waitcnt vmcnt(9)
  v_cmp_gt_u32 vcc, s53, v142
  s_cbranch_vccz bell_x_42
  s_nop 7
  buffer_load_dword v142, v6, s[8:11], 0 offen sc1
  s_waitcnt vmcnt(9)
  v_cmp_gt_u32 vcc, s53, v143
  s_cbranch_vccz bell_x_42
  s_nop 7
  buffer_load_dword v143, v6, s[8:11], 0 offen sc1
  s_waitcnt vmcnt(9)
  v_cmp_gt_u32 vcc, s53, v144
  s_cbranch_vccz bell_x_42
  s_nop 7
  buffer_load_dword v144, v6, s[8:11], 0 offen sc1
  s_waitcnt vmcnt(9)
  v_cmp_gt_u32 vcc, s53, v145
  s_cbranch_vccz bell_x_42
  s_add_u32 s50, s50, 1
  s_cmp_gt_u32 s50, 131072
  s_cbranch_scc1 L_fail
  s_branch bell_41
bell_x_42:
  s_mov_b64 exec, -1
  s_barrier
  s_sub_u32 s46, s53, 1
  v_mov_b32 v12, s46
  s_barrier
  s_sleep 0
  buffer_store_dword v12, v19, s[8:11], 0 offen sc1
  s_sleep 16
  s_add_u32 s53, s53, 1
  s_cmp_lt_u32 s53, 64
  s_cbranch_scc1 ow_listen
  s_endpgm
ow_main:
  v_mov_b32 v5, 0x44444444
  v_mov_b32 v10, 0xeeeeeeee
  v_and_b32 v11, 2, v0
  v_cmp_ne_u32 vcc, 0, v11
  s_nop 1
  v_cndmask_b32 v5, v5, v10, vcc
  v_lshlrev_b32 v1, 4, v0
  v_and_b32 v10, 15, v0
  v_lshrrev_b32 v11, 4, v0
  v_lshlrev_b32 v2, 3, v10
  v_lshl_add_u32 v2, v11, 8, v2
  v_and_b32 v13, 1, v10
  v_lshl_add_u32 v12, v11, 1, v13
  v_mov_b32 v4, 0x05040100
  v_mov_b32 v14, 0x03020706
  v_cmp_eq_u32 vcc, 1, v13
  s_nop 1
  v_cndmask_b32 v4, v4, v14, vcc
  v_and_b32 v13, 3, v10
  v_lshl_add_u32 v3, v11, 2, v13
  v_lshlrev_b32 v3, 4, v3
  v_lshrrev_b32 v13, 2, v10
  v_lshl_add_u32 v3, v13, 2, v3
  v_mov_b32 v14, 2146435072
  s_cmp_eq_u32 s44, 16
  s_cselect_b64 vcc, 15, 0
  v_cndmask_b32 v7, v14, v7, vcc
  s_lshl_b32 s46, s62, 8
  s_cmp_ge_u32 s62, 32
  s_cselect_b32 s47, 40960, 0
  s_add_u32 s46, s46, s47
  s_add_u32 s46, s46, s3
  s_add_u32 s46, s46, 12582912
  v_add_u32 v3, s46, v3
  v_mul_u32_u24 v12, 1280, v12
  v_and_b32 v13, 14, v10
  v_lshl_add_u32 v12, v13, 1, v12
  s_lshl_b32 s46, s62, 5
  buffer_load_dword v15, v12, s[12:15], s46 offen
  v_lshlrev_b32 v9, 7, v0
  s_and_b32 s46, s62, 3
  s_lshl_b32 s46, s46, 2
  s_add_u32 s46, s46, 1060864
  v_add_u32 v9, s46, v9
  v_and_b32 v18, 3, v0
  v_min_u32 v18, 2, v18
  v_lshlrev_b32 v18, 8, v18
  s_mul_i32 s46, s43, 768
  s_cmp_ge_u32 s44, 21
  s_cselect_b32 s47, 128, 0
  s_add_u32 s46, s46, s47
  s_add_u32 s46, s46, 1073152
  v_add_u32 v18, s46, v18
  v_cmp_lt_u32 vcc, 31, v0
  s_nop 1
  v_cndmask_b32 v9, v9, v18, vcc
  s_lshl_b32 s63, s62, 16
  s_add_u32 s63, s63, s3
  s_add_u32 s63, s63, 81788928
  s_mov_b32 s61, 0
  s_mov_b32 s52, 0
  s_mov_b32 s58, 0
  s_mov_b32 s54, 0
  s_mov_b32 s100, 0
  v_mov_b32 v20, -1
  v_mov_b32 v24, 0
  v_mov_b32 v21, -1
  v_mov_b32 v25, 0
  v_mov_b32 v22, -1
  v_mov_b32 v26, 0
  v_mov_b32 v23, -1
  v_mov_b32 v27, 0
  s_mov_b32 s46, 0
  buffer_store_dword v20, v3, s[8:11], s46 offen sc1
  s_mov_b32 s46, 65536
  buffer_store_dword v20, v3, s[8:11], s46 offen sc1
  s_mov_b32 s46, 131072
  buffer_store_dword v20, v3, s[8:11], s46 offen sc1
  s_mov_b32 s46, 196608
  buffer_store_dword v20, v3, s[8:11], s46 offen sc1
  s_mov_b32 s46, 262144
  buffer_store_dword v20, v3, s[8:11], s46 offen sc1
  s_mov_b32 s46, 327680
  buffer_store_dword v20, v3, s[8:11], s46 offen sc1
  s_mov_b32 s46, 393216
  buffer_store_dword v20, v3, s[8:11], s46 offen sc1
  s_mov_b32 s46, 458752
  buffer_store_dword v20, v3, s[8:11], s46 offen sc1
  s_mov_b32 s46, 524288
  buffer_store_dword v20, v3, s[8:11], s46 offen sc1
  s_mov_b32 s46, 589824
  buffer_store_dword v20, v3, s[8:11], s46 offen sc1
  s_mov_b32 s46, 655360
  buffer_store_dword v20, v3, s[8:11], s46 offen sc1
  s_mov_b32 s46, 720896
  buffer_store_dword v20, v3, s[8:11], s46 offen sc1
  s_lshl_b32 s46, s62, 9
  s_cmp_ge_u32 s62, 16
  s_cselect_b32 s47, 8192, 0
  s_add_u32 s46, s46, s47
  s_cmp_ge_u32 s62, 32
  s_cselect_b32 s47, 10240, 0
  s_add_u32 s46, s46, s47
  s_add_u32 s46, s46, s3
  s_add_u32 s46, s46, 12599296
  v_lshlrev_b32 v13, 3, v0
  buffer_store_dwordx2 v[20:21], v13, s[8:11], s46 offen sc1
  s_add_u32 s46, s46, 262144
  buffer_store_dwordx2 v[20:21], v13, s[8:11], s46 offen sc1
  s_add_u32 s46, s46, 262144
  buffer_store_dwordx2 v[20:21], v13, s[8:11], s46 offen sc1
  s_add_u32 s46, s46, 262144
  v_min_u32 v13, 12, v0
  v_lshlrev_b32 v13, 7, v13
  s_mul_i32 s46, s62, 1664
  s_add_u32 s46, s46, 1048576
  buffer_store_dwordx4 v[24:27], v13, s[8:11], s46 offen sc1
  s_lshl_b32 s46, s62, 7
  s_add_u32 s46, s46, s3
  s_add_u32 s46, s46, 13369344
  buffer_store_dword v24, v24, s[8:11], s46 offen sc1
  v_mov_b32 v13, 140
  v_mov_b32 v14, 1
  s_waitcnt vmcnt(0)
  s_mov_b64 exec, 1
  global_atomic_add v12, v13, v14, s[38:39] sc0 sc1
  s_waitcnt vmcnt(0)
  v_readfirstlane_b32 s46, v12
  s_nop 0
  s_cmp_lg_u32 s46, 39
  s_cbranch_scc1 ow_notlast
  v_mov_b32 v13, 8
  global_store_dword v13, v14, s[38:39] sc1
ow_notlast:
  s_mov_b64 exec, -1
  v_and_b32 v13, 3, v0
  v_lshlrev_b32 v13, 2, v13
  s_mov_b32 s50, 0
ss_43:
  global_load_dword v12, v13, s[38:39] sc1
  s_add_u32 s50, s50, 1
  s_cmp_gt_u32 s50, 131072
  s_cbranch_scc1 L_fail
  s_waitcnt vmcnt(0)
  v_readlane_b32 s46, v12, 0
  v_readlane_b32 s47, v12, 2
  s_cmp_lg_u32 s46, 0
  s_cselect_b32 s48, 7, 0
  s_add_u32 s46, s46, s2
  s_xor_b32 s49, s46, s43
  s_and_b32 s49, s49, s48
  s_cbranch_scc1 L_reroll
  s_cmp_lg_u32 s47, 0
  s_cbranch_scc1 ss_ok_44
  s_sleep 10
  s_branch ss_43
ss_ok_44:
  v_readlane_b32 s3, v12, 1
  s_nop 0
  s_and_b32 s3, s3, 0x2000
  s_barrier
  s_mov_b32 s49, 1
  s_cmp_ge_u32 s61, s49
  s_cbranch_scc1 wf_done_45
  s_mov_b32 s50, 0
wf_loop_46:
  buffer_load_dword v12, v18, s[8:11], 0 offen sc1
  s_add_u32 s50, s50, 1
  s_cmp_gt_u32 s50, 131072
  s_cbranch_scc1 L_fail
  s_waitcnt vmcnt(0)
  v_min_u32_dpp v12, v12, v12 row_ror:8 row_mask:0xf bank_mask:0xf
  s_nop 1
  v_min_u32_dpp v12, v12, v12 row_ror:4 row_mask:0xf bank_mask:0xf
  s_nop 1
  v_min_u32_dpp v12, v12, v12 row_ror:2 row_mask:0xf bank_mask:0xf
  s_nop 1
  v_min_u32_dpp v12, v12, v12 row_ror:1 row_mask:0xf bank_mask:0xf
  v_mov_b32 v13, v12
  s_nop 1
  v_permlane16_swap_b32 v13, v12
  v_min_u32 v12, v12, v13
  v_mov_b32 v13, v12
  s_nop 1
  v_permlane32_swap_b32 v13, v12
  v_min_u32 v12, v12, v13
  s_nop 0
  v_readfirstlane_b32 s61, v12
  s_nop 0
  s_cmp_ge_u32 s61, s49
  s_cbranch_scc1 wf_done_45
  s_sleep 2
  s_branch wf_loop_46
wf_done_45:
  s_mov_b32 s61, 0
  v_min_u32 v15, -2, v15
  s_mov_b32 s46, 0
  buffer_store_dword v15, v3, s[8:11], s46 offen sc1
  s_mov_b32 s46, 65536
  buffer_store_dword v15, v3, s[8:11], s46 offen sc1
  s_mov_b32 s46, 131072
  buffer_store_dword v15, v3, s[8:11], s46 offen sc1
  s_mov_b32 s46, 196608
  buffer_store_dword v15, v3, s[8:11], s46 offen sc1
  v_mov_b32 v16, 1
  buffer_store_dword v16, v7, s[8:11], 0 offen sc1
  s_mov_b32 s49, 1
  s_cmp_ge_u32 s61, s49
  s_cbranch_scc1 wf_done_47
  s_mov_b32 s50, 0
wf_loop_48:
  buffer_load_dword v12, v9, s[8:11], 0 offen sc1
  s_add_u32 s50, s50, 1
  s_cmp_gt_u32 s50, 131072
  s_cbranch_scc1 L_fail
  s_waitcnt vmcnt(0)
  v_min_u32_dpp v12, v12, v12 row_ror:8 row_mask:0xf bank_mask:0xf
  s_nop 1
  v_min_u32_dpp v12, v12, v12 row_ror:4 row_mask:0xf bank_mask:0xf
  s_nop 1
  v_min_u32_dpp v12, v12, v12 row_ror:2 row_mask:0xf bank_mask:0xf
  s_nop 1
  v_min_u32_dpp v12, v12, v12 row_ror:1 row_mask:0xf bank_mask:0xf
  v_mov_b32 v13, v12
  s_nop 1
  v_permlane16_swap_b32 v13, v12
  v_min_u32 v12, v12, v13
  v_mov_b32 v13, v12
  s_nop 1
  v_permlane32_swap_b32 v13, v12
  v_min_u32 v12, v12, v13
  s_nop 0
  v_readfirstlane_b32 s61, v12
  s_nop 0
  s_cmp_ge_u32 s61, s49
  s_cbranch_scc1 wf_done_47
  s_sleep 2
  s_branch wf_loop_48
wf_done_47:
  s_mov_b32 s47, s63
  s_lshr_b32 s46, s47, 8
  s_and_b32 s46, s46, 0x2000
  s_xor_b32 s47, s47, s46
  s_add_u32 s46, s47, 0
  buffer_load_dwordx4 a[0:3], v1, s[8:11], s46 offen offset:0 sc1
  buffer_load_dwordx4 a[4:7], v1, s[8:11], s46 offen offset:1024 sc1
  buffer_load_dwordx4 a[8:11], v1, s[8:11], s46 offen offset:2048 sc1
  buffer_load_dwordx4 a[12:15], v1, s[8:11], s46 offen offset:3072 sc1
  s_add_u32 s46, s47, 4096
  buffer_load_dwordx4 a[16:19], v1, s[8:11], s46 offen offset:0 sc1
  buffer_load_dwordx4 a[20:23], v1, s[8:11], s46 offen offset:1024 sc1
  buffer_load_dwordx4 a[24:27], v1, s[8:11], s46 offen offset:2048 sc1
  buffer_load_dwordx4 a[28:31], v1, s[8:11], s46 offen offset:3072 sc1
  s_add_u32 s46, s47, 16384
  buffer_load_dwordx4 a[32:35], v1, s[8:11], s46 offen offset:0 sc1
  buffer_load_dwordx4 a[36:39], v1, s[8:11], s46 offen offset:1024 sc1
  buffer_load_dwordx4 a[40:43], v1, s[8:11], s46 offen offset:2048 sc1
  buffer_load_dwordx4 a[44:47], v1, s[8:11], s46 offen offset:3072 sc1
  s_add_u32 s46, s47, 20480
  buffer_load_dwordx4 a[48:51], v1, s[8:11], s46 offen offset:0 sc1
  buffer_load_dwordx4 a[52:55], v1, s[8:11], s46 offen offset:1024 sc1
  buffer_load_dwordx4 a[56:59], v1, s[8:11], s46 offen offset:2048 sc1
  buffer_load_dwordx4 a[60:63], v1, s[8:11], s46 offen offset:3072 sc1
  s_add_u32 s46, s47, 32768
  buffer_load_dwordx4 a[64:67], v1, s[8:11], s46 offen offset:0 sc1
  buffer_load_dwordx4 a[68:71], v1, s[8:11], s46 offen offset:1024 sc1
  buffer_load_dwordx4 a[72:75], v1, s[8:11], s46 offen offset:2048 sc1
  buffer_load_dwordx4 a[76:79], v1, s[8:11], s46 offen offset:3072 sc1
  s_add_u32 s46, s47, 36864
  buffer_load_dwordx4 a[80:83], v1, s[8:11], s46 offen offset:0 sc1
  buffer_load_dwordx4 a[84:87], v1, s[8:11], s46 offen offset:1024 sc1
  buffer_load_dwordx4 a[88:91], v1, s[8:11], s46 offen offset:2048 sc1
  buffer_load_dwordx4 a[92:95], v1, s[8:11], s46 offen offset:3072 sc1
  s_add_u32 s46, s47, 49152
  buffer_load_dwordx4 a[96:99], v1, s[8:11], s46 offen offset:0 sc1
  buffer_load_dwordx4 a[100:103], v1, s[8:11], s46 offen offset:1024 sc1
  buffer_load_dwordx4 a[104:107], v1, s[8:11], s46 offen offset:2048 sc1
  buffer_load_dwordx4 a[108:111], v1, s[8:11], s46 offen offset:3072 sc1
  s_add_u32 s46, s47, 53248
  buffer_load_dwordx4 a[112:115], v1, s[8:11], s46 offen offset:0 sc1
  buffer_load_dwordx4 a[116:119], v1, s[8:11], s46 offen offset:1024 sc1
  buffer_load_dwordx4 a[120:123], v1, s[8:11], s46 offen offset:2048 sc1
  buffer_load_dwordx4 a[124:127], v1, s[8:11], s46 offen offset:3072 sc1
  s_add_u32 s63, s63, 2621440
  s_cmp_ge_u32 s63, 165675008
  s_cselect_b32 s46, 83886080, 0
  s_sub_u32 s63, s63, s46
ow_loop:
  s_add_u32 s53, s52, 1
  s_lshl_b32 s56, s58, 2
  s_add_u32 s56, s56, s43
  s_lshl_b32 s56, s56, 16
  s_add_u32 s56, s56, s3
  s_add_u32 s56, s56, 12582912
  s_add_u32 s66, s58, 1
  s_cmp_eq_u32 s66, 3
  s_cselect_b32 s66, 0, s66
  s_lshl_b32 s72, s54, 21
  s_mul_i32 s46, s58, 655360
  s_add_u32 s72, s72, s46
  s_add_u32 s72, s72, s3
  s_add_u32 s72, s72, 4194304
  s_lshr_b32 s46, s72, 8
  s_and_b32 s46, s46, 0x2000
  s_xor_b32 s72, s72, s46
  s_lshl_b32 s46, s62, 14
  s_add_u32 s72, s72, s46
  s_add_u32 s73, s72, 4096
  s_and_b32 s46, s43, 3
  s_lshl_b32 s46, s46, 16
  s_sub_u32 s56, s56, s46
  s_add_u32 s74, s56, 16384
  s_add_u32 s75, s56, 20480
  s_add_u32 s76, s56, 32768
  s_add_u32 s77, s56, 36864
  s_add_u32 s78, s56, 51200
  s_lshl_b32 s80, s66, 18
  s_add_u32 s81, s80, 65536
  s_add_u32 s82, s80, 131072
  s_add_u32 s83, s80, 196608
  s_add_u32 s64, s52, 2
  v_mov_b32 v16, s64
  s_mov_b64 s[16:17], -1
  s_mov_b32 s71, 0
  v_mov_b32 v20, 0
  v_mov_b32 v21, 0
  v_mov_b32 v22, 0
  v_mov_b32 v23, 0
  s_add_u32 s49, s52, 4
  s_min_u32 s49, s49, 64
  s_cmp_ge_u32 s61, s49
  s_cbranch_scc1 ow_norf
  buffer_load_dword v12, v9, s[8:11], 0 offen sc1
  s_waitcnt vmcnt(0)
  v_min_u32_dpp v12, v12, v12 row_ror:8 row_mask:0xf bank_mask:0xf
  s_nop 1
  v_min_u32_dpp v12, v12, v12 row_ror:4 row_mask:0xf bank_mask:0xf
  s_nop 1
  v_min_u32_dpp v12, v12, v12 row_ror:2 row_mask:0xf bank_mask:0xf
  s_nop 1
  v_min_u32_dpp v12, v12, v12 row_ror:1 row_mask:0xf bank_mask:0xf
  v_mov_b32 v13, v12
  s_nop 1
  v_permlane16_swap_b32 v13, v12
  v_min_u32 v12, v12, v13
  v_mov_b32 v13, v12
  s_nop 1
  v_permlane32_swap_b32 v13, v12
  v_min_u32 v12, v12, v13
  s_nop 0
  v_readfirstlane_b32 s61, v12
ow_norf:
  s_waitcnt vmcnt(0)
  s_barrier
  buffer_load_dwordx4 v[24:27], v1, s[8:11], s72 offen offset:0 sc1
  buffer_load_dwordx4 v[28:31], v1, s[8:11], s72 offen offset:1024 sc1
  buffer_load_dwordx4 v[32:35], v1, s[8:11], s72 offen offset:2048 sc1
  buffer_load_dwordx4 v[36:39], v1, s[8:11], s72 offen offset:3072 sc1
  buffer_load_dwordx4 v[40:43], v1, s[8:11], s73 offen offset:0 sc1
  buffer_load_dwordx4 v[44:47], v1, s[8:11], s73 offen offset:1024 sc1
  buffer_load_dwordx4 v[48:51], v1, s[8:11], s73 offen offset:2048 sc1
  buffer_load_dwordx4 v[52:55], v1, s[8:11], s73 offen offset:3072 sc1
  buffer_load_dwordx2 v[56:57], v2, s[8:11], s78 offen offset:0 sc1
  buffer_load_dwordx2 v[58:59], v2, s[8:11], s78 offen offset:128 sc1
  buffer_load_dwordx2 v[60:61], v2, s[8:11], s78 offen offset:1024 sc1
  buffer_load_dwordx2 v[62:63], v2, s[8:11], s78 offen offset:1152 sc1
  buffer_load_dwordx2 v[64:65], v2, s[8:11], s78 offen offset:2048 sc1
  buffer_load_dwordx2 v[66:67], v2, s[8:11], s78 offen offset:2176 sc1
  buffer_load_dwordx2 v[68:69], v2, s[8:11], s78 offen offset:3072 sc1
  buffer_load_dwordx2 v[70:71], v2, s[8:11], s78 offen offset:3200 sc1
  buffer_load_dwordx4 v[72:75], v1, s[8:11], s74 offen offset:0 sc1
  buffer_load_dwordx4 v[76:79], v1, s[8:11], s74 offen offset:1024 sc1
  buffer_load_dwordx4 v[80:83], v1, s[8:11], s74 offen offset:2048 sc1
  buffer_load_dwordx4 v[84:87], v1, s[8:11], s74 offen offset:3072 sc1
  buffer_load_dwordx4 v[88:91], v1, s[8:11], s75 offen offset:0 sc1
  buffer_load_dwordx4 v[92:95], v1, s[8:11], s75 offen offset:1024 sc1
  buffer_load_dwordx4 v[96:99], v1, s[8:11], s75 offen offset:2048 sc1
  buffer_load_dwordx4 v[100:103], v1, s[8:11], s75 offen offset:3072 sc1
  buffer_load_dwordx4 v[104:107], v1, s[8:11], s76 offen offset:0 sc1
  buffer_load_dwordx4 v[108:111], v1, s[8:11], s76 offen offset:1024 sc1
  buffer_load_dwordx4 v[112:115], v1, s[8:11], s76 offen offset:2048 sc1
  buffer_load_dwordx4 v[116:119], v1, s[8:11], s76 offen offset:3072 sc1
  buffer_load_dwordx4 v[120:123], v1, s[8:11], s77 offen offset:0 sc1
  buffer_load_dwordx4 v[124:127], v1, s[8:11], s77 offen offset:1024 sc1
  buffer_load_dwordx4 v[128:131], v1, s[8:11], s77 offen offset:2048 sc1
  buffer_load_dwordx4 v[132:135], v1, s[8:11], s77 offen offset:3072 sc1
ow_go:
  s_waitcnt vmcnt(22)
  v_smfmac_f32_16x16x64_bf16 v[20:23], v[56:59], v[24:31], v5
  s_waitcnt vmcnt(20)
  v_smfmac_f32_16x16x64_bf16 v[20:23], v[60:63], v[32:39], v5
  s_waitcnt vmcnt(18)
  v_smfmac_f32_16x16x64_bf16 v[20:23], v[64:67], v[40:47], v5
  s_waitcnt vmcnt(16)
  v_smfmac_f32_16x16x64_bf16 v[20:23], v[68:71], v[48:55], v5
  s_waitcnt vmcnt(15)
  v_smfmac_f32_16x16x64_bf16 v[20:23], v[72:75], a[0:7], v5
  s_waitcnt vmcnt(14)
  v_smfmac_f32_16x16x64_bf16 v[20:23], v[76:79], a[8:15], v5
  buffer_store_dword v16, v7, s[8:11], 0 offen sc1
  s_waitcnt vmcnt(14)
  v_smfmac_f32_16x16x64_bf16 v[20:23], v[80:83], a[16:23], v5
  s_waitcnt vmcnt(13)
  v_smfmac_f32_16x16x64_bf16 v[20:23], v[84:87], a[24:31], v5
  s_waitcnt vmcnt(12)
  v_smfmac_f32_16x16x64_bf16 v[20:23], v[88:91], a[32:39], v5
  s_waitcnt vmcnt(11)
  v_smfmac_f32_16x16x64_bf16 v[20:23], v[92:95], a[40:47], v5
  s_waitcnt vmcnt(10)
  v_smfmac_f32_16x16x64_bf16 v[20:23], v[96:99], a[48:55], v5
  s_waitcnt vmcnt(9)
  v_smfmac_f32_16x16x64_bf16 v[20:23], v[100:103], a[56:63], v5
  s_waitcnt vmcnt(8)
  v_smfmac_f32_16x16x64_bf16 v[20:23], v[104:107], a[64:71], v5
  s_waitcnt vmcnt(7)
  v_smfmac_f32_16x16x64_bf16 v[20:23], v[108:111], a[72:79], v5
  s_waitcnt vmcnt(6)
  v_smfmac_f32_16x16x64_bf16 v[20:23], v[112:115], a[80:87], v5
  s_waitcnt vmcnt(5)
  v_smfmac_f32_16x16x64_bf16 v[20:23], v[116:119], a[88:95], v5
  s_waitcnt vmcnt(4)
  v_smfmac_f32_16x16x64_bf16 v[20:23], v[120:123], a[96:103], v5
  s_waitcnt vmcnt(3)
  v_smfmac_f32_16x16x64_bf16 v[20:23], v[124:127], a[104:111], v5
  s_waitcnt vmcnt(2)
  v_smfmac_f32_16x16x64_bf16 v[20:23], v[128:131], a[112:119], v5
  s_waitcnt vmcnt(1)
  v_smfmac_f32_16x16x64_bf16 v[20:23], v[132:135], a[120:127], v5
  s_nop 7
  v_add_f32 v20, v20, v22
  v_add_f32 v21, v21, v23
  v_cvt_pk_bf16_f32 v10, v20, v21
  v_cmp_u_f32 vcc, v20, v21
  s_nop 0
  v_mov_b32_dpp v11, v10 quad_perm:[1,0,3,2] row_mask:0xf bank_mask:0xf
  v_perm_b32 v10, v11, v10, v4
  s_and_b64 vcc, vcc, s[16:17]
  s_cbranch_scc1 ow_redo
  buffer_store_dword v10, v3, s[8:11], s80 offen sc1
  buffer_store_dword v10, v3, s[8:11], s81 offen sc1
  buffer_store_dword v10, v3, s[8:11], s82 offen sc1
  buffer_store_dword v10, v3, s[8:11], s83 offen sc1
  s_barrier
  s_add_u32 s49, s52, 2
  v_mov_b32 v11, -1
  s_lshl_b32 s47, s58, 18
  s_add_u32 s46, s47, 0
  buffer_store_dword v11, v3, s[8:11], s46 offen sc1
  s_add_u32 s46, s47, 65536
  buffer_store_dword v11, v3, s[8:11], s46 offen sc1
  s_add_u32 s46, s47, 131072
  buffer_store_dword v11, v3, s[8:11], s46 offen sc1
  s_add_u32 s46, s47, 196608
  buffer_store_dword v11, v3, s[8:11], s46 offen sc1
  s_waitcnt vmcnt(0)
  s_cmp_ge_u32 s61, s49
  s_cbranch_scc1 wf_done_49
  s_mov_b32 s50, 0
wf_loop_50:
  buffer_load_dword v12, v9, s[8:11], 0 offen sc1
  s_add_u32 s50, s50, 1
  s_cmp_gt_u32 s50, 131072
  s_cbranch_scc1 L_fail
  s_waitcnt vmcnt(0)
  v_min_u32_dpp v12, v12, v12 row_ror:8 row_mask:0xf bank_mask:0xf
  s_nop 1
  v_min_u32_dpp v12, v12, v12 row_ror:4 row_mask:0xf bank_mask:0xf
  s_nop 1
  v_min_u32_dpp v12, v12, v12 row_ror:2 row_mask:0xf bank_mask:0xf
  s_nop 1
  v_min_u32_dpp v12, v12, v12 row_ror:1 row_mask:0xf bank_mask:0xf
  v_mov_b32 v13, v12
  s_nop 1
  v_permlane16_swap_b32 v13, v12
  v_min_u32 v12, v12, v13
  v_mov_b32 v13, v12
  s_nop 1
  v_permlane32_swap_b32 v13, v12
  v_min_u32 v12, v12, v13
  s_nop 0
  v_readfirstlane_b32 s61, v12
  s_nop 0
  s_cmp_ge_u32 s61, s49
  s_cbranch_scc1 wf_done_49
  s_sleep 2
  s_branch wf_loop_50
wf_done_49:
  s_mov_b32 s47, s63
  s_lshr_b32 s46, s47, 8
  s_and_b32 s46, s46, 0x2000
  s_xor_b32 s47, s47, s46
  s_add_u32 s46, s47, 0
  buffer_load_dwordx4 a[0:3], v1, s[8:11], s46 offen offset:0 sc1
  buffer_load_dwordx4 a[4:7], v1, s[8:11], s46 offen offset:1024 sc1
  buffer_load_dwordx4 a[8:11], v1, s[8:11], s46 offen offset:2048 sc1
  buffer_load_dwordx4 a[12:15], v1, s[8:11], s46 offen offset:3072 sc1
  s_add_u32 s46, s47, 4096
  buffer_load_dwordx4 a[16:19], v1, s[8:11], s46 offen offset:0 sc1
  buffer_load_dwordx4 a[20:23], v1, s[8:11], s46 offen offset:1024 sc1
  buffer_load_dwordx4 a[24:27], v1, s[8:11], s46 offen offset:2048 sc1
  buffer_load_dwordx4 a[28:31], v1, s[8:11], s46 offen offset:3072 sc1
  s_add_u32 s46, s47, 16384
  buffer_load_dwordx4 a[32:35], v1, s[8:11], s46 offen offset:0 sc1
  buffer_load_dwordx4 a[36:39], v1, s[8:11], s46 offen offset:1024 sc1
  buffer_load_dwordx4 a[40:43], v1, s[8:11], s46 offen offset:2048 sc1
  buffer_load_dwordx4 a[44:47], v1, s[8:11], s46 offen offset:3072 sc1
  s_add_u32 s46, s47, 20480
  buffer_load_dwordx4 a[48:51], v1, s[8:11], s46 offen offset:0 sc1
  buffer_load_dwordx4 a[52:55], v1, s[8:11], s46 offen offset:1024 sc1
  buffer_load_dwordx4 a[56:59], v1, s[8:11], s46 offen offset:2048 sc1
  buffer_load_dwordx4 a[60:63], v1, s[8:11], s46 offen offset:3072 sc1
  s_add_u32 s46, s47, 32768
  buffer_load_dwordx4 a[64:67], v1, s[8:11], s46 offen offset:0 sc1
  buffer_load_dwordx4 a[68:71], v1, s[8:11], s46 offen offset:1024 sc1
  buffer_load_dwordx4 a[72:75], v1, s[8:11], s46 offen offset:2048 sc1
  buffer_load_dwordx4 a[76:79], v1, s[8:11], s46 offen offset:3072 sc1
  s_add_u32 s46, s47, 36864
  buffer_load_dwordx4 a[80:83], v1, s[8:11], s46 offen offset:0 sc1
  buffer_load_dwordx4 a[84:87], v1, s[8:11], s46 offen offset:1024 sc1
  buffer_load_dwordx4 a[88:91], v1, s[8:11], s46 offen offset:2048 sc1
  buffer_load_dwordx4 a[92:95], v1, s[8:11], s46 offen offset:3072 sc1
  s_add_u32 s46, s47, 49152
  buffer_load_dwordx4 a[96:99], v1, s[8:11], s46 offen offset:0 sc1
  buffer_load_dwordx4 a[100:103], v1, s[8:11], s46 offen offset:1024 sc1
  buffer_load_dwordx4 a[104:107], v1, s[8:11], s46 offen offset:2048 sc1
  buffer_load_dwordx4 a[108:111], v1, s[8:11], s46 offen offset:3072 sc1
  s_add_u32 s46, s47, 53248
  buffer_load_dwordx4 a[112:115], v1, s[8:11], s46 offen offset:0 sc1
  buffer_load_dwordx4 a[116:119], v1, s[8:11], s46 offen offset:1024 sc1
  buffer_load_dwordx4 a[120:123], v1, s[8:11], s46 offen offset:2048 sc1
  buffer_load_dwordx4 a[124:127], v1, s[8:11], s46 offen offset:3072 sc1
  s_add_u32 s63, s63, 2621440
  s_cmp_ge_u32 s63, 165675008
  s_cselect_b32 s46, 83886080, 0
  s_sub_u32 s63, s63, s46
  s_mov_b32 s58, s66
  s_cmp_eq_u32 s58, 0
  s_addc_u32 s54, s54, 0
  s_cmp_eq_u32 s54, 3
  s_cselect_b32 s54, 0, s54
  s_mov_b32 s52, s53
  s_cmp_lt_u32 s52, 63
  s_cbranch_scc1 ow_loop
  s_endpgm
ow_redo:
  s_mov_b32 s50, 0
ow_poll:
  buffer_load_dwordx4 v[24:27], v1, s[8:11], s72 offen offset:0 sc1
  buffer_load_dwordx4 v[28:31], v1, s[8:11], s72 offen offset:1024 sc1
  buffer_load_dwordx4 v[32:35], v1, s[8:11], s72 offen offset:2048 sc1
  buffer_load_dwordx4 v[36:39], v1, s[8:11], s72 offen offset:3072 sc1
  buffer_load_dwordx4 v[40:43], v1, s[8:11], s73 offen offset:0 sc1
  buffer_load_dwordx4 v[44:47], v1, s[8:11], s73 offen offset:1024 sc1
  buffer_load_dwordx4 v[48:51], v1, s[8:11], s73 offen offset:2048 sc1
  buffer_load_dwordx4 v[52:55], v1, s[8:11], s73 offen offset:3072 sc1
  buffer_load_dwordx2 v[56:57], v2, s[8:11], s78 offen offset:0 sc1
  buffer_load_dwordx2 v[58:59], v2, s[8:11], s78 offen offset:128 sc1
  buffer_load_dwordx2 v[60:61], v2, s[8:11], s78 offen offset:1024 sc1
  buffer_load_dwordx2 v[62:63], v2, s[8:11], s78 offen offset:1152 sc1
  buffer_load_dwordx2 v[64:65], v2, s[8:11], s78 offen offset:2048 sc1
  buffer_load_dwordx2 v[66:67], v2, s[8:11], s78 offen offset:2176 sc1
  buffer_load_dwordx2 v[68:69], v2, s[8:11], s78 offen offset:3072 sc1
  buffer_load_dwordx2 v[70:71], v2, s[8:11], s78 offen offset:3200 sc1
  buffer_load_dwordx4 v[72:75], v1, s[8:11], s74 offen offset:0 sc1
  buffer_load_dwordx4 v[76:79], v1, s[8:11], s74 offen offset:1024 sc1
  buffer_load_dwordx4 v[80:83], v1, s[8:11], s74 offen offset:2048 sc1
  buffer_load_dwordx4 v[84:87], v1, s[8:11], s74 offen offset:3072 sc1
  buffer_load_dwordx4 v[88:91], v1, s[8:11], s75 offen offset:0 sc1
  buffer_load_dwordx4 v[92:95], v1, s[8:11], s75 offen offset:1024 sc1
  buffer_load_dwordx4 v[96:99], v1, s[8:11], s75 offen offset:2048 sc1
  buffer_load_dwordx4 v[100:103], v1, s[8:11], s75 offen offset:3072 sc1
  buffer_load_dwordx4 v[104:107], v1, s[8:11], s76 offen offset:0 sc1
  buffer_load_dwordx4 v[108:111], v1, s[8:11], s76 offen offset:1024 sc1
  buffer_load_dwordx4 v[112:115], v1, s[8:11], s76 offen offset:2048 sc1
  buffer_load_dwordx4 v[116:119], v1, s[8:11], s76 offen offset:3072 sc1
  buffer_load_dwordx4 v[120:123], v1, s[8:11], s77 offen offset:0 sc1
  buffer_load_dwordx4 v[124:127], v1, s[8:11], s77 offen offset:1024 sc1
  buffer_load_dwordx4 v[128:131], v1, s[8:11], s77 offen offset:2048 sc1
  buffer_load_dwordx4 v[132:135], v1, s[8:11], s77 offen offset:3072 sc1
  s_add_u32 s71, s71, 1
  s_cmp_le_u32 s71, 2
  s_cbranch_scc1 ow_again
  s_add_u32 s50, s50, 1
  s_cmp_gt_u32 s50, 131072
  s_cbranch_scc1 L_fail
  s_waitcnt vmcnt(0)
  v_max_u32 v8, v24, v25
  v_max3_u32 v8, v26, v27, v8
  v_max3_u32 v8, v28, v29, v8
  v_max3_u32 v8, v30, v31, v8
  v_max3_u32 v8, v32, v33, v8
  v_max3_u32 v8, v34, v35, v8
  v_max3_u32 v8, v36, v37, v8
  v_max3_u32 v8, v38, v39, v8
  v_max3_u32 v8, v40, v41, v8
  v_max3_u32 v8, v42, v43, v8
  v_max3_u32 v8, v44, v45, v8
  v_max3_u32 v8, v46, v47, v8
  v_max3_u32 v8, v48, v49, v8
  v_max3_u32 v8, v50, v51, v8
  v_max3_u32 v8, v52, v53, v8
  v_max3_u32 v8, v54, v55, v8
  v_max3_u32 v8, v56, v57, v8
  v_max3_u32 v8, v58, v59, v8
  v_max3_u32 v8, v60, v61, v8
  v_max3_u32 v8, v62, v63, v8
  v_max3_u32 v8, v64, v65, v8
  v_max3_u32 v8, v66, v67, v8
  v_max3_u32 v8, v68, v69, v8
  v_max3_u32 v8, v70, v71, v8
  v_max3_u32 v8, v72, v73, v8
  v_max3_u32 v8, v74, v75, v8
  v_max3_u32 v8, v76, v77, v8
  v_max3_u32 v8, v78, v79, v8
  v_max3_u32 v8, v80, v81, v8
  v_max3_u32 v8, v82, v83, v8
  v_max3_u32 v8, v84, v85, v8
  v_max3_u32 v8, v86, v87, v8
  v_max3_u32 v8, v88, v89, v8
  v_max3_u32 v8, v90, v91, v8
  v_max3_u32 v8, v92, v93, v8
  v_max3_u32 v8, v94, v95, v8
  v_max3_u32 v8, v96, v97, v8
  v_max3_u32 v8, v98, v99, v8
  v_max3_u32 v8, v100, v101, v8
  v_max3_u32 v8, v102, v103, v8
  v_max3_u32 v8, v104, v105, v8
  v_max3_u32 v8, v106, v107, v8
  v_max3_u32 v8, v108, v109, v8
  v_max3_u32 v8, v110, v111, v8
  v_max3_u32 v8, v112, v113, v8
  v_max3_u32 v8, v114, v115, v8
  v_max3_u32 v8, v116, v117, v8
  v_max3_u32 v8, v118, v119, v8
  v_max3_u32 v8, v120, v121, v8
  v_max3_u32 v8, v122, v123, v8
  v_max3_u32 v8, v124, v125, v8
  v_max3_u32 v8, v126, v127, v8
  v_max3_u32 v8, v128, v129, v8
  v_max3_u32 v8, v130, v131, v8
  v_max3_u32 v8, v132, v133, v8
  v_max3_u32 v8, v134, v135, v8
  v_cmp_eq_u32 vcc, -1, v8
  s_cbranch_vccnz ow_poll
  s_mov_b64 s[16:17], 0
ow_again:
  v_mov_b32 v20, 0
  v_mov_b32 v21, 0
  v_mov_b32 v22, 0
  v_mov_b32 v23, 0
  s_branch ow_go
L_xowner:
  s_mov_b32 s4, s16
  s_mov_b32 s5, s17
  s_mov_b32 s6, 2621440
  s_mov_b32 s7, 0x20000
  s_mov_b32 s12, s36
  s_mov_b32 s13, s37
  s_mov_b32 s14, 5242880
  s_mov_b32 s15, 0x20000
  s_cmp_lg_u32 s42, 0
  s_cbranch_scc1 pr_skip
  s_cmp_ge_u32 s44, 28
  s_cbranch_scc1 pr_skip
  s_lshl_b32 s62, s43, 14
  s_and_b32 s46, s44, 1
  s_lshl_b32 s46, s46, 12
  s_add_u32 s62, s62, s46
  s_add_u32 s62, s62, 6160384
  s_add_u32 s65, s62, 8192
  v_lshlrev_b32 v1, 2, v0
  s_mov_b32 s63, -1
  s_mov_b32 s64, -1
  s_memtime s[72:73]
  s_waitcnt lgkmcnt(0)
  buffer_store_dword v1, v1, s[8:11], s62 offen sc1
  s_waitcnt vmcnt(0)
  s_memtime s[74:75]
  s_waitcnt lgkmcnt(0)
  s_sub_u32 s46, s74, s72
  s_min_u32 s63, s63, s46
  s_memtime s[72:73]
  s_waitcnt lgkmcnt(0)
  buffer_store_dword v1, v1, s[8:11], s65 offen sc1
  s_waitcnt vmcnt(0)
  s_memtime s[74:75]
  s_waitcnt lgkmcnt(0)
  s_sub_u32 s46, s74, s72
  s_min_u32 s64, s64, s46
  s_memtime s[72:73]
  s_waitcnt lgkmcnt(0)
  buffer_store_dword v1, v1, s[8:11], s62 offen sc1
  s_waitcnt vmcnt(0)
  s_memtime s[74:75]
  s_waitcnt lgkmcnt(0)
  s_sub_u32 s46, s74, s72
  s_min_u32 s63, s63, s46
  s_memtime s[72:73]
  s_waitcnt lgkmcnt(0)
  buffer_store_dword v1, v1, s[8:11], s65 offen sc1
  s_waitcnt vmcnt(0)
  s_memtime s[74:75]
  s_waitcnt lgkmcnt(0)
  s_sub_u32 s46, s74, s72
  s_min_u32 s64, s64, s46
  s_memtime s[72:73]
  s_waitcnt lgkmcnt(0)
  buffer_store_dword v1, v1, s[8:11], s62 offen sc1
  s_waitcnt vmcnt(0)
  s_memtime s[74:75]
  s_waitcnt lgkmcnt(0)
  s_sub_u32 s46, s74, s72
  s_min_u32 s63, s63, s46
  s_memtime s[72:73]
  s_waitcnt lgkmcnt(0)
  buffer_store_dword v1, v1, s[8:11], s65 offen sc1
  s_waitcnt vmcnt(0)
  s_memtime s[74:75]
  s_waitcnt lgkmcnt(0)
  s_sub_u32 s46, s74, s72
  s_min_u32 s64, s64, s46
  s_memtime s[72:73]
  s_waitcnt lgkmcnt(0)
  buffer_store_dword v1, v1, s[8:11], s62 offen sc1
  s_waitcnt vmcnt(0)
  s_memtime s[74:75]
  s_waitcnt lgkmcnt(0)
  s_sub_u32 s46, s74, s72
  s_min_u32 s63, s63, s46
  s_memtime s[72:73]
  s_waitcnt lgkmcnt(0)
  buffer_store_dword v1, v1, s[8:11], s65 offen sc1
  s_waitcnt vmcnt(0)
  s_memtime s[74:75]
  s_waitcnt lgkmcnt(0)
  s_sub_u32 s46, s74, s72
  s_min_u32 s64, s64, s46
  s_not_b32 s63, s63
  s_not_b32 s64, s64
  v_mov_b32 v2, s63
  v_writelane_b32 v2, s64, 1
  v_mov_b32 v3, 1
  s_mov_b64 exec, 3
  global_atomic_umax v1, v2, s[38:39] offset:128 sc1
  s_waitcnt vmcnt(0)
  s_mov_b64 exec, 1
  global_atomic_add v2, v1, v3, s[38:39] offset:136 sc0 sc1
  s_waitcnt vmcnt(0)
  v_readfirstlane_b32 s46, v2
  s_mov_b64 exec, 3
  s_cmp_lg_u32 s46, 7
  s_cbranch_scc1 pr_done
  global_atomic_umax v2, v1, v3, s[38:39] offset:128 sc0 sc1
  s_waitcnt vmcnt(0)
  v_readlane_b32 s46, v2, 0
  v_readlane_b32 s47, v2, 1
  s_nop 0
  s_cmp_gt_u32 s47, s46
  s_cselect_b32 s46, 0x2001, 1
  v_mov_b32 v2, s46
  s_mov_b64 exec, 1
  global_store_dword v1, v2, s[38:39] offset:4 sc1
pr_done:
  s_mov_b64 exec, -1
pr_skip:
  s_barrier
  v_and_b32 v11, 3, v0
  v_lshlrev_b32 v11, 2, v11
  s_mov_b32 s50, 0
ss_51:
  global_load_dword v10, v11, s[38:39] sc1
  s_add_u32 s50, s50, 1
  s_cmp_gt_u32 s50, 131072
  s_cbranch_scc1 L_fail
  s_waitcnt vmcnt(0)
  v_readlane_b32 s46, v10, 0
  v_readlane_b32 s47, v10, 1
  s_cmp_lg_u32 s46, 0
  s_cselect_b32 s48, 7, 0
  s_add_u32 s46, s46, s2
  s_xor_b32 s49, s46, s43
  s_and_b32 s49, s49, s48
  s_cbranch_scc1 L_reroll
  s_cmp_lg_u32 s47, 0
  s_cbranch_scc1 ss_ok_52
  s_sleep 10
  s_branch ss_51
ss_ok_52:
  v_readlane_b32 s3, v10, 1
  s_nop 0
  s_and_b32 s3, s3, 0x2000
  s_lshl_b32 s46, s43, 7
  s_add_u32 s46, s46, s3
  s_add_u32 s46, s46, 13373440
  v_mov_b32 v14, s46
  s_sub_u32 s48, s44, 26
  s_and_b32 s46, s48, 1
  s_mul_i32 s46, s46, 5
  s_mul_i32 s62, s43, 10
  s_add_u32 s62, s62, s46
  s_lshr_b32 s52, s48, 1
  v_lshlrev_b32 v1, 4, v0
  v_and_b32 v10, 7, v0
  v_lshlrev_b32 v10, 7, v10
  v_add_u32 v10, s51, v10
  v_bfe_u32 v11, v0, 3, 2
  v_lshl_add_u32 v2, v11, 2, v10
  v_add_u32 v3, 1064960, v2
  v_add_u32 v2, 1060864, v2
  v_bfe_u32 v11, v0, 3, 1
  v_lshl_add_u32 v4, v11, 2, v10
  v_add_u32 v4, 1069056, v4
  v_cmp_lt_u32 vcc, 31, v0
  s_nop 1
  v_cndmask_b32 v3, v3, v4, vcc
  s_mul_i32 s46, s43, 6
  s_add_u32 s46, s46, s48
  s_lshl_b32 s46, s46, 7
  s_add_u32 s46, s46, 1073152
  v_mov_b32 v15, s46
  v_mov_b32 v11, 2146435072
  s_cmp_eq_u32 s42, 0
  s_cselect_b64 vcc, 1, 0
  v_cndmask_b32 v15, v11, v15, vcc
  s_mul_i32 s46, s42, 10240
  v_add_u32 v5, s46, v1
  v_add_u32 v6, s51, v1
  s_mul_i32 s63, s52, 40
  s_add_u32 s63, s63, s62
  s_lshl_b32 s63, s63, 16
  s_lshl_b32 s46, s42, 14
  s_add_u32 s63, s63, s46
  s_add_u32 s63, s63, s3
  s_add_u32 s63, s63, 81788928
  s_lshl_b32 s65, s52, 18
  s_add_u32 s65, s65, s3
  s_add_u32 s65, s65, 14680064
  s_lshl_b32 s67, s62, 14
  s_lshl_b32 s46, s42, 11
  s_add_u32 s67, s67, s46
  s_mov_b32 s58, s52
  s_mul_i32 s66, s52, 81920
  v_and_b32 v10, 15, v0
  v_mul_u32_u24 v10, 2560, v10
  v_lshrrev_b32 v11, 4, v0
  v_lshl_add_u32 v10, v11, 3, v10
  s_add_u32 s46, s42, 0
  s_cmp_ge_u32 s46, 5
  s_cselect_b32 s47, 40800, 0
  s_add_u32 s48, s46, s62
  s_lshl_b32 s48, s48, 5
  s_add_u32 s47, s47, s48
  s_add_u32 s47, s47, 1280
  s_cmp_ge_u32 s46, 10
  s_cselect_b32 s47, 2146435072, s47
  v_add_u32 v7, s47, v10
  s_add_u32 s46, s42, 4
  s_cmp_ge_u32 s46, 5
  s_cselect_b32 s47, 40800, 0
  s_add_u32 s48, s46, s62
  s_lshl_b32 s48, s48, 5
  s_add_u32 s47, s47, s48
  s_add_u32 s47, s47, 1280
  s_cmp_ge_u32 s46, 10
  s_cselect_b32 s47, 2146435072, s47
  v_add_u32 v8, s47, v10
  s_add_u32 s46, s42, 8
  s_cmp_ge_u32 s46, 5
  s_cselect_b32 s47, 40800, 0
  s_add_u32 s48, s46, s62
  s_lshl_b32 s48, s48, 5
  s_add_u32 s47, s47, s48
  s_add_u32 s47, s47, 1280
  s_cmp_ge_u32 s46, 10
  s_cselect_b32 s47, 2146435072, s47
  v_add_u32 v9, s47, v10
  v_mov_b32 v224, -1
  v_mov_b32 v225, -1
  v_mov_b32 v226, -1
  v_mov_b32 v227, -1
  s_mov_b32 s54, 0
  s_lshl_b32 s64, s54, 21
  s_mul_i32 s46, s58, 655360
  s_add_u32 s64, s64, s46
  s_add_u32 s64, s64, s3
  s_add_u32 s64, s64, 4194304
  s_lshr_b32 s46, s64, 8
  s_and_b32 s46, s46, 0x2000
  s_xor_b32 s64, s64, s46
  s_add_u32 s64, s64, s67
  s_add_u32 s46, s64, 0
  buffer_store_dwordx4 v[224:227], v1, s[8:11], s46 offen offset:0 sc1
  buffer_store_dwordx4 v[224:227], v1, s[8:11], s46 offen offset:1024 sc1
  s_add_u32 s46, s64, 16384
  buffer_store_dwordx4 v[224:227], v1, s[8:11], s46 offen offset:0 sc1
  buffer_store_dwordx4 v[224:227], v1, s[8:11], s46 offen offset:1024 sc1
  s_add_u32 s46, s64, 32768
  buffer_store_dwordx4 v[224:227], v1, s[8:11], s46 offen offset:0 sc1
  buffer_store_dwordx4 v[224:227], v1, s[8:11], s46 offen offset:1024 sc1
  s_add_u32 s46, s64, 49152
  buffer_store_dwordx4 v[224:227], v1, s[8:11], s46 offen offset:0 sc1
  buffer_store_dwordx4 v[224:227], v1, s[8:11], s46 offen offset:1024 sc1
  s_add_u32 s46, s64, 65536
  buffer_store_dwordx4 v[224:227], v1, s[8:11], s46 offen offset:0 sc1
  buffer_store_dwordx4 v[224:227], v1, s[8:11], s46 offen offset:1024 sc1
  s_mov_b32 s54, 1
  s_lshl_b32 s64, s54, 21
  s_mul_i32 s46, s58, 655360
  s_add_u32 s64, s64, s46
  s_add_u32 s64, s64, s3
  s_add_u32 s64, s64, 4194304
  s_lshr_b32 s46, s64, 8
  s_and_b32 s46, s46, 0x2000
  s_xor_b32 s64, s64, s46
  s_add_u32 s64, s64, s67
  s_add_u32 s46, s64, 0
  buffer_store_dwordx4 v[224:227], v1, s[8:11], s46 offen offset:0 sc1
  buffer_store_dwordx4 v[224:227], v1, s[8:11], s46 offen offset:1024 sc1
  s_add_u32 s46, s64, 16384
  buffer_store_dwordx4 v[224:227], v1, s[8:11], s46 offen offset:0 sc1
  buffer_store_dwordx4 v[224:227], v1, s[8:11], s46 offen offset:1024 sc1
  s_add_u32 s46, s64, 32768
  buffer_store_dwordx4 v[224:227], v1, s[8:11], s46 offen offset:0 sc1
  buffer_store_dwordx4 v[224:227], v1, s[8:11], s46 offen offset:1024 sc1
  s_add_u32 s46, s64, 49152
  buffer_store_dwordx4 v[224:227], v1, s[8:11], s46 offen offset:0 sc1
  buffer_store_dwordx4 v[224:227], v1, s[8:11], s46 offen offset:1024 sc1
  s_add_u32 s46, s64, 65536
  buffer_store_dwordx4 v[224:227], v1, s[8:11], s46 offen offset:0 sc1
  buffer_store_dwordx4 v[224:227], v1, s[8:11], s46 offen offset:1024 sc1
  s_mov_b32 s54, 2
  s_lshl_b32 s64, s54, 21
  s_mul_i32 s46, s58, 655360
  s_add_u32 s64, s64, s46
  s_add_u32 s64, s64, s3
  s_add_u32 s64, s64, 4194304
  s_lshr_b32 s46, s64, 8
  s_and_b32 s46, s46, 0x2000
  s_xor_b32 s64, s64, s46
  s_add_u32 s64, s64, s67
  s_add_u32 s46, s64, 0
  buffer_store_dwordx4 v[224:227], v1, s[8:11], s46 offen offset:0 sc1
  buffer_store_dwordx4 v[224:227], v1, s[8:11], s46 offen offset:1024 sc1
  s_add_u32 s46, s64, 16384
  buffer_store_dwordx4 v[224:227], v1, s[8:11], s46 offen offset:0 sc1
  buffer_store_dwordx4 v[224:227], v1, s[8:11], s46 offen offset:1024 sc1
  s_add_u32 s46, s64, 32768
  buffer_store_dwordx4 v[224:227], v1, s[8:11], s46 offen offset:0 sc1
  buffer_store_dwordx4 v[224:227], v1, s[8:11], s46 offen offset:1024 sc1
  s_add_u32 s46, s64, 49152
  buffer_store_dwordx4 v[224:227], v1, s[8:11], s46 offen offset:0 sc1
  buffer_store_dwordx4 v[224:227], v1, s[8:11], s46 offen offset:1024 sc1
  s_add_u32 s46, s64, 65536
  buffer_store_dwordx4 v[224:227], v1, s[8:11], s46 offen offset:0 sc1
  buffer_store_dwordx4 v[224:227], v1, s[8:11], s46 offen offset:1024 sc1
  v_and_b32 v11, 3, v0
  v_lshlrev_b32 v11, 2, v11
  s_mov_b32 s50, 0
ss_53:
  global_load_dword v10, v11, s[38:39] sc1
  s_add_u32 s50, s50, 1
  s_cmp_gt_u32 s50, 131072
  s_cbranch_scc1 L_fail
  s_waitcnt vmcnt(0)
  v_readlane_b32 s46, v10, 0
  v_readlane_b32 s47, v10, 2
  s_cmp_lg_u32 s46, 0
  s_cselect_b32 s48, 7, 0
  s_add_u32 s46, s46, s2
  s_xor_b32 s49, s46, s43
  s_and_b32 s49, s49, s48
  s_cbranch_scc1 L_reroll
  s_cmp_lg_u32 s47, 0
  s_cbranch_scc1 ss_ok_54
  s_sleep 10
  s_branch ss_53
ss_ok_54:
  v_readlane_b32 s3, v10, 1
  s_nop 0
  s_and_b32 s3, s3, 0x2000
  s_add_u32 s46, s52, 7
  v_mov_b32 v10, s46
  s_waitcnt vmcnt(0)
  s_barrier
  buffer_store_dword v10, v15, s[8:11], 0 offen sc1
  s_mov_b32 s60, 0
  s_mov_b32 s61, 0
  s_mov_b32 s54, 0
  v_lshlrev_b32 v228, 7, v0
  s_mul_i32 s76, s43, 6
  s_add_u32 s76, s76, s44
  s_sub_u32 s76, s76, 26
  s_lshl_b32 s76, s76, 2
  s_add_u32 s76, s76, s42
  s_lshl_b32 s76, s76, 13
  s_mov_b32 s77, 2457600
  s_mov_b32 s78, 819200
xo_loop:
  s_add_u32 s53, s52, 1
  s_cmp_ge_u32 s60, s53
  s_cbranch_scc1 wf_done_55
  s_mov_b32 s50, 0
wf_loop_56:
  buffer_load_dword v10, v2, s[8:11], 0 offen sc1
  s_add_u32 s50, s50, 1
  s_cmp_gt_u32 s50, 131072
  s_cbranch_scc1 L_fail
  s_waitcnt vmcnt(0)
  v_min_u32_dpp v10, v10, v10 row_ror:8 row_mask:0xf bank_mask:0xf
  s_nop 1
  v_min_u32_dpp v10, v10, v10 row_ror:4 row_mask:0xf bank_mask:0xf
  s_nop 1
  v_min_u32_dpp v10, v10, v10 row_ror:2 row_mask:0xf bank_mask:0xf
  s_nop 1
  v_min_u32_dpp v10, v10, v10 row_ror:1 row_mask:0xf bank_mask:0xf
  v_mov_b32 v11, v10
  s_nop 1
  v_permlane16_swap_b32 v11, v10
  v_min_u32 v10, v10, v11
  v_mov_b32 v11, v10
  s_nop 1
  v_permlane32_swap_b32 v11, v10
  v_min_u32 v10, v10, v11
  s_nop 0
  v_readfirstlane_b32 s60, v10
  s_nop 0
  s_cmp_ge_u32 s60, s53
  s_cbranch_scc1 wf_done_55
  s_sleep 2
  s_branch wf_loop_56
wf_done_55:
  s_add_u32 s46, s63, 0
  s_lshr_b32 s47, s46, 8
  s_and_b32 s47, s47, 0x2000
  s_xor_b32 s46, s46, s47
  buffer_load_dwordx4 a[0:3], v1, s[8:11], s46 offen offset:0 sc1
  buffer_load_dwordx4 a[4:7], v1, s[8:11], s46 offen offset:1024 sc1
  buffer_load_dwordx4 a[8:11], v1, s[8:11], s46 offen offset:2048 sc1
  buffer_load_dwordx4 a[12:15], v1, s[8:11], s46 offen offset:3072 sc1
  s_add_u32 s46, s46, 4096
  buffer_load_dwordx4 a[16:19], v1, s[8:11], s46 offen offset:0 sc1
  buffer_load_dwordx4 a[20:23], v1, s[8:11], s46 offen offset:1024 sc1
  buffer_load_dwordx4 a[24:27], v1, s[8:11], s46 offen offset:2048 sc1
  buffer_load_dwordx4 a[28:31], v1, s[8:11], s46 offen offset:3072 sc1
  s_add_u32 s46, s63, 65536
  s_lshr_b32 s47, s46, 8
  s_and_b32 s47, s47, 0x2000
  s_xor_b32 s46, s46, s47
  buffer_load_dwordx4 a[32:35], v1, s[8:11], s46 offen offset:0 sc1
  buffer_load_dwordx4 a[36:39], v1, s[8:11], s46 offen offset:1024 sc1
  buffer_load_dwordx4 a[40:43], v1, s[8:11], s46 offen offset:2048 sc1
  buffer_load_dwordx4 a[44:47], v1, s[8:11], s46 offen offset:3072 sc1
  s_add_u32 s46, s46, 4096
  buffer_load_dwordx4 a[48:51], v1, s[8:11], s46 offen offset:0 sc1
  buffer_load_dwordx4 a[52:55], v1, s[8:11], s46 offen offset:1024 sc1
  buffer_load_dwordx4 a[56:59], v1, s[8:11], s46 offen offset:2048 sc1
  buffer_load_dwordx4 a[60:63], v1, s[8:11], s46 offen offset:3072 sc1
  s_add_u32 s46, s63, 131072
  s_lshr_b32 s47, s46, 8
  s_and_b32 s47, s47, 0x2000
  s_xor_b32 s46, s46, s47
  buffer_load_dwordx4 a[64:67], v1, s[8:11], s46 offen offset:0 sc1
  buffer_load_dwordx4 a[68:71], v1, s[8:11], s46 offen offset:1024 sc1
  buffer_load_dwordx4 a[72:75], v1, s[8:11], s46 offen offset:2048 sc1
  buffer_load_dwordx4 a[76:79], v1, s[8:11], s46 offen offset:3072 sc1
  s_add_u32 s46, s46, 4096
  buffer_load_dwordx4 a[80:83], v1, s[8:11], s46 offen offset:0 sc1
  buffer_load_dwordx4 a[84:87], v1, s[8:11], s46 offen offset:1024 sc1
  buffer_load_dwordx4 a[88:91], v1, s[8:11], s46 offen offset:2048 sc1
  buffer_load_dwordx4 a[92:95], v1, s[8:11], s46 offen offset:3072 sc1
  s_add_u32 s46, s63, 196608
  s_lshr_b32 s47, s46, 8
  s_and_b32 s47, s47, 0x2000
  s_xor_b32 s46, s46, s47
  buffer_load_dwordx4 a[96:99], v1, s[8:11], s46 offen offset:0 sc1
  buffer_load_dwordx4 a[100:103], v1, s[8:11], s46 offen offset:1024 sc1
  buffer_load_dwordx4 a[104:107], v1, s[8:11], s46 offen offset:2048 sc1
  buffer_load_dwordx4 a[108:111], v1, s[8:11], s46 offen offset:3072 sc1
  s_add_u32 s46, s46, 4096
  buffer_load_dwordx4 a[112:115], v1, s[8:11], s46 offen offset:0 sc1
  buffer_load_dwordx4 a[116:119], v1, s[8:11], s46 offen offset:1024 sc1
  buffer_load_dwordx4 a[120:123], v1, s[8:11], s46 offen offset:2048 sc1
  buffer_load_dwordx4 a[124:127], v1, s[8:11], s46 offen offset:3072 sc1
  s_add_u32 s46, s63, 262144
  s_lshr_b32 s47, s46, 8
  s_and_b32 s47, s47, 0x2000
  s_xor_b32 s46, s46, s47
  buffer_load_dwordx4 a[128:131], v1, s[8:11], s46 offen offset:0 sc1
  buffer_load_dwordx4 a[132:135], v1, s[8:11], s46 offen offset:1024 sc1
  buffer_load_dwordx4 a[136:139], v1, s[8:11], s46 offen offset:2048 sc1
  buffer_load_dwordx4 a[140:143], v1, s[8:11], s46 offen offset:3072 sc1
  s_add_u32 s46, s46, 4096
  buffer_load_dwordx4 a[144:147], v1, s[8:11], s46 offen offset:0 sc1
  buffer_load_dwordx4 a[148:151], v1, s[8:11], s46 offen offset:1024 sc1
  buffer_load_dwordx4 a[152:155], v1, s[8:11], s46 offen offset:2048 sc1
  buffer_load_dwordx4 a[156:159], v1, s[8:11], s46 offen offset:3072 sc1
  s_cmp_lt_u32 s76, 3145728
  s_cbranch_scc1 xo_pf
  s_sub_u32 s76, s76, 3145728
  s_mov_b32 s4, s18
  s_mov_b32 s5, s19
  s_mov_b32 s6, s77
  s_mov_b32 s18, s20
  s_mov_b32 s19, s21
  s_mov_b32 s77, s78
  s_mov_b32 s78, 0
xo_pf:
  buffer_load_dword v12, v228, s[4:7], s76 offen
  s_add_u32 s76, s76, 786432
  s_waitcnt vmcnt(24)
  s_add_u32 s53, s52, 2
  s_cmp_ge_u32 s52, 61
  s_cbranch_scc1 xo_last
  s_cmp_lg_u32 s42, 0
  s_cbranch_scc1 xo_go
  s_cmp_ge_u32 s61, s53
  s_cbranch_scc1 wf_done_57
  s_mov_b32 s50, 0
wf_loop_58:
  buffer_load_dword v10, v14, s[8:11], 0 offen sc1
  s_add_u32 s50, s50, 1
  s_cmp_gt_u32 s50, 131072
  s_cbranch_scc1 L_fail
  s_waitcnt vmcnt(0)
  v_readfirstlane_b32 s61, v10
  s_nop 0
  s_cmp_ge_u32 s61, s53
  s_cbranch_scc1 wf_done_57
  s_sleep 2
  s_branch wf_loop_58
wf_done_57:
  s_branch xo_go
xo_last:
  s_mov_b32 s53, 64
  s_mov_b32 s61, 0
  s_cmp_ge_u32 s61, s53
  s_cbranch_scc1 wf_done_59
  s_mov_b32 s50, 0
wf_loop_60:
  buffer_load_dword v10, v3, s[8:11], 0 offen sc1
  s_add_u32 s50, s50, 1
  s_cmp_gt_u32 s50, 131072
  s_cbranch_scc1 L_fail
  s_waitcnt vmcnt(0)
  v_min_u32_dpp v10, v10, v10 row_ror:8 row_mask:0xf bank_mask:0xf
  s_nop 1
  v_min_u32_dpp v10, v10, v10 row_ror:4 row_mask:0xf bank_mask:0xf
  s_nop 1
  v_min_u32_dpp v10, v10, v10 row_ror:2 row_mask:0xf bank_mask:0xf
  s_nop 1
  v_min_u32_dpp v10, v10, v10 row_ror:1 row_mask:0xf bank_mask:0xf
  v_mov_b32 v11, v10
  s_nop 1
  v_permlane16_swap_b32 v11, v10
  v_min_u32 v10, v10, v11
  v_mov_b32 v11, v10
  s_nop 1
  v_permlane32_swap_b32 v11, v10
  v_min_u32 v10, v10, v11
  s_nop 0
  v_readfirstlane_b32 s61, v10
  s_nop 0
  s_cmp_ge_u32 s61, s53
  s_cbranch_scc1 wf_done_59
  s_sleep 2
  s_branch wf_loop_60
wf_done_59:
xo_go:
  s_barrier
  s_lshl_b32 s64, s54, 21
  s_mul_i32 s46, s58, 655360
  s_add_u32 s64, s64, s46
  s_add_u32 s64, s64, s3
  s_add_u32 s64, s64, 4194304
  s_lshr_b32 s46, s64, 8
  s_and_b32 s46, s46, 0x2000
  s_xor_b32 s64, s64, s46
  s_add_u32 s64, s64, s67
  s_mov_b32 s49, s65
  s_lshr_b32 s46, s49, 8
  s_and_b32 s46, s46, 0x2000
  s_xor_b32 s49, s49, s46
  s_lshl_b32 s47, s42, 14
  s_add_u32 s47, s47, s49
  s_lshl_b32 s48, s42, 11
  s_add_u32 s48, s48, s49
  s_add_u32 s46, s47, 0
  buffer_load_dwordx4 v[56:59], v1, s[8:11], s46 offen sc1
  s_add_u32 s46, s47, 81920
  buffer_load_dwordx4 v[60:63], v1, s[8:11], s46 offen sc1
  s_add_u32 s46, s47, 1024
  buffer_load_dwordx4 v[64:67], v1, s[8:11], s46 offen sc1
  s_add_u32 s46, s47, 82944
  buffer_load_dwordx4 v[68:71], v1, s[8:11], s46 offen sc1
  s_add_u32 s46, s47, 2048
  buffer_load_dwordx4 v[72:75], v1, s[8:11], s46 offen sc1
  s_add_u32 s46, s47, 83968
  buffer_load_dwordx4 v[76:79], v1, s[8:11], s46 offen sc1
  s_add_u32 s46, s47, 3072
  buffer_load_dwordx4 v[80:83], v1, s[8:11], s46 offen sc1
  s_add_u32 s46, s47, 84992
  buffer_load_dwordx4 v[84:87], v1, s[8:11], s46 offen sc1
  s_add_u32 s46, s47, 4096
  buffer_load_dwordx4 v[88:91], v1, s[8:11], s46 offen sc1
  s_add_u32 s46, s47, 86016
  buffer_load_dwordx4 v[92:95], v1, s[8:11], s46 offen sc1
  s_add_u32 s46, s47, 5120
  buffer_load_dwordx4 v[96:99], v1, s[8:11], s46 offen sc1
  s_add_u32 s46, s47, 87040
  buffer_load_dwordx4 v[100:103], v1, s[8:11], s46 offen sc1
  s_add_u32 s46, s47, 6144
  buffer_load_dwordx4 v[104:107], v1, s[8:11], s46 offen sc1
  s_add_u32 s46, s47, 88064
  buffer_load_dwordx4 v[108:111], v1, s[8:11], s46 offen sc1
  s_add_u32 s46, s47, 7168
  buffer_load_dwordx4 v[112:115], v1, s[8:11], s46 offen sc1
  s_add_u32 s46, s47, 89088
  buffer_load_dwordx4 v[116:119], v1, s[8:11], s46 offen sc1
  s_add_u32 s46, s48, 65536
  buffer_load_dwordx4 v[120:123], v1, s[8:11], s46 offen sc1
  s_add_u32 s46, s48, 147456
  buffer_load_dwordx4 v[124:127], v1, s[8:11], s46 offen sc1
  s_add_u32 s46, s48, 66560
  buffer_load_dwordx4 v[128:131], v1, s[8:11], s46 offen sc1
  s_add_u32 s46, s48, 148480
  buffer_load_dwordx4 v[132:135], v1, s[8:11], s46 offen sc1
  s_add_u32 s46, s64, 0
  buffer_load_dwordx4 v[16:19], v1, s[8:11], s46 offen offset:0 sc1
  buffer_load_dwordx4 v[20:23], v1, s[8:11], s46 offen offset:1024 sc1
  s_add_u32 s46, s64, 16384
  buffer_load_dwordx4 v[24:27], v1, s[8:11], s46 offen offset:0 sc1
  buffer_load_dwordx4 v[28:31], v1, s[8:11], s46 offen offset:1024 sc1
  s_add_u32 s46, s64, 32768
  buffer_load_dwordx4 v[32:35], v1, s[8:11], s46 offen offset:0 sc1
  buffer_load_dwordx4 v[36:39], v1, s[8:11], s46 offen offset:1024 sc1
  s_add_u32 s46, s64, 49152
  buffer_load_dwordx4 v[40:43], v1, s[8:11], s46 offen offset:0 sc1
  buffer_load_dwordx4 v[44:47], v1, s[8:11], s46 offen offset:1024 sc1
  s_add_u32 s46, s64, 65536
  buffer_load_dwordx4 v[48:51], v1, s[8:11], s46 offen offset:0 sc1
  buffer_load_dwordx4 v[52:55], v1, s[8:11], s46 offen offset:1024 sc1
  s_waitcnt vmcnt(29)
  v_mfma_f32_16x16x32_bf16 v[136:139], a[0:3], v[56:59], 0
  v_mfma_f32_16x16x32_bf16 v[140:143], a[32:35], v[56:59], 0
  v_mfma_f32_16x16x32_bf16 v[144:147], a[64:67], v[56:59], 0
  v_mfma_f32_16x16x32_bf16 v[148:151], a[96:99], v[56:59], 0
  v_mfma_f32_16x16x32_bf16 v[152:155], a[128:131], v[56:59], 0
  s_waitcnt vmcnt(28)
  v_mfma_f32_16x16x32_bf16 v[156:159], a[0:3], v[60:63], 0
  v_mfma_f32_16x16x32_bf16 v[160:163], a[32:35], v[60:63], 0
  v_mfma_f32_16x16x32_bf16 v[164:167], a[64:67], v[60:63], 0
  v_mfma_f32_16x16x32_bf16 v[168:171], a[96:99], v[60:63], 0
  v_mfma_f32_16x16x32_bf16 v[172:175], a[128:131], v[60:63], 0
  s_waitcnt vmcnt(27)
  v_mfma_f32_16x16x32_bf16 v[136:139], a[4:7], v[64:67], v[136:139]
  v_mfma_f32_16x16x32_bf16 v[140:143], a[36:39], v[64:67], v[140:143]
  v_mfma_f32_16x16x32_bf16 v[144:147], a[68:71], v[64:67], v[144:147]
  v_mfma_f32_16x16x32_bf16 v[148:151], a[100:103], v[64:67], v[148:151]
  v_mfma_f32_16x16x32_bf16 v[152:155], a[132:135], v[64:67], v[152:155]
  s_waitcnt vmcnt(26)
  v_mfma_f32_16x16x32_bf16 v[156:159], a[4:7], v[68:71], v[156:159]
  v_mfma_f32_16x16x32_bf16 v[160:163], a[36:39], v[68:71], v[160:163]
  v_mfma_f32_16x16x32_bf16 v[164:167], a[68:71], v[68:71], v[164:167]
  v_mfma_f32_16x16x32_bf16 v[168:171], a[100:103], v[68:71], v[168:171]
  v_mfma_f32_16x16x32_bf16 v[172:175], a[132:135], v[68:71], v[172:175]
  s_waitcnt vmcnt(25)
  v_mfma_f32_16x16x32_bf16 v[136:139], a[8:11], v[72:75], v[136:139]
  v_mfma_f32_16x16x32_bf16 v[140:143], a[40:43], v[72:75], v[140:143]
  v_mfma_f32_16x16x32_bf16 v[144:147], a[72:75], v[72:75], v[144:147]
  v_mfma_f32_16x16x32_bf16 v[148:151], a[104:107], v[72:75], v[148:151]
  v_mfma_f32_16x16x32_bf16 v[152:155], a[136:139], v[72:75], v[152:155]
  s_waitcnt vmcnt(24)
  v_mfma_f32_16x16x32_bf16 v[156:159], a[8:11], v[76:79], v[156:159]
  v_mfma_f32_16x16x32_bf16 v[160:163], a[40:43], v[76:79], v[160:163]
  v_mfma_f32_16x16x32_bf16 v[164:167], a[72:75], v[76:79], v[164:167]
  v_mfma_f32_16x16x32_bf16 v[168:171], a[104:107], v[76:79], v[168:171]
  v_mfma_f32_16x16x32_bf16 v[172:175], a[136:139], v[76:79], v[172:175]
  s_waitcnt vmcnt(23)
  v_mfma_f32_16x16x32_bf16 v[136:139], a[12:15], v[80:83], v[136:139]
  v_mfma_f32_16x16x32_bf16 v[140:143], a[44:47], v[80:83], v[140:143]
  v_mfma_f32_16x16x32_bf16 v[144:147], a[76:79], v[80:83], v[144:147]
  v_mfma_f32_16x16x32_bf16 v[148:151], a[108:111], v[80:83], v[148:151]
  v_mfma_f32_16x16x32_bf16 v[152:155], a[140:143], v[80:83], v[152:155]
  s_waitcnt vmcnt(22)
  v_mfma_f32_16x16x32_bf16 v[156:159], a[12:15], v[84:87], v[156:159]
  v_mfma_f32_16x16x32_bf16 v[160:163], a[44:47], v[84:87], v[160:163]
  v_mfma_f32_16x16x32_bf16 v[164:167], a[76:79], v[84:87], v[164:167]
  v_mfma_f32_16x16x32_bf16 v[168:171], a[108:111], v[84:87], v[168:171]
  v_mfma_f32_16x16x32_bf16 v[172:175], a[140:143], v[84:87], v[172:175]
  s_waitcnt vmcnt(21)
  v_mfma_f32_16x16x32_bf16 v[136:139], a[16:19], v[88:91], v[136:139]
  v_mfma_f32_16x16x32_bf16 v[140:143], a[48:51], v[88:91], v[140:143]
  v_mfma_f32_16x16x32_bf16 v[144:147], a[80:83], v[88:91], v[144:147]
  v_mfma_f32_16x16x32_bf16 v[148:151], a[112:115], v[88:91], v[148:151]
  v_mfma_f32_16x16x32_bf16 v[152:155], a[144:147], v[88:91], v[152:155]
  s_waitcnt vmcnt(20)
  v_mfma_f32_16x16x32_bf16 v[156:159], a[16:19], v[92:95], v[156:159]
  v_mfma_f32_16x16x32_bf16 v[160:163], a[48:51], v[92:95], v[160:163]
  v_mfma_f32_16x16x32_bf16 v[164:167], a[80:83], v[92:95], v[164:167]
  v_mfma_f32_16x16x32_bf16 v[168:171], a[112:115], v[92:95], v[168:171]
  v_mfma_f32_16x16x32_bf16 v[172:175], a[144:147], v[92:95], v[172:175]
  s_waitcnt vmcnt(19)
  v_mfma_f32_16x16x32_bf16 v[136:139], a[20:23], v[96:99], v[136:139]
  v_mfma_f32_16x16x32_bf16 v[140:143], a[52:55], v[96:99], v[140:143]
  v_mfma_f32_16x16x32_bf16 v[144:147], a[84:87], v[96:99], v[144:147]
  v_mfma_f32_16x16x32_bf16 v[148:151], a[116:119], v[96:99], v[148:151]
  v_mfma_f32_16x16x32_bf16 v[152:155], a[148:151], v[96:99], v[152:155]
  s_waitcnt vmcnt(18)
  v_mfma_f32_16x16x32_bf16 v[156:159], a[20:23], v[100:103], v[156:159]
  v_mfma_f32_16x16x32_bf16 v[160:163], a[52:55], v[100:103], v[160:163]
  v_mfma_f32_16x16x32_bf16 v[164:167], a[84:87], v[100:103], v[164:167]
  v_mfma_f32_16x16x32_bf16 v[168:171], a[116:119], v[100:103], v[168:171]
  v_mfma_f32_16x16x32_bf16 v[172:175], a[148:151], v[100:103], v[172:175]
  s_waitcnt vmcnt(17)
  v_mfma_f32_16x16x32_bf16 v[136:139], a[24:27], v[104:107], v[136:139]
  v_mfma_f32_16x16x32_bf16 v[140:143], a[56:59], v[104:107], v[140:143]
  v_mfma_f32_16x16x32_bf16 v[144:147], a[88:91], v[104:107], v[144:147]
  v_mfma_f32_16x16x32_bf16 v[148:151], a[120:123], v[104:107], v[148:151]
  v_mfma_f32_16x16x32_bf16 v[152:155], a[152:155], v[104:107], v[152:155]
  s_waitcnt vmcnt(16)
  v_mfma_f32_16x16x32_bf16 v[156:159], a[24:27], v[108:111], v[156:159]
  v_mfma_f32_16x16x32_bf16 v[160:163], a[56:59], v[108:111], v[160:163]
  v_mfma_f32_16x16x32_bf16 v[164:167], a[88:91], v[108:111], v[164:167]
  v_mfma_f32_16x16x32_bf16 v[168:171], a[120:123], v[108:111], v[168:171]
  v_mfma_f32_16x16x32_bf16 v[172:175], a[152:155], v[108:111], v[172:175]
  s_waitcnt vmcnt(15)
  v_mfma_f32_16x16x32_bf16 v[136:139], a[28:31], v[112:115], v[136:139]
  v_mfma_f32_16x16x32_bf16 v[140:143], a[60:63], v[112:115], v[140:143]
  v_mfma_f32_16x16x32_bf16 v[144:147], a[92:95], v[112:115], v[144:147]
  v_mfma_f32_16x16x32_bf16 v[148:151], a[124:127], v[112:115], v[148:151]
  v_mfma_f32_16x16x32_bf16 v[152:155], a[156:159], v[112:115], v[152:155]
  s_waitcnt vmcnt(14)
  v_mfma_f32_16x16x32_bf16 v[156:159], a[28:31], v[116:119], v[156:159]
  v_mfma_f32_16x16x32_bf16 v[160:163], a[60:63], v[116:119], v[160:163]
  v_mfma_f32_16x16x32_bf16 v[164:167], a[92:95], v[116:119], v[164:167]
  v_mfma_f32_16x16x32_bf16 v[168:171], a[124:127], v[116:119], v[168:171]
  v_mfma_f32_16x16x32_bf16 v[172:175], a[156:159], v[116:119], v[172:175]
  s_waitcnt vmcnt(8)
  v_mfma_f32_16x16x32_bf16 v[136:139], v[16:19], v[120:123], v[136:139]
  v_mfma_f32_16x16x32_bf16 v[156:159], v[16:19], v[124:127], v[156:159]
  v_mfma_f32_16x16x32_bf16 v[136:139], v[20:23], v[128:131], v[136:139]
  v_mfma_f32_16x16x32_bf16 v[156:159], v[20:23], v[132:135], v[156:159]
  s_waitcnt vmcnt(6)
  v_mfma_f32_16x16x32_bf16 v[140:143], v[24:27], v[120:123], v[140:143]
  v_mfma_f32_16x16x32_bf16 v[160:163], v[24:27], v[124:127], v[160:163]
  v_mfma_f32_16x16x32_bf16 v[140:143], v[28:31], v[128:131], v[140:143]
  v_mfma_f32_16x16x32_bf16 v[160:163], v[28:31], v[132:135], v[160:163]
  s_waitcnt vmcnt(4)
  v_mfma_f32_16x16x32_bf16 v[144:147], v[32:35], v[120:123], v[144:147]
  v_mfma_f32_16x16x32_bf16 v[164:167], v[32:35], v[124:127], v[164:167]
  v_mfma_f32_16x16x32_bf16 v[144:147], v[36:39], v[128:131], v[144:147]
  v_mfma_f32_16x16x32_bf16 v[164:167], v[36:39], v[132:135], v[164:167]
  s_waitcnt vmcnt(2)
  v_mfma_f32_16x16x32_bf16 v[148:151], v[40:43], v[120:123], v[148:151]
  v_mfma_f32_16x16x32_bf16 v[168:171], v[40:43], v[124:127], v[168:171]
  v_mfma_f32_16x16x32_bf16 v[148:151], v[44:47], v[128:131], v[148:151]
  v_mfma_f32_16x16x32_bf16 v[168:171], v[44:47], v[132:135], v[168:171]
  s_waitcnt vmcnt(0)
  v_mfma_f32_16x16x32_bf16 v[152:155], v[48:51], v[120:123], v[152:155]
  v_mfma_f32_16x16x32_bf16 v[172:175], v[48:51], v[124:127], v[172:175]
  v_mfma_f32_16x16x32_bf16 v[152:155], v[52:55], v[128:131], v[152:155]
  v_mfma_f32_16x16x32_bf16 v[172:175], v[52:55], v[132:135], v[172:175]
  s_add_u32 s46, s64, 0
  buffer_store_dwordx4 v[224:227], v1, s[8:11], s46 offen offset:0 sc1
  buffer_store_dwordx4 v[224:227], v1, s[8:11], s46 offen offset:1024 sc1
  s_add_u32 s46, s64, 16384
  buffer_store_dwordx4 v[224:227], v1, s[8:11], s46 offen offset:0 sc1
  buffer_store_dwordx4 v[224:227], v1, s[8:11], s46 offen offset:1024 sc1
  s_add_u32 s46, s64, 32768
  buffer_store_dwordx4 v[224:227], v1, s[8:11], s46 offen offset:0 sc1
  buffer_store_dwordx4 v[224:227], v1, s[8:11], s46 offen offset:1024 sc1
  s_add_u32 s46, s64, 49152
  buffer_store_dwordx4 v[224:227], v1, s[8:11], s46 offen offset:0 sc1
  buffer_store_dwordx4 v[224:227], v1, s[8:11], s46 offen offset:1024 sc1
  s_add_u32 s46, s64, 65536
  buffer_store_dwordx4 v[224:227], v1, s[8:11], s46 offen offset:0 sc1
  buffer_store_dwordx4 v[224:227], v1, s[8:11], s46 offen offset:1024 sc1
  ds_write_b128 v5, v[136:139] offset:0
  ds_write_b128 v5, v[140:143] offset:1024
  ds_write_b128 v5, v[144:147] offset:2048
  ds_write_b128 v5, v[148:151] offset:3072
  ds_write_b128 v5, v[152:155] offset:4096
  ds_write_b128 v5, v[156:159] offset:5120
  ds_write_b128 v5, v[160:163] offset:6144
  ds_write_b128 v5, v[164:167] offset:7168
  ds_write_b128 v5, v[168:171] offset:8192
  ds_write_b128 v5, v[172:175] offset:9216
  s_waitcnt lgkmcnt(0)
  s_barrier
  ds_read_b128 v[176:179], v6 offset:0
  ds_read_b128 v[180:183], v6 offset:10240
  ds_read_b128 v[184:187], v6 offset:20480
  ds_read_b128 v[188:191], v6 offset:30720
  ds_read_b128 v[192:195], v6 offset:4096
  ds_read_b128 v[196:199], v6 offset:14336
  ds_read_b128 v[200:203], v6 offset:24576
  ds_read_b128 v[204:207], v6 offset:34816
  ds_read_b128 v[208:211], v6 offset:8192
  ds_read_b128 v[212:215], v6 offset:18432
  ds_read_b128 v[216:219], v6 offset:28672
  ds_read_b128 v[220:223], v6 offset:38912
  s_waitcnt lgkmcnt(8)
  v_add_f32 v176, v176, v180
  v_add_f32 v184, v184, v188
  v_add_f32 v176, v176, v184
  v_add_f32 v177, v177, v181
  v_add_f32 v185, v185, v189
  v_add_f32 v177, v177, v185
  v_add_f32 v178, v178, v182
  v_add_f32 v186, v186, v190
  v_add_f32 v178, v178, v186
  v_add_f32 v179, v179, v183
  v_add_f32 v187, v187, v191
  v_add_f32 v179, v179, v187
  v_cvt_pk_bf16_f32 v176, v176, v177
  v_cvt_pk_bf16_f32 v177, v178, v179
  buffer_store_dwordx2 v[176:177], v7, s[12:15], s66 offen
  s_waitcnt lgkmcnt(4)
  v_add_f32 v192, v192, v196
  v_add_f32 v200, v200, v204
  v_add_f32 v192, v192, v200
  v_add_f32 v193, v193, v197
  v_add_f32 v201, v201, v205
  v_add_f32 v193, v193, v201
  v_add_f32 v194, v194, v198
  v_add_f32 v202, v202, v206
  v_add_f32 v194, v194, v202
  v_add_f32 v195, v195, v199
  v_add_f32 v203, v203, v207
  v_add_f32 v195, v195, v203
  v_cvt_pk_bf16_f32 v192, v192, v193
  v_cvt_pk_bf16_f32 v193, v194, v195
  buffer_store_dwordx2 v[192:193], v8, s[12:15], s66 offen
  s_waitcnt lgkmcnt(0)
  v_add_f32 v208, v208, v212
  v_add_f32 v216, v216, v220
  v_add_f32 v208, v208, v216
  v_add_f32 v209, v209, v213
  v_add_f32 v217, v217, v221
  v_add_f32 v209, v209, v217
  v_add_f32 v210, v210, v214
  v_add_f32 v218, v218, v222
  v_add_f32 v210, v210, v218
  v_add_f32 v211, v211, v215
  v_add_f32 v219, v219, v223
  v_add_f32 v211, v211, v219
  v_cvt_pk_bf16_f32 v208, v208, v209
  v_cvt_pk_bf16_f32 v209, v210, v211
  buffer_store_dwordx2 v[208:209], v9, s[12:15], s66 offen
  s_add_u32 s46, s52, 10
  v_mov_b32 v10, s46
  s_waitcnt vmcnt(0)
  s_barrier
  buffer_store_dword v10, v15, s[8:11], 0 offen sc1
  s_add_u32 s54, s54, 1
  s_cmp_eq_u32 s54, 3
  s_cselect_b32 s54, 0, s54
  s_add_u32 s63, s63, 7864320
  s_cmp_ge_u32 s63, 165675008
  s_cselect_b32 s46, 83886080, 0
  s_sub_u32 s63, s63, s46
  s_add_u32 s65, s65, 786432
  s_cmp_ge_u32 s65, 16777216
  s_cselect_b32 s46, 2097152, 0
  s_sub_u32 s65, s65, s46
  s_add_u32 s66, s66, 245760
  s_add_u32 s52, s52, 3
  s_cmp_lt_u32 s52, 64
  s_cbranch_scc1 xo_loop
  s_endpgm
L_end:
  s_endpgm
L_fail:
  s_mov_b32 s4, s38
  s_mov_b32 s5, s39
  s_mov_b32 s6, 256
  s_mov_b32 s7, 0x20000
  s_lshl_b32 s46, s43, 8
  s_or_b32 s46, s46, s44
  s_or_b32 s46, s46, 0x10000
  v_mov_b32 v1, 32
  v_mov_b32 v2, s46
  s_mov_b64 exec, 1
  buffer_store_dword v2, v1, s[4:7], 0 offen sc1
  s_waitcnt vmcnt(0)
  s_endpgm
.section .rodata,"a"
.p2align 6
.amdhsa_kernel concat_heads__sliding_local_dilated__memory_aug_recurrent_mem_tr__prompt_kernel
  .amdhsa_next_free_vgpr 512
  .amdhsa_next_free_sgpr 102
  .amdhsa_accum_offset 256
  .amdhsa_group_segment_fixed_size 0
  .amdhsa_kernarg_size 104
  .amdhsa_user_sgpr_count 2
  .amdhsa_user_sgpr_kernarg_segment_ptr 1
  .amdhsa_system_sgpr_workgroup_id_x 1
.end_amdhsa_kernel
```

```asm
; @launch grid=(256,1,1) block=(256,1,1) lds=163840
.amdgcn_target "amdgcn-amd-amdhsa--gfx950"
.text
.globl concat_heads__sliding_local_dilated__memory_aug_recurrent_mem_tr__prompt_kernel
.p2align 8
.type concat_heads__sliding_local_dilated__memory_aug_recurrent_mem_tr__prompt_kernel,@function
concat_heads__sliding_local_dilated__memory_aug_recurrent_mem_tr__prompt_kernel:
  s_cmp_ge_u32 s2, 256
  s_cbranch_scc1 L_end
  v_lshrrev_b32 v1, 6, v0
  v_and_b32 v0, 63, v0
  v_readfirstlane_b32 s42, v1
  s_getreg_b32 s46, hwreg(HW_REG_XCC_ID)
  s_lshr_b32 s44, s2, 3
  s_lshl_b32 s51, s42, 10
  s_mov_b32 s3, 0
L_reroll:
  s_load_dwordx16 s[16:31], s[0:1], 0
  s_load_dwordx8 s[32:39], s[0:1], 64
  s_load_dwordx2 s[40:41], s[0:1], 96
  s_and_b32 s43, s46, 7
  s_and_b32 s46, s44, 7
  s_lshl_b32 s46, s46, 2
  s_and_b32 s47, s43, 3
  s_add_u32 s45, s46, s47
  s_waitcnt lgkmcnt(0)
  s_add_u32 s8, s40, 0x1fffff
  s_addc_u32 s9, s41, 0
  s_and_b32 s8, s8, 0xffe00000
  s_mov_b32 s10, 266338304
  s_mov_b32 s11, 0x20000
  s_mov_b32 s4, s38
  s_mov_b32 s5, s39
  s_mov_b32 s6, 256
  s_mov_b32 s7, 0x20000
  s_mov_b32 s12, s22
  s_mov_b32 s13, s23
  s_mov_b32 s14, 2621440
  s_mov_b32 s15, 0x20000
  s_or_b32 s46, s2, s42
  s_cbranch_scc1 L_norot
  v_mov_b32 v1, 0
  s_or_b32 s46, s43, 8
  v_mov_b32 v2, s46
  buffer_store_dword v2, v1, s[4:7], 0 offen sc1
L_norot:
  s_cmp_lt_u32 s43, 4
  s_cbranch_scc1 L_recur
  s_cmp_ge_u32 s44, 24
  s_cbranch_scc1 L_uw
  s_lshr_b32 s48, s44, 3
  s_cmp_eq_u32 s48, 0
  s_cselect_b32 s4, s26, s28
  s_cselect_b32 s5, s27, s29
  s_cmp_eq_u32 s48, 2
  s_cselect_b32 s4, s30, s4
  s_cselect_b32 s5, s31, s5
  s_mov_b32 s6, 7864320
  s_mul_i32 s60, s45, 384
  s_mov_b32 s61, 0
  s_mov_b32 s62, 64
  s_cselect_b32 s63, 50331648, 0
  s_add_u32 s63, s63, 31457280
  s_cmp_lg_u32 s48, 1
  s_cselect_b32 s46, 0x2000, 0
  s_add_u32 s63, s63, s46
  s_mov_b32 s67, s45
  s_lshl_b32 s64, s48, 5
  s_add_u32 s64, s64, s45
  s_lshl_b32 s64, s64, 7
  s_add_u32 s64, s64, 1048576
  v_lshrrev_b32 v10, 3, v0
  v_lshrrev_b32 v11, 2, v10
  v_lshlrev_b32 v11, 3, v11
  v_and_b32 v1, 3, v10
  v_add_u32 v1, v1, v11
  s_and_b32 s46, s42, 1
  s_lshl_b32 s46, s46, 2
  s_lshr_b32 s47, s42, 1
  s_lshl_b32 s47, s47, 4
  s_add_u32 s46, s46, s47
  v_add_u32 v1, s46, v1
  v_mul_u32_u24 v1, 12288, v1
  v_lshrrev_b32 v10, 1, v10
  v_bfe_u32 v11, v0, 1, 2
  v_xor_b32 v10, v10, v11
  v_lshlrev_b32 v10, 5, v10
  v_and_b32 v11, 1, v0
  v_lshlrev_b32 v11, 4, v11
  v_add3_u32 v1, v1, v10, v11
  v_lshrrev_b32 v10, 5, v0
  v_lshlrev_b32 v2, 11, v10
  v_bfe_u32 v10, v0, 2, 3
  v_lshl_add_u32 v2, v10, 7, v2
  v_lshrrev_b32 v10, 1, v10
  v_xor_b32 v10, s42, v10
  v_lshl_add_u32 v2, v10, 5, v2
  v_and_b32 v10, 3, v0
  v_lshl_add_u32 v2, v10, 3, v2
  v_add_u32 v3, 0x10000, v2
  v_add_u32 v4, 0x20000, v2
  v_lshrrev_b32 v10, 3, v0
  s_lshl_b32 s46, s42, 3
  v_add_u32 v10, s46, v10
  v_mul_u32_u24 v5, 1280, v10
  v_bfe_u32 v10, v10, 1, 3
  v_and_b32 v11, 7, v0
  v_xor_b32 v10, v10, v11
  v_lshl_add_u32 v5, v10, 4, v5
  v_and_b32 v10, 15, v0
  v_lshlrev_b32 v6, 7, v10
  v_lshrrev_b32 v10, 1, v10
  v_lshrrev_b32 v11, 4, v0
  v_xor_b32 v10, v10, v11
  v_lshl_add_u32 v6, v10, 4, v6
  v_add_u32 v6, 122880, v6
  v_xor_b32 v7, 64, v6
  v_and_b32 v10, 15, v0
  v_lshlrev_b32 v8, 4, v10
  v_bfe_u32 v10, v0, 4, 1
  v_lshlrev_b32 v10, 11, v10
  v_lshrrev_b32 v11, 5, v0
  v_lshlrev_b32 v11, 8, v11
  v_add3_u32 v8, v8, v10, v11
  s_lshl_b32 s46, s42, 9
  v_add_u32 v8, s46, v8
  v_mov_b32 v9, s64
  v_mov_b32 v10, 2146435072
  s_cmp_eq_u32 s42, 0
  s_cselect_b64 vcc, 1, 0
  v_cndmask_b32 v9, v10, v9, vcc
  s_lshl_b32 s46, s43, 7
  s_add_u32 s46, s46, 1076736
  v_mov_b32 v14, s46
  s_mov_b32 s68, 0
  s_lshr_b32 s70, s44, 5
  s_add_u32 s70, s70, 60
  s_mov_b32 s52, s61
  s_mul_i32 s53, s52, 40960
  s_add_u32 s54, s51, 122880
  s_add_u32 m0, s54, 0
  s_nop 0
  buffer_load_dwordx4 v5, s[12:15], s53 offen offset:0 lds
  s_add_u32 m0, s54, 3968
  s_nop 0
  buffer_load_dwordx4 v5, s[12:15], s53 offen offset:128 lds
  s_add_u32 m0, s54, 7936
  s_nop 0
  buffer_load_dwordx4 v5, s[12:15], s53 offen offset:256 lds
  s_add_u32 m0, s54, 11904
  s_nop 0
  buffer_load_dwordx4 v5, s[12:15], s53 offen offset:384 lds
  s_add_u32 m0, s54, 15872
  s_nop 0
  buffer_load_dwordx4 v5, s[12:15], s53 offen offset:512 lds
  s_add_u32 m0, s54, 19840
  s_nop 0
  buffer_load_dwordx4 v5, s[12:15], s53 offen offset:640 lds
  s_add_u32 m0, s54, 23808
  s_nop 0
  buffer_load_dwordx4 v5, s[12:15], s53 offen offset:768 lds
  s_add_u32 m0, s54, 27776
  s_nop 0
  buffer_load_dwordx4 v5, s[12:15], s53 offen offset:896 lds
  s_add_u32 m0, s54, 31744
  s_nop 0
  buffer_load_dwordx4 v5, s[12:15], s53 offen offset:1024 lds
  s_add_u32 m0, s54, 35712
  s_nop 0
  buffer_load_dwordx4 v5, s[12:15], s53 offen offset:1152 lds
  s_add_u32 m0, s51, 0
  s_add_u32 s46, s60, 0
  buffer_load_dwordx4 v1, s[4:7], s46 offen lds
  s_add_u32 m0, s51, 4096
  s_add_u32 s46, s60, 128
  buffer_load_dwordx4 v1, s[4:7], s46 offen lds
  s_add_u32 m0, s51, 8192
  s_add_u32 s46, s60, 256
  buffer_load_dwordx4 v1, s[4:7], s46 offen lds
  s_add_u32 m0, s51, 12288
  s_add_u32 s46, s60, 393216
  buffer_load_dwordx4 v1, s[4:7], s46 offen lds
  s_add_u32 m0, s51, 16384
  s_add_u32 s46, s60, 393344
  buffer_load_dwordx4 v1, s[4:7], s46 offen lds
  s_add_u32 m0, s51, 20480
  s_add_u32 s46, s60, 393472
  buffer_load_dwordx4 v1, s[4:7], s46 offen lds
  s_add_u32 m0, s51, 24576
  s_add_u32 s46, s60, 786432
  buffer_load_dwordx4 v1, s[4:7], s46 offen lds
  s_add_u32 m0, s51, 28672
  s_add_u32 s46, s60, 786560
  buffer_load_dwordx4 v1, s[4:7], s46 offen lds
  s_add_u32 m0, s51, 32768
  s_add_u32 s46, s60, 786688
  buffer_load_dwordx4 v1, s[4:7], s46 offen lds
  s_add_u32 m0, s51, 36864
  s_add_u32 s46, s60, 1179648
  buffer_load_dwordx4 v1, s[4:7], s46 offen lds
  s_add_u32 m0, s51, 40960
  s_add_u32 s46, s60, 1179776
  buffer_load_dwordx4 v1, s[4:7], s46 offen lds
  s_add_u32 m0, s51, 45056
  s_add_u32 s46, s60, 1179904
  buffer_load_dwordx4 v1, s[4:7], s46 offen lds
  s_add_u32 m0, s51, 49152
  s_add_u32 s46, s60, 1572864
  buffer_load_dwordx4 v1, s[4:7], s46 offen lds
  s_add_u32 m0, s51, 53248
  s_add_u32 s46, s60, 1572992
  buffer_load_dwordx4 v1, s[4:7], s46 offen lds
  s_add_u32 m0, s51, 57344
  s_add_u32 s46, s60, 1573120
  buffer_load_dwordx4 v1, s[4:7], s46 offen lds
  s_add_u32 m0, s51, 61440
  s_add_u32 s46, s60, 1966080
  buffer_load_dwordx4 v1, s[4:7], s46 offen lds
  s_add_u32 m0, s51, 65536
  s_add_u32 s46, s60, 1966208
  buffer_load_dwordx4 v1, s[4:7], s46 offen lds
  s_add_u32 m0, s51, 69632
  s_add_u32 s46, s60, 1966336
  buffer_load_dwordx4 v1, s[4:7], s46 offen lds
  s_add_u32 m0, s51, 73728
  s_add_u32 s46, s60, 2359296
  buffer_load_dwordx4 v1, s[4:7], s46 offen lds
  s_add_u32 m0, s51, 77824
  s_add_u32 s46, s60, 2359424
  buffer_load_dwordx4 v1, s[4:7], s46 offen lds
  s_add_u32 m0, s51, 81920
  s_add_u32 s46, s60, 2359552
  buffer_load_dwordx4 v1, s[4:7], s46 offen lds
  s_add_u32 m0, s51, 86016
  s_add_u32 s46, s60, 2752512
  buffer_load_dwordx4 v1, s[4:7], s46 offen lds
  s_add_u32 m0, s51, 90112
  s_add_u32 s46, s60, 2752640
  buffer_load_dwordx4 v1, s[4:7], s46 offen lds
  s_add_u32 m0, s51, 94208
  s_add_u32 s46, s60, 2752768
  buffer_load_dwordx4 v1, s[4:7], s46 offen lds
  s_waitcnt vmcnt(18)
  s_barrier
  s_add_u32 m0, s51, 98304
  s_add_u32 s46, s60, 3145728
  buffer_load_dwordx4 v1, s[4:7], s46 offen lds
  s_add_u32 m0, s51, 102400
  s_add_u32 s46, s60, 3145856
  buffer_load_dwordx4 v1, s[4:7], s46 offen lds
  s_add_u32 m0, s51, 106496
  s_add_u32 s46, s60, 3145984
  buffer_load_dwordx4 v1, s[4:7], s46 offen lds
  s_add_u32 m0, s51, 110592
  s_add_u32 s46, s60, 3538944
  buffer_load_dwordx4 v1, s[4:7], s46 offen lds
  s_add_u32 m0, s51, 114688
  s_add_u32 s46, s60, 3539072
  buffer_load_dwordx4 v1, s[4:7], s46 offen lds
  s_add_u32 m0, s51, 118784
  s_add_u32 s46, s60, 3539200
  buffer_load_dwordx4 v1, s[4:7], s46 offen lds
  ds_read_b64_tr_b16 a[0:1], v2 offset:0
  ds_read_b64_tr_b16 a[2:3], v2 offset:1024
  ds_read_b64_tr_b16 a[4:5], v2 offset:4096
  ds_read_b64_tr_b16 a[6:7], v2 offset:5120
  ds_read_b64_tr_b16 a[8:9], v2 offset:8192
  ds_read_b64_tr_b16 a[10:11], v2 offset:9216
  ds_read_b64_tr_b16 a[12:13], v2 offset:12288
  ds_read_b64_tr_b16 a[14:15], v2 offset:13312
  ds_read_b64_tr_b16 a[16:17], v2 offset:16384
  ds_read_b64_tr_b16 a[18:19], v2 offset:17408
  ds_read_b64_tr_b16 a[20:21], v2 offset:20480
  ds_read_b64_tr_b16 a[22:23], v2 offset:21504
  s_waitcnt lgkmcnt(0)
  s_waitcnt vmcnt(18)
  s_barrier
  s_add_u32 m0, s51, 0
  s_add_u32 s46, s60, 3932160
  buffer_load_dwordx4 v1, s[4:7], s46 offen lds
  s_add_u32 m0, s51, 4096
  s_add_u32 s46, s60, 3932288
  buffer_load_dwordx4 v1, s[4:7], s46 offen lds
  s_add_u32 m0, s51, 8192
  s_add_u32 s46, s60, 3932416
  buffer_load_dwordx4 v1, s[4:7], s46 offen lds
  s_add_u32 m0, s51, 12288
  s_add_u32 s46, s60, 4325376
  buffer_load_dwordx4 v1, s[4:7], s46 offen lds
  s_add_u32 m0, s51, 16384
  s_add_u32 s46, s60, 4325504
  buffer_load_dwordx4 v1, s[4:7], s46 offen lds
  s_add_u32 m0, s51, 20480
  s_add_u32 s46, s60, 4325632
  buffer_load_dwordx4 v1, s[4:7], s46 offen lds
  ds_read_b64_tr_b16 a[24:25], v2 offset:24576
  ds_read_b64_tr_b16 a[26:27], v2 offset:25600
  ds_read_b64_tr_b16 a[28:29], v2 offset:28672
  ds_read_b64_tr_b16 a[30:31], v2 offset:29696
  ds_read_b64_tr_b16 a[32:33], v2 offset:32768
  ds_read_b64_tr_b16 a[34:35], v2 offset:33792
  ds_read_b64_tr_b16 a[36:37], v2 offset:36864
  ds_read_b64_tr_b16 a[38:39], v2 offset:37888
  ds_read_b64_tr_b16 a[40:41], v2 offset:40960
  ds_read_b64_tr_b16 a[42:43], v2 offset:41984
  ds_read_b64_tr_b16 a[44:45], v2 offset:45056
  ds_read_b64_tr_b16 a[46:47], v2 offset:46080
  s_waitcnt lgkmcnt(0)
  s_waitcnt vmcnt(18)
  s_barrier
  s_add_u32 m0, s51, 24576
  s_add_u32 s46, s60, 4718592
  buffer_load_dwordx4 v1, s[4:7], s46 offen lds
  s_add_u32 m0, s51, 28672
  s_add_u32 s46, s60, 4718720
  buffer_load_dwordx4 v1, s[4:7], s46 offen lds
  s_add_u32 m0, s51, 32768
  s_add_u32 s46, s60, 4718848
  buffer_load_dwordx4 v1, s[4:7], s46 offen lds
  s_add_u32 m0, s51, 36864
  s_add_u32 s46, s60, 5111808
  buffer_load_dwordx4 v1, s[4:7], s46 offen lds
  s_add_u32 m0, s51, 40960
  s_add_u32 s46, s60, 5111936
  buffer_load_dwordx4 v1, s[4:7], s46 offen lds
  s_add_u32 m0, s51, 45056
  s_add_u32 s46, s60, 5112064
  buffer_load_dwordx4 v1, s[4:7], s46 offen lds
  ds_read_b64_tr_b16 a[48:49], v2 offset:49152
  ds_read_b64_tr_b16 a[50:51], v2 offset:50176
  ds_read_b64_tr_b16 a[52:53], v2 offset:53248
  ds_read_b64_tr_b16 a[54:55], v2 offset:54272
  ds_read_b64_tr_b16 a[56:57], v2 offset:57344
  ds_read_b64_tr_b16 a[58:59], v2 offset:58368
  ds_read_b64_tr_b16 a[60:61], v2 offset:61440
  ds_read_b64_tr_b16 a[62:63], v2 offset:62464
  ds_read_b64_tr_b16 a[64:65], v3 offset:0
  ds_read_b64_tr_b16 a[66:67], v3 offset:1024
  ds_read_b64_tr_b16 a[68:69], v3 offset:4096
  ds_read_b64_tr_b16 a[70:71], v3 offset:5120
  s_waitcnt lgkmcnt(0)
  s_waitcnt vmcnt(18)
  s_barrier
  s_add_u32 m0, s51, 49152
  s_add_u32 s46, s60, 5505024
  buffer_load_dwordx4 v1, s[4:7], s46 offen lds
  s_add_u32 m0, s51, 53248
  s_add_u32 s46, s60, 5505152
  buffer_load_dwordx4 v1, s[4:7], s46 offen lds
  s_add_u32 m0, s51, 57344
  s_add_u32 s46, s60, 5505280
  buffer_load_dwordx4 v1, s[4:7], s46 offen lds
  s_add_u32 m0, s51, 61440
  s_add_u32 s46, s60, 5898240
  buffer_load_dwordx4 v1, s[4:7], s46 offen lds
  s_add_u32 m0, s51, 65536
  s_add_u32 s46, s60, 5898368
  buffer_load_dwordx4 v1, s[4:7], s46 offen lds
  s_add_u32 m0, s51, 69632
  s_add_u32 s46, s60, 5898496
  buffer_load_dwordx4 v1, s[4:7], s46 offen lds
  ds_read_b64_tr_b16 a[72:73], v3 offset:8192
  ds_read_b64_tr_b16 a[74:75], v3 offset:9216
  ds_read_b64_tr_b16 a[76:77], v3 offset:12288
  ds_read_b64_tr_b16 a[78:79], v3 offset:13312
  ds_read_b64_tr_b16 a[80:81], v3 offset:16384
  ds_read_b64_tr_b16 a[82:83], v3 offset:17408
  ds_read_b64_tr_b16 a[84:85], v3 offset:20480
  ds_read_b64_tr_b16 a[86:87], v3 offset:21504
  ds_read_b64_tr_b16 a[88:89], v3 offset:24576
  ds_read_b64_tr_b16 a[90:91], v3 offset:25600
  ds_read_b64_tr_b16 a[92:93], v3 offset:28672
  ds_read_b64_tr_b16 a[94:95], v3 offset:29696
  s_waitcnt lgkmcnt(0)
  s_waitcnt vmcnt(18)
  s_barrier
  s_add_u32 m0, s51, 73728
  s_add_u32 s46, s60, 6291456
  buffer_load_dwordx4 v1, s[4:7], s46 offen lds
  s_add_u32 m0, s51, 77824
  s_add_u32 s46, s60, 6291584
  buffer_load_dwordx4 v1, s[4:7], s46 offen lds
  s_add_u32 m0, s51, 81920
  s_add_u32 s46, s60, 6291712
  buffer_load_dwordx4 v1, s[4:7], s46 offen lds
  s_add_u32 m0, s51, 86016
  s_add_u32 s46, s60, 6684672
  buffer_load_dwordx4 v1, s[4:7], s46 offen lds
  s_add_u32 m0, s51, 90112
  s_add_u32 s46, s60, 6684800
  buffer_load_dwordx4 v1, s[4:7], s46 offen lds
  s_add_u32 m0, s51, 94208
  s_add_u32 s46, s60, 6684928
  buffer_load_dwordx4 v1, s[4:7], s46 offen lds
  ds_read_b64_tr_b16 a[96:97], v3 offset:32768
  ds_read_b64_tr_b16 a[98:99], v3 offset:33792
  ds_read_b64_tr_b16 a[100:101], v3 offset:36864
  ds_read_b64_tr_b16 a[102:103], v3 offset:37888
  ds_read_b64_tr_b16 a[104:105], v3 offset:40960
  ds_read_b64_tr_b16 a[106:107], v3 offset:41984
  ds_read_b64_tr_b16 a[108:109], v3 offset:45056
  ds_read_b64_tr_b16 a[110:111], v3 offset:46080
  ds_read_b64_tr_b16 a[112:113], v3 offset:49152
  ds_read_b64_tr_b16 a[114:115], v3 offset:50176
  ds_read_b64_tr_b16 a[116:117], v3 offset:53248
  ds_read_b64_tr_b16 a[118:119], v3 offset:54272
  s_waitcnt lgkmcnt(0)
  s_waitcnt vmcnt(18)
  s_barrier
  s_add_u32 m0, s51, 98304
  s_add_u32 s46, s60, 7077888
  buffer_load_dwordx4 v1, s[4:7], s46 offen lds
  s_add_u32 m0, s51, 102400
  s_add_u32 s46, s60, 7078016
  buffer_load_dwordx4 v1, s[4:7], s46 offen lds
  s_add_u32 m0, s51, 106496
  s_add_u32 s46, s60, 7078144
  buffer_load_dwordx4 v1, s[4:7], s46 offen lds
  s_add_u32 m0, s51, 110592
  s_add_u32 s46, s60, 7471104
  buffer_load_dwordx4 v1, s[4:7], s46 offen lds
  s_add_u32 m0, s51, 114688
  s_add_u32 s46, s60, 7471232
  buffer_load_dwordx4 v1, s[4:7], s46 offen lds
  s_add_u32 m0, s51, 118784
  s_add_u32 s46, s60, 7471360
  buffer_load_dwordx4 v1, s[4:7], s46 offen lds
  ds_read_b64_tr_b16 a[120:121], v2 offset:0
  ds_read_b64_tr_b16 a[122:123], v2 offset:1024
  ds_read_b64_tr_b16 a[124:125], v2 offset:4096
  ds_read_b64_tr_b16 a[126:127], v2 offset:5120
  ds_read_b64_tr_b16 a[128:129], v2 offset:8192
  ds_read_b64_tr_b16 a[130:131], v2 offset:9216
  ds_read_b64_tr_b16 a[132:133], v2 offset:12288
  ds_read_b64_tr_b16 a[134:135], v2 offset:13312
  ds_read_b64_tr_b16 a[136:137], v2 offset:16384
  ds_read_b64_tr_b16 a[138:139], v2 offset:17408
  ds_read_b64_tr_b16 a[140:141], v2 offset:20480
  ds_read_b64_tr_b16 a[142:143], v2 offset:21504
  s_waitcnt lgkmcnt(0)
  s_waitcnt vmcnt(18)
  s_barrier
  ds_read_b64_tr_b16 a[144:145], v2 offset:24576
  ds_read_b64_tr_b16 a[146:147], v2 offset:25600
  ds_read_b64_tr_b16 a[148:149], v2 offset:28672
  ds_read_b64_tr_b16 a[150:151], v2 offset:29696
  ds_read_b64_tr_b16 a[152:153], v2 offset:32768
  ds_read_b64_tr_b16 a[154:155], v2 offset:33792
  ds_read_b64_tr_b16 a[156:157], v2 offset:36864
  ds_read_b64_tr_b16 a[158:159], v2 offset:37888
  ds_read_b64_tr_b16 a[160:161], v2 offset:40960
  ds_read_b64_tr_b16 a[162:163], v2 offset:41984
  ds_read_b64_tr_b16 a[164:165], v2 offset:45056
  ds_read_b64_tr_b16 a[166:167], v2 offset:46080
  s_waitcnt lgkmcnt(0)
  s_waitcnt vmcnt(12)
  s_barrier
  ds_read_b64_tr_b16 a[168:169], v2 offset:49152
  ds_read_b64_tr_b16 a[170:171], v2 offset:50176
  ds_read_b64_tr_b16 a[172:173], v2 offset:53248
  ds_read_b64_tr_b16 a[174:175], v2 offset:54272
  ds_read_b64_tr_b16 a[176:177], v2 offset:57344
  ds_read_b64_tr_b16 a[178:179], v2 offset:58368
  ds_read_b64_tr_b16 a[180:181], v2 offset:61440
  ds_read_b64_tr_b16 a[182:183], v2 offset:62464
  ds_read_b64_tr_b16 a[184:185], v3 offset:0
  ds_read_b64_tr_b16 a[186:187], v3 offset:1024
  ds_read_b64_tr_b16 a[188:189], v3 offset:4096
  ds_read_b64_tr_b16 a[190:191], v3 offset:5120
  s_waitcnt lgkmcnt(0)
  s_waitcnt vmcnt(6)
  s_barrier
  ds_read_b64_tr_b16 a[192:193], v3 offset:8192
  ds_read_b64_tr_b16 a[194:195], v3 offset:9216
  ds_read_b64_tr_b16 a[196:197], v3 offset:12288
  ds_read_b64_tr_b16 a[198:199], v3 offset:13312
  ds_read_b64_tr_b16 a[200:201], v3 offset:16384
  ds_read_b64_tr_b16 a[202:203], v3 offset:17408
  ds_read_b64_tr_b16 a[204:205], v3 offset:20480
  ds_read_b64_tr_b16 a[206:207], v3 offset:21504
  ds_read_b64_tr_b16 a[208:209], v3 offset:24576
  ds_read_b64_tr_b16 a[210:211], v3 offset:25600
  ds_read_b64_tr_b16 a[212:213], v3 offset:28672
  ds_read_b64_tr_b16 a[214:215], v3 offset:29696
  s_waitcnt lgkmcnt(0)
  s_waitcnt vmcnt(0)
  s_barrier
  ds_read_b64_tr_b16 a[216:217], v3 offset:32768
  ds_read_b64_tr_b16 a[218:219], v3 offset:33792
  ds_read_b64_tr_b16 a[220:221], v3 offset:36864
  ds_read_b64_tr_b16 a[222:223], v3 offset:37888
  ds_read_b64_tr_b16 a[224:225], v3 offset:40960
  ds_read_b64_tr_b16 a[226:227], v3 offset:41984
  ds_read_b64_tr_b16 a[228:229], v3 offset:45056
  ds_read_b64_tr_b16 a[230:231], v3 offset:46080
  ds_read_b64_tr_b16 a[232:233], v3 offset:49152
  ds_read_b64_tr_b16 a[234:235], v3 offset:50176
  ds_read_b64_tr_b16 a[236:237], v3 offset:53248
  ds_read_b64_tr_b16 a[238:239], v3 offset:54272
  s_waitcnt lgkmcnt(0)
  s_barrier
  v_and_b32 v11, 3, v0
  v_lshlrev_b32 v11, 2, v11
  s_mov_b32 s50, 0
ss_1:
  global_load_dword v10, v11, s[38:39] sc1
  s_add_u32 s50, s50, 1
  s_cmp_gt_u32 s50, 131072
  s_cbranch_scc1 L_fail
  s_waitcnt vmcnt(0)
  v_readlane_b32 s46, v10, 0
  v_readlane_b32 s47, v10, 2
  s_cmp_lg_u32 s46, 0
  s_cselect_b32 s48, 7, 0
  s_add_u32 s46, s46, s2
  s_xor_b32 s49, s46, s43
  s_and_b32 s49, s49, s48
  s_cbranch_scc1 L_reroll
  s_cmp_lg_u32 s47, 0
  s_cbranch_scc1 ss_ok_2
  s_sleep 10
  s_branch ss_1
ss_ok_2:
  v_readlane_b32 s3, v10, 1
  s_nop 0
  s_and_b32 s3, s3, 0x2000
  s_mov_b32 s54, s51
  s_add_u32 s53, s53, 40960
  s_add_u32 m0, s54, 0
  s_nop 0
  buffer_load_dwordx4 v5, s[12:15], s53 offen offset:0 lds
  s_add_u32 m0, s54, 3968
  s_nop 0
  buffer_load_dwordx4 v5, s[12:15], s53 offen offset:128 lds
  s_add_u32 m0, s54, 7936
  s_nop 0
  buffer_load_dwordx4 v5, s[12:15], s53 offen offset:256 lds
  s_add_u32 m0, s54, 11904
  s_nop 0
  buffer_load_dwordx4 v5, s[12:15], s53 offen offset:384 lds
  s_add_u32 m0, s54, 15872
  s_nop 0
  buffer_load_dwordx4 v5, s[12:15], s53 offen offset:512 lds
  s_add_u32 m0, s54, 19840
  s_nop 0
  buffer_load_dwordx4 v5, s[12:15], s53 offen offset:640 lds
  s_add_u32 m0, s54, 23808
  s_nop 0
  buffer_load_dwordx4 v5, s[12:15], s53 offen offset:768 lds
  s_add_u32 m0, s54, 27776
  s_nop 0
  buffer_load_dwordx4 v5, s[12:15], s53 offen offset:896 lds
  s_add_u32 m0, s54, 31744
  s_nop 0
  buffer_load_dwordx4 v5, s[12:15], s53 offen offset:1024 lds
  s_add_u32 m0, s54, 35712
  s_nop 0
  buffer_load_dwordx4 v5, s[12:15], s53 offen offset:1152 lds
  s_mov_b32 s55, 2146435072
  s_mov_b32 s56, 2146435072
  s_mov_b32 s57, 2146435072
  s_xor_b32 s63, s63, s3
  s_mov_b32 s58, 122880
  ds_read_b128 v[16:19], v6 offset:0
  ds_read_b128 v[20:23], v7 offset:0
  ds_read_b128 v[24:27], v6 offset:4096
  ds_read_b128 v[28:31], v7 offset:4096
  s_waitcnt lgkmcnt(3)
pj_loop_3:
  v_mfma_f32_16x16x32_bf16 v[40:43], a[0:3], v[16:19], 0
  ds_read_b128 v[32:35], v6 offset:8192
  v_mfma_f32_16x16x32_bf16 v[48:51], a[4:7], v[16:19], 0
  v_mfma_f32_16x16x32_bf16 v[56:59], a[8:11], v[16:19], 0
  s_waitcnt lgkmcnt(3)
  v_cvt_pk_bf16_f32 v66, v44, v45
  v_mfma_f32_16x16x32_bf16 v[40:43], a[12:15], v[20:23], v[40:43]
  ds_read_b128 v[16:19], v7 offset:8192
  v_cvt_pk_bf16_f32 v67, v46, v47
  v_mfma_f32_16x16x32_bf16 v[48:51], a[16:19], v[20:23], v[48:51]
  v_cvt_pk_bf16_f32 v70, v52, v53
  v_mfma_f32_16x16x32_bf16 v[56:59], a[20:23], v[20:23], v[56:59]
  s_waitcnt lgkmcnt(3)
  v_cvt_pk_bf16_f32 v71, v54, v55
  v_mfma_f32_16x16x32_bf16 v[40:43], a[24:27], v[24:27], v[40:43]
  ds_read_b128 v[20:23], v6 offset:12288
  v_cvt_pk_bf16_f32 v74, v60, v61
  v_mfma_f32_16x16x32_bf16 v[48:51], a[28:31], v[24:27], v[48:51]
  v_cvt_pk_bf16_f32 v75, v62, v63
  v_mfma_f32_16x16x32_bf16 v[56:59], a[32:35], v[24:27], v[56:59]
  s_waitcnt lgkmcnt(3)
  v_mfma_f32_16x16x32_bf16 v[40:43], a[36:39], v[28:31], v[40:43]
  ds_read_b128 v[24:27], v7 offset:12288
  v_permlane16_swap_b32 v64, v66
  v_mfma_f32_16x16x32_bf16 v[48:51], a[40:43], v[28:31], v[48:51]
  v_permlane16_swap_b32 v65, v67
  v_mfma_f32_16x16x32_bf16 v[56:59], a[44:47], v[28:31], v[56:59]
  buffer_store_dwordx4 v[64:67], v8, s[8:11], s55 offen sc1
  s_waitcnt lgkmcnt(3)
  v_mfma_f32_16x16x32_bf16 v[40:43], a[48:51], v[32:35], v[40:43]
  ds_read_b128 v[28:31], v6 offset:16384
  v_permlane16_swap_b32 v68, v70
  v_mfma_f32_16x16x32_bf16 v[48:51], a[52:55], v[32:35], v[48:51]
  v_permlane16_swap_b32 v69, v71
  v_mfma_f32_16x16x32_bf16 v[56:59], a[56:59], v[32:35], v[56:59]
  buffer_store_dwordx4 v[68:71], v8, s[8:11], s56 offen sc1
  s_waitcnt lgkmcnt(3)
  v_mfma_f32_16x16x32_bf16 v[40:43], a[60:63], v[16:19], v[40:43]
  ds_read_b128 v[32:35], v7 offset:16384
  v_permlane16_swap_b32 v72, v74
  v_mfma_f32_16x16x32_bf16 v[48:51], a[64:67], v[16:19], v[48:51]
  v_permlane16_swap_b32 v73, v75
  v_mfma_f32_16x16x32_bf16 v[56:59], a[68:71], v[16:19], v[56:59]
  buffer_store_dwordx4 v[72:75], v8, s[8:11], s57 offen sc1
  s_waitcnt lgkmcnt(3)
  v_mfma_f32_16x16x32_bf16 v[40:43], a[72:75], v[20:23], v[40:43]
  ds_read_b128 v[16:19], v6 offset:20480
  v_mfma_f32_16x16x32_bf16 v[48:51], a[76:79], v[20:23], v[48:51]
  v_mfma_f32_16x16x32_bf16 v[56:59], a[80:83], v[20:23], v[56:59]
  s_waitcnt lgkmcnt(3)
  v_mfma_f32_16x16x32_bf16 v[40:43], a[84:87], v[24:27], v[40:43]
  ds_read_b128 v[20:23], v7 offset:20480
  v_mfma_f32_16x16x32_bf16 v[48:51], a[88:91], v[24:27], v[48:51]
  v_mov_b32 v10, s52
  v_mfma_f32_16x16x32_bf16 v[56:59], a[92:95], v[24:27], v[56:59]
  s_waitcnt lgkmcnt(3)
  v_mfma_f32_16x16x32_bf16 v[40:43], a[96:99], v[28:31], v[40:43]
  ds_read_b128 v[24:27], v6 offset:24576
  v_mfma_f32_16x16x32_bf16 v[48:51], a[100:103], v[28:31], v[48:51]
  s_add_u32 s53, s53, 40960
  s_add_u32 s54, s54, 40960
  v_mfma_f32_16x16x32_bf16 v[56:59], a[104:107], v[28:31], v[56:59]
  s_waitcnt lgkmcnt(3)
  v_mfma_f32_16x16x32_bf16 v[40:43], a[108:111], v[32:35], v[40:43]
  ds_read_b128 v[28:31], v7 offset:24576
  v_mfma_f32_16x16x32_bf16 v[48:51], a[112:115], v[32:35], v[48:51]
  s_cmp_ge_u32 s54, 163840
  s_cselect_b32 s54, s51, s54
  v_mfma_f32_16x16x32_bf16 v[56:59], a[116:119], v[32:35], v[56:59]
  s_waitcnt lgkmcnt(3)
  v_mfma_f32_16x16x32_bf16 v[40:43], a[120:123], v[16:19], v[40:43]
  ds_read_b128 v[32:35], v6 offset:28672
  v_mfma_f32_16x16x32_bf16 v[48:51], a[124:127], v[16:19], v[48:51]
  s_cmp_eq_u32 s58, 122880
  s_cselect_b32 s59, 163840, 0
  v_mfma_f32_16x16x32_bf16 v[56:59], a[128:131], v[16:19], v[56:59]
  s_waitcnt lgkmcnt(3)
  v_mfma_f32_16x16x32_bf16 v[40:43], a[132:135], v[20:23], v[40:43]
  ds_read_b128 v[16:19], v7 offset:28672
  v_mfma_f32_16x16x32_bf16 v[48:51], a[136:139], v[20:23], v[48:51]
  s_sub_u32 s59, 40960, s59
  s_add_u32 s58, s58, s59
  v_mfma_f32_16x16x32_bf16 v[56:59], a[140:143], v[20:23], v[56:59]
  s_waitcnt lgkmcnt(3)
  v_mfma_f32_16x16x32_bf16 v[40:43], a[144:147], v[24:27], v[40:43]
  ds_read_b128 v[20:23], v6 offset:32768
  v_mfma_f32_16x16x32_bf16 v[48:51], a[148:151], v[24:27], v[48:51]
  s_lshr_b32 s55, s67, 1
  v_mfma_f32_16x16x32_bf16 v[56:59], a[152:155], v[24:27], v[56:59]
  s_lshl_b32 s55, s55, 14
  s_waitcnt lgkmcnt(3)
  v_mfma_f32_16x16x32_bf16 v[40:43], a[156:159], v[28:31], v[40:43]
  ds_read_b128 v[24:27], v7 offset:32768
  v_mfma_f32_16x16x32_bf16 v[48:51], a[160:163], v[28:31], v[48:51]
  s_and_b32 s56, s67, 1
  v_mfma_f32_16x16x32_bf16 v[56:59], a[164:167], v[28:31], v[56:59]
  s_lshl_b32 s56, s56, 12
  s_waitcnt lgkmcnt(3)
  v_mfma_f32_16x16x32_bf16 v[40:43], a[168:171], v[32:35], v[40:43]
  ds_read_b128 v[28:31], v6 offset:36864
  v_mfma_f32_16x16x32_bf16 v[48:51], a[172:175], v[32:35], v[48:51]
  s_add_u32 s55, s55, s56
  v_mfma_f32_16x16x32_bf16 v[56:59], a[176:179], v[32:35], v[56:59]
  s_add_u32 s55, s55, s63
  s_waitcnt lgkmcnt(3)
  v_mfma_f32_16x16x32_bf16 v[40:43], a[180:183], v[16:19], v[40:43]
  ds_read_b128 v[32:35], v7 offset:36864
  v_mfma_f32_16x16x32_bf16 v[48:51], a[184:187], v[16:19], v[48:51]
  s_lshr_b32 s56, s55, 8
  v_mfma_f32_16x16x32_bf16 v[56:59], a[188:191], v[16:19], v[56:59]
  s_and_b32 s56, s56, 0x2000
  s_waitcnt lgkmcnt(3)
  v_mfma_f32_16x16x32_bf16 v[40:43], a[192:195], v[20:23], v[40:43]
  ds_read_b128 v[16:19], v6 offset:2048
  v_mfma_f32_16x16x32_bf16 v[48:51], a[196:199], v[20:23], v[48:51]
  s_xor_b32 s55, s55, s56
  v_mfma_f32_16x16x32_bf16 v[56:59], a[200:203], v[20:23], v[56:59]
  s_add_u32 s67, s67, 32
  s_waitcnt lgkmcnt(3)
  v_mfma_f32_16x16x32_bf16 v[40:43], a[204:207], v[24:27], v[40:43]
  ds_read_b128 v[20:23], v7 offset:2048
  v_mfma_f32_16x16x32_bf16 v[48:51], a[208:211], v[24:27], v[48:51]
  s_cmp_ge_u32 s67, 1024
  s_cselect_b32 s56, 1024, 0
  v_mfma_f32_16x16x32_bf16 v[56:59], a[212:215], v[24:27], v[56:59]
  s_sub_u32 s67, s67, s56
  s_waitcnt lgkmcnt(3)
  v_mfma_f32_16x16x32_bf16 v[40:43], a[216:219], v[28:31], v[40:43]
  ds_read_b128 v[24:27], v6 offset:6144
  v_mfma_f32_16x16x32_bf16 v[48:51], a[220:223], v[28:31], v[48:51]
  s_add_u32 s56, s55, 16777216
  v_mfma_f32_16x16x32_bf16 v[56:59], a[224:227], v[28:31], v[56:59]
  s_add_u32 s57, s55, 33554432
  s_waitcnt lgkmcnt(3)
  v_mfma_f32_16x16x32_bf16 v[40:43], a[228:231], v[32:35], v[40:43]
  ds_read_b128 v[28:31], v7 offset:6144
  v_mfma_f32_16x16x32_bf16 v[48:51], a[232:235], v[32:35], v[48:51]
  v_mfma_f32_16x16x32_bf16 v[56:59], a[236:239], v[32:35], v[56:59]
  s_waitcnt lgkmcnt(3)
  v_mfma_f32_16x16x32_bf16 v[44:47], a[0:3], v[16:19], 0
  ds_read_b128 v[32:35], v6 offset:10240
  v_mfma_f32_16x16x32_bf16 v[52:55], a[4:7], v[16:19], 0
  v_mfma_f32_16x16x32_bf16 v[60:63], a[8:11], v[16:19], 0
  s_waitcnt lgkmcnt(3)
  v_cvt_pk_bf16_f32 v64, v40, v41
  v_mfma_f32_16x16x32_bf16 v[44:47], a[12:15], v[20:23], v[44:47]
  ds_read_b128 v[16:19], v7 offset:10240
  v_cvt_pk_bf16_f32 v65, v42, v43
  v_mfma_f32_16x16x32_bf16 v[52:55], a[16:19], v[20:23], v[52:55]
  v_cvt_pk_bf16_f32 v68, v48, v49
  v_mfma_f32_16x16x32_bf16 v[60:63], a[20:23], v[20:23], v[60:63]
  s_waitcnt lgkmcnt(3)
  v_cvt_pk_bf16_f32 v69, v50, v51
  v_mfma_f32_16x16x32_bf16 v[44:47], a[24:27], v[24:27], v[44:47]
  ds_read_b128 v[20:23], v6 offset:14336
  v_cvt_pk_bf16_f32 v72, v56, v57
  v_mfma_f32_16x16x32_bf16 v[52:55], a[28:31], v[24:27], v[52:55]
  v_cvt_pk_bf16_f32 v73, v58, v59
  v_mfma_f32_16x16x32_bf16 v[60:63], a[32:35], v[24:27], v[60:63]
  s_waitcnt lgkmcnt(3)
  v_mfma_f32_16x16x32_bf16 v[44:47], a[36:39], v[28:31], v[44:47]
  ds_read_b128 v[24:27], v7 offset:14336
  v_mfma_f32_16x16x32_bf16 v[52:55], a[40:43], v[28:31], v[52:55]
  s_waitcnt vmcnt(0)
  s_barrier
  v_mfma_f32_16x16x32_bf16 v[60:63], a[44:47], v[28:31], v[60:63]
  buffer_store_dword v10, v9, s[8:11], 0 offen sc1
  s_waitcnt lgkmcnt(3)
  v_mfma_f32_16x16x32_bf16 v[44:47], a[48:51], v[32:35], v[44:47]
  ds_read_b128 v[28:31], v6 offset:18432
  s_add_u32 m0, s54, 0
  v_mfma_f32_16x16x32_bf16 v[52:55], a[52:55], v[32:35], v[52:55]
  buffer_load_dwordx4 v5, s[12:15], s53 offen offset:0 lds
  v_mfma_f32_16x16x32_bf16 v[60:63], a[56:59], v[32:35], v[60:63]
  s_waitcnt lgkmcnt(3)
  v_mfma_f32_16x16x32_bf16 v[44:47], a[60:63], v[16:19], v[44:47]
  ds_read_b128 v[32:35], v7 offset:18432
  s_add_u32 m0, s54, 3968
  v_mfma_f32_16x16x32_bf16 v[52:55], a[64:67], v[16:19], v[52:55]
  buffer_load_dwordx4 v5, s[12:15], s53 offen offset:128 lds
  v_mfma_f32_16x16x32_bf16 v[60:63], a[68:71], v[16:19], v[60:63]
  s_waitcnt lgkmcnt(3)
  v_mfma_f32_16x16x32_bf16 v[44:47], a[72:75], v[20:23], v[44:47]
  ds_read_b128 v[16:19], v6 offset:22528
  s_add_u32 m0, s54, 7936
  v_mfma_f32_16x16x32_bf16 v[52:55], a[76:79], v[20:23], v[52:55]
  buffer_load_dwordx4 v5, s[12:15], s53 offen offset:256 lds
  v_mfma_f32_16x16x32_bf16 v[60:63], a[80:83], v[20:23], v[60:63]
  s_waitcnt lgkmcnt(3)
  v_mfma_f32_16x16x32_bf16 v[44:47], a[84:87], v[24:27], v[44:47]
  ds_read_b128 v[20:23], v7 offset:22528
  s_add_u32 m0, s54, 11904
  v_mfma_f32_16x16x32_bf16 v[52:55], a[88:91], v[24:27], v[52:55]
  buffer_load_dwordx4 v5, s[12:15], s53 offen offset:384 lds
  v_mfma_f32_16x16x32_bf16 v[60:63], a[92:95], v[24:27], v[60:63]
  s_waitcnt lgkmcnt(3)
  v_mfma_f32_16x16x32_bf16 v[44:47], a[96:99], v[28:31], v[44:47]
  ds_read_b128 v[24:27], v6 offset:26624
  s_add_u32 m0, s54, 15872
  v_mfma_f32_16x16x32_bf16 v[52:55], a[100:103], v[28:31], v[52:55]
  buffer_load_dwordx4 v5, s[12:15], s53 offen offset:512 lds
  v_mfma_f32_16x16x32_bf16 v[60:63], a[104:107], v[28:31], v[60:63]
  s_waitcnt lgkmcnt(3)
  v_mfma_f32_16x16x32_bf16 v[44:47], a[108:111], v[32:35], v[44:47]
  ds_read_b128 v[28:31], v7 offset:26624
  s_add_u32 m0, s54, 19840
  v_mfma_f32_16x16x32_bf16 v[52:55], a[112:115], v[32:35], v[52:55]
  buffer_load_dwordx4 v5, s[12:15], s53 offen offset:640 lds
  v_mfma_f32_16x16x32_bf16 v[60:63], a[116:119], v[32:35], v[60:63]
  s_waitcnt lgkmcnt(3)
  v_mfma_f32_16x16x32_bf16 v[44:47], a[120:123], v[16:19], v[44:47]
  ds_read_b128 v[32:35], v6 offset:30720
  s_add_u32 m0, s54, 23808
  v_mfma_f32_16x16x32_bf16 v[52:55], a[124:127], v[16:19], v[52:55]
  buffer_load_dwordx4 v5, s[12:15], s53 offen offset:768 lds
  v_mfma_f32_16x16x32_bf16 v[60:63], a[128:131], v[16:19], v[60:63]
  s_waitcnt lgkmcnt(3)
  v_mfma_f32_16x16x32_bf16 v[44:47], a[132:135], v[20:23], v[44:47]
  ds_read_b128 v[16:19], v7 offset:30720
  s_add_u32 m0, s54, 27776
  v_mfma_f32_16x16x32_bf16 v[52:55], a[136:139], v[20:23], v[52:55]
  buffer_load_dwordx4 v5, s[12:15], s53 offen offset:896 lds
  v_mfma_f32_16x16x32_bf16 v[60:63], a[140:143], v[20:23], v[60:63]
  s_waitcnt lgkmcnt(3)
  v_mfma_f32_16x16x32_bf16 v[44:47], a[144:147], v[24:27], v[44:47]
  ds_read_b128 v[20:23], v6 offset:34816
  s_add_u32 m0, s54, 31744
  v_mfma_f32_16x16x32_bf16 v[52:55], a[148:151], v[24:27], v[52:55]
  buffer_load_dwordx4 v5, s[12:15], s53 offen offset:1024 lds
  v_mfma_f32_16x16x32_bf16 v[60:63], a[152:155], v[24:27], v[60:63]
  s_waitcnt lgkmcnt(3)
  v_mfma_f32_16x16x32_bf16 v[44:47], a[156:159], v[28:31], v[44:47]
  ds_read_b128 v[24:27], v7 offset:34816
  s_add_u32 m0, s54, 35712
  v_mfma_f32_16x16x32_bf16 v[52:55], a[160:163], v[28:31], v[52:55]
  buffer_load_dwordx4 v5, s[12:15], s53 offen offset:1152 lds
  v_mfma_f32_16x16x32_bf16 v[60:63], a[164:167], v[28:31], v[60:63]
  s_waitcnt lgkmcnt(3)
  v_mfma_f32_16x16x32_bf16 v[44:47], a[168:171], v[32:35], v[44:47]
  ds_read_b128 v[28:31], v6 offset:38912
  v_mfma_f32_16x16x32_bf16 v[52:55], a[172:175], v[32:35], v[52:55]
  s_max_u32 s69, s52, 25
  s_sub_u32 s69, s69, 25
  v_mfma_f32_16x16x32_bf16 v[60:63], a[176:179], v[32:35], v[60:63]
  s_cmp_eq_u32 s52, s70
  s_cbranch_scc1 pj_warm
pj_wback:
  s_waitcnt lgkmcnt(3)
  v_mfma_f32_16x16x32_bf16 v[44:47], a[180:183], v[16:19], v[44:47]
  ds_read_b128 v[32:35], v7 offset:38912
  v_mfma_f32_16x16x32_bf16 v[52:55], a[184:187], v[16:19], v[52:55]
  v_add_u32 v6, s59, v6
  v_add_u32 v7, s59, v7
  v_mfma_f32_16x16x32_bf16 v[60:63], a[188:191], v[16:19], v[60:63]
  s_waitcnt lgkmcnt(3)
  v_mfma_f32_16x16x32_bf16 v[44:47], a[192:195], v[20:23], v[44:47]
  ds_read_b128 v[16:19], v6 offset:0
  v_mfma_f32_16x16x32_bf16 v[52:55], a[196:199], v[20:23], v[52:55]
  s_cmp_lt_u32 s68, s69
  s_cbranch_scc1 pj_slow
pj_back:
  v_mfma_f32_16x16x32_bf16 v[60:63], a[200:203], v[20:23], v[60:63]
  s_waitcnt lgkmcnt(3)
  v_mfma_f32_16x16x32_bf16 v[44:47], a[204:207], v[24:27], v[44:47]
  ds_read_b128 v[20:23], v7 offset:0
  v_mfma_f32_16x16x32_bf16 v[52:55], a[208:211], v[24:27], v[52:55]
  s_add_u32 s52, s52, 1
  v_mfma_f32_16x16x32_bf16 v[60:63], a[212:215], v[24:27], v[60:63]
  s_waitcnt lgkmcnt(3)
  v_mfma_f32_16x16x32_bf16 v[44:47], a[216:219], v[28:31], v[44:47]
  ds_read_b128 v[24:27], v6 offset:4096
  v_mfma_f32_16x16x32_bf16 v[52:55], a[220:223], v[28:31], v[52:55]
  v_mfma_f32_16x16x32_bf16 v[60:63], a[224:227], v[28:31], v[60:63]
  s_waitcnt lgkmcnt(3)
  v_mfma_f32_16x16x32_bf16 v[44:47], a[228:231], v[32:35], v[44:47]
  ds_read_b128 v[28:31], v7 offset:4096
  v_mfma_f32_16x16x32_bf16 v[52:55], a[232:235], v[32:35], v[52:55]
  s_cmp_lt_u32 s52, s62
  v_mfma_f32_16x16x32_bf16 v[60:63], a[236:239], v[32:35], v[60:63]
  s_waitcnt lgkmcnt(3)
  s_cbranch_scc1 pj_loop_3
  v_cvt_pk_bf16_f32 v66, v44, v45
  v_cvt_pk_bf16_f32 v67, v46, v47
  s_nop 1
  v_cvt_pk_bf16_f32 v70, v52, v53
  v_cvt_pk_bf16_f32 v71, v54, v55
  v_cvt_pk_bf16_f32 v74, v60, v61
  v_cvt_pk_bf16_f32 v75, v62, v63
  v_permlane16_swap_b32 v64, v66
  v_permlane16_swap_b32 v65, v67
  v_permlane16_swap_b32 v68, v70
  v_permlane16_swap_b32 v69, v71
  v_permlane16_swap_b32 v72, v74
  v_permlane16_swap_b32 v73, v75
  buffer_store_dwordx4 v[64:67], v8, s[8:11], s55 offen sc1
  buffer_store_dwordx4 v[68:71], v8, s[8:11], s56 offen sc1
  buffer_store_dwordx4 v[72:75], v8, s[8:11], s57 offen sc1
  v_mov_b32 v10, s52
  s_waitcnt vmcnt(0) lgkmcnt(0)
  s_barrier
  buffer_store_dword v10, v9, s[8:11], 0 offen sc1
  s_branch pj_done
pj_slow:
  s_cmp_ge_u32 s68, s69
  s_cbranch_scc1 wf_done_4
  s_mov_b32 s50, 0
wf_loop_5:
  buffer_load_dword v11, v14, s[8:11], 0 offen sc1
  s_add_u32 s50, s50, 1
  s_cmp_gt_u32 s50, 131072
  s_cbranch_scc1 L_fail
  s_waitcnt vmcnt(0)
  v_readfirstlane_b32 s68, v11
  s_nop 0
  s_cmp_ge_u32 s68, s69
  s_cbranch_scc1 wf_done_4
  s_sleep 2
  s_branch wf_loop_5
wf_done_4:
  s_branch pj_back
pj_warm:
  s_lshl_b32 s46, s44, 2
  s_add_u32 s46, s46, s43
  s_sub_u32 s46, s46, 4
  s_lshl_b32 s46, s46, 2
  s_add_u32 s46, s46, s42
  s_lshl_b32 s46, s46, 13
  v_lshlrev_b32 v11, 7, v0
  s_mov_b32 s4, s16
  s_mov_b32 s5, s17
  s_mov_b32 s6, 2621440
  s_mov_b32 s7, 0x20000
  buffer_load_dword v12, v11, s[4:7], s46 offen
  s_mov_b32 s4, s18
  s_mov_b32 s5, s19
  s_mov_b32 s6, 2457600
  s_mov_b32 s7, 0x20000
  buffer_load_dword v12, v11, s[4:7], s46 offen
  s_mov_b32 s4, s20
  s_mov_b32 s5, s21
  s_mov_b32 s6, 819200
  s_mov_b32 s7, 0x20000
  buffer_load_dword v12, v11, s[4:7], s46 offen
  s_branch pj_wback
pj_done:
  s_branch L_parta
L_uw:
  s_mov_b32 s4, s32
  s_mov_b32 s5, s33
  s_mov_b32 s6, 7864320
  s_mov_b32 s7, 0x20000
  v_lshrrev_b32 v8, 3, v0
  v_lshrrev_b32 v9, 2, v8
  v_lshlrev_b32 v9, 3, v9
  v_and_b32 v1, 3, v8
  v_add_u32 v1, v1, v9
  s_and_b32 s46, s42, 1
  s_lshl_b32 s46, s46, 2
  s_lshr_b32 s47, s42, 1
  s_lshl_b32 s47, s47, 4
  s_add_u32 s46, s46, s47
  v_add_u32 v1, s46, v1
  v_mul_u32_u24 v1, 1280, v1
  v_lshrrev_b32 v8, 1, v8
  v_bfe_u32 v9, v0, 1, 2
  v_xor_b32 v8, v8, v9
  v_lshlrev_b32 v8, 5, v8
  v_and_b32 v9, 1, v0
  v_lshlrev_b32 v9, 4, v9
  v_add3_u32 v1, v1, v8, v9
  v_lshrrev_b32 v8, 5, v0
  v_lshlrev_b32 v2, 11, v8
  v_bfe_u32 v8, v0, 2, 3
  v_lshl_add_u32 v2, v8, 7, v2
  v_lshrrev_b32 v8, 1, v8
  v_xor_b32 v8, s42, v8
  v_lshl_add_u32 v2, v8, 5, v2
  v_and_b32 v8, 3, v0
  v_lshl_add_u32 v2, v8, 3, v2
  v_add_u32 v3, 0x10000, v2
  v_add_u32 v4, 0x20000, v2
  s_mul_i32 s53, s45, 245760
  v_lshlrev_b32 v5, 4, v0
  s_lshl_b32 s46, s45, 7
  s_add_u32 s47, s46, 1056768
  v_mov_b32 v6, s47
  s_lshl_b32 s47, s42, 2
  s_add_u32 s46, s46, s47
  s_add_u32 s46, s46, 1060864
  v_mov_b32 v7, s46
  v_mov_b32 v8, 2146435072
  v_cmp_eq_u32 vcc, 0, v0
  s_nop 1
  v_cndmask_b32 v7, v8, v7, vcc
  v_cndmask_b32 v6, v8, v6, vcc
  s_mov_b32 s60, s51
  s_add_u32 s61, s51, 81797120
  s_mov_b32 s62, s45
  v_mov_b32 v12, v5
  s_lshr_b32 s55, s45, 3
  s_lshl_b32 s55, s55, 14
  s_and_b32 s46, s45, 7
  s_lshl_b32 s46, s46, 10
  s_add_u32 s55, s55, s46
  s_lshl_b32 s46, s42, 16
  s_add_u32 s55, s55, s46
  s_add_u32 s55, s55, 81788928
  s_mov_b32 s52, 0
  s_mov_b32 s56, 0
  s_add_u32 m0, s51, 0
  s_add_u32 s46, s53, 0
  buffer_load_dwordx4 v1, s[4:7], s46 offen lds
  s_add_u32 m0, s51, 4096
  s_add_u32 s46, s53, 128
  buffer_load_dwordx4 v1, s[4:7], s46 offen lds
  s_add_u32 m0, s51, 8192
  s_add_u32 s46, s53, 256
  buffer_load_dwordx4 v1, s[4:7], s46 offen lds
  s_add_u32 m0, s51, 12288
  s_add_u32 s46, s53, 384
  buffer_load_dwordx4 v1, s[4:7], s46 offen lds
  s_add_u32 m0, s51, 16384
  s_add_u32 s46, s53, 512
  buffer_load_dwordx4 v1, s[4:7], s46 offen lds
  s_add_u32 m0, s51, 20480
  s_add_u32 s46, s53, 640
  buffer_load_dwordx4 v1, s[4:7], s46 offen lds
  s_add_u32 m0, s51, 24576
  s_add_u32 s46, s53, 768
  buffer_load_dwordx4 v1, s[4:7], s46 offen lds
  s_add_u32 m0, s51, 28672
  s_add_u32 s46, s53, 896
  buffer_load_dwordx4 v1, s[4:7], s46 offen lds
  s_add_u32 m0, s51, 32768
  s_add_u32 s46, s53, 1024
  buffer_load_dwordx4 v1, s[4:7], s46 offen lds
  s_add_u32 m0, s51, 36864
  s_add_u32 s46, s53, 1152
  buffer_load_dwordx4 v1, s[4:7], s46 offen lds
  s_add_u32 m0, s51, 40960
  s_add_u32 s46, s53, 40960
  buffer_load_dwordx4 v1, s[4:7], s46 offen lds
  s_add_u32 m0, s51, 45056
  s_add_u32 s46, s53, 41088
  buffer_load_dwordx4 v1, s[4:7], s46 offen lds
  s_add_u32 m0, s51, 49152
  s_add_u32 s46, s53, 41216
  buffer_load_dwordx4 v1, s[4:7], s46 offen lds
  s_add_u32 m0, s51, 53248
  s_add_u32 s46, s53, 41344
  buffer_load_dwordx4 v1, s[4:7], s46 offen lds
  s_add_u32 m0, s51, 57344
  s_add_u32 s46, s53, 41472
  buffer_load_dwordx4 v1, s[4:7], s46 offen lds
  s_add_u32 m0, s51, 61440
  s_add_u32 s46, s53, 41600
  buffer_load_dwordx4 v1, s[4:7], s46 offen lds
  s_add_u32 m0, s51, 65536
  s_add_u32 s46, s53, 41728
  buffer_load_dwordx4 v1, s[4:7], s46 offen lds
  s_add_u32 m0, s51, 69632
  s_add_u32 s46, s53, 41856
  buffer_load_dwordx4 v1, s[4:7], s46 offen lds
  s_add_u32 m0, s51, 73728
  s_add_u32 s46, s53, 41984
  buffer_load_dwordx4 v1, s[4:7], s46 offen lds
  s_add_u32 m0, s51, 77824
  s_add_u32 s46, s53, 42112
  buffer_load_dwordx4 v1, s[4:7], s46 offen lds
  s_add_u32 m0, s51, 81920
  s_add_u32 s46, s53, 81920
  buffer_load_dwordx4 v1, s[4:7], s46 offen lds
  s_add_u32 m0, s51, 86016
  s_add_u32 s46, s53, 82048
  buffer_load_dwordx4 v1, s[4:7], s46 offen lds
  s_add_u32 m0, s51, 90112
  s_add_u32 s46, s53, 82176
  buffer_load_dwordx4 v1, s[4:7], s46 offen lds
  s_add_u32 m0, s51, 94208
  s_add_u32 s46, s53, 82304
  buffer_load_dwordx4 v1, s[4:7], s46 offen lds
  s_add_u32 m0, s51, 98304
  s_add_u32 s46, s53, 82432
  buffer_load_dwordx4 v1, s[4:7], s46 offen lds
  s_add_u32 m0, s51, 102400
  s_add_u32 s46, s53, 82560
  buffer_load_dwordx4 v1, s[4:7], s46 offen lds
  s_add_u32 m0, s51, 106496
  s_add_u32 s46, s53, 82688
  buffer_load_dwordx4 v1, s[4:7], s46 offen lds
  s_add_u32 m0, s51, 110592
  s_add_u32 s46, s53, 82816
  buffer_load_dwordx4 v1, s[4:7], s46 offen lds
  s_add_u32 m0, s51, 114688
  s_add_u32 s46, s53, 82944
  buffer_load_dwordx4 v1, s[4:7], s46 offen lds
  s_add_u32 m0, s51, 118784
  s_add_u32 s46, s53, 83072
  buffer_load_dwordx4 v1, s[4:7], s46 offen lds
  s_waitcnt vmcnt(24)
  s_barrier
  s_add_u32 m0, s51, 122880
  s_add_u32 s46, s53, 122880
  buffer_load_dwordx4 v1, s[4:7], s46 offen lds
  s_add_u32 m0, s51, 126976
  s_add_u32 s46, s53, 123008
  buffer_load_dwordx4 v1, s[4:7], s46 offen lds
  s_add_u32 m0, s51, 131072
  s_add_u32 s46, s53, 123136
  buffer_load_dwordx4 v1, s[4:7], s46 offen lds
  s_add_u32 m0, s51, 135168
  s_add_u32 s46, s53, 123264
  buffer_load_dwordx4 v1, s[4:7], s46 offen lds
  s_add_u32 m0, s51, 139264
  s_add_u32 s46, s53, 123392
  buffer_load_dwordx4 v1, s[4:7], s46 offen lds
  s_add_u32 m0, s51, 143360
  s_add_u32 s46, s53, 123520
  buffer_load_dwordx4 v1, s[4:7], s46 offen lds
  ds_read_b64_tr_b16 a[0:1], v2 offset:0
  ds_read_b64_tr_b16 a[2:3], v2 offset:1024
  ds_read_b64_tr_b16 a[24:25], v2 offset:4096
  ds_read_b64_tr_b16 a[26:27], v2 offset:5120
  ds_read_b64_tr_b16 a[48:49], v2 offset:8192
  ds_read_b64_tr_b16 a[50:51], v2 offset:9216
  ds_read_b64_tr_b16 a[72:73], v2 offset:12288
  ds_read_b64_tr_b16 a[74:75], v2 offset:13312
  ds_read_b64_tr_b16 a[96:97], v2 offset:16384
  ds_read_b64_tr_b16 a[98:99], v2 offset:17408
  ds_read_b64_tr_b16 a[120:121], v2 offset:20480
  ds_read_b64_tr_b16 a[122:123], v2 offset:21504
  s_waitcnt lgkmcnt(0)
  s_waitcnt vmcnt(24)
  s_barrier
  s_add_u32 m0, s51, 0
  s_add_u32 s46, s53, 123648
  buffer_load_dwordx4 v1, s[4:7], s46 offen lds
  s_add_u32 m0, s51, 4096
  s_add_u32 s46, s53, 123776
  buffer_load_dwordx4 v1, s[4:7], s46 offen lds
  s_add_u32 m0, s51, 8192
  s_add_u32 s46, s53, 123904
  buffer_load_dwordx4 v1, s[4:7], s46 offen lds
  s_add_u32 m0, s51, 12288
  s_add_u32 s46, s53, 124032
  buffer_load_dwordx4 v1, s[4:7], s46 offen lds
  s_add_u32 m0, s51, 16384
  s_add_u32 s46, s53, 163840
  buffer_load_dwordx4 v1, s[4:7], s46 offen lds
  s_add_u32 m0, s51, 20480
  s_add_u32 s46, s53, 163968
  buffer_load_dwordx4 v1, s[4:7], s46 offen lds
  ds_read_b64_tr_b16 a[144:145], v2 offset:24576
  ds_read_b64_tr_b16 a[146:147], v2 offset:25600
  ds_read_b64_tr_b16 a[168:169], v2 offset:28672
  ds_read_b64_tr_b16 a[170:171], v2 offset:29696
  ds_read_b64_tr_b16 a[192:193], v2 offset:32768
  ds_read_b64_tr_b16 a[194:195], v2 offset:33792
  ds_read_b64_tr_b16 a[216:217], v2 offset:36864
  ds_read_b64_tr_b16 a[218:219], v2 offset:37888
  ds_read_b64_tr_b16 a[4:5], v2 offset:40960
  ds_read_b64_tr_b16 a[6:7], v2 offset:41984
  ds_read_b64_tr_b16 a[28:29], v2 offset:45056
  ds_read_b64_tr_b16 a[30:31], v2 offset:46080
  s_waitcnt lgkmcnt(0)
  s_waitcnt vmcnt(24)
  s_barrier
  s_add_u32 m0, s51, 24576
  s_add_u32 s46, s53, 164096
  buffer_load_dwordx4 v1, s[4:7], s46 offen lds
  s_add_u32 m0, s51, 28672
  s_add_u32 s46, s53, 164224
  buffer_load_dwordx4 v1, s[4:7], s46 offen lds
  s_add_u32 m0, s51, 32768
  s_add_u32 s46, s53, 164352
  buffer_load_dwordx4 v1, s[4:7], s46 offen lds
  s_add_u32 m0, s51, 36864
  s_add_u32 s46, s53, 164480
  buffer_load_dwordx4 v1, s[4:7], s46 offen lds
  s_add_u32 m0, s51, 40960
  s_add_u32 s46, s53, 164608
  buffer_load_dwordx4 v1, s[4:7], s46 offen lds
  s_add_u32 m0, s51, 45056
  s_add_u32 s46, s53, 164736
  buffer_load_dwordx4 v1, s[4:7], s46 offen lds
  ds_read_b64_tr_b16 a[52:53], v2 offset:49152
  ds_read_b64_tr_b16 a[54:55], v2 offset:50176
  ds_read_b64_tr_b16 a[76:77], v2 offset:53248
  ds_read_b64_tr_b16 a[78:79], v2 offset:54272
  ds_read_b64_tr_b16 a[100:101], v2 offset:57344
  ds_read_b64_tr_b16 a[102:103], v2 offset:58368
  ds_read_b64_tr_b16 a[124:125], v2 offset:61440
  ds_read_b64_tr_b16 a[126:127], v2 offset:62464
  ds_read_b64_tr_b16 a[148:149], v3 offset:0
  ds_read_b64_tr_b16 a[150:151], v3 offset:1024
  ds_read_b64_tr_b16 a[172:173], v3 offset:4096
  ds_read_b64_tr_b16 a[174:175], v3 offset:5120
  s_waitcnt lgkmcnt(0)
  s_waitcnt vmcnt(24)
  s_barrier
  s_add_u32 m0, s51, 49152
  s_add_u32 s46, s53, 164864
  buffer_load_dwordx4 v1, s[4:7], s46 offen lds
  s_add_u32 m0, s51, 53248
  s_add_u32 s46, s53, 164992
  buffer_load_dwordx4 v1, s[4:7], s46 offen lds
  s_add_u32 m0, s51, 57344
  s_add_u32 s46, s53, 204800
  buffer_load_dwordx4 v1, s[4:7], s46 offen lds
  s_add_u32 m0, s51, 61440
  s_add_u32 s46, s53, 204928
  buffer_load_dwordx4 v1, s[4:7], s46 offen lds
  s_add_u32 m0, s51, 65536
  s_add_u32 s46, s53, 205056
  buffer_load_dwordx4 v1, s[4:7], s46 offen lds
  s_add_u32 m0, s51, 69632
  s_add_u32 s46, s53, 205184
  buffer_load_dwordx4 v1, s[4:7], s46 offen lds
  ds_read_b64_tr_b16 a[196:197], v3 offset:8192
  ds_read_b64_tr_b16 a[198:199], v3 offset:9216
  ds_read_b64_tr_b16 a[220:221], v3 offset:12288
  ds_read_b64_tr_b16 a[222:223], v3 offset:13312
  ds_read_b64_tr_b16 a[8:9], v3 offset:16384
  ds_read_b64_tr_b16 a[10:11], v3 offset:17408
  ds_read_b64_tr_b16 a[32:33], v3 offset:20480
  ds_read_b64_tr_b16 a[34:35], v3 offset:21504
  ds_read_b64_tr_b16 a[56:57], v3 offset:24576
  ds_read_b64_tr_b16 a[58:59], v3 offset:25600
  ds_read_b64_tr_b16 a[80:81], v3 offset:28672
  ds_read_b64_tr_b16 a[82:83], v3 offset:29696
  s_waitcnt lgkmcnt(0)
  s_waitcnt vmcnt(24)
  s_barrier
  s_add_u32 m0, s51, 73728
  s_add_u32 s46, s53, 205312
  buffer_load_dwordx4 v1, s[4:7], s46 offen lds
  s_add_u32 m0, s51, 77824
  s_add_u32 s46, s53, 205440
  buffer_load_dwordx4 v1, s[4:7], s46 offen lds
  s_add_u32 m0, s51, 81920
  s_add_u32 s46, s53, 205568
  buffer_load_dwordx4 v1, s[4:7], s46 offen lds
  s_add_u32 m0, s51, 86016
  s_add_u32 s46, s53, 205696
  buffer_load_dwordx4 v1, s[4:7], s46 offen lds
  s_add_u32 m0, s51, 90112
  s_add_u32 s46, s53, 205824
  buffer_load_dwordx4 v1, s[4:7], s46 offen lds
  s_add_u32 m0, s51, 94208
  s_add_u32 s46, s53, 205952
  buffer_load_dwordx4 v1, s[4:7], s46 offen lds
  ds_read_b64_tr_b16 a[104:105], v3 offset:32768
  ds_read_b64_tr_b16 a[106:107], v3 offset:33792
  ds_read_b64_tr_b16 a[128:129], v3 offset:36864
  ds_read_b64_tr_b16 a[130:131], v3 offset:37888
  ds_read_b64_tr_b16 a[152:153], v3 offset:40960
  ds_read_b64_tr_b16 a[154:155], v3 offset:41984
  ds_read_b64_tr_b16 a[176:177], v3 offset:45056
  ds_read_b64_tr_b16 a[178:179], v3 offset:46080
  ds_read_b64_tr_b16 a[200:201], v3 offset:49152
  ds_read_b64_tr_b16 a[202:203], v3 offset:50176
  ds_read_b64_tr_b16 a[224:225], v3 offset:53248
  ds_read_b64_tr_b16 a[226:227], v3 offset:54272
  s_waitcnt lgkmcnt(0)
  s_waitcnt vmcnt(24)
  s_barrier
  ds_read_b64_tr_b16 a[12:13], v3 offset:57344
  ds_read_b64_tr_b16 a[14:15], v3 offset:58368
  ds_read_b64_tr_b16 a[36:37], v3 offset:61440
  ds_read_b64_tr_b16 a[38:39], v3 offset:62464
  ds_read_b64_tr_b16 a[60:61], v4 offset:0
  ds_read_b64_tr_b16 a[62:63], v4 offset:1024
  ds_read_b64_tr_b16 a[84:85], v4 offset:4096
  ds_read_b64_tr_b16 a[86:87], v4 offset:5120
  ds_read_b64_tr_b16 a[108:109], v4 offset:8192
  ds_read_b64_tr_b16 a[110:111], v4 offset:9216
  ds_read_b64_tr_b16 a[132:133], v4 offset:12288
  ds_read_b64_tr_b16 a[134:135], v4 offset:13312
  s_waitcnt lgkmcnt(0)
  s_waitcnt vmcnt(18)
  s_barrier
  ds_read_b64_tr_b16 a[156:157], v2 offset:0
  ds_read_b64_tr_b16 a[158:159], v2 offset:1024
  ds_read_b64_tr_b16 a[180:181], v2 offset:4096
  ds_read_b64_tr_b16 a[182:183], v2 offset:5120
  ds_read_b64_tr_b16 a[204:205], v2 offset:8192
  ds_read_b64_tr_b16 a[206:207], v2 offset:9216
  ds_read_b64_tr_b16 a[228:229], v2 offset:12288
  ds_read_b64_tr_b16 a[230:231], v2 offset:13312
  ds_read_b64_tr_b16 a[16:17], v2 offset:16384
  ds_read_b64_tr_b16 a[18:19], v2 offset:17408
  ds_read_b64_tr_b16 a[40:41], v2 offset:20480
  ds_read_b64_tr_b16 a[42:43], v2 offset:21504
  s_waitcnt lgkmcnt(0)
  s_waitcnt vmcnt(12)
  s_barrier
  ds_read_b64_tr_b16 a[64:65], v2 offset:24576
  ds_read_b64_tr_b16 a[66:67], v2 offset:25600
  ds_read_b64_tr_b16 a[88:89], v2 offset:28672
  ds_read_b64_tr_b16 a[90:91], v2 offset:29696
  ds_read_b64_tr_b16 a[112:113], v2 offset:32768
  ds_read_b64_tr_b16 a[114:115], v2 offset:33792
  ds_read_b64_tr_b16 a[136:137], v2 offset:36864
  ds_read_b64_tr_b16 a[138:139], v2 offset:37888
  ds_read_b64_tr_b16 a[160:161], v2 offset:40960
  ds_read_b64_tr_b16 a[162:163], v2 offset:41984
  ds_read_b64_tr_b16 a[184:185], v2 offset:45056
  ds_read_b64_tr_b16 a[186:187], v2 offset:46080
  s_waitcnt lgkmcnt(0)
  s_waitcnt vmcnt(6)
  s_barrier
  ds_read_b64_tr_b16 a[208:209], v2 offset:49152
  ds_read_b64_tr_b16 a[210:211], v2 offset:50176
  ds_read_b64_tr_b16 a[232:233], v2 offset:53248
  ds_read_b64_tr_b16 a[234:235], v2 offset:54272
  ds_read_b64_tr_b16 a[20:21], v2 offset:57344
  ds_read_b64_tr_b16 a[22:23], v2 offset:58368
  ds_read_b64_tr_b16 a[44:45], v2 offset:61440
  ds_read_b64_tr_b16 a[46:47], v2 offset:62464
  ds_read_b64_tr_b16 a[68:69], v3 offset:0
  ds_read_b64_tr_b16 a[70:71], v3 offset:1024
  ds_read_b64_tr_b16 a[92:93], v3 offset:4096
  ds_read_b64_tr_b16 a[94:95], v3 offset:5120
  s_waitcnt lgkmcnt(0)
  s_waitcnt vmcnt(0)
  s_barrier
  ds_read_b64_tr_b16 a[116:117], v3 offset:8192
  ds_read_b64_tr_b16 a[118:119], v3 offset:9216
  ds_read_b64_tr_b16 a[140:141], v3 offset:12288
  ds_read_b64_tr_b16 a[142:143], v3 offset:13312
  ds_read_b64_tr_b16 a[164:165], v3 offset:16384
  ds_read_b64_tr_b16 a[166:167], v3 offset:17408
  ds_read_b64_tr_b16 a[188:189], v3 offset:20480
  ds_read_b64_tr_b16 a[190:191], v3 offset:21504
  ds_read_b64_tr_b16 a[212:213], v3 offset:24576
  ds_read_b64_tr_b16 a[214:215], v3 offset:25600
  ds_read_b64_tr_b16 a[236:237], v3 offset:28672
  ds_read_b64_tr_b16 a[238:239], v3 offset:29696
  s_waitcnt lgkmcnt(0)
  s_barrier
  v_and_b32 v9, 3, v0
  v_lshlrev_b32 v9, 2, v9
  s_mov_b32 s50, 0
ss_6:
  global_load_dword v8, v9, s[38:39] sc1
  s_add_u32 s50, s50, 1
  s_cmp_gt_u32 s50, 131072
  s_cbranch_scc1 L_fail
  s_waitcnt vmcnt(0)
  v_readlane_b32 s46, v8, 0
  v_readlane_b32 s47, v8, 2
  s_cmp_lg_u32 s46, 0
  s_cselect_b32 s48, 7, 0
  s_add_u32 s46, s46, s2
  s_xor_b32 s49, s46, s43
  s_and_b32 s49, s49, s48
  s_cbranch_scc1 L_reroll
  s_cmp_lg_u32 s47, 0
  s_cbranch_scc1 ss_ok_7
  s_sleep 10
  s_branch ss_6
ss_ok_7:
  v_readlane_b32 s3, v8, 1
  s_nop 0
  s_and_b32 s3, s3, 0x2000
  s_xor_b32 s61, s61, s3
  s_xor_b32 s55, s55, s3
  s_mov_b32 s57, 1
  s_cmp_ge_u32 s56, s57
  s_cbranch_scc1 wf_done_8
  s_mov_b32 s50, 0
wf_loop_9:
  buffer_load_dword v13, v6, s[8:11], 0 offen sc1
  s_add_u32 s50, s50, 1
  s_cmp_gt_u32 s50, 131072
  s_cbranch_scc1 L_fail
  s_waitcnt vmcnt(0)
  v_readfirstlane_b32 s56, v13
  s_nop 0
  s_cmp_ge_u32 s56, s57
  s_cbranch_scc1 wf_done_8
  s_sleep 2
  s_branch wf_loop_9
wf_done_8:
  s_lshr_b32 s54, s62, 1
  s_lshl_b32 s54, s54, 14
  s_and_b32 s47, s62, 1
  s_lshl_b32 s47, s47, 12
  s_add_u32 s54, s54, s47
  s_add_u32 s54, s54, s61
  s_lshr_b32 s47, s54, 8
  s_and_b32 s47, s47, 0x2000
  s_xor_b32 s54, s54, s47
  s_add_u32 m0, s60, 0
  s_add_u32 s47, s54, 0
  buffer_load_dwordx4 v5, s[8:11], s47 offen sc1 lds
  s_add_u32 m0, s60, 4096
  s_add_u32 s47, s54, 16777216
  buffer_load_dwordx4 v5, s[8:11], s47 offen sc1 lds
  s_add_u32 m0, s60, 8192
  s_add_u32 s47, s54, 33554432
  buffer_load_dwordx4 v5, s[8:11], s47 offen sc1 lds
  s_mov_b32 s59, 2146435072
  s_waitcnt vmcnt(0)
  s_barrier
  ds_read_b128 v[16:19], v12 offset:0
  ds_read_b128 v[40:43], v12 offset:2048
  ds_read_b128 v[20:23], v12 offset:1024
  ds_read_b128 v[44:47], v12 offset:3072
  ds_read_b128 v[24:27], v12 offset:4096
  ds_read_b128 v[48:51], v12 offset:6144
  ds_read_b128 v[28:31], v12 offset:5120
  ds_read_b128 v[52:55], v12 offset:7168
  ds_read_b128 v[32:35], v12 offset:8192
  ds_read_b128 v[56:59], v12 offset:10240
  ds_read_b128 v[36:39], v12 offset:9216
  ds_read_b128 v[60:63], v12 offset:11264
u_loop:
  s_waitcnt lgkmcnt(8)
  v_mfma_f32_16x16x32_bf16 v[64:67], v[16:19], a[0:3], 0
  buffer_load_dword v13, v6, s[8:11], 0 offen sc1
  v_mfma_f32_16x16x32_bf16 v[68:71], v[40:43], a[0:3], 0
  v_mfma_f32_16x16x32_bf16 v[64:67], v[20:23], a[4:7], v[64:67]
  v_cvt_pk_bf16_f32 v84, v72, v73
  v_mfma_f32_16x16x32_bf16 v[68:71], v[44:47], a[4:7], v[68:71]
  s_waitcnt lgkmcnt(4)
  v_cvt_pk_bf16_f32 v85, v74, v75
  v_mfma_f32_16x16x32_bf16 v[64:67], v[24:27], a[8:11], v[64:67]
  v_cvt_pk_bf16_f32 v86, v76, v77
  v_mfma_f32_16x16x32_bf16 v[68:71], v[48:51], a[8:11], v[68:71]
  v_cvt_pk_bf16_f32 v87, v78, v79
  v_mfma_f32_16x16x32_bf16 v[64:67], v[28:31], a[12:15], v[64:67]
  buffer_store_dwordx4 v[84:87], v5, s[8:11], s59 offen sc1
  v_mfma_f32_16x16x32_bf16 v[68:71], v[52:55], a[12:15], v[68:71]
  s_add_u32 s58, s55, 0
  s_waitcnt lgkmcnt(0)
  v_mfma_f32_16x16x32_bf16 v[64:67], v[32:35], a[16:19], v[64:67]
  s_lshr_b32 s46, s58, 8
  v_mfma_f32_16x16x32_bf16 v[68:71], v[56:59], a[16:19], v[68:71]
  s_and_b32 s46, s46, 0x2000
  v_mfma_f32_16x16x32_bf16 v[64:67], v[36:39], a[20:23], v[64:67]
  s_xor_b32 s58, s58, s46
  v_mfma_f32_16x16x32_bf16 v[68:71], v[60:63], a[20:23], v[68:71]
  v_mfma_f32_16x16x32_bf16 v[72:75], v[16:19], a[24:27], 0
  s_add_u32 s59, s55, 2359296
  v_mfma_f32_16x16x32_bf16 v[76:79], v[40:43], a[24:27], 0
  s_lshr_b32 s46, s59, 8
  v_mfma_f32_16x16x32_bf16 v[72:75], v[20:23], a[28:31], v[72:75]
  s_and_b32 s46, s46, 0x2000
  v_cvt_pk_bf16_f32 v80, v64, v65
  v_mfma_f32_16x16x32_bf16 v[76:79], v[44:47], a[28:31], v[76:79]
  s_xor_b32 s59, s59, s46
  v_cvt_pk_bf16_f32 v81, v66, v67
  v_mfma_f32_16x16x32_bf16 v[72:75], v[24:27], a[32:35], v[72:75]
  v_cvt_pk_bf16_f32 v82, v68, v69
  v_mfma_f32_16x16x32_bf16 v[76:79], v[48:51], a[32:35], v[76:79]
  s_add_u32 s57, s52, 2
  s_min_u32 s57, s57, 64
  v_cvt_pk_bf16_f32 v83, v70, v71
  v_mfma_f32_16x16x32_bf16 v[72:75], v[28:31], a[36:39], v[72:75]
  buffer_store_dwordx4 v[80:83], v5, s[8:11], s58 offen sc1
  v_mfma_f32_16x16x32_bf16 v[76:79], v[52:55], a[36:39], v[76:79]
  s_add_u32 s58, s55, 262144
  v_mfma_f32_16x16x32_bf16 v[72:75], v[32:35], a[40:43], v[72:75]
  s_lshr_b32 s46, s58, 8
  v_mfma_f32_16x16x32_bf16 v[76:79], v[56:59], a[40:43], v[76:79]
  s_and_b32 s46, s46, 0x2000
  v_mfma_f32_16x16x32_bf16 v[72:75], v[36:39], a[44:47], v[72:75]
  s_xor_b32 s58, s58, s46
  v_mfma_f32_16x16x32_bf16 v[76:79], v[60:63], a[44:47], v[76:79]
  s_xor_b32 s60, s60, 0x4000
  v_mov_b32 v8, s52
  v_mfma_f32_16x16x32_bf16 v[64:67], v[16:19], a[48:51], 0
  s_add_u32 s62, s62, 32
  v_xor_b32 v12, 0x4000, v12
  v_mfma_f32_16x16x32_bf16 v[68:71], v[40:43], a[48:51], 0
  s_cmp_ge_u32 s62, 1024
  s_cselect_b32 s47, 1024, 0
  v_mfma_f32_16x16x32_bf16 v[64:67], v[20:23], a[52:55], v[64:67]
  s_sub_u32 s62, s62, s47
  v_cvt_pk_bf16_f32 v84, v72, v73
  v_mfma_f32_16x16x32_bf16 v[68:71], v[44:47], a[52:55], v[68:71]
  s_lshr_b32 s54, s62, 1
  v_cvt_pk_bf16_f32 v85, v74, v75
  v_mfma_f32_16x16x32_bf16 v[64:67], v[24:27], a[56:59], v[64:67]
  s_lshl_b32 s54, s54, 14
  v_cvt_pk_bf16_f32 v86, v76, v77
  v_mfma_f32_16x16x32_bf16 v[68:71], v[48:51], a[56:59], v[68:71]
  s_and_b32 s47, s62, 1
  v_cvt_pk_bf16_f32 v87, v78, v79
  v_mfma_f32_16x16x32_bf16 v[64:67], v[28:31], a[60:63], v[64:67]
  buffer_store_dwordx4 v[84:87], v5, s[8:11], s58 offen sc1
  s_lshl_b32 s47, s47, 12
  v_mfma_f32_16x16x32_bf16 v[68:71], v[52:55], a[60:63], v[68:71]
  s_add_u32 s58, s55, 524288
  s_add_u32 s54, s54, s47
  v_mfma_f32_16x16x32_bf16 v[64:67], v[32:35], a[64:67], v[64:67]
  s_lshr_b32 s46, s58, 8
  s_add_u32 s54, s54, s61
  v_mfma_f32_16x16x32_bf16 v[68:71], v[56:59], a[64:67], v[68:71]
  s_and_b32 s46, s46, 0x2000
  s_lshr_b32 s47, s54, 8
  v_mfma_f32_16x16x32_bf16 v[64:67], v[36:39], a[68:71], v[64:67]
  s_xor_b32 s58, s58, s46
  s_and_b32 s47, s47, 0x2000
  v_mfma_f32_16x16x32_bf16 v[68:71], v[60:63], a[68:71], v[68:71]
  s_xor_b32 s54, s54, s47
  v_mfma_f32_16x16x32_bf16 v[72:75], v[16:19], a[72:75], 0
  v_mfma_f32_16x16x32_bf16 v[76:79], v[40:43], a[72:75], 0
  v_mfma_f32_16x16x32_bf16 v[72:75], v[20:23], a[76:79], v[72:75]
  v_cvt_pk_bf16_f32 v80, v64, v65
  v_mfma_f32_16x16x32_bf16 v[76:79], v[44:47], a[76:79], v[76:79]
  v_cvt_pk_bf16_f32 v81, v66, v67
  v_mfma_f32_16x16x32_bf16 v[72:75], v[24:27], a[80:83], v[72:75]
  v_cvt_pk_bf16_f32 v82, v68, v69
  v_mfma_f32_16x16x32_bf16 v[76:79], v[48:51], a[80:83], v[76:79]
  v_cvt_pk_bf16_f32 v83, v70, v71
  v_mfma_f32_16x16x32_bf16 v[72:75], v[28:31], a[84:87], v[72:75]
  buffer_store_dwordx4 v[80:83], v5, s[8:11], s58 offen sc1
  v_mfma_f32_16x16x32_bf16 v[76:79], v[52:55], a[84:87], v[76:79]
  s_add_u32 s58, s55, 786432
  v_mfma_f32_16x16x32_bf16 v[72:75], v[32:35], a[88:91], v[72:75]
  s_lshr_b32 s46, s58, 8
  v_mfma_f32_16x16x32_bf16 v[76:79], v[56:59], a[88:91], v[76:79]
  s_and_b32 s46, s46, 0x2000
  v_mfma_f32_16x16x32_bf16 v[72:75], v[36:39], a[92:95], v[72:75]
  s_xor_b32 s58, s58, s46
  s_waitcnt vmcnt(3)
  v_readfirstlane_b32 s56, v13
  v_mfma_f32_16x16x32_bf16 v[76:79], v[60:63], a[92:95], v[76:79]
  buffer_store_dword v8, v7, s[8:11], 0 offen sc1
  v_mfma_f32_16x16x32_bf16 v[64:67], v[16:19], a[96:99], 0
  s_cmp_lt_u32 s56, s57
  s_cbranch_scc1 u_slow
u_back:
  v_mfma_f32_16x16x32_bf16 v[68:71], v[40:43], a[96:99], 0
  s_add_u32 m0, s60, 0
  s_add_u32 s47, s54, 0
  buffer_load_dwordx4 v5, s[8:11], s47 offen sc1 lds
  v_mfma_f32_16x16x32_bf16 v[64:67], v[20:23], a[100:103], v[64:67]
  s_add_u32 m0, s60, 4096
  s_add_u32 s47, s54, 16777216
  buffer_load_dwordx4 v5, s[8:11], s47 offen sc1 lds
  v_cvt_pk_bf16_f32 v84, v72, v73
  v_mfma_f32_16x16x32_bf16 v[68:71], v[44:47], a[100:103], v[68:71]
  s_add_u32 m0, s60, 8192
  s_add_u32 s47, s54, 33554432
  buffer_load_dwordx4 v5, s[8:11], s47 offen sc1 lds
  v_cvt_pk_bf16_f32 v85, v74, v75
  v_mfma_f32_16x16x32_bf16 v[64:67], v[24:27], a[104:107], v[64:67]
  v_cvt_pk_bf16_f32 v86, v76, v77
  v_mfma_f32_16x16x32_bf16 v[68:71], v[48:51], a[104:107], v[68:71]
  v_cvt_pk_bf16_f32 v87, v78, v79
  v_mfma_f32_16x16x32_bf16 v[64:67], v[28:31], a[108:111], v[64:67]
  buffer_store_dwordx4 v[84:87], v5, s[8:11], s58 offen sc1
  v_mfma_f32_16x16x32_bf16 v[68:71], v[52:55], a[108:111], v[68:71]
  s_add_u32 s58, s55, 1048576
  v_mfma_f32_16x16x32_bf16 v[64:67], v[32:35], a[112:115], v[64:67]
  s_lshr_b32 s46, s58, 8
  v_mfma_f32_16x16x32_bf16 v[68:71], v[56:59], a[112:115], v[68:71]
  s_and_b32 s46, s46, 0x2000
  v_mfma_f32_16x16x32_bf16 v[64:67], v[36:39], a[116:119], v[64:67]
  s_xor_b32 s58, s58, s46
  v_mfma_f32_16x16x32_bf16 v[68:71], v[60:63], a[116:119], v[68:71]
  v_mfma_f32_16x16x32_bf16 v[72:75], v[16:19], a[120:123], 0
  v_mfma_f32_16x16x32_bf16 v[76:79], v[40:43], a[120:123], 0
  v_mfma_f32_16x16x32_bf16 v[72:75], v[20:23], a[124:127], v[72:75]
  v_cvt_pk_bf16_f32 v80, v64, v65
  v_mfma_f32_16x16x32_bf16 v[76:79], v[44:47], a[124:127], v[76:79]
  v_cvt_pk_bf16_f32 v81, v66, v67
  v_mfma_f32_16x16x32_bf16 v[72:75], v[24:27], a[128:131], v[72:75]
  v_cvt_pk_bf16_f32 v82, v68, v69
  v_mfma_f32_16x16x32_bf16 v[76:79], v[48:51], a[128:131], v[76:79]
  v_cvt_pk_bf16_f32 v83, v70, v71
  v_mfma_f32_16x16x32_bf16 v[72:75], v[28:31], a[132:135], v[72:75]
  buffer_store_dwordx4 v[80:83], v5, s[8:11], s58 offen sc1
  v_mfma_f32_16x16x32_bf16 v[76:79], v[52:55], a[132:135], v[76:79]
  s_add_u32 s58, s55, 1310720
  v_mfma_f32_16x16x32_bf16 v[72:75], v[32:35], a[136:139], v[72:75]
  s_lshr_b32 s46, s58, 8
  v_mfma_f32_16x16x32_bf16 v[76:79], v[56:59], a[136:139], v[76:79]
  s_and_b32 s46, s46, 0x2000
  v_mfma_f32_16x16x32_bf16 v[72:75], v[36:39], a[140:143], v[72:75]
  s_xor_b32 s58, s58, s46
  v_mfma_f32_16x16x32_bf16 v[76:79], v[60:63], a[140:143], v[76:79]
  v_mfma_f32_16x16x32_bf16 v[64:67], v[16:19], a[144:147], 0
  v_mfma_f32_16x16x32_bf16 v[68:71], v[40:43], a[144:147], 0
  v_mfma_f32_16x16x32_bf16 v[64:67], v[20:23], a[148:151], v[64:67]
  v_cvt_pk_bf16_f32 v84, v72, v73
  v_mfma_f32_16x16x32_bf16 v[68:71], v[44:47], a[148:151], v[68:71]
  v_cvt_pk_bf16_f32 v85, v74, v75
  v_mfma_f32_16x16x32_bf16 v[64:67], v[24:27], a[152:155], v[64:67]
  v_cvt_pk_bf16_f32 v86, v76, v77
  v_mfma_f32_16x16x32_bf16 v[68:71], v[48:51], a[152:155], v[68:71]
  v_cvt_pk_bf16_f32 v87, v78, v79
  v_mfma_f32_16x16x32_bf16 v[64:67], v[28:31], a[156:159], v[64:67]
  buffer_store_dwordx4 v[84:87], v5, s[8:11], s58 offen sc1
  v_mfma_f32_16x16x32_bf16 v[68:71], v[52:55], a[156:159], v[68:71]
  s_add_u32 s58, s55, 1572864
  v_mfma_f32_16x16x32_bf16 v[64:67], v[32:35], a[160:163], v[64:67]
  s_lshr_b32 s46, s58, 8
  v_mfma_f32_16x16x32_bf16 v[68:71], v[56:59], a[160:163], v[68:71]
  s_and_b32 s46, s46, 0x2000
  v_mfma_f32_16x16x32_bf16 v[64:67], v[36:39], a[164:167], v[64:67]
  s_xor_b32 s58, s58, s46
  v_mfma_f32_16x16x32_bf16 v[68:71], v[60:63], a[164:167], v[68:71]
  v_mfma_f32_16x16x32_bf16 v[72:75], v[16:19], a[168:171], 0
  v_mfma_f32_16x16x32_bf16 v[76:79], v[40:43], a[168:171], 0
  v_mfma_f32_16x16x32_bf16 v[72:75], v[20:23], a[172:175], v[72:75]
  v_cvt_pk_bf16_f32 v80, v64, v65
  v_mfma_f32_16x16x32_bf16 v[76:79], v[44:47], a[172:175], v[76:79]
  v_cvt_pk_bf16_f32 v81, v66, v67
  v_mfma_f32_16x16x32_bf16 v[72:75], v[24:27], a[176:179], v[72:75]
  v_cvt_pk_bf16_f32 v82, v68, v69
  v_mfma_f32_16x16x32_bf16 v[76:79], v[48:51], a[176:179], v[76:79]
  v_cvt_pk_bf16_f32 v83, v70, v71
  v_mfma_f32_16x16x32_bf16 v[72:75], v[28:31], a[180:183], v[72:75]
  buffer_store_dwordx4 v[80:83], v5, s[8:11], s58 offen sc1
  v_mfma_f32_16x16x32_bf16 v[76:79], v[52:55], a[180:183], v[76:79]
  s_add_u32 s58, s55, 1835008
  v_mfma_f32_16x16x32_bf16 v[72:75], v[32:35], a[184:187], v[72:75]
  s_lshr_b32 s46, s58, 8
  v_mfma_f32_16x16x32_bf16 v[76:79], v[56:59], a[184:187], v[76:79]
  s_and_b32 s46, s46, 0x2000
  v_mfma_f32_16x16x32_bf16 v[72:75], v[36:39], a[188:191], v[72:75]
  s_xor_b32 s58, s58, s46
  v_mfma_f32_16x16x32_bf16 v[76:79], v[60:63], a[188:191], v[76:79]
  v_mfma_f32_16x16x32_bf16 v[64:67], v[16:19], a[192:195], 0
  v_mfma_f32_16x16x32_bf16 v[68:71], v[40:43], a[192:195], 0
  v_mfma_f32_16x16x32_bf16 v[64:67], v[20:23], a[196:199], v[64:67]
  v_cvt_pk_bf16_f32 v84, v72, v73
  v_mfma_f32_16x16x32_bf16 v[68:71], v[44:47], a[196:199], v[68:71]
  v_cvt_pk_bf16_f32 v85, v74, v75
  v_mfma_f32_16x16x32_bf16 v[64:67], v[24:27], a[200:203], v[64:67]
  v_cvt_pk_bf16_f32 v86, v76, v77
  v_mfma_f32_16x16x32_bf16 v[68:71], v[48:51], a[200:203], v[68:71]
  v_cvt_pk_bf16_f32 v87, v78, v79
  v_mfma_f32_16x16x32_bf16 v[64:67], v[28:31], a[204:207], v[64:67]
  buffer_store_dwordx4 v[84:87], v5, s[8:11], s58 offen sc1
  v_mfma_f32_16x16x32_bf16 v[68:71], v[52:55], a[204:207], v[68:71]
  s_add_u32 s58, s55, 2097152
  v_mfma_f32_16x16x32_bf16 v[64:67], v[32:35], a[208:211], v[64:67]
  s_lshr_b32 s46, s58, 8
  v_mfma_f32_16x16x32_bf16 v[68:71], v[56:59], a[208:211], v[68:71]
  s_and_b32 s46, s46, 0x2000
  v_mfma_f32_16x16x32_bf16 v[64:67], v[36:39], a[212:215], v[64:67]
  s_xor_b32 s58, s58, s46
  s_waitcnt vmcnt(5)
  s_barrier
  v_mfma_f32_16x16x32_bf16 v[68:71], v[60:63], a[212:215], v[68:71]
  s_add_u32 s55, s55, 2621440
  v_mfma_f32_16x16x32_bf16 v[72:75], v[16:19], a[216:219], 0
  ds_read_b128 v[16:19], v12 offset:0
  v_mfma_f32_16x16x32_bf16 v[76:79], v[40:43], a[216:219], 0
  ds_read_b128 v[40:43], v12 offset:2048
  v_mfma_f32_16x16x32_bf16 v[72:75], v[20:23], a[220:223], v[72:75]
  ds_read_b128 v[20:23], v12 offset:1024
  v_cvt_pk_bf16_f32 v80, v64, v65
  v_mfma_f32_16x16x32_bf16 v[76:79], v[44:47], a[220:223], v[76:79]
  ds_read_b128 v[44:47], v12 offset:3072
  v_cvt_pk_bf16_f32 v81, v66, v67
  v_mfma_f32_16x16x32_bf16 v[72:75], v[24:27], a[224:227], v[72:75]
  ds_read_b128 v[24:27], v12 offset:4096
  v_cvt_pk_bf16_f32 v82, v68, v69
  v_mfma_f32_16x16x32_bf16 v[76:79], v[48:51], a[224:227], v[76:79]
  ds_read_b128 v[48:51], v12 offset:6144
  v_cvt_pk_bf16_f32 v83, v70, v71
  v_mfma_f32_16x16x32_bf16 v[72:75], v[28:31], a[228:231], v[72:75]
  buffer_store_dwordx4 v[80:83], v5, s[8:11], s58 offen sc1
  ds_read_b128 v[28:31], v12 offset:5120
  v_mfma_f32_16x16x32_bf16 v[76:79], v[52:55], a[228:231], v[76:79]
  ds_read_b128 v[52:55], v12 offset:7168
  s_cmp_ge_u32 s55, 165675008
  s_cselect_b32 s46, 83886080, 0
  v_mfma_f32_16x16x32_bf16 v[72:75], v[32:35], a[232:235], v[72:75]
  ds_read_b128 v[32:35], v12 offset:8192
  s_sub_u32 s55, s55, s46
  v_mfma_f32_16x16x32_bf16 v[76:79], v[56:59], a[232:235], v[76:79]
  ds_read_b128 v[56:59], v12 offset:10240
  s_add_u32 s52, s52, 1
  v_mfma_f32_16x16x32_bf16 v[72:75], v[36:39], a[236:239], v[72:75]
  ds_read_b128 v[36:39], v12 offset:9216
  s_cmp_lt_u32 s52, 64
  v_mfma_f32_16x16x32_bf16 v[76:79], v[60:63], a[236:239], v[76:79]
  ds_read_b128 v[60:63], v12 offset:11264
  s_cbranch_scc1 u_loop
  s_nop 2
  v_cvt_pk_bf16_f32 v84, v72, v73
  v_cvt_pk_bf16_f32 v85, v74, v75
  s_nop 0
  v_cvt_pk_bf16_f32 v86, v76, v77
  v_cvt_pk_bf16_f32 v87, v78, v79
  buffer_store_dwordx4 v[84:87], v5, s[8:11], s59 offen sc1
  v_mov_b32 v8, s52
  s_waitcnt vmcnt(0) lgkmcnt(0)
  buffer_store_dword v8, v7, s[8:11], 0 offen sc1
  s_branch u_done
u_slow:
  s_cmp_ge_u32 s56, s57
  s_cbranch_scc1 wf_done_10
  s_mov_b32 s50, 0
wf_loop_11:
  buffer_load_dword v13, v6, s[8:11], 0 offen sc1
  s_add_u32 s50, s50, 1
  s_cmp_gt_u32 s50, 131072
  s_cbranch_scc1 L_fail
  s_waitcnt vmcnt(0)
  v_readfirstlane_b32 s56, v13
  s_nop 0
  s_cmp_ge_u32 s56, s57
  s_cbranch_scc1 wf_done_10
  s_sleep 2
  s_branch wf_loop_11
wf_done_10:
  s_branch u_back
u_done:
L_parta:
  s_barrier
  s_lshl_b32 s65, s44, 2
  s_add_u32 s65, s65, s43
  s_sub_u32 s65, s65, 4
  s_cmp_ge_u32 s65, 120
  s_cbranch_scc1 pa_att
  s_mov_b32 s4, s18
  s_mov_b32 s5, s19
  s_mov_b32 s6, 2457600
  s_mov_b32 s7, 0x20000
  s_mov_b32 s12, s16
  s_mov_b32 s13, s17
  s_mov_b32 s14, 2621440
  s_mov_b32 s15, 0x20000
  s_mul_i32 s46, s65, 205
  s_lshr_b32 s46, s46, 11
  s_mul_i32 s47, s46, 10
  s_sub_u32 s47, s65, s47
  s_mul_i32 s60, s47, 384
  s_lshl_b32 s67, s47, 6
  s_mov_b32 s63, 132128768
  s_mul_i32 s61, s46, 6
  s_add_u32 s62, s61, 6
  s_mul_i32 s48, s46, 3
  s_add_u32 s49, s48, 31
  s_add_u32 s48, s48, 28
  s_min_u32 s61, s61, s48
  s_min_u32 s62, s62, s49
  s_add_u32 s67, s67, s61
  s_lshl_b32 s64, s65, 7
  s_add_u32 s64, s64, 1081344
  v_lshrrev_b32 v10, 3, v0
  v_lshrrev_b32 v11, 2, v10
  v_lshlrev_b32 v11, 3, v11
  v_and_b32 v1, 3, v10
  v_add_u32 v1, v1, v11
  s_and_b32 s46, s42, 1
  s_lshl_b32 s46, s46, 2
  s_lshr_b32 s47, s42, 1
  s_lshl_b32 s47, s47, 4
  s_add_u32 s46, s46, s47
  v_add_u32 v1, s46, v1
  v_mul_u32_u24 v1, 3840, v1
  v_lshrrev_b32 v10, 1, v10
  v_bfe_u32 v11, v0, 1, 2
  v_xor_b32 v10, v10, v11
  v_lshlrev_b32 v10, 5, v10
  v_and_b32 v11, 1, v0
  v_lshlrev_b32 v11, 4, v11
  v_add3_u32 v1, v1, v10, v11
  v_lshrrev_b32 v10, 5, v0
  v_lshlrev_b32 v2, 11, v10
  v_bfe_u32 v10, v0, 2, 3
  v_lshl_add_u32 v2, v10, 7, v2
  v_lshrrev_b32 v10, 1, v10
  v_xor_b32 v10, s42, v10
  v_lshl_add_u32 v2, v10, 5, v2
  v_and_b32 v10, 3, v0
  v_lshl_add_u32 v2, v10, 3, v2
  v_add_u32 v3, 0x10000, v2
  v_add_u32 v4, 0x20000, v2
  v_lshrrev_b32 v10, 3, v0
  s_lshl_b32 s46, s42, 3
  v_add_u32 v10, s46, v10
  v_mul_u32_u24 v5, 1280, v10
  v_bfe_u32 v10, v10, 1, 3
  v_and_b32 v11, 7, v0
  v_xor_b32 v10, v10, v11
  v_lshl_add_u32 v5, v10, 4, v5
  v_and_b32 v10, 15, v0
  v_lshlrev_b32 v6, 7, v10
  v_lshrrev_b32 v10, 1, v10
  v_lshrrev_b32 v11, 4, v0
  v_xor_b32 v10, v10, v11
  v_lshl_add_u32 v6, v10, 4, v6
  v_add_u32 v6, 122880, v6
  v_xor_b32 v7, 64, v6
  v_and_b32 v10, 15, v0
  v_lshlrev_b32 v8, 4, v10
  v_bfe_u32 v10, v0, 4, 1
  v_lshlrev_b32 v10, 11, v10
  v_lshrrev_b32 v11, 5, v0
  v_lshlrev_b32 v11, 8, v11
  v_add3_u32 v8, v8, v10, v11
  s_lshl_b32 s46, s42, 9
  v_add_u32 v8, s46, v8
  v_mov_b32 v9, s64
  v_mov_b32 v10, 2146435072
  s_cmp_eq_u32 s42, 0
  s_cselect_b64 vcc, 1, 0
  v_cndmask_b32 v9, v10, v9, vcc
  s_lshl_b32 s46, s43, 7
  s_add_u32 s46, s46, 1076736
  v_mov_b32 v14, s46
  s_mov_b32 s68, 0
  s_lshr_b32 s70, s44, 5
  s_add_u32 s70, s70, 60
  s_mov_b32 s52, s61
  s_mul_i32 s53, s52, 40960
  s_add_u32 s54, s51, 122880
  s_add_u32 m0, s54, 0
  s_nop 0
  buffer_load_dwordx4 v5, s[12:15], s53 offen offset:0 lds
  s_add_u32 m0, s54, 3968
  s_nop 0
  buffer_load_dwordx4 v5, s[12:15], s53 offen offset:128 lds
  s_add_u32 m0, s54, 7936
  s_nop 0
  buffer_load_dwordx4 v5, s[12:15], s53 offen offset:256 lds
  s_add_u32 m0, s54, 11904
  s_nop 0
  buffer_load_dwordx4 v5, s[12:15], s53 offen offset:384 lds
  s_add_u32 m0, s54, 15872
  s_nop 0
  buffer_load_dwordx4 v5, s[12:15], s53 offen offset:512 lds
  s_add_u32 m0, s54, 19840
  s_nop 0
  buffer_load_dwordx4 v5, s[12:15], s53 offen offset:640 lds
  s_add_u32 m0, s54, 23808
  s_nop 0
  buffer_load_dwordx4 v5, s[12:15], s53 offen offset:768 lds
  s_add_u32 m0, s54, 27776
  s_nop 0
  buffer_load_dwordx4 v5, s[12:15], s53 offen offset:896 lds
  s_add_u32 m0, s54, 31744
  s_nop 0
  buffer_load_dwordx4 v5, s[12:15], s53 offen offset:1024 lds
  s_add_u32 m0, s54, 35712
  s_nop 0
  buffer_load_dwordx4 v5, s[12:15], s53 offen offset:1152 lds
  s_add_u32 m0, s51, 0
  s_add_u32 s46, s60, 0
  buffer_load_dwordx4 v1, s[4:7], s46 offen lds
  s_add_u32 m0, s51, 4096
  s_add_u32 s46, s60, 128
  buffer_load_dwordx4 v1, s[4:7], s46 offen lds
  s_add_u32 m0, s51, 8192
  s_add_u32 s46, s60, 256
  buffer_load_dwordx4 v1, s[4:7], s46 offen lds
  s_add_u32 m0, s51, 12288
  s_add_u32 s46, s60, 122880
  buffer_load_dwordx4 v1, s[4:7], s46 offen lds
  s_add_u32 m0, s51, 16384
  s_add_u32 s46, s60, 123008
  buffer_load_dwordx4 v1, s[4:7], s46 offen lds
  s_add_u32 m0, s51, 20480
  s_add_u32 s46, s60, 123136
  buffer_load_dwordx4 v1, s[4:7], s46 offen lds
  s_add_u32 m0, s51, 24576
  s_add_u32 s46, s60, 245760
  buffer_load_dwordx4 v1, s[4:7], s46 offen lds
  s_add_u32 m0, s51, 28672
  s_add_u32 s46, s60, 245888
  buffer_load_dwordx4 v1, s[4:7], s46 offen lds
  s_add_u32 m0, s51, 32768
  s_add_u32 s46, s60, 246016
  buffer_load_dwordx4 v1, s[4:7], s46 offen lds
  s_add_u32 m0, s51, 36864
  s_add_u32 s46, s60, 368640
  buffer_load_dwordx4 v1, s[4:7], s46 offen lds
  s_add_u32 m0, s51, 40960
  s_add_u32 s46, s60, 368768
  buffer_load_dwordx4 v1, s[4:7], s46 offen lds
  s_add_u32 m0, s51, 45056
  s_add_u32 s46, s60, 368896
  buffer_load_dwordx4 v1, s[4:7], s46 offen lds
  s_add_u32 m0, s51, 49152
  s_add_u32 s46, s60, 491520
  buffer_load_dwordx4 v1, s[4:7], s46 offen lds
  s_add_u32 m0, s51, 53248
  s_add_u32 s46, s60, 491648
  buffer_load_dwordx4 v1, s[4:7], s46 offen lds
  s_add_u32 m0, s51, 57344
  s_add_u32 s46, s60, 491776
  buffer_load_dwordx4 v1, s[4:7], s46 offen lds
  s_add_u32 m0, s51, 61440
  s_add_u32 s46, s60, 614400
  buffer_load_dwordx4 v1, s[4:7], s46 offen lds
  s_add_u32 m0, s51, 65536
  s_add_u32 s46, s60, 614528
  buffer_load_dwordx4 v1, s[4:7], s46 offen lds
  s_add_u32 m0, s51, 69632
  s_add_u32 s46, s60, 614656
  buffer_load_dwordx4 v1, s[4:7], s46 offen lds
  s_add_u32 m0, s51, 73728
  s_add_u32 s46, s60, 737280
  buffer_load_dwordx4 v1, s[4:7], s46 offen lds
  s_add_u32 m0, s51, 77824
  s_add_u32 s46, s60, 737408
  buffer_load_dwordx4 v1, s[4:7], s46 offen lds
  s_add_u32 m0, s51, 81920
  s_add_u32 s46, s60, 737536
  buffer_load_dwordx4 v1, s[4:7], s46 offen lds
  s_add_u32 m0, s51, 86016
  s_add_u32 s46, s60, 860160
  buffer_load_dwordx4 v1, s[4:7], s46 offen lds
  s_add_u32 m0, s51, 90112
  s_add_u32 s46, s60, 860288
  buffer_load_dwordx4 v1, s[4:7], s46 offen lds
  s_add_u32 m0, s51, 94208
  s_add_u32 s46, s60, 860416
  buffer_load_dwordx4 v1, s[4:7], s46 offen lds
  s_waitcnt vmcnt(18)
  s_barrier
  s_add_u32 m0, s51, 98304
  s_add_u32 s46, s60, 983040
  buffer_load_dwordx4 v1, s[4:7], s46 offen lds
  s_add_u32 m0, s51, 102400
  s_add_u32 s46, s60, 983168
  buffer_load_dwordx4 v1, s[4:7], s46 offen lds
  s_add_u32 m0, s51, 106496
  s_add_u32 s46, s60, 983296
  buffer_load_dwordx4 v1, s[4:7], s46 offen lds
  s_add_u32 m0, s51, 110592
  s_add_u32 s46, s60, 1105920
  buffer_load_dwordx4 v1, s[4:7], s46 offen lds
  s_add_u32 m0, s51, 114688
  s_add_u32 s46, s60, 1106048
  buffer_load_dwordx4 v1, s[4:7], s46 offen lds
  s_add_u32 m0, s51, 118784
  s_add_u32 s46, s60, 1106176
  buffer_load_dwordx4 v1, s[4:7], s46 offen lds
  ds_read_b64_tr_b16 a[0:1], v2 offset:0
  ds_read_b64_tr_b16 a[2:3], v2 offset:1024
  ds_read_b64_tr_b16 a[4:5], v2 offset:4096
  ds_read_b64_tr_b16 a[6:7], v2 offset:5120
  ds_read_b64_tr_b16 a[8:9], v2 offset:8192
  ds_read_b64_tr_b16 a[10:11], v2 offset:9216
  ds_read_b64_tr_b16 a[12:13], v2 offset:12288
  ds_read_b64_tr_b16 a[14:15], v2 offset:13312
  ds_read_b64_tr_b16 a[16:17], v2 offset:16384
  ds_read_b64_tr_b16 a[18:19], v2 offset:17408
  ds_read_b64_tr_b16 a[20:21], v2 offset:20480
  ds_read_b64_tr_b16 a[22:23], v2 offset:21504
  s_waitcnt lgkmcnt(0)
  s_waitcnt vmcnt(18)
  s_barrier
  s_add_u32 m0, s51, 0
  s_add_u32 s46, s60, 1228800
  buffer_load_dwordx4 v1, s[4:7], s46 offen lds
  s_add_u32 m0, s51, 4096
  s_add_u32 s46, s60, 1228928
  buffer_load_dwordx4 v1, s[4:7], s46 offen lds
  s_add_u32 m0, s51, 8192
  s_add_u32 s46, s60, 1229056
  buffer_load_dwordx4 v1, s[4:7], s46 offen lds
  s_add_u32 m0, s51, 12288
  s_add_u32 s46, s60, 1351680
  buffer_load_dwordx4 v1, s[4:7], s46 offen lds
  s_add_u32 m0, s51, 16384
  s_add_u32 s46, s60, 1351808
  buffer_load_dwordx4 v1, s[4:7], s46 offen lds
  s_add_u32 m0, s51, 20480
  s_add_u32 s46, s60, 1351936
  buffer_load_dwordx4 v1, s[4:7], s46 offen lds
  ds_read_b64_tr_b16 a[24:25], v2 offset:24576
  ds_read_b64_tr_b16 a[26:27], v2 offset:25600
  ds_read_b64_tr_b16 a[28:29], v2 offset:28672
  ds_read_b64_tr_b16 a[30:31], v2 offset:29696
  ds_read_b64_tr_b16 a[32:33], v2 offset:32768
  ds_read_b64_tr_b16 a[34:35], v2 offset:33792
  ds_read_b64_tr_b16 a[36:37], v2 offset:36864
  ds_read_b64_tr_b16 a[38:39], v2 offset:37888
  ds_read_b64_tr_b16 a[40:41], v2 offset:40960
  ds_read_b64_tr_b16 a[42:43], v2 offset:41984
  ds_read_b64_tr_b16 a[44:45], v2 offset:45056
  ds_read_b64_tr_b16 a[46:47], v2 offset:46080
  s_waitcnt lgkmcnt(0)
  s_waitcnt vmcnt(18)
  s_barrier
  s_add_u32 m0, s51, 24576
  s_add_u32 s46, s60, 1474560
  buffer_load_dwordx4 v1, s[4:7], s46 offen lds
  s_add_u32 m0, s51, 28672
  s_add_u32 s46, s60, 1474688
  buffer_load_dwordx4 v1, s[4:7], s46 offen lds
  s_add_u32 m0, s51, 32768
  s_add_u32 s46, s60, 1474816
  buffer_load_dwordx4 v1, s[4:7], s46 offen lds
  s_add_u32 m0, s51, 36864
  s_add_u32 s46, s60, 1597440
  buffer_load_dwordx4 v1, s[4:7], s46 offen lds
  s_add_u32 m0, s51, 40960
  s_add_u32 s46, s60, 1597568
  buffer_load_dwordx4 v1, s[4:7], s46 offen lds
  s_add_u32 m0, s51, 45056
  s_add_u32 s46, s60, 1597696
  buffer_load_dwordx4 v1, s[4:7], s46 offen lds
  ds_read_b64_tr_b16 a[48:49], v2 offset:49152
  ds_read_b64_tr_b16 a[50:51], v2 offset:50176
  ds_read_b64_tr_b16 a[52:53], v2 offset:53248
  ds_read_b64_tr_b16 a[54:55], v2 offset:54272
  ds_read_b64_tr_b16 a[56:57], v2 offset:57344
  ds_read_b64_tr_b16 a[58:59], v2 offset:58368
  ds_read_b64_tr_b16 a[60:61], v2 offset:61440
  ds_read_b64_tr_b16 a[62:63], v2 offset:62464
  ds_read_b64_tr_b16 a[64:65], v3 offset:0
  ds_read_b64_tr_b16 a[66:67], v3 offset:1024
  ds_read_b64_tr_b16 a[68:69], v3 offset:4096
  ds_read_b64_tr_b16 a[70:71], v3 offset:5120
  s_waitcnt lgkmcnt(0)
  s_waitcnt vmcnt(18)
  s_barrier
  s_add_u32 m0, s51, 49152
  s_add_u32 s46, s60, 1720320
  buffer_load_dwordx4 v1, s[4:7], s46 offen lds
  s_add_u32 m0, s51, 53248
  s_add_u32 s46, s60, 1720448
  buffer_load_dwordx4 v1, s[4:7], s46 offen lds
  s_add_u32 m0, s51, 57344
  s_add_u32 s46, s60, 1720576
  buffer_load_dwordx4 v1, s[4:7], s46 offen lds
  s_add_u32 m0, s51, 61440
  s_add_u32 s46, s60, 1843200
  buffer_load_dwordx4 v1, s[4:7], s46 offen lds
  s_add_u32 m0, s51, 65536
  s_add_u32 s46, s60, 1843328
  buffer_load_dwordx4 v1, s[4:7], s46 offen lds
  s_add_u32 m0, s51, 69632
  s_add_u32 s46, s60, 1843456
  buffer_load_dwordx4 v1, s[4:7], s46 offen lds
  ds_read_b64_tr_b16 a[72:73], v3 offset:8192
  ds_read_b64_tr_b16 a[74:75], v3 offset:9216
  ds_read_b64_tr_b16 a[76:77], v3 offset:12288
  ds_read_b64_tr_b16 a[78:79], v3 offset:13312
  ds_read_b64_tr_b16 a[80:81], v3 offset:16384
  ds_read_b64_tr_b16 a[82:83], v3 offset:17408
  ds_read_b64_tr_b16 a[84:85], v3 offset:20480
  ds_read_b64_tr_b16 a[86:87], v3 offset:21504
  ds_read_b64_tr_b16 a[88:89], v3 offset:24576
  ds_read_b64_tr_b16 a[90:91], v3 offset:25600
  ds_read_b64_tr_b16 a[92:93], v3 offset:28672
  ds_read_b64_tr_b16 a[94:95], v3 offset:29696
  s_waitcnt lgkmcnt(0)
  s_waitcnt vmcnt(18)
  s_barrier
  s_add_u32 m0, s51, 73728
  s_add_u32 s46, s60, 1966080
  buffer_load_dwordx4 v1, s[4:7], s46 offen lds
  s_add_u32 m0, s51, 77824
  s_add_u32 s46, s60, 1966208
  buffer_load_dwordx4 v1, s[4:7], s46 offen lds
  s_add_u32 m0, s51, 81920
  s_add_u32 s46, s60, 1966336
  buffer_load_dwordx4 v1, s[4:7], s46 offen lds
  s_add_u32 m0, s51, 86016
  s_add_u32 s46, s60, 2088960
  buffer_load_dwordx4 v1, s[4:7], s46 offen lds
  s_add_u32 m0, s51, 90112
  s_add_u32 s46, s60, 2089088
  buffer_load_dwordx4 v1, s[4:7], s46 offen lds
  s_add_u32 m0, s51, 94208
  s_add_u32 s46, s60, 2089216
  buffer_load_dwordx4 v1, s[4:7], s46 offen lds
  ds_read_b64_tr_b16 a[96:97], v3 offset:32768
  ds_read_b64_tr_b16 a[98:99], v3 offset:33792
  ds_read_b64_tr_b16 a[100:101], v3 offset:36864
  ds_read_b64_tr_b16 a[102:103], v3 offset:37888
  ds_read_b64_tr_b16 a[104:105], v3 offset:40960
  ds_read_b64_tr_b16 a[106:107], v3 offset:41984
  ds_read_b64_tr_b16 a[108:109], v3 offset:45056
  ds_read_b64_tr_b16 a[110:111], v3 offset:46080
  ds_read_b64_tr_b16 a[112:113], v3 offset:49152
  ds_read_b64_tr_b16 a[114:115], v3 offset:50176
  ds_read_b64_tr_b16 a[116:117], v3 offset:53248
  ds_read_b64_tr_b16 a[118:119], v3 offset:54272
  s_waitcnt lgkmcnt(0)
  s_waitcnt vmcnt(18)
  s_barrier
  s_add_u32 m0, s51, 98304
  s_add_u32 s46, s60, 2211840
  buffer_load_dwordx4 v1, s[4:7], s46 offen lds
  s_add_u32 m0, s51, 102400
  s_add_u32 s46, s60, 2211968
  buffer_load_dwordx4 v1, s[4:7], s46 offen lds
  s_add_u32 m0, s51, 106496
  s_add_u32 s46, s60, 2212096
  buffer_load_dwordx4 v1, s[4:7], s46 offen lds
  s_add_u32 m0, s51, 110592
  s_add_u32 s46, s60, 2334720
  buffer_load_dwordx4 v1, s[4:7], s46 offen lds
  s_add_u32 m0, s51, 114688
  s_add_u32 s46, s60, 2334848
  buffer_load_dwordx4 v1, s[4:7], s46 offen lds
  s_add_u32 m0, s51, 118784
  s_add_u32 s46, s60, 2334976
  buffer_load_dwordx4 v1, s[4:7], s46 offen lds
  ds_read_b64_tr_b16 a[120:121], v2 offset:0
  ds_read_b64_tr_b16 a[122:123], v2 offset:1024
  ds_read_b64_tr_b16 a[124:125], v2 offset:4096
  ds_read_b64_tr_b16 a[126:127], v2 offset:5120
  ds_read_b64_tr_b16 a[128:129], v2 offset:8192
  ds_read_b64_tr_b16 a[130:131], v2 offset:9216
  ds_read_b64_tr_b16 a[132:133], v2 offset:12288
  ds_read_b64_tr_b16 a[134:135], v2 offset:13312
  ds_read_b64_tr_b16 a[136:137], v2 offset:16384
  ds_read_b64_tr_b16 a[138:139], v2 offset:17408
  ds_read_b64_tr_b16 a[140:141], v2 offset:20480
  ds_read_b64_tr_b16 a[142:143], v2 offset:21504
  s_waitcnt lgkmcnt(0)
  s_waitcnt vmcnt(18)
  s_barrier
  ds_read_b64_tr_b16 a[144:145], v2 offset:24576
  ds_read_b64_tr_b16 a[146:147], v2 offset:25600
  ds_read_b64_tr_b16 a[148:149], v2 offset:28672
  ds_read_b64_tr_b16 a[150:151], v2 offset:29696
  ds_read_b64_tr_b16 a[152:153], v2 offset:32768
  ds_read_b64_tr_b16 a[154:155], v2 offset:33792
  ds_read_b64_tr_b16 a[156:157], v2 offset:36864
  ds_read_b64_tr_b16 a[158:159], v2 offset:37888
  ds_read_b64_tr_b16 a[160:161], v2 offset:40960
  ds_read_b64_tr_b16 a[162:163], v2 offset:41984
  ds_read_b64_tr_b16 a[164:165], v2 offset:45056
  ds_read_b64_tr_b16 a[166:167], v2 offset:46080
  s_waitcnt lgkmcnt(0)
  s_waitcnt vmcnt(12)
  s_barrier
  ds_read_b64_tr_b16 a[168:169], v2 offset:49152
  ds_read_b64_tr_b16 a[170:171], v2 offset:50176
  ds_read_b64_tr_b16 a[172:173], v2 offset:53248
  ds_read_b64_tr_b16 a[174:175], v2 offset:54272
  ds_read_b64_tr_b16 a[176:177], v2 offset:57344
  ds_read_b64_tr_b16 a[178:179], v2 offset:58368
  ds_read_b64_tr_b16 a[180:181], v2 offset:61440
  ds_read_b64_tr_b16 a[182:183], v2 offset:62464
  ds_read_b64_tr_b16 a[184:185], v3 offset:0
  ds_read_b64_tr_b16 a[186:187], v3 offset:1024
  ds_read_b64_tr_b16 a[188:189], v3 offset:4096
  ds_read_b64_tr_b16 a[190:191], v3 offset:5120
  s_waitcnt lgkmcnt(0)
  s_waitcnt vmcnt(6)
  s_barrier
  ds_read_b64_tr_b16 a[192:193], v3 offset:8192
  ds_read_b64_tr_b16 a[194:195], v3 offset:9216
  ds_read_b64_tr_b16 a[196:197], v3 offset:12288
  ds_read_b64_tr_b16 a[198:199], v3 offset:13312
  ds_read_b64_tr_b16 a[200:201], v3 offset:16384
  ds_read_b64_tr_b16 a[202:203], v3 offset:17408
  ds_read_b64_tr_b16 a[204:205], v3 offset:20480
  ds_read_b64_tr_b16 a[206:207], v3 offset:21504
  ds_read_b64_tr_b16 a[208:209], v3 offset:24576
  ds_read_b64_tr_b16 a[210:211], v3 offset:25600
  ds_read_b64_tr_b16 a[212:213], v3 offset:28672
  ds_read_b64_tr_b16 a[214:215], v3 offset:29696
  s_waitcnt lgkmcnt(0)
  s_waitcnt vmcnt(0)
  s_barrier
  ds_read_b64_tr_b16 a[216:217], v3 offset:32768
  ds_read_b64_tr_b16 a[218:219], v3 offset:33792
  ds_read_b64_tr_b16 a[220:221], v3 offset:36864
  ds_read_b64_tr_b16 a[222:223], v3 offset:37888
  ds_read_b64_tr_b16 a[224:225], v3 offset:40960
  ds_read_b64_tr_b16 a[226:227], v3 offset:41984
  ds_read_b64_tr_b16 a[228:229], v3 offset:45056
  ds_read_b64_tr_b16 a[230:231], v3 offset:46080
  ds_read_b64_tr_b16 a[232:233], v3 offset:49152
  ds_read_b64_tr_b16 a[234:235], v3 offset:50176
  ds_read_b64_tr_b16 a[236:237], v3 offset:53248
  ds_read_b64_tr_b16 a[238:239], v3 offset:54272
  s_waitcnt lgkmcnt(0)
  s_barrier
  s_mov_b32 s54, s51
  s_add_u32 s53, s53, 40960
  s_add_u32 m0, s54, 0
  s_nop 0
  buffer_load_dwordx4 v5, s[12:15], s53 offen offset:0 lds
  s_add_u32 m0, s54, 3968
  s_nop 0
  buffer_load_dwordx4 v5, s[12:15], s53 offen offset:128 lds
  s_add_u32 m0, s54, 7936
  s_nop 0
  buffer_load_dwordx4 v5, s[12:15], s53 offen offset:256 lds
  s_add_u32 m0, s54, 11904
  s_nop 0
  buffer_load_dwordx4 v5, s[12:15], s53 offen offset:384 lds
  s_add_u32 m0, s54, 15872
  s_nop 0
  buffer_load_dwordx4 v5, s[12:15], s53 offen offset:512 lds
  s_add_u32 m0, s54, 19840
  s_nop 0
  buffer_load_dwordx4 v5, s[12:15], s53 offen offset:640 lds
  s_add_u32 m0, s54, 23808
  s_nop 0
  buffer_load_dwordx4 v5, s[12:15], s53 offen offset:768 lds
  s_add_u32 m0, s54, 27776
  s_nop 0
  buffer_load_dwordx4 v5, s[12:15], s53 offen offset:896 lds
  s_add_u32 m0, s54, 31744
  s_nop 0
  buffer_load_dwordx4 v5, s[12:15], s53 offen offset:1024 lds
  s_add_u32 m0, s54, 35712
  s_nop 0
  buffer_load_dwordx4 v5, s[12:15], s53 offen offset:1152 lds
  s_mov_b32 s55, 2146435072
  s_mov_b32 s56, 2146435072
  s_mov_b32 s57, 2146435072
  s_xor_b32 s63, s63, s3
  s_mov_b32 s58, 122880
  ds_read_b128 v[16:19], v6 offset:0
  ds_read_b128 v[20:23], v7 offset:0
  ds_read_b128 v[24:27], v6 offset:4096
  ds_read_b128 v[28:31], v7 offset:4096
  s_waitcnt lgkmcnt(3)
pa_loop_12:
  v_mfma_f32_16x16x32_bf16 v[40:43], a[0:3], v[16:19], 0
  ds_read_b128 v[32:35], v6 offset:8192
  v_mfma_f32_16x16x32_bf16 v[48:51], a[4:7], v[16:19], 0
  v_mfma_f32_16x16x32_bf16 v[56:59], a[8:11], v[16:19], 0
  s_waitcnt lgkmcnt(3)
  v_cvt_pk_bf16_f32 v66, v44, v45
  v_mfma_f32_16x16x32_bf16 v[40:43], a[12:15], v[20:23], v[40:43]
  ds_read_b128 v[16:19], v7 offset:8192
  v_cvt_pk_bf16_f32 v67, v46, v47
  v_mfma_f32_16x16x32_bf16 v[48:51], a[16:19], v[20:23], v[48:51]
  v_cvt_pk_bf16_f32 v70, v52, v53
  v_mfma_f32_16x16x32_bf16 v[56:59], a[20:23], v[20:23], v[56:59]
  s_waitcnt lgkmcnt(3)
  v_cvt_pk_bf16_f32 v71, v54, v55
  v_mfma_f32_16x16x32_bf16 v[40:43], a[24:27], v[24:27], v[40:43]
  ds_read_b128 v[20:23], v6 offset:12288
  v_cvt_pk_bf16_f32 v74, v60, v61
  v_mfma_f32_16x16x32_bf16 v[48:51], a[28:31], v[24:27], v[48:51]
  v_cvt_pk_bf16_f32 v75, v62, v63
  v_mfma_f32_16x16x32_bf16 v[56:59], a[32:35], v[24:27], v[56:59]
  s_waitcnt lgkmcnt(3)
  v_mfma_f32_16x16x32_bf16 v[40:43], a[36:39], v[28:31], v[40:43]
  ds_read_b128 v[24:27], v7 offset:12288
  v_permlane16_swap_b32 v64, v66
  v_mfma_f32_16x16x32_bf16 v[48:51], a[40:43], v[28:31], v[48:51]
  v_permlane16_swap_b32 v65, v67
  v_mfma_f32_16x16x32_bf16 v[56:59], a[44:47], v[28:31], v[56:59]
  buffer_store_dwordx4 v[64:67], v8, s[8:11], s55 offen sc1
  s_waitcnt lgkmcnt(3)
  v_mfma_f32_16x16x32_bf16 v[40:43], a[48:51], v[32:35], v[40:43]
  ds_read_b128 v[28:31], v6 offset:16384
  v_permlane16_swap_b32 v68, v70
  v_mfma_f32_16x16x32_bf16 v[48:51], a[52:55], v[32:35], v[48:51]
  v_permlane16_swap_b32 v69, v71
  v_mfma_f32_16x16x32_bf16 v[56:59], a[56:59], v[32:35], v[56:59]
  buffer_store_dwordx4 v[68:71], v8, s[8:11], s56 offen sc1
  s_waitcnt lgkmcnt(3)
  v_mfma_f32_16x16x32_bf16 v[40:43], a[60:63], v[16:19], v[40:43]
  ds_read_b128 v[32:35], v7 offset:16384
  v_permlane16_swap_b32 v72, v74
  v_mfma_f32_16x16x32_bf16 v[48:51], a[64:67], v[16:19], v[48:51]
  v_permlane16_swap_b32 v73, v75
  v_mfma_f32_16x16x32_bf16 v[56:59], a[68:71], v[16:19], v[56:59]
  buffer_store_dwordx4 v[72:75], v8, s[8:11], s57 offen sc1
  s_waitcnt lgkmcnt(3)
  v_mfma_f32_16x16x32_bf16 v[40:43], a[72:75], v[20:23], v[40:43]
  ds_read_b128 v[16:19], v6 offset:20480
  v_mfma_f32_16x16x32_bf16 v[48:51], a[76:79], v[20:23], v[48:51]
  v_mfma_f32_16x16x32_bf16 v[56:59], a[80:83], v[20:23], v[56:59]
  s_waitcnt lgkmcnt(3)
  v_mfma_f32_16x16x32_bf16 v[40:43], a[84:87], v[24:27], v[40:43]
  ds_read_b128 v[20:23], v7 offset:20480
  v_mfma_f32_16x16x32_bf16 v[48:51], a[88:91], v[24:27], v[48:51]
  v_mov_b32 v10, s52
  v_mfma_f32_16x16x32_bf16 v[56:59], a[92:95], v[24:27], v[56:59]
  s_waitcnt lgkmcnt(3)
  v_mfma_f32_16x16x32_bf16 v[40:43], a[96:99], v[28:31], v[40:43]
  ds_read_b128 v[24:27], v6 offset:24576
  v_mfma_f32_16x16x32_bf16 v[48:51], a[100:103], v[28:31], v[48:51]
  s_add_u32 s53, s53, 40960
  s_add_u32 s54, s54, 40960
  v_mfma_f32_16x16x32_bf16 v[56:59], a[104:107], v[28:31], v[56:59]
  s_waitcnt lgkmcnt(3)
  v_mfma_f32_16x16x32_bf16 v[40:43], a[108:111], v[32:35], v[40:43]
  ds_read_b128 v[28:31], v7 offset:24576
  v_mfma_f32_16x16x32_bf16 v[48:51], a[112:115], v[32:35], v[48:51]
  s_cmp_ge_u32 s54, 163840
  s_cselect_b32 s54, s51, s54
  v_mfma_f32_16x16x32_bf16 v[56:59], a[116:119], v[32:35], v[56:59]
  s_waitcnt lgkmcnt(3)
  v_mfma_f32_16x16x32_bf16 v[40:43], a[120:123], v[16:19], v[40:43]
  ds_read_b128 v[32:35], v6 offset:28672
  v_mfma_f32_16x16x32_bf16 v[48:51], a[124:127], v[16:19], v[48:51]
  s_cmp_eq_u32 s58, 122880
  s_cselect_b32 s59, 163840, 0
  v_mfma_f32_16x16x32_bf16 v[56:59], a[128:131], v[16:19], v[56:59]
  s_waitcnt lgkmcnt(3)
  v_mfma_f32_16x16x32_bf16 v[40:43], a[132:135], v[20:23], v[40:43]
  ds_read_b128 v[16:19], v7 offset:28672
  v_mfma_f32_16x16x32_bf16 v[48:51], a[136:139], v[20:23], v[48:51]
  s_sub_u32 s59, 40960, s59
  s_add_u32 s58, s58, s59
  v_mfma_f32_16x16x32_bf16 v[56:59], a[140:143], v[20:23], v[56:59]
  s_waitcnt lgkmcnt(3)
  v_mfma_f32_16x16x32_bf16 v[40:43], a[144:147], v[24:27], v[40:43]
  ds_read_b128 v[20:23], v6 offset:32768
  v_mfma_f32_16x16x32_bf16 v[48:51], a[148:151], v[24:27], v[48:51]
  s_lshr_b32 s55, s67, 1
  v_mfma_f32_16x16x32_bf16 v[56:59], a[152:155], v[24:27], v[56:59]
  s_lshl_b32 s55, s55, 14
  s_waitcnt lgkmcnt(3)
  v_mfma_f32_16x16x32_bf16 v[40:43], a[156:159], v[28:31], v[40:43]
  ds_read_b128 v[24:27], v7 offset:32768
  v_mfma_f32_16x16x32_bf16 v[48:51], a[160:163], v[28:31], v[48:51]
  s_and_b32 s56, s67, 1
  v_mfma_f32_16x16x32_bf16 v[56:59], a[164:167], v[28:31], v[56:59]
  s_lshl_b32 s56, s56, 12
  s_waitcnt lgkmcnt(3)
  v_mfma_f32_16x16x32_bf16 v[40:43], a[168:171], v[32:35], v[40:43]
  ds_read_b128 v[28:31], v6 offset:36864
  v_mfma_f32_16x16x32_bf16 v[48:51], a[172:175], v[32:35], v[48:51]
  s_add_u32 s55, s55, s56
  v_mfma_f32_16x16x32_bf16 v[56:59], a[176:179], v[32:35], v[56:59]
  s_add_u32 s55, s55, s63
  s_waitcnt lgkmcnt(3)
  v_mfma_f32_16x16x32_bf16 v[40:43], a[180:183], v[16:19], v[40:43]
  ds_read_b128 v[32:35], v7 offset:36864
  v_mfma_f32_16x16x32_bf16 v[48:51], a[184:187], v[16:19], v[48:51]
  s_lshr_b32 s56, s55, 8
  v_mfma_f32_16x16x32_bf16 v[56:59], a[188:191], v[16:19], v[56:59]
  s_and_b32 s56, s56, 0x2000
  s_waitcnt lgkmcnt(3)
  v_mfma_f32_16x16x32_bf16 v[40:43], a[192:195], v[20:23], v[40:43]
  ds_read_b128 v[16:19], v6 offset:2048
  v_mfma_f32_16x16x32_bf16 v[48:51], a[196:199], v[20:23], v[48:51]
  s_xor_b32 s55, s55, s56
  v_mfma_f32_16x16x32_bf16 v[56:59], a[200:203], v[20:23], v[56:59]
  s_add_u32 s67, s67, 1
  s_waitcnt lgkmcnt(3)
  v_mfma_f32_16x16x32_bf16 v[40:43], a[204:207], v[24:27], v[40:43]
  ds_read_b128 v[20:23], v7 offset:2048
  v_mfma_f32_16x16x32_bf16 v[48:51], a[208:211], v[24:27], v[48:51]
  s_add_u32 s56, s55, 16777216
  v_mfma_f32_16x16x32_bf16 v[56:59], a[212:215], v[24:27], v[56:59]
  s_add_u32 s57, s55, 33554432
  s_waitcnt lgkmcnt(3)
  v_mfma_f32_16x16x32_bf16 v[40:43], a[216:219], v[28:31], v[40:43]
  ds_read_b128 v[24:27], v6 offset:6144
  v_mfma_f32_16x16x32_bf16 v[48:51], a[220:223], v[28:31], v[48:51]
  v_mfma_f32_16x16x32_bf16 v[56:59], a[224:227], v[28:31], v[56:59]
  s_waitcnt lgkmcnt(3)
  v_mfma_f32_16x16x32_bf16 v[40:43], a[228:231], v[32:35], v[40:43]
  ds_read_b128 v[28:31], v7 offset:6144
  v_mfma_f32_16x16x32_bf16 v[48:51], a[232:235], v[32:35], v[48:51]
  v_mfma_f32_16x16x32_bf16 v[56:59], a[236:239], v[32:35], v[56:59]
  s_waitcnt lgkmcnt(3)
  v_mfma_f32_16x16x32_bf16 v[44:47], a[0:3], v[16:19], 0
  ds_read_b128 v[32:35], v6 offset:10240
  v_mfma_f32_16x16x32_bf16 v[52:55], a[4:7], v[16:19], 0
  v_mfma_f32_16x16x32_bf16 v[60:63], a[8:11], v[16:19], 0
  s_waitcnt lgkmcnt(3)
  v_cvt_pk_bf16_f32 v64, v40, v41
  v_mfma_f32_16x16x32_bf16 v[44:47], a[12:15], v[20:23], v[44:47]
  ds_read_b128 v[16:19], v7 offset:10240
  v_cvt_pk_bf16_f32 v65, v42, v43
  v_mfma_f32_16x16x32_bf16 v[52:55], a[16:19], v[20:23], v[52:55]
  v_cvt_pk_bf16_f32 v68, v48, v49
  v_mfma_f32_16x16x32_bf16 v[60:63], a[20:23], v[20:23], v[60:63]
  s_waitcnt lgkmcnt(3)
  v_cvt_pk_bf16_f32 v69, v50, v51
  v_mfma_f32_16x16x32_bf16 v[44:47], a[24:27], v[24:27], v[44:47]
  ds_read_b128 v[20:23], v6 offset:14336
  v_cvt_pk_bf16_f32 v72, v56, v57
  v_mfma_f32_16x16x32_bf16 v[52:55], a[28:31], v[24:27], v[52:55]
  v_cvt_pk_bf16_f32 v73, v58, v59
  v_mfma_f32_16x16x32_bf16 v[60:63], a[32:35], v[24:27], v[60:63]
  s_waitcnt lgkmcnt(3)
  v_mfma_f32_16x16x32_bf16 v[44:47], a[36:39], v[28:31], v[44:47]
  ds_read_b128 v[24:27], v7 offset:14336
  v_mfma_f32_16x16x32_bf16 v[52:55], a[40:43], v[28:31], v[52:55]
  s_waitcnt vmcnt(0)
  s_barrier
  v_mfma_f32_16x16x32_bf16 v[60:63], a[44:47], v[28:31], v[60:63]
  buffer_store_dword v10, v9, s[8:11], 0 offen sc1
  s_waitcnt lgkmcnt(3)
  v_mfma_f32_16x16x32_bf16 v[44:47], a[48:51], v[32:35], v[44:47]
  ds_read_b128 v[28:31], v6 offset:18432
  s_add_u32 m0, s54, 0
  v_mfma_f32_16x16x32_bf16 v[52:55], a[52:55], v[32:35], v[52:55]
  buffer_load_dwordx4 v5, s[12:15], s53 offen offset:0 lds
  v_mfma_f32_16x16x32_bf16 v[60:63], a[56:59], v[32:35], v[60:63]
  s_waitcnt lgkmcnt(3)
  v_mfma_f32_16x16x32_bf16 v[44:47], a[60:63], v[16:19], v[44:47]
  ds_read_b128 v[32:35], v7 offset:18432
  s_add_u32 m0, s54, 3968
  v_mfma_f32_16x16x32_bf16 v[52:55], a[64:67], v[16:19], v[52:55]
  buffer_load_dwordx4 v5, s[12:15], s53 offen offset:128 lds
  v_mfma_f32_16x16x32_bf16 v[60:63], a[68:71], v[16:19], v[60:63]
  s_waitcnt lgkmcnt(3)
  v_mfma_f32_16x16x32_bf16 v[44:47], a[72:75], v[20:23], v[44:47]
  ds_read_b128 v[16:19], v6 offset:22528
  s_add_u32 m0, s54, 7936
  v_mfma_f32_16x16x32_bf16 v[52:55], a[76:79], v[20:23], v[52:55]
  buffer_load_dwordx4 v5, s[12:15], s53 offen offset:256 lds
  v_mfma_f32_16x16x32_bf16 v[60:63], a[80:83], v[20:23], v[60:63]
  s_waitcnt lgkmcnt(3)
  v_mfma_f32_16x16x32_bf16 v[44:47], a[84:87], v[24:27], v[44:47]
  ds_read_b128 v[20:23], v7 offset:22528
  s_add_u32 m0, s54, 11904
  v_mfma_f32_16x16x32_bf16 v[52:55], a[88:91], v[24:27], v[52:55]
  buffer_load_dwordx4 v5, s[12:15], s53 offen offset:384 lds
  v_mfma_f32_16x16x32_bf16 v[60:63], a[92:95], v[24:27], v[60:63]
  s_waitcnt lgkmcnt(3)
  v_mfma_f32_16x16x32_bf16 v[44:47], a[96:99], v[28:31], v[44:47]
  ds_read_b128 v[24:27], v6 offset:26624
  s_add_u32 m0, s54, 15872
  v_mfma_f32_16x16x32_bf16 v[52:55], a[100:103], v[28:31], v[52:55]
  buffer_load_dwordx4 v5, s[12:15], s53 offen offset:512 lds
  v_mfma_f32_16x16x32_bf16 v[60:63], a[104:107], v[28:31], v[60:63]
  s_waitcnt lgkmcnt(3)
  v_mfma_f32_16x16x32_bf16 v[44:47], a[108:111], v[32:35], v[44:47]
  ds_read_b128 v[28:31], v7 offset:26624
  s_add_u32 m0, s54, 19840
  v_mfma_f32_16x16x32_bf16 v[52:55], a[112:115], v[32:35], v[52:55]
  buffer_load_dwordx4 v5, s[12:15], s53 offen offset:640 lds
  v_mfma_f32_16x16x32_bf16 v[60:63], a[116:119], v[32:35], v[60:63]
  s_waitcnt lgkmcnt(3)
  v_mfma_f32_16x16x32_bf16 v[44:47], a[120:123], v[16:19], v[44:47]
  ds_read_b128 v[32:35], v6 offset:30720
  s_add_u32 m0, s54, 23808
  v_mfma_f32_16x16x32_bf16 v[52:55], a[124:127], v[16:19], v[52:55]
  buffer_load_dwordx4 v5, s[12:15], s53 offen offset:768 lds
  v_mfma_f32_16x16x32_bf16 v[60:63], a[128:131], v[16:19], v[60:63]
  s_waitcnt lgkmcnt(3)
  v_mfma_f32_16x16x32_bf16 v[44:47], a[132:135], v[20:23], v[44:47]
  ds_read_b128 v[16:19], v7 offset:30720
  s_add_u32 m0, s54, 27776
  v_mfma_f32_16x16x32_bf16 v[52:55], a[136:139], v[20:23], v[52:55]
  buffer_load_dwordx4 v5, s[12:15], s53 offen offset:896 lds
  v_mfma_f32_16x16x32_bf16 v[60:63], a[140:143], v[20:23], v[60:63]
  s_waitcnt lgkmcnt(3)
  v_mfma_f32_16x16x32_bf16 v[44:47], a[144:147], v[24:27], v[44:47]
  ds_read_b128 v[20:23], v6 offset:34816
  s_add_u32 m0, s54, 31744
  v_mfma_f32_16x16x32_bf16 v[52:55], a[148:151], v[24:27], v[52:55]
  buffer_load_dwordx4 v5, s[12:15], s53 offen offset:1024 lds
  v_mfma_f32_16x16x32_bf16 v[60:63], a[152:155], v[24:27], v[60:63]
  s_waitcnt lgkmcnt(3)
  v_mfma_f32_16x16x32_bf16 v[44:47], a[156:159], v[28:31], v[44:47]
  ds_read_b128 v[24:27], v7 offset:34816
  s_add_u32 m0, s54, 35712
  v_mfma_f32_16x16x32_bf16 v[52:55], a[160:163], v[28:31], v[52:55]
  buffer_load_dwordx4 v5, s[12:15], s53 offen offset:1152 lds
  v_mfma_f32_16x16x32_bf16 v[60:63], a[164:167], v[28:31], v[60:63]
  s_waitcnt lgkmcnt(3)
  v_mfma_f32_16x16x32_bf16 v[44:47], a[168:171], v[32:35], v[44:47]
  ds_read_b128 v[28:31], v6 offset:38912
  v_mfma_f32_16x16x32_bf16 v[52:55], a[172:175], v[32:35], v[52:55]
  v_mfma_f32_16x16x32_bf16 v[60:63], a[176:179], v[32:35], v[60:63]
  s_waitcnt lgkmcnt(3)
  v_mfma_f32_16x16x32_bf16 v[44:47], a[180:183], v[16:19], v[44:47]
  ds_read_b128 v[32:35], v7 offset:38912
  v_mfma_f32_16x16x32_bf16 v[52:55], a[184:187], v[16:19], v[52:55]
  v_add_u32 v6, s59, v6
  v_add_u32 v7, s59, v7
  v_mfma_f32_16x16x32_bf16 v[60:63], a[188:191], v[16:19], v[60:63]
  s_waitcnt lgkmcnt(3)
  v_mfma_f32_16x16x32_bf16 v[44:47], a[192:195], v[20:23], v[44:47]
  ds_read_b128 v[16:19], v6 offset:0
  v_mfma_f32_16x16x32_bf16 v[52:55], a[196:199], v[20:23], v[52:55]
  v_mfma_f32_16x16x32_bf16 v[60:63], a[200:203], v[20:23], v[60:63]
  s_waitcnt lgkmcnt(3)
  v_mfma_f32_16x16x32_bf16 v[44:47], a[204:207], v[24:27], v[44:47]
  ds_read_b128 v[20:23], v7 offset:0
  v_mfma_f32_16x16x32_bf16 v[52:55], a[208:211], v[24:27], v[52:55]
  s_add_u32 s52, s52, 1
  v_mfma_f32_16x16x32_bf16 v[60:63], a[212:215], v[24:27], v[60:63]
  s_waitcnt lgkmcnt(3)
  v_mfma_f32_16x16x32_bf16 v[44:47], a[216:219], v[28:31], v[44:47]
  ds_read_b128 v[24:27], v6 offset:4096
  v_mfma_f32_16x16x32_bf16 v[52:55], a[220:223], v[28:31], v[52:55]
  v_mfma_f32_16x16x32_bf16 v[60:63], a[224:227], v[28:31], v[60:63]
  s_waitcnt lgkmcnt(3)
  v_mfma_f32_16x16x32_bf16 v[44:47], a[228:231], v[32:35], v[44:47]
  ds_read_b128 v[28:31], v7 offset:4096
  v_mfma_f32_16x16x32_bf16 v[52:55], a[232:235], v[32:35], v[52:55]
  s_cmp_lt_u32 s52, s62
  v_mfma_f32_16x16x32_bf16 v[60:63], a[236:239], v[32:35], v[60:63]
  s_waitcnt lgkmcnt(3)
  s_cbranch_scc1 pa_loop_12
  v_cvt_pk_bf16_f32 v66, v44, v45
  v_cvt_pk_bf16_f32 v67, v46, v47
  s_nop 1
  v_cvt_pk_bf16_f32 v70, v52, v53
  v_cvt_pk_bf16_f32 v71, v54, v55
  v_cvt_pk_bf16_f32 v74, v60, v61
  v_cvt_pk_bf16_f32 v75, v62, v63
  v_permlane16_swap_b32 v64, v66
  v_permlane16_swap_b32 v65, v67
  v_permlane16_swap_b32 v68, v70
  v_permlane16_swap_b32 v69, v71
  v_permlane16_swap_b32 v72, v74
  v_permlane16_swap_b32 v73, v75
  buffer_store_dwordx4 v[64:67], v8, s[8:11], s55 offen sc1
  buffer_store_dwordx4 v[68:71], v8, s[8:11], s56 offen sc1
  buffer_store_dwordx4 v[72:75], v8, s[8:11], s57 offen sc1
  v_mov_b32 v10, s52
  s_waitcnt vmcnt(0) lgkmcnt(0)
  s_barrier
  buffer_store_dword v10, v9, s[8:11], 0 offen sc1
pa_att:
  v_min_u32 v1, 19, v0
  v_cmp_lt_u32 vcc, 9, v1
  s_lshl_b32 s46, s65, 4
  s_max_u32 s47, s46, 14
  s_sub_u32 s47, s47, 14
  s_lshr_b32 s47, s47, 5
  s_lshr_b32 s48, s46, 5
  v_mov_b32 v2, s47
  v_mov_b32 v3, s48
  v_cndmask_b32 v2, v2, v3, vcc
  v_subrev_u32 v3, 10, v1
  v_cndmask_b32 v1, v1, v3, vcc
  v_mul_u32_u24 v3, 171, v2
  v_lshrrev_b32 v3, 10, v3
  v_max_u32 v4, 28, v2
  v_subrev_u32 v4, 28, v4
  v_mul_u32_u24 v4, 171, v4
  v_lshrrev_b32 v4, 9, v4
  v_max_u32 v3, v3, v4
  v_mul_u32_u24 v3, 10, v3
  v_add_u32 v1, v1, v3
  v_lshlrev_b32 v1, 7, v1
  v_add_u32 v1, 1081344, v1
  v_lshrrev_b32 v3, 4, v0
  s_lshl_b32 s47, s42, 2
  v_add_u32 v3, s47, v3
  v_mul_u32_u24 v3, 5, v3
  s_xor_b32 s47, s3, 132128768
  v_add_u32 v8, 0, v3
  v_mul_u32_u24 v4, 171, v8
  v_lshrrev_b32 v4, 12, v4
  v_mul_u32_u24 v5, 3, v4
  v_lshrrev_b32 v6, 3, v8
  v_sub_u32 v5, v6, v5
  v_and_b32 v8, 7, v8
  v_lshl_add_u32 v8, v8, 8, s47
  v_lshl_add_u32 v8, v4, 19, v8
  v_lshl_add_u32 v8, v5, 24, v8
  v_lshrrev_b32 v4, 8, v8
  v_and_b32 v4, 0x2000, v4
  v_xor_b32 v8, v8, v4
  v_add_u32 v9, 1, v3
  v_mul_u32_u24 v4, 171, v9
  v_lshrrev_b32 v4, 12, v4
  v_mul_u32_u24 v5, 3, v4
  v_lshrrev_b32 v6, 3, v9
  v_sub_u32 v5, v6, v5
  v_and_b32 v9, 7, v9
  v_lshl_add_u32 v9, v9, 8, s47
  v_lshl_add_u32 v9, v4, 19, v9
  v_lshl_add_u32 v9, v5, 24, v9
  v_lshrrev_b32 v4, 8, v9
  v_and_b32 v4, 0x2000, v4
  v_xor_b32 v9, v9, v4
  v_add_u32 v10, 2, v3
  v_mul_u32_u24 v4, 171, v10
  v_lshrrev_b32 v4, 12, v4
  v_mul_u32_u24 v5, 3, v4
  v_lshrrev_b32 v6, 3, v10
  v_sub_u32 v5, v6, v5
  v_and_b32 v10, 7, v10
  v_lshl_add_u32 v10, v10, 8, s47
  v_lshl_add_u32 v10, v4, 19, v10
  v_lshl_add_u32 v10, v5, 24, v10
  v_lshrrev_b32 v4, 8, v10
  v_and_b32 v4, 0x2000, v4
  v_xor_b32 v10, v10, v4
  v_add_u32 v11, 3, v3
  v_mul_u32_u24 v4, 171, v11
  v_lshrrev_b32 v4, 12, v4
  v_mul_u32_u24 v5, 3, v4
  v_lshrrev_b32 v6, 3, v11
  v_sub_u32 v5, v6, v5
  v_and_b32 v11, 7, v11
  v_lshl_add_u32 v11, v11, 8, s47
  v_lshl_add_u32 v11, v4, 19, v11
  v_lshl_add_u32 v11, v5, 24, v11
  v_lshrrev_b32 v4, 8, v11
  v_and_b32 v4, 0x2000, v4
  v_xor_b32 v11, v11, v4
  v_add_u32 v12, 4, v3
  v_mul_u32_u24 v4, 171, v12
  v_lshrrev_b32 v4, 12, v4
  v_mul_u32_u24 v5, 3, v4
  v_lshrrev_b32 v6, 3, v12
  v_sub_u32 v5, v6, v5
  v_and_b32 v12, 7, v12
  v_lshl_add_u32 v12, v12, 8, s47
  v_lshl_add_u32 v12, v4, 19, v12
  v_lshl_add_u32 v12, v5, 24, v12
  v_lshrrev_b32 v4, 8, v12
  v_and_b32 v4, 0x2000, v4
  v_xor_b32 v12, v12, v4
  v_add_u32 v13, 80, v3
  v_mul_u32_u24 v4, 171, v13
  v_lshrrev_b32 v4, 12, v4
  v_mul_u32_u24 v5, 3, v4
  v_lshrrev_b32 v6, 3, v13
  v_sub_u32 v5, v6, v5
  v_and_b32 v13, 7, v13
  v_lshl_add_u32 v13, v13, 8, s47
  v_lshl_add_u32 v13, v4, 19, v13
  v_lshl_add_u32 v13, v5, 24, v13
  v_lshrrev_b32 v4, 8, v13
  v_and_b32 v4, 0x2000, v4
  v_xor_b32 v13, v13, v4
  v_add_u32 v14, 81, v3
  v_mul_u32_u24 v4, 171, v14
  v_lshrrev_b32 v4, 12, v4
  v_mul_u32_u24 v5, 3, v4
  v_lshrrev_b32 v6, 3, v14
  v_sub_u32 v5, v6, v5
  v_and_b32 v14, 7, v14
  v_lshl_add_u32 v14, v14, 8, s47
  v_lshl_add_u32 v14, v4, 19, v14
  v_lshl_add_u32 v14, v5, 24, v14
  v_lshrrev_b32 v4, 8, v14
  v_and_b32 v4, 0x2000, v4
  v_xor_b32 v14, v14, v4
  v_add_u32 v15, 82, v3
  v_mul_u32_u24 v4, 171, v15
  v_lshrrev_b32 v4, 12, v4
  v_mul_u32_u24 v5, 3, v4
  v_lshrrev_b32 v6, 3, v15
  v_sub_u32 v5, v6, v5
  v_and_b32 v15, 7, v15
  v_lshl_add_u32 v15, v15, 8, s47
  v_lshl_add_u32 v15, v4, 19, v15
  v_lshl_add_u32 v15, v5, 24, v15
  v_lshrrev_b32 v4, 8, v15
  v_and_b32 v4, 0x2000, v4
  v_xor_b32 v15, v15, v4
  v_add_u32 v16, 83, v3
  v_mul_u32_u24 v4, 171, v16
  v_lshrrev_b32 v4, 12, v4
  v_mul_u32_u24 v5, 3, v4
  v_lshrrev_b32 v6, 3, v16
  v_sub_u32 v5, v6, v5
  v_and_b32 v16, 7, v16
  v_lshl_add_u32 v16, v16, 8, s47
  v_lshl_add_u32 v16, v4, 19, v16
  v_lshl_add_u32 v16, v5, 24, v16
  v_lshrrev_b32 v4, 8, v16
  v_and_b32 v4, 0x2000, v4
  v_xor_b32 v16, v16, v4
  v_add_u32 v17, 84, v3
  v_mul_u32_u24 v4, 171, v17
  v_lshrrev_b32 v4, 12, v4
  v_mul_u32_u24 v5, 3, v4
  v_lshrrev_b32 v6, 3, v17
  v_sub_u32 v5, v6, v5
  v_and_b32 v17, 7, v17
  v_lshl_add_u32 v17, v17, 8, s47
  v_lshl_add_u32 v17, v4, 19, v17
  v_lshl_add_u32 v17, v5, 24, v17
  v_lshrrev_b32 v4, 8, v17
  v_and_b32 v4, 0x2000, v4
  v_xor_b32 v17, v17, v4
  v_add_u32 v18, 160, v3
  v_mul_u32_u24 v4, 171, v18
  v_lshrrev_b32 v4, 12, v4
  v_mul_u32_u24 v5, 3, v4
  v_lshrrev_b32 v6, 3, v18
  v_sub_u32 v5, v6, v5
  v_and_b32 v18, 7, v18
  v_lshl_add_u32 v18, v18, 8, s47
  v_lshl_add_u32 v18, v4, 19, v18
  v_lshl_add_u32 v18, v5, 24, v18
  v_lshrrev_b32 v4, 8, v18
  v_and_b32 v4, 0x2000, v4
  v_xor_b32 v18, v18, v4
  v_add_u32 v19, 161, v3
  v_mul_u32_u24 v4, 171, v19
  v_lshrrev_b32 v4, 12, v4
  v_mul_u32_u24 v5, 3, v4
  v_lshrrev_b32 v6, 3, v19
  v_sub_u32 v5, v6, v5
  v_and_b32 v19, 7, v19
  v_lshl_add_u32 v19, v19, 8, s47
  v_lshl_add_u32 v19, v4, 19, v19
  v_lshl_add_u32 v19, v5, 24, v19
  v_lshrrev_b32 v4, 8, v19
  v_and_b32 v4, 0x2000, v4
  v_xor_b32 v19, v19, v4
  v_add_u32 v20, 162, v3
  v_mul_u32_u24 v4, 171, v20
  v_lshrrev_b32 v4, 12, v4
  v_mul_u32_u24 v5, 3, v4
  v_lshrrev_b32 v6, 3, v20
  v_sub_u32 v5, v6, v5
  v_and_b32 v20, 7, v20
  v_lshl_add_u32 v20, v20, 8, s47
  v_lshl_add_u32 v20, v4, 19, v20
  v_lshl_add_u32 v20, v5, 24, v20
  v_lshrrev_b32 v4, 8, v20
  v_and_b32 v4, 0x2000, v4
  v_xor_b32 v20, v20, v4
  v_add_u32 v21, 163, v3
  v_mul_u32_u24 v4, 171, v21
  v_lshrrev_b32 v4, 12, v4
  v_mul_u32_u24 v5, 3, v4
  v_lshrrev_b32 v6, 3, v21
  v_sub_u32 v5, v6, v5
  v_and_b32 v21, 7, v21
  v_lshl_add_u32 v21, v21, 8, s47
  v_lshl_add_u32 v21, v4, 19, v21
  v_lshl_add_u32 v21, v5, 24, v21
  v_lshrrev_b32 v4, 8, v21
  v_and_b32 v4, 0x2000, v4
  v_xor_b32 v21, v21, v4
  v_add_u32 v22, 164, v3
  v_mul_u32_u24 v4, 171, v22
  v_lshrrev_b32 v4, 12, v4
  v_mul_u32_u24 v5, 3, v4
  v_lshrrev_b32 v6, 3, v22
  v_sub_u32 v5, v6, v5
  v_and_b32 v22, 7, v22
  v_lshl_add_u32 v22, v22, 8, s47
  v_lshl_add_u32 v22, v4, 19, v22
  v_lshl_add_u32 v22, v5, 24, v22
  v_lshrrev_b32 v4, 8, v22
  v_and_b32 v4, 0x2000, v4
  v_xor_b32 v22, v22, v4
  v_and_b32 v5, 15, v0
  v_add_u32 v6, s46, v5
  v_subrev_u32 v4, 0, v6
  v_max_i32 v4, 0, v4
  v_and_b32 v23, 15, v4
  v_lshlrev_b32 v23, 4, v23
  v_bfe_u32 v7, v4, 4, 2
  v_lshl_add_u32 v23, v7, 11, v23
  v_lshrrev_b32 v4, 6, v4
  v_lshl_add_u32 v23, v4, 14, v23
  v_cmp_gt_u32 s[72:73], 0, v6
  v_subrev_u32 v4, 2, v6
  v_max_i32 v4, 0, v4
  v_and_b32 v24, 15, v4
  v_lshlrev_b32 v24, 4, v24
  v_bfe_u32 v7, v4, 4, 2
  v_lshl_add_u32 v24, v7, 11, v24
  v_lshrrev_b32 v4, 6, v4
  v_lshl_add_u32 v24, v4, 14, v24
  v_cmp_gt_u32 s[74:75], 2, v6
  v_subrev_u32 v4, 4, v6
  v_max_i32 v4, 0, v4
  v_and_b32 v25, 15, v4
  v_lshlrev_b32 v25, 4, v25
  v_bfe_u32 v7, v4, 4, 2
  v_lshl_add_u32 v25, v7, 11, v25
  v_lshrrev_b32 v4, 6, v4
  v_lshl_add_u32 v25, v4, 14, v25
  v_cmp_gt_u32 s[76:77], 4, v6
  v_subrev_u32 v4, 6, v6
  v_max_i32 v4, 0, v4
  v_and_b32 v26, 15, v4
  v_lshlrev_b32 v26, 4, v26
  v_bfe_u32 v7, v4, 4, 2
  v_lshl_add_u32 v26, v7, 11, v26
  v_lshrrev_b32 v4, 6, v4
  v_lshl_add_u32 v26, v4, 14, v26
  v_cmp_gt_u32 s[78:79], 6, v6
  v_subrev_u32 v4, 8, v6
  v_max_i32 v4, 0, v4
  v_and_b32 v27, 15, v4
  v_lshlrev_b32 v27, 4, v27
  v_bfe_u32 v7, v4, 4, 2
  v_lshl_add_u32 v27, v7, 11, v27
  v_lshrrev_b32 v4, 6, v4
  v_lshl_add_u32 v27, v4, 14, v27
  v_cmp_gt_u32 s[80:81], 8, v6
  v_subrev_u32 v4, 10, v6
  v_max_i32 v4, 0, v4
  v_and_b32 v28, 15, v4
  v_lshlrev_b32 v28, 4, v28
  v_bfe_u32 v7, v4, 4, 2
  v_lshl_add_u32 v28, v7, 11, v28
  v_lshrrev_b32 v4, 6, v4
  v_lshl_add_u32 v28, v4, 14, v28
  v_cmp_gt_u32 s[82:83], 10, v6
  v_subrev_u32 v4, 12, v6
  v_max_i32 v4, 0, v4
  v_and_b32 v29, 15, v4
  v_lshlrev_b32 v29, 4, v29
  v_bfe_u32 v7, v4, 4, 2
  v_lshl_add_u32 v29, v7, 11, v29
  v_lshrrev_b32 v4, 6, v4
  v_lshl_add_u32 v29, v4, 14, v29
  v_cmp_gt_u32 s[84:85], 12, v6
  v_subrev_u32 v4, 14, v6
  v_max_i32 v4, 0, v4
  v_and_b32 v30, 15, v4
  v_lshlrev_b32 v30, 4, v30
  v_bfe_u32 v7, v4, 4, 2
  v_lshl_add_u32 v30, v7, 11, v30
  v_lshrrev_b32 v4, 6, v4
  v_lshl_add_u32 v30, v4, 14, v30
  v_cmp_gt_u32 s[86:87], 14, v6
  s_mov_b32 s50, 0
  s_mov_b32 s66, 0
pa_wait:
  buffer_load_dword v4, v1, s[8:11], 0 offen sc1
  s_add_u32 s50, s50, 1
  s_cmp_gt_u32 s50, 131072
  s_cbranch_scc1 L_fail
  s_waitcnt vmcnt(0)
  v_cmp_le_u32 vcc, v4, v2
  s_cbranch_vccnz pa_wait
  v_add_u32 v232, v8, v23
  buffer_load_dwordx4 v[32:35], v232, s[8:11], s66 offen sc1
  v_add_u32 v233, v9, v23
  buffer_load_dwordx4 v[36:39], v233, s[8:11], s66 offen sc1
  v_add_u32 v234, v10, v23
  buffer_load_dwordx4 v[40:43], v234, s[8:11], s66 offen sc1
  v_add_u32 v235, v11, v23
  buffer_load_dwordx4 v[44:47], v235, s[8:11], s66 offen sc1
  v_add_u32 v236, v12, v23
  buffer_load_dwordx4 v[48:51], v236, s[8:11], s66 offen sc1
  v_add_u32 v232, v13, v23
  buffer_load_dwordx4 v[72:75], v232, s[8:11], s66 offen sc1
  v_add_u32 v233, v14, v23
  buffer_load_dwordx4 v[76:79], v233, s[8:11], s66 offen sc1
  v_add_u32 v234, v15, v23
  buffer_load_dwordx4 v[80:83], v234, s[8:11], s66 offen sc1
  v_add_u32 v235, v16, v23
  buffer_load_dwordx4 v[84:87], v235, s[8:11], s66 offen sc1
  v_add_u32 v236, v17, v23
  buffer_load_dwordx4 v[88:91], v236, s[8:11], s66 offen sc1
  v_add_u32 v232, v13, v24
  buffer_load_dwordx4 v[92:95], v232, s[8:11], s66 offen sc1
  v_add_u32 v233, v14, v24
  buffer_load_dwordx4 v[96:99], v233, s[8:11], s66 offen sc1
  v_add_u32 v234, v15, v24
  buffer_load_dwordx4 v[100:103], v234, s[8:11], s66 offen sc1
  v_add_u32 v235, v16, v24
  buffer_load_dwordx4 v[104:107], v235, s[8:11], s66 offen sc1
  v_add_u32 v236, v17, v24
  buffer_load_dwordx4 v[108:111], v236, s[8:11], s66 offen sc1
  v_add_u32 v232, v13, v25
  buffer_load_dwordx4 v[112:115], v232, s[8:11], s66 offen sc1
  v_add_u32 v233, v14, v25
  buffer_load_dwordx4 v[116:119], v233, s[8:11], s66 offen sc1
  v_add_u32 v234, v15, v25
  buffer_load_dwordx4 v[120:123], v234, s[8:11], s66 offen sc1
  v_add_u32 v235, v16, v25
  buffer_load_dwordx4 v[124:127], v235, s[8:11], s66 offen sc1
  v_add_u32 v236, v17, v25
  buffer_load_dwordx4 v[128:131], v236, s[8:11], s66 offen sc1
  v_add_u32 v232, v13, v26
  buffer_load_dwordx4 v[132:135], v232, s[8:11], s66 offen sc1
  v_add_u32 v233, v14, v26
  buffer_load_dwordx4 v[136:139], v233, s[8:11], s66 offen sc1
  v_add_u32 v234, v15, v26
  buffer_load_dwordx4 v[140:143], v234, s[8:11], s66 offen sc1
  v_add_u32 v235, v16, v26
  buffer_load_dwordx4 v[144:147], v235, s[8:11], s66 offen sc1
  v_add_u32 v236, v17, v26
  buffer_load_dwordx4 v[148:151], v236, s[8:11], s66 offen sc1
  v_add_u32 v232, v13, v27
  buffer_load_dwordx4 v[152:155], v232, s[8:11], s66 offen sc1
  v_add_u32 v233, v14, v27
  buffer_load_dwordx4 v[156:159], v233, s[8:11], s66 offen sc1
  v_add_u32 v234, v15, v27
  buffer_load_dwordx4 v[160:163], v234, s[8:11], s66 offen sc1
  v_add_u32 v235, v16, v27
  buffer_load_dwordx4 v[164:167], v235, s[8:11], s66 offen sc1
  v_add_u32 v236, v17, v27
  buffer_load_dwordx4 v[168:171], v236, s[8:11], s66 offen sc1
  v_add_u32 v232, v13, v28
  buffer_load_dwordx4 v[172:175], v232, s[8:11], s66 offen sc1
  v_add_u32 v233, v14, v28
  buffer_load_dwordx4 v[176:179], v233, s[8:11], s66 offen sc1
  v_add_u32 v234, v15, v28
  buffer_load_dwordx4 v[180:183], v234, s[8:11], s66 offen sc1
  v_add_u32 v235, v16, v28
  buffer_load_dwordx4 v[184:187], v235, s[8:11], s66 offen sc1
  v_add_u32 v236, v17, v28
  buffer_load_dwordx4 v[188:191], v236, s[8:11], s66 offen sc1
  v_add_u32 v232, v13, v29
  buffer_load_dwordx4 v[192:195], v232, s[8:11], s66 offen sc1
  v_add_u32 v233, v14, v29
  buffer_load_dwordx4 v[196:199], v233, s[8:11], s66 offen sc1
  v_add_u32 v234, v15, v29
  buffer_load_dwordx4 v[200:203], v234, s[8:11], s66 offen sc1
  v_add_u32 v235, v16, v29
  buffer_load_dwordx4 v[204:207], v235, s[8:11], s66 offen sc1
  v_add_u32 v236, v17, v29
  buffer_load_dwordx4 v[208:211], v236, s[8:11], s66 offen sc1
  v_add_u32 v232, v13, v30
  buffer_load_dwordx4 v[212:215], v232, s[8:11], s66 offen sc1
  v_add_u32 v233, v14, v30
  buffer_load_dwordx4 v[216:219], v233, s[8:11], s66 offen sc1
  v_add_u32 v234, v15, v30
  buffer_load_dwordx4 v[220:223], v234, s[8:11], s66 offen sc1
  v_add_u32 v235, v16, v30
  buffer_load_dwordx4 v[224:227], v235, s[8:11], s66 offen sc1
  v_add_u32 v236, v17, v30
  buffer_load_dwordx4 v[228:231], v236, s[8:11], s66 offen sc1
  s_waitcnt vmcnt(35)
  v_dot2_f32_bf16 v52, v32, v72, 0
  v_dot2_f32_bf16 v60, v42, v82, 0
  v_dot2_f32_bf16 v52, v33, v73, v52
  v_dot2_f32_bf16 v60, v43, v83, v60
  v_dot2_f32_bf16 v52, v34, v74, v52
  v_dot2_f32_bf16 v60, v44, v84, v60
  v_dot2_f32_bf16 v52, v35, v75, v52
  v_dot2_f32_bf16 v60, v45, v85, v60
  v_dot2_f32_bf16 v52, v36, v76, v52
  v_dot2_f32_bf16 v60, v46, v86, v60
  v_dot2_f32_bf16 v52, v37, v77, v52
  v_dot2_f32_bf16 v60, v47, v87, v60
  v_dot2_f32_bf16 v52, v38, v78, v52
  v_dot2_f32_bf16 v60, v48, v88, v60
  v_dot2_f32_bf16 v52, v39, v79, v52
  v_dot2_f32_bf16 v60, v49, v89, v60
  v_dot2_f32_bf16 v52, v40, v80, v52
  v_dot2_f32_bf16 v60, v50, v90, v60
  v_dot2_f32_bf16 v52, v41, v81, v52
  v_dot2_f32_bf16 v60, v51, v91, v60
  v_add_u32 v232, v18, v23
  buffer_load_dwordx4 v[72:75], v232, s[8:11], s66 offen sc1
  v_add_u32 v233, v19, v23
  buffer_load_dwordx4 v[76:79], v233, s[8:11], s66 offen sc1
  v_add_u32 v234, v20, v23
  buffer_load_dwordx4 v[80:83], v234, s[8:11], s66 offen sc1
  v_add_u32 v235, v21, v23
  buffer_load_dwordx4 v[84:87], v235, s[8:11], s66 offen sc1
  v_add_u32 v236, v22, v23
  buffer_load_dwordx4 v[88:91], v236, s[8:11], s66 offen sc1
  s_waitcnt vmcnt(35)
  v_dot2_f32_bf16 v53, v32, v92, 0
  v_dot2_f32_bf16 v61, v42, v102, 0
  v_dot2_f32_bf16 v53, v33, v93, v53
  v_dot2_f32_bf16 v61, v43, v103, v61
  v_dot2_f32_bf16 v53, v34, v94, v53
  v_dot2_f32_bf16 v61, v44, v104, v61
  v_dot2_f32_bf16 v53, v35, v95, v53
  v_dot2_f32_bf16 v61, v45, v105, v61
  v_dot2_f32_bf16 v53, v36, v96, v53
  v_dot2_f32_bf16 v61, v46, v106, v61
  v_dot2_f32_bf16 v53, v37, v97, v53
  v_dot2_f32_bf16 v61, v47, v107, v61
  v_dot2_f32_bf16 v53, v38, v98, v53
  v_dot2_f32_bf16 v61, v48, v108, v61
  v_dot2_f32_bf16 v53, v39, v99, v53
  v_dot2_f32_bf16 v61, v49, v109, v61
  v_dot2_f32_bf16 v53, v40, v100, v53
  v_dot2_f32_bf16 v61, v50, v110, v61
  v_dot2_f32_bf16 v53, v41, v101, v53
  v_dot2_f32_bf16 v61, v51, v111, v61
  v_add_u32 v232, v18, v24
  buffer_load_dwordx4 v[92:95], v232, s[8:11], s66 offen sc1
  v_add_u32 v233, v19, v24
  buffer_load_dwordx4 v[96:99], v233, s[8:11], s66 offen sc1
  v_add_u32 v234, v20, v24
  buffer_load_dwordx4 v[100:103], v234, s[8:11], s66 offen sc1
  v_add_u32 v235, v21, v24
  buffer_load_dwordx4 v[104:107], v235, s[8:11], s66 offen sc1
  v_add_u32 v236, v22, v24
  buffer_load_dwordx4 v[108:111], v236, s[8:11], s66 offen sc1
  s_waitcnt vmcnt(35)
  v_dot2_f32_bf16 v54, v32, v112, 0
  v_dot2_f32_bf16 v62, v42, v122, 0
  v_dot2_f32_bf16 v54, v33, v113, v54
  v_dot2_f32_bf16 v62, v43, v123, v62
  v_dot2_f32_bf16 v54, v34, v114, v54
  v_dot2_f32_bf16 v62, v44, v124, v62
  v_dot2_f32_bf16 v54, v35, v115, v54
  v_dot2_f32_bf16 v62, v45, v125, v62
  v_dot2_f32_bf16 v54, v36, v116, v54
  v_dot2_f32_bf16 v62, v46, v126, v62
  v_dot2_f32_bf16 v54, v37, v117, v54
  v_dot2_f32_bf16 v62, v47, v127, v62
  v_dot2_f32_bf16 v54, v38, v118, v54
  v_dot2_f32_bf16 v62, v48, v128, v62
  v_dot2_f32_bf16 v54, v39, v119, v54
  v_dot2_f32_bf16 v62, v49, v129, v62
  v_dot2_f32_bf16 v54, v40, v120, v54
  v_dot2_f32_bf16 v62, v50, v130, v62
  v_dot2_f32_bf16 v54, v41, v121, v54
  v_dot2_f32_bf16 v62, v51, v131, v62
  v_add_u32 v232, v18, v25
  buffer_load_dwordx4 v[112:115], v232, s[8:11], s66 offen sc1
  v_add_u32 v233, v19, v25
  buffer_load_dwordx4 v[116:119], v233, s[8:11], s66 offen sc1
  v_add_u32 v234, v20, v25
  buffer_load_dwordx4 v[120:123], v234, s[8:11], s66 offen sc1
  v_add_u32 v235, v21, v25
  buffer_load_dwordx4 v[124:127], v235, s[8:11], s66 offen sc1
  v_add_u32 v236, v22, v25
  buffer_load_dwordx4 v[128:131], v236, s[8:11], s66 offen sc1
  s_waitcnt vmcnt(35)
  v_dot2_f32_bf16 v55, v32, v132, 0
  v_dot2_f32_bf16 v63, v42, v142, 0
  v_dot2_f32_bf16 v55, v33, v133, v55
  v_dot2_f32_bf16 v63, v43, v143, v63
  v_dot2_f32_bf16 v55, v34, v134, v55
  v_dot2_f32_bf16 v63, v44, v144, v63
  v_dot2_f32_bf16 v55, v35, v135, v55
  v_dot2_f32_bf16 v63, v45, v145, v63
  v_dot2_f32_bf16 v55, v36, v136, v55
  v_dot2_f32_bf16 v63, v46, v146, v63
  v_dot2_f32_bf16 v55, v37, v137, v55
  v_dot2_f32_bf16 v63, v47, v147, v63
  v_dot2_f32_bf16 v55, v38, v138, v55
  v_dot2_f32_bf16 v63, v48, v148, v63
  v_dot2_f32_bf16 v55, v39, v139, v55
  v_dot2_f32_bf16 v63, v49, v149, v63
  v_dot2_f32_bf16 v55, v40, v140, v55
  v_dot2_f32_bf16 v63, v50, v150, v63
  v_dot2_f32_bf16 v55, v41, v141, v55
  v_dot2_f32_bf16 v63, v51, v151, v63
  v_add_u32 v232, v18, v26
  buffer_load_dwordx4 v[132:135], v232, s[8:11], s66 offen sc1
  v_add_u32 v233, v19, v26
  buffer_load_dwordx4 v[136:139], v233, s[8:11], s66 offen sc1
  v_add_u32 v234, v20, v26
  buffer_load_dwordx4 v[140:143], v234, s[8:11], s66 offen sc1
  v_add_u32 v235, v21, v26
  buffer_load_dwordx4 v[144:147], v235, s[8:11], s66 offen sc1
  v_add_u32 v236, v22, v26
  buffer_load_dwordx4 v[148:151], v236, s[8:11], s66 offen sc1
  s_waitcnt vmcnt(35)
  v_dot2_f32_bf16 v56, v32, v152, 0
  v_dot2_f32_bf16 v64, v42, v162, 0
  v_dot2_f32_bf16 v56, v33, v153, v56
  v_dot2_f32_bf16 v64, v43, v163, v64
  v_dot2_f32_bf16 v56, v34, v154, v56
  v_dot2_f32_bf16 v64, v44, v164, v64
  v_dot2_f32_bf16 v56, v35, v155, v56
  v_dot2_f32_bf16 v64, v45, v165, v64
  v_dot2_f32_bf16 v56, v36, v156, v56
  v_dot2_f32_bf16 v64, v46, v166, v64
  v_dot2_f32_bf16 v56, v37, v157, v56
  v_dot2_f32_bf16 v64, v47, v167, v64
  v_dot2_f32_bf16 v56, v38, v158, v56
  v_dot2_f32_bf16 v64, v48, v168, v64
  v_dot2_f32_bf16 v56, v39, v159, v56
  v_dot2_f32_bf16 v64, v49, v169, v64
  v_dot2_f32_bf16 v56, v40, v160, v56
  v_dot2_f32_bf16 v64, v50, v170, v64
  v_dot2_f32_bf16 v56, v41, v161, v56
  v_dot2_f32_bf16 v64, v51, v171, v64
  v_add_u32 v232, v18, v27
  buffer_load_dwordx4 v[152:155], v232, s[8:11], s66 offen sc1
  v_add_u32 v233, v19, v27
  buffer_load_dwordx4 v[156:159], v233, s[8:11], s66 offen sc1
  v_add_u32 v234, v20, v27
  buffer_load_dwordx4 v[160:163], v234, s[8:11], s66 offen sc1
  v_add_u32 v235, v21, v27
  buffer_load_dwordx4 v[164:167], v235, s[8:11], s66 offen sc1
  v_add_u32 v236, v22, v27
  buffer_load_dwordx4 v[168:171], v236, s[8:11], s66 offen sc1
  s_waitcnt vmcnt(35)
  v_dot2_f32_bf16 v57, v32, v172, 0
  v_dot2_f32_bf16 v65, v42, v182, 0
  v_dot2_f32_bf16 v57, v33, v173, v57
  v_dot2_f32_bf16 v65, v43, v183, v65
  v_dot2_f32_bf16 v57, v34, v174, v57
  v_dot2_f32_bf16 v65, v44, v184, v65
  v_dot2_f32_bf16 v57, v35, v175, v57
  v_dot2_f32_bf16 v65, v45, v185, v65
  v_dot2_f32_bf16 v57, v36, v176, v57
  v_dot2_f32_bf16 v65, v46, v186, v65
  v_dot2_f32_bf16 v57, v37, v177, v57
  v_dot2_f32_bf16 v65, v47, v187, v65
  v_dot2_f32_bf16 v57, v38, v178, v57
  v_dot2_f32_bf16 v65, v48, v188, v65
  v_dot2_f32_bf16 v57, v39, v179, v57
  v_dot2_f32_bf16 v65, v49, v189, v65
  v_dot2_f32_bf16 v57, v40, v180, v57
  v_dot2_f32_bf16 v65, v50, v190, v65
  v_dot2_f32_bf16 v57, v41, v181, v57
  v_dot2_f32_bf16 v65, v51, v191, v65
  v_add_u32 v232, v18, v28
  buffer_load_dwordx4 v[172:175], v232, s[8:11], s66 offen sc1
  v_add_u32 v233, v19, v28
  buffer_load_dwordx4 v[176:179], v233, s[8:11], s66 offen sc1
  v_add_u32 v234, v20, v28
  buffer_load_dwordx4 v[180:183], v234, s[8:11], s66 offen sc1
  v_add_u32 v235, v21, v28
  buffer_load_dwordx4 v[184:187], v235, s[8:11], s66 offen sc1
  v_add_u32 v236, v22, v28
  buffer_load_dwordx4 v[188:191], v236, s[8:11], s66 offen sc1
  s_waitcnt vmcnt(35)
  v_dot2_f32_bf16 v58, v32, v192, 0
  v_dot2_f32_bf16 v66, v42, v202, 0
  v_dot2_f32_bf16 v58, v33, v193, v58
  v_dot2_f32_bf16 v66, v43, v203, v66
  v_dot2_f32_bf16 v58, v34, v194, v58
  v_dot2_f32_bf16 v66, v44, v204, v66
  v_dot2_f32_bf16 v58, v35, v195, v58
  v_dot2_f32_bf16 v66, v45, v205, v66
  v_dot2_f32_bf16 v58, v36, v196, v58
  v_dot2_f32_bf16 v66, v46, v206, v66
  v_dot2_f32_bf16 v58, v37, v197, v58
  v_dot2_f32_bf16 v66, v47, v207, v66
  v_dot2_f32_bf16 v58, v38, v198, v58
  v_dot2_f32_bf16 v66, v48, v208, v66
  v_dot2_f32_bf16 v58, v39, v199, v58
  v_dot2_f32_bf16 v66, v49, v209, v66
  v_dot2_f32_bf16 v58, v40, v200, v58
  v_dot2_f32_bf16 v66, v50, v210, v66
  v_dot2_f32_bf16 v58, v41, v201, v58
  v_dot2_f32_bf16 v66, v51, v211, v66
  v_add_u32 v232, v18, v29
  buffer_load_dwordx4 v[192:195], v232, s[8:11], s66 offen sc1
  v_add_u32 v233, v19, v29
  buffer_load_dwordx4 v[196:199], v233, s[8:11], s66 offen sc1
  v_add_u32 v234, v20, v29
  buffer_load_dwordx4 v[200:203], v234, s[8:11], s66 offen sc1
  v_add_u32 v235, v21, v29
  buffer_load_dwordx4 v[204:207], v235, s[8:11], s66 offen sc1
  v_add_u32 v236, v22, v29
  buffer_load_dwordx4 v[208:211], v236, s[8:11], s66 offen sc1
  s_waitcnt vmcnt(35)
  v_dot2_f32_bf16 v59, v32, v212, 0
  v_dot2_f32_bf16 v67, v42, v222, 0
  v_dot2_f32_bf16 v59, v33, v213, v59
  v_dot2_f32_bf16 v67, v43, v223, v67
  v_dot2_f32_bf16 v59, v34, v214, v59
  v_dot2_f32_bf16 v67, v44, v224, v67
  v_dot2_f32_bf16 v59, v35, v215, v59
  v_dot2_f32_bf16 v67, v45, v225, v67
  v_dot2_f32_bf16 v59, v36, v216, v59
  v_dot2_f32_bf16 v67, v46, v226, v67
  v_dot2_f32_bf16 v59, v37, v217, v59
  v_dot2_f32_bf16 v67, v47, v227, v67
  v_dot2_f32_bf16 v59, v38, v218, v59
  v_dot2_f32_bf16 v67, v48, v228, v67
  v_dot2_f32_bf16 v59, v39, v219, v59
  v_dot2_f32_bf16 v67, v49, v229, v67
  v_dot2_f32_bf16 v59, v40, v220, v59
  v_dot2_f32_bf16 v67, v50, v230, v67
  v_dot2_f32_bf16 v59, v41, v221, v59
  v_dot2_f32_bf16 v67, v51, v231, v67
  v_add_u32 v232, v18, v30
  buffer_load_dwordx4 v[212:215], v232, s[8:11], s66 offen sc1
  v_add_u32 v233, v19, v30
  buffer_load_dwordx4 v[216:219], v233, s[8:11], s66 offen sc1
  v_add_u32 v234, v20, v30
  buffer_load_dwordx4 v[220:223], v234, s[8:11], s66 offen sc1
  v_add_u32 v235, v21, v30
  buffer_load_dwordx4 v[224:227], v235, s[8:11], s66 offen sc1
  v_add_u32 v236, v22, v30
  buffer_load_dwordx4 v[228:231], v236, s[8:11], s66 offen sc1
  s_mov_b32 s46, 1051011932
  v_mov_b32 v232, 3481618353
  v_cndmask_b32 v53, v53, v232, s[74:75]
  v_cndmask_b32 v54, v54, v232, s[76:77]
  v_cndmask_b32 v55, v55, v232, s[78:79]
  v_cndmask_b32 v56, v56, v232, s[80:81]
  v_cndmask_b32 v57, v57, v232, s[82:83]
  v_cndmask_b32 v58, v58, v232, s[84:85]
  v_cndmask_b32 v59, v59, v232, s[86:87]
  v_max_f32 v233, v52, v53
  v_max3_f32 v233, v233, v54, v55
  v_max3_f32 v233, v233, v56, v57
  v_max3_f32 v233, v233, v58, v59
  v_mul_f32 v233, s46, v233
  v_fma_f32 v52, v52, s46, -v233
  v_fma_f32 v53, v53, s46, -v233
  v_fma_f32 v54, v54, s46, -v233
  v_fma_f32 v55, v55, s46, -v233
  v_fma_f32 v56, v56, s46, -v233
  v_fma_f32 v57, v57, s46, -v233
  v_fma_f32 v58, v58, s46, -v233
  v_fma_f32 v59, v59, s46, -v233
  v_exp_f32 v52, v52
  v_exp_f32 v53, v53
  v_exp_f32 v54, v54
  v_exp_f32 v55, v55
  v_exp_f32 v56, v56
  v_exp_f32 v57, v57
  v_exp_f32 v58, v58
  v_exp_f32 v59, v59
  v_add_f32 v233, v52, v53
  v_add_f32 v233, v233, v54
  v_add_f32 v233, v233, v55
  v_add_f32 v233, v233, v56
  v_add_f32 v233, v233, v57
  v_add_f32 v233, v233, v58
  v_add_f32 v233, v233, v59
  v_rcp_f32 v233, v233
  s_nop 0
  v_mul_f32 v52, v52, v233
  v_mul_f32 v53, v53, v233
  v_mul_f32 v54, v54, v233
  v_mul_f32 v55, v55, v233
  v_mul_f32 v56, v56, v233
  v_mul_f32 v57, v57, v233
  v_mul_f32 v58, v58, v233
  v_mul_f32 v59, v59, v233
  v_cndmask_b32 v61, v61, v232, s[74:75]
  v_cndmask_b32 v62, v62, v232, s[76:77]
  v_cndmask_b32 v63, v63, v232, s[78:79]
  v_cndmask_b32 v64, v64, v232, s[80:81]
  v_cndmask_b32 v65, v65, v232, s[82:83]
  v_cndmask_b32 v66, v66, v232, s[84:85]
  v_cndmask_b32 v67, v67, v232, s[86:87]
  v_max_f32 v233, v60, v61
  v_max3_f32 v233, v233, v62, v63
  v_max3_f32 v233, v233, v64, v65
  v_max3_f32 v233, v233, v66, v67
  v_mul_f32 v233, s46, v233
  v_fma_f32 v60, v60, s46, -v233
  v_fma_f32 v61, v61, s46, -v233
  v_fma_f32 v62, v62, s46, -v233
  v_fma_f32 v63, v63, s46, -v233
  v_fma_f32 v64, v64, s46, -v233
  v_fma_f32 v65, v65, s46, -v233
  v_fma_f32 v66, v66, s46, -v233
  v_fma_f32 v67, v67, s46, -v233
  v_exp_f32 v60, v60
  v_exp_f32 v61, v61
  v_exp_f32 v62, v62
  v_exp_f32 v63, v63
  v_exp_f32 v64, v64
  v_exp_f32 v65, v65
  v_exp_f32 v66, v66
  v_exp_f32 v67, v67
  v_add_f32 v233, v60, v61
  v_add_f32 v233, v233, v62
  v_add_f32 v233, v233, v63
  v_add_f32 v233, v233, v64
  v_add_f32 v233, v233, v65
  v_add_f32 v233, v233, v66
  v_add_f32 v233, v233, v67
  v_rcp_f32 v233, v233
  s_nop 0
  v_mul_f32 v60, v60, v233
  v_mul_f32 v61, v61, v233
  v_mul_f32 v62, v62, v233
  v_mul_f32 v63, v63, v233
  v_mul_f32 v64, v64, v233
  v_mul_f32 v65, v65, v233
  v_mul_f32 v66, v66, v233
  v_mul_f32 v67, v67, v233
  v_cvt_pk_bf16_f32 v52, v52, 0
  v_lshlrev_b32 v236, 16, v52
  v_cvt_pk_bf16_f32 v53, v53, 0
  v_lshlrev_b32 v237, 16, v53
  v_cvt_pk_bf16_f32 v54, v54, 0
  v_lshlrev_b32 v238, 16, v54
  v_cvt_pk_bf16_f32 v55, v55, 0
  v_lshlrev_b32 v239, 16, v55
  v_cvt_pk_bf16_f32 v56, v56, 0
  v_lshlrev_b32 v240, 16, v56
  v_cvt_pk_bf16_f32 v57, v57, 0
  v_lshlrev_b32 v241, 16, v57
  v_cvt_pk_bf16_f32 v58, v58, 0
  v_lshlrev_b32 v242, 16, v58
  v_cvt_pk_bf16_f32 v59, v59, 0
  v_lshlrev_b32 v243, 16, v59
  v_cvt_pk_bf16_f32 v60, v60, 0
  v_lshlrev_b32 v244, 16, v60
  v_cvt_pk_bf16_f32 v61, v61, 0
  v_lshlrev_b32 v245, 16, v61
  v_cvt_pk_bf16_f32 v62, v62, 0
  v_lshlrev_b32 v246, 16, v62
  v_cvt_pk_bf16_f32 v63, v63, 0
  v_lshlrev_b32 v247, 16, v63
  v_cvt_pk_bf16_f32 v64, v64, 0
  v_lshlrev_b32 v248, 16, v64
  v_cvt_pk_bf16_f32 v65, v65, 0
  v_lshlrev_b32 v249, 16, v65
  v_cvt_pk_bf16_f32 v66, v66, 0
  v_lshlrev_b32 v250, 16, v66
  v_cvt_pk_bf16_f32 v67, v67, 0
  v_lshlrev_b32 v251, 16, v67
  s_waitcnt vmcnt(35)
  v_dot2_f32_bf16 v8, v72, v52, 0
  v_dot2_f32_bf16 v9, v72, v236, 0
  v_dot2_f32_bf16 v10, v73, v52, 0
  v_dot2_f32_bf16 v11, v73, v236, 0
  v_dot2_f32_bf16 v12, v74, v52, 0
  v_dot2_f32_bf16 v13, v74, v236, 0
  v_dot2_f32_bf16 v14, v75, v52, 0
  v_dot2_f32_bf16 v15, v75, v236, 0
  v_dot2_f32_bf16 v16, v76, v52, 0
  v_dot2_f32_bf16 v17, v76, v236, 0
  v_dot2_f32_bf16 v18, v77, v52, 0
  v_dot2_f32_bf16 v19, v77, v236, 0
  v_dot2_f32_bf16 v20, v78, v52, 0
  v_dot2_f32_bf16 v21, v78, v236, 0
  v_dot2_f32_bf16 v22, v79, v52, 0
  v_dot2_f32_bf16 v23, v79, v236, 0
  v_dot2_f32_bf16 v24, v80, v52, 0
  v_dot2_f32_bf16 v25, v80, v236, 0
  v_dot2_f32_bf16 v26, v81, v52, 0
  v_dot2_f32_bf16 v27, v81, v236, 0
  v_dot2_f32_bf16 v28, v82, v60, 0
  v_dot2_f32_bf16 v29, v82, v244, 0
  v_dot2_f32_bf16 v30, v83, v60, 0
  v_dot2_f32_bf16 v31, v83, v244, 0
  v_dot2_f32_bf16 v32, v84, v60, 0
  v_dot2_f32_bf16 v33, v84, v244, 0
  v_dot2_f32_bf16 v34, v85, v60, 0
  v_dot2_f32_bf16 v35, v85, v244, 0
  v_dot2_f32_bf16 v36, v86, v60, 0
  v_dot2_f32_bf16 v37, v86, v244, 0
  v_dot2_f32_bf16 v38, v87, v60, 0
  v_dot2_f32_bf16 v39, v87, v244, 0
  v_dot2_f32_bf16 v40, v88, v60, 0
  v_dot2_f32_bf16 v41, v88, v244, 0
  v_dot2_f32_bf16 v42, v89, v60, 0
  v_dot2_f32_bf16 v43, v89, v244, 0
  v_dot2_f32_bf16 v44, v90, v60, 0
  v_dot2_f32_bf16 v45, v90, v244, 0
  v_dot2_f32_bf16 v46, v91, v60, 0
  v_dot2_f32_bf16 v47, v91, v244, 0
  s_waitcnt vmcnt(30)
  v_dot2_f32_bf16 v8, v92, v53, v8
  v_dot2_f32_bf16 v9, v92, v237, v9
  v_dot2_f32_bf16 v10, v93, v53, v10
  v_dot2_f32_bf16 v11, v93, v237, v11
  v_dot2_f32_bf16 v12, v94, v53, v12
  v_dot2_f32_bf16 v13, v94, v237, v13
  v_dot2_f32_bf16 v14, v95, v53, v14
  v_dot2_f32_bf16 v15, v95, v237, v15
  v_dot2_f32_bf16 v16, v96, v53, v16
  v_dot2_f32_bf16 v17, v96, v237, v17
  v_dot2_f32_bf16 v18, v97, v53, v18
  v_dot2_f32_bf16 v19, v97, v237, v19
  v_dot2_f32_bf16 v20, v98, v53, v20
  v_dot2_f32_bf16 v21, v98, v237, v21
  v_dot2_f32_bf16 v22, v99, v53, v22
  v_dot2_f32_bf16 v23, v99, v237, v23
  v_dot2_f32_bf16 v24, v100, v53, v24
  v_dot2_f32_bf16 v25, v100, v237, v25
  v_dot2_f32_bf16 v26, v101, v53, v26
  v_dot2_f32_bf16 v27, v101, v237, v27
  v_dot2_f32_bf16 v28, v102, v61, v28
  v_dot2_f32_bf16 v29, v102, v245, v29
  v_dot2_f32_bf16 v30, v103, v61, v30
  v_dot2_f32_bf16 v31, v103, v245, v31
  v_dot2_f32_bf16 v32, v104, v61, v32
  v_dot2_f32_bf16 v33, v104, v245, v33
  v_dot2_f32_bf16 v34, v105, v61, v34
  v_dot2_f32_bf16 v35, v105, v245, v35
  v_dot2_f32_bf16 v36, v106, v61, v36
  v_dot2_f32_bf16 v37, v106, v245, v37
  v_dot2_f32_bf16 v38, v107, v61, v38
  v_dot2_f32_bf16 v39, v107, v245, v39
  v_dot2_f32_bf16 v40, v108, v61, v40
  v_dot2_f32_bf16 v41, v108, v245, v41
  v_dot2_f32_bf16 v42, v109, v61, v42
  v_dot2_f32_bf16 v43, v109, v245, v43
  v_dot2_f32_bf16 v44, v110, v61, v44
  v_dot2_f32_bf16 v45, v110, v245, v45
  v_dot2_f32_bf16 v46, v111, v61, v46
  v_dot2_f32_bf16 v47, v111, v245, v47
  s_waitcnt vmcnt(25)
  v_dot2_f32_bf16 v8, v112, v54, v8
  v_dot2_f32_bf16 v9, v112, v238, v9
  v_dot2_f32_bf16 v10, v113, v54, v10
  v_dot2_f32_bf16 v11, v113, v238, v11
  v_dot2_f32_bf16 v12, v114, v54, v12
  v_dot2_f32_bf16 v13, v114, v238, v13
  v_dot2_f32_bf16 v14, v115, v54, v14
  v_dot2_f32_bf16 v15, v115, v238, v15
  v_dot2_f32_bf16 v16, v116, v54, v16
  v_dot2_f32_bf16 v17, v116, v238, v17
  v_dot2_f32_bf16 v18, v117, v54, v18
  v_dot2_f32_bf16 v19, v117, v238, v19
  v_dot2_f32_bf16 v20, v118, v54, v20
  v_dot2_f32_bf16 v21, v118, v238, v21
  v_dot2_f32_bf16 v22, v119, v54, v22
  v_dot2_f32_bf16 v23, v119, v238, v23
  v_dot2_f32_bf16 v24, v120, v54, v24
  v_dot2_f32_bf16 v25, v120, v238, v25
  v_dot2_f32_bf16 v26, v121, v54, v26
  v_dot2_f32_bf16 v27, v121, v238, v27
  v_dot2_f32_bf16 v28, v122, v62, v28
  v_dot2_f32_bf16 v29, v122, v246, v29
  v_dot2_f32_bf16 v30, v123, v62, v30
  v_dot2_f32_bf16 v31, v123, v246, v31
  v_dot2_f32_bf16 v32, v124, v62, v32
  v_dot2_f32_bf16 v33, v124, v246, v33
  v_dot2_f32_bf16 v34, v125, v62, v34
  v_dot2_f32_bf16 v35, v125, v246, v35
  v_dot2_f32_bf16 v36, v126, v62, v36
  v_dot2_f32_bf16 v37, v126, v246, v37
  v_dot2_f32_bf16 v38, v127, v62, v38
  v_dot2_f32_bf16 v39, v127, v246, v39
  v_dot2_f32_bf16 v40, v128, v62, v40
  v_dot2_f32_bf16 v41, v128, v246, v41
  v_dot2_f32_bf16 v42, v129, v62, v42
  v_dot2_f32_bf16 v43, v129, v246, v43
  v_dot2_f32_bf16 v44, v130, v62, v44
  v_dot2_f32_bf16 v45, v130, v246, v45
  v_dot2_f32_bf16 v46, v131, v62, v46
  v_dot2_f32_bf16 v47, v131, v246, v47
  s_waitcnt vmcnt(20)
  v_dot2_f32_bf16 v8, v132, v55, v8
  v_dot2_f32_bf16 v9, v132, v239, v9
  v_dot2_f32_bf16 v10, v133, v55, v10
  v_dot2_f32_bf16 v11, v133, v239, v11
  v_dot2_f32_bf16 v12, v134, v55, v12
  v_dot2_f32_bf16 v13, v134, v239, v13
  v_dot2_f32_bf16 v14, v135, v55, v14
  v_dot2_f32_bf16 v15, v135, v239, v15
  v_dot2_f32_bf16 v16, v136, v55, v16
  v_dot2_f32_bf16 v17, v136, v239, v17
  v_dot2_f32_bf16 v18, v137, v55, v18
  v_dot2_f32_bf16 v19, v137, v239, v19
  v_dot2_f32_bf16 v20, v138, v55, v20
  v_dot2_f32_bf16 v21, v138, v239, v21
  v_dot2_f32_bf16 v22, v139, v55, v22
  v_dot2_f32_bf16 v23, v139, v239, v23
  v_dot2_f32_bf16 v24, v140, v55, v24
  v_dot2_f32_bf16 v25, v140, v239, v25
  v_dot2_f32_bf16 v26, v141, v55, v26
  v_dot2_f32_bf16 v27, v141, v239, v27
  v_dot2_f32_bf16 v28, v142, v63, v28
  v_dot2_f32_bf16 v29, v142, v247, v29
  v_dot2_f32_bf16 v30, v143, v63, v30
  v_dot2_f32_bf16 v31, v143, v247, v31
  v_dot2_f32_bf16 v32, v144, v63, v32
  v_dot2_f32_bf16 v33, v144, v247, v33
  v_dot2_f32_bf16 v34, v145, v63, v34
  v_dot2_f32_bf16 v35, v145, v247, v35
  v_dot2_f32_bf16 v36, v146, v63, v36
  v_dot2_f32_bf16 v37, v146, v247, v37
  v_dot2_f32_bf16 v38, v147, v63, v38
  v_dot2_f32_bf16 v39, v147, v247, v39
  v_dot2_f32_bf16 v40, v148, v63, v40
  v_dot2_f32_bf16 v41, v148, v247, v41
  v_dot2_f32_bf16 v42, v149, v63, v42
  v_dot2_f32_bf16 v43, v149, v247, v43
  v_dot2_f32_bf16 v44, v150, v63, v44
  v_dot2_f32_bf16 v45, v150, v247, v45
  v_dot2_f32_bf16 v46, v151, v63, v46
  v_dot2_f32_bf16 v47, v151, v247, v47
  s_waitcnt vmcnt(15)
  v_dot2_f32_bf16 v8, v152, v56, v8
  v_dot2_f32_bf16 v9, v152, v240, v9
  v_dot2_f32_bf16 v10, v153, v56, v10
  v_dot2_f32_bf16 v11, v153, v240, v11
  v_dot2_f32_bf16 v12, v154, v56, v12
  v_dot2_f32_bf16 v13, v154, v240, v13
  v_dot2_f32_bf16 v14, v155, v56, v14
  v_dot2_f32_bf16 v15, v155, v240, v15
  v_dot2_f32_bf16 v16, v156, v56, v16
  v_dot2_f32_bf16 v17, v156, v240, v17
  v_dot2_f32_bf16 v18, v157, v56, v18
  v_dot2_f32_bf16 v19, v157, v240, v19
  v_dot2_f32_bf16 v20, v158, v56, v20
  v_dot2_f32_bf16 v21, v158, v240, v21
  v_dot2_f32_bf16 v22, v159, v56, v22
  v_dot2_f32_bf16 v23, v159, v240, v23
  v_dot2_f32_bf16 v24, v160, v56, v24
  v_dot2_f32_bf16 v25, v160, v240, v25
  v_dot2_f32_bf16 v26, v161, v56, v26
  v_dot2_f32_bf16 v27, v161, v240, v27
  v_dot2_f32_bf16 v28, v162, v64, v28
  v_dot2_f32_bf16 v29, v162, v248, v29
  v_dot2_f32_bf16 v30, v163, v64, v30
  v_dot2_f32_bf16 v31, v163, v248, v31
  v_dot2_f32_bf16 v32, v164, v64, v32
  v_dot2_f32_bf16 v33, v164, v248, v33
  v_dot2_f32_bf16 v34, v165, v64, v34
  v_dot2_f32_bf16 v35, v165, v248, v35
  v_dot2_f32_bf16 v36, v166, v64, v36
  v_dot2_f32_bf16 v37, v166, v248, v37
  v_dot2_f32_bf16 v38, v167, v64, v38
  v_dot2_f32_bf16 v39, v167, v248, v39
  v_dot2_f32_bf16 v40, v168, v64, v40
  v_dot2_f32_bf16 v41, v168, v248, v41
  v_dot2_f32_bf16 v42, v169, v64, v42
  v_dot2_f32_bf16 v43, v169, v248, v43
  v_dot2_f32_bf16 v44, v170, v64, v44
  v_dot2_f32_bf16 v45, v170, v248, v45
  v_dot2_f32_bf16 v46, v171, v64, v46
  v_dot2_f32_bf16 v47, v171, v248, v47
  s_waitcnt vmcnt(10)
  v_dot2_f32_bf16 v8, v172, v57, v8
  v_dot2_f32_bf16 v9, v172, v241, v9
  v_dot2_f32_bf16 v10, v173, v57, v10
  v_dot2_f32_bf16 v11, v173, v241, v11
  v_dot2_f32_bf16 v12, v174, v57, v12
  v_dot2_f32_bf16 v13, v174, v241, v13
  v_dot2_f32_bf16 v14, v175, v57, v14
  v_dot2_f32_bf16 v15, v175, v241, v15
  v_dot2_f32_bf16 v16, v176, v57, v16
  v_dot2_f32_bf16 v17, v176, v241, v17
  v_dot2_f32_bf16 v18, v177, v57, v18
  v_dot2_f32_bf16 v19, v177, v241, v19
  v_dot2_f32_bf16 v20, v178, v57, v20
  v_dot2_f32_bf16 v21, v178, v241, v21
  v_dot2_f32_bf16 v22, v179, v57, v22
  v_dot2_f32_bf16 v23, v179, v241, v23
  v_dot2_f32_bf16 v24, v180, v57, v24
  v_dot2_f32_bf16 v25, v180, v241, v25
  v_dot2_f32_bf16 v26, v181, v57, v26
  v_dot2_f32_bf16 v27, v181, v241, v27
  v_dot2_f32_bf16 v28, v182, v65, v28
  v_dot2_f32_bf16 v29, v182, v249, v29
  v_dot2_f32_bf16 v30, v183, v65, v30
  v_dot2_f32_bf16 v31, v183, v249, v31
  v_dot2_f32_bf16 v32, v184, v65, v32
  v_dot2_f32_bf16 v33, v184, v249, v33
  v_dot2_f32_bf16 v34, v185, v65, v34
  v_dot2_f32_bf16 v35, v185, v249, v35
  v_dot2_f32_bf16 v36, v186, v65, v36
  v_dot2_f32_bf16 v37, v186, v249, v37
  v_dot2_f32_bf16 v38, v187, v65, v38
  v_dot2_f32_bf16 v39, v187, v249, v39
  v_dot2_f32_bf16 v40, v188, v65, v40
  v_dot2_f32_bf16 v41, v188, v249, v41
  v_dot2_f32_bf16 v42, v189, v65, v42
  v_dot2_f32_bf16 v43, v189, v249, v43
  v_dot2_f32_bf16 v44, v190, v65, v44
  v_dot2_f32_bf16 v45, v190, v249, v45
  v_dot2_f32_bf16 v46, v191, v65, v46
  v_dot2_f32_bf16 v47, v191, v249, v47
  s_waitcnt vmcnt(5)
  v_dot2_f32_bf16 v8, v192, v58, v8
  v_dot2_f32_bf16 v9, v192, v242, v9
  v_dot2_f32_bf16 v10, v193, v58, v10
  v_dot2_f32_bf16 v11, v193, v242, v11
  v_dot2_f32_bf16 v12, v194, v58, v12
  v_dot2_f32_bf16 v13, v194, v242, v13
  v_dot2_f32_bf16 v14, v195, v58, v14
  v_dot2_f32_bf16 v15, v195, v242, v15
  v_dot2_f32_bf16 v16, v196, v58, v16
  v_dot2_f32_bf16 v17, v196, v242, v17
  v_dot2_f32_bf16 v18, v197, v58, v18
  v_dot2_f32_bf16 v19, v197, v242, v19
  v_dot2_f32_bf16 v20, v198, v58, v20
  v_dot2_f32_bf16 v21, v198, v242, v21
  v_dot2_f32_bf16 v22, v199, v58, v22
  v_dot2_f32_bf16 v23, v199, v242, v23
  v_dot2_f32_bf16 v24, v200, v58, v24
  v_dot2_f32_bf16 v25, v200, v242, v25
  v_dot2_f32_bf16 v26, v201, v58, v26
  v_dot2_f32_bf16 v27, v201, v242, v27
  v_dot2_f32_bf16 v28, v202, v66, v28
  v_dot2_f32_bf16 v29, v202, v250, v29
  v_dot2_f32_bf16 v30, v203, v66, v30
  v_dot2_f32_bf16 v31, v203, v250, v31
  v_dot2_f32_bf16 v32, v204, v66, v32
  v_dot2_f32_bf16 v33, v204, v250, v33
  v_dot2_f32_bf16 v34, v205, v66, v34
  v_dot2_f32_bf16 v35, v205, v250, v35
  v_dot2_f32_bf16 v36, v206, v66, v36
  v_dot2_f32_bf16 v37, v206, v250, v37
  v_dot2_f32_bf16 v38, v207, v66, v38
  v_dot2_f32_bf16 v39, v207, v250, v39
  v_dot2_f32_bf16 v40, v208, v66, v40
  v_dot2_f32_bf16 v41, v208, v250, v41
  v_dot2_f32_bf16 v42, v209, v66, v42
  v_dot2_f32_bf16 v43, v209, v250, v43
  v_dot2_f32_bf16 v44, v210, v66, v44
  v_dot2_f32_bf16 v45, v210, v250, v45
  v_dot2_f32_bf16 v46, v211, v66, v46
  v_dot2_f32_bf16 v47, v211, v250, v47
  s_waitcnt vmcnt(0)
  v_dot2_f32_bf16 v8, v212, v59, v8
  v_dot2_f32_bf16 v9, v212, v243, v9
  v_dot2_f32_bf16 v10, v213, v59, v10
  v_dot2_f32_bf16 v11, v213, v243, v11
  v_dot2_f32_bf16 v12, v214, v59, v12
  v_dot2_f32_bf16 v13, v214, v243, v13
  v_dot2_f32_bf16 v14, v215, v59, v14
  v_dot2_f32_bf16 v15, v215, v243, v15
  v_dot2_f32_bf16 v16, v216, v59, v16
  v_dot2_f32_bf16 v17, v216, v243, v17
  v_dot2_f32_bf16 v18, v217, v59, v18
  v_dot2_f32_bf16 v19, v217, v243, v19
  v_dot2_f32_bf16 v20, v218, v59, v20
  v_dot2_f32_bf16 v21, v218, v243, v21
  v_dot2_f32_bf16 v22, v219, v59, v22
  v_dot2_f32_bf16 v23, v219, v243, v23
  v_dot2_f32_bf16 v24, v220, v59, v24
  v_dot2_f32_bf16 v25, v220, v243, v25
  v_dot2_f32_bf16 v26, v221, v59, v26
  v_dot2_f32_bf16 v27, v221, v243, v27
  v_dot2_f32_bf16 v28, v222, v67, v28
  v_dot2_f32_bf16 v29, v222, v251, v29
  v_dot2_f32_bf16 v30, v223, v67, v30
  v_dot2_f32_bf16 v31, v223, v251, v31
  v_dot2_f32_bf16 v32, v224, v67, v32
  v_dot2_f32_bf16 v33, v224, v251, v33
  v_dot2_f32_bf16 v34, v225, v67, v34
  v_dot2_f32_bf16 v35, v225, v251, v35
  v_dot2_f32_bf16 v36, v226, v67, v36
  v_dot2_f32_bf16 v37, v226, v251, v37
  v_dot2_f32_bf16 v38, v227, v67, v38
  v_dot2_f32_bf16 v39, v227, v251, v39
  v_dot2_f32_bf16 v40, v228, v67, v40
  v_dot2_f32_bf16 v41, v228, v251, v41
  v_dot2_f32_bf16 v42, v229, v67, v42
  v_dot2_f32_bf16 v43, v229, v251, v43
  v_dot2_f32_bf16 v44, v230, v67, v44
  v_dot2_f32_bf16 v45, v230, v251, v45
  v_dot2_f32_bf16 v46, v231, v67, v46
  v_dot2_f32_bf16 v47, v231, v251, v47
  v_cvt_pk_bf16_f32 v72, v8, v9
  v_cvt_pk_bf16_f32 v73, v10, v11
  v_cvt_pk_bf16_f32 v74, v12, v13
  v_cvt_pk_bf16_f32 v75, v14, v15
  v_cvt_pk_bf16_f32 v76, v16, v17
  v_cvt_pk_bf16_f32 v77, v18, v19
  v_cvt_pk_bf16_f32 v78, v20, v21
  v_cvt_pk_bf16_f32 v79, v22, v23
  v_cvt_pk_bf16_f32 v80, v24, v25
  v_cvt_pk_bf16_f32 v81, v26, v27
  v_cvt_pk_bf16_f32 v82, v28, v29
  v_cvt_pk_bf16_f32 v83, v30, v31
  v_cvt_pk_bf16_f32 v84, v32, v33
  v_cvt_pk_bf16_f32 v85, v34, v35
  v_cvt_pk_bf16_f32 v86, v36, v37
  v_cvt_pk_bf16_f32 v87, v38, v39
  v_cvt_pk_bf16_f32 v88, v40, v41
  v_cvt_pk_bf16_f32 v89, v42, v43
  v_cvt_pk_bf16_f32 v90, v44, v45
  v_cvt_pk_bf16_f32 v91, v46, v47
  v_lshlrev_b32 v3, 8, v3
  v_lshl_add_u32 v3, v5, 4, v3
  v_add_u32 v3, 122880, v3
  ds_write_b128 v3, v[72:75] offset:0
  ds_write_b128 v3, v[76:79] offset:256
  ds_write_b128 v3, v[80:83] offset:512
  ds_write_b128 v3, v[84:87] offset:768
  ds_write_b128 v3, v[88:91] offset:1024
  s_waitcnt lgkmcnt(0)
  s_barrier
  v_lshlrev_b32 v13, 4, v0
  v_add_u32 v13, 122880, v13
  ds_read_b128 v[20:23], v13 offset:0
  ds_read_b128 v[24:27], v13 offset:1024
  ds_read_b128 v[28:31], v13 offset:2048
  ds_read_b128 v[32:35], v13 offset:3072
  ds_read_b128 v[36:39], v13 offset:4096
  ds_read_b128 v[40:43], v13 offset:5120
  ds_read_b128 v[44:47], v13 offset:6144
  ds_read_b128 v[48:51], v13 offset:7168
  ds_read_b128 v[52:55], v13 offset:8192
  ds_read_b128 v[56:59], v13 offset:9216
  ds_read_b128 v[60:63], v13 offset:10240
  ds_read_b128 v[64:67], v13 offset:11264
  s_waitcnt lgkmcnt(4)
  ds_read_b128 v[68:71], v13 offset:12288
  ds_read_b128 v[72:75], v13 offset:13312
  ds_read_b128 v[76:79], v13 offset:14336
  ds_read_b128 v[80:83], v13 offset:15360
  ds_read_b128 v[84:87], v13 offset:16384
  ds_read_b128 v[88:91], v13 offset:17408
  ds_read_b128 v[92:95], v13 offset:18432
  ds_read_b128 v[96:99], v13 offset:19456
  s_mov_b32 s4, s20
  s_mov_b32 s5, s21
  s_mov_b32 s6, 819200
  s_mov_b32 s7, 0x20000
  s_mov_b32 s12, s36
  s_mov_b32 s13, s37
  s_mov_b32 s14, 5242880
  s_mov_b32 s15, 0x20000
  v_mul_u32_u24 v12, 2560, v6
  v_lshrrev_b32 v14, 4, v0
  v_lshl_add_u32 v12, v14, 3, v12
  s_lshl_b32 s46, s42, 5
  v_add_u32 v12, s46, v12
  s_mov_b32 s66, 0
  s_waitcnt lgkmcnt(0)
  v_lshrrev_b32 v13, 3, v0
  v_lshrrev_b32 v14, 2, v13
  v_lshlrev_b32 v14, 3, v14
  v_and_b32 v8, 3, v13
  v_add_u32 v8, v8, v14
  s_and_b32 s46, s42, 1
  s_lshl_b32 s46, s46, 2
  s_lshr_b32 s47, s42, 1
  s_lshl_b32 s47, s47, 4
  s_add_u32 s46, s46, s47
  v_add_u32 v8, s46, v8
  v_mul_u32_u24 v8, 1280, v8
  v_lshrrev_b32 v13, 1, v13
  v_bfe_u32 v14, v0, 1, 2
  v_xor_b32 v13, v13, v14
  v_lshlrev_b32 v13, 5, v13
  v_and_b32 v14, 1, v0
  v_lshlrev_b32 v14, 4, v14
  v_add3_u32 v8, v8, v13, v14
  v_lshrrev_b32 v13, 5, v0
  v_lshlrev_b32 v9, 11, v13
  v_bfe_u32 v13, v0, 2, 3
  v_lshl_add_u32 v9, v13, 7, v9
  v_lshrrev_b32 v13, 1, v13
  v_xor_b32 v13, s42, v13
  v_lshl_add_u32 v9, v13, 5, v9
  v_and_b32 v13, 3, v0
  v_lshl_add_u32 v9, v13, 3, v9
  v_add_u32 v10, 0x10000, v9
  v_add_u32 v11, 0x20000, v9
  s_add_u32 m0, s51, 0
  s_add_u32 s46, s66, 0
  buffer_load_dwordx4 v8, s[4:7], s46 offen lds
  s_add_u32 m0, s51, 4096
  s_add_u32 s46, s66, 128
  buffer_load_dwordx4 v8, s[4:7], s46 offen lds
  s_add_u32 m0, s51, 8192
  s_add_u32 s46, s66, 256
  buffer_load_dwordx4 v8, s[4:7], s46 offen lds
  s_add_u32 m0, s51, 12288
  s_add_u32 s46, s66, 384
  buffer_load_dwordx4 v8, s[4:7], s46 offen lds
  s_add_u32 m0, s51, 16384
  s_add_u32 s46, s66, 512
  buffer_load_dwordx4 v8, s[4:7], s46 offen lds
  s_add_u32 m0, s51, 20480
  s_add_u32 s46, s66, 640
  buffer_load_dwordx4 v8, s[4:7], s46 offen lds
  s_add_u32 m0, s51, 24576
  s_add_u32 s46, s66, 768
  buffer_load_dwordx4 v8, s[4:7], s46 offen lds
  s_add_u32 m0, s51, 28672
  s_add_u32 s46, s66, 896
  buffer_load_dwordx4 v8, s[4:7], s46 offen lds
  s_add_u32 m0, s51, 32768
  s_add_u32 s46, s66, 1024
  buffer_load_dwordx4 v8, s[4:7], s46 offen lds
  s_add_u32 m0, s51, 36864
  s_add_u32 s46, s66, 1152
  buffer_load_dwordx4 v8, s[4:7], s46 offen lds
  s_add_u32 m0, s51, 40960
  s_add_u32 s46, s66, 40960
  buffer_load_dwordx4 v8, s[4:7], s46 offen lds
  s_add_u32 m0, s51, 45056
  s_add_u32 s46, s66, 41088
  buffer_load_dwordx4 v8, s[4:7], s46 offen lds
  s_add_u32 m0, s51, 49152
  s_add_u32 s46, s66, 41216
  buffer_load_dwordx4 v8, s[4:7], s46 offen lds
  s_add_u32 m0, s51, 53248
  s_add_u32 s46, s66, 41344
  buffer_load_dwordx4 v8, s[4:7], s46 offen lds
  s_add_u32 m0, s51, 57344
  s_add_u32 s46, s66, 41472
  buffer_load_dwordx4 v8, s[4:7], s46 offen lds
  s_add_u32 m0, s51, 61440
  s_add_u32 s46, s66, 41600
  buffer_load_dwordx4 v8, s[4:7], s46 offen lds
  s_add_u32 m0, s51, 65536
  s_add_u32 s46, s66, 41728
  buffer_load_dwordx4 v8, s[4:7], s46 offen lds
  s_add_u32 m0, s51, 69632
  s_add_u32 s46, s66, 41856
  buffer_load_dwordx4 v8, s[4:7], s46 offen lds
  s_add_u32 m0, s51, 73728
  s_add_u32 s46, s66, 41984
  buffer_load_dwordx4 v8, s[4:7], s46 offen lds
  s_add_u32 m0, s51, 77824
  s_add_u32 s46, s66, 42112
  buffer_load_dwordx4 v8, s[4:7], s46 offen lds
  s_add_u32 m0, s51, 81920
  s_add_u32 s46, s66, 81920
  buffer_load_dwordx4 v8, s[4:7], s46 offen lds
  s_add_u32 m0, s51, 86016
  s_add_u32 s46, s66, 82048
  buffer_load_dwordx4 v8, s[4:7], s46 offen lds
  s_add_u32 m0, s51, 90112
  s_add_u32 s46, s66, 82176
  buffer_load_dwordx4 v8, s[4:7], s46 offen lds
  s_add_u32 m0, s51, 94208
  s_add_u32 s46, s66, 82304
  buffer_load_dwordx4 v8, s[4:7], s46 offen lds
  s_add_u32 m0, s51, 98304
  s_add_u32 s46, s66, 82432
  buffer_load_dwordx4 v8, s[4:7], s46 offen lds
  s_waitcnt vmcnt(20)
  s_barrier
  s_add_u32 m0, s51, 102400
  s_add_u32 s46, s66, 82560
  buffer_load_dwordx4 v8, s[4:7], s46 offen lds
  s_add_u32 m0, s51, 106496
  s_add_u32 s46, s66, 82688
  buffer_load_dwordx4 v8, s[4:7], s46 offen lds
  s_add_u32 m0, s51, 110592
  s_add_u32 s46, s66, 82816
  buffer_load_dwordx4 v8, s[4:7], s46 offen lds
  s_add_u32 m0, s51, 114688
  s_add_u32 s46, s66, 82944
  buffer_load_dwordx4 v8, s[4:7], s46 offen lds
  s_add_u32 m0, s51, 118784
  s_add_u32 s46, s66, 83072
  buffer_load_dwordx4 v8, s[4:7], s46 offen lds
  ds_read_b64_tr_b16 v[100:101], v9 offset:0
  ds_read_b64_tr_b16 v[102:103], v9 offset:1024
  ds_read_b64_tr_b16 v[104:105], v9 offset:4096
  ds_read_b64_tr_b16 v[106:107], v9 offset:5120
  ds_read_b64_tr_b16 v[108:109], v9 offset:8192
  ds_read_b64_tr_b16 v[110:111], v9 offset:9216
  ds_read_b64_tr_b16 v[112:113], v9 offset:12288
  ds_read_b64_tr_b16 v[114:115], v9 offset:13312
  ds_read_b64_tr_b16 v[116:117], v9 offset:16384
  ds_read_b64_tr_b16 v[118:119], v9 offset:17408
  s_waitcnt lgkmcnt(0)
  v_mfma_f32_16x16x32_bf16 v[140:143], v[100:103], v[20:23], 0
  v_mfma_f32_16x16x32_bf16 v[144:147], v[104:107], v[20:23], 0
  v_mfma_f32_16x16x32_bf16 v[148:151], v[108:111], v[20:23], 0
  v_mfma_f32_16x16x32_bf16 v[152:155], v[112:115], v[20:23], 0
  v_mfma_f32_16x16x32_bf16 v[156:159], v[116:119], v[20:23], 0
  s_waitcnt vmcnt(20)
  s_barrier
  s_add_u32 m0, s51, 0
  s_add_u32 s46, s66, 122880
  buffer_load_dwordx4 v8, s[4:7], s46 offen lds
  s_add_u32 m0, s51, 4096
  s_add_u32 s46, s66, 123008
  buffer_load_dwordx4 v8, s[4:7], s46 offen lds
  s_add_u32 m0, s51, 8192
  s_add_u32 s46, s66, 123136
  buffer_load_dwordx4 v8, s[4:7], s46 offen lds
  s_add_u32 m0, s51, 12288
  s_add_u32 s46, s66, 123264
  buffer_load_dwordx4 v8, s[4:7], s46 offen lds
  s_add_u32 m0, s51, 16384
  s_add_u32 s46, s66, 123392
  buffer_load_dwordx4 v8, s[4:7], s46 offen lds
  ds_read_b64_tr_b16 v[120:121], v9 offset:20480
  ds_read_b64_tr_b16 v[122:123], v9 offset:21504
  ds_read_b64_tr_b16 v[124:125], v9 offset:24576
  ds_read_b64_tr_b16 v[126:127], v9 offset:25600
  ds_read_b64_tr_b16 v[128:129], v9 offset:28672
  ds_read_b64_tr_b16 v[130:131], v9 offset:29696
  ds_read_b64_tr_b16 v[132:133], v9 offset:32768
  ds_read_b64_tr_b16 v[134:135], v9 offset:33792
  ds_read_b64_tr_b16 v[136:137], v9 offset:36864
  ds_read_b64_tr_b16 v[138:139], v9 offset:37888
  s_waitcnt lgkmcnt(0)
  v_mfma_f32_16x16x32_bf16 v[160:163], v[120:123], v[20:23], 0
  v_mfma_f32_16x16x32_bf16 v[164:167], v[124:127], v[20:23], 0
  v_mfma_f32_16x16x32_bf16 v[168:171], v[128:131], v[20:23], 0
  v_mfma_f32_16x16x32_bf16 v[172:175], v[132:135], v[20:23], 0
  v_mfma_f32_16x16x32_bf16 v[176:179], v[136:139], v[20:23], 0
  s_waitcnt vmcnt(20)
  s_barrier
  s_add_u32 m0, s51, 20480
  s_add_u32 s46, s66, 123520
  buffer_load_dwordx4 v8, s[4:7], s46 offen lds
  s_add_u32 m0, s51, 24576
  s_add_u32 s46, s66, 123648
  buffer_load_dwordx4 v8, s[4:7], s46 offen lds
  s_add_u32 m0, s51, 28672
  s_add_u32 s46, s66, 123776
  buffer_load_dwordx4 v8, s[4:7], s46 offen lds
  s_add_u32 m0, s51, 32768
  s_add_u32 s46, s66, 123904
  buffer_load_dwordx4 v8, s[4:7], s46 offen lds
  s_add_u32 m0, s51, 36864
  s_add_u32 s46, s66, 124032
  buffer_load_dwordx4 v8, s[4:7], s46 offen lds
  ds_read_b64_tr_b16 v[100:101], v9 offset:40960
  ds_read_b64_tr_b16 v[102:103], v9 offset:41984
  ds_read_b64_tr_b16 v[104:105], v9 offset:45056
  ds_read_b64_tr_b16 v[106:107], v9 offset:46080
  ds_read_b64_tr_b16 v[108:109], v9 offset:49152
  ds_read_b64_tr_b16 v[110:111], v9 offset:50176
  ds_read_b64_tr_b16 v[112:113], v9 offset:53248
  ds_read_b64_tr_b16 v[114:115], v9 offset:54272
  ds_read_b64_tr_b16 v[116:117], v9 offset:57344
  ds_read_b64_tr_b16 v[118:119], v9 offset:58368
  s_waitcnt lgkmcnt(0)
  v_mfma_f32_16x16x32_bf16 v[140:143], v[100:103], v[24:27], v[140:143]
  v_mfma_f32_16x16x32_bf16 v[144:147], v[104:107], v[24:27], v[144:147]
  v_mfma_f32_16x16x32_bf16 v[148:151], v[108:111], v[24:27], v[148:151]
  v_mfma_f32_16x16x32_bf16 v[152:155], v[112:115], v[24:27], v[152:155]
  v_mfma_f32_16x16x32_bf16 v[156:159], v[116:119], v[24:27], v[156:159]
  s_waitcnt vmcnt(20)
  s_barrier
  s_add_u32 m0, s51, 40960
  s_add_u32 s46, s66, 163840
  buffer_load_dwordx4 v8, s[4:7], s46 offen lds
  s_add_u32 m0, s51, 45056
  s_add_u32 s46, s66, 163968
  buffer_load_dwordx4 v8, s[4:7], s46 offen lds
  s_add_u32 m0, s51, 49152
  s_add_u32 s46, s66, 164096
  buffer_load_dwordx4 v8, s[4:7], s46 offen lds
  s_add_u32 m0, s51, 53248
  s_add_u32 s46, s66, 164224
  buffer_load_dwordx4 v8, s[4:7], s46 offen lds
  s_add_u32 m0, s51, 57344
  s_add_u32 s46, s66, 164352
  buffer_load_dwordx4 v8, s[4:7], s46 offen lds
  ds_read_b64_tr_b16 v[120:121], v9 offset:61440
  ds_read_b64_tr_b16 v[122:123], v9 offset:62464
  ds_read_b64_tr_b16 v[124:125], v10 offset:0
  ds_read_b64_tr_b16 v[126:127], v10 offset:1024
  ds_read_b64_tr_b16 v[128:129], v10 offset:4096
  ds_read_b64_tr_b16 v[130:131], v10 offset:5120
  ds_read_b64_tr_b16 v[132:133], v10 offset:8192
  ds_read_b64_tr_b16 v[134:135], v10 offset:9216
  ds_read_b64_tr_b16 v[136:137], v10 offset:12288
  ds_read_b64_tr_b16 v[138:139], v10 offset:13312
  s_waitcnt lgkmcnt(0)
  v_mfma_f32_16x16x32_bf16 v[160:163], v[120:123], v[24:27], v[160:163]
  v_mfma_f32_16x16x32_bf16 v[164:167], v[124:127], v[24:27], v[164:167]
  v_mfma_f32_16x16x32_bf16 v[168:171], v[128:131], v[24:27], v[168:171]
  v_mfma_f32_16x16x32_bf16 v[172:175], v[132:135], v[24:27], v[172:175]
  v_mfma_f32_16x16x32_bf16 v[176:179], v[136:139], v[24:27], v[176:179]
  s_waitcnt vmcnt(20)
  s_barrier
  s_add_u32 m0, s51, 61440
  s_add_u32 s46, s66, 164480
  buffer_load_dwordx4 v8, s[4:7], s46 offen lds
  s_add_u32 m0, s51, 65536
  s_add_u32 s46, s66, 164608
  buffer_load_dwordx4 v8, s[4:7], s46 offen lds
  s_add_u32 m0, s51, 69632
  s_add_u32 s46, s66, 164736
  buffer_load_dwordx4 v8, s[4:7], s46 offen lds
  s_add_u32 m0, s51, 73728
  s_add_u32 s46, s66, 164864
  buffer_load_dwordx4 v8, s[4:7], s46 offen lds
  s_add_u32 m0, s51, 77824
  s_add_u32 s46, s66, 164992
  buffer_load_dwordx4 v8, s[4:7], s46 offen lds
  ds_read_b64_tr_b16 v[100:101], v10 offset:16384
  ds_read_b64_tr_b16 v[102:103], v10 offset:17408
  ds_read_b64_tr_b16 v[104:105], v10 offset:20480
  ds_read_b64_tr_b16 v[106:107], v10 offset:21504
  ds_read_b64_tr_b16 v[108:109], v10 offset:24576
  ds_read_b64_tr_b16 v[110:111], v10 offset:25600
  ds_read_b64_tr_b16 v[112:113], v10 offset:28672
  ds_read_b64_tr_b16 v[114:115], v10 offset:29696
  ds_read_b64_tr_b16 v[116:117], v10 offset:32768
  ds_read_b64_tr_b16 v[118:119], v10 offset:33792
  s_waitcnt lgkmcnt(0)
  v_mfma_f32_16x16x32_bf16 v[140:143], v[100:103], v[28:31], v[140:143]
  v_mfma_f32_16x16x32_bf16 v[144:147], v[104:107], v[28:31], v[144:147]
  v_mfma_f32_16x16x32_bf16 v[148:151], v[108:111], v[28:31], v[148:151]
  v_mfma_f32_16x16x32_bf16 v[152:155], v[112:115], v[28:31], v[152:155]
  v_mfma_f32_16x16x32_bf16 v[156:159], v[116:119], v[28:31], v[156:159]
  s_waitcnt vmcnt(20)
  s_barrier
  s_add_u32 m0, s51, 81920
  s_add_u32 s46, s66, 204800
  buffer_load_dwordx4 v8, s[4:7], s46 offen lds
  s_add_u32 m0, s51, 86016
  s_add_u32 s46, s66, 204928
  buffer_load_dwordx4 v8, s[4:7], s46 offen lds
  s_add_u32 m0, s51, 90112
  s_add_u32 s46, s66, 205056
  buffer_load_dwordx4 v8, s[4:7], s46 offen lds
  s_add_u32 m0, s51, 94208
  s_add_u32 s46, s66, 205184
  buffer_load_dwordx4 v8, s[4:7], s46 offen lds
  s_add_u32 m0, s51, 98304
  s_add_u32 s46, s66, 205312
  buffer_load_dwordx4 v8, s[4:7], s46 offen lds
  ds_read_b64_tr_b16 v[120:121], v10 offset:36864
  ds_read_b64_tr_b16 v[122:123], v10 offset:37888
  ds_read_b64_tr_b16 v[124:125], v10 offset:40960
  ds_read_b64_tr_b16 v[126:127], v10 offset:41984
  ds_read_b64_tr_b16 v[128:129], v10 offset:45056
  ds_read_b64_tr_b16 v[130:131], v10 offset:46080
  ds_read_b64_tr_b16 v[132:133], v10 offset:49152
  ds_read_b64_tr_b16 v[134:135], v10 offset:50176
  ds_read_b64_tr_b16 v[136:137], v10 offset:53248
  ds_read_b64_tr_b16 v[138:139], v10 offset:54272
  s_waitcnt lgkmcnt(0)
  v_mfma_f32_16x16x32_bf16 v[160:163], v[120:123], v[28:31], v[160:163]
  v_mfma_f32_16x16x32_bf16 v[164:167], v[124:127], v[28:31], v[164:167]
  v_mfma_f32_16x16x32_bf16 v[168:171], v[128:131], v[28:31], v[168:171]
  v_mfma_f32_16x16x32_bf16 v[172:175], v[132:135], v[28:31], v[172:175]
  v_mfma_f32_16x16x32_bf16 v[176:179], v[136:139], v[28:31], v[176:179]
  s_waitcnt vmcnt(20)
  s_barrier
  s_add_u32 m0, s51, 102400
  s_add_u32 s46, s66, 205440
  buffer_load_dwordx4 v8, s[4:7], s46 offen lds
  s_add_u32 m0, s51, 106496
  s_add_u32 s46, s66, 205568
  buffer_load_dwordx4 v8, s[4:7], s46 offen lds
  s_add_u32 m0, s51, 110592
  s_add_u32 s46, s66, 205696
  buffer_load_dwordx4 v8, s[4:7], s46 offen lds
  s_add_u32 m0, s51, 114688
  s_add_u32 s46, s66, 205824
  buffer_load_dwordx4 v8, s[4:7], s46 offen lds
  s_add_u32 m0, s51, 118784
  s_add_u32 s46, s66, 205952
  buffer_load_dwordx4 v8, s[4:7], s46 offen lds
  ds_read_b64_tr_b16 v[100:101], v9 offset:0
  ds_read_b64_tr_b16 v[102:103], v9 offset:1024
  ds_read_b64_tr_b16 v[104:105], v9 offset:4096
  ds_read_b64_tr_b16 v[106:107], v9 offset:5120
  ds_read_b64_tr_b16 v[108:109], v9 offset:8192
  ds_read_b64_tr_b16 v[110:111], v9 offset:9216
  ds_read_b64_tr_b16 v[112:113], v9 offset:12288
  ds_read_b64_tr_b16 v[114:115], v9 offset:13312
  ds_read_b64_tr_b16 v[116:117], v9 offset:16384
  ds_read_b64_tr_b16 v[118:119], v9 offset:17408
  s_waitcnt lgkmcnt(0)
  v_mfma_f32_16x16x32_bf16 v[140:143], v[100:103], v[32:35], v[140:143]
  v_mfma_f32_16x16x32_bf16 v[144:147], v[104:107], v[32:35], v[144:147]
  v_mfma_f32_16x16x32_bf16 v[148:151], v[108:111], v[32:35], v[148:151]
  v_mfma_f32_16x16x32_bf16 v[152:155], v[112:115], v[32:35], v[152:155]
  v_mfma_f32_16x16x32_bf16 v[156:159], v[116:119], v[32:35], v[156:159]
  s_waitcnt vmcnt(20)
  s_barrier
  s_add_u32 m0, s51, 0
  s_add_u32 s46, s66, 245760
  buffer_load_dwordx4 v8, s[4:7], s46 offen lds
  s_add_u32 m0, s51, 4096
  s_add_u32 s46, s66, 245888
  buffer_load_dwordx4 v8, s[4:7], s46 offen lds
  s_add_u32 m0, s51, 8192
  s_add_u32 s46, s66, 246016
  buffer_load_dwordx4 v8, s[4:7], s46 offen lds
  s_add_u32 m0, s51, 12288
  s_add_u32 s46, s66, 246144
  buffer_load_dwordx4 v8, s[4:7], s46 offen lds
  s_add_u32 m0, s51, 16384
  s_add_u32 s46, s66, 246272
  buffer_load_dwordx4 v8, s[4:7], s46 offen lds
  ds_read_b64_tr_b16 v[120:121], v9 offset:20480
  ds_read_b64_tr_b16 v[122:123], v9 offset:21504
  ds_read_b64_tr_b16 v[124:125], v9 offset:24576
  ds_read_b64_tr_b16 v[126:127], v9 offset:25600
  ds_read_b64_tr_b16 v[128:129], v9 offset:28672
  ds_read_b64_tr_b16 v[130:131], v9 offset:29696
  ds_read_b64_tr_b16 v[132:133], v9 offset:32768
  ds_read_b64_tr_b16 v[134:135], v9 offset:33792
  ds_read_b64_tr_b16 v[136:137], v9 offset:36864
  ds_read_b64_tr_b16 v[138:139], v9 offset:37888
  s_waitcnt lgkmcnt(0)
  v_mfma_f32_16x16x32_bf16 v[160:163], v[120:123], v[32:35], v[160:163]
  v_mfma_f32_16x16x32_bf16 v[164:167], v[124:127], v[32:35], v[164:167]
  v_mfma_f32_16x16x32_bf16 v[168:171], v[128:131], v[32:35], v[168:171]
  v_mfma_f32_16x16x32_bf16 v[172:175], v[132:135], v[32:35], v[172:175]
  v_mfma_f32_16x16x32_bf16 v[176:179], v[136:139], v[32:35], v[176:179]
  s_waitcnt vmcnt(20)
  s_barrier
  s_add_u32 m0, s51, 20480
  s_add_u32 s46, s66, 246400
  buffer_load_dwordx4 v8, s[4:7], s46 offen lds
  s_add_u32 m0, s51, 24576
  s_add_u32 s46, s66, 246528
  buffer_load_dwordx4 v8, s[4:7], s46 offen lds
  s_add_u32 m0, s51, 28672
  s_add_u32 s46, s66, 246656
  buffer_load_dwordx4 v8, s[4:7], s46 offen lds
  s_add_u32 m0, s51, 32768
  s_add_u32 s46, s66, 246784
  buffer_load_dwordx4 v8, s[4:7], s46 offen lds
  s_add_u32 m0, s51, 36864
  s_add_u32 s46, s66, 246912
  buffer_load_dwordx4 v8, s[4:7], s46 offen lds
  ds_read_b64_tr_b16 v[100:101], v9 offset:40960
  ds_read_b64_tr_b16 v[102:103], v9 offset:41984
  ds_read_b64_tr_b16 v[104:105], v9 offset:45056
  ds_read_b64_tr_b16 v[106:107], v9 offset:46080
  ds_read_b64_tr_b16 v[108:109], v9 offset:49152
  ds_read_b64_tr_b16 v[110:111], v9 offset:50176
  ds_read_b64_tr_b16 v[112:113], v9 offset:53248
  ds_read_b64_tr_b16 v[114:115], v9 offset:54272
  ds_read_b64_tr_b16 v[116:117], v9 offset:57344
  ds_read_b64_tr_b16 v[118:119], v9 offset:58368
  s_waitcnt lgkmcnt(0)
  v_mfma_f32_16x16x32_bf16 v[140:143], v[100:103], v[36:39], v[140:143]
  v_mfma_f32_16x16x32_bf16 v[144:147], v[104:107], v[36:39], v[144:147]
  v_mfma_f32_16x16x32_bf16 v[148:151], v[108:111], v[36:39], v[148:151]
  v_mfma_f32_16x16x32_bf16 v[152:155], v[112:115], v[36:39], v[152:155]
  v_mfma_f32_16x16x32_bf16 v[156:159], v[116:119], v[36:39], v[156:159]
  s_waitcnt vmcnt(20)
  s_barrier
  s_add_u32 m0, s51, 40960
  s_add_u32 s46, s66, 286720
  buffer_load_dwordx4 v8, s[4:7], s46 offen lds
  s_add_u32 m0, s51, 45056
  s_add_u32 s46, s66, 286848
  buffer_load_dwordx4 v8, s[4:7], s46 offen lds
  s_add_u32 m0, s51, 49152
  s_add_u32 s46, s66, 286976
  buffer_load_dwordx4 v8, s[4:7], s46 offen lds
  s_add_u32 m0, s51, 53248
  s_add_u32 s46, s66, 287104
  buffer_load_dwordx4 v8, s[4:7], s46 offen lds
  s_add_u32 m0, s51, 57344
  s_add_u32 s46, s66, 287232
  buffer_load_dwordx4 v8, s[4:7], s46 offen lds
  ds_read_b64_tr_b16 v[120:121], v9 offset:61440
  ds_read_b64_tr_b16 v[122:123], v9 offset:62464
  ds_read_b64_tr_b16 v[124:125], v10 offset:0
  ds_read_b64_tr_b16 v[126:127], v10 offset:1024
  ds_read_b64_tr_b16 v[128:129], v10 offset:4096
  ds_read_b64_tr_b16 v[130:131], v10 offset:5120
  ds_read_b64_tr_b16 v[132:133], v10 offset:8192
  ds_read_b64_tr_b16 v[134:135], v10 offset:9216
  ds_read_b64_tr_b16 v[136:137], v10 offset:12288
  ds_read_b64_tr_b16 v[138:139], v10 offset:13312
  s_waitcnt lgkmcnt(0)
  v_mfma_f32_16x16x32_bf16 v[160:163], v[120:123], v[36:39], v[160:163]
  v_mfma_f32_16x16x32_bf16 v[164:167], v[124:127], v[36:39], v[164:167]
  v_mfma_f32_16x16x32_bf16 v[168:171], v[128:131], v[36:39], v[168:171]
  v_mfma_f32_16x16x32_bf16 v[172:175], v[132:135], v[36:39], v[172:175]
  v_mfma_f32_16x16x32_bf16 v[176:179], v[136:139], v[36:39], v[176:179]
  s_waitcnt vmcnt(20)
  s_barrier
  s_add_u32 m0, s51, 61440
  s_add_u32 s46, s66, 287360
  buffer_load_dwordx4 v8, s[4:7], s46 offen lds
  s_add_u32 m0, s51, 65536
  s_add_u32 s46, s66, 287488
  buffer_load_dwordx4 v8, s[4:7], s46 offen lds
  s_add_u32 m0, s51, 69632
  s_add_u32 s46, s66, 287616
  buffer_load_dwordx4 v8, s[4:7], s46 offen lds
  s_add_u32 m0, s51, 73728
  s_add_u32 s46, s66, 287744
  buffer_load_dwordx4 v8, s[4:7], s46 offen lds
  s_add_u32 m0, s51, 77824
  s_add_u32 s46, s66, 287872
  buffer_load_dwordx4 v8, s[4:7], s46 offen lds
  ds_read_b64_tr_b16 v[100:101], v10 offset:16384
  ds_read_b64_tr_b16 v[102:103], v10 offset:17408
  ds_read_b64_tr_b16 v[104:105], v10 offset:20480
  ds_read_b64_tr_b16 v[106:107], v10 offset:21504
  ds_read_b64_tr_b16 v[108:109], v10 offset:24576
  ds_read_b64_tr_b16 v[110:111], v10 offset:25600
  ds_read_b64_tr_b16 v[112:113], v10 offset:28672
  ds_read_b64_tr_b16 v[114:115], v10 offset:29696
  ds_read_b64_tr_b16 v[116:117], v10 offset:32768
  ds_read_b64_tr_b16 v[118:119], v10 offset:33792
  s_waitcnt lgkmcnt(0)
  v_mfma_f32_16x16x32_bf16 v[140:143], v[100:103], v[40:43], v[140:143]
  v_mfma_f32_16x16x32_bf16 v[144:147], v[104:107], v[40:43], v[144:147]
  v_mfma_f32_16x16x32_bf16 v[148:151], v[108:111], v[40:43], v[148:151]
  v_mfma_f32_16x16x32_bf16 v[152:155], v[112:115], v[40:43], v[152:155]
  v_mfma_f32_16x16x32_bf16 v[156:159], v[116:119], v[40:43], v[156:159]
  s_waitcnt vmcnt(20)
  s_barrier
  s_add_u32 m0, s51, 81920
  s_add_u32 s46, s66, 327680
  buffer_load_dwordx4 v8, s[4:7], s46 offen lds
  s_add_u32 m0, s51, 86016
  s_add_u32 s46, s66, 327808
  buffer_load_dwordx4 v8, s[4:7], s46 offen lds
  s_add_u32 m0, s51, 90112
  s_add_u32 s46, s66, 327936
  buffer_load_dwordx4 v8, s[4:7], s46 offen lds
  s_add_u32 m0, s51, 94208
  s_add_u32 s46, s66, 328064
  buffer_load_dwordx4 v8, s[4:7], s46 offen lds
  s_add_u32 m0, s51, 98304
  s_add_u32 s46, s66, 328192
  buffer_load_dwordx4 v8, s[4:7], s46 offen lds
  ds_read_b64_tr_b16 v[120:121], v10 offset:36864
  ds_read_b64_tr_b16 v[122:123], v10 offset:37888
  ds_read_b64_tr_b16 v[124:125], v10 offset:40960
  ds_read_b64_tr_b16 v[126:127], v10 offset:41984
  ds_read_b64_tr_b16 v[128:129], v10 offset:45056
  ds_read_b64_tr_b16 v[130:131], v10 offset:46080
  ds_read_b64_tr_b16 v[132:133], v10 offset:49152
  ds_read_b64_tr_b16 v[134:135], v10 offset:50176
  ds_read_b64_tr_b16 v[136:137], v10 offset:53248
  ds_read_b64_tr_b16 v[138:139], v10 offset:54272
  s_waitcnt lgkmcnt(0)
  v_mfma_f32_16x16x32_bf16 v[160:163], v[120:123], v[40:43], v[160:163]
  v_mfma_f32_16x16x32_bf16 v[164:167], v[124:127], v[40:43], v[164:167]
  v_mfma_f32_16x16x32_bf16 v[168:171], v[128:131], v[40:43], v[168:171]
  v_mfma_f32_16x16x32_bf16 v[172:175], v[132:135], v[40:43], v[172:175]
  v_mfma_f32_16x16x32_bf16 v[176:179], v[136:139], v[40:43], v[176:179]
  s_waitcnt vmcnt(20)
  s_barrier
  s_add_u32 m0, s51, 102400
  s_add_u32 s46, s66, 328320
  buffer_load_dwordx4 v8, s[4:7], s46 offen lds
  s_add_u32 m0, s51, 106496
  s_add_u32 s46, s66, 328448
  buffer_load_dwordx4 v8, s[4:7], s46 offen lds
  s_add_u32 m0, s51, 110592
  s_add_u32 s46, s66, 328576
  buffer_load_dwordx4 v8, s[4:7], s46 offen lds
  s_add_u32 m0, s51, 114688
  s_add_u32 s46, s66, 328704
  buffer_load_dwordx4 v8, s[4:7], s46 offen lds
  s_add_u32 m0, s51, 118784
  s_add_u32 s46, s66, 328832
  buffer_load_dwordx4 v8, s[4:7], s46 offen lds
  ds_read_b64_tr_b16 v[100:101], v9 offset:0
  ds_read_b64_tr_b16 v[102:103], v9 offset:1024
  ds_read_b64_tr_b16 v[104:105], v9 offset:4096
  ds_read_b64_tr_b16 v[106:107], v9 offset:5120
  ds_read_b64_tr_b16 v[108:109], v9 offset:8192
  ds_read_b64_tr_b16 v[110:111], v9 offset:9216
  ds_read_b64_tr_b16 v[112:113], v9 offset:12288
  ds_read_b64_tr_b16 v[114:115], v9 offset:13312
  ds_read_b64_tr_b16 v[116:117], v9 offset:16384
  ds_read_b64_tr_b16 v[118:119], v9 offset:17408
  s_waitcnt lgkmcnt(0)
  v_mfma_f32_16x16x32_bf16 v[140:143], v[100:103], v[44:47], v[140:143]
  v_mfma_f32_16x16x32_bf16 v[144:147], v[104:107], v[44:47], v[144:147]
  v_mfma_f32_16x16x32_bf16 v[148:151], v[108:111], v[44:47], v[148:151]
  v_mfma_f32_16x16x32_bf16 v[152:155], v[112:115], v[44:47], v[152:155]
  v_mfma_f32_16x16x32_bf16 v[156:159], v[116:119], v[44:47], v[156:159]
  s_waitcnt vmcnt(20)
  s_barrier
  s_add_u32 m0, s51, 0
  s_add_u32 s46, s66, 368640
  buffer_load_dwordx4 v8, s[4:7], s46 offen lds
  s_add_u32 m0, s51, 4096
  s_add_u32 s46, s66, 368768
  buffer_load_dwordx4 v8, s[4:7], s46 offen lds
  s_add_u32 m0, s51, 8192
  s_add_u32 s46, s66, 368896
  buffer_load_dwordx4 v8, s[4:7], s46 offen lds
  s_add_u32 m0, s51, 12288
  s_add_u32 s46, s66, 369024
  buffer_load_dwordx4 v8, s[4:7], s46 offen lds
  s_add_u32 m0, s51, 16384
  s_add_u32 s46, s66, 369152
  buffer_load_dwordx4 v8, s[4:7], s46 offen lds
  ds_read_b64_tr_b16 v[120:121], v9 offset:20480
  ds_read_b64_tr_b16 v[122:123], v9 offset:21504
  ds_read_b64_tr_b16 v[124:125], v9 offset:24576
  ds_read_b64_tr_b16 v[126:127], v9 offset:25600
  ds_read_b64_tr_b16 v[128:129], v9 offset:28672
  ds_read_b64_tr_b16 v[130:131], v9 offset:29696
  ds_read_b64_tr_b16 v[132:133], v9 offset:32768
  ds_read_b64_tr_b16 v[134:135], v9 offset:33792
  ds_read_b64_tr_b16 v[136:137], v9 offset:36864
  ds_read_b64_tr_b16 v[138:139], v9 offset:37888
  s_waitcnt lgkmcnt(0)
  v_mfma_f32_16x16x32_bf16 v[160:163], v[120:123], v[44:47], v[160:163]
  v_mfma_f32_16x16x32_bf16 v[164:167], v[124:127], v[44:47], v[164:167]
  v_mfma_f32_16x16x32_bf16 v[168:171], v[128:131], v[44:47], v[168:171]
  v_mfma_f32_16x16x32_bf16 v[172:175], v[132:135], v[44:47], v[172:175]
  v_mfma_f32_16x16x32_bf16 v[176:179], v[136:139], v[44:47], v[176:179]
  s_waitcnt vmcnt(20)
  s_barrier
  s_add_u32 m0, s51, 20480
  s_add_u32 s46, s66, 369280
  buffer_load_dwordx4 v8, s[4:7], s46 offen lds
  s_add_u32 m0, s51, 24576
  s_add_u32 s46, s66, 369408
  buffer_load_dwordx4 v8, s[4:7], s46 offen lds
  s_add_u32 m0, s51, 28672
  s_add_u32 s46, s66, 369536
  buffer_load_dwordx4 v8, s[4:7], s46 offen lds
  s_add_u32 m0, s51, 32768
  s_add_u32 s46, s66, 369664
  buffer_load_dwordx4 v8, s[4:7], s46 offen lds
  s_add_u32 m0, s51, 36864
  s_add_u32 s46, s66, 369792
  buffer_load_dwordx4 v8, s[4:7], s46 offen lds
  ds_read_b64_tr_b16 v[100:101], v9 offset:40960
  ds_read_b64_tr_b16 v[102:103], v9 offset:41984
  ds_read_b64_tr_b16 v[104:105], v9 offset:45056
  ds_read_b64_tr_b16 v[106:107], v9 offset:46080
  ds_read_b64_tr_b16 v[108:109], v9 offset:49152
  ds_read_b64_tr_b16 v[110:111], v9 offset:50176
  ds_read_b64_tr_b16 v[112:113], v9 offset:53248
  ds_read_b64_tr_b16 v[114:115], v9 offset:54272
  ds_read_b64_tr_b16 v[116:117], v9 offset:57344
  ds_read_b64_tr_b16 v[118:119], v9 offset:58368
  s_waitcnt lgkmcnt(0)
  v_mfma_f32_16x16x32_bf16 v[140:143], v[100:103], v[48:51], v[140:143]
  v_mfma_f32_16x16x32_bf16 v[144:147], v[104:107], v[48:51], v[144:147]
  v_mfma_f32_16x16x32_bf16 v[148:151], v[108:111], v[48:51], v[148:151]
  v_mfma_f32_16x16x32_bf16 v[152:155], v[112:115], v[48:51], v[152:155]
  v_mfma_f32_16x16x32_bf16 v[156:159], v[116:119], v[48:51], v[156:159]
  s_waitcnt vmcnt(20)
  s_barrier
  s_add_u32 m0, s51, 40960
  s_add_u32 s46, s66, 409600
  buffer_load_dwordx4 v8, s[4:7], s46 offen lds
  s_add_u32 m0, s51, 45056
  s_add_u32 s46, s66, 409728
  buffer_load_dwordx4 v8, s[4:7], s46 offen lds
  s_add_u32 m0, s51, 49152
  s_add_u32 s46, s66, 409856
  buffer_load_dwordx4 v8, s[4:7], s46 offen lds
  s_add_u32 m0, s51, 53248
  s_add_u32 s46, s66, 409984
  buffer_load_dwordx4 v8, s[4:7], s46 offen lds
  s_add_u32 m0, s51, 57344
  s_add_u32 s46, s66, 410112
  buffer_load_dwordx4 v8, s[4:7], s46 offen lds
  ds_read_b64_tr_b16 v[120:121], v9 offset:61440
  ds_read_b64_tr_b16 v[122:123], v9 offset:62464
  ds_read_b64_tr_b16 v[124:125], v10 offset:0
  ds_read_b64_tr_b16 v[126:127], v10 offset:1024
  ds_read_b64_tr_b16 v[128:129], v10 offset:4096
  ds_read_b64_tr_b16 v[130:131], v10 offset:5120
  ds_read_b64_tr_b16 v[132:133], v10 offset:8192
  ds_read_b64_tr_b16 v[134:135], v10 offset:9216
  ds_read_b64_tr_b16 v[136:137], v10 offset:12288
  ds_read_b64_tr_b16 v[138:139], v10 offset:13312
  s_waitcnt lgkmcnt(0)
  v_mfma_f32_16x16x32_bf16 v[160:163], v[120:123], v[48:51], v[160:163]
  v_mfma_f32_16x16x32_bf16 v[164:167], v[124:127], v[48:51], v[164:167]
  v_mfma_f32_16x16x32_bf16 v[168:171], v[128:131], v[48:51], v[168:171]
  v_mfma_f32_16x16x32_bf16 v[172:175], v[132:135], v[48:51], v[172:175]
  v_mfma_f32_16x16x32_bf16 v[176:179], v[136:139], v[48:51], v[176:179]
  s_waitcnt vmcnt(20)
  s_barrier
  s_add_u32 m0, s51, 61440
  s_add_u32 s46, s66, 410240
  buffer_load_dwordx4 v8, s[4:7], s46 offen lds
  s_add_u32 m0, s51, 65536
  s_add_u32 s46, s66, 410368
  buffer_load_dwordx4 v8, s[4:7], s46 offen lds
  s_add_u32 m0, s51, 69632
  s_add_u32 s46, s66, 410496
  buffer_load_dwordx4 v8, s[4:7], s46 offen lds
  s_add_u32 m0, s51, 73728
  s_add_u32 s46, s66, 410624
  buffer_load_dwordx4 v8, s[4:7], s46 offen lds
  s_add_u32 m0, s51, 77824
  s_add_u32 s46, s66, 410752
  buffer_load_dwordx4 v8, s[4:7], s46 offen lds
  ds_read_b64_tr_b16 v[100:101], v10 offset:16384
  ds_read_b64_tr_b16 v[102:103], v10 offset:17408
  ds_read_b64_tr_b16 v[104:105], v10 offset:20480
  ds_read_b64_tr_b16 v[106:107], v10 offset:21504
  ds_read_b64_tr_b16 v[108:109], v10 offset:24576
  ds_read_b64_tr_b16 v[110:111], v10 offset:25600
  ds_read_b64_tr_b16 v[112:113], v10 offset:28672
  ds_read_b64_tr_b16 v[114:115], v10 offset:29696
  ds_read_b64_tr_b16 v[116:117], v10 offset:32768
  ds_read_b64_tr_b16 v[118:119], v10 offset:33792
  s_waitcnt lgkmcnt(0)
  v_mfma_f32_16x16x32_bf16 v[140:143], v[100:103], v[52:55], v[140:143]
  v_mfma_f32_16x16x32_bf16 v[144:147], v[104:107], v[52:55], v[144:147]
  v_mfma_f32_16x16x32_bf16 v[148:151], v[108:111], v[52:55], v[148:151]
  v_mfma_f32_16x16x32_bf16 v[152:155], v[112:115], v[52:55], v[152:155]
  v_mfma_f32_16x16x32_bf16 v[156:159], v[116:119], v[52:55], v[156:159]
  s_waitcnt vmcnt(20)
  s_barrier
  s_add_u32 m0, s51, 81920
  s_add_u32 s46, s66, 450560
  buffer_load_dwordx4 v8, s[4:7], s46 offen lds
  s_add_u32 m0, s51, 86016
  s_add_u32 s46, s66, 450688
  buffer_load_dwordx4 v8, s[4:7], s46 offen lds
  s_add_u32 m0, s51, 90112
  s_add_u32 s46, s66, 450816
  buffer_load_dwordx4 v8, s[4:7], s46 offen lds
  s_add_u32 m0, s51, 94208
  s_add_u32 s46, s66, 450944
  buffer_load_dwordx4 v8, s[4:7], s46 offen lds
  s_add_u32 m0, s51, 98304
  s_add_u32 s46, s66, 451072
  buffer_load_dwordx4 v8, s[4:7], s46 offen lds
  ds_read_b64_tr_b16 v[120:121], v10 offset:36864
  ds_read_b64_tr_b16 v[122:123], v10 offset:37888
  ds_read_b64_tr_b16 v[124:125], v10 offset:40960
  ds_read_b64_tr_b16 v[126:127], v10 offset:41984
  ds_read_b64_tr_b16 v[128:129], v10 offset:45056
  ds_read_b64_tr_b16 v[130:131], v10 offset:46080
  ds_read_b64_tr_b16 v[132:133], v10 offset:49152
  ds_read_b64_tr_b16 v[134:135], v10 offset:50176
  ds_read_b64_tr_b16 v[136:137], v10 offset:53248
  ds_read_b64_tr_b16 v[138:139], v10 offset:54272
  s_waitcnt lgkmcnt(0)
  v_mfma_f32_16x16x32_bf16 v[160:163], v[120:123], v[52:55], v[160:163]
  v_mfma_f32_16x16x32_bf16 v[164:167], v[124:127], v[52:55], v[164:167]
  v_mfma_f32_16x16x32_bf16 v[168:171], v[128:131], v[52:55], v[168:171]
  v_mfma_f32_16x16x32_bf16 v[172:175], v[132:135], v[52:55], v[172:175]
  v_mfma_f32_16x16x32_bf16 v[176:179], v[136:139], v[52:55], v[176:179]
  s_waitcnt vmcnt(20)
  s_barrier
  s_add_u32 m0, s51, 102400
  s_add_u32 s46, s66, 451200
  buffer_load_dwordx4 v8, s[4:7], s46 offen lds
  s_add_u32 m0, s51, 106496
  s_add_u32 s46, s66, 451328
  buffer_load_dwordx4 v8, s[4:7], s46 offen lds
  s_add_u32 m0, s51, 110592
  s_add_u32 s46, s66, 451456
  buffer_load_dwordx4 v8, s[4:7], s46 offen lds
  s_add_u32 m0, s51, 114688
  s_add_u32 s46, s66, 451584
  buffer_load_dwordx4 v8, s[4:7], s46 offen lds
  s_add_u32 m0, s51, 118784
  s_add_u32 s46, s66, 451712
  buffer_load_dwordx4 v8, s[4:7], s46 offen lds
  ds_read_b64_tr_b16 v[100:101], v9 offset:0
  ds_read_b64_tr_b16 v[102:103], v9 offset:1024
  ds_read_b64_tr_b16 v[104:105], v9 offset:4096
  ds_read_b64_tr_b16 v[106:107], v9 offset:5120
  ds_read_b64_tr_b16 v[108:109], v9 offset:8192
  ds_read_b64_tr_b16 v[110:111], v9 offset:9216
  ds_read_b64_tr_b16 v[112:113], v9 offset:12288
  ds_read_b64_tr_b16 v[114:115], v9 offset:13312
  ds_read_b64_tr_b16 v[116:117], v9 offset:16384
  ds_read_b64_tr_b16 v[118:119], v9 offset:17408
  s_waitcnt lgkmcnt(0)
  v_mfma_f32_16x16x32_bf16 v[140:143], v[100:103], v[56:59], v[140:143]
  v_mfma_f32_16x16x32_bf16 v[144:147], v[104:107], v[56:59], v[144:147]
  v_mfma_f32_16x16x32_bf16 v[148:151], v[108:111], v[56:59], v[148:151]
  v_mfma_f32_16x16x32_bf16 v[152:155], v[112:115], v[56:59], v[152:155]
  v_mfma_f32_16x16x32_bf16 v[156:159], v[116:119], v[56:59], v[156:159]
  s_waitcnt vmcnt(20)
  s_barrier
  s_add_u32 m0, s51, 0
  s_add_u32 s46, s66, 491520
  buffer_load_dwordx4 v8, s[4:7], s46 offen lds
  s_add_u32 m0, s51, 4096
  s_add_u32 s46, s66, 491648
  buffer_load_dwordx4 v8, s[4:7], s46 offen lds
  s_add_u32 m0, s51, 8192
  s_add_u32 s46, s66, 491776
  buffer_load_dwordx4 v8, s[4:7], s46 offen lds
  s_add_u32 m0, s51, 12288
  s_add_u32 s46, s66, 491904
  buffer_load_dwordx4 v8, s[4:7], s46 offen lds
  s_add_u32 m0, s51, 16384
  s_add_u32 s46, s66, 492032
  buffer_load_dwordx4 v8, s[4:7], s46 offen lds
  ds_read_b64_tr_b16 v[120:121], v9 offset:20480
  ds_read_b64_tr_b16 v[122:123], v9 offset:21504
  ds_read_b64_tr_b16 v[124:125], v9 offset:24576
  ds_read_b64_tr_b16 v[126:127], v9 offset:25600
  ds_read_b64_tr_b16 v[128:129], v9 offset:28672
  ds_read_b64_tr_b16 v[130:131], v9 offset:29696
  ds_read_b64_tr_b16 v[132:133], v9 offset:32768
  ds_read_b64_tr_b16 v[134:135], v9 offset:33792
  ds_read_b64_tr_b16 v[136:137], v9 offset:36864
  ds_read_b64_tr_b16 v[138:139], v9 offset:37888
  s_waitcnt lgkmcnt(0)
  v_mfma_f32_16x16x32_bf16 v[160:163], v[120:123], v[56:59], v[160:163]
  v_mfma_f32_16x16x32_bf16 v[164:167], v[124:127], v[56:59], v[164:167]
  v_mfma_f32_16x16x32_bf16 v[168:171], v[128:131], v[56:59], v[168:171]
  v_mfma_f32_16x16x32_bf16 v[172:175], v[132:135], v[56:59], v[172:175]
  v_mfma_f32_16x16x32_bf16 v[176:179], v[136:139], v[56:59], v[176:179]
  s_waitcnt vmcnt(20)
  s_barrier
  s_add_u32 m0, s51, 20480
  s_add_u32 s46, s66, 492160
  buffer_load_dwordx4 v8, s[4:7], s46 offen lds
  s_add_u32 m0, s51, 24576
  s_add_u32 s46, s66, 492288
  buffer_load_dwordx4 v8, s[4:7], s46 offen lds
  s_add_u32 m0, s51, 28672
  s_add_u32 s46, s66, 492416
  buffer_load_dwordx4 v8, s[4:7], s46 offen lds
  s_add_u32 m0, s51, 32768
  s_add_u32 s46, s66, 492544
  buffer_load_dwordx4 v8, s[4:7], s46 offen lds
  s_add_u32 m0, s51, 36864
  s_add_u32 s46, s66, 492672
  buffer_load_dwordx4 v8, s[4:7], s46 offen lds
  ds_read_b64_tr_b16 v[100:101], v9 offset:40960
  ds_read_b64_tr_b16 v[102:103], v9 offset:41984
  ds_read_b64_tr_b16 v[104:105], v9 offset:45056
  ds_read_b64_tr_b16 v[106:107], v9 offset:46080
  ds_read_b64_tr_b16 v[108:109], v9 offset:49152
  ds_read_b64_tr_b16 v[110:111], v9 offset:50176
  ds_read_b64_tr_b16 v[112:113], v9 offset:53248
  ds_read_b64_tr_b16 v[114:115], v9 offset:54272
  ds_read_b64_tr_b16 v[116:117], v9 offset:57344
  ds_read_b64_tr_b16 v[118:119], v9 offset:58368
  s_waitcnt lgkmcnt(0)
  v_mfma_f32_16x16x32_bf16 v[140:143], v[100:103], v[60:63], v[140:143]
  v_mfma_f32_16x16x32_bf16 v[144:147], v[104:107], v[60:63], v[144:147]
  v_mfma_f32_16x16x32_bf16 v[148:151], v[108:111], v[60:63], v[148:151]
  v_mfma_f32_16x16x32_bf16 v[152:155], v[112:115], v[60:63], v[152:155]
  v_mfma_f32_16x16x32_bf16 v[156:159], v[116:119], v[60:63], v[156:159]
  s_waitcnt vmcnt(20)
  s_barrier
  s_add_u32 m0, s51, 40960
  s_add_u32 s46, s66, 532480
  buffer_load_dwordx4 v8, s[4:7], s46 offen lds
  s_add_u32 m0, s51, 45056
  s_add_u32 s46, s66, 532608
  buffer_load_dwordx4 v8, s[4:7], s46 offen lds
  s_add_u32 m0, s51, 49152
  s_add_u32 s46, s66, 532736
  buffer_load_dwordx4 v8, s[4:7], s46 offen lds
  s_add_u32 m0, s51, 53248
  s_add_u32 s46, s66, 532864
  buffer_load_dwordx4 v8, s[4:7], s46 offen lds
  s_add_u32 m0, s51, 57344
  s_add_u32 s46, s66, 532992
  buffer_load_dwordx4 v8, s[4:7], s46 offen lds
  ds_read_b64_tr_b16 v[120:121], v9 offset:61440
  ds_read_b64_tr_b16 v[122:123], v9 offset:62464
  ds_read_b64_tr_b16 v[124:125], v10 offset:0
  ds_read_b64_tr_b16 v[126:127], v10 offset:1024
  ds_read_b64_tr_b16 v[128:129], v10 offset:4096
  ds_read_b64_tr_b16 v[130:131], v10 offset:5120
  ds_read_b64_tr_b16 v[132:133], v10 offset:8192
  ds_read_b64_tr_b16 v[134:135], v10 offset:9216
  ds_read_b64_tr_b16 v[136:137], v10 offset:12288
  ds_read_b64_tr_b16 v[138:139], v10 offset:13312
  s_waitcnt lgkmcnt(0)
  v_mfma_f32_16x16x32_bf16 v[160:163], v[120:123], v[60:63], v[160:163]
  v_mfma_f32_16x16x32_bf16 v[164:167], v[124:127], v[60:63], v[164:167]
  v_mfma_f32_16x16x32_bf16 v[168:171], v[128:131], v[60:63], v[168:171]
  v_mfma_f32_16x16x32_bf16 v[172:175], v[132:135], v[60:63], v[172:175]
  v_mfma_f32_16x16x32_bf16 v[176:179], v[136:139], v[60:63], v[176:179]
  s_waitcnt vmcnt(20)
  s_barrier
  s_add_u32 m0, s51, 61440
  s_add_u32 s46, s66, 533120
  buffer_load_dwordx4 v8, s[4:7], s46 offen lds
  s_add_u32 m0, s51, 65536
  s_add_u32 s46, s66, 533248
  buffer_load_dwordx4 v8, s[4:7], s46 offen lds
  s_add_u32 m0, s51, 69632
  s_add_u32 s46, s66, 533376
  buffer_load_dwordx4 v8, s[4:7], s46 offen lds
  s_add_u32 m0, s51, 73728
  s_add_u32 s46, s66, 533504
  buffer_load_dwordx4 v8, s[4:7], s46 offen lds
  s_add_u32 m0, s51, 77824
  s_add_u32 s46, s66, 533632
  buffer_load_dwordx4 v8, s[4:7], s46 offen lds
  ds_read_b64_tr_b16 v[100:101], v10 offset:16384
  ds_read_b64_tr_b16 v[102:103], v10 offset:17408
  ds_read_b64_tr_b16 v[104:105], v10 offset:20480
  ds_read_b64_tr_b16 v[106:107], v10 offset:21504
  ds_read_b64_tr_b16 v[108:109], v10 offset:24576
  ds_read_b64_tr_b16 v[110:111], v10 offset:25600
  ds_read_b64_tr_b16 v[112:113], v10 offset:28672
  ds_read_b64_tr_b16 v[114:115], v10 offset:29696
  ds_read_b64_tr_b16 v[116:117], v10 offset:32768
  ds_read_b64_tr_b16 v[118:119], v10 offset:33792
  s_waitcnt lgkmcnt(0)
  v_mfma_f32_16x16x32_bf16 v[140:143], v[100:103], v[64:67], v[140:143]
  v_mfma_f32_16x16x32_bf16 v[144:147], v[104:107], v[64:67], v[144:147]
  v_mfma_f32_16x16x32_bf16 v[148:151], v[108:111], v[64:67], v[148:151]
  v_mfma_f32_16x16x32_bf16 v[152:155], v[112:115], v[64:67], v[152:155]
  v_mfma_f32_16x16x32_bf16 v[156:159], v[116:119], v[64:67], v[156:159]
  s_waitcnt vmcnt(20)
  s_barrier
  s_add_u32 m0, s51, 81920
  s_add_u32 s46, s66, 573440
  buffer_load_dwordx4 v8, s[4:7], s46 offen lds
  s_add_u32 m0, s51, 86016
  s_add_u32 s46, s66, 573568
  buffer_load_dwordx4 v8, s[4:7], s46 offen lds
  s_add_u32 m0, s51, 90112
  s_add_u32 s46, s66, 573696
  buffer_load_dwordx4 v8, s[4:7], s46 offen lds
  s_add_u32 m0, s51, 94208
  s_add_u32 s46, s66, 573824
  buffer_load_dwordx4 v8, s[4:7], s46 offen lds
  s_add_u32 m0, s51, 98304
  s_add_u32 s46, s66, 573952
  buffer_load_dwordx4 v8, s[4:7], s46 offen lds
  ds_read_b64_tr_b16 v[120:121], v10 offset:36864
  ds_read_b64_tr_b16 v[122:123], v10 offset:37888
  ds_read_b64_tr_b16 v[124:125], v10 offset:40960
  ds_read_b64_tr_b16 v[126:127], v10 offset:41984
  ds_read_b64_tr_b16 v[128:129], v10 offset:45056
  ds_read_b64_tr_b16 v[130:131], v10 offset:46080
  ds_read_b64_tr_b16 v[132:133], v10 offset:49152
  ds_read_b64_tr_b16 v[134:135], v10 offset:50176
  ds_read_b64_tr_b16 v[136:137], v10 offset:53248
  ds_read_b64_tr_b16 v[138:139], v10 offset:54272
  s_waitcnt lgkmcnt(0)
  v_mfma_f32_16x16x32_bf16 v[160:163], v[120:123], v[64:67], v[160:163]
  v_mfma_f32_16x16x32_bf16 v[164:167], v[124:127], v[64:67], v[164:167]
  v_mfma_f32_16x16x32_bf16 v[168:171], v[128:131], v[64:67], v[168:171]
  v_mfma_f32_16x16x32_bf16 v[172:175], v[132:135], v[64:67], v[172:175]
  v_mfma_f32_16x16x32_bf16 v[176:179], v[136:139], v[64:67], v[176:179]
  s_waitcnt vmcnt(20)
  s_barrier
  s_add_u32 m0, s51, 102400
  s_add_u32 s46, s66, 574080
  buffer_load_dwordx4 v8, s[4:7], s46 offen lds
  s_add_u32 m0, s51, 106496
  s_add_u32 s46, s66, 574208
  buffer_load_dwordx4 v8, s[4:7], s46 offen lds
  s_add_u32 m0, s51, 110592
  s_add_u32 s46, s66, 574336
  buffer_load_dwordx4 v8, s[4:7], s46 offen lds
  s_add_u32 m0, s51, 114688
  s_add_u32 s46, s66, 574464
  buffer_load_dwordx4 v8, s[4:7], s46 offen lds
  s_add_u32 m0, s51, 118784
  s_add_u32 s46, s66, 574592
  buffer_load_dwordx4 v8, s[4:7], s46 offen lds
  ds_read_b64_tr_b16 v[100:101], v9 offset:0
  ds_read_b64_tr_b16 v[102:103], v9 offset:1024
  ds_read_b64_tr_b16 v[104:105], v9 offset:4096
  ds_read_b64_tr_b16 v[106:107], v9 offset:5120
  ds_read_b64_tr_b16 v[108:109], v9 offset:8192
  ds_read_b64_tr_b16 v[110:111], v9 offset:9216
  ds_read_b64_tr_b16 v[112:113], v9 offset:12288
  ds_read_b64_tr_b16 v[114:115], v9 offset:13312
  ds_read_b64_tr_b16 v[116:117], v9 offset:16384
  ds_read_b64_tr_b16 v[118:119], v9 offset:17408
  s_waitcnt lgkmcnt(0)
  v_mfma_f32_16x16x32_bf16 v[140:143], v[100:103], v[68:71], v[140:143]
  v_mfma_f32_16x16x32_bf16 v[144:147], v[104:107], v[68:71], v[144:147]
  v_mfma_f32_16x16x32_bf16 v[148:151], v[108:111], v[68:71], v[148:151]
  v_mfma_f32_16x16x32_bf16 v[152:155], v[112:115], v[68:71], v[152:155]
  v_mfma_f32_16x16x32_bf16 v[156:159], v[116:119], v[68:71], v[156:159]
  s_waitcnt vmcnt(20)
  s_barrier
  s_add_u32 m0, s51, 0
  s_add_u32 s46, s66, 614400
  buffer_load_dwordx4 v8, s[4:7], s46 offen lds
  s_add_u32 m0, s51, 4096
  s_add_u32 s46, s66, 614528
  buffer_load_dwordx4 v8, s[4:7], s46 offen lds
  s_add_u32 m0, s51, 8192
  s_add_u32 s46, s66, 614656
  buffer_load_dwordx4 v8, s[4:7], s46 offen lds
  s_add_u32 m0, s51, 12288
  s_add_u32 s46, s66, 614784
  buffer_load_dwordx4 v8, s[4:7], s46 offen lds
  s_add_u32 m0, s51, 16384
  s_add_u32 s46, s66, 614912
  buffer_load_dwordx4 v8, s[4:7], s46 offen lds
  ds_read_b64_tr_b16 v[120:121], v9 offset:20480
  ds_read_b64_tr_b16 v[122:123], v9 offset:21504
  ds_read_b64_tr_b16 v[124:125], v9 offset:24576
  ds_read_b64_tr_b16 v[126:127], v9 offset:25600
  ds_read_b64_tr_b16 v[128:129], v9 offset:28672
  ds_read_b64_tr_b16 v[130:131], v9 offset:29696
  ds_read_b64_tr_b16 v[132:133], v9 offset:32768
  ds_read_b64_tr_b16 v[134:135], v9 offset:33792
  ds_read_b64_tr_b16 v[136:137], v9 offset:36864
  ds_read_b64_tr_b16 v[138:139], v9 offset:37888
  s_waitcnt lgkmcnt(0)
  v_mfma_f32_16x16x32_bf16 v[160:163], v[120:123], v[68:71], v[160:163]
  v_mfma_f32_16x16x32_bf16 v[164:167], v[124:127], v[68:71], v[164:167]
  v_mfma_f32_16x16x32_bf16 v[168:171], v[128:131], v[68:71], v[168:171]
  v_mfma_f32_16x16x32_bf16 v[172:175], v[132:135], v[68:71], v[172:175]
  v_mfma_f32_16x16x32_bf16 v[176:179], v[136:139], v[68:71], v[176:179]
  s_waitcnt vmcnt(20)
  s_barrier
  s_add_u32 m0, s51, 20480
  s_add_u32 s46, s66, 615040
  buffer_load_dwordx4 v8, s[4:7], s46 offen lds
  s_add_u32 m0, s51, 24576
  s_add_u32 s46, s66, 615168
  buffer_load_dwordx4 v8, s[4:7], s46 offen lds
  s_add_u32 m0, s51, 28672
  s_add_u32 s46, s66, 615296
  buffer_load_dwordx4 v8, s[4:7], s46 offen lds
  s_add_u32 m0, s51, 32768
  s_add_u32 s46, s66, 615424
  buffer_load_dwordx4 v8, s[4:7], s46 offen lds
  s_add_u32 m0, s51, 36864
  s_add_u32 s46, s66, 615552
  buffer_load_dwordx4 v8, s[4:7], s46 offen lds
  ds_read_b64_tr_b16 v[100:101], v9 offset:40960
  ds_read_b64_tr_b16 v[102:103], v9 offset:41984
  ds_read_b64_tr_b16 v[104:105], v9 offset:45056
  ds_read_b64_tr_b16 v[106:107], v9 offset:46080
  ds_read_b64_tr_b16 v[108:109], v9 offset:49152
  ds_read_b64_tr_b16 v[110:111], v9 offset:50176
  ds_read_b64_tr_b16 v[112:113], v9 offset:53248
  ds_read_b64_tr_b16 v[114:115], v9 offset:54272
  ds_read_b64_tr_b16 v[116:117], v9 offset:57344
  ds_read_b64_tr_b16 v[118:119], v9 offset:58368
  s_waitcnt lgkmcnt(0)
  v_mfma_f32_16x16x32_bf16 v[140:143], v[100:103], v[72:75], v[140:143]
  v_mfma_f32_16x16x32_bf16 v[144:147], v[104:107], v[72:75], v[144:147]
  v_mfma_f32_16x16x32_bf16 v[148:151], v[108:111], v[72:75], v[148:151]
  v_mfma_f32_16x16x32_bf16 v[152:155], v[112:115], v[72:75], v[152:155]
  v_mfma_f32_16x16x32_bf16 v[156:159], v[116:119], v[72:75], v[156:159]
  s_waitcnt vmcnt(20)
  s_barrier
  s_add_u32 m0, s51, 40960
  s_add_u32 s46, s66, 655360
  buffer_load_dwordx4 v8, s[4:7], s46 offen lds
  s_add_u32 m0, s51, 45056
  s_add_u32 s46, s66, 655488
  buffer_load_dwordx4 v8, s[4:7], s46 offen lds
  s_add_u32 m0, s51, 49152
  s_add_u32 s46, s66, 655616
  buffer_load_dwordx4 v8, s[4:7], s46 offen lds
  s_add_u32 m0, s51, 53248
  s_add_u32 s46, s66, 655744
  buffer_load_dwordx4 v8, s[4:7], s46 offen lds
  s_add_u32 m0, s51, 57344
  s_add_u32 s46, s66, 655872
  buffer_load_dwordx4 v8, s[4:7], s46 offen lds
  ds_read_b64_tr_b16 v[120:121], v9 offset:61440
  ds_read_b64_tr_b16 v[122:123], v9 offset:62464
  ds_read_b64_tr_b16 v[124:125], v10 offset:0
  ds_read_b64_tr_b16 v[126:127], v10 offset:1024
  ds_read_b64_tr_b16 v[128:129], v10 offset:4096
  ds_read_b64_tr_b16 v[130:131], v10 offset:5120
  ds_read_b64_tr_b16 v[132:133], v10 offset:8192
  ds_read_b64_tr_b16 v[134:135], v10 offset:9216
  ds_read_b64_tr_b16 v[136:137], v10 offset:12288
  ds_read_b64_tr_b16 v[138:139], v10 offset:13312
  s_waitcnt lgkmcnt(0)
  v_mfma_f32_16x16x32_bf16 v[160:163], v[120:123], v[72:75], v[160:163]
  v_mfma_f32_16x16x32_bf16 v[164:167], v[124:127], v[72:75], v[164:167]
  v_mfma_f32_16x16x32_bf16 v[168:171], v[128:131], v[72:75], v[168:171]
  v_mfma_f32_16x16x32_bf16 v[172:175], v[132:135], v[72:75], v[172:175]
  v_mfma_f32_16x16x32_bf16 v[176:179], v[136:139], v[72:75], v[176:179]
  s_waitcnt vmcnt(20)
  s_barrier
  s_add_u32 m0, s51, 61440
  s_add_u32 s46, s66, 656000
  buffer_load_dwordx4 v8, s[4:7], s46 offen lds
  s_add_u32 m0, s51, 65536
  s_add_u32 s46, s66, 656128
  buffer_load_dwordx4 v8, s[4:7], s46 offen lds
  s_add_u32 m0, s51, 69632
  s_add_u32 s46, s66, 656256
  buffer_load_dwordx4 v8, s[4:7], s46 offen lds
  s_add_u32 m0, s51, 73728
  s_add_u32 s46, s66, 656384
  buffer_load_dwordx4 v8, s[4:7], s46 offen lds
  s_add_u32 m0, s51, 77824
  s_add_u32 s46, s66, 656512
  buffer_load_dwordx4 v8, s[4:7], s46 offen lds
  ds_read_b64_tr_b16 v[100:101], v10 offset:16384
  ds_read_b64_tr_b16 v[102:103], v10 offset:17408
  ds_read_b64_tr_b16 v[104:105], v10 offset:20480
  ds_read_b64_tr_b16 v[106:107], v10 offset:21504
  ds_read_b64_tr_b16 v[108:109], v10 offset:24576
  ds_read_b64_tr_b16 v[110:111], v10 offset:25600
  ds_read_b64_tr_b16 v[112:113], v10 offset:28672
  ds_read_b64_tr_b16 v[114:115], v10 offset:29696
  ds_read_b64_tr_b16 v[116:117], v10 offset:32768
  ds_read_b64_tr_b16 v[118:119], v10 offset:33792
  s_waitcnt lgkmcnt(0)
  v_mfma_f32_16x16x32_bf16 v[140:143], v[100:103], v[76:79], v[140:143]
  v_mfma_f32_16x16x32_bf16 v[144:147], v[104:107], v[76:79], v[144:147]
  v_mfma_f32_16x16x32_bf16 v[148:151], v[108:111], v[76:79], v[148:151]
  v_mfma_f32_16x16x32_bf16 v[152:155], v[112:115], v[76:79], v[152:155]
  v_mfma_f32_16x16x32_bf16 v[156:159], v[116:119], v[76:79], v[156:159]
  s_waitcnt vmcnt(20)
  s_barrier
  s_add_u32 m0, s51, 81920
  s_add_u32 s46, s66, 696320
  buffer_load_dwordx4 v8, s[4:7], s46 offen lds
  s_add_u32 m0, s51, 86016
  s_add_u32 s46, s66, 696448
  buffer_load_dwordx4 v8, s[4:7], s46 offen lds
  s_add_u32 m0, s51, 90112
  s_add_u32 s46, s66, 696576
  buffer_load_dwordx4 v8, s[4:7], s46 offen lds
  s_add_u32 m0, s51, 94208
  s_add_u32 s46, s66, 696704
  buffer_load_dwordx4 v8, s[4:7], s46 offen lds
  s_add_u32 m0, s51, 98304
  s_add_u32 s46, s66, 696832
  buffer_load_dwordx4 v8, s[4:7], s46 offen lds
  ds_read_b64_tr_b16 v[120:121], v10 offset:36864
  ds_read_b64_tr_b16 v[122:123], v10 offset:37888
  ds_read_b64_tr_b16 v[124:125], v10 offset:40960
  ds_read_b64_tr_b16 v[126:127], v10 offset:41984
  ds_read_b64_tr_b16 v[128:129], v10 offset:45056
  ds_read_b64_tr_b16 v[130:131], v10 offset:46080
  ds_read_b64_tr_b16 v[132:133], v10 offset:49152
  ds_read_b64_tr_b16 v[134:135], v10 offset:50176
  ds_read_b64_tr_b16 v[136:137], v10 offset:53248
  ds_read_b64_tr_b16 v[138:139], v10 offset:54272
  s_waitcnt lgkmcnt(0)
  v_mfma_f32_16x16x32_bf16 v[160:163], v[120:123], v[76:79], v[160:163]
  v_mfma_f32_16x16x32_bf16 v[164:167], v[124:127], v[76:79], v[164:167]
  v_mfma_f32_16x16x32_bf16 v[168:171], v[128:131], v[76:79], v[168:171]
  v_mfma_f32_16x16x32_bf16 v[172:175], v[132:135], v[76:79], v[172:175]
  v_mfma_f32_16x16x32_bf16 v[176:179], v[136:139], v[76:79], v[176:179]
  s_waitcnt vmcnt(20)
  s_barrier
  s_add_u32 m0, s51, 102400
  s_add_u32 s46, s66, 696960
  buffer_load_dwordx4 v8, s[4:7], s46 offen lds
  s_add_u32 m0, s51, 106496
  s_add_u32 s46, s66, 697088
  buffer_load_dwordx4 v8, s[4:7], s46 offen lds
  s_add_u32 m0, s51, 110592
  s_add_u32 s46, s66, 697216
  buffer_load_dwordx4 v8, s[4:7], s46 offen lds
  s_add_u32 m0, s51, 114688
  s_add_u32 s46, s66, 697344
  buffer_load_dwordx4 v8, s[4:7], s46 offen lds
  s_add_u32 m0, s51, 118784
  s_add_u32 s46, s66, 697472
  buffer_load_dwordx4 v8, s[4:7], s46 offen lds
  ds_read_b64_tr_b16 v[100:101], v9 offset:0
  ds_read_b64_tr_b16 v[102:103], v9 offset:1024
  ds_read_b64_tr_b16 v[104:105], v9 offset:4096
  ds_read_b64_tr_b16 v[106:107], v9 offset:5120
  ds_read_b64_tr_b16 v[108:109], v9 offset:8192
  ds_read_b64_tr_b16 v[110:111], v9 offset:9216
  ds_read_b64_tr_b16 v[112:113], v9 offset:12288
  ds_read_b64_tr_b16 v[114:115], v9 offset:13312
  ds_read_b64_tr_b16 v[116:117], v9 offset:16384
  ds_read_b64_tr_b16 v[118:119], v9 offset:17408
  s_waitcnt lgkmcnt(0)
  v_mfma_f32_16x16x32_bf16 v[140:143], v[100:103], v[80:83], v[140:143]
  v_mfma_f32_16x16x32_bf16 v[144:147], v[104:107], v[80:83], v[144:147]
  v_mfma_f32_16x16x32_bf16 v[148:151], v[108:111], v[80:83], v[148:151]
  v_mfma_f32_16x16x32_bf16 v[152:155], v[112:115], v[80:83], v[152:155]
  v_mfma_f32_16x16x32_bf16 v[156:159], v[116:119], v[80:83], v[156:159]
  s_waitcnt vmcnt(20)
  s_barrier
  s_add_u32 m0, s51, 0
  s_add_u32 s46, s66, 737280
  buffer_load_dwordx4 v8, s[4:7], s46 offen lds
  s_add_u32 m0, s51, 4096
  s_add_u32 s46, s66, 737408
  buffer_load_dwordx4 v8, s[4:7], s46 offen lds
  s_add_u32 m0, s51, 8192
  s_add_u32 s46, s66, 737536
  buffer_load_dwordx4 v8, s[4:7], s46 offen lds
  s_add_u32 m0, s51, 12288
  s_add_u32 s46, s66, 737664
  buffer_load_dwordx4 v8, s[4:7], s46 offen lds
  s_add_u32 m0, s51, 16384
  s_add_u32 s46, s66, 737792
  buffer_load_dwordx4 v8, s[4:7], s46 offen lds
  ds_read_b64_tr_b16 v[120:121], v9 offset:20480
  ds_read_b64_tr_b16 v[122:123], v9 offset:21504
  ds_read_b64_tr_b16 v[124:125], v9 offset:24576
  ds_read_b64_tr_b16 v[126:127], v9 offset:25600
  ds_read_b64_tr_b16 v[128:129], v9 offset:28672
  ds_read_b64_tr_b16 v[130:131], v9 offset:29696
  ds_read_b64_tr_b16 v[132:133], v9 offset:32768
  ds_read_b64_tr_b16 v[134:135], v9 offset:33792
  ds_read_b64_tr_b16 v[136:137], v9 offset:36864
  ds_read_b64_tr_b16 v[138:139], v9 offset:37888
  s_waitcnt lgkmcnt(0)
  v_mfma_f32_16x16x32_bf16 v[160:163], v[120:123], v[80:83], v[160:163]
  v_mfma_f32_16x16x32_bf16 v[164:167], v[124:127], v[80:83], v[164:167]
  v_mfma_f32_16x16x32_bf16 v[168:171], v[128:131], v[80:83], v[168:171]
  v_mfma_f32_16x16x32_bf16 v[172:175], v[132:135], v[80:83], v[172:175]
  v_mfma_f32_16x16x32_bf16 v[176:179], v[136:139], v[80:83], v[176:179]
  s_waitcnt vmcnt(20)
  s_barrier
  s_add_u32 m0, s51, 20480
  s_add_u32 s46, s66, 737920
  buffer_load_dwordx4 v8, s[4:7], s46 offen lds
  s_add_u32 m0, s51, 24576
  s_add_u32 s46, s66, 738048
  buffer_load_dwordx4 v8, s[4:7], s46 offen lds
  s_add_u32 m0, s51, 28672
  s_add_u32 s46, s66, 738176
  buffer_load_dwordx4 v8, s[4:7], s46 offen lds
  s_add_u32 m0, s51, 32768
  s_add_u32 s46, s66, 738304
  buffer_load_dwordx4 v8, s[4:7], s46 offen lds
  s_add_u32 m0, s51, 36864
  s_add_u32 s46, s66, 738432
  buffer_load_dwordx4 v8, s[4:7], s46 offen lds
  ds_read_b64_tr_b16 v[100:101], v9 offset:40960
  ds_read_b64_tr_b16 v[102:103], v9 offset:41984
  ds_read_b64_tr_b16 v[104:105], v9 offset:45056
  ds_read_b64_tr_b16 v[106:107], v9 offset:46080
  ds_read_b64_tr_b16 v[108:109], v9 offset:49152
  ds_read_b64_tr_b16 v[110:111], v9 offset:50176
  ds_read_b64_tr_b16 v[112:113], v9 offset:53248
  ds_read_b64_tr_b16 v[114:115], v9 offset:54272
  ds_read_b64_tr_b16 v[116:117], v9 offset:57344
  ds_read_b64_tr_b16 v[118:119], v9 offset:58368
  s_waitcnt lgkmcnt(0)
  v_mfma_f32_16x16x32_bf16 v[140:143], v[100:103], v[84:87], v[140:143]
  v_mfma_f32_16x16x32_bf16 v[144:147], v[104:107], v[84:87], v[144:147]
  v_mfma_f32_16x16x32_bf16 v[148:151], v[108:111], v[84:87], v[148:151]
  v_mfma_f32_16x16x32_bf16 v[152:155], v[112:115], v[84:87], v[152:155]
  v_mfma_f32_16x16x32_bf16 v[156:159], v[116:119], v[84:87], v[156:159]
  s_waitcnt vmcnt(20)
  s_barrier
  s_add_u32 m0, s51, 40960
  s_add_u32 s46, s66, 778240
  buffer_load_dwordx4 v8, s[4:7], s46 offen lds
  s_add_u32 m0, s51, 45056
  s_add_u32 s46, s66, 778368
  buffer_load_dwordx4 v8, s[4:7], s46 offen lds
  s_add_u32 m0, s51, 49152
  s_add_u32 s46, s66, 778496
  buffer_load_dwordx4 v8, s[4:7], s46 offen lds
  s_add_u32 m0, s51, 53248
  s_add_u32 s46, s66, 778624
  buffer_load_dwordx4 v8, s[4:7], s46 offen lds
  s_add_u32 m0, s51, 57344
  s_add_u32 s46, s66, 778752
  buffer_load_dwordx4 v8, s[4:7], s46 offen lds
  ds_read_b64_tr_b16 v[120:121], v9 offset:61440
  ds_read_b64_tr_b16 v[122:123], v9 offset:62464
  ds_read_b64_tr_b16 v[124:125], v10 offset:0
  ds_read_b64_tr_b16 v[126:127], v10 offset:1024
  ds_read_b64_tr_b16 v[128:129], v10 offset:4096
  ds_read_b64_tr_b16 v[130:131], v10 offset:5120
  ds_read_b64_tr_b16 v[132:133], v10 offset:8192
  ds_read_b64_tr_b16 v[134:135], v10 offset:9216
  ds_read_b64_tr_b16 v[136:137], v10 offset:12288
  ds_read_b64_tr_b16 v[138:139], v10 offset:13312
  s_waitcnt lgkmcnt(0)
  v_mfma_f32_16x16x32_bf16 v[160:163], v[120:123], v[84:87], v[160:163]
  v_mfma_f32_16x16x32_bf16 v[164:167], v[124:127], v[84:87], v[164:167]
  v_mfma_f32_16x16x32_bf16 v[168:171], v[128:131], v[84:87], v[168:171]
  v_mfma_f32_16x16x32_bf16 v[172:175], v[132:135], v[84:87], v[172:175]
  v_mfma_f32_16x16x32_bf16 v[176:179], v[136:139], v[84:87], v[176:179]
  s_waitcnt vmcnt(20)
  s_barrier
  s_add_u32 m0, s51, 61440
  s_add_u32 s46, s66, 778880
  buffer_load_dwordx4 v8, s[4:7], s46 offen lds
  s_add_u32 m0, s51, 65536
  s_add_u32 s46, s66, 779008
  buffer_load_dwordx4 v8, s[4:7], s46 offen lds
  s_add_u32 m0, s51, 69632
  s_add_u32 s46, s66, 779136
  buffer_load_dwordx4 v8, s[4:7], s46 offen lds
  s_add_u32 m0, s51, 73728
  s_add_u32 s46, s66, 779264
  buffer_load_dwordx4 v8, s[4:7], s46 offen lds
  s_add_u32 m0, s51, 77824
  s_add_u32 s46, s66, 779392
  buffer_load_dwordx4 v8, s[4:7], s46 offen lds
  ds_read_b64_tr_b16 v[100:101], v10 offset:16384
  ds_read_b64_tr_b16 v[102:103], v10 offset:17408
  ds_read_b64_tr_b16 v[104:105], v10 offset:20480
  ds_read_b64_tr_b16 v[106:107], v10 offset:21504
  ds_read_b64_tr_b16 v[108:109], v10 offset:24576
  ds_read_b64_tr_b16 v[110:111], v10 offset:25600
  ds_read_b64_tr_b16 v[112:113], v10 offset:28672
  ds_read_b64_tr_b16 v[114:115], v10 offset:29696
  ds_read_b64_tr_b16 v[116:117], v10 offset:32768
  ds_read_b64_tr_b16 v[118:119], v10 offset:33792
  s_waitcnt lgkmcnt(0)
  v_mfma_f32_16x16x32_bf16 v[140:143], v[100:103], v[88:91], v[140:143]
  v_mfma_f32_16x16x32_bf16 v[144:147], v[104:107], v[88:91], v[144:147]
  v_mfma_f32_16x16x32_bf16 v[148:151], v[108:111], v[88:91], v[148:151]
  v_mfma_f32_16x16x32_bf16 v[152:155], v[112:115], v[88:91], v[152:155]
  v_mfma_f32_16x16x32_bf16 v[156:159], v[116:119], v[88:91], v[156:159]
  s_waitcnt vmcnt(20)
  s_barrier
  ds_read_b64_tr_b16 v[120:121], v10 offset:36864
  ds_read_b64_tr_b16 v[122:123], v10 offset:37888
  ds_read_b64_tr_b16 v[124:125], v10 offset:40960
  ds_read_b64_tr_b16 v[126:127], v10 offset:41984
  ds_read_b64_tr_b16 v[128:129], v10 offset:45056
  ds_read_b64_tr_b16 v[130:131], v10 offset:46080
  ds_read_b64_tr_b16 v[132:133], v10 offset:49152
  ds_read_b64_tr_b16 v[134:135], v10 offset:50176
  ds_read_b64_tr_b16 v[136:137], v10 offset:53248
  ds_read_b64_tr_b16 v[138:139], v10 offset:54272
  s_waitcnt lgkmcnt(0)
  v_mfma_f32_16x16x32_bf16 v[160:163], v[120:123], v[88:91], v[160:163]
  v_mfma_f32_16x16x32_bf16 v[164:167], v[124:127], v[88:91], v[164:167]
  v_mfma_f32_16x16x32_bf16 v[168:171], v[128:131], v[88:91], v[168:171]
  v_mfma_f32_16x16x32_bf16 v[172:175], v[132:135], v[88:91], v[172:175]
  v_mfma_f32_16x16x32_bf16 v[176:179], v[136:139], v[88:91], v[176:179]
  s_waitcnt vmcnt(15)
  s_barrier
  ds_read_b64_tr_b16 v[100:101], v9 offset:0
  ds_read_b64_tr_b16 v[102:103], v9 offset:1024
  ds_read_b64_tr_b16 v[104:105], v9 offset:4096
  ds_read_b64_tr_b16 v[106:107], v9 offset:5120
  ds_read_b64_tr_b16 v[108:109], v9 offset:8192
  ds_read_b64_tr_b16 v[110:111], v9 offset:9216
  ds_read_b64_tr_b16 v[112:113], v9 offset:12288
  ds_read_b64_tr_b16 v[114:115], v9 offset:13312
  ds_read_b64_tr_b16 v[116:117], v9 offset:16384
  ds_read_b64_tr_b16 v[118:119], v9 offset:17408
  s_waitcnt lgkmcnt(0)
  v_mfma_f32_16x16x32_bf16 v[140:143], v[100:103], v[92:95], v[140:143]
  v_mfma_f32_16x16x32_bf16 v[144:147], v[104:107], v[92:95], v[144:147]
  v_mfma_f32_16x16x32_bf16 v[148:151], v[108:111], v[92:95], v[148:151]
  v_mfma_f32_16x16x32_bf16 v[152:155], v[112:115], v[92:95], v[152:155]
  v_mfma_f32_16x16x32_bf16 v[156:159], v[116:119], v[92:95], v[156:159]
  s_waitcnt vmcnt(10)
  s_barrier
  ds_read_b64_tr_b16 v[120:121], v9 offset:20480
  ds_read_b64_tr_b16 v[122:123], v9 offset:21504
  ds_read_b64_tr_b16 v[124:125], v9 offset:24576
  ds_read_b64_tr_b16 v[126:127], v9 offset:25600
  ds_read_b64_tr_b16 v[128:129], v9 offset:28672
  ds_read_b64_tr_b16 v[130:131], v9 offset:29696
  ds_read_b64_tr_b16 v[132:133], v9 offset:32768
  ds_read_b64_tr_b16 v[134:135], v9 offset:33792
  ds_read_b64_tr_b16 v[136:137], v9 offset:36864
  ds_read_b64_tr_b16 v[138:139], v9 offset:37888
  s_waitcnt lgkmcnt(0)
  v_mfma_f32_16x16x32_bf16 v[160:163], v[120:123], v[92:95], v[160:163]
  v_mfma_f32_16x16x32_bf16 v[164:167], v[124:127], v[92:95], v[164:167]
  v_mfma_f32_16x16x32_bf16 v[168:171], v[128:131], v[92:95], v[168:171]
  v_mfma_f32_16x16x32_bf16 v[172:175], v[132:135], v[92:95], v[172:175]
  v_mfma_f32_16x16x32_bf16 v[176:179], v[136:139], v[92:95], v[176:179]
  s_waitcnt vmcnt(5)
  s_barrier
  ds_read_b64_tr_b16 v[100:101], v9 offset:40960
  ds_read_b64_tr_b16 v[102:103], v9 offset:41984
  ds_read_b64_tr_b16 v[104:105], v9 offset:45056
  ds_read_b64_tr_b16 v[106:107], v9 offset:46080
  ds_read_b64_tr_b16 v[108:109], v9 offset:49152
  ds_read_b64_tr_b16 v[110:111], v9 offset:50176
  ds_read_b64_tr_b16 v[112:113], v9 offset:53248
  ds_read_b64_tr_b16 v[114:115], v9 offset:54272
  ds_read_b64_tr_b16 v[116:117], v9 offset:57344
  ds_read_b64_tr_b16 v[118:119], v9 offset:58368
  s_waitcnt lgkmcnt(0)
  v_mfma_f32_16x16x32_bf16 v[140:143], v[100:103], v[96:99], v[140:143]
  v_mfma_f32_16x16x32_bf16 v[144:147], v[104:107], v[96:99], v[144:147]
  v_mfma_f32_16x16x32_bf16 v[148:151], v[108:111], v[96:99], v[148:151]
  v_mfma_f32_16x16x32_bf16 v[152:155], v[112:115], v[96:99], v[152:155]
  v_mfma_f32_16x16x32_bf16 v[156:159], v[116:119], v[96:99], v[156:159]
  s_waitcnt vmcnt(0)
  s_barrier
  ds_read_b64_tr_b16 v[120:121], v9 offset:61440
  ds_read_b64_tr_b16 v[122:123], v9 offset:62464
  ds_read_b64_tr_b16 v[124:125], v10 offset:0
  ds_read_b64_tr_b16 v[126:127], v10 offset:1024
  ds_read_b64_tr_b16 v[128:129], v10 offset:4096
  ds_read_b64_tr_b16 v[130:131], v10 offset:5120
  ds_read_b64_tr_b16 v[132:133], v10 offset:8192
  ds_read_b64_tr_b16 v[134:135], v10 offset:9216
  ds_read_b64_tr_b16 v[136:137], v10 offset:12288
  ds_read_b64_tr_b16 v[138:139], v10 offset:13312
  s_waitcnt lgkmcnt(0)
  v_mfma_f32_16x16x32_bf16 v[160:163], v[120:123], v[96:99], v[160:163]
  v_mfma_f32_16x16x32_bf16 v[164:167], v[124:127], v[96:99], v[164:167]
  v_mfma_f32_16x16x32_bf16 v[168:171], v[128:131], v[96:99], v[168:171]
  v_mfma_f32_16x16x32_bf16 v[172:175], v[132:135], v[96:99], v[172:175]
  v_mfma_f32_16x16x32_bf16 v[176:179], v[136:139], v[96:99], v[176:179]
  s_barrier
  v_cvt_pk_bf16_f32 v140, v140, v141
  v_cvt_pk_bf16_f32 v141, v142, v143
  buffer_store_dwordx2 v[140:141], v12, s[12:15], 0 offen offset:0
  v_cvt_pk_bf16_f32 v144, v144, v145
  v_cvt_pk_bf16_f32 v145, v146, v147
  buffer_store_dwordx2 v[144:145], v12, s[12:15], 0 offen offset:128
  v_cvt_pk_bf16_f32 v148, v148, v149
  v_cvt_pk_bf16_f32 v149, v150, v151
  buffer_store_dwordx2 v[148:149], v12, s[12:15], 0 offen offset:256
  v_cvt_pk_bf16_f32 v152, v152, v153
  v_cvt_pk_bf16_f32 v153, v154, v155
  buffer_store_dwordx2 v[152:153], v12, s[12:15], 0 offen offset:384
  v_cvt_pk_bf16_f32 v156, v156, v157
  v_cvt_pk_bf16_f32 v157, v158, v159
  buffer_store_dwordx2 v[156:157], v12, s[12:15], 0 offen offset:512
  v_cvt_pk_bf16_f32 v160, v160, v161
  v_cvt_pk_bf16_f32 v161, v162, v163
  buffer_store_dwordx2 v[160:161], v12, s[12:15], 0 offen offset:640
  v_cvt_pk_bf16_f32 v164, v164, v165
  v_cvt_pk_bf16_f32 v165, v166, v167
  buffer_store_dwordx2 v[164:165], v12, s[12:15], 0 offen offset:768
  v_cvt_pk_bf16_f32 v168, v168, v169
  v_cvt_pk_bf16_f32 v169, v170, v171
  buffer_store_dwordx2 v[168:169], v12, s[12:15], 0 offen offset:896
  v_cvt_pk_bf16_f32 v172, v172, v173
  v_cvt_pk_bf16_f32 v173, v174, v175
  buffer_store_dwordx2 v[172:173], v12, s[12:15], 0 offen offset:1024
  v_cvt_pk_bf16_f32 v176, v176, v177
  v_cvt_pk_bf16_f32 v177, v178, v179
  buffer_store_dwordx2 v[176:177], v12, s[12:15], 0 offen offset:1152
  s_endpgm
L_recur:
  s_cmp_lt_u32 s44, 8
  s_cbranch_scc1 L_score
  s_cmp_lt_u32 s44, 16
  s_cbranch_scc1 L_value
  v_and_b32 v3, 3, v0
  v_lshlrev_b32 v3, 2, v3
  s_mov_b32 s50, 0
ss_13:
  global_load_dword v2, v3, s[38:39] sc1
  s_add_u32 s50, s50, 1
  s_cmp_gt_u32 s50, 131072
  s_cbranch_scc1 L_fail
  s_waitcnt vmcnt(0)
  v_readlane_b32 s46, v2, 0
  v_readlane_b32 s47, v2, 0
  s_cmp_lg_u32 s46, 0
  s_cselect_b32 s48, 7, 0
  s_add_u32 s46, s46, s2
  s_xor_b32 s49, s46, s43
  s_and_b32 s49, s49, s48
  s_cbranch_scc1 L_reroll
  s_cmp_lg_u32 s47, 0
  s_cbranch_scc1 ss_ok_14
  s_sleep 10
  s_branch ss_13
ss_ok_14:
  s_cmp_lt_u32 s42, 2
  s_cbranch_scc1 rc_nowarm
  s_lshl_b32 s46, s44, 2
  s_add_u32 s46, s46, s43
  s_lshl_b32 s46, s46, 1
  s_add_u32 s46, s46, s42
  s_sub_u32 s46, s46, 130
  s_mul_i32 s46, s46, 20480
  v_lshlrev_b32 v1, 7, v0
  s_add_u32 s47, s46, 0
  buffer_load_dword v2, v1, s[12:15], s47 offen
  s_add_u32 s47, s46, 8192
  buffer_load_dword v2, v1, s[12:15], s47 offen
  s_add_u32 s47, s46, 12288
  buffer_load_dword v2, v1, s[12:15], s47 offen
  s_waitcnt vmcnt(0)
rc_nowarm:
  s_cmp_lt_u32 s44, 26
  s_cbranch_scc1 L_owner
  s_branch L_xowner
L_score:
  s_mov_b32 s4, s26
  s_mov_b32 s5, s27
  s_mov_b32 s6, 7864320
  s_mov_b32 s7, 0x20000
  s_mov_b32 s12, s28
  s_mov_b32 s13, s29
  s_mov_b32 s14, 7864320
  s_mov_b32 s15, 0x20000
  v_lshrrev_b32 v136, 3, v0
  v_lshrrev_b32 v137, 2, v136
  v_lshlrev_b32 v137, 3, v137
  v_and_b32 v64, 3, v136
  v_add_u32 v64, v64, v137
  s_and_b32 s46, s42, 1
  s_lshl_b32 s46, s46, 2
  s_lshr_b32 s47, s42, 1
  s_lshl_b32 s47, s47, 4
  s_add_u32 s46, s46, s47
  v_add_u32 v64, s46, v64
  v_mul_u32_u24 v64, 12288, v64
  v_lshrrev_b32 v136, 1, v136
  v_bfe_u32 v137, v0, 1, 2
  v_xor_b32 v136, v136, v137
  v_lshlrev_b32 v136, 5, v136
  v_and_b32 v137, 1, v0
  v_lshlrev_b32 v137, 4, v137
  v_add3_u32 v64, v64, v136, v137
  v_lshrrev_b32 v136, 5, v0
  v_lshlrev_b32 v65, 11, v136
  v_bfe_u32 v136, v0, 2, 3
  v_lshl_add_u32 v65, v136, 7, v65
  v_lshrrev_b32 v136, 1, v136
  v_xor_b32 v136, s42, v136
  v_lshl_add_u32 v65, v136, 5, v65
  v_and_b32 v136, 3, v0
  v_lshl_add_u32 v65, v136, 3, v65
  v_add_u32 v66, 0x10000, v65
  v_add_u32 v67, 0x20000, v65
  v_lshlrev_b32 v1, 4, v0
  v_add_u32 v2, s51, v1
  v_add_u32 v3, 0x10000, v2
  s_mul_i32 s62, s45, 384
  s_mov_b32 s24, 4096
  s_mov_b32 s25, 49152
  s_add_u32 m0, s51, 73728
  s_add_u32 s46, s62, 0
  buffer_load_dwordx4 v64, s[12:15], s46 offen lds
  s_add_u32 m0, s51, 77824
  s_add_u32 s46, s62, 393216
  buffer_load_dwordx4 v64, s[12:15], s46 offen lds
  s_add_u32 m0, s51, 81920
  s_add_u32 s46, s62, 128
  buffer_load_dwordx4 v64, s[12:15], s46 offen lds
  s_add_u32 m0, s51, 86016
  s_add_u32 s46, s62, 393344
  buffer_load_dwordx4 v64, s[12:15], s46 offen lds
  s_add_u32 m0, s51, 90112
  s_add_u32 s46, s62, 256
  buffer_load_dwordx4 v64, s[12:15], s46 offen lds
  s_add_u32 m0, s51, 94208
  s_add_u32 s46, s62, 393472
  buffer_load_dwordx4 v64, s[12:15], s46 offen lds
  s_add_u32 m0, s51, 98304
  s_add_u32 s46, s62, 786432
  buffer_load_dwordx4 v64, s[12:15], s46 offen lds
  s_add_u32 m0, s51, 102400
  s_add_u32 s46, s62, 1179648
  buffer_load_dwordx4 v64, s[12:15], s46 offen lds
  s_add_u32 m0, s51, 106496
  s_add_u32 s46, s62, 786560
  buffer_load_dwordx4 v64, s[12:15], s46 offen lds
  s_add_u32 m0, s51, 110592
  s_add_u32 s46, s62, 1179776
  buffer_load_dwordx4 v64, s[12:15], s46 offen lds
  s_add_u32 m0, s51, 114688
  s_add_u32 s46, s62, 786688
  buffer_load_dwordx4 v64, s[12:15], s46 offen lds
  s_add_u32 m0, s51, 118784
  s_add_u32 s46, s62, 1179904
  buffer_load_dwordx4 v64, s[12:15], s46 offen lds
  s_add_u32 m0, s51, 122880
  s_add_u32 s46, s62, 1572864
  buffer_load_dwordx4 v64, s[12:15], s46 offen lds
  s_add_u32 m0, s51, 126976
  s_add_u32 s46, s62, 1966080
  buffer_load_dwordx4 v64, s[12:15], s46 offen lds
  s_add_u32 m0, s51, 131072
  s_add_u32 s46, s62, 1572992
  buffer_load_dwordx4 v64, s[12:15], s46 offen lds
  s_add_u32 m0, s51, 135168
  s_add_u32 s46, s62, 1966208
  buffer_load_dwordx4 v64, s[12:15], s46 offen lds
  s_add_u32 m0, s51, 139264
  s_add_u32 s46, s62, 1573120
  buffer_load_dwordx4 v64, s[12:15], s46 offen lds
  s_add_u32 m0, s51, 143360
  s_add_u32 s46, s62, 1966336
  buffer_load_dwordx4 v64, s[12:15], s46 offen lds
  s_add_u32 m0, s51, 0
  s_add_u32 s46, s62, 2359296
  buffer_load_dwordx4 v64, s[12:15], s46 offen lds
  s_add_u32 m0, s51, 4096
  s_add_u32 s46, s62, 2752512
  buffer_load_dwordx4 v64, s[12:15], s46 offen lds
  s_add_u32 m0, s51, 8192
  s_add_u32 s46, s62, 2359424
  buffer_load_dwordx4 v64, s[12:15], s46 offen lds
  s_add_u32 m0, s51, 12288
  s_add_u32 s46, s62, 2752640
  buffer_load_dwordx4 v64, s[12:15], s46 offen lds
  s_add_u32 m0, s51, 16384
  s_add_u32 s46, s62, 2359552
  buffer_load_dwordx4 v64, s[12:15], s46 offen lds
  s_add_u32 m0, s51, 20480
  s_add_u32 s46, s62, 2752768
  buffer_load_dwordx4 v64, s[12:15], s46 offen lds
  s_add_u32 m0, s51, 24576
  s_add_u32 s46, s62, 3932160
  buffer_load_dwordx4 v64, s[12:15], s46 offen lds
  s_add_u32 m0, s51, 28672
  s_add_u32 s46, s62, 4325376
  buffer_load_dwordx4 v64, s[12:15], s46 offen lds
  s_add_u32 m0, s51, 32768
  s_add_u32 s46, s62, 3932288
  buffer_load_dwordx4 v64, s[12:15], s46 offen lds
  s_add_u32 m0, s51, 36864
  s_add_u32 s46, s62, 4325504
  buffer_load_dwordx4 v64, s[12:15], s46 offen lds
  s_add_u32 m0, s51, 40960
  s_add_u32 s46, s62, 3932416
  buffer_load_dwordx4 v64, s[12:15], s46 offen lds
  s_add_u32 m0, s51, 45056
  s_add_u32 s46, s62, 4325632
  buffer_load_dwordx4 v64, s[12:15], s46 offen lds
  s_waitcnt vmcnt(24)
  s_barrier
  s_add_u32 m0, s51, 49152
  s_add_u32 s46, s62, 4718592
  buffer_load_dwordx4 v64, s[12:15], s46 offen lds
  s_add_u32 m0, s51, 53248
  s_add_u32 s46, s62, 5111808
  buffer_load_dwordx4 v64, s[12:15], s46 offen lds
  s_add_u32 m0, s51, 57344
  s_add_u32 s46, s62, 4718720
  buffer_load_dwordx4 v64, s[12:15], s46 offen lds
  s_add_u32 m0, s51, 61440
  s_add_u32 s46, s62, 5111936
  buffer_load_dwordx4 v64, s[12:15], s46 offen lds
  s_add_u32 m0, s51, 65536
  s_add_u32 s46, s62, 4718848
  buffer_load_dwordx4 v64, s[12:15], s46 offen lds
  s_add_u32 m0, s51, 69632
  s_add_u32 s46, s62, 5112064
  buffer_load_dwordx4 v64, s[12:15], s46 offen lds
  ds_read_b64_tr_b16 a[0:1], v66 offset:8192
  ds_read_b64_tr_b16 a[2:3], v66 offset:9216
  ds_read_b64_tr_b16 a[4:5], v66 offset:12288
  ds_read_b64_tr_b16 a[6:7], v66 offset:13312
  ds_read_b64_tr_b16 a[8:9], v66 offset:16384
  ds_read_b64_tr_b16 a[10:11], v66 offset:17408
  ds_read_b64_tr_b16 a[12:13], v66 offset:20480
  ds_read_b64_tr_b16 a[14:15], v66 offset:21504
  ds_read_b64_tr_b16 a[16:17], v66 offset:24576
  ds_read_b64_tr_b16 a[18:19], v66 offset:25600
  ds_read_b64_tr_b16 a[20:21], v66 offset:28672
  ds_read_b64_tr_b16 a[22:23], v66 offset:29696
  s_waitcnt lgkmcnt(0)
  s_waitcnt vmcnt(24)
  s_barrier
  s_add_u32 m0, s51, 73728
  s_add_u32 s46, s62, 6291456
  buffer_load_dwordx4 v64, s[12:15], s46 offen lds
  s_add_u32 m0, s51, 77824
  s_add_u32 s46, s62, 6684672
  buffer_load_dwordx4 v64, s[12:15], s46 offen lds
  s_add_u32 m0, s51, 81920
  s_add_u32 s46, s62, 6291584
  buffer_load_dwordx4 v64, s[12:15], s46 offen lds
  s_add_u32 m0, s51, 86016
  s_add_u32 s46, s62, 6684800
  buffer_load_dwordx4 v64, s[12:15], s46 offen lds
  s_add_u32 m0, s51, 90112
  s_add_u32 s46, s62, 6291712
  buffer_load_dwordx4 v64, s[12:15], s46 offen lds
  s_add_u32 m0, s51, 94208
  s_add_u32 s46, s62, 6684928
  buffer_load_dwordx4 v64, s[12:15], s46 offen lds
  ds_read_b64_tr_b16 a[24:25], v66 offset:32768
  ds_read_b64_tr_b16 a[26:27], v66 offset:33792
  ds_read_b64_tr_b16 a[28:29], v66 offset:36864
  ds_read_b64_tr_b16 a[30:31], v66 offset:37888
  ds_read_b64_tr_b16 a[32:33], v66 offset:40960
  ds_read_b64_tr_b16 a[34:35], v66 offset:41984
  ds_read_b64_tr_b16 a[36:37], v66 offset:45056
  ds_read_b64_tr_b16 a[38:39], v66 offset:46080
  ds_read_b64_tr_b16 a[40:41], v66 offset:49152
  ds_read_b64_tr_b16 a[42:43], v66 offset:50176
  ds_read_b64_tr_b16 a[44:45], v66 offset:53248
  ds_read_b64_tr_b16 a[46:47], v66 offset:54272
  s_waitcnt lgkmcnt(0)
  s_waitcnt vmcnt(24)
  s_barrier
  s_add_u32 m0, s51, 98304
  s_add_u32 s46, s62, 7077888
  buffer_load_dwordx4 v64, s[12:15], s46 offen lds
  s_add_u32 m0, s51, 102400
  s_add_u32 s46, s62, 7471104
  buffer_load_dwordx4 v64, s[12:15], s46 offen lds
  s_add_u32 m0, s51, 106496
  s_add_u32 s46, s62, 7078016
  buffer_load_dwordx4 v64, s[12:15], s46 offen lds
  s_add_u32 m0, s51, 110592
  s_add_u32 s46, s62, 7471232
  buffer_load_dwordx4 v64, s[12:15], s46 offen lds
  s_add_u32 m0, s51, 114688
  s_add_u32 s46, s62, 7078144
  buffer_load_dwordx4 v64, s[12:15], s46 offen lds
  s_add_u32 m0, s51, 118784
  s_add_u32 s46, s62, 7471360
  buffer_load_dwordx4 v64, s[12:15], s46 offen lds
  ds_read_b64_tr_b16 a[48:49], v66 offset:57344
  ds_read_b64_tr_b16 a[50:51], v66 offset:58368
  ds_read_b64_tr_b16 a[52:53], v66 offset:61440
  ds_read_b64_tr_b16 a[54:55], v66 offset:62464
  ds_read_b64_tr_b16 a[56:57], v67 offset:0
  ds_read_b64_tr_b16 a[58:59], v67 offset:1024
  ds_read_b64_tr_b16 a[60:61], v67 offset:4096
  ds_read_b64_tr_b16 a[62:63], v67 offset:5120
  ds_read_b64_tr_b16 a[64:65], v67 offset:8192
  ds_read_b64_tr_b16 a[66:67], v67 offset:9216
  ds_read_b64_tr_b16 a[68:69], v67 offset:12288
  ds_read_b64_tr_b16 a[70:71], v67 offset:13312
  s_waitcnt lgkmcnt(0)
  s_waitcnt vmcnt(24)
  s_barrier
  s_add_u32 m0, s51, 122880
  s_add_u32 s46, s62, 0
  buffer_load_dwordx4 v64, s[4:7], s46 offen lds
  s_add_u32 m0, s51, 126976
  s_add_u32 s46, s62, 393216
  buffer_load_dwordx4 v64, s[4:7], s46 offen lds
  s_add_u32 m0, s51, 131072
  s_add_u32 s46, s62, 128
  buffer_load_dwordx4 v64, s[4:7], s46 offen lds
  s_add_u32 m0, s51, 135168
  s_add_u32 s46, s62, 393344
  buffer_load_dwordx4 v64, s[4:7], s46 offen lds
  s_add_u32 m0, s51, 139264
  s_add_u32 s46, s62, 256
  buffer_load_dwordx4 v64, s[4:7], s46 offen lds
  s_add_u32 m0, s51, 143360
  s_add_u32 s46, s62, 393472
  buffer_load_dwordx4 v64, s[4:7], s46 offen lds
  ds_read_b64_tr_b16 a[72:73], v65 offset:0
  ds_read_b64_tr_b16 a[74:75], v65 offset:1024
  ds_read_b64_tr_b16 a[76:77], v65 offset:4096
  ds_read_b64_tr_b16 a[78:79], v65 offset:5120
  ds_read_b64_tr_b16 a[80:81], v65 offset:8192
  ds_read_b64_tr_b16 a[82:83], v65 offset:9216
  ds_read_b64_tr_b16 a[84:85], v65 offset:12288
  ds_read_b64_tr_b16 a[86:87], v65 offset:13312
  ds_read_b64_tr_b16 a[88:89], v65 offset:16384
  ds_read_b64_tr_b16 a[90:91], v65 offset:17408
  ds_read_b64_tr_b16 a[92:93], v65 offset:20480
  ds_read_b64_tr_b16 a[94:95], v65 offset:21504
  s_waitcnt lgkmcnt(0)
  s_waitcnt vmcnt(24)
  s_barrier
  s_add_u32 m0, s51, 0
  s_add_u32 s46, s62, 786432
  buffer_load_dwordx4 v64, s[4:7], s46 offen lds
  s_add_u32 m0, s51, 4096
  s_add_u32 s46, s62, 1179648
  buffer_load_dwordx4 v64, s[4:7], s46 offen lds
  s_add_u32 m0, s51, 8192
  s_add_u32 s46, s62, 786560
  buffer_load_dwordx4 v64, s[4:7], s46 offen lds
  s_add_u32 m0, s51, 12288
  s_add_u32 s46, s62, 1179776
  buffer_load_dwordx4 v64, s[4:7], s46 offen lds
  s_add_u32 m0, s51, 16384
  s_add_u32 s46, s62, 786688
  buffer_load_dwordx4 v64, s[4:7], s46 offen lds
  s_add_u32 m0, s51, 20480
  s_add_u32 s46, s62, 1179904
  buffer_load_dwordx4 v64, s[4:7], s46 offen lds
  ds_read_b64_tr_b16 a[96:97], v65 offset:24576
  ds_read_b64_tr_b16 a[98:99], v65 offset:25600
  ds_read_b64_tr_b16 a[100:101], v65 offset:28672
  ds_read_b64_tr_b16 a[102:103], v65 offset:29696
  ds_read_b64_tr_b16 a[104:105], v65 offset:32768
  ds_read_b64_tr_b16 a[106:107], v65 offset:33792
  ds_read_b64_tr_b16 a[108:109], v65 offset:36864
  ds_read_b64_tr_b16 a[110:111], v65 offset:37888
  ds_read_b64_tr_b16 a[112:113], v65 offset:40960
  ds_read_b64_tr_b16 a[114:115], v65 offset:41984
  ds_read_b64_tr_b16 a[116:117], v65 offset:45056
  ds_read_b64_tr_b16 a[118:119], v65 offset:46080
  s_waitcnt lgkmcnt(0)
  s_waitcnt vmcnt(24)
  s_barrier
  s_add_u32 m0, s51, 24576
  s_add_u32 s46, s62, 2359296
  buffer_load_dwordx4 v64, s[4:7], s46 offen lds
  s_add_u32 m0, s51, 28672
  s_add_u32 s46, s62, 2752512
  buffer_load_dwordx4 v64, s[4:7], s46 offen lds
  s_add_u32 m0, s51, 32768
  s_add_u32 s46, s62, 2359424
  buffer_load_dwordx4 v64, s[4:7], s46 offen lds
  s_add_u32 m0, s51, 36864
  s_add_u32 s46, s62, 2752640
  buffer_load_dwordx4 v64, s[4:7], s46 offen lds
  s_add_u32 m0, s51, 40960
  s_add_u32 s46, s62, 2359552
  buffer_load_dwordx4 v64, s[4:7], s46 offen lds
  s_add_u32 m0, s51, 45056
  s_add_u32 s46, s62, 2752768
  buffer_load_dwordx4 v64, s[4:7], s46 offen lds
  ds_read_b64_tr_b16 a[120:121], v65 offset:49152
  ds_read_b64_tr_b16 a[122:123], v65 offset:50176
  ds_read_b64_tr_b16 a[124:125], v65 offset:53248
  ds_read_b64_tr_b16 a[126:127], v65 offset:54272
  ds_read_b64_tr_b16 a[128:129], v65 offset:57344
  ds_read_b64_tr_b16 a[130:131], v65 offset:58368
  ds_read_b64_tr_b16 a[132:133], v65 offset:61440
  ds_read_b64_tr_b16 a[134:135], v65 offset:62464
  ds_read_b64_tr_b16 a[136:137], v66 offset:0
  ds_read_b64_tr_b16 a[138:139], v66 offset:1024
  ds_read_b64_tr_b16 a[140:141], v66 offset:4096
  ds_read_b64_tr_b16 a[142:143], v66 offset:5120
  s_waitcnt lgkmcnt(0)
  s_waitcnt vmcnt(24)
  s_barrier
  s_add_u32 m0, s51, 49152
  s_add_u32 s46, s62, 3145728
  buffer_load_dwordx4 v64, s[4:7], s46 offen lds
  s_add_u32 m0, s51, 53248
  s_add_u32 s46, s62, 3538944
  buffer_load_dwordx4 v64, s[4:7], s46 offen lds
  s_add_u32 m0, s51, 57344
  s_add_u32 s46, s62, 3145856
  buffer_load_dwordx4 v64, s[4:7], s46 offen lds
  s_add_u32 m0, s51, 61440
  s_add_u32 s46, s62, 3539072
  buffer_load_dwordx4 v64, s[4:7], s46 offen lds
  s_add_u32 m0, s51, 65536
  s_add_u32 s46, s62, 3145984
  buffer_load_dwordx4 v64, s[4:7], s46 offen lds
  s_add_u32 m0, s51, 69632
  s_add_u32 s46, s62, 3539200
  buffer_load_dwordx4 v64, s[4:7], s46 offen lds
  ds_read_b64_tr_b16 a[144:145], v66 offset:8192
  ds_read_b64_tr_b16 a[146:147], v66 offset:9216
  ds_read_b64_tr_b16 a[148:149], v66 offset:12288
  ds_read_b64_tr_b16 a[150:151], v66 offset:13312
  ds_read_b64_tr_b16 a[152:153], v66 offset:16384
  ds_read_b64_tr_b16 a[154:155], v66 offset:17408
  ds_read_b64_tr_b16 a[156:157], v66 offset:20480
  ds_read_b64_tr_b16 a[158:159], v66 offset:21504
  ds_read_b64_tr_b16 a[160:161], v66 offset:24576
  ds_read_b64_tr_b16 a[162:163], v66 offset:25600
  ds_read_b64_tr_b16 a[164:165], v66 offset:28672
  ds_read_b64_tr_b16 a[166:167], v66 offset:29696
  s_waitcnt lgkmcnt(0)
  s_waitcnt vmcnt(24)
  s_barrier
  s_add_u32 m0, s51, 73728
  s_add_u32 s46, s62, 4718592
  buffer_load_dwordx4 v64, s[4:7], s46 offen lds
  s_add_u32 m0, s51, 77824
  s_add_u32 s46, s62, 5111808
  buffer_load_dwordx4 v64, s[4:7], s46 offen lds
  s_add_u32 m0, s51, 81920
  s_add_u32 s46, s62, 4718720
  buffer_load_dwordx4 v64, s[4:7], s46 offen lds
  s_add_u32 m0, s51, 86016
  s_add_u32 s46, s62, 5111936
  buffer_load_dwordx4 v64, s[4:7], s46 offen lds
  s_add_u32 m0, s51, 90112
  s_add_u32 s46, s62, 4718848
  buffer_load_dwordx4 v64, s[4:7], s46 offen lds
  s_add_u32 m0, s51, 94208
  s_add_u32 s46, s62, 5112064
  buffer_load_dwordx4 v64, s[4:7], s46 offen lds
  ds_read_b64_tr_b16 a[168:169], v66 offset:32768
  ds_read_b64_tr_b16 a[170:171], v66 offset:33792
  ds_read_b64_tr_b16 a[172:173], v66 offset:36864
  ds_read_b64_tr_b16 a[174:175], v66 offset:37888
  ds_read_b64_tr_b16 a[176:177], v66 offset:40960
  ds_read_b64_tr_b16 a[178:179], v66 offset:41984
  ds_read_b64_tr_b16 a[180:181], v66 offset:45056
  ds_read_b64_tr_b16 a[182:183], v66 offset:46080
  ds_read_b64_tr_b16 a[184:185], v66 offset:49152
  ds_read_b64_tr_b16 a[186:187], v66 offset:50176
  ds_read_b64_tr_b16 a[188:189], v66 offset:53248
  ds_read_b64_tr_b16 a[190:191], v66 offset:54272
  s_waitcnt lgkmcnt(0)
  s_waitcnt vmcnt(24)
  s_barrier
  s_add_u32 m0, s51, 98304
  s_add_u32 s46, s62, 5505024
  buffer_load_dwordx4 v64, s[4:7], s46 offen lds
  s_add_u32 m0, s51, 102400
  s_add_u32 s46, s62, 5898240
  buffer_load_dwordx4 v64, s[4:7], s46 offen lds
  s_add_u32 m0, s51, 106496
  s_add_u32 s46, s62, 5505152
  buffer_load_dwordx4 v64, s[4:7], s46 offen lds
  s_add_u32 m0, s51, 110592
  s_add_u32 s46, s62, 5898368
  buffer_load_dwordx4 v64, s[4:7], s46 offen lds
  s_add_u32 m0, s51, 114688
  s_add_u32 s46, s62, 5505280
  buffer_load_dwordx4 v64, s[4:7], s46 offen lds
  s_add_u32 m0, s51, 118784
  s_add_u32 s46, s62, 5898496
  buffer_load_dwordx4 v64, s[4:7], s46 offen lds
  ds_read_b64_tr_b16 a[192:193], v66 offset:57344
  ds_read_b64_tr_b16 a[194:195], v66 offset:58368
  ds_read_b64_tr_b16 a[196:197], v66 offset:61440
  ds_read_b64_tr_b16 a[198:199], v66 offset:62464
  ds_read_b64_tr_b16 a[200:201], v67 offset:0
  ds_read_b64_tr_b16 a[202:203], v67 offset:1024
  ds_read_b64_tr_b16 a[204:205], v67 offset:4096
  ds_read_b64_tr_b16 a[206:207], v67 offset:5120
  ds_read_b64_tr_b16 a[208:209], v67 offset:8192
  ds_read_b64_tr_b16 a[210:211], v67 offset:9216
  ds_read_b64_tr_b16 a[212:213], v67 offset:12288
  ds_read_b64_tr_b16 a[214:215], v67 offset:13312
  s_waitcnt lgkmcnt(0)
  s_waitcnt vmcnt(24)
  s_barrier
  s_add_u32 m0, s51, 122880
  s_add_u32 s46, s62, 7077888
  buffer_load_dwordx4 v64, s[4:7], s46 offen lds
  s_add_u32 m0, s51, 126976
  s_add_u32 s46, s62, 7471104
  buffer_load_dwordx4 v64, s[4:7], s46 offen lds
  s_add_u32 m0, s51, 131072
  s_add_u32 s46, s62, 7078016
  buffer_load_dwordx4 v64, s[4:7], s46 offen lds
  s_add_u32 m0, s51, 135168
  s_add_u32 s46, s62, 7471232
  buffer_load_dwordx4 v64, s[4:7], s46 offen lds
  s_add_u32 m0, s51, 139264
  s_add_u32 s46, s62, 7078144
  buffer_load_dwordx4 v64, s[4:7], s46 offen lds
  s_add_u32 m0, s51, 143360
  s_add_u32 s46, s62, 7471360
  buffer_load_dwordx4 v64, s[4:7], s46 offen lds
  ds_read_b64_tr_b16 a[216:217], v65 offset:0
  ds_read_b64_tr_b16 a[218:219], v65 offset:1024
  ds_read_b64_tr_b16 a[220:221], v65 offset:4096
  ds_read_b64_tr_b16 a[222:223], v65 offset:5120
  ds_read_b64_tr_b16 a[224:225], v65 offset:8192
  ds_read_b64_tr_b16 a[226:227], v65 offset:9216
  ds_read_b64_tr_b16 a[228:229], v65 offset:12288
  ds_read_b64_tr_b16 a[230:231], v65 offset:13312
  ds_read_b64_tr_b16 a[232:233], v65 offset:16384
  ds_read_b64_tr_b16 a[234:235], v65 offset:17408
  ds_read_b64_tr_b16 a[236:237], v65 offset:20480
  ds_read_b64_tr_b16 a[238:239], v65 offset:21504
  s_waitcnt lgkmcnt(0)
  s_waitcnt vmcnt(24)
  s_barrier
  s_add_u32 m0, s51, 0
  s_add_u32 s46, s62, 1572864
  buffer_load_dwordx4 v64, s[4:7], s46 offen lds
  s_add_u32 m0, s51, 4096
  s_add_u32 s46, s62, 1966080
  buffer_load_dwordx4 v64, s[4:7], s46 offen lds
  s_add_u32 m0, s51, 8192
  s_add_u32 s46, s62, 1572992
  buffer_load_dwordx4 v64, s[4:7], s46 offen lds
  s_add_u32 m0, s51, 12288
  s_add_u32 s46, s62, 1966208
  buffer_load_dwordx4 v64, s[4:7], s46 offen lds
  s_add_u32 m0, s51, 16384
  s_add_u32 s46, s62, 1573120
  buffer_load_dwordx4 v64, s[4:7], s46 offen lds
  s_add_u32 m0, s51, 20480
  s_add_u32 s46, s62, 1966336
  buffer_load_dwordx4 v64, s[4:7], s46 offen lds
  ds_read_b64_tr_b16 a[240:241], v65 offset:24576
  ds_read_b64_tr_b16 a[242:243], v65 offset:25600
  ds_read_b64_tr_b16 a[244:245], v65 offset:28672
  ds_read_b64_tr_b16 a[246:247], v65 offset:29696
  ds_read_b64_tr_b16 a[248:249], v65 offset:32768
  ds_read_b64_tr_b16 a[250:251], v65 offset:33792
  ds_read_b64_tr_b16 a[252:253], v65 offset:36864
  ds_read_b64_tr_b16 a[254:255], v65 offset:37888
  ds_read_b64_tr_b16 v[152:153], v65 offset:40960
  ds_read_b64_tr_b16 v[154:155], v65 offset:41984
  ds_read_b64_tr_b16 v[156:157], v65 offset:45056
  ds_read_b64_tr_b16 v[158:159], v65 offset:46080
  s_waitcnt lgkmcnt(0)
  s_waitcnt vmcnt(24)
  s_barrier
  s_add_u32 m0, s51, 24576
  s_add_u32 s46, s62, 3145728
  buffer_load_dwordx4 v64, s[12:15], s46 offen lds
  s_add_u32 m0, s51, 28672
  s_add_u32 s46, s62, 3538944
  buffer_load_dwordx4 v64, s[12:15], s46 offen lds
  s_add_u32 m0, s51, 32768
  s_add_u32 s46, s62, 3145856
  buffer_load_dwordx4 v64, s[12:15], s46 offen lds
  s_add_u32 m0, s51, 36864
  s_add_u32 s46, s62, 3539072
  buffer_load_dwordx4 v64, s[12:15], s46 offen lds
  s_add_u32 m0, s51, 40960
  s_add_u32 s46, s62, 3145984
  buffer_load_dwordx4 v64, s[12:15], s46 offen lds
  s_add_u32 m0, s51, 45056
  s_add_u32 s46, s62, 3539200
  buffer_load_dwordx4 v64, s[12:15], s46 offen lds
  ds_read_b64_tr_b16 v[160:161], v65 offset:49152
  ds_read_b64_tr_b16 v[162:163], v65 offset:50176
  ds_read_b64_tr_b16 v[164:165], v65 offset:53248
  ds_read_b64_tr_b16 v[166:167], v65 offset:54272
  ds_read_b64_tr_b16 v[168:169], v65 offset:57344
  ds_read_b64_tr_b16 v[170:171], v65 offset:58368
  ds_read_b64_tr_b16 v[172:173], v65 offset:61440
  ds_read_b64_tr_b16 v[174:175], v65 offset:62464
  ds_read_b64_tr_b16 v[176:177], v66 offset:0
  ds_read_b64_tr_b16 v[178:179], v66 offset:1024
  ds_read_b64_tr_b16 v[180:181], v66 offset:4096
  ds_read_b64_tr_b16 v[182:183], v66 offset:5120
  s_waitcnt lgkmcnt(0)
  s_waitcnt vmcnt(24)
  s_barrier
  s_add_u32 m0, s51, 49152
  s_add_u32 s46, s62, 3932160
  buffer_load_dwordx4 v64, s[4:7], s46 offen lds
  s_add_u32 m0, s51, 53248
  s_add_u32 s46, s62, 4325376
  buffer_load_dwordx4 v64, s[4:7], s46 offen lds
  s_add_u32 m0, s51, 57344
  s_add_u32 s46, s62, 3932288
  buffer_load_dwordx4 v64, s[4:7], s46 offen lds
  s_add_u32 m0, s51, 61440
  s_add_u32 s46, s62, 4325504
  buffer_load_dwordx4 v64, s[4:7], s46 offen lds
  s_add_u32 m0, s51, 65536
  s_add_u32 s46, s62, 3932416
  buffer_load_dwordx4 v64, s[4:7], s46 offen lds
  s_add_u32 m0, s51, 69632
  s_add_u32 s46, s62, 4325632
  buffer_load_dwordx4 v64, s[4:7], s46 offen lds
  ds_read_b64_tr_b16 v[184:185], v66 offset:8192
  ds_read_b64_tr_b16 v[186:187], v66 offset:9216
  ds_read_b64_tr_b16 v[188:189], v66 offset:12288
  ds_read_b64_tr_b16 v[190:191], v66 offset:13312
  ds_read_b64_tr_b16 v[192:193], v66 offset:16384
  ds_read_b64_tr_b16 v[194:195], v66 offset:17408
  ds_read_b64_tr_b16 v[196:197], v66 offset:20480
  ds_read_b64_tr_b16 v[198:199], v66 offset:21504
  ds_read_b64_tr_b16 v[200:201], v66 offset:24576
  ds_read_b64_tr_b16 v[202:203], v66 offset:25600
  ds_read_b64_tr_b16 v[204:205], v66 offset:28672
  ds_read_b64_tr_b16 v[206:207], v66 offset:29696
  s_waitcnt lgkmcnt(0)
  s_waitcnt vmcnt(24)
  s_barrier
  s_add_u32 m0, s51, 73728
  s_add_u32 s46, s62, 5505024
  buffer_load_dwordx4 v64, s[12:15], s46 offen lds
  s_add_u32 m0, s51, 77824
  s_add_u32 s46, s62, 5898240
  buffer_load_dwordx4 v64, s[12:15], s46 offen lds
  s_add_u32 m0, s51, 81920
  s_add_u32 s46, s62, 5505152
  buffer_load_dwordx4 v64, s[12:15], s46 offen lds
  s_add_u32 m0, s51, 86016
  s_add_u32 s46, s62, 5898368
  buffer_load_dwordx4 v64, s[12:15], s46 offen lds
  s_add_u32 m0, s51, 90112
  s_add_u32 s46, s62, 5505280
  buffer_load_dwordx4 v64, s[12:15], s46 offen lds
  s_add_u32 m0, s51, 94208
  s_add_u32 s46, s62, 5898496
  buffer_load_dwordx4 v64, s[12:15], s46 offen lds
  ds_read_b64_tr_b16 v[208:209], v66 offset:32768
  ds_read_b64_tr_b16 v[210:211], v66 offset:33792
  ds_read_b64_tr_b16 v[212:213], v66 offset:36864
  ds_read_b64_tr_b16 v[214:215], v66 offset:37888
  ds_read_b64_tr_b16 v[216:217], v66 offset:40960
  ds_read_b64_tr_b16 v[218:219], v66 offset:41984
  ds_read_b64_tr_b16 v[220:221], v66 offset:45056
  ds_read_b64_tr_b16 v[222:223], v66 offset:46080
  ds_read_b64_tr_b16 v[224:225], v66 offset:49152
  ds_read_b64_tr_b16 v[226:227], v66 offset:50176
  ds_read_b64_tr_b16 v[228:229], v66 offset:53248
  ds_read_b64_tr_b16 v[230:231], v66 offset:54272
  s_waitcnt lgkmcnt(0)
  s_waitcnt vmcnt(24)
  s_barrier
  s_add_u32 m0, s51, 98304
  s_add_u32 s46, s62, 6291456
  buffer_load_dwordx4 v64, s[4:7], s46 offen lds
  s_add_u32 m0, s51, 102400
  s_add_u32 s46, s62, 6684672
  buffer_load_dwordx4 v64, s[4:7], s46 offen lds
  s_add_u32 m0, s51, 106496
  s_add_u32 s46, s62, 6291584
  buffer_load_dwordx4 v64, s[4:7], s46 offen lds
  s_add_u32 m0, s51, 110592
  s_add_u32 s46, s62, 6684800
  buffer_load_dwordx4 v64, s[4:7], s46 offen lds
  s_add_u32 m0, s51, 114688
  s_add_u32 s46, s62, 6291712
  buffer_load_dwordx4 v64, s[4:7], s46 offen lds
  s_add_u32 m0, s51, 118784
  s_add_u32 s46, s62, 6684928
  buffer_load_dwordx4 v64, s[4:7], s46 offen lds
  ds_read_b64_tr_b16 v[232:233], v66 offset:57344
  ds_read_b64_tr_b16 v[234:235], v66 offset:58368
  ds_read_b64_tr_b16 v[236:237], v66 offset:61440
  ds_read_b64_tr_b16 v[238:239], v66 offset:62464
  ds_read_b64_tr_b16 v[240:241], v67 offset:0
  ds_read_b64_tr_b16 v[242:243], v67 offset:1024
  ds_read_b64_tr_b16 v[244:245], v67 offset:4096
  ds_read_b64_tr_b16 v[246:247], v67 offset:5120
  ds_read_b64_tr_b16 v[248:249], v67 offset:8192
  ds_read_b64_tr_b16 v[250:251], v67 offset:9216
  ds_read_b64_tr_b16 v[252:253], v67 offset:12288
  ds_read_b64_tr_b16 v[254:255], v67 offset:13312
  s_waitcnt lgkmcnt(0)
  s_waitcnt vmcnt(24)
  s_barrier
  ds_read_b64_tr_b16 v[40:41], v65 offset:0
  ds_read_b64_tr_b16 v[42:43], v65 offset:1024
  ds_read_b64_tr_b16 v[44:45], v65 offset:4096
  ds_read_b64_tr_b16 v[46:47], v65 offset:5120
  ds_read_b64_tr_b16 v[48:49], v65 offset:8192
  ds_read_b64_tr_b16 v[50:51], v65 offset:9216
  ds_read_b64_tr_b16 v[52:53], v65 offset:12288
  ds_read_b64_tr_b16 v[54:55], v65 offset:13312
  ds_read_b64_tr_b16 v[56:57], v65 offset:16384
  ds_read_b64_tr_b16 v[58:59], v65 offset:17408
  ds_read_b64_tr_b16 v[60:61], v65 offset:20480
  ds_read_b64_tr_b16 v[62:63], v65 offset:21504
  s_waitcnt lgkmcnt(0)
  s_waitcnt vmcnt(18)
  s_barrier
  ds_write_b128 v2, v[40:43] offset:0
  ds_write_b128 v2, v[44:47] offset:4096
  ds_write_b128 v2, v[48:51] offset:8192
  ds_write_b128 v2, v[52:55] offset:12288
  ds_write_b128 v2, v[56:59] offset:16384
  ds_write_b128 v2, v[60:63] offset:20480
  ds_read_b64_tr_b16 v[16:17], v65 offset:24576
  ds_read_b64_tr_b16 v[18:19], v65 offset:25600
  ds_read_b64_tr_b16 v[20:21], v65 offset:28672
  ds_read_b64_tr_b16 v[22:23], v65 offset:29696
  ds_read_b64_tr_b16 v[24:25], v65 offset:32768
  ds_read_b64_tr_b16 v[26:27], v65 offset:33792
  ds_read_b64_tr_b16 v[28:29], v65 offset:36864
  ds_read_b64_tr_b16 v[30:31], v65 offset:37888
  ds_read_b64_tr_b16 v[32:33], v65 offset:40960
  ds_read_b64_tr_b16 v[34:35], v65 offset:41984
  ds_read_b64_tr_b16 v[36:37], v65 offset:45056
  ds_read_b64_tr_b16 v[38:39], v65 offset:46080
  s_waitcnt lgkmcnt(0)
  s_waitcnt vmcnt(12)
  s_barrier
  ds_write_b128 v2, v[16:19] offset:24576
  ds_write_b128 v2, v[20:23] offset:28672
  ds_write_b128 v2, v[24:27] offset:32768
  ds_write_b128 v2, v[28:31] offset:36864
  ds_write_b128 v2, v[32:35] offset:40960
  ds_write_b128 v2, v[36:39] offset:45056
  ds_read_b64_tr_b16 v[40:41], v65 offset:49152
  ds_read_b64_tr_b16 v[42:43], v65 offset:50176
  ds_read_b64_tr_b16 v[44:45], v65 offset:53248
  ds_read_b64_tr_b16 v[46:47], v65 offset:54272
  ds_read_b64_tr_b16 v[48:49], v65 offset:57344
  ds_read_b64_tr_b16 v[50:51], v65 offset:58368
  ds_read_b64_tr_b16 v[52:53], v65 offset:61440
  ds_read_b64_tr_b16 v[54:55], v65 offset:62464
  ds_read_b64_tr_b16 v[56:57], v66 offset:0
  ds_read_b64_tr_b16 v[58:59], v66 offset:1024
  ds_read_b64_tr_b16 v[60:61], v66 offset:4096
  ds_read_b64_tr_b16 v[62:63], v66 offset:5120
  s_waitcnt lgkmcnt(0)
  s_waitcnt vmcnt(6)
  s_barrier
  ds_write_b128 v2, v[40:43] offset:49152
  ds_write_b128 v2, v[44:47] offset:53248
  ds_write_b128 v2, v[48:51] offset:57344
  ds_write_b128 v2, v[52:55] offset:61440
  ds_write_b128 v3, v[56:59] offset:0
  ds_write_b128 v3, v[60:63] offset:4096
  ds_read_b64_tr_b16 v[16:17], v66 offset:8192
  ds_read_b64_tr_b16 v[18:19], v66 offset:9216
  ds_read_b64_tr_b16 v[20:21], v66 offset:12288
  ds_read_b64_tr_b16 v[22:23], v66 offset:13312
  ds_read_b64_tr_b16 v[24:25], v66 offset:16384
  ds_read_b64_tr_b16 v[26:27], v66 offset:17408
  ds_read_b64_tr_b16 v[28:29], v66 offset:20480
  ds_read_b64_tr_b16 v[30:31], v66 offset:21504
  ds_read_b64_tr_b16 v[32:33], v66 offset:24576
  ds_read_b64_tr_b16 v[34:35], v66 offset:25600
  ds_read_b64_tr_b16 v[36:37], v66 offset:28672
  ds_read_b64_tr_b16 v[38:39], v66 offset:29696
  s_waitcnt lgkmcnt(0)
  s_waitcnt vmcnt(0)
  s_barrier
  ds_write_b128 v3, v[16:19] offset:8192
  ds_write_b128 v3, v[20:23] offset:12288
  ds_write_b128 v3, v[24:27] offset:16384
  ds_write_b128 v3, v[28:31] offset:20480
  ds_write_b128 v3, v[32:35] offset:24576
  ds_write_b128 v3, v[36:39] offset:28672
  ds_read_b64_tr_b16 v[40:41], v66 offset:32768
  ds_read_b64_tr_b16 v[42:43], v66 offset:33792
  ds_read_b64_tr_b16 v[44:45], v66 offset:36864
  ds_read_b64_tr_b16 v[46:47], v66 offset:37888
  ds_read_b64_tr_b16 v[48:49], v66 offset:40960
  ds_read_b64_tr_b16 v[50:51], v66 offset:41984
  ds_read_b64_tr_b16 v[52:53], v66 offset:45056
  ds_read_b64_tr_b16 v[54:55], v66 offset:46080
  ds_read_b64_tr_b16 v[56:57], v66 offset:49152
  ds_read_b64_tr_b16 v[58:59], v66 offset:50176
  ds_read_b64_tr_b16 v[60:61], v66 offset:53248
  ds_read_b64_tr_b16 v[62:63], v66 offset:54272
  s_waitcnt lgkmcnt(0)
  s_barrier
  ds_write_b128 v3, v[40:43] offset:32768
  ds_write_b128 v3, v[44:47] offset:36864
  ds_write_b128 v3, v[48:51] offset:40960
  ds_write_b128 v3, v[52:55] offset:45056
  ds_write_b128 v3, v[56:59] offset:49152
  ds_write_b128 v3, v[60:63] offset:53248
  s_waitcnt lgkmcnt(0)
  v_and_b32 v137, 3, v0
  v_lshlrev_b32 v137, 2, v137
  s_mov_b32 s50, 0
ss_15:
  global_load_dword v136, v137, s[38:39] sc1
  s_add_u32 s50, s50, 1
  s_cmp_gt_u32 s50, 131072
  s_cbranch_scc1 L_fail
  s_waitcnt vmcnt(0)
  v_readlane_b32 s46, v136, 0
  v_readlane_b32 s47, v136, 2
  s_cmp_lg_u32 s46, 0
  s_cselect_b32 s48, 7, 0
  s_add_u32 s46, s46, s2
  s_xor_b32 s49, s46, s43
  s_and_b32 s49, s49, s48
  s_cbranch_scc1 L_reroll
  s_cmp_lg_u32 s47, 0
  s_cbranch_scc1 ss_ok_16
  s_sleep 10
  s_branch ss_15
ss_ok_16:
  v_readlane_b32 s3, v136, 1
  s_nop 0
  s_and_b32 s3, s3, 0x2000
  v_and_b32 v136, 3, v0
  s_lshl_b32 s46, s43, 9
  s_add_u32 s46, s46, s3
  s_add_u32 s46, s46, 13369344
  v_lshl_add_u32 v10, v136, 7, s46
  s_lshl_b32 s46, s43, 7
  s_add_u32 s46, s46, s3
  s_add_u32 s46, s46, 13371392
  v_lshl_add_u32 v11, v136, 9, s46
  v_mov_b32 v7, 0x44444444
  v_mov_b32 v136, 0xeeeeeeee
  v_and_b32 v137, 2, v0
  v_cmp_ne_u32 vcc, 0, v137
  s_nop 1
  v_cndmask_b32 v7, v7, v136, vcc
  s_mov_b32 s69, 1037384597
  s_mov_b32 s70, 3494803967
  v_and_b32 v136, 15, v0
  v_lshrrev_b32 v138, 4, v0
  v_lshlrev_b32 v4, 4, v136
  v_lshl_add_u32 v4, v138, 2, v4
  s_lshl_b32 s46, s42, 8
  s_add_u32 s46, s46, 147456
  v_add_u32 v4, s46, v4
  v_lshlrev_b32 v5, 7, v138
  v_bfe_u32 v137, v0, 2, 2
  v_lshl_add_u32 v5, v137, 4, v5
  v_and_b32 v137, 1, v0
  v_lshl_add_u32 v5, v137, 3, v5
  v_add_u32 v5, 147456, v5
  v_add_u32 v13, 122880, v1
  v_bfe_u32 v140, v0, 1, 2
  v_lshl_add_u32 v140, v140, 2, v137
  v_bfe_u32 v137, v0, 3, 1
  v_lshl_add_u32 v140, v137, 1, v140
  v_cmp_eq_u32 s[18:19], 1, v137
  s_add_u32 s46, s3, 12582912
  s_lshr_b32 s47, s45, 4
  s_add_u32 s47, s47, 1
  s_lshl_b32 s47, s47, 14
  s_and_b32 s48, s45, 15
  s_lshl_b32 s48, s48, 9
  s_add_u32 s47, s47, s48
  s_add_u32 s47, s47, s46
  v_lshrrev_b32 v137, 1, v138
  v_and_b32 v139, 1, v138
  v_lshl_add_u32 v8, v137, 4, v140
  v_lshlrev_b32 v8, 4, v8
  v_lshl_add_u32 v8, v139, 3, v8
  v_add_u32 v8, s47, v8
  s_lshl_b32 s47, s45, 7
  s_add_u32 s47, s47, s46
  s_add_u32 s47, s47, 51200
  v_lshlrev_b32 v9, 3, v140
  v_lshl_add_u32 v9, v139, 2, v9
  v_add_u32 v9, s47, v9
  v_lshl_add_u32 v9, v137, 30, v9
  v_mov_b32 v140, 2146435072
  s_cmp_eq_u32 s44, 0
  s_cselect_b64 vcc, 15, 0
  v_cndmask_b32 v11, v140, v11, vcc
  v_lshlrev_b32 v14, 4, v136
  v_lshl_add_u32 v14, v139, 3, v14
  v_lshl_add_u32 v14, v137, 2, v14
  s_lshl_b32 s47, s45, 8
  s_add_u32 s47, s47, 65536
  v_add_u32 v14, s47, v14
  s_lshl_b32 s47, s42, 4
  v_add_u32 v136, s47, v136
  v_lshlrev_b32 v138, 2, v138
  v_sub_u32 v136, v136, v138
  v_cmp_gt_i32 s[72:73], 0, v136
  v_cmp_gt_i32 s[74:75], 1, v136
  v_cmp_gt_i32 s[76:77], 2, v136
  v_cmp_gt_i32 s[78:79], 3, v136
  v_cmp_gt_i32 s[80:81], 16, v136
  v_cmp_gt_i32 s[82:83], 17, v136
  v_cmp_gt_i32 s[84:85], 18, v136
  v_cmp_gt_i32 s[86:87], 19, v136
  s_lshl_b32 s46, s45, 7
  s_lshl_b32 s47, s42, 2
  s_add_u32 s47, s47, s46
  s_add_u32 s47, s47, 1069056
  v_mov_b32 v15, s47
  s_cmp_lg_u32 s42, 2
  s_cbranch_scc1 sc_fl
  v_and_b32 v15, 1, v0
  v_lshlrev_b32 v15, 12, v15
  s_add_u32 s46, s46, 1048576
  v_add_u32 v15, s46, v15
sc_fl:
  s_mov_b32 s23, s45
  s_lshl_b32 s20, s42, 24
  s_add_u32 s20, s20, s3
  s_add_u32 s20, s20, 31457280
  s_lshl_b32 s26, s42, 11
  s_lshl_b32 s46, s42, 24
  s_sub_u32 s26, s26, s46
  s_cmp_eq_u32 s42, 2
  s_cselect_b32 s26, 2012217344, s26
  s_lshl_b32 s21, s42, 12
  s_add_u32 s21, s21, 122880
  s_mov_b32 s22, 12288
  s_mul_i32 s64, s42, 81920
  s_add_u32 s64, s64, s3
  s_add_u32 s64, s64, 14680064
  s_lshr_b32 s27, s45, 3
  s_lshl_b32 s27, s27, 14
  s_and_b32 s46, s45, 7
  s_lshl_b32 s46, s46, 10
  s_add_u32 s27, s27, s46
  s_mov_b32 s61, 0
  s_mov_b32 s52, 0
  s_mov_b32 s58, 0
  s_mov_b32 s65, 524288
  s_mov_b32 s100, 0
  s_cmp_lg_u32 s42, 2
  s_cbranch_scc1 sc_k0
  s_mov_b32 s53, 1
  s_cmp_ge_u32 s61, s53
  s_cbranch_scc1 wf_done_17
  s_mov_b32 s50, 0
wf_loop_18:
  buffer_load_dword v136, v15, s[8:11], 0 offen sc1
  s_add_u32 s50, s50, 1
  s_cmp_gt_u32 s50, 131072
  s_cbranch_scc1 L_fail
  s_waitcnt vmcnt(0)
  v_min_u32_dpp v136, v136, v136 row_ror:8 row_mask:0xf bank_mask:0xf
  s_nop 1
  v_min_u32_dpp v136, v136, v136 row_ror:4 row_mask:0xf bank_mask:0xf
  s_nop 1
  v_min_u32_dpp v136, v136, v136 row_ror:2 row_mask:0xf bank_mask:0xf
  s_nop 1
  v_min_u32_dpp v136, v136, v136 row_ror:1 row_mask:0xf bank_mask:0xf
  v_mov_b32 v137, v136
  s_nop 1
  v_permlane16_swap_b32 v137, v136
  v_min_u32 v136, v136, v137
  v_mov_b32 v137, v136
  s_nop 1
  v_permlane32_swap_b32 v137, v136
  v_min_u32 v136, v136, v137
  s_nop 0
  v_readfirstlane_b32 s61, v136
  s_nop 0
  s_cmp_ge_u32 s61, s53
  s_cbranch_scc1 wf_done_17
  s_sleep 2
  s_branch wf_loop_18
wf_done_17:
sc_k0:
  s_barrier
  s_cmp_eq_u32 s42, 3
  s_cbranch_scc1 scs_loop
  s_mov_b32 m0, s21
  s_lshr_b32 s63, s23, 1
  s_lshl_b32 s63, s63, 14
  s_and_b32 s46, s23, 1
  s_lshl_b32 s46, s46, 12
  s_add_u32 s63, s63, s46
  s_add_u32 s63, s63, s20
  s_lshr_b32 s46, s63, 8
  s_and_b32 s46, s46, 0x2000
  s_xor_b32 s63, s63, s46
  buffer_load_dwordx4 v1, s[8:11], s63 offen offset:0 sc1 lds
  buffer_load_dwordx4 v1, s[8:11], s63 offen offset:1024 sc1 lds
  buffer_load_dwordx4 v1, s[8:11], s63 offen offset:2048 sc1 lds
  buffer_load_dwordx4 v1, s[8:11], s63 offen offset:3072 sc1 lds
  s_waitcnt vmcnt(0)
  s_branch sch_loop
scs_loop:
  s_add_u32 s53, s52, 1
  s_lshl_b32 s56, s58, 2
  s_add_u32 s56, s56, s43
  s_lshl_b32 s56, s56, 16
  s_add_u32 s56, s56, s3
  s_add_u32 s56, s56, 12582912
  v_add_u32 v12, s56, v1
  s_lshl_b32 s66, s58, 18
  s_mov_b64 s[16:17], -1
  s_mov_b32 s71, 0
  ds_read_b128 v[56:59], v2 offset:0
  ds_read_b128 v[60:63], v2 offset:4096
  ds_read_b128 v[64:67], v2 offset:8192
  ds_read_b128 v[68:71], v2 offset:12288
  ds_read_b128 v[72:75], v2 offset:16384
  ds_read_b128 v[76:79], v2 offset:20480
  ds_read_b128 v[80:83], v2 offset:24576
  ds_read_b128 v[84:87], v2 offset:28672
  v_mov_b32 v88, 0
  v_mov_b32 v89, 0
  v_mov_b32 v90, 0
  v_mov_b32 v91, 0
  v_mov_b32 v92, 0
  v_mov_b32 v93, 0
  v_mov_b32 v94, 0
  v_mov_b32 v95, 0
  v_mov_b32 v96, 0
  v_mov_b32 v97, 0
  v_mov_b32 v98, 0
  v_mov_b32 v99, 0
  v_mov_b32 v100, 0
  v_mov_b32 v101, 0
  v_mov_b32 v102, 0
  v_mov_b32 v103, 0
  v_mov_b32 v104, 0
  v_mov_b32 v105, 0
  v_mov_b32 v106, 0
  v_mov_b32 v107, 0
  v_mov_b32 v108, 0
  v_mov_b32 v109, 0
  v_mov_b32 v110, 0
  v_mov_b32 v111, 0
  v_mov_b32 v6, s53
  s_waitcnt lgkmcnt(0)
  s_barrier
  buffer_load_dwordx4 v[16:19], v12, s[8:11], 0 offen offset:0 sc1
  s_barrier
  buffer_load_dwordx4 v[20:23], v12, s[8:11], 0 offen offset:1024 sc1
  s_barrier
  buffer_load_dwordx4 v[24:27], v12, s[8:11], 0 offen offset:2048 sc1
  s_barrier
  buffer_load_dwordx4 v[28:31], v12, s[8:11], 0 offen offset:3072 sc1
  s_barrier
  buffer_load_dwordx4 v[32:35], v12, s[8:11], s24 offen offset:0 sc1
  s_barrier
  buffer_load_dwordx4 v[36:39], v12, s[8:11], s24 offen offset:1024 sc1
  s_barrier
  buffer_load_dwordx4 v[40:43], v12, s[8:11], s24 offen offset:2048 sc1
  s_barrier
  buffer_load_dwordx4 v[44:47], v12, s[8:11], s24 offen offset:3072 sc1
  s_barrier
  buffer_load_dwordx4 v[48:51], v12, s[8:11], s25 offen offset:0 sc1
  s_barrier
  buffer_load_dwordx4 v[52:55], v12, s[8:11], s25 offen offset:1024 sc1
scs_go_19:
  s_waitcnt vmcnt(9)
  v_smfmac_f32_16x16x64_bf16 v[88:91], v[16:19], a[192:199], v7
  v_smfmac_f32_16x16x64_bf16 v[92:95], v[16:19], a[200:207], v7
  v_smfmac_f32_16x16x64_bf16 v[96:99], v[16:19], a[208:215], v7
  v_smfmac_f32_16x16x64_bf16 v[100:103], v[16:19], a[0:7], v7
  s_waitcnt vmcnt(8)
  v_smfmac_f32_16x16x64_bf16 v[88:91], v[20:23], a[216:223], v7
  v_smfmac_f32_16x16x64_bf16 v[92:95], v[20:23], a[224:231], v7
  v_smfmac_f32_16x16x64_bf16 v[96:99], v[20:23], a[232:239], v7
  v_smfmac_f32_16x16x64_bf16 v[100:103], v[20:23], a[24:31], v7
  s_waitcnt vmcnt(7)
  v_smfmac_f32_16x16x64_bf16 v[88:91], v[24:27], v[56:63], v7
  v_smfmac_f32_16x16x64_bf16 v[92:95], v[24:27], v[64:71], v7
  ds_read_b128 v[56:59], v2 offset:49152
  v_smfmac_f32_16x16x64_bf16 v[96:99], v[24:27], v[72:79], v7
  ds_read_b128 v[60:63], v2 offset:53248
  v_smfmac_f32_16x16x64_bf16 v[100:103], v[24:27], a[48:55], v7
  ds_read_b128 v[64:67], v2 offset:57344
  s_waitcnt vmcnt(6)
  v_smfmac_f32_16x16x64_bf16 v[88:91], v[28:31], a[240:247], v7
  ds_read_b128 v[68:71], v2 offset:61440
  v_smfmac_f32_16x16x64_bf16 v[92:95], v[28:31], a[248:255], v7
  ds_read_b128 v[72:75], v3 offset:0
  v_smfmac_f32_16x16x64_bf16 v[96:99], v[28:31], v[152:159], v7
  ds_read_b128 v[76:79], v3 offset:4096
  v_smfmac_f32_16x16x64_bf16 v[100:103], v[28:31], a[72:79], v7
  s_waitcnt vmcnt(5)
  v_smfmac_f32_16x16x64_bf16 v[88:91], v[32:35], v[160:167], v7
  v_smfmac_f32_16x16x64_bf16 v[92:95], v[32:35], v[168:175], v7
  v_smfmac_f32_16x16x64_bf16 v[96:99], v[32:35], v[176:183], v7
  v_smfmac_f32_16x16x64_bf16 v[100:103], v[32:35], v[80:87], v7
  ds_read_b128 v[80:83], v3 offset:8192
  s_waitcnt vmcnt(4)
  s_waitcnt lgkmcnt(5)
  v_smfmac_f32_16x16x64_bf16 v[88:91], v[36:39], v[56:63], v7
  ds_read_b128 v[84:87], v3 offset:12288
  s_waitcnt lgkmcnt(4)
  v_smfmac_f32_16x16x64_bf16 v[92:95], v[36:39], v[64:71], v7
  ds_read_b128 v[56:59], v3 offset:32768
  s_waitcnt lgkmcnt(3)
  v_smfmac_f32_16x16x64_bf16 v[96:99], v[36:39], v[72:79], v7
  ds_read_b128 v[60:63], v3 offset:36864
  v_smfmac_f32_16x16x64_bf16 v[100:103], v[36:39], a[96:103], v7
  ds_read_b128 v[64:67], v3 offset:40960
  s_waitcnt vmcnt(3)
  v_smfmac_f32_16x16x64_bf16 v[88:91], v[40:43], v[184:191], v7
  ds_read_b128 v[68:71], v3 offset:45056
  v_smfmac_f32_16x16x64_bf16 v[92:95], v[40:43], v[192:199], v7
  ds_read_b128 v[72:75], v3 offset:49152
  v_smfmac_f32_16x16x64_bf16 v[96:99], v[40:43], v[200:207], v7
  ds_read_b128 v[76:79], v3 offset:53248
  v_smfmac_f32_16x16x64_bf16 v[100:103], v[40:43], a[120:127], v7
  s_waitcnt vmcnt(2)
  v_smfmac_f32_16x16x64_bf16 v[88:91], v[44:47], v[208:215], v7
  v_smfmac_f32_16x16x64_bf16 v[92:95], v[44:47], v[216:223], v7
  v_smfmac_f32_16x16x64_bf16 v[96:99], v[44:47], v[224:231], v7
  s_waitcnt lgkmcnt(6)
  v_smfmac_f32_16x16x64_bf16 v[100:103], v[44:47], v[80:87], v7
  ds_read_b128 v[80:83], v2 offset:32768
  s_waitcnt vmcnt(1)
  s_waitcnt lgkmcnt(5)
  v_smfmac_f32_16x16x64_bf16 v[88:91], v[48:51], v[56:63], v7
  ds_read_b128 v[84:87], v2 offset:36864
  s_waitcnt lgkmcnt(4)
  v_smfmac_f32_16x16x64_bf16 v[92:95], v[48:51], v[64:71], v7
  ds_read_b128 v[56:59], v3 offset:16384
  s_waitcnt lgkmcnt(3)
  v_smfmac_f32_16x16x64_bf16 v[96:99], v[48:51], v[72:79], v7
  ds_read_b128 v[60:63], v3 offset:20480
  v_smfmac_f32_16x16x64_bf16 v[100:103], v[48:51], a[144:151], v7
  ds_read_b128 v[64:67], v2 offset:40960
  s_waitcnt vmcnt(0)
  v_smfmac_f32_16x16x64_bf16 v[88:91], v[52:55], v[232:239], v7
  ds_read_b128 v[68:71], v2 offset:45056
  v_smfmac_f32_16x16x64_bf16 v[92:95], v[52:55], v[240:247], v7
  ds_read_b128 v[72:75], v3 offset:24576
  v_smfmac_f32_16x16x64_bf16 v[96:99], v[52:55], v[248:255], v7
  ds_read_b128 v[76:79], v3 offset:28672
  v_smfmac_f32_16x16x64_bf16 v[100:103], v[52:55], a[168:175], v7
  v_smfmac_f32_16x16x64_bf16 v[104:107], v[16:19], a[8:15], v7
  v_add_f32 v88, v88, v90
  v_smfmac_f32_16x16x64_bf16 v[104:107], v[20:23], a[32:39], v7
  v_add_f32 v89, v89, v91
  v_smfmac_f32_16x16x64_bf16 v[104:107], v[24:27], a[56:63], v7
  v_cmp_u_f32 vcc, v88, v89
  v_smfmac_f32_16x16x64_bf16 v[104:107], v[28:31], a[80:87], v7
  v_cvt_pk_bf16_f32 v136, v88, v89
  v_smfmac_f32_16x16x64_bf16 v[104:107], v[36:39], a[104:111], v7
  s_and_b64 vcc, vcc, s[16:17]
  s_cbranch_scc1 scs_redo_20
  v_add_f32 v92, v92, v94
  v_smfmac_f32_16x16x64_bf16 v[104:107], v[40:43], a[128:135], v7
  ds_write_b32 v4, v136 offset:0
  v_add_f32 v93, v93, v95
  v_smfmac_f32_16x16x64_bf16 v[104:107], v[48:51], a[152:159], v7
  s_waitcnt lgkmcnt(1)
  v_cvt_pk_bf16_f32 v137, v92, v93
  v_smfmac_f32_16x16x64_bf16 v[104:107], v[52:55], a[176:183], v7
  ds_write_b32 v4, v137 offset:1024
  v_add_f32 v96, v96, v98
  v_smfmac_f32_16x16x64_bf16 v[104:107], v[32:35], v[80:87], v7
  v_add_f32 v97, v97, v99
  v_smfmac_f32_16x16x64_bf16 v[104:107], v[44:47], v[56:63], v7
  ds_read_b128 v[80:83], v13 offset:5120
  v_cvt_pk_bf16_f32 v138, v96, v97
  v_smfmac_f32_16x16x64_bf16 v[108:111], v[32:35], v[64:71], v7
  ds_write_b32 v4, v138 offset:2048
  v_add_f32 v100, v100, v102
  v_smfmac_f32_16x16x64_bf16 v[108:111], v[44:47], v[72:79], v7
  ds_read_b128 v[56:59], v13 offset:0
  v_add_f32 v101, v101, v103
  v_smfmac_f32_16x16x64_bf16 v[108:111], v[16:19], a[16:23], v7
  ds_read_b128 v[60:63], v13 offset:2048
  v_cvt_pk_bf16_f32 v139, v100, v101
  v_smfmac_f32_16x16x64_bf16 v[108:111], v[20:23], a[40:47], v7
  ds_write_b32 v4, v139 offset:3072
  v_add_f32 v104, v104, v106
  v_smfmac_f32_16x16x64_bf16 v[108:111], v[24:27], a[64:71], v7
  s_waitcnt lgkmcnt(3)
  s_barrier
  v_add_f32 v105, v105, v107
  v_smfmac_f32_16x16x64_bf16 v[108:111], v[28:31], a[88:95], v7
  ds_read_b64_tr_b16 v[112:113], v5 offset:0
  ds_read_b64_tr_b16 v[114:115], v5 offset:64
  v_cvt_pk_bf16_f32 v140, v104, v105
  v_smfmac_f32_16x16x64_bf16 v[108:111], v[36:39], a[112:119], v7
  ds_write_b32 v4, v140 offset:4096
  ds_read_b64_tr_b16 v[116:117], v5 offset:512
  v_smfmac_f32_16x16x64_bf16 v[108:111], v[40:43], a[136:143], v7
  ds_read_b64_tr_b16 v[118:119], v5 offset:576
  ds_read_b128 v[64:67], v13 offset:1024
  v_smfmac_f32_16x16x64_bf16 v[108:111], v[48:51], a[160:167], v7
  ds_read_b64_tr_b16 v[120:121], v5 offset:1024
  ds_read_b128 v[68:71], v13 offset:3072
  v_smfmac_f32_16x16x64_bf16 v[108:111], v[52:55], a[184:191], v7
  ds_read_b64_tr_b16 v[122:123], v5 offset:1088
  ds_read_b128 v[72:75], v13 offset:4096
  s_waitcnt lgkmcnt(8)
  v_mfma_f32_16x16x32_bf16 v[88:91], v[56:59], v[112:115], 0
  ds_read_b128 v[76:79], v13 offset:6144
  ds_read_b128 v[84:87], v13 offset:7168
  v_mfma_f32_16x16x32_bf16 v[92:95], v[60:63], v[112:115], 0
  ds_read_b64_tr_b16 v[124:125], v5 offset:1536
  ds_read_b64_tr_b16 v[126:127], v5 offset:1600
  s_waitcnt lgkmcnt(8)
  v_add_f32 v108, v108, v110
  v_mfma_f32_16x16x32_bf16 v[88:91], v[64:67], v[116:119], v[88:91]
  s_waitcnt lgkmcnt(6)
  v_add_f32 v109, v109, v111
  v_cvt_pk_bf16_f32 v141, v108, v109
  v_mfma_f32_16x16x32_bf16 v[92:95], v[68:71], v[116:119], v[92:95]
  ds_write_b32 v4, v141 offset:5120
  ds_read_b128 v[56:59], v13 offset:8192
  s_waitcnt lgkmcnt(6)
  v_mfma_f32_16x16x32_bf16 v[88:91], v[72:75], v[120:123], v[88:91]
  ds_read_b64_tr_b16 v[128:129], v5 offset:2048
  ds_read_b64_tr_b16 v[130:131], v5 offset:2112
  buffer_store_dword v6, v11, s[8:11], 0 offen sc1
  s_waitcnt lgkmcnt(7)
  v_mfma_f32_16x16x32_bf16 v[92:95], v[76:79], v[120:123], v[92:95]
  ds_read_b128 v[60:63], v13 offset:10240
  ds_read_b128 v[64:67], v13 offset:9216
  s_waitcnt lgkmcnt(6)
  v_mfma_f32_16x16x32_bf16 v[88:91], v[80:83], v[124:127], v[88:91]
  ds_read_b64_tr_b16 v[132:133], v5 offset:2560
  ds_read_b64_tr_b16 v[134:135], v5 offset:2624
  v_mfma_f32_16x16x32_bf16 v[92:95], v[84:87], v[124:127], v[92:95]
  ds_read_b128 v[68:71], v13 offset:11264
  s_waitcnt lgkmcnt(8)
  s_barrier
  s_waitcnt lgkmcnt(5)
  v_mfma_f32_16x16x32_bf16 v[88:91], v[56:59], v[128:131], v[88:91]
  ds_read_b64_tr_b16 v[16:17], v5 offset:3072
  ds_read_b64_tr_b16 v[18:19], v5 offset:3136
  s_waitcnt lgkmcnt(6)
  v_mfma_f32_16x16x32_bf16 v[92:95], v[60:63], v[128:131], v[92:95]
  ds_read_b64_tr_b16 v[20:21], v5 offset:3584
  ds_read_b64_tr_b16 v[22:23], v5 offset:3648
  s_waitcnt lgkmcnt(5)
  v_mfma_f32_16x16x32_bf16 v[88:91], v[64:67], v[132:135], v[88:91]
  ds_read_b64_tr_b16 v[24:25], v5 offset:4096
  ds_read_b64_tr_b16 v[26:27], v5 offset:4160
  s_waitcnt lgkmcnt(6)
  v_mfma_f32_16x16x32_bf16 v[92:95], v[68:71], v[132:135], v[92:95]
  ds_read_b64_tr_b16 v[28:29], v5 offset:4608
  ds_read_b64_tr_b16 v[30:31], v5 offset:4672
  s_waitcnt lgkmcnt(6)
  v_mfma_f32_16x16x32_bf16 v[96:99], v[16:19], v[112:115], 0
  ds_read_b64_tr_b16 v[32:33], v5 offset:5120
  ds_read_b64_tr_b16 v[34:35], v5 offset:5184
  s_waitcnt lgkmcnt(6)
  v_mfma_f32_16x16x32_bf16 v[96:99], v[20:23], v[116:119], v[96:99]
  ds_read_b64_tr_b16 v[36:37], v5 offset:5632
  ds_read_b64_tr_b16 v[38:39], v5 offset:5696
  s_waitcnt lgkmcnt(6)
  v_cndmask_b32 v136, v88, v90, s[18:19]
  v_mfma_f32_16x16x32_bf16 v[96:99], v[24:27], v[120:123], v[96:99]
  s_barrier
  s_waitcnt lgkmcnt(4)
  v_cndmask_b32 v137, v89, v91, s[18:19]
  v_cndmask_b32 v138, v92, v94, s[18:19]
  v_mfma_f32_16x16x32_bf16 v[96:99], v[28:31], v[124:127], v[96:99]
  s_waitcnt lgkmcnt(2)
  v_cndmask_b32 v139, v93, v95, s[18:19]
  v_max3_f32 v142, v136, v137, v138
  v_mfma_f32_16x16x32_bf16 v[96:99], v[32:35], v[128:131], v[96:99]
  s_waitcnt lgkmcnt(0)
  v_max_f32 v142, v142, v139
  v_mov_b32 v143, v142
  v_mfma_f32_16x16x32_bf16 v[96:99], v[36:39], v[132:135], v[96:99]
  s_nop 0
  v_permlane32_swap_b32 v143, v142
  v_max_f32 v142, v142, v143
  s_nop 4
  v_cndmask_b32 v140, v96, v98, s[18:19]
  v_cndmask_b32 v141, v97, v99, s[18:19]
  v_max3_f32 v142, v142, v140, v141
  s_nop 1
  v_max_f32_dpp v142, v142, v142 row_ror:8 row_mask:0xf bank_mask:0xf
  v_mov_b32 v143, v142
  s_nop 1
  v_permlane16_swap_b32 v143, v142
  v_max_f32 v142, v142, v143
  v_mul_f32 v142, s69, v142
  v_fma_f32 v136, v136, s69, -v142
  v_fma_f32 v137, v137, s69, -v142
  v_fma_f32 v138, v138, s69, -v142
  v_fma_f32 v139, v139, s69, -v142
  v_fma_f32 v140, v140, s69, -v142
  v_fma_f32 v141, v141, s69, -v142
  v_exp_f32 v136, v136
  v_exp_f32 v137, v137
  v_exp_f32 v138, v138
  v_exp_f32 v139, v139
  v_add_f32 v142, v136, v137
  v_add_f32 v143, v138, v139
  v_add_f32 v142, v142, v143
  v_mov_b32 v143, v142
  v_exp_f32 v140, v140
  v_exp_f32 v141, v141
  v_permlane32_swap_b32 v143, v142
  v_add_f32 v144, v140, v141
  v_add_f32 v142, v142, v143
  v_add_f32 v142, v142, v144
  s_nop 1
  v_add_f32_dpp v142, v142, v142 row_ror:8 row_mask:0xf bank_mask:0xf
  v_mov_b32 v143, v142
  s_nop 1
  v_permlane16_swap_b32 v143, v142
  v_add_f32 v142, v142, v143
  v_rcp_f32 v142, v142
  s_nop 0
  v_mul_f32 v136, v136, v142
  v_mul_f32 v137, v137, v142
  v_mul_f32 v138, v138, v142
  v_mul_f32 v139, v139, v142
  v_cvt_pk_bf16_f32 v146, v136, v137
  v_cvt_pk_bf16_f32 v147, v138, v139
  buffer_store_dwordx2 v[146:147], v8, s[8:11], s66 offen sc1
  v_mul_f32 v140, v140, v142
  v_mul_f32 v141, v141, v142
  v_cvt_pk_bf16_f32 v148, v140, v141
  buffer_store_dword v148, v9, s[8:11], s66 offen sc1
  v_mov_b32 v150, -1
  v_mov_b32 v151, -1
  s_add_u32 s46, s65, 0
  buffer_store_dwordx2 v[150:151], v8, s[8:11], s46 offen sc1
  buffer_store_dword v150, v9, s[8:11], s46 offen sc1
  s_mov_b32 s65, s66
  v_add_u32 v13, s22, v13
  s_sub_u32 s22, 0, s22
  s_add_u32 s58, s58, 1
  s_cmp_eq_u32 s58, 3
  s_cselect_b32 s58, 0, s58
  s_mov_b32 s52, s53
  s_cmp_lt_u32 s52, 64
  s_cbranch_scc1 scs_loop
  s_endpgm
sch_loop:
  s_add_u32 s53, s52, 1
  s_lshl_b32 s56, s58, 2
  s_add_u32 s56, s56, s43
  s_lshl_b32 s56, s56, 16
  s_add_u32 s56, s56, s3
  s_add_u32 s56, s56, 12582912
  v_add_u32 v12, s56, v1
  s_lshl_b32 s66, s58, 18
  s_mov_b64 s[16:17], -1
  s_mov_b32 s71, 0
  ds_read_b128 v[56:59], v2 offset:0
  ds_read_b128 v[60:63], v2 offset:4096
  ds_read_b128 v[64:67], v2 offset:8192
  ds_read_b128 v[68:71], v2 offset:12288
  ds_read_b128 v[72:75], v2 offset:16384
  ds_read_b128 v[76:79], v2 offset:20480
  ds_read_b128 v[80:83], v2 offset:24576
  ds_read_b128 v[84:87], v2 offset:28672
  v_mov_b32 v88, 0
  v_mov_b32 v89, 0
  v_mov_b32 v90, 0
  v_mov_b32 v91, 0
  v_mov_b32 v92, 0
  v_mov_b32 v93, 0
  v_mov_b32 v94, 0
  v_mov_b32 v95, 0
  v_mov_b32 v96, 0
  v_mov_b32 v97, 0
  v_mov_b32 v98, 0
  v_mov_b32 v99, 0
  v_mov_b32 v100, 0
  v_mov_b32 v101, 0
  v_mov_b32 v102, 0
  v_mov_b32 v103, 0
  v_mov_b32 v104, 0
  v_mov_b32 v105, 0
  v_mov_b32 v106, 0
  v_mov_b32 v107, 0
  v_mov_b32 v108, 0
  v_mov_b32 v109, 0
  v_mov_b32 v110, 0
  v_mov_b32 v111, 0
  s_xor_b32 s28, s63, 0x2000
  s_add_u32 s28, s28, s26
  s_add_u32 s29, s28, 16777216
  s_add_u32 s30, s28, 33554432
  s_add_u32 s23, s23, 32
  s_cmp_ge_u32 s23, 1024
  s_cselect_b32 s46, 1024, 0
  s_sub_u32 s23, s23, s46
  s_lshr_b32 s63, s23, 1
  s_lshl_b32 s63, s63, 14
  s_and_b32 s46, s23, 1
  s_lshl_b32 s46, s46, 12
  s_add_u32 s63, s63, s46
  s_add_u32 s63, s63, s20
  s_lshr_b32 s46, s63, 8
  s_and_b32 s46, s46, 0x2000
  s_xor_b32 s63, s63, s46
  s_add_u32 s21, s21, s22
  s_mov_b32 m0, s21
  s_cmp_lg_u32 s42, 2
  s_cbranch_scc1 sc_nobell
  s_add_u32 s49, s52, 2
  s_min_u32 s49, s49, 64
  s_cmp_ge_u32 s61, s49
  s_cbranch_scc1 wf_done_21
  s_mov_b32 s50, 0
wf_loop_22:
  buffer_load_dword v136, v15, s[8:11], 0 offen sc1
  s_add_u32 s50, s50, 1
  s_cmp_gt_u32 s50, 131072
  s_cbranch_scc1 L_fail
  s_waitcnt vmcnt(0)
  v_min_u32_dpp v136, v136, v136 row_ror:8 row_mask:0xf bank_mask:0xf
  s_nop 1
  v_min_u32_dpp v136, v136, v136 row_ror:4 row_mask:0xf bank_mask:0xf
  s_nop 1
  v_min_u32_dpp v136, v136, v136 row_ror:2 row_mask:0xf bank_mask:0xf
  s_nop 1
  v_min_u32_dpp v136, v136, v136 row_ror:1 row_mask:0xf bank_mask:0xf
  v_mov_b32 v137, v136
  s_nop 1
  v_permlane16_swap_b32 v137, v136
  v_min_u32 v136, v136, v137
  v_mov_b32 v137, v136
  s_nop 1
  v_permlane32_swap_b32 v137, v136
  v_min_u32 v136, v136, v137
  s_nop 0
  v_readfirstlane_b32 s61, v136
  s_nop 0
  s_cmp_ge_u32 s61, s49
  s_cbranch_scc1 wf_done_21
  s_sleep 2
  s_branch wf_loop_22
wf_done_21:
  s_mov_b32 s50, 0
  s_mov_b64 exec, 15
  buffer_load_dword v112, v10, s[8:11], 0 offen sc1
  s_nop 11
  buffer_load_dword v113, v10, s[8:11], 0 offen sc1
  s_nop 11
  buffer_load_dword v114, v10, s[8:11], 0 offen sc1
  s_nop 11
  buffer_load_dword v115, v10, s[8:11], 0 offen sc1
  s_nop 11
  buffer_load_dword v116, v10, s[8:11], 0 offen sc1
  s_nop 11
  buffer_load_dword v117, v10, s[8:11], 0 offen sc1
  s_nop 11
  buffer_load_dword v118, v10, s[8:11], 0 offen sc1
  s_nop 11
  buffer_load_dword v119, v10, s[8:11], 0 offen sc1
  s_nop 11
  buffer_load_dword v120, v10, s[8:11], 0 offen sc1
  s_nop 11
bell_23:
  buffer_load_dword v121, v10, s[8:11], 0 offen sc1
  s_waitcnt vmcnt(9)
  v_cmp_gt_u32 vcc, s53, v112
  s_cbranch_vccz bell_x_24
  s_nop 7
  buffer_load_dword v112, v10, s[8:11], 0 offen sc1
  s_waitcnt vmcnt(9)
  v_cmp_gt_u32 vcc, s53, v113
  s_cbranch_vccz bell_x_24
  s_nop 7
  buffer_load_dword v113, v10, s[8:11], 0 offen sc1
  s_waitcnt vmcnt(9)
  v_cmp_gt_u32 vcc, s53, v114
  s_cbranch_vccz bell_x_24
  s_nop 7
  buffer_load_dword v114, v10, s[8:11], 0 offen sc1
  s_waitcnt vmcnt(9)
  v_cmp_gt_u32 vcc, s53, v115
  s_cbranch_vccz bell_x_24
  s_nop 7
  buffer_load_dword v115, v10, s[8:11], 0 offen sc1
  s_waitcnt vmcnt(9)
  v_cmp_gt_u32 vcc, s53, v116
  s_cbranch_vccz bell_x_24
  s_nop 7
  buffer_load_dword v116, v10, s[8:11], 0 offen sc1
  s_waitcnt vmcnt(9)
  v_cmp_gt_u32 vcc, s53, v117
  s_cbranch_vccz bell_x_24
  s_nop 7
  buffer_load_dword v117, v10, s[8:11], 0 offen sc1
  s_waitcnt vmcnt(9)
  v_cmp_gt_u32 vcc, s53, v118
  s_cbranch_vccz bell_x_24
  s_nop 7
  buffer_load_dword v118, v10, s[8:11], 0 offen sc1
  s_waitcnt vmcnt(9)
  v_cmp_gt_u32 vcc, s53, v119
  s_cbranch_vccz bell_x_24
  s_nop 7
  buffer_load_dword v119, v10, s[8:11], 0 offen sc1
  s_waitcnt vmcnt(9)
  v_cmp_gt_u32 vcc, s53, v120
  s_cbranch_vccz bell_x_24
  s_nop 7
  buffer_load_dword v120, v10, s[8:11], 0 offen sc1
  s_waitcnt vmcnt(9)
  v_cmp_gt_u32 vcc, s53, v121
  s_cbranch_vccz bell_x_24
  s_add_u32 s50, s50, 1
  s_cmp_gt_u32 s50, 131072
  s_cbranch_scc1 L_fail
  s_branch bell_23
bell_x_24:
  s_mov_b64 exec, -1
sc_nobell:
  s_waitcnt lgkmcnt(0)
  s_barrier
  buffer_load_dwordx4 v[16:19], v12, s[8:11], 0 offen offset:0 sc1
  s_barrier
  buffer_load_dwordx4 v[20:23], v12, s[8:11], 0 offen offset:1024 sc1
  s_barrier
  buffer_load_dwordx4 v[24:27], v12, s[8:11], 0 offen offset:2048 sc1
  s_barrier
  buffer_load_dwordx4 v[28:31], v12, s[8:11], 0 offen offset:3072 sc1
  s_barrier
  buffer_load_dwordx4 v[32:35], v12, s[8:11], s24 offen offset:0 sc1
  s_barrier
  buffer_load_dwordx4 v[36:39], v12, s[8:11], s24 offen offset:1024 sc1
  s_barrier
  buffer_load_dwordx4 v[40:43], v12, s[8:11], s24 offen offset:2048 sc1
  s_barrier
  buffer_load_dwordx4 v[44:47], v12, s[8:11], s24 offen offset:3072 sc1
  s_barrier
  buffer_load_dwordx4 v[48:51], v12, s[8:11], s25 offen offset:0 sc1
  s_barrier
  buffer_load_dwordx4 v[52:55], v12, s[8:11], s25 offen offset:1024 sc1
sch_go_25:
  s_waitcnt vmcnt(9)
  v_smfmac_f32_16x16x64_bf16 v[88:91], v[16:19], a[192:199], v7
  v_smfmac_f32_16x16x64_bf16 v[92:95], v[16:19], a[200:207], v7
  v_smfmac_f32_16x16x64_bf16 v[96:99], v[16:19], a[208:215], v7
  v_smfmac_f32_16x16x64_bf16 v[100:103], v[16:19], a[0:7], v7
  s_waitcnt vmcnt(8)
  v_smfmac_f32_16x16x64_bf16 v[88:91], v[20:23], a[216:223], v7
  v_smfmac_f32_16x16x64_bf16 v[92:95], v[20:23], a[224:231], v7
  v_smfmac_f32_16x16x64_bf16 v[96:99], v[20:23], a[232:239], v7
  v_smfmac_f32_16x16x64_bf16 v[100:103], v[20:23], a[24:31], v7
  s_waitcnt vmcnt(7)
  v_smfmac_f32_16x16x64_bf16 v[88:91], v[24:27], v[56:63], v7
  buffer_load_dwordx4 v[112:115], v1, s[8:11], s28 offen offset:0 sc1
  v_smfmac_f32_16x16x64_bf16 v[92:95], v[24:27], v[64:71], v7
  ds_read_b128 v[56:59], v2 offset:49152
  v_smfmac_f32_16x16x64_bf16 v[96:99], v[24:27], v[72:79], v7
  ds_read_b128 v[60:63], v2 offset:53248
  v_smfmac_f32_16x16x64_bf16 v[100:103], v[24:27], a[48:55], v7
  ds_read_b128 v[64:67], v2 offset:57344
  buffer_load_dwordx4 v[116:119], v1, s[8:11], s28 offen offset:1024 sc1
  s_waitcnt vmcnt(8)
  v_smfmac_f32_16x16x64_bf16 v[88:91], v[28:31], a[240:247], v7
  ds_read_b128 v[68:71], v2 offset:61440
  v_smfmac_f32_16x16x64_bf16 v[92:95], v[28:31], a[248:255], v7
  ds_read_b128 v[72:75], v3 offset:0
  v_smfmac_f32_16x16x64_bf16 v[96:99], v[28:31], v[152:159], v7
  ds_read_b128 v[76:79], v3 offset:4096
  buffer_load_dwordx4 v[120:123], v1, s[8:11], s29 offen offset:0 sc1
  v_smfmac_f32_16x16x64_bf16 v[100:103], v[28:31], a[72:79], v7
  s_waitcnt vmcnt(8)
  v_smfmac_f32_16x16x64_bf16 v[88:91], v[32:35], v[160:167], v7
  v_smfmac_f32_16x16x64_bf16 v[92:95], v[32:35], v[168:175], v7
  buffer_load_dwordx4 v[124:127], v1, s[8:11], s29 offen offset:1024 sc1
  v_smfmac_f32_16x16x64_bf16 v[96:99], v[32:35], v[176:183], v7
  v_smfmac_f32_16x16x64_bf16 v[100:103], v[32:35], v[80:87], v7
  ds_read_b128 v[80:83], v3 offset:8192
  s_waitcnt vmcnt(8)
  s_waitcnt lgkmcnt(5)
  v_smfmac_f32_16x16x64_bf16 v[88:91], v[36:39], v[56:63], v7
  ds_read_b128 v[84:87], v3 offset:12288
  buffer_load_dwordx4 v[128:131], v1, s[8:11], s30 offen offset:0 sc1
  s_waitcnt lgkmcnt(4)
  v_smfmac_f32_16x16x64_bf16 v[92:95], v[36:39], v[64:71], v7
  ds_read_b128 v[56:59], v3 offset:32768
  s_waitcnt lgkmcnt(3)
  v_smfmac_f32_16x16x64_bf16 v[96:99], v[36:39], v[72:79], v7
  ds_read_b128 v[60:63], v3 offset:36864
  v_smfmac_f32_16x16x64_bf16 v[100:103], v[36:39], a[96:103], v7
  ds_read_b128 v[64:67], v3 offset:40960
  buffer_load_dwordx4 v[132:135], v1, s[8:11], s30 offen offset:1024 sc1
  s_waitcnt vmcnt(9)
  v_smfmac_f32_16x16x64_bf16 v[88:91], v[40:43], v[184:191], v7
  ds_read_b128 v[68:71], v3 offset:45056
  v_smfmac_f32_16x16x64_bf16 v[92:95], v[40:43], v[192:199], v7
  ds_read_b128 v[72:75], v3 offset:49152
  v_smfmac_f32_16x16x64_bf16 v[96:99], v[40:43], v[200:207], v7
  ds_read_b128 v[76:79], v3 offset:53248
  buffer_load_dwordx4 v1, s[8:11], s63 offen offset:0 sc1 lds
  v_smfmac_f32_16x16x64_bf16 v[100:103], v[40:43], a[120:127], v7
  s_waitcnt vmcnt(9)
  v_smfmac_f32_16x16x64_bf16 v[88:91], v[44:47], v[208:215], v7
  v_smfmac_f32_16x16x64_bf16 v[92:95], v[44:47], v[216:223], v7
  buffer_load_dwordx4 v1, s[8:11], s63 offen offset:1024 sc1 lds
  v_smfmac_f32_16x16x64_bf16 v[96:99], v[44:47], v[224:231], v7
  s_waitcnt lgkmcnt(6)
  v_smfmac_f32_16x16x64_bf16 v[100:103], v[44:47], v[80:87], v7
  ds_read_b128 v[80:83], v2 offset:32768
  s_waitcnt vmcnt(9)
  s_waitcnt lgkmcnt(5)
  v_smfmac_f32_16x16x64_bf16 v[88:91], v[48:51], v[56:63], v7
  ds_read_b128 v[84:87], v2 offset:36864
  buffer_load_dwordx4 v1, s[8:11], s63 offen offset:2048 sc1 lds
  s_waitcnt lgkmcnt(4)
  v_smfmac_f32_16x16x64_bf16 v[92:95], v[48:51], v[64:71], v7
  ds_read_b128 v[56:59], v3 offset:16384
  s_waitcnt lgkmcnt(3)
  v_smfmac_f32_16x16x64_bf16 v[96:99], v[48:51], v[72:79], v7
  ds_read_b128 v[60:63], v3 offset:20480
  v_smfmac_f32_16x16x64_bf16 v[100:103], v[48:51], a[144:151], v7
  ds_read_b128 v[64:67], v2 offset:40960
  buffer_load_dwordx4 v1, s[8:11], s63 offen offset:3072 sc1 lds
  s_waitcnt vmcnt(10)
  v_smfmac_f32_16x16x64_bf16 v[88:91], v[52:55], v[232:239], v7
  ds_read_b128 v[68:71], v2 offset:45056
  v_smfmac_f32_16x16x64_bf16 v[92:95], v[52:55], v[240:247], v7
  ds_read_b128 v[72:75], v3 offset:24576
  v_smfmac_f32_16x16x64_bf16 v[96:99], v[52:55], v[248:255], v7
  ds_read_b128 v[76:79], v3 offset:28672
  v_smfmac_f32_16x16x64_bf16 v[100:103], v[52:55], a[168:175], v7
  v_smfmac_f32_16x16x64_bf16 v[104:107], v[16:19], a[8:15], v7
  v_add_f32 v88, v88, v90
  v_smfmac_f32_16x16x64_bf16 v[104:107], v[20:23], a[32:39], v7
  v_add_f32 v89, v89, v91
  v_smfmac_f32_16x16x64_bf16 v[104:107], v[24:27], a[56:63], v7
  v_cmp_u_f32 vcc, v88, v89
  v_smfmac_f32_16x16x64_bf16 v[104:107], v[28:31], a[80:87], v7
  v_cvt_pk_bf16_f32 v136, v88, v89
  v_smfmac_f32_16x16x64_bf16 v[104:107], v[36:39], a[104:111], v7
  s_and_b64 vcc, vcc, s[16:17]
  s_cbranch_scc1 sch_redo_26
  v_add_f32 v92, v92, v94
  v_smfmac_f32_16x16x64_bf16 v[104:107], v[40:43], a[128:135], v7
  ds_write_b32 v4, v136 offset:0
  v_add_f32 v93, v93, v95
  v_smfmac_f32_16x16x64_bf16 v[104:107], v[48:51], a[152:159], v7
  s_waitcnt lgkmcnt(1)
  v_cvt_pk_bf16_f32 v137, v92, v93
  v_smfmac_f32_16x16x64_bf16 v[104:107], v[52:55], a[176:183], v7
  ds_write_b32 v4, v137 offset:1024
  v_add_f32 v96, v96, v98
  v_smfmac_f32_16x16x64_bf16 v[104:107], v[32:35], v[80:87], v7
  v_add_f32 v97, v97, v99
  v_smfmac_f32_16x16x64_bf16 v[104:107], v[44:47], v[56:63], v7
  v_cvt_pk_bf16_f32 v138, v96, v97
  v_smfmac_f32_16x16x64_bf16 v[108:111], v[32:35], v[64:71], v7
  ds_write_b32 v4, v138 offset:2048
  v_add_f32 v100, v100, v102
  v_smfmac_f32_16x16x64_bf16 v[108:111], v[44:47], v[72:79], v7
  v_add_f32 v101, v101, v103
  v_smfmac_f32_16x16x64_bf16 v[108:111], v[16:19], a[16:23], v7
  v_cvt_pk_bf16_f32 v139, v100, v101
  v_smfmac_f32_16x16x64_bf16 v[108:111], v[20:23], a[40:47], v7
  ds_write_b32 v4, v139 offset:3072
  v_add_f32 v104, v104, v106
  v_smfmac_f32_16x16x64_bf16 v[108:111], v[24:27], a[64:71], v7
  s_waitcnt lgkmcnt(1)
  s_barrier
  v_add_f32 v105, v105, v107
  v_smfmac_f32_16x16x64_bf16 v[108:111], v[28:31], a[88:95], v7
  v_cvt_pk_bf16_f32 v140, v104, v105
  v_smfmac_f32_16x16x64_bf16 v[108:111], v[36:39], a[112:119], v7
  ds_write_b32 v4, v140 offset:4096
  v_smfmac_f32_16x16x64_bf16 v[108:111], v[40:43], a[136:143], v7
  v_smfmac_f32_16x16x64_bf16 v[108:111], v[48:51], a[160:167], v7
  v_smfmac_f32_16x16x64_bf16 v[108:111], v[52:55], a[184:191], v7
  s_nop 7
  v_add_f32 v108, v108, v110
  v_add_f32 v109, v109, v111
  v_cvt_pk_bf16_f32 v141, v108, v109
  ds_write_b32 v4, v141 offset:5120
  s_waitcnt lgkmcnt(0)
  s_barrier
  s_barrier
  s_cmp_ge_u32 s42, 2
  s_cbranch_scc1 sc_nox
  ds_read_b128 v[56:59], v13 offset:0
  ds_read_b128 v[60:63], v13 offset:2048
  ds_read_b128 v[64:67], v13 offset:1024
  ds_read_b128 v[68:71], v13 offset:3072
  ds_read_b128 v[72:75], v13 offset:4096
  ds_read_b128 v[76:79], v13 offset:6144
  ds_read_b128 v[80:83], v13 offset:5120
  ds_read_b128 v[84:87], v13 offset:7168
  s_waitcnt vmcnt(0)
  s_waitcnt lgkmcnt(7)
  v_mfma_f32_16x16x32_bf16 v[88:91], v[56:59], v[112:115], 0
  ds_read_b128 v[56:59], v13 offset:8192
  s_waitcnt lgkmcnt(7)
  v_mfma_f32_16x16x32_bf16 v[92:95], v[60:63], v[112:115], 0
  ds_read_b128 v[60:63], v13 offset:10240
  s_waitcnt lgkmcnt(7)
  v_mfma_f32_16x16x32_bf16 v[88:91], v[64:67], v[116:119], v[88:91]
  ds_read_b128 v[64:67], v13 offset:9216
  s_waitcnt lgkmcnt(7)
  v_mfma_f32_16x16x32_bf16 v[92:95], v[68:71], v[116:119], v[92:95]
  ds_read_b128 v[68:71], v13 offset:11264
  s_waitcnt lgkmcnt(7)
  v_mfma_f32_16x16x32_bf16 v[88:91], v[72:75], v[120:123], v[88:91]
  ds_read_b64_tr_b16 v[16:17], v5 offset:3072
  ds_read_b64_tr_b16 v[18:19], v5 offset:3136
  s_waitcnt lgkmcnt(8)
  v_mfma_f32_16x16x32_bf16 v[92:95], v[76:79], v[120:123], v[92:95]
  ds_read_b64_tr_b16 v[20:21], v5 offset:3584
  ds_read_b64_tr_b16 v[22:23], v5 offset:3648
  s_waitcnt lgkmcnt(9)
  v_mfma_f32_16x16x32_bf16 v[88:91], v[80:83], v[124:127], v[88:91]
  ds_read_b64_tr_b16 v[24:25], v5 offset:4096
  ds_read_b64_tr_b16 v[26:27], v5 offset:4160
  s_waitcnt lgkmcnt(10)
  v_mfma_f32_16x16x32_bf16 v[92:95], v[84:87], v[124:127], v[92:95]
  ds_read_b64_tr_b16 v[28:29], v5 offset:4608
  ds_read_b64_tr_b16 v[30:31], v5 offset:4672
  s_waitcnt lgkmcnt(11)
  v_mfma_f32_16x16x32_bf16 v[88:91], v[56:59], v[128:131], v[88:91]
  ds_read_b64_tr_b16 v[32:33], v5 offset:5120
  ds_read_b64_tr_b16 v[34:35], v5 offset:5184
  s_waitcnt lgkmcnt(12)
  v_mfma_f32_16x16x32_bf16 v[92:95], v[60:63], v[128:131], v[92:95]
  ds_read_b64_tr_b16 v[36:37], v5 offset:5632
  ds_read_b64_tr_b16 v[38:39], v5 offset:5696
  s_waitcnt lgkmcnt(13)
  v_mfma_f32_16x16x32_bf16 v[88:91], v[64:67], v[132:135], v[88:91]
  s_waitcnt lgkmcnt(12)
  v_mfma_f32_16x16x32_bf16 v[92:95], v[68:71], v[132:135], v[92:95]
  s_waitcnt lgkmcnt(10)
  v_mfma_f32_16x16x32_bf16 v[96:99], v[16:19], v[112:115], 0
  s_waitcnt lgkmcnt(8)
  v_mfma_f32_16x16x32_bf16 v[96:99], v[20:23], v[116:119], v[96:99]
  s_waitcnt lgkmcnt(6)
  v_mfma_f32_16x16x32_bf16 v[96:99], v[24:27], v[120:123], v[96:99]
  s_waitcnt lgkmcnt(4)
  v_mfma_f32_16x16x32_bf16 v[96:99], v[28:31], v[124:127], v[96:99]
  s_waitcnt lgkmcnt(2)
  v_mfma_f32_16x16x32_bf16 v[96:99], v[32:35], v[128:131], v[96:99]
  s_waitcnt lgkmcnt(0)
  v_mfma_f32_16x16x32_bf16 v[96:99], v[36:39], v[132:135], v[96:99]
  v_mov_b32 v143, s70
  v_cndmask_b32 v88, v88, v143, s[72:73]
  v_cndmask_b32 v89, v89, v143, s[74:75]
  v_cndmask_b32 v90, v90, v143, s[76:77]
  v_cndmask_b32 v91, v91, v143, s[78:79]
  v_cndmask_b32 v92, v92, v143, s[80:81]
  v_cndmask_b32 v93, v93, v143, s[82:83]
  v_cndmask_b32 v94, v94, v143, s[84:85]
  v_cndmask_b32 v95, v95, v143, s[86:87]
  s_mov_b32 vcc_lo, 0
  s_mov_b32 vcc_hi, -1
  v_cndmask_b32 v96, v96, v98, vcc
  v_cndmask_b32 v97, v97, v99, vcc
  v_max_f32 v142, v88, v89
  v_max3_f32 v142, v142, v90, v91
  v_max3_f32 v142, v142, v92, v93
  v_max3_f32 v142, v142, v94, v95
  v_max3_f32 v142, v142, v96, v97
  v_mov_b32 v143, v142
  s_nop 1
  v_permlane16_swap_b32 v143, v142
  v_max_f32 v142, v142, v143
  v_mov_b32 v143, v142
  s_nop 1
  v_permlane32_swap_b32 v143, v142
  v_max_f32 v142, v142, v143
  v_mul_f32 v142, s69, v142
  v_fma_f32 v88, v88, s69, -v142
  v_fma_f32 v89, v89, s69, -v142
  v_fma_f32 v90, v90, s69, -v142
  v_fma_f32 v91, v91, s69, -v142
  v_fma_f32 v92, v92, s69, -v142
  v_fma_f32 v93, v93, s69, -v142
  v_fma_f32 v94, v94, s69, -v142
  v_fma_f32 v95, v95, s69, -v142
  v_fma_f32 v96, v96, s69, -v142
  v_fma_f32 v97, v97, s69, -v142
  v_exp_f32 v88, v88
  v_exp_f32 v89, v89
  v_exp_f32 v90, v90
  v_exp_f32 v91, v91
  v_exp_f32 v92, v92
  v_exp_f32 v93, v93
  v_exp_f32 v94, v94
  v_exp_f32 v95, v95
  v_exp_f32 v96, v96
  v_exp_f32 v97, v97
  v_add_f32 v142, v88, v89
  v_add_f32 v142, v142, v90
  v_add_f32 v142, v142, v91
  v_add_f32 v142, v142, v92
  v_add_f32 v142, v142, v93
  v_add_f32 v142, v142, v94
  v_add_f32 v142, v142, v95
  v_add_f32 v142, v142, v96
  v_add_f32 v142, v142, v97
  v_mov_b32 v143, v142
  s_nop 1
  v_permlane16_swap_b32 v143, v142
  v_add_f32 v142, v142, v143
  v_mov_b32 v143, v142
  s_nop 1
  v_permlane32_swap_b32 v143, v142
  v_add_f32 v142, v142, v143
  v_rcp_f32 v142, v142
  s_nop 0
  v_mul_f32 v88, v88, v142
  v_mul_f32 v89, v89, v142
  v_mul_f32 v90, v90, v142
  v_mul_f32 v91, v91, v142
  v_mul_f32 v92, v92, v142
  v_mul_f32 v93, v93, v142
  v_mul_f32 v94, v94, v142
  v_mul_f32 v95, v95, v142
  v_mul_f32 v96, v96, v142
  v_mul_f32 v97, v97, v142
  v_cvt_pk_bf16_f32 v144, v88, v89
  v_cvt_pk_bf16_f32 v145, v90, v91
  v_cvt_pk_bf16_f32 v146, v92, v93
  v_cvt_pk_bf16_f32 v147, v94, v95
  v_cvt_pk_bf16_f32 v148, v96, v97
  s_mov_b32 s47, s64
  s_lshr_b32 s46, s47, 8
  s_and_b32 s46, s46, 0x2000
  s_xor_b32 s47, s47, s46
  s_add_u32 s46, s47, s27
  buffer_store_dwordx4 v[144:147], v1, s[8:11], s46 offen sc1
  buffer_store_dword v148, v14, s[8:11], s47 offen sc1
  s_add_u32 s64, s64, 262144
  s_cmp_ge_u32 s64, 16777216
  s_cselect_b32 s46, 2097152, 0
  s_sub_u32 s64, s64, s46
  s_branch sc_join
sc_nox:
  s_waitcnt vmcnt(0)
sc_join:
  v_add_u32 v13, s22, v13
  s_sub_u32 s22, 0, s22
  s_add_u32 s58, s58, 1
  s_cmp_eq_u32 s58, 3
  s_cselect_b32 s58, 0, s58
  s_mov_b32 s52, s53
  s_cmp_lt_u32 s52, 64
  s_cbranch_scc1 sch_loop
  s_waitcnt vmcnt(0)
  s_cmp_ge_u32 s42, 2
  s_cbranch_scc1 L_end
  v_mov_b32 v136, s52
  s_mov_b64 exec, 1
  buffer_store_dword v136, v15, s[8:11], 0 offen sc1
  s_mov_b64 exec, -1
  s_endpgm
scs_redo_20:
  s_mov_b32 s50, 0
scs_poll_27:
  buffer_load_dwordx4 v[16:19], v12, s[8:11], 0 offen offset:0 sc1
  buffer_load_dwordx4 v[20:23], v12, s[8:11], 0 offen offset:1024 sc1
  buffer_load_dwordx4 v[24:27], v12, s[8:11], 0 offen offset:2048 sc1
  buffer_load_dwordx4 v[28:31], v12, s[8:11], 0 offen offset:3072 sc1
  buffer_load_dwordx4 v[32:35], v12, s[8:11], s24 offen offset:0 sc1
  buffer_load_dwordx4 v[36:39], v12, s[8:11], s24 offen offset:1024 sc1
  buffer_load_dwordx4 v[40:43], v12, s[8:11], s24 offen offset:2048 sc1
  buffer_load_dwordx4 v[44:47], v12, s[8:11], s24 offen offset:3072 sc1
  buffer_load_dwordx4 v[48:51], v12, s[8:11], s25 offen offset:0 sc1
  buffer_load_dwordx4 v[52:55], v12, s[8:11], s25 offen offset:1024 sc1
  s_add_u32 s71, s71, 1
  s_cmp_le_u32 s71, 2
  s_cbranch_scc1 scs_again_28
  s_add_u32 s50, s50, 1
  s_cmp_gt_u32 s50, 131072
  s_cbranch_scc1 L_fail
  s_waitcnt vmcnt(0)
  v_max_u32 v149, v16, v17
  v_max3_u32 v149, v18, v19, v149
  v_max3_u32 v149, v20, v21, v149
  v_max3_u32 v149, v22, v23, v149
  v_max3_u32 v149, v24, v25, v149
  v_max3_u32 v149, v26, v27, v149
  v_max3_u32 v149, v28, v29, v149
  v_max3_u32 v149, v30, v31, v149
  v_max3_u32 v149, v32, v33, v149
  v_max3_u32 v149, v34, v35, v149
  v_max3_u32 v149, v36, v37, v149
  v_max3_u32 v149, v38, v39, v149
  v_max3_u32 v149, v40, v41, v149
  v_max3_u32 v149, v42, v43, v149
  v_max3_u32 v149, v44, v45, v149
  v_max3_u32 v149, v46, v47, v149
  v_max3_u32 v149, v48, v49, v149
  v_max3_u32 v149, v50, v51, v149
  v_max3_u32 v149, v52, v53, v149
  v_max3_u32 v149, v54, v55, v149
  v_cmp_eq_u32 vcc, -1, v149
  s_cbranch_vccnz scs_poll_27
  s_mov_b64 s[16:17], 0
scs_again_28:
  s_waitcnt lgkmcnt(0)
  ds_read_b128 v[56:59], v2 offset:0
  ds_read_b128 v[60:63], v2 offset:4096
  ds_read_b128 v[64:67], v2 offset:8192
  ds_read_b128 v[68:71], v2 offset:12288
  ds_read_b128 v[72:75], v2 offset:16384
  ds_read_b128 v[76:79], v2 offset:20480
  ds_read_b128 v[80:83], v2 offset:24576
  ds_read_b128 v[84:87], v2 offset:28672
  v_mov_b32 v88, 0
  v_mov_b32 v89, 0
  v_mov_b32 v90, 0
  v_mov_b32 v91, 0
  v_mov_b32 v92, 0
  v_mov_b32 v93, 0
  v_mov_b32 v94, 0
  v_mov_b32 v95, 0
  v_mov_b32 v96, 0
  v_mov_b32 v97, 0
  v_mov_b32 v98, 0
  v_mov_b32 v99, 0
  v_mov_b32 v100, 0
  v_mov_b32 v101, 0
  v_mov_b32 v102, 0
  v_mov_b32 v103, 0
  v_mov_b32 v104, 0
  v_mov_b32 v105, 0
  v_mov_b32 v106, 0
  v_mov_b32 v107, 0
  v_mov_b32 v108, 0
  v_mov_b32 v109, 0
  v_mov_b32 v110, 0
  v_mov_b32 v111, 0
  s_waitcnt lgkmcnt(0)
  s_branch scs_go_19
sch_redo_26:
  s_mov_b32 s50, 0
sch_poll_29:
  buffer_load_dwordx4 v[16:19], v12, s[8:11], 0 offen offset:0 sc1
  buffer_load_dwordx4 v[20:23], v12, s[8:11], 0 offen offset:1024 sc1
  buffer_load_dwordx4 v[24:27], v12, s[8:11], 0 offen offset:2048 sc1
  buffer_load_dwordx4 v[28:31], v12, s[8:11], 0 offen offset:3072 sc1
  buffer_load_dwordx4 v[32:35], v12, s[8:11], s24 offen offset:0 sc1
  buffer_load_dwordx4 v[36:39], v12, s[8:11], s24 offen offset:1024 sc1
  buffer_load_dwordx4 v[40:43], v12, s[8:11], s24 offen offset:2048 sc1
  buffer_load_dwordx4 v[44:47], v12, s[8:11], s24 offen offset:3072 sc1
  buffer_load_dwordx4 v[48:51], v12, s[8:11], s25 offen offset:0 sc1
  buffer_load_dwordx4 v[52:55], v12, s[8:11], s25 offen offset:1024 sc1
  s_add_u32 s71, s71, 1
  s_cmp_le_u32 s71, 2
  s_cbranch_scc1 sch_again_30
  s_add_u32 s50, s50, 1
  s_cmp_gt_u32 s50, 131072
  s_cbranch_scc1 L_fail
  s_waitcnt vmcnt(0)
  v_max_u32 v149, v16, v17
  v_max3_u32 v149, v18, v19, v149
  v_max3_u32 v149, v20, v21, v149
  v_max3_u32 v149, v22, v23, v149
  v_max3_u32 v149, v24, v25, v149
  v_max3_u32 v149, v26, v27, v149
  v_max3_u32 v149, v28, v29, v149
  v_max3_u32 v149, v30, v31, v149
  v_max3_u32 v149, v32, v33, v149
  v_max3_u32 v149, v34, v35, v149
  v_max3_u32 v149, v36, v37, v149
  v_max3_u32 v149, v38, v39, v149
  v_max3_u32 v149, v40, v41, v149
  v_max3_u32 v149, v42, v43, v149
  v_max3_u32 v149, v44, v45, v149
  v_max3_u32 v149, v46, v47, v149
  v_max3_u32 v149, v48, v49, v149
  v_max3_u32 v149, v50, v51, v149
  v_max3_u32 v149, v52, v53, v149
  v_max3_u32 v149, v54, v55, v149
  v_cmp_eq_u32 vcc, -1, v149
  s_cbranch_vccnz sch_poll_29
  s_mov_b64 s[16:17], 0
sch_again_30:
  s_waitcnt lgkmcnt(0)
  ds_read_b128 v[56:59], v2 offset:0
  ds_read_b128 v[60:63], v2 offset:4096
  ds_read_b128 v[64:67], v2 offset:8192
  ds_read_b128 v[68:71], v2 offset:12288
  ds_read_b128 v[72:75], v2 offset:16384
  ds_read_b128 v[76:79], v2 offset:20480
  ds_read_b128 v[80:83], v2 offset:24576
  ds_read_b128 v[84:87], v2 offset:28672
  v_mov_b32 v88, 0
  v_mov_b32 v89, 0
  v_mov_b32 v90, 0
  v_mov_b32 v91, 0
  v_mov_b32 v92, 0
  v_mov_b32 v93, 0
  v_mov_b32 v94, 0
  v_mov_b32 v95, 0
  v_mov_b32 v96, 0
  v_mov_b32 v97, 0
  v_mov_b32 v98, 0
  v_mov_b32 v99, 0
  v_mov_b32 v100, 0
  v_mov_b32 v101, 0
  v_mov_b32 v102, 0
  v_mov_b32 v103, 0
  v_mov_b32 v104, 0
  v_mov_b32 v105, 0
  v_mov_b32 v106, 0
  v_mov_b32 v107, 0
  v_mov_b32 v108, 0
  v_mov_b32 v109, 0
  v_mov_b32 v110, 0
  v_mov_b32 v111, 0
  s_waitcnt lgkmcnt(0)
  s_branch sch_go_25
L_value:
  s_mov_b32 s4, s30
  s_mov_b32 s5, s31
  s_mov_b32 s6, 7864320
  s_mov_b32 s7, 0x20000
  s_mov_b32 s12, s32
  s_mov_b32 s13, s33
  s_mov_b32 s14, 7864320
  s_mov_b32 s15, 0x20000
  v_lshrrev_b32 v140, 3, v0
  v_lshrrev_b32 v141, 2, v140
  v_lshlrev_b32 v141, 3, v141
  v_and_b32 v64, 3, v140
  v_add_u32 v64, v64, v141
  s_and_b32 s46, s42, 1
  s_lshl_b32 s46, s46, 2
  s_lshr_b32 s47, s42, 1
  s_lshl_b32 s47, s47, 4
  s_add_u32 s46, s46, s47
  v_add_u32 v64, s46, v64
  v_mul_u32_u24 v64, 12288, v64
  v_lshrrev_b32 v140, 1, v140
  v_bfe_u32 v141, v0, 1, 2
  v_xor_b32 v140, v140, v141
  v_lshlrev_b32 v140, 5, v140
  v_and_b32 v141, 1, v0
  v_lshlrev_b32 v141, 4, v141
  v_add3_u32 v64, v64, v140, v141
  v_lshrrev_b32 v140, 3, v0
  v_lshrrev_b32 v141, 2, v140
  v_lshlrev_b32 v141, 3, v141
  v_and_b32 v65, 3, v140
  v_add_u32 v65, v65, v141
  s_and_b32 s46, s42, 1
  s_lshl_b32 s46, s46, 2
  s_lshr_b32 s47, s42, 1
  s_lshl_b32 s47, s47, 4
  s_add_u32 s46, s46, s47
  v_add_u32 v65, s46, v65
  v_mul_u32_u24 v65, 1280, v65
  v_lshrrev_b32 v140, 1, v140
  v_bfe_u32 v141, v0, 1, 2
  v_xor_b32 v140, v140, v141
  v_lshlrev_b32 v140, 5, v140
  v_and_b32 v141, 1, v0
  v_lshlrev_b32 v141, 4, v141
  v_add3_u32 v65, v65, v140, v141
  v_lshrrev_b32 v140, 5, v0
  v_lshlrev_b32 v66, 11, v140
  v_bfe_u32 v140, v0, 2, 3
  v_lshl_add_u32 v66, v140, 7, v66
  v_lshrrev_b32 v140, 1, v140
  v_xor_b32 v140, s42, v140
  v_lshl_add_u32 v66, v140, 5, v66
  v_and_b32 v140, 3, v0
  v_lshl_add_u32 v66, v140, 3, v66
  v_add_u32 v67, 0x10000, v66
  v_add_u32 v68, 0x20000, v66
  v_lshlrev_b32 v1, 4, v0
  v_add_u32 v2, s51, v1
  v_add_u32 v3, 0x10000, v2
  s_mul_i32 s62, s45, 384
  s_mul_i32 s63, s45, 245760
  s_mov_b32 s24, 4096
  s_mov_b32 s25, 49152
  s_add_u32 m0, s51, 73728
  s_add_u32 s46, s62, 0
  buffer_load_dwordx4 v64, s[4:7], s46 offen lds
  s_add_u32 m0, s51, 77824
  s_add_u32 s46, s62, 393216
  buffer_load_dwordx4 v64, s[4:7], s46 offen lds
  s_add_u32 m0, s51, 81920
  s_add_u32 s46, s62, 128
  buffer_load_dwordx4 v64, s[4:7], s46 offen lds
  s_add_u32 m0, s51, 86016
  s_add_u32 s46, s62, 393344
  buffer_load_dwordx4 v64, s[4:7], s46 offen lds
  s_add_u32 m0, s51, 90112
  s_add_u32 s46, s62, 256
  buffer_load_dwordx4 v64, s[4:7], s46 offen lds
  s_add_u32 m0, s51, 94208
  s_add_u32 s46, s62, 393472
  buffer_load_dwordx4 v64, s[4:7], s46 offen lds
  s_add_u32 m0, s51, 98304
  s_add_u32 s46, s62, 1572864
  buffer_load_dwordx4 v64, s[4:7], s46 offen lds
  s_add_u32 m0, s51, 102400
  s_add_u32 s46, s62, 1966080
  buffer_load_dwordx4 v64, s[4:7], s46 offen lds
  s_add_u32 m0, s51, 106496
  s_add_u32 s46, s62, 1572992
  buffer_load_dwordx4 v64, s[4:7], s46 offen lds
  s_add_u32 m0, s51, 110592
  s_add_u32 s46, s62, 1966208
  buffer_load_dwordx4 v64, s[4:7], s46 offen lds
  s_add_u32 m0, s51, 114688
  s_add_u32 s46, s62, 1573120
  buffer_load_dwordx4 v64, s[4:7], s46 offen lds
  s_add_u32 m0, s51, 118784
  s_add_u32 s46, s62, 1966336
  buffer_load_dwordx4 v64, s[4:7], s46 offen lds
  s_add_u32 m0, s51, 122880
  s_add_u32 s46, s62, 3145728
  buffer_load_dwordx4 v64, s[4:7], s46 offen lds
  s_add_u32 m0, s51, 126976
  s_add_u32 s46, s62, 3538944
  buffer_load_dwordx4 v64, s[4:7], s46 offen lds
  s_add_u32 m0, s51, 131072
  s_add_u32 s46, s62, 3145856
  buffer_load_dwordx4 v64, s[4:7], s46 offen lds
  s_add_u32 m0, s51, 135168
  s_add_u32 s46, s62, 3539072
  buffer_load_dwordx4 v64, s[4:7], s46 offen lds
  s_add_u32 m0, s51, 139264
  s_add_u32 s46, s62, 3145984
  buffer_load_dwordx4 v64, s[4:7], s46 offen lds
  s_add_u32 m0, s51, 143360
  s_add_u32 s46, s62, 3539200
  buffer_load_dwordx4 v64, s[4:7], s46 offen lds
  s_add_u32 m0, s51, 0
  s_add_u32 s46, s62, 4718592
  buffer_load_dwordx4 v64, s[4:7], s46 offen lds
  s_add_u32 m0, s51, 4096
  s_add_u32 s46, s62, 5111808
  buffer_load_dwordx4 v64, s[4:7], s46 offen lds
  s_add_u32 m0, s51, 8192
  s_add_u32 s46, s62, 4718720
  buffer_load_dwordx4 v64, s[4:7], s46 offen lds
  s_add_u32 m0, s51, 12288
  s_add_u32 s46, s62, 5111936
  buffer_load_dwordx4 v64, s[4:7], s46 offen lds
  s_add_u32 m0, s51, 16384
  s_add_u32 s46, s62, 4718848
  buffer_load_dwordx4 v64, s[4:7], s46 offen lds
  s_add_u32 m0, s51, 20480
  s_add_u32 s46, s62, 5112064
  buffer_load_dwordx4 v64, s[4:7], s46 offen lds
  s_add_u32 m0, s51, 24576
  s_add_u32 s46, s62, 6291456
  buffer_load_dwordx4 v64, s[4:7], s46 offen lds
  s_add_u32 m0, s51, 28672
  s_add_u32 s46, s62, 6684672
  buffer_load_dwordx4 v64, s[4:7], s46 offen lds
  s_add_u32 m0, s51, 32768
  s_add_u32 s46, s62, 6291584
  buffer_load_dwordx4 v64, s[4:7], s46 offen lds
  s_add_u32 m0, s51, 36864
  s_add_u32 s46, s62, 6684800
  buffer_load_dwordx4 v64, s[4:7], s46 offen lds
  s_add_u32 m0, s51, 40960
  s_add_u32 s46, s62, 6291712
  buffer_load_dwordx4 v64, s[4:7], s46 offen lds
  s_add_u32 m0, s51, 45056
  s_add_u32 s46, s62, 6684928
  buffer_load_dwordx4 v64, s[4:7], s46 offen lds
  s_waitcnt vmcnt(24)
  s_barrier
  s_add_u32 m0, s51, 49152
  s_add_u32 s46, s63, 0
  buffer_load_dwordx4 v65, s[12:15], s46 offen lds
  s_add_u32 m0, s51, 53248
  s_add_u32 s46, s63, 128
  buffer_load_dwordx4 v65, s[12:15], s46 offen lds
  s_add_u32 m0, s51, 57344
  s_add_u32 s46, s63, 256
  buffer_load_dwordx4 v65, s[12:15], s46 offen lds
  s_add_u32 m0, s51, 61440
  s_add_u32 s46, s63, 384
  buffer_load_dwordx4 v65, s[12:15], s46 offen lds
  s_add_u32 m0, s51, 65536
  s_add_u32 s46, s63, 512
  buffer_load_dwordx4 v65, s[12:15], s46 offen lds
  s_add_u32 m0, s51, 69632
  s_add_u32 s46, s63, 640
  buffer_load_dwordx4 v65, s[12:15], s46 offen lds
  ds_read_b64_tr_b16 a[240:241], v67 offset:8192
  ds_read_b64_tr_b16 a[242:243], v67 offset:9216
  ds_read_b64_tr_b16 a[244:245], v67 offset:12288
  ds_read_b64_tr_b16 a[246:247], v67 offset:13312
  ds_read_b64_tr_b16 a[248:249], v67 offset:16384
  ds_read_b64_tr_b16 a[250:251], v67 offset:17408
  ds_read_b64_tr_b16 a[252:253], v67 offset:20480
  ds_read_b64_tr_b16 a[254:255], v67 offset:21504
  ds_read_b64_tr_b16 v[152:153], v67 offset:24576
  ds_read_b64_tr_b16 v[154:155], v67 offset:25600
  ds_read_b64_tr_b16 v[156:157], v67 offset:28672
  ds_read_b64_tr_b16 v[158:159], v67 offset:29696
  s_waitcnt lgkmcnt(0)
  s_waitcnt vmcnt(24)
  s_barrier
  s_add_u32 m0, s51, 73728
  s_add_u32 s46, s63, 768
  buffer_load_dwordx4 v65, s[12:15], s46 offen lds
  s_add_u32 m0, s51, 77824
  s_add_u32 s46, s63, 896
  buffer_load_dwordx4 v65, s[12:15], s46 offen lds
  s_add_u32 m0, s51, 81920
  s_add_u32 s46, s63, 1024
  buffer_load_dwordx4 v65, s[12:15], s46 offen lds
  s_add_u32 m0, s51, 86016
  s_add_u32 s46, s63, 1152
  buffer_load_dwordx4 v65, s[12:15], s46 offen lds
  s_add_u32 m0, s51, 90112
  s_add_u32 s46, s63, 40960
  buffer_load_dwordx4 v65, s[12:15], s46 offen lds
  s_add_u32 m0, s51, 94208
  s_add_u32 s46, s63, 41088
  buffer_load_dwordx4 v65, s[12:15], s46 offen lds
  ds_read_b64_tr_b16 v[160:161], v67 offset:32768
  ds_read_b64_tr_b16 v[162:163], v67 offset:33792
  ds_read_b64_tr_b16 v[164:165], v67 offset:36864
  ds_read_b64_tr_b16 v[166:167], v67 offset:37888
  ds_read_b64_tr_b16 v[168:169], v67 offset:40960
  ds_read_b64_tr_b16 v[170:171], v67 offset:41984
  ds_read_b64_tr_b16 v[172:173], v67 offset:45056
  ds_read_b64_tr_b16 v[174:175], v67 offset:46080
  ds_read_b64_tr_b16 v[176:177], v67 offset:49152
  ds_read_b64_tr_b16 v[178:179], v67 offset:50176
  ds_read_b64_tr_b16 v[180:181], v67 offset:53248
  ds_read_b64_tr_b16 v[182:183], v67 offset:54272
  s_waitcnt lgkmcnt(0)
  s_waitcnt vmcnt(24)
  s_barrier
  s_add_u32 m0, s51, 98304
  s_add_u32 s46, s63, 41216
  buffer_load_dwordx4 v65, s[12:15], s46 offen lds
  s_add_u32 m0, s51, 102400
  s_add_u32 s46, s63, 41344
  buffer_load_dwordx4 v65, s[12:15], s46 offen lds
  s_add_u32 m0, s51, 106496
  s_add_u32 s46, s63, 41472
  buffer_load_dwordx4 v65, s[12:15], s46 offen lds
  s_add_u32 m0, s51, 110592
  s_add_u32 s46, s63, 41600
  buffer_load_dwordx4 v65, s[12:15], s46 offen lds
  s_add_u32 m0, s51, 114688
  s_add_u32 s46, s63, 41728
  buffer_load_dwordx4 v65, s[12:15], s46 offen lds
  s_add_u32 m0, s51, 118784
  s_add_u32 s46, s63, 41856
  buffer_load_dwordx4 v65, s[12:15], s46 offen lds
  ds_read_b64_tr_b16 v[184:185], v67 offset:57344
  ds_read_b64_tr_b16 v[186:187], v67 offset:58368
  ds_read_b64_tr_b16 v[188:189], v67 offset:61440
  ds_read_b64_tr_b16 v[190:191], v67 offset:62464
  ds_read_b64_tr_b16 v[192:193], v68 offset:0
  ds_read_b64_tr_b16 v[194:195], v68 offset:1024
  ds_read_b64_tr_b16 v[196:197], v68 offset:4096
  ds_read_b64_tr_b16 v[198:199], v68 offset:5120
  ds_read_b64_tr_b16 v[200:201], v68 offset:8192
  ds_read_b64_tr_b16 v[202:203], v68 offset:9216
  ds_read_b64_tr_b16 v[204:205], v68 offset:12288
  ds_read_b64_tr_b16 v[206:207], v68 offset:13312
  s_waitcnt lgkmcnt(0)
  s_waitcnt vmcnt(24)
  s_barrier
  s_add_u32 m0, s51, 122880
  s_add_u32 s46, s63, 41984
  buffer_load_dwordx4 v65, s[12:15], s46 offen lds
  s_add_u32 m0, s51, 126976
  s_add_u32 s46, s63, 42112
  buffer_load_dwordx4 v65, s[12:15], s46 offen lds
  s_add_u32 m0, s51, 131072
  s_add_u32 s46, s63, 81920
  buffer_load_dwordx4 v65, s[12:15], s46 offen lds
  s_add_u32 m0, s51, 135168
  s_add_u32 s46, s63, 82048
  buffer_load_dwordx4 v65, s[12:15], s46 offen lds
  s_add_u32 m0, s51, 139264
  s_add_u32 s46, s63, 82176
  buffer_load_dwordx4 v65, s[12:15], s46 offen lds
  s_add_u32 m0, s51, 143360
  s_add_u32 s46, s63, 82304
  buffer_load_dwordx4 v65, s[12:15], s46 offen lds
  ds_read_b64_tr_b16 v[208:209], v66 offset:0
  ds_read_b64_tr_b16 v[210:211], v66 offset:1024
  ds_read_b64_tr_b16 v[212:213], v66 offset:4096
  ds_read_b64_tr_b16 v[214:215], v66 offset:5120
  ds_read_b64_tr_b16 v[216:217], v66 offset:8192
  ds_read_b64_tr_b16 v[218:219], v66 offset:9216
  ds_read_b64_tr_b16 v[220:221], v66 offset:12288
  ds_read_b64_tr_b16 v[222:223], v66 offset:13312
  ds_read_b64_tr_b16 v[224:225], v66 offset:16384
  ds_read_b64_tr_b16 v[226:227], v66 offset:17408
  ds_read_b64_tr_b16 v[228:229], v66 offset:20480
  ds_read_b64_tr_b16 v[230:231], v66 offset:21504
  s_waitcnt lgkmcnt(0)
  s_waitcnt vmcnt(24)
  s_barrier
  s_add_u32 m0, s51, 0
  s_add_u32 s46, s63, 82432
  buffer_load_dwordx4 v65, s[12:15], s46 offen lds
  s_add_u32 m0, s51, 4096
  s_add_u32 s46, s63, 82560
  buffer_load_dwordx4 v65, s[12:15], s46 offen lds
  s_add_u32 m0, s51, 8192
  s_add_u32 s46, s63, 82688
  buffer_load_dwordx4 v65, s[12:15], s46 offen lds
  s_add_u32 m0, s51, 12288
  s_add_u32 s46, s63, 82816
  buffer_load_dwordx4 v65, s[12:15], s46 offen lds
  s_add_u32 m0, s51, 16384
  s_add_u32 s46, s63, 82944
  buffer_load_dwordx4 v65, s[12:15], s46 offen lds
  s_add_u32 m0, s51, 20480
  s_add_u32 s46, s63, 83072
  buffer_load_dwordx4 v65, s[12:15], s46 offen lds
  ds_read_b64_tr_b16 v[232:233], v66 offset:24576
  ds_read_b64_tr_b16 v[234:235], v66 offset:25600
  ds_read_b64_tr_b16 v[236:237], v66 offset:28672
  ds_read_b64_tr_b16 v[238:239], v66 offset:29696
  ds_read_b64_tr_b16 v[240:241], v66 offset:32768
  ds_read_b64_tr_b16 v[242:243], v66 offset:33792
  ds_read_b64_tr_b16 v[244:245], v66 offset:36864
  ds_read_b64_tr_b16 v[246:247], v66 offset:37888
  ds_read_b64_tr_b16 v[248:249], v66 offset:40960
  ds_read_b64_tr_b16 v[250:251], v66 offset:41984
  ds_read_b64_tr_b16 v[252:253], v66 offset:45056
  ds_read_b64_tr_b16 v[254:255], v66 offset:46080
  s_waitcnt lgkmcnt(0)
  s_waitcnt vmcnt(24)
  s_barrier
  s_add_u32 m0, s51, 24576
  s_add_u32 s46, s63, 122880
  buffer_load_dwordx4 v65, s[12:15], s46 offen lds
  s_add_u32 m0, s51, 28672
  s_add_u32 s46, s63, 123008
  buffer_load_dwordx4 v65, s[12:15], s46 offen lds
  s_add_u32 m0, s51, 32768
  s_add_u32 s46, s63, 123136
  buffer_load_dwordx4 v65, s[12:15], s46 offen lds
  s_add_u32 m0, s51, 36864
  s_add_u32 s46, s63, 123264
  buffer_load_dwordx4 v65, s[12:15], s46 offen lds
  s_add_u32 m0, s51, 40960
  s_add_u32 s46, s63, 123392
  buffer_load_dwordx4 v65, s[12:15], s46 offen lds
  s_add_u32 m0, s51, 45056
  s_add_u32 s46, s63, 123520
  buffer_load_dwordx4 v65, s[12:15], s46 offen lds
  ds_read_b64_tr_b16 a[0:1], v66 offset:49152
  ds_read_b64_tr_b16 a[2:3], v66 offset:50176
  ds_read_b64_tr_b16 a[24:25], v66 offset:53248
  ds_read_b64_tr_b16 a[26:27], v66 offset:54272
  ds_read_b64_tr_b16 a[48:49], v66 offset:57344
  ds_read_b64_tr_b16 a[50:51], v66 offset:58368
  ds_read_b64_tr_b16 a[72:73], v66 offset:61440
  ds_read_b64_tr_b16 a[74:75], v66 offset:62464
  ds_read_b64_tr_b16 a[96:97], v67 offset:0
  ds_read_b64_tr_b16 a[98:99], v67 offset:1024
  ds_read_b64_tr_b16 a[120:121], v67 offset:4096
  ds_read_b64_tr_b16 a[122:123], v67 offset:5120
  s_waitcnt lgkmcnt(0)
  s_waitcnt vmcnt(24)
  s_barrier
  s_add_u32 m0, s51, 49152
  s_add_u32 s46, s63, 123648
  buffer_load_dwordx4 v65, s[12:15], s46 offen lds
  s_add_u32 m0, s51, 53248
  s_add_u32 s46, s63, 123776
  buffer_load_dwordx4 v65, s[12:15], s46 offen lds
  s_add_u32 m0, s51, 57344
  s_add_u32 s46, s63, 123904
  buffer_load_dwordx4 v65, s[12:15], s46 offen lds
  s_add_u32 m0, s51, 61440
  s_add_u32 s46, s63, 124032
  buffer_load_dwordx4 v65, s[12:15], s46 offen lds
  s_add_u32 m0, s51, 65536
  s_add_u32 s46, s63, 163840
  buffer_load_dwordx4 v65, s[12:15], s46 offen lds
  s_add_u32 m0, s51, 69632
  s_add_u32 s46, s63, 163968
  buffer_load_dwordx4 v65, s[12:15], s46 offen lds
  ds_read_b64_tr_b16 a[144:145], v67 offset:8192
  ds_read_b64_tr_b16 a[146:147], v67 offset:9216
  ds_read_b64_tr_b16 a[168:169], v67 offset:12288
  ds_read_b64_tr_b16 a[170:171], v67 offset:13312
  ds_read_b64_tr_b16 a[192:193], v67 offset:16384
  ds_read_b64_tr_b16 a[194:195], v67 offset:17408
  ds_read_b64_tr_b16 a[216:217], v67 offset:20480
  ds_read_b64_tr_b16 a[218:219], v67 offset:21504
  ds_read_b64_tr_b16 a[4:5], v67 offset:24576
  ds_read_b64_tr_b16 a[6:7], v67 offset:25600
  ds_read_b64_tr_b16 a[28:29], v67 offset:28672
  ds_read_b64_tr_b16 a[30:31], v67 offset:29696
  s_waitcnt lgkmcnt(0)
  s_waitcnt vmcnt(24)
  s_barrier
  s_add_u32 m0, s51, 73728
  s_add_u32 s46, s63, 164096
  buffer_load_dwordx4 v65, s[12:15], s46 offen lds
  s_add_u32 m0, s51, 77824
  s_add_u32 s46, s63, 164224
  buffer_load_dwordx4 v65, s[12:15], s46 offen lds
  s_add_u32 m0, s51, 81920
  s_add_u32 s46, s63, 164352
  buffer_load_dwordx4 v65, s[12:15], s46 offen lds
  s_add_u32 m0, s51, 86016
  s_add_u32 s46, s63, 164480
  buffer_load_dwordx4 v65, s[12:15], s46 offen lds
  s_add_u32 m0, s51, 90112
  s_add_u32 s46, s63, 164608
  buffer_load_dwordx4 v65, s[12:15], s46 offen lds
  s_add_u32 m0, s51, 94208
  s_add_u32 s46, s63, 164736
  buffer_load_dwordx4 v65, s[12:15], s46 offen lds
  ds_read_b64_tr_b16 a[52:53], v67 offset:32768
  ds_read_b64_tr_b16 a[54:55], v67 offset:33792
  ds_read_b64_tr_b16 a[76:77], v67 offset:36864
  ds_read_b64_tr_b16 a[78:79], v67 offset:37888
  ds_read_b64_tr_b16 a[100:101], v67 offset:40960
  ds_read_b64_tr_b16 a[102:103], v67 offset:41984
  ds_read_b64_tr_b16 a[124:125], v67 offset:45056
  ds_read_b64_tr_b16 a[126:127], v67 offset:46080
  ds_read_b64_tr_b16 a[148:149], v67 offset:49152
  ds_read_b64_tr_b16 a[150:151], v67 offset:50176
  ds_read_b64_tr_b16 a[172:173], v67 offset:53248
  ds_read_b64_tr_b16 a[174:175], v67 offset:54272
  s_waitcnt lgkmcnt(0)
  s_waitcnt vmcnt(24)
  s_barrier
  s_add_u32 m0, s51, 98304
  s_add_u32 s46, s63, 164864
  buffer_load_dwordx4 v65, s[12:15], s46 offen lds
  s_add_u32 m0, s51, 102400
  s_add_u32 s46, s63, 164992
  buffer_load_dwordx4 v65, s[12:15], s46 offen lds
  s_add_u32 m0, s51, 106496
  s_add_u32 s46, s63, 204800
  buffer_load_dwordx4 v65, s[12:15], s46 offen lds
  s_add_u32 m0, s51, 110592
  s_add_u32 s46, s63, 204928
  buffer_load_dwordx4 v65, s[12:15], s46 offen lds
  s_add_u32 m0, s51, 114688
  s_add_u32 s46, s63, 205056
  buffer_load_dwordx4 v65, s[12:15], s46 offen lds
  s_add_u32 m0, s51, 118784
  s_add_u32 s46, s63, 205184
  buffer_load_dwordx4 v65, s[12:15], s46 offen lds
  ds_read_b64_tr_b16 a[196:197], v67 offset:57344
  ds_read_b64_tr_b16 a[198:199], v67 offset:58368
  ds_read_b64_tr_b16 a[220:221], v67 offset:61440
  ds_read_b64_tr_b16 a[222:223], v67 offset:62464
  ds_read_b64_tr_b16 a[8:9], v68 offset:0
  ds_read_b64_tr_b16 a[10:11], v68 offset:1024
  ds_read_b64_tr_b16 a[32:33], v68 offset:4096
  ds_read_b64_tr_b16 a[34:35], v68 offset:5120
  ds_read_b64_tr_b16 a[56:57], v68 offset:8192
  ds_read_b64_tr_b16 a[58:59], v68 offset:9216
  ds_read_b64_tr_b16 a[80:81], v68 offset:12288
  ds_read_b64_tr_b16 a[82:83], v68 offset:13312
  s_waitcnt lgkmcnt(0)
  s_waitcnt vmcnt(24)
  s_barrier
  s_add_u32 m0, s51, 122880
  s_add_u32 s46, s63, 205312
  buffer_load_dwordx4 v65, s[12:15], s46 offen lds
  s_add_u32 m0, s51, 126976
  s_add_u32 s46, s63, 205440
  buffer_load_dwordx4 v65, s[12:15], s46 offen lds
  s_add_u32 m0, s51, 131072
  s_add_u32 s46, s63, 205568
  buffer_load_dwordx4 v65, s[12:15], s46 offen lds
  s_add_u32 m0, s51, 135168
  s_add_u32 s46, s63, 205696
  buffer_load_dwordx4 v65, s[12:15], s46 offen lds
  s_add_u32 m0, s51, 139264
  s_add_u32 s46, s63, 205824
  buffer_load_dwordx4 v65, s[12:15], s46 offen lds
  s_add_u32 m0, s51, 143360
  s_add_u32 s46, s63, 205952
  buffer_load_dwordx4 v65, s[12:15], s46 offen lds
  ds_read_b64_tr_b16 a[104:105], v66 offset:0
  ds_read_b64_tr_b16 a[106:107], v66 offset:1024
  ds_read_b64_tr_b16 a[128:129], v66 offset:4096
  ds_read_b64_tr_b16 a[130:131], v66 offset:5120
  ds_read_b64_tr_b16 a[152:153], v66 offset:8192
  ds_read_b64_tr_b16 a[154:155], v66 offset:9216
  ds_read_b64_tr_b16 a[176:177], v66 offset:12288
  ds_read_b64_tr_b16 a[178:179], v66 offset:13312
  ds_read_b64_tr_b16 a[200:201], v66 offset:16384
  ds_read_b64_tr_b16 a[202:203], v66 offset:17408
  ds_read_b64_tr_b16 a[224:225], v66 offset:20480
  ds_read_b64_tr_b16 a[226:227], v66 offset:21504
  s_waitcnt lgkmcnt(0)
  s_waitcnt vmcnt(24)
  s_barrier
  s_add_u32 m0, s51, 0
  s_add_u32 s46, s62, 786432
  buffer_load_dwordx4 v64, s[4:7], s46 offen lds
  s_add_u32 m0, s51, 4096
  s_add_u32 s46, s62, 1179648
  buffer_load_dwordx4 v64, s[4:7], s46 offen lds
  s_add_u32 m0, s51, 8192
  s_add_u32 s46, s62, 786560
  buffer_load_dwordx4 v64, s[4:7], s46 offen lds
  s_add_u32 m0, s51, 12288
  s_add_u32 s46, s62, 1179776
  buffer_load_dwordx4 v64, s[4:7], s46 offen lds
  s_add_u32 m0, s51, 16384
  s_add_u32 s46, s62, 786688
  buffer_load_dwordx4 v64, s[4:7], s46 offen lds
  s_add_u32 m0, s51, 20480
  s_add_u32 s46, s62, 1179904
  buffer_load_dwordx4 v64, s[4:7], s46 offen lds
  ds_read_b64_tr_b16 a[12:13], v66 offset:24576
  ds_read_b64_tr_b16 a[14:15], v66 offset:25600
  ds_read_b64_tr_b16 a[36:37], v66 offset:28672
  ds_read_b64_tr_b16 a[38:39], v66 offset:29696
  ds_read_b64_tr_b16 a[60:61], v66 offset:32768
  ds_read_b64_tr_b16 a[62:63], v66 offset:33792
  ds_read_b64_tr_b16 a[84:85], v66 offset:36864
  ds_read_b64_tr_b16 a[86:87], v66 offset:37888
  ds_read_b64_tr_b16 a[108:109], v66 offset:40960
  ds_read_b64_tr_b16 a[110:111], v66 offset:41984
  ds_read_b64_tr_b16 a[132:133], v66 offset:45056
  ds_read_b64_tr_b16 a[134:135], v66 offset:46080
  s_waitcnt lgkmcnt(0)
  s_waitcnt vmcnt(24)
  s_barrier
  s_add_u32 m0, s51, 24576
  s_add_u32 s46, s62, 2359296
  buffer_load_dwordx4 v64, s[4:7], s46 offen lds
  s_add_u32 m0, s51, 28672
  s_add_u32 s46, s62, 2752512
  buffer_load_dwordx4 v64, s[4:7], s46 offen lds
  s_add_u32 m0, s51, 32768
  s_add_u32 s46, s62, 2359424
  buffer_load_dwordx4 v64, s[4:7], s46 offen lds
  s_add_u32 m0, s51, 36864
  s_add_u32 s46, s62, 2752640
  buffer_load_dwordx4 v64, s[4:7], s46 offen lds
  s_add_u32 m0, s51, 40960
  s_add_u32 s46, s62, 2359552
  buffer_load_dwordx4 v64, s[4:7], s46 offen lds
  s_add_u32 m0, s51, 45056
  s_add_u32 s46, s62, 2752768
  buffer_load_dwordx4 v64, s[4:7], s46 offen lds
  ds_read_b64_tr_b16 a[156:157], v66 offset:49152
  ds_read_b64_tr_b16 a[158:159], v66 offset:50176
  ds_read_b64_tr_b16 a[180:181], v66 offset:53248
  ds_read_b64_tr_b16 a[182:183], v66 offset:54272
  ds_read_b64_tr_b16 a[204:205], v66 offset:57344
  ds_read_b64_tr_b16 a[206:207], v66 offset:58368
  ds_read_b64_tr_b16 a[228:229], v66 offset:61440
  ds_read_b64_tr_b16 a[230:231], v66 offset:62464
  ds_read_b64_tr_b16 a[16:17], v67 offset:0
  ds_read_b64_tr_b16 a[18:19], v67 offset:1024
  ds_read_b64_tr_b16 a[40:41], v67 offset:4096
  ds_read_b64_tr_b16 a[42:43], v67 offset:5120
  s_waitcnt lgkmcnt(0)
  s_waitcnt vmcnt(24)
  s_barrier
  s_add_u32 m0, s51, 49152
  s_add_u32 s46, s62, 3932160
  buffer_load_dwordx4 v64, s[4:7], s46 offen lds
  s_add_u32 m0, s51, 53248
  s_add_u32 s46, s62, 4325376
  buffer_load_dwordx4 v64, s[4:7], s46 offen lds
  s_add_u32 m0, s51, 57344
  s_add_u32 s46, s62, 3932288
  buffer_load_dwordx4 v64, s[4:7], s46 offen lds
  s_add_u32 m0, s51, 61440
  s_add_u32 s46, s62, 4325504
  buffer_load_dwordx4 v64, s[4:7], s46 offen lds
  s_add_u32 m0, s51, 65536
  s_add_u32 s46, s62, 3932416
  buffer_load_dwordx4 v64, s[4:7], s46 offen lds
  s_add_u32 m0, s51, 69632
  s_add_u32 s46, s62, 4325632
  buffer_load_dwordx4 v64, s[4:7], s46 offen lds
  ds_read_b64_tr_b16 a[64:65], v67 offset:8192
  ds_read_b64_tr_b16 a[66:67], v67 offset:9216
  ds_read_b64_tr_b16 a[88:89], v67 offset:12288
  ds_read_b64_tr_b16 a[90:91], v67 offset:13312
  ds_read_b64_tr_b16 a[112:113], v67 offset:16384
  ds_read_b64_tr_b16 a[114:115], v67 offset:17408
  ds_read_b64_tr_b16 a[136:137], v67 offset:20480
  ds_read_b64_tr_b16 a[138:139], v67 offset:21504
  ds_read_b64_tr_b16 a[160:161], v67 offset:24576
  ds_read_b64_tr_b16 a[162:163], v67 offset:25600
  ds_read_b64_tr_b16 a[184:185], v67 offset:28672
  ds_read_b64_tr_b16 a[186:187], v67 offset:29696
  s_waitcnt lgkmcnt(0)
  s_waitcnt vmcnt(24)
  s_barrier
  s_add_u32 m0, s51, 73728
  s_add_u32 s46, s62, 5505024
  buffer_load_dwordx4 v64, s[4:7], s46 offen lds
  s_add_u32 m0, s51, 77824
  s_add_u32 s46, s62, 5898240
  buffer_load_dwordx4 v64, s[4:7], s46 offen lds
  s_add_u32 m0, s51, 81920
  s_add_u32 s46, s62, 5505152
  buffer_load_dwordx4 v64, s[4:7], s46 offen lds
  s_add_u32 m0, s51, 86016
  s_add_u32 s46, s62, 5898368
  buffer_load_dwordx4 v64, s[4:7], s46 offen lds
  s_add_u32 m0, s51, 90112
  s_add_u32 s46, s62, 5505280
  buffer_load_dwordx4 v64, s[4:7], s46 offen lds
  s_add_u32 m0, s51, 94208
  s_add_u32 s46, s62, 5898496
  buffer_load_dwordx4 v64, s[4:7], s46 offen lds
  ds_read_b64_tr_b16 a[208:209], v67 offset:32768
  ds_read_b64_tr_b16 a[210:211], v67 offset:33792
  ds_read_b64_tr_b16 a[232:233], v67 offset:36864
  ds_read_b64_tr_b16 a[234:235], v67 offset:37888
  ds_read_b64_tr_b16 a[20:21], v67 offset:40960
  ds_read_b64_tr_b16 a[22:23], v67 offset:41984
  ds_read_b64_tr_b16 a[44:45], v67 offset:45056
  ds_read_b64_tr_b16 a[46:47], v67 offset:46080
  ds_read_b64_tr_b16 a[68:69], v67 offset:49152
  ds_read_b64_tr_b16 a[70:71], v67 offset:50176
  ds_read_b64_tr_b16 a[92:93], v67 offset:53248
  ds_read_b64_tr_b16 a[94:95], v67 offset:54272
  s_waitcnt lgkmcnt(0)
  s_waitcnt vmcnt(24)
  s_barrier
  s_add_u32 m0, s51, 98304
  s_add_u32 s46, s62, 7077888
  buffer_load_dwordx4 v64, s[4:7], s46 offen lds
  s_add_u32 m0, s51, 102400
  s_add_u32 s46, s62, 7471104
  buffer_load_dwordx4 v64, s[4:7], s46 offen lds
  s_add_u32 m0, s51, 106496
  s_add_u32 s46, s62, 7078016
  buffer_load_dwordx4 v64, s[4:7], s46 offen lds
  s_add_u32 m0, s51, 110592
  s_add_u32 s46, s62, 7471232
  buffer_load_dwordx4 v64, s[4:7], s46 offen lds
  s_add_u32 m0, s51, 114688
  s_add_u32 s46, s62, 7078144
  buffer_load_dwordx4 v64, s[4:7], s46 offen lds
  s_add_u32 m0, s51, 118784
  s_add_u32 s46, s62, 7471360
  buffer_load_dwordx4 v64, s[4:7], s46 offen lds
  ds_read_b64_tr_b16 a[116:117], v67 offset:57344
  ds_read_b64_tr_b16 a[118:119], v67 offset:58368
  ds_read_b64_tr_b16 a[140:141], v67 offset:61440
  ds_read_b64_tr_b16 a[142:143], v67 offset:62464
  ds_read_b64_tr_b16 a[164:165], v68 offset:0
  ds_read_b64_tr_b16 a[166:167], v68 offset:1024
  ds_read_b64_tr_b16 a[188:189], v68 offset:4096
  ds_read_b64_tr_b16 a[190:191], v68 offset:5120
  ds_read_b64_tr_b16 a[212:213], v68 offset:8192
  ds_read_b64_tr_b16 a[214:215], v68 offset:9216
  ds_read_b64_tr_b16 a[236:237], v68 offset:12288
  ds_read_b64_tr_b16 a[238:239], v68 offset:13312
  s_waitcnt lgkmcnt(0)
  s_waitcnt vmcnt(24)
  s_barrier
  ds_read_b64_tr_b16 v[40:41], v66 offset:0
  ds_read_b64_tr_b16 v[42:43], v66 offset:1024
  ds_read_b64_tr_b16 v[44:45], v66 offset:4096
  ds_read_b64_tr_b16 v[46:47], v66 offset:5120
  ds_read_b64_tr_b16 v[48:49], v66 offset:8192
  ds_read_b64_tr_b16 v[50:51], v66 offset:9216
  ds_read_b64_tr_b16 v[52:53], v66 offset:12288
  ds_read_b64_tr_b16 v[54:55], v66 offset:13312
  ds_read_b64_tr_b16 v[56:57], v66 offset:16384
  ds_read_b64_tr_b16 v[58:59], v66 offset:17408
  ds_read_b64_tr_b16 v[60:61], v66 offset:20480
  ds_read_b64_tr_b16 v[62:63], v66 offset:21504
  s_waitcnt lgkmcnt(0)
  s_waitcnt vmcnt(18)
  s_barrier
  ds_write_b128 v2, v[40:43] offset:0
  ds_write_b128 v2, v[44:47] offset:4096
  ds_write_b128 v2, v[48:51] offset:8192
  ds_write_b128 v2, v[52:55] offset:12288
  ds_write_b128 v2, v[56:59] offset:16384
  ds_write_b128 v2, v[60:63] offset:20480
  ds_read_b64_tr_b16 v[16:17], v66 offset:24576
  ds_read_b64_tr_b16 v[18:19], v66 offset:25600
  ds_read_b64_tr_b16 v[20:21], v66 offset:28672
  ds_read_b64_tr_b16 v[22:23], v66 offset:29696
  ds_read_b64_tr_b16 v[24:25], v66 offset:32768
  ds_read_b64_tr_b16 v[26:27], v66 offset:33792
  ds_read_b64_tr_b16 v[28:29], v66 offset:36864
  ds_read_b64_tr_b16 v[30:31], v66 offset:37888
  ds_read_b64_tr_b16 v[32:33], v66 offset:40960
  ds_read_b64_tr_b16 v[34:35], v66 offset:41984
  ds_read_b64_tr_b16 v[36:37], v66 offset:45056
  ds_read_b64_tr_b16 v[38:39], v66 offset:46080
  s_waitcnt lgkmcnt(0)
  s_waitcnt vmcnt(12)
  s_barrier
  ds_write_b128 v2, v[16:19] offset:24576
  ds_write_b128 v2, v[20:23] offset:28672
  ds_write_b128 v2, v[24:27] offset:32768
  ds_write_b128 v2, v[28:31] offset:36864
  ds_write_b128 v2, v[32:35] offset:40960
  ds_write_b128 v2, v[36:39] offset:45056
  ds_read_b64_tr_b16 v[40:41], v66 offset:49152
  ds_read_b64_tr_b16 v[42:43], v66 offset:50176
  ds_read_b64_tr_b16 v[44:45], v66 offset:53248
  ds_read_b64_tr_b16 v[46:47], v66 offset:54272
  ds_read_b64_tr_b16 v[48:49], v66 offset:57344
  ds_read_b64_tr_b16 v[50:51], v66 offset:58368
  ds_read_b64_tr_b16 v[52:53], v66 offset:61440
  ds_read_b64_tr_b16 v[54:55], v66 offset:62464
  ds_read_b64_tr_b16 v[56:57], v67 offset:0
  ds_read_b64_tr_b16 v[58:59], v67 offset:1024
  ds_read_b64_tr_b16 v[60:61], v67 offset:4096
  ds_read_b64_tr_b16 v[62:63], v67 offset:5120
  s_waitcnt lgkmcnt(0)
  s_waitcnt vmcnt(6)
  s_barrier
  ds_write_b128 v2, v[40:43] offset:49152
  ds_write_b128 v2, v[44:47] offset:53248
  ds_write_b128 v2, v[48:51] offset:57344
  ds_write_b128 v2, v[52:55] offset:61440
  ds_write_b128 v3, v[56:59] offset:0
  ds_write_b128 v3, v[60:63] offset:4096
  ds_read_b64_tr_b16 v[16:17], v67 offset:8192
  ds_read_b64_tr_b16 v[18:19], v67 offset:9216
  ds_read_b64_tr_b16 v[20:21], v67 offset:12288
  ds_read_b64_tr_b16 v[22:23], v67 offset:13312
  ds_read_b64_tr_b16 v[24:25], v67 offset:16384
  ds_read_b64_tr_b16 v[26:27], v67 offset:17408
  ds_read_b64_tr_b16 v[28:29], v67 offset:20480
  ds_read_b64_tr_b16 v[30:31], v67 offset:21504
  ds_read_b64_tr_b16 v[32:33], v67 offset:24576
  ds_read_b64_tr_b16 v[34:35], v67 offset:25600
  ds_read_b64_tr_b16 v[36:37], v67 offset:28672
  ds_read_b64_tr_b16 v[38:39], v67 offset:29696
  s_waitcnt lgkmcnt(0)
  s_waitcnt vmcnt(0)
  s_barrier
  ds_write_b128 v3, v[16:19] offset:8192
  ds_write_b128 v3, v[20:23] offset:12288
  ds_write_b128 v3, v[24:27] offset:16384
  ds_write_b128 v3, v[28:31] offset:20480
  ds_write_b128 v3, v[32:35] offset:24576
  ds_write_b128 v3, v[36:39] offset:28672
  ds_read_b64_tr_b16 v[40:41], v67 offset:32768
  ds_read_b64_tr_b16 v[42:43], v67 offset:33792
  ds_read_b64_tr_b16 v[44:45], v67 offset:36864
  ds_read_b64_tr_b16 v[46:47], v67 offset:37888
  ds_read_b64_tr_b16 v[48:49], v67 offset:40960
  ds_read_b64_tr_b16 v[50:51], v67 offset:41984
  ds_read_b64_tr_b16 v[52:53], v67 offset:45056
  ds_read_b64_tr_b16 v[54:55], v67 offset:46080
  ds_read_b64_tr_b16 v[56:57], v67 offset:49152
  ds_read_b64_tr_b16 v[58:59], v67 offset:50176
  ds_read_b64_tr_b16 v[60:61], v67 offset:53248
  ds_read_b64_tr_b16 v[62:63], v67 offset:54272
  s_waitcnt lgkmcnt(0)
  s_barrier
  ds_write_b128 v3, v[40:43] offset:32768
  ds_write_b128 v3, v[44:47] offset:36864
  ds_write_b128 v3, v[48:51] offset:40960
  ds_write_b128 v3, v[52:55] offset:45056
  ds_write_b128 v3, v[56:59] offset:49152
  ds_write_b128 v3, v[60:63] offset:53248
  s_waitcnt lgkmcnt(0)
  v_and_b32 v141, 3, v0
  v_lshlrev_b32 v141, 2, v141
  s_mov_b32 s50, 0
ss_31:
  global_load_dword v140, v141, s[38:39] sc1
  s_add_u32 s50, s50, 1
  s_cmp_gt_u32 s50, 131072
  s_cbranch_scc1 L_fail
  s_waitcnt vmcnt(0)
  v_readlane_b32 s46, v140, 0
  v_readlane_b32 s47, v140, 2
  s_cmp_lg_u32 s46, 0
  s_cselect_b32 s48, 7, 0
  s_add_u32 s46, s46, s2
  s_xor_b32 s49, s46, s43
  s_and_b32 s49, s49, s48
  s_cbranch_scc1 L_reroll
  s_cmp_lg_u32 s47, 0
  s_cbranch_scc1 ss_ok_32
  s_sleep 10
  s_branch ss_31
ss_ok_32:
  v_readlane_b32 s3, v140, 1
  s_nop 0
  s_and_b32 s3, s3, 0x2000
  v_and_b32 v140, 3, v0
  s_lshl_b32 s46, s43, 9
  s_add_u32 s46, s46, s3
  s_add_u32 s46, s46, 13369344
  v_lshl_add_u32 v10, v140, 7, s46
  v_mov_b32 v7, 0x44444444
  v_mov_b32 v140, 0xeeeeeeee
  v_and_b32 v141, 2, v0
  v_cmp_ne_u32 vcc, 0, v141
  s_nop 1
  v_cndmask_b32 v7, v7, v140, vcc
  v_and_b32 v140, 15, v0
  v_lshrrev_b32 v141, 4, v0
  v_lshlrev_b32 v8, 4, v140
  v_lshrrev_b32 v142, 1, v141
  v_lshl_add_u32 v8, v142, 3, v8
  v_and_b32 v143, 1, v141
  v_lshrrev_b32 v142, 2, v140
  v_lshlrev_b32 v4, 6, v142
  v_and_b32 v142, 1, v140
  v_lshl_add_u32 v4, v142, 5, v4
  v_lshl_add_u32 v4, v141, 3, v4
  v_bfe_u32 v142, v140, 1, 1
  v_lshl_add_u32 v4, v142, 2, v4
  s_and_b32 s46, s42, 1
  s_lshl_b32 s46, s46, 7
  v_xor_b32 v4, s46, v4
  s_lshl_b32 s46, s42, 8
  s_add_u32 s46, s46, 122880
  v_add_u32 v4, s46, v4
  s_lshl_b32 s46, s45, 8
  s_lshl_b32 s47, s42, 14
  s_add_u32 s47, s47, s46
  v_lshl_add_u32 v8, v143, 16, v8
  v_add_u32 v8, s47, v8
  v_lshlrev_b32 v5, 8, v141
  v_and_b32 v142, 1, v141
  v_lshl_add_u32 v5, v142, 7, v5
  v_lshl_add_u32 v5, v140, 3, v5
  v_xor_b32 v6, 0x80, v5
  v_add_u32 v5, 122880, v5
  v_add_u32 v6, 122880, v6
  s_lshl_b32 s46, s45, 7
  s_lshl_b32 s47, s42, 2
  s_add_u32 s47, s47, s46
  s_add_u32 s47, s47, 1064960
  v_mov_b32 v15, s47
  s_mov_b32 s52, 0
  s_mov_b32 s58, 0
  s_mov_b32 s54, 0
  s_mov_b32 s100, 0
va_loop:
  s_add_u32 s53, s52, 1
  s_lshl_b32 s56, s58, 2
  s_add_u32 s56, s56, s43
  s_lshl_b32 s56, s56, 16
  s_add_u32 s56, s56, s3
  s_add_u32 s56, s56, 12582912
  s_lshl_b32 s66, s54, 21
  s_mul_i32 s46, s58, 655360
  s_add_u32 s66, s66, s46
  s_add_u32 s66, s66, s3
  s_add_u32 s66, s66, 4194304
  s_lshr_b32 s46, s66, 8
  s_and_b32 s46, s46, 0x2000
  s_xor_b32 s66, s66, s46
  v_add_u32 v11, s56, v1
  s_mov_b64 s[16:17], -1
  s_mov_b32 s71, 0
  ds_read_b128 v[56:59], v2 offset:0
  ds_read_b128 v[60:63], v2 offset:4096
  ds_read_b128 v[64:67], v2 offset:8192
  ds_read_b128 v[68:71], v2 offset:12288
  ds_read_b128 v[72:75], v2 offset:16384
  ds_read_b128 v[76:79], v2 offset:20480
  ds_read_b128 v[80:83], v2 offset:24576
  ds_read_b128 v[84:87], v2 offset:28672
  ds_read_b128 v[88:91], v2 offset:32768
  ds_read_b128 v[92:95], v2 offset:36864
  ds_read_b128 v[96:99], v2 offset:40960
  ds_read_b128 v[100:103], v2 offset:45056
  v_mov_b32 v104, 0
  v_mov_b32 v105, 0
  v_mov_b32 v106, 0
  v_mov_b32 v107, 0
  v_mov_b32 v108, 0
  v_mov_b32 v109, 0
  v_mov_b32 v110, 0
  v_mov_b32 v111, 0
  v_mov_b32 v112, 0
  v_mov_b32 v113, 0
  v_mov_b32 v114, 0
  v_mov_b32 v115, 0
  s_cmp_lg_u32 s42, 3
  s_cbranch_scc1 va_nobell
  s_mov_b32 s50, 0
  s_mov_b64 exec, 15
  buffer_load_dword v116, v10, s[8:11], 0 offen sc1
  s_nop 11
  buffer_load_dword v117, v10, s[8:11], 0 offen sc1
  s_nop 11
  buffer_load_dword v118, v10, s[8:11], 0 offen sc1
  s_nop 11
  buffer_load_dword v119, v10, s[8:11], 0 offen sc1
  s_nop 11
  buffer_load_dword v120, v10, s[8:11], 0 offen sc1
  s_nop 11
  buffer_load_dword v121, v10, s[8:11], 0 offen sc1
  s_nop 11
  buffer_load_dword v122, v10, s[8:11], 0 offen sc1
  s_nop 11
  buffer_load_dword v123, v10, s[8:11], 0 offen sc1
  s_nop 11
  buffer_load_dword v124, v10, s[8:11], 0 offen sc1
  s_nop 11
bell_33:
  buffer_load_dword v125, v10, s[8:11], 0 offen sc1
  s_waitcnt vmcnt(9)
  v_cmp_gt_u32 vcc, s53, v116
  s_cbranch_vccz bell_x_34
  s_nop 7
  buffer_load_dword v116, v10, s[8:11], 0 offen sc1
  s_waitcnt vmcnt(9)
  v_cmp_gt_u32 vcc, s53, v117
  s_cbranch_vccz bell_x_34
  s_nop 7
  buffer_load_dword v117, v10, s[8:11], 0 offen sc1
  s_waitcnt vmcnt(9)
  v_cmp_gt_u32 vcc, s53, v118
  s_cbranch_vccz bell_x_34
  s_nop 7
  buffer_load_dword v118, v10, s[8:11], 0 offen sc1
  s_waitcnt vmcnt(9)
  v_cmp_gt_u32 vcc, s53, v119
  s_cbranch_vccz bell_x_34
  s_nop 7
  buffer_load_dword v119, v10, s[8:11], 0 offen sc1
  s_waitcnt vmcnt(9)
  v_cmp_gt_u32 vcc, s53, v120
  s_cbranch_vccz bell_x_34
  s_nop 7
  buffer_load_dword v120, v10, s[8:11], 0 offen sc1
  s_waitcnt vmcnt(9)
  v_cmp_gt_u32 vcc, s53, v121
  s_cbranch_vccz bell_x_34
  s_nop 7
  buffer_load_dword v121, v10, s[8:11], 0 offen sc1
  s_waitcnt vmcnt(9)
  v_cmp_gt_u32 vcc, s53, v122
  s_cbranch_vccz bell_x_34
  s_nop 7
  buffer_load_dword v122, v10, s[8:11], 0 offen sc1
  s_waitcnt vmcnt(9)
  v_cmp_gt_u32 vcc, s53, v123
  s_cbranch_vccz bell_x_34
  s_nop 7
  buffer_load_dword v123, v10, s[8:11], 0 offen sc1
  s_waitcnt vmcnt(9)
  v_cmp_gt_u32 vcc, s53, v124
  s_cbranch_vccz bell_x_34
  s_nop 7
  buffer_load_dword v124, v10, s[8:11], 0 offen sc1
  s_waitcnt vmcnt(9)
  v_cmp_gt_u32 vcc, s53, v125
  s_cbranch_vccz bell_x_34
  s_add_u32 s50, s50, 1
  s_cmp_gt_u32 s50, 131072
  s_cbranch_scc1 L_fail
  s_branch bell_33
bell_x_34:
  s_mov_b64 exec, -1
va_nobell:
  s_waitcnt lgkmcnt(0)
  s_barrier
  buffer_load_dwordx4 v[16:19], v11, s[8:11], 0 offen offset:0 sc1
  s_barrier
  buffer_load_dwordx4 v[20:23], v11, s[8:11], 0 offen offset:1024 sc1
  s_barrier
  buffer_load_dwordx4 v[24:27], v11, s[8:11], 0 offen offset:2048 sc1
  s_barrier
  buffer_load_dwordx4 v[28:31], v11, s[8:11], 0 offen offset:3072 sc1
  s_barrier
  buffer_load_dwordx4 v[32:35], v11, s[8:11], s24 offen offset:0 sc1
  s_barrier
  buffer_load_dwordx4 v[36:39], v11, s[8:11], s24 offen offset:1024 sc1
  s_barrier
  buffer_load_dwordx4 v[40:43], v11, s[8:11], s24 offen offset:2048 sc1
  s_barrier
  buffer_load_dwordx4 v[44:47], v11, s[8:11], s24 offen offset:3072 sc1
  s_barrier
  buffer_load_dwordx4 v[48:51], v11, s[8:11], s25 offen offset:0 sc1
  s_barrier
  buffer_load_dwordx4 v[52:55], v11, s[8:11], s25 offen offset:1024 sc1
va_go_35:
  s_waitcnt vmcnt(9)
  v_smfmac_f32_16x16x64_bf16 v[104:107], v[16:19], a[240:247], v7
  v_smfmac_f32_16x16x64_bf16 v[108:111], v[16:19], a[248:255], v7
  v_smfmac_f32_16x16x64_bf16 v[112:115], v[16:19], v[152:159], v7
  s_waitcnt vmcnt(8)
  v_smfmac_f32_16x16x64_bf16 v[104:107], v[20:23], v[56:63], v7
  v_mov_b32 v16, 0
  v_smfmac_f32_16x16x64_bf16 v[108:111], v[20:23], v[64:71], v7
  ds_read_b128 v[56:59], v2 offset:49152
  v_mov_b32 v17, 0
  v_smfmac_f32_16x16x64_bf16 v[112:115], v[20:23], v[72:79], v7
  ds_read_b128 v[60:63], v2 offset:53248
  v_mov_b32 v18, 0
  v_mov_b32 v19, 0
  s_waitcnt vmcnt(7)
  v_smfmac_f32_16x16x64_bf16 v[104:107], v[24:27], v[160:167], v7
  ds_read_b128 v[64:67], v2 offset:57344
  v_mov_b32 v20, 0
  v_smfmac_f32_16x16x64_bf16 v[108:111], v[24:27], v[168:175], v7
  ds_read_b128 v[68:71], v2 offset:61440
  v_mov_b32 v21, 0
  v_smfmac_f32_16x16x64_bf16 v[112:115], v[24:27], v[176:183], v7
  ds_read_b128 v[72:75], v3 offset:0
  v_mov_b32 v22, 0
  v_mov_b32 v23, 0
  s_waitcnt vmcnt(6)
  v_smfmac_f32_16x16x64_bf16 v[104:107], v[28:31], v[80:87], v7
  ds_read_b128 v[76:79], v3 offset:4096
  v_mov_b32 v24, 0
  v_smfmac_f32_16x16x64_bf16 v[108:111], v[28:31], v[88:95], v7
  ds_read_b128 v[80:83], v3 offset:8192
  v_mov_b32 v25, 0
  v_smfmac_f32_16x16x64_bf16 v[112:115], v[28:31], v[96:103], v7
  ds_read_b128 v[84:87], v3 offset:12288
  v_mov_b32 v26, 0
  v_mov_b32 v27, 0
  s_waitcnt vmcnt(5)
  v_smfmac_f32_16x16x64_bf16 v[104:107], v[32:35], v[184:191], v7
  ds_read_b128 v[88:91], v3 offset:16384
  v_mov_b32 v28, 0
  v_smfmac_f32_16x16x64_bf16 v[108:111], v[32:35], v[192:199], v7
  ds_read_b128 v[92:95], v3 offset:20480
  v_mov_b32 v29, 0
  v_smfmac_f32_16x16x64_bf16 v[112:115], v[32:35], v[200:207], v7
  ds_read_b128 v[96:99], v3 offset:24576
  v_mov_b32 v30, 0
  v_mov_b32 v31, 0
  s_waitcnt vmcnt(4)
  s_waitcnt lgkmcnt(9)
  v_smfmac_f32_16x16x64_bf16 v[104:107], v[36:39], v[56:63], v7
  ds_read_b128 v[100:103], v3 offset:28672
  v_mov_b32 v32, 0
  s_waitcnt lgkmcnt(8)
  v_smfmac_f32_16x16x64_bf16 v[108:111], v[36:39], v[64:71], v7
  ds_read_b128 v[56:59], v3 offset:32768
  v_mov_b32 v33, 0
  s_waitcnt lgkmcnt(7)
  v_smfmac_f32_16x16x64_bf16 v[112:115], v[36:39], v[72:79], v7
  ds_read_b128 v[60:63], v3 offset:36864
  v_mov_b32 v34, 0
  v_mov_b32 v35, 0
  s_waitcnt vmcnt(3)
  v_smfmac_f32_16x16x64_bf16 v[104:107], v[40:43], v[208:215], v7
  ds_read_b128 v[64:67], v3 offset:40960
  v_mov_b32 v36, 0
  v_smfmac_f32_16x16x64_bf16 v[108:111], v[40:43], v[216:223], v7
  ds_read_b128 v[68:71], v3 offset:45056
  v_mov_b32 v37, 0
  v_smfmac_f32_16x16x64_bf16 v[112:115], v[40:43], v[224:231], v7
  ds_read_b128 v[72:75], v3 offset:49152
  v_mov_b32 v38, 0
  v_mov_b32 v39, 0
  s_waitcnt vmcnt(2)
  s_waitcnt lgkmcnt(9)
  v_smfmac_f32_16x16x64_bf16 v[104:107], v[44:47], v[80:87], v7
  ds_read_b128 v[76:79], v3 offset:53248
  v_mov_b32 v40, 0
  s_waitcnt lgkmcnt(8)
  v_smfmac_f32_16x16x64_bf16 v[108:111], v[44:47], v[88:95], v7
  v_mov_b32 v41, 0
  s_waitcnt lgkmcnt(6)
  v_smfmac_f32_16x16x64_bf16 v[112:115], v[44:47], v[96:103], v7
  v_mov_b32 v42, 0
  v_mov_b32 v43, 0
  s_waitcnt vmcnt(1)
  v_smfmac_f32_16x16x64_bf16 v[104:107], v[48:51], v[232:239], v7
  v_mov_b32 v44, 0
  v_smfmac_f32_16x16x64_bf16 v[108:111], v[48:51], v[240:247], v7
  v_mov_b32 v45, 0
  v_smfmac_f32_16x16x64_bf16 v[112:115], v[48:51], v[248:255], v7
  v_mov_b32 v46, 0
  v_mov_b32 v47, 0
  s_waitcnt vmcnt(0)
  s_waitcnt lgkmcnt(4)
  v_smfmac_f32_16x16x64_bf16 v[104:107], v[52:55], v[56:63], v7
  v_mov_b32 v48, 0
  s_waitcnt lgkmcnt(2)
  v_smfmac_f32_16x16x64_bf16 v[108:111], v[52:55], v[64:71], v7
  v_mov_b32 v49, 0
  s_waitcnt lgkmcnt(0)
  v_smfmac_f32_16x16x64_bf16 v[112:115], v[52:55], v[72:79], v7
  v_mov_b32 v50, 0
  v_mov_b32 v51, 0
  v_add_f32 v104, v104, v106
  v_add_f32 v105, v105, v107
  v_cmp_u_f32 vcc, v104, v105
  v_cvt_pk_bf16_f32 v106, v104, v105
  v_add_f32 v108, v108, v110
  v_add_f32 v109, v109, v111
  v_cvt_pk_bf16_f32 v110, v108, v109
  v_add_f32 v112, v112, v114
  v_add_f32 v113, v113, v115
  v_cvt_pk_bf16_f32 v114, v112, v113
  s_and_b64 vcc, vcc, s[16:17]
  s_cbranch_scc1 va_redo_36
  ds_write_b32 v4, v106 offset:0
  ds_write_b32 v4, v110 offset:1024
  ds_write_b32 v4, v114 offset:2048
  v_mov_b32 v52, 0
  v_mov_b32 v53, 0
  v_mov_b32 v54, 0
  v_mov_b32 v55, 0
  s_waitcnt lgkmcnt(0)
  s_barrier
  ds_read_b64_tr_b16 v[116:117], v5 offset:0
  ds_read_b64_tr_b16 v[118:119], v6 offset:0
  ds_read_b64_tr_b16 v[120:121], v5 offset:1024
  ds_read_b64_tr_b16 v[122:123], v6 offset:1024
  ds_read_b64_tr_b16 v[124:125], v5 offset:2048
  ds_read_b64_tr_b16 v[126:127], v6 offset:2048
  s_waitcnt lgkmcnt(4)
  v_smfmac_f32_16x16x64_bf16 v[16:19], v[116:119], a[0:7], v7
  s_waitcnt lgkmcnt(2)
  v_smfmac_f32_16x16x64_bf16 v[16:19], v[120:123], a[8:15], v7
  s_waitcnt lgkmcnt(0)
  v_smfmac_f32_16x16x64_bf16 v[16:19], v[124:127], a[16:23], v7
  v_smfmac_f32_16x16x64_bf16 v[20:23], v[116:119], a[24:31], v7
  v_smfmac_f32_16x16x64_bf16 v[20:23], v[120:123], a[32:39], v7
  v_add_f32 v16, v16, v18
  v_smfmac_f32_16x16x64_bf16 v[20:23], v[124:127], a[40:47], v7
  v_add_f32 v17, v17, v19
  v_smfmac_f32_16x16x64_bf16 v[24:27], v[116:119], a[48:55], v7
  v_cvt_pk_bf16_f32 v128, v16, v17
  v_smfmac_f32_16x16x64_bf16 v[24:27], v[120:123], a[56:63], v7
  v_add_f32 v20, v20, v22
  v_smfmac_f32_16x16x64_bf16 v[24:27], v[124:127], a[64:71], v7
  v_add_f32 v21, v21, v23
  v_smfmac_f32_16x16x64_bf16 v[28:31], v[116:119], a[72:79], v7
  s_add_u32 s46, s66, 0
  v_cvt_pk_bf16_f32 v129, v20, v21
  v_smfmac_f32_16x16x64_bf16 v[28:31], v[120:123], a[80:87], v7
  v_add_f32 v24, v24, v26
  v_smfmac_f32_16x16x64_bf16 v[28:31], v[124:127], a[88:95], v7
  v_permlane16_swap_b32 v128, v129
  v_add_f32 v25, v25, v27
  v_smfmac_f32_16x16x64_bf16 v[32:35], v[116:119], a[96:103], v7
  buffer_store_dwordx2 v[128:129], v8, s[8:11], s46 offen sc1
  v_cvt_pk_bf16_f32 v130, v24, v25
  v_smfmac_f32_16x16x64_bf16 v[32:35], v[120:123], a[104:111], v7
  v_add_f32 v28, v28, v30
  v_smfmac_f32_16x16x64_bf16 v[32:35], v[124:127], a[112:119], v7
  v_add_f32 v29, v29, v31
  v_smfmac_f32_16x16x64_bf16 v[36:39], v[116:119], a[120:127], v7
  s_add_u32 s46, s66, 131072
  v_cvt_pk_bf16_f32 v131, v28, v29
  v_smfmac_f32_16x16x64_bf16 v[36:39], v[120:123], a[128:135], v7
  v_add_f32 v32, v32, v34
  v_smfmac_f32_16x16x64_bf16 v[36:39], v[124:127], a[136:143], v7
  v_permlane16_swap_b32 v130, v131
  v_add_f32 v33, v33, v35
  v_smfmac_f32_16x16x64_bf16 v[40:43], v[116:119], a[144:151], v7
  buffer_store_dwordx2 v[130:131], v8, s[8:11], s46 offen sc1
  v_cvt_pk_bf16_f32 v132, v32, v33
  v_smfmac_f32_16x16x64_bf16 v[40:43], v[120:123], a[152:159], v7
  v_add_f32 v36, v36, v38
  v_smfmac_f32_16x16x64_bf16 v[40:43], v[124:127], a[160:167], v7
  v_add_f32 v37, v37, v39
  v_smfmac_f32_16x16x64_bf16 v[44:47], v[116:119], a[168:175], v7
  s_add_u32 s46, s66, 262144
  v_cvt_pk_bf16_f32 v133, v36, v37
  v_smfmac_f32_16x16x64_bf16 v[44:47], v[120:123], a[176:183], v7
  v_add_f32 v40, v40, v42
  v_smfmac_f32_16x16x64_bf16 v[44:47], v[124:127], a[184:191], v7
  v_permlane16_swap_b32 v132, v133
  v_add_f32 v41, v41, v43
  v_smfmac_f32_16x16x64_bf16 v[48:51], v[116:119], a[192:199], v7
  buffer_store_dwordx2 v[132:133], v8, s[8:11], s46 offen sc1
  v_cvt_pk_bf16_f32 v134, v40, v41
  v_smfmac_f32_16x16x64_bf16 v[48:51], v[120:123], a[200:207], v7
  v_add_f32 v44, v44, v46
  v_smfmac_f32_16x16x64_bf16 v[48:51], v[124:127], a[208:215], v7
  v_add_f32 v45, v45, v47
  v_smfmac_f32_16x16x64_bf16 v[52:55], v[116:119], a[216:223], v7
  s_add_u32 s46, s66, 393216
  v_cvt_pk_bf16_f32 v135, v44, v45
  v_smfmac_f32_16x16x64_bf16 v[52:55], v[120:123], a[224:231], v7
  v_add_f32 v48, v48, v50
  v_smfmac_f32_16x16x64_bf16 v[52:55], v[124:127], a[232:239], v7
  v_permlane16_swap_b32 v134, v135
  buffer_store_dwordx2 v[134:135], v8, s[8:11], s46 offen sc1
  v_add_f32 v49, v49, v51
  v_cvt_pk_bf16_f32 v136, v48, v49
  s_nop 3
  v_add_f32 v52, v52, v54
  v_add_f32 v53, v53, v55
  v_cvt_pk_bf16_f32 v137, v52, v53
  s_add_u32 s46, s66, 524288
  s_nop 0
  v_permlane16_swap_b32 v136, v137
  buffer_store_dwordx2 v[136:137], v8, s[8:11], s46 offen sc1
  s_add_u32 s58, s58, 1
  s_cmp_eq_u32 s58, 3
  s_cselect_b32 s58, 0, s58
  s_cmp_eq_u32 s58, 0
  s_addc_u32 s54, s54, 0
  s_cmp_eq_u32 s54, 3
  s_cselect_b32 s54, 0, s54
  s_mov_b32 s52, s53
  s_cmp_lt_u32 s52, 64
  s_cbranch_scc1 va_loop
  s_waitcnt vmcnt(0)
  v_mov_b32 v140, s52
  s_mov_b64 exec, 1
  buffer_store_dword v140, v15, s[8:11], 0 offen sc1
  s_mov_b64 exec, -1
  s_endpgm
va_redo_36:
  s_mov_b32 s50, 0
va_poll_37:
  buffer_load_dwordx4 v[16:19], v11, s[8:11], 0 offen offset:0 sc1
  buffer_load_dwordx4 v[20:23], v11, s[8:11], 0 offen offset:1024 sc1
  buffer_load_dwordx4 v[24:27], v11, s[8:11], 0 offen offset:2048 sc1
  buffer_load_dwordx4 v[28:31], v11, s[8:11], 0 offen offset:3072 sc1
  buffer_load_dwordx4 v[32:35], v11, s[8:11], s24 offen offset:0 sc1
  buffer_load_dwordx4 v[36:39], v11, s[8:11], s24 offen offset:1024 sc1
  buffer_load_dwordx4 v[40:43], v11, s[8:11], s24 offen offset:2048 sc1
  buffer_load_dwordx4 v[44:47], v11, s[8:11], s24 offen offset:3072 sc1
  buffer_load_dwordx4 v[48:51], v11, s[8:11], s25 offen offset:0 sc1
  buffer_load_dwordx4 v[52:55], v11, s[8:11], s25 offen offset:1024 sc1
  s_add_u32 s71, s71, 1
  s_cmp_le_u32 s71, 2
  s_cbranch_scc1 va_again_38
  s_add_u32 s50, s50, 1
  s_cmp_gt_u32 s50, 131072
  s_cbranch_scc1 L_fail
  s_waitcnt vmcnt(0)
  v_max_u32 v12, v16, v17
  v_max3_u32 v12, v18, v19, v12
  v_max3_u32 v12, v20, v21, v12
  v_max3_u32 v12, v22, v23, v12
  v_max3_u32 v12, v24, v25, v12
  v_max3_u32 v12, v26, v27, v12
  v_max3_u32 v12, v28, v29, v12
  v_max3_u32 v12, v30, v31, v12
  v_max3_u32 v12, v32, v33, v12
  v_max3_u32 v12, v34, v35, v12
  v_max3_u32 v12, v36, v37, v12
  v_max3_u32 v12, v38, v39, v12
  v_max3_u32 v12, v40, v41, v12
  v_max3_u32 v12, v42, v43, v12
  v_max3_u32 v12, v44, v45, v12
  v_max3_u32 v12, v46, v47, v12
  v_max3_u32 v12, v48, v49, v12
  v_max3_u32 v12, v50, v51, v12
  v_max3_u32 v12, v52, v53, v12
  v_max3_u32 v12, v54, v55, v12
  v_cmp_eq_u32 vcc, -1, v12
  s_cbranch_vccnz va_poll_37
  s_mov_b64 s[16:17], 0
va_again_38:
  s_waitcnt lgkmcnt(0)
  ds_read_b128 v[56:59], v2 offset:0
  ds_read_b128 v[60:63], v2 offset:4096
  ds_read_b128 v[64:67], v2 offset:8192
  ds_read_b128 v[68:71], v2 offset:12288
  ds_read_b128 v[72:75], v2 offset:16384
  ds_read_b128 v[76:79], v2 offset:20480
  ds_read_b128 v[80:83], v2 offset:24576
  ds_read_b128 v[84:87], v2 offset:28672
  ds_read_b128 v[88:91], v2 offset:32768
  ds_read_b128 v[92:95], v2 offset:36864
  ds_read_b128 v[96:99], v2 offset:40960
  ds_read_b128 v[100:103], v2 offset:45056
  v_mov_b32 v104, 0
  v_mov_b32 v105, 0
  v_mov_b32 v106, 0
  v_mov_b32 v107, 0
  v_mov_b32 v108, 0
  v_mov_b32 v109, 0
  v_mov_b32 v110, 0
  v_mov_b32 v111, 0
  v_mov_b32 v112, 0
  v_mov_b32 v113, 0
  v_mov_b32 v114, 0
  v_mov_b32 v115, 0
  s_waitcnt lgkmcnt(0)
  s_branch va_go_35
L_owner:
  s_cmp_ge_u32 s42, 2
  s_cbranch_scc1 L_end
  s_mul_i32 s62, s43, 10
  s_add_u32 s62, s62, s44
  s_sub_u32 s62, s62, 16
  s_mov_b32 s12, s24
  s_mov_b32 s13, s25
  s_mov_b32 s14, 10240
  s_mov_b32 s15, 0x20000
  v_and_b32 v11, 3, v0
  v_lshlrev_b32 v11, 2, v11
  s_mov_b32 s50, 0
ss_39:
  global_load_dword v10, v11, s[38:39] sc1
  s_add_u32 s50, s50, 1
  s_cmp_gt_u32 s50, 131072
  s_cbranch_scc1 L_fail
  s_waitcnt vmcnt(0)
  v_readlane_b32 s46, v10, 0
  v_readlane_b32 s47, v10, 1
  s_cmp_lg_u32 s46, 0
  s_cselect_b32 s48, 7, 0
  s_add_u32 s46, s46, s2
  s_xor_b32 s49, s46, s43
  s_and_b32 s49, s49, s48
  s_cbranch_scc1 L_reroll
  s_cmp_lg_u32 s47, 0
  s_cbranch_scc1 ss_ok_40
  s_sleep 10
  s_branch ss_39
ss_ok_40:
  v_readlane_b32 s3, v10, 1
  s_nop 0
  s_and_b32 s3, s3, 0x2000
  v_and_b32 v10, 3, v0
  s_lshl_b32 s46, s43, 9
  s_add_u32 s46, s46, s3
  s_add_u32 s46, s46, 13371392
  v_lshl_add_u32 v6, v10, 7, s46
  s_lshl_b32 s46, s43, 7
  s_add_u32 s46, s46, s3
  s_add_u32 s46, s46, 13369344
  v_lshl_add_u32 v7, v10, 9, s46
  v_mov_b32 v17, 0
  v_mov_b32 v14, 2146435072
  s_cmp_eq_u32 s44, 16
  s_cselect_b64 vcc, 15, 0
  v_cndmask_b32 v7, v14, v7, vcc
  v_lshlrev_b32 v9, 7, v0
  s_and_b32 s46, s62, 3
  s_lshl_b32 s46, s46, 2
  s_add_u32 s46, s46, 1060864
  v_add_u32 v9, s46, v9
  v_and_b32 v18, 3, v0
  v_min_u32 v18, 2, v18
  v_lshlrev_b32 v18, 8, v18
  s_mul_i32 s46, s43, 768
  s_cmp_ge_u32 s44, 21
  s_cselect_b32 s47, 128, 0
  s_add_u32 s46, s46, s47
  s_add_u32 s46, s46, 1073152
  v_add_u32 v18, s46, v18
  v_cmp_lt_u32 vcc, 31, v0
  s_nop 1
  v_cndmask_b32 v9, v9, v18, vcc
  s_cmp_eq_u32 s42, 0
  s_cbranch_scc1 ow_main
  v_mov_b32 v14, 2146435072
  s_lshl_b32 s46, s43, 7
  s_add_u32 s46, s46, s3
  s_add_u32 s46, s46, 13373440
  v_mov_b32 v19, s46
  s_lshl_b32 s46, s43, 7
  s_add_u32 s46, s46, 1077248
  v_writelane_b32 v19, s46, 1
  s_cmp_eq_u32 s44, 17
  s_cselect_b64 vcc, 3, 0
  v_cndmask_b32 v19, v14, v19, vcc
  s_barrier
  s_mov_b32 s53, 1
ow_listen:
  buffer_load_dword v12, v9, s[8:11], 0 offen sc1
  s_waitcnt vmcnt(0)
  v_min_u32_dpp v12, v12, v12 row_ror:8 row_mask:0xf bank_mask:0xf
  s_nop 1
  v_min_u32_dpp v12, v12, v12 row_ror:4 row_mask:0xf bank_mask:0xf
  s_nop 1
  v_min_u32_dpp v12, v12, v12 row_ror:2 row_mask:0xf bank_mask:0xf
  s_nop 1
  v_min_u32_dpp v12, v12, v12 row_ror:1 row_mask:0xf bank_mask:0xf
  v_mov_b32 v13, v12
  s_nop 1
  v_permlane16_swap_b32 v13, v12
  v_min_u32 v12, v12, v13
  v_mov_b32 v13, v12
  s_nop 1
  v_permlane32_swap_b32 v13, v12
  v_min_u32 v12, v12, v13
  ds_write_b32 v17, v12
  s_waitcnt lgkmcnt(0)
  s_add_u32 s46, s53, 1
  v_mov_b32 v16, s46
  s_mov_b32 s50, 0
  s_mov_b64 exec, 15
  buffer_load_dword v136, v6, s[8:11], 0 offen sc1
  s_nop 11
  buffer_load_dword v137, v6, s[8:11], 0 offen sc1
  s_nop 11
  buffer_load_dword v138, v6, s[8:11], 0 offen sc1
  s_nop 11
  buffer_load_dword v139, v6, s[8:11], 0 offen sc1
  s_nop 11
  buffer_load_dword v140, v6, s[8:11], 0 offen sc1
  s_nop 11
  buffer_load_dword v141, v6, s[8:11], 0 offen sc1
  s_nop 11
  buffer_load_dword v142, v6, s[8:11], 0 offen sc1
  s_nop 11
  buffer_load_dword v143, v6, s[8:11], 0 offen sc1
  s_nop 11
  buffer_load_dword v144, v6, s[8:11], 0 offen sc1
  s_nop 11
bell_41:
  buffer_load_dword v145, v6, s[8:11], 0 offen sc1
  s_waitcnt vmcnt(9)
  v_cmp_gt_u32 vcc, s53, v136
  s_cbranch_vccz bell_x_42
  s_nop 7
  buffer_load_dword v136, v6, s[8:11], 0 offen sc1
  s_waitcnt vmcnt(9)
  v_cmp_gt_u32 vcc, s53, v137
  s_cbranch_vccz bell_x_42
  s_nop 7
  buffer_load_dword v137, v6, s[8:11], 0 offen sc1
  s_waitcnt vmcnt(9)
  v_cmp_gt_u32 vcc, s53, v138
  s_cbranch_vccz bell_x_42
  s_nop 7
  buffer_load_dword v138, v6, s[8:11], 0 offen sc1
  s_waitcnt vmcnt(9)
  v_cmp_gt_u32 vcc, s53, v139
  s_cbranch_vccz bell_x_42
  s_nop 7
  buffer_load_dword v139, v6, s[8:11], 0 offen sc1
  s_waitcnt vmcnt(9)
  v_cmp_gt_u32 vcc, s53, v140
  s_cbranch_vccz bell_x_42
  s_nop 7
  buffer_load_dword v140, v6, s[8:11], 0 offen sc1
  s_waitcnt vmcnt(9)
  v_cmp_gt_u32 vcc, s53, v141
  s_cbranch_vccz bell_x_42
  s_nop 7
  buffer_load_dword v141, v6, s[8:11], 0 offen sc1
  s_waitcnt vmcnt(9)
  v_cmp_gt_u32 vcc, s53, v142
  s_cbranch_vccz bell_x_42
  s_nop 7
  buffer_load_dword v142, v6, s[8:11], 0 offen sc1
  s_waitcnt vmcnt(9)
  v_cmp_gt_u32 vcc, s53, v143
  s_cbranch_vccz bell_x_42
  s_nop 7
  buffer_load_dword v143, v6, s[8:11], 0 offen sc1
  s_waitcnt vmcnt(9)
  v_cmp_gt_u32 vcc, s53, v144
  s_cbranch_vccz bell_x_42
  s_nop 7
  buffer_load_dword v144, v6, s[8:11], 0 offen sc1
  s_waitcnt vmcnt(9)
  v_cmp_gt_u32 vcc, s53, v145
  s_cbranch_vccz bell_x_42
  s_add_u32 s50, s50, 1
  s_cmp_gt_u32 s50, 131072
  s_cbranch_scc1 L_fail
  s_branch bell_41
bell_x_42:
  s_mov_b64 exec, -1
  s_barrier
  s_sub_u32 s46, s53, 1
  v_mov_b32 v12, s46
  s_barrier
  s_sleep 0
  buffer_store_dword v12, v19, s[8:11], 0 offen sc1
  s_sleep 8
  s_add_u32 s53, s53, 1
  s_cmp_lt_u32 s53, 64
  s_cbranch_scc1 ow_listen
  s_endpgm
ow_main:
  v_mov_b32 v5, 0x44444444
  v_mov_b32 v10, 0xeeeeeeee
  v_and_b32 v11, 2, v0
  v_cmp_ne_u32 vcc, 0, v11
  s_nop 1
  v_cndmask_b32 v5, v5, v10, vcc
  v_lshlrev_b32 v1, 4, v0
  v_and_b32 v10, 15, v0
  v_lshrrev_b32 v11, 4, v0
  v_lshlrev_b32 v2, 3, v10
  v_lshl_add_u32 v2, v11, 8, v2
  v_and_b32 v13, 1, v10
  v_lshl_add_u32 v12, v11, 1, v13
  v_mov_b32 v4, 0x05040100
  v_mov_b32 v14, 0x03020706
  v_cmp_eq_u32 vcc, 1, v13
  s_nop 1
  v_cndmask_b32 v4, v4, v14, vcc
  v_and_b32 v13, 3, v10
  v_lshl_add_u32 v3, v11, 2, v13
  v_lshlrev_b32 v3, 4, v3
  v_lshrrev_b32 v13, 2, v10
  v_lshl_add_u32 v3, v13, 2, v3
  s_lshl_b32 s46, s62, 8
  s_cmp_ge_u32 s62, 32
  s_cselect_b32 s47, 40960, 0
  s_add_u32 s46, s46, s47
  s_add_u32 s46, s46, s3
  s_add_u32 s46, s46, 12582912
  v_add_u32 v3, s46, v3
  v_mul_u32_u24 v12, 1280, v12
  v_and_b32 v13, 14, v10
  v_lshl_add_u32 v12, v13, 1, v12
  s_lshl_b32 s46, s62, 5
  buffer_load_dword v15, v12, s[12:15], s46 offen
  s_lshl_b32 s63, s62, 16
  s_add_u32 s63, s63, s3
  s_add_u32 s63, s63, 81788928
  s_mov_b32 s61, 0
  s_mov_b32 s52, 0
  s_mov_b32 s58, 0
  s_mov_b32 s54, 0
  s_mov_b32 s100, 0
  v_mov_b32 v20, -1
  v_mov_b32 v24, 0
  v_mov_b32 v21, -1
  v_mov_b32 v25, 0
  v_mov_b32 v22, -1
  v_mov_b32 v26, 0
  v_mov_b32 v23, -1
  v_mov_b32 v27, 0
  s_mov_b32 s46, 0
  buffer_store_dword v20, v3, s[8:11], s46 offen sc1
  s_mov_b32 s46, 65536
  buffer_store_dword v20, v3, s[8:11], s46 offen sc1
  s_mov_b32 s46, 131072
  buffer_store_dword v20, v3, s[8:11], s46 offen sc1
  s_mov_b32 s46, 196608
  buffer_store_dword v20, v3, s[8:11], s46 offen sc1
  s_mov_b32 s46, 262144
  buffer_store_dword v20, v3, s[8:11], s46 offen sc1
  s_mov_b32 s46, 327680
  buffer_store_dword v20, v3, s[8:11], s46 offen sc1
  s_mov_b32 s46, 393216
  buffer_store_dword v20, v3, s[8:11], s46 offen sc1
  s_mov_b32 s46, 458752
  buffer_store_dword v20, v3, s[8:11], s46 offen sc1
  s_mov_b32 s46, 524288
  buffer_store_dword v20, v3, s[8:11], s46 offen sc1
  s_mov_b32 s46, 589824
  buffer_store_dword v20, v3, s[8:11], s46 offen sc1
  s_mov_b32 s46, 655360
  buffer_store_dword v20, v3, s[8:11], s46 offen sc1
  s_mov_b32 s46, 720896
  buffer_store_dword v20, v3, s[8:11], s46 offen sc1
  s_lshl_b32 s46, s62, 9
  s_cmp_ge_u32 s62, 16
  s_cselect_b32 s47, 8192, 0
  s_add_u32 s46, s46, s47
  s_cmp_ge_u32 s62, 32
  s_cselect_b32 s47, 10240, 0
  s_add_u32 s46, s46, s47
  s_add_u32 s46, s46, s3
  s_add_u32 s46, s46, 12599296
  v_lshlrev_b32 v13, 3, v0
  buffer_store_dwordx2 v[20:21], v13, s[8:11], s46 offen sc1
  s_add_u32 s46, s46, 262144
  buffer_store_dwordx2 v[20:21], v13, s[8:11], s46 offen sc1
  s_add_u32 s46, s46, 262144
  buffer_store_dwordx2 v[20:21], v13, s[8:11], s46 offen sc1
  s_add_u32 s46, s46, 262144
  v_min_u32 v13, 12, v0
  v_lshlrev_b32 v13, 7, v13
  s_mul_i32 s46, s62, 1664
  s_add_u32 s46, s46, 1048576
  buffer_store_dwordx4 v[24:27], v13, s[8:11], s46 offen sc1
  s_lshl_b32 s46, s62, 7
  s_add_u32 s46, s46, s3
  s_add_u32 s46, s46, 13369344
  buffer_store_dword v24, v24, s[8:11], s46 offen sc1
  v_mov_b32 v13, 140
  v_mov_b32 v14, 1
  s_waitcnt vmcnt(0)
  s_mov_b64 exec, 1
  global_atomic_add v12, v13, v14, s[38:39] sc0 sc1
  s_waitcnt vmcnt(0)
  v_readfirstlane_b32 s46, v12
  s_nop 0
  s_cmp_lg_u32 s46, 39
  s_cbranch_scc1 ow_notlast
  v_mov_b32 v13, 8
  global_store_dword v13, v14, s[38:39] sc1
ow_notlast:
  s_mov_b64 exec, -1
  v_and_b32 v13, 3, v0
  v_lshlrev_b32 v13, 2, v13
  s_mov_b32 s50, 0
ss_43:
  global_load_dword v12, v13, s[38:39] sc1
  s_add_u32 s50, s50, 1
  s_cmp_gt_u32 s50, 131072
  s_cbranch_scc1 L_fail
  s_waitcnt vmcnt(0)
  v_readlane_b32 s46, v12, 0
  v_readlane_b32 s47, v12, 2
  s_cmp_lg_u32 s46, 0
  s_cselect_b32 s48, 7, 0
  s_add_u32 s46, s46, s2
  s_xor_b32 s49, s46, s43
  s_and_b32 s49, s49, s48
  s_cbranch_scc1 L_reroll
  s_cmp_lg_u32 s47, 0
  s_cbranch_scc1 ss_ok_44
  s_sleep 10
  s_branch ss_43
ss_ok_44:
  v_readlane_b32 s3, v12, 1
  s_nop 0
  s_and_b32 s3, s3, 0x2000
  s_barrier
  s_mov_b32 s49, 1
  s_cmp_ge_u32 s61, s49
  s_cbranch_scc1 wf_done_45
  s_mov_b32 s50, 0
wf_loop_46:
  buffer_load_dword v12, v18, s[8:11], 0 offen sc1
  s_add_u32 s50, s50, 1
  s_cmp_gt_u32 s50, 131072
  s_cbranch_scc1 L_fail
  s_waitcnt vmcnt(0)
  v_min_u32_dpp v12, v12, v12 row_ror:8 row_mask:0xf bank_mask:0xf
  s_nop 1
  v_min_u32_dpp v12, v12, v12 row_ror:4 row_mask:0xf bank_mask:0xf
  s_nop 1
  v_min_u32_dpp v12, v12, v12 row_ror:2 row_mask:0xf bank_mask:0xf
  s_nop 1
  v_min_u32_dpp v12, v12, v12 row_ror:1 row_mask:0xf bank_mask:0xf
  v_mov_b32 v13, v12
  s_nop 1
  v_permlane16_swap_b32 v13, v12
  v_min_u32 v12, v12, v13
  v_mov_b32 v13, v12
  s_nop 1
  v_permlane32_swap_b32 v13, v12
  v_min_u32 v12, v12, v13
  s_nop 0
  v_readfirstlane_b32 s61, v12
  s_nop 0
  s_cmp_ge_u32 s61, s49
  s_cbranch_scc1 wf_done_45
  s_sleep 2
  s_branch wf_loop_46
wf_done_45:
  s_mov_b32 s61, 0
  v_min_u32 v15, -2, v15
  s_mov_b32 s46, 0
  buffer_store_dword v15, v3, s[8:11], s46 offen sc1
  s_mov_b32 s46, 65536
  buffer_store_dword v15, v3, s[8:11], s46 offen sc1
  s_mov_b32 s46, 131072
  buffer_store_dword v15, v3, s[8:11], s46 offen sc1
  s_mov_b32 s46, 196608
  buffer_store_dword v15, v3, s[8:11], s46 offen sc1
  v_mov_b32 v16, 1
  buffer_store_dword v16, v7, s[8:11], 0 offen sc1
  s_mov_b32 s49, 1
  s_cmp_ge_u32 s61, s49
  s_cbranch_scc1 wf_done_47
  s_mov_b32 s50, 0
wf_loop_48:
  buffer_load_dword v12, v9, s[8:11], 0 offen sc1
  s_add_u32 s50, s50, 1
  s_cmp_gt_u32 s50, 131072
  s_cbranch_scc1 L_fail
  s_waitcnt vmcnt(0)
  v_min_u32_dpp v12, v12, v12 row_ror:8 row_mask:0xf bank_mask:0xf
  s_nop 1
  v_min_u32_dpp v12, v12, v12 row_ror:4 row_mask:0xf bank_mask:0xf
  s_nop 1
  v_min_u32_dpp v12, v12, v12 row_ror:2 row_mask:0xf bank_mask:0xf
  s_nop 1
  v_min_u32_dpp v12, v12, v12 row_ror:1 row_mask:0xf bank_mask:0xf
  v_mov_b32 v13, v12
  s_nop 1
  v_permlane16_swap_b32 v13, v12
  v_min_u32 v12, v12, v13
  v_mov_b32 v13, v12
  s_nop 1
  v_permlane32_swap_b32 v13, v12
  v_min_u32 v12, v12, v13
  s_nop 0
  v_readfirstlane_b32 s61, v12
  s_nop 0
  s_cmp_ge_u32 s61, s49
  s_cbranch_scc1 wf_done_47
  s_sleep 2
  s_branch wf_loop_48
wf_done_47:
  s_mov_b32 s65, s63
  s_lshr_b32 s46, s65, 8
  s_and_b32 s46, s46, 0x2000
  s_xor_b32 s65, s65, s46
  s_add_u32 s63, s63, 2621440
  s_cmp_ge_u32 s63, 165675008
  s_cselect_b32 s46, 83886080, 0
  s_sub_u32 s63, s63, s46
  s_add_u32 s46, s65, 0
  buffer_load_dwordx4 a[0:3], v1, s[8:11], s46 offen offset:0 sc1
  buffer_load_dwordx4 a[4:7], v1, s[8:11], s46 offen offset:1024 sc1
  buffer_load_dwordx4 a[8:11], v1, s[8:11], s46 offen offset:2048 sc1
  buffer_load_dwordx4 a[12:15], v1, s[8:11], s46 offen offset:3072 sc1
  s_add_u32 s46, s65, 4096
  buffer_load_dwordx4 a[16:19], v1, s[8:11], s46 offen offset:0 sc1
  buffer_load_dwordx4 a[20:23], v1, s[8:11], s46 offen offset:1024 sc1
  buffer_load_dwordx4 a[24:27], v1, s[8:11], s46 offen offset:2048 sc1
  buffer_load_dwordx4 a[28:31], v1, s[8:11], s46 offen offset:3072 sc1
  s_add_u32 s46, s65, 16384
  buffer_load_dwordx4 a[32:35], v1, s[8:11], s46 offen offset:0 sc1
  buffer_load_dwordx4 a[36:39], v1, s[8:11], s46 offen offset:1024 sc1
  buffer_load_dwordx4 a[40:43], v1, s[8:11], s46 offen offset:2048 sc1
  buffer_load_dwordx4 a[44:47], v1, s[8:11], s46 offen offset:3072 sc1
  s_add_u32 s46, s65, 20480
  buffer_load_dwordx4 a[48:51], v1, s[8:11], s46 offen offset:0 sc1
  buffer_load_dwordx4 a[52:55], v1, s[8:11], s46 offen offset:1024 sc1
  buffer_load_dwordx4 a[56:59], v1, s[8:11], s46 offen offset:2048 sc1
  buffer_load_dwordx4 a[60:63], v1, s[8:11], s46 offen offset:3072 sc1
  s_add_u32 s46, s65, 32768
  buffer_load_dwordx4 a[64:67], v1, s[8:11], s46 offen offset:0 sc1
  buffer_load_dwordx4 a[68:71], v1, s[8:11], s46 offen offset:1024 sc1
  buffer_load_dwordx4 a[72:75], v1, s[8:11], s46 offen offset:2048 sc1
  buffer_load_dwordx4 a[76:79], v1, s[8:11], s46 offen offset:3072 sc1
  s_add_u32 s46, s65, 36864
  buffer_load_dwordx4 a[80:83], v1, s[8:11], s46 offen offset:0 sc1
  buffer_load_dwordx4 a[84:87], v1, s[8:11], s46 offen offset:1024 sc1
  buffer_load_dwordx4 a[88:91], v1, s[8:11], s46 offen offset:2048 sc1
  buffer_load_dwordx4 a[92:95], v1, s[8:11], s46 offen offset:3072 sc1
  s_add_u32 s46, s65, 49152
  buffer_load_dwordx4 a[96:99], v1, s[8:11], s46 offen offset:0 sc1
  buffer_load_dwordx4 a[100:103], v1, s[8:11], s46 offen offset:1024 sc1
  buffer_load_dwordx4 a[104:107], v1, s[8:11], s46 offen offset:2048 sc1
  buffer_load_dwordx4 a[108:111], v1, s[8:11], s46 offen offset:3072 sc1
  s_add_u32 s46, s65, 53248
  buffer_load_dwordx4 a[112:115], v1, s[8:11], s46 offen offset:0 sc1
  buffer_load_dwordx4 a[116:119], v1, s[8:11], s46 offen offset:1024 sc1
  buffer_load_dwordx4 a[120:123], v1, s[8:11], s46 offen offset:2048 sc1
  buffer_load_dwordx4 a[124:127], v1, s[8:11], s46 offen offset:3072 sc1
ow_loop:
  s_add_u32 s53, s52, 1
  s_lshl_b32 s56, s58, 2
  s_add_u32 s56, s56, s43
  s_lshl_b32 s56, s56, 16
  s_add_u32 s56, s56, s3
  s_add_u32 s56, s56, 12582912
  s_add_u32 s66, s58, 1
  s_cmp_eq_u32 s66, 3
  s_cselect_b32 s66, 0, s66
  s_lshl_b32 s72, s54, 21
  s_mul_i32 s46, s58, 655360
  s_add_u32 s72, s72, s46
  s_add_u32 s72, s72, s3
  s_add_u32 s72, s72, 4194304
  s_lshr_b32 s46, s72, 8
  s_and_b32 s46, s46, 0x2000
  s_xor_b32 s72, s72, s46
  s_lshl_b32 s46, s62, 14
  s_add_u32 s72, s72, s46
  s_add_u32 s73, s72, 4096
  s_and_b32 s46, s43, 3
  s_lshl_b32 s46, s46, 16
  s_sub_u32 s56, s56, s46
  s_add_u32 s74, s56, 16384
  s_add_u32 s75, s56, 20480
  s_add_u32 s76, s56, 32768
  s_add_u32 s77, s56, 36864
  s_add_u32 s78, s56, 51200
  s_lshl_b32 s80, s66, 18
  s_add_u32 s81, s80, 65536
  s_add_u32 s82, s80, 131072
  s_add_u32 s83, s80, 196608
  s_add_u32 s64, s52, 2
  v_mov_b32 v16, s64
  s_mov_b64 s[16:17], -1
  s_mov_b32 s71, 0
  v_mov_b32 v20, 0
  v_mov_b32 v21, 0
  v_mov_b32 v22, 0
  v_mov_b32 v23, 0
  s_waitcnt vmcnt(0)
  s_barrier
  buffer_load_dwordx4 v[24:27], v1, s[8:11], s72 offen offset:0 sc1
  buffer_load_dwordx4 v[28:31], v1, s[8:11], s72 offen offset:1024 sc1
  buffer_load_dwordx4 v[32:35], v1, s[8:11], s72 offen offset:2048 sc1
  buffer_load_dwordx4 v[36:39], v1, s[8:11], s72 offen offset:3072 sc1
  buffer_load_dwordx4 v[40:43], v1, s[8:11], s73 offen offset:0 sc1
  buffer_load_dwordx4 v[44:47], v1, s[8:11], s73 offen offset:1024 sc1
  buffer_load_dwordx4 v[48:51], v1, s[8:11], s73 offen offset:2048 sc1
  buffer_load_dwordx4 v[52:55], v1, s[8:11], s73 offen offset:3072 sc1
  buffer_load_dwordx2 v[56:57], v2, s[8:11], s78 offen offset:0 sc1
  buffer_load_dwordx2 v[58:59], v2, s[8:11], s78 offen offset:128 sc1
  buffer_load_dwordx2 v[60:61], v2, s[8:11], s78 offen offset:1024 sc1
  buffer_load_dwordx2 v[62:63], v2, s[8:11], s78 offen offset:1152 sc1
  buffer_load_dwordx2 v[64:65], v2, s[8:11], s78 offen offset:2048 sc1
  buffer_load_dwordx2 v[66:67], v2, s[8:11], s78 offen offset:2176 sc1
  buffer_load_dwordx2 v[68:69], v2, s[8:11], s78 offen offset:3072 sc1
  buffer_load_dwordx2 v[70:71], v2, s[8:11], s78 offen offset:3200 sc1
  buffer_load_dwordx4 v[72:75], v1, s[8:11], s74 offen offset:0 sc1
  buffer_load_dwordx4 v[76:79], v1, s[8:11], s74 offen offset:1024 sc1
  buffer_load_dwordx4 v[80:83], v1, s[8:11], s74 offen offset:2048 sc1
  buffer_load_dwordx4 v[84:87], v1, s[8:11], s74 offen offset:3072 sc1
  buffer_load_dwordx4 v[88:91], v1, s[8:11], s75 offen offset:0 sc1
  buffer_load_dwordx4 v[92:95], v1, s[8:11], s75 offen offset:1024 sc1
  buffer_load_dwordx4 v[96:99], v1, s[8:11], s75 offen offset:2048 sc1
  buffer_load_dwordx4 v[100:103], v1, s[8:11], s75 offen offset:3072 sc1
  buffer_load_dwordx4 v[104:107], v1, s[8:11], s76 offen offset:0 sc1
  buffer_load_dwordx4 v[108:111], v1, s[8:11], s76 offen offset:1024 sc1
  buffer_load_dwordx4 v[112:115], v1, s[8:11], s76 offen offset:2048 sc1
  buffer_load_dwordx4 v[116:119], v1, s[8:11], s76 offen offset:3072 sc1
  buffer_load_dwordx4 v[120:123], v1, s[8:11], s77 offen offset:0 sc1
  buffer_load_dwordx4 v[124:127], v1, s[8:11], s77 offen offset:1024 sc1
  buffer_load_dwordx4 v[128:131], v1, s[8:11], s77 offen offset:2048 sc1
  buffer_load_dwordx4 v[132:135], v1, s[8:11], s77 offen offset:3072 sc1
ow_go:
  s_waitcnt vmcnt(22)
  v_smfmac_f32_16x16x64_bf16 v[20:23], v[56:59], v[24:31], v5
  buffer_store_dword v16, v7, s[8:11], 0 offen sc1
  s_waitcnt vmcnt(21)
  v_smfmac_f32_16x16x64_bf16 v[20:23], v[60:63], v[32:39], v5
  s_waitcnt vmcnt(19)
  v_smfmac_f32_16x16x64_bf16 v[20:23], v[64:67], v[40:47], v5
  s_waitcnt vmcnt(17)
  v_smfmac_f32_16x16x64_bf16 v[20:23], v[68:71], v[48:55], v5
  s_waitcnt vmcnt(16)
  v_smfmac_f32_16x16x64_bf16 v[20:23], v[72:75], a[0:7], v5
  s_waitcnt vmcnt(15)
  v_smfmac_f32_16x16x64_bf16 v[20:23], v[76:79], a[8:15], v5
  s_waitcnt vmcnt(14)
  v_smfmac_f32_16x16x64_bf16 v[20:23], v[80:83], a[16:23], v5
  s_waitcnt vmcnt(13)
  v_smfmac_f32_16x16x64_bf16 v[20:23], v[84:87], a[24:31], v5
  s_waitcnt vmcnt(12)
  v_smfmac_f32_16x16x64_bf16 v[20:23], v[88:91], a[32:39], v5
  s_waitcnt vmcnt(11)
  v_smfmac_f32_16x16x64_bf16 v[20:23], v[92:95], a[40:47], v5
  s_waitcnt vmcnt(10)
  v_smfmac_f32_16x16x64_bf16 v[20:23], v[96:99], a[48:55], v5
  s_waitcnt vmcnt(9)
  v_smfmac_f32_16x16x64_bf16 v[20:23], v[100:103], a[56:63], v5
  s_waitcnt vmcnt(8)
  v_smfmac_f32_16x16x64_bf16 v[20:23], v[104:107], a[64:71], v5
  s_waitcnt vmcnt(7)
  v_smfmac_f32_16x16x64_bf16 v[20:23], v[108:111], a[72:79], v5
  s_waitcnt vmcnt(6)
  v_smfmac_f32_16x16x64_bf16 v[20:23], v[112:115], a[80:87], v5
  s_waitcnt vmcnt(5)
  v_smfmac_f32_16x16x64_bf16 v[20:23], v[116:119], a[88:95], v5
  s_waitcnt vmcnt(4)
  v_smfmac_f32_16x16x64_bf16 v[20:23], v[120:123], a[96:103], v5
  s_waitcnt vmcnt(3)
  v_smfmac_f32_16x16x64_bf16 v[20:23], v[124:127], a[104:111], v5
  s_waitcnt vmcnt(2)
  v_smfmac_f32_16x16x64_bf16 v[20:23], v[128:131], a[112:119], v5
  s_waitcnt vmcnt(1)
  v_smfmac_f32_16x16x64_bf16 v[20:23], v[132:135], a[120:127], v5
  s_nop 7
  v_add_f32 v20, v20, v22
  v_add_f32 v21, v21, v23
  v_cvt_pk_bf16_f32 v10, v20, v21
  v_cmp_u_f32 vcc, v20, v21
  s_nop 0
  v_mov_b32_dpp v11, v10 quad_perm:[1,0,3,2] row_mask:0xf bank_mask:0xf
  v_perm_b32 v10, v11, v10, v4
  s_and_b64 vcc, vcc, s[16:17]
  s_cbranch_scc1 ow_redo
  buffer_store_dword v10, v3, s[8:11], s80 offen sc1
  buffer_store_dword v10, v3, s[8:11], s81 offen sc1
  buffer_store_dword v10, v3, s[8:11], s82 offen sc1
  buffer_store_dword v10, v3, s[8:11], s83 offen sc1
  s_barrier
  s_add_u32 s49, s52, 2
  v_mov_b32 v11, -1
  s_lshl_b32 s47, s58, 18
  s_add_u32 s46, s47, 0
  buffer_store_dword v11, v3, s[8:11], s46 offen sc1
  s_add_u32 s46, s47, 65536
  buffer_store_dword v11, v3, s[8:11], s46 offen sc1
  s_add_u32 s46, s47, 131072
  buffer_store_dword v11, v3, s[8:11], s46 offen sc1
  s_add_u32 s46, s47, 196608
  buffer_store_dword v11, v3, s[8:11], s46 offen sc1
  s_waitcnt vmcnt(0)
  s_sleep 4
  ds_read_b32 v12, v17
  s_waitcnt lgkmcnt(0)
  v_readfirstlane_b32 s46, v12
  s_nop 0
  s_max_u32 s61, s61, s46
  s_cmp_ge_u32 s61, s49
  s_cbranch_scc1 wf_done_49
  s_mov_b32 s50, 0
wf_loop_50:
  buffer_load_dword v12, v9, s[8:11], 0 offen sc1
  s_add_u32 s50, s50, 1
  s_cmp_gt_u32 s50, 131072
  s_cbranch_scc1 L_fail
  s_waitcnt vmcnt(0)
  v_min_u32_dpp v12, v12, v12 row_ror:8 row_mask:0xf bank_mask:0xf
  s_nop 1
  v_min_u32_dpp v12, v12, v12 row_ror:4 row_mask:0xf bank_mask:0xf
  s_nop 1
  v_min_u32_dpp v12, v12, v12 row_ror:2 row_mask:0xf bank_mask:0xf
  s_nop 1
  v_min_u32_dpp v12, v12, v12 row_ror:1 row_mask:0xf bank_mask:0xf
  v_mov_b32 v13, v12
  s_nop 1
  v_permlane16_swap_b32 v13, v12
  v_min_u32 v12, v12, v13
  v_mov_b32 v13, v12
  s_nop 1
  v_permlane32_swap_b32 v13, v12
  v_min_u32 v12, v12, v13
  s_nop 0
  v_readfirstlane_b32 s61, v12
  s_nop 0
  s_cmp_ge_u32 s61, s49
  s_cbranch_scc1 wf_done_49
  s_sleep 2
  s_branch wf_loop_50
wf_done_49:
  s_mov_b32 s65, s63
  s_lshr_b32 s46, s65, 8
  s_and_b32 s46, s46, 0x2000
  s_xor_b32 s65, s65, s46
  s_add_u32 s63, s63, 2621440
  s_cmp_ge_u32 s63, 165675008
  s_cselect_b32 s46, 83886080, 0
  s_sub_u32 s63, s63, s46
  s_add_u32 s46, s65, 0
  buffer_load_dwordx4 a[0:3], v1, s[8:11], s46 offen offset:0 sc1
  buffer_load_dwordx4 a[4:7], v1, s[8:11], s46 offen offset:1024 sc1
  buffer_load_dwordx4 a[8:11], v1, s[8:11], s46 offen offset:2048 sc1
  buffer_load_dwordx4 a[12:15], v1, s[8:11], s46 offen offset:3072 sc1
  s_add_u32 s46, s65, 4096
  buffer_load_dwordx4 a[16:19], v1, s[8:11], s46 offen offset:0 sc1
  buffer_load_dwordx4 a[20:23], v1, s[8:11], s46 offen offset:1024 sc1
  buffer_load_dwordx4 a[24:27], v1, s[8:11], s46 offen offset:2048 sc1
  buffer_load_dwordx4 a[28:31], v1, s[8:11], s46 offen offset:3072 sc1
  s_add_u32 s46, s65, 16384
  buffer_load_dwordx4 a[32:35], v1, s[8:11], s46 offen offset:0 sc1
  buffer_load_dwordx4 a[36:39], v1, s[8:11], s46 offen offset:1024 sc1
  buffer_load_dwordx4 a[40:43], v1, s[8:11], s46 offen offset:2048 sc1
  buffer_load_dwordx4 a[44:47], v1, s[8:11], s46 offen offset:3072 sc1
  s_add_u32 s46, s65, 20480
  buffer_load_dwordx4 a[48:51], v1, s[8:11], s46 offen offset:0 sc1
  buffer_load_dwordx4 a[52:55], v1, s[8:11], s46 offen offset:1024 sc1
  buffer_load_dwordx4 a[56:59], v1, s[8:11], s46 offen offset:2048 sc1
  buffer_load_dwordx4 a[60:63], v1, s[8:11], s46 offen offset:3072 sc1
  s_add_u32 s46, s65, 32768
  buffer_load_dwordx4 a[64:67], v1, s[8:11], s46 offen offset:0 sc1
  buffer_load_dwordx4 a[68:71], v1, s[8:11], s46 offen offset:1024 sc1
  buffer_load_dwordx4 a[72:75], v1, s[8:11], s46 offen offset:2048 sc1
  buffer_load_dwordx4 a[76:79], v1, s[8:11], s46 offen offset:3072 sc1
  s_add_u32 s46, s65, 36864
  buffer_load_dwordx4 a[80:83], v1, s[8:11], s46 offen offset:0 sc1
  buffer_load_dwordx4 a[84:87], v1, s[8:11], s46 offen offset:1024 sc1
  buffer_load_dwordx4 a[88:91], v1, s[8:11], s46 offen offset:2048 sc1
  buffer_load_dwordx4 a[92:95], v1, s[8:11], s46 offen offset:3072 sc1
  s_add_u32 s46, s65, 49152
  buffer_load_dwordx4 a[96:99], v1, s[8:11], s46 offen offset:0 sc1
  buffer_load_dwordx4 a[100:103], v1, s[8:11], s46 offen offset:1024 sc1
  buffer_load_dwordx4 a[104:107], v1, s[8:11], s46 offen offset:2048 sc1
  buffer_load_dwordx4 a[108:111], v1, s[8:11], s46 offen offset:3072 sc1
  s_add_u32 s46, s65, 53248
  buffer_load_dwordx4 a[112:115], v1, s[8:11], s46 offen offset:0 sc1
  buffer_load_dwordx4 a[116:119], v1, s[8:11], s46 offen offset:1024 sc1
  buffer_load_dwordx4 a[120:123], v1, s[8:11], s46 offen offset:2048 sc1
  buffer_load_dwordx4 a[124:127], v1, s[8:11], s46 offen offset:3072 sc1
  s_mov_b32 s58, s66
  s_cmp_eq_u32 s58, 0
  s_addc_u32 s54, s54, 0
  s_cmp_eq_u32 s54, 3
  s_cselect_b32 s54, 0, s54
  s_mov_b32 s52, s53
  s_cmp_lt_u32 s52, 63
  s_cbranch_scc1 ow_loop
  s_endpgm
ow_redo:
  s_mov_b32 s50, 0
ow_poll:
  buffer_load_dwordx4 v[24:27], v1, s[8:11], s72 offen offset:0 sc1
  buffer_load_dwordx4 v[28:31], v1, s[8:11], s72 offen offset:1024 sc1
  buffer_load_dwordx4 v[32:35], v1, s[8:11], s72 offen offset:2048 sc1
  buffer_load_dwordx4 v[36:39], v1, s[8:11], s72 offen offset:3072 sc1
  buffer_load_dwordx4 v[40:43], v1, s[8:11], s73 offen offset:0 sc1
  buffer_load_dwordx4 v[44:47], v1, s[8:11], s73 offen offset:1024 sc1
  buffer_load_dwordx4 v[48:51], v1, s[8:11], s73 offen offset:2048 sc1
  buffer_load_dwordx4 v[52:55], v1, s[8:11], s73 offen offset:3072 sc1
  buffer_load_dwordx2 v[56:57], v2, s[8:11], s78 offen offset:0 sc1
  buffer_load_dwordx2 v[58:59], v2, s[8:11], s78 offen offset:128 sc1
  buffer_load_dwordx2 v[60:61], v2, s[8:11], s78 offen offset:1024 sc1
  buffer_load_dwordx2 v[62:63], v2, s[8:11], s78 offen offset:1152 sc1
  buffer_load_dwordx2 v[64:65], v2, s[8:11], s78 offen offset:2048 sc1
  buffer_load_dwordx2 v[66:67], v2, s[8:11], s78 offen offset:2176 sc1
  buffer_load_dwordx2 v[68:69], v2, s[8:11], s78 offen offset:3072 sc1
  buffer_load_dwordx2 v[70:71], v2, s[8:11], s78 offen offset:3200 sc1
  buffer_load_dwordx4 v[72:75], v1, s[8:11], s74 offen offset:0 sc1
  buffer_load_dwordx4 v[76:79], v1, s[8:11], s74 offen offset:1024 sc1
  buffer_load_dwordx4 v[80:83], v1, s[8:11], s74 offen offset:2048 sc1
  buffer_load_dwordx4 v[84:87], v1, s[8:11], s74 offen offset:3072 sc1
  buffer_load_dwordx4 v[88:91], v1, s[8:11], s75 offen offset:0 sc1
  buffer_load_dwordx4 v[92:95], v1, s[8:11], s75 offen offset:1024 sc1
  buffer_load_dwordx4 v[96:99], v1, s[8:11], s75 offen offset:2048 sc1
  buffer_load_dwordx4 v[100:103], v1, s[8:11], s75 offen offset:3072 sc1
  buffer_load_dwordx4 v[104:107], v1, s[8:11], s76 offen offset:0 sc1
  buffer_load_dwordx4 v[108:111], v1, s[8:11], s76 offen offset:1024 sc1
  buffer_load_dwordx4 v[112:115], v1, s[8:11], s76 offen offset:2048 sc1
  buffer_load_dwordx4 v[116:119], v1, s[8:11], s76 offen offset:3072 sc1
  buffer_load_dwordx4 v[120:123], v1, s[8:11], s77 offen offset:0 sc1
  buffer_load_dwordx4 v[124:127], v1, s[8:11], s77 offen offset:1024 sc1
  buffer_load_dwordx4 v[128:131], v1, s[8:11], s77 offen offset:2048 sc1
  buffer_load_dwordx4 v[132:135], v1, s[8:11], s77 offen offset:3072 sc1
  s_add_u32 s71, s71, 1
  s_cmp_le_u32 s71, 2
  s_cbranch_scc1 ow_again
  s_add_u32 s50, s50, 1
  s_cmp_gt_u32 s50, 131072
  s_cbranch_scc1 L_fail
  s_waitcnt vmcnt(0)
  v_max_u32 v8, v24, v25
  v_max3_u32 v8, v26, v27, v8
  v_max3_u32 v8, v28, v29, v8
  v_max3_u32 v8, v30, v31, v8
  v_max3_u32 v8, v32, v33, v8
  v_max3_u32 v8, v34, v35, v8
  v_max3_u32 v8, v36, v37, v8
  v_max3_u32 v8, v38, v39, v8
  v_max3_u32 v8, v40, v41, v8
  v_max3_u32 v8, v42, v43, v8
  v_max3_u32 v8, v44, v45, v8
  v_max3_u32 v8, v46, v47, v8
  v_max3_u32 v8, v48, v49, v8
  v_max3_u32 v8, v50, v51, v8
  v_max3_u32 v8, v52, v53, v8
  v_max3_u32 v8, v54, v55, v8
  v_max3_u32 v8, v56, v57, v8
  v_max3_u32 v8, v58, v59, v8
  v_max3_u32 v8, v60, v61, v8
  v_max3_u32 v8, v62, v63, v8
  v_max3_u32 v8, v64, v65, v8
  v_max3_u32 v8, v66, v67, v8
  v_max3_u32 v8, v68, v69, v8
  v_max3_u32 v8, v70, v71, v8
  v_max3_u32 v8, v72, v73, v8
  v_max3_u32 v8, v74, v75, v8
  v_max3_u32 v8, v76, v77, v8
  v_max3_u32 v8, v78, v79, v8
  v_max3_u32 v8, v80, v81, v8
  v_max3_u32 v8, v82, v83, v8
  v_max3_u32 v8, v84, v85, v8
  v_max3_u32 v8, v86, v87, v8
  v_max3_u32 v8, v88, v89, v8
  v_max3_u32 v8, v90, v91, v8
  v_max3_u32 v8, v92, v93, v8
  v_max3_u32 v8, v94, v95, v8
  v_max3_u32 v8, v96, v97, v8
  v_max3_u32 v8, v98, v99, v8
  v_max3_u32 v8, v100, v101, v8
  v_max3_u32 v8, v102, v103, v8
  v_max3_u32 v8, v104, v105, v8
  v_max3_u32 v8, v106, v107, v8
  v_max3_u32 v8, v108, v109, v8
  v_max3_u32 v8, v110, v111, v8
  v_max3_u32 v8, v112, v113, v8
  v_max3_u32 v8, v114, v115, v8
  v_max3_u32 v8, v116, v117, v8
  v_max3_u32 v8, v118, v119, v8
  v_max3_u32 v8, v120, v121, v8
  v_max3_u32 v8, v122, v123, v8
  v_max3_u32 v8, v124, v125, v8
  v_max3_u32 v8, v126, v127, v8
  v_max3_u32 v8, v128, v129, v8
  v_max3_u32 v8, v130, v131, v8
  v_max3_u32 v8, v132, v133, v8
  v_max3_u32 v8, v134, v135, v8
  v_cmp_eq_u32 vcc, -1, v8
  s_cbranch_vccnz ow_poll
  s_mov_b64 s[16:17], 0
ow_again:
  v_mov_b32 v20, 0
  v_mov_b32 v21, 0
  v_mov_b32 v22, 0
  v_mov_b32 v23, 0
  s_branch ow_go
L_xowner:
  s_mov_b32 s4, s16
  s_mov_b32 s5, s17
  s_mov_b32 s6, 2621440
  s_mov_b32 s7, 0x20000
  s_mov_b32 s12, s36
  s_mov_b32 s13, s37
  s_mov_b32 s14, 5242880
  s_mov_b32 s15, 0x20000
  s_cmp_lg_u32 s42, 0
  s_cbranch_scc1 pr_skip
  s_cmp_ge_u32 s44, 28
  s_cbranch_scc1 pr_skip
  s_lshl_b32 s62, s43, 14
  s_and_b32 s46, s44, 1
  s_lshl_b32 s46, s46, 12
  s_add_u32 s62, s62, s46
  s_add_u32 s62, s62, 6160384
  s_add_u32 s65, s62, 8192
  v_lshlrev_b32 v1, 2, v0
  s_mov_b32 s63, -1
  s_mov_b32 s64, -1
  s_memtime s[72:73]
  s_waitcnt lgkmcnt(0)
  buffer_store_dword v1, v1, s[8:11], s62 offen sc1
  s_waitcnt vmcnt(0)
  s_memtime s[74:75]
  s_waitcnt lgkmcnt(0)
  s_sub_u32 s46, s74, s72
  s_min_u32 s63, s63, s46
  s_memtime s[72:73]
  s_waitcnt lgkmcnt(0)
  buffer_store_dword v1, v1, s[8:11], s65 offen sc1
  s_waitcnt vmcnt(0)
  s_memtime s[74:75]
  s_waitcnt lgkmcnt(0)
  s_sub_u32 s46, s74, s72
  s_min_u32 s64, s64, s46
  s_memtime s[72:73]
  s_waitcnt lgkmcnt(0)
  buffer_store_dword v1, v1, s[8:11], s62 offen sc1
  s_waitcnt vmcnt(0)
  s_memtime s[74:75]
  s_waitcnt lgkmcnt(0)
  s_sub_u32 s46, s74, s72
  s_min_u32 s63, s63, s46
  s_memtime s[72:73]
  s_waitcnt lgkmcnt(0)
  buffer_store_dword v1, v1, s[8:11], s65 offen sc1
  s_waitcnt vmcnt(0)
  s_memtime s[74:75]
  s_waitcnt lgkmcnt(0)
  s_sub_u32 s46, s74, s72
  s_min_u32 s64, s64, s46
  s_memtime s[72:73]
  s_waitcnt lgkmcnt(0)
  buffer_store_dword v1, v1, s[8:11], s62 offen sc1
  s_waitcnt vmcnt(0)
  s_memtime s[74:75]
  s_waitcnt lgkmcnt(0)
  s_sub_u32 s46, s74, s72
  s_min_u32 s63, s63, s46
  s_memtime s[72:73]
  s_waitcnt lgkmcnt(0)
  buffer_store_dword v1, v1, s[8:11], s65 offen sc1
  s_waitcnt vmcnt(0)
  s_memtime s[74:75]
  s_waitcnt lgkmcnt(0)
  s_sub_u32 s46, s74, s72
  s_min_u32 s64, s64, s46
  s_memtime s[72:73]
  s_waitcnt lgkmcnt(0)
  buffer_store_dword v1, v1, s[8:11], s62 offen sc1
  s_waitcnt vmcnt(0)
  s_memtime s[74:75]
  s_waitcnt lgkmcnt(0)
  s_sub_u32 s46, s74, s72
  s_min_u32 s63, s63, s46
  s_memtime s[72:73]
  s_waitcnt lgkmcnt(0)
  buffer_store_dword v1, v1, s[8:11], s65 offen sc1
  s_waitcnt vmcnt(0)
  s_memtime s[74:75]
  s_waitcnt lgkmcnt(0)
  s_sub_u32 s46, s74, s72
  s_min_u32 s64, s64, s46
  s_not_b32 s63, s63
  s_not_b32 s64, s64
  v_mov_b32 v2, s63
  v_writelane_b32 v2, s64, 1
  v_mov_b32 v3, 1
  s_mov_b64 exec, 3
  global_atomic_umax v1, v2, s[38:39] offset:128 sc1
  s_waitcnt vmcnt(0)
  s_mov_b64 exec, 1
  global_atomic_add v2, v1, v3, s[38:39] offset:136 sc0 sc1
  s_waitcnt vmcnt(0)
  v_readfirstlane_b32 s46, v2
  s_mov_b64 exec, 3
  s_cmp_lg_u32 s46, 7
  s_cbranch_scc1 pr_done
  global_atomic_umax v2, v1, v3, s[38:39] offset:128 sc0 sc1
  s_waitcnt vmcnt(0)
  v_readlane_b32 s46, v2, 0
  v_readlane_b32 s47, v2, 1
  s_nop 0
  s_cmp_gt_u32 s47, s46
  s_cselect_b32 s46, 0x2001, 1
  v_mov_b32 v2, s46
  s_mov_b64 exec, 1
  global_store_dword v1, v2, s[38:39] offset:4 sc1
pr_done:
  s_mov_b64 exec, -1
pr_skip:
  s_barrier
  v_and_b32 v11, 3, v0
  v_lshlrev_b32 v11, 2, v11
  s_mov_b32 s50, 0
ss_51:
  global_load_dword v10, v11, s[38:39] sc1
  s_add_u32 s50, s50, 1
  s_cmp_gt_u32 s50, 131072
  s_cbranch_scc1 L_fail
  s_waitcnt vmcnt(0)
  v_readlane_b32 s46, v10, 0
  v_readlane_b32 s47, v10, 1
  s_cmp_lg_u32 s46, 0
  s_cselect_b32 s48, 7, 0
  s_add_u32 s46, s46, s2
  s_xor_b32 s49, s46, s43
  s_and_b32 s49, s49, s48
  s_cbranch_scc1 L_reroll
  s_cmp_lg_u32 s47, 0
  s_cbranch_scc1 ss_ok_52
  s_sleep 10
  s_branch ss_51
ss_ok_52:
  v_readlane_b32 s3, v10, 1
  s_nop 0
  s_and_b32 s3, s3, 0x2000
  s_lshl_b32 s46, s43, 7
  s_add_u32 s46, s46, s3
  s_add_u32 s46, s46, 13373440
  v_mov_b32 v14, s46
  s_sub_u32 s48, s44, 26
  s_and_b32 s46, s48, 1
  s_mul_i32 s46, s46, 5
  s_mul_i32 s62, s43, 10
  s_add_u32 s62, s62, s46
  s_lshr_b32 s52, s48, 1
  v_lshlrev_b32 v1, 4, v0
  v_and_b32 v10, 7, v0
  v_lshlrev_b32 v10, 7, v10
  v_add_u32 v10, s51, v10
  v_bfe_u32 v11, v0, 3, 2
  v_lshl_add_u32 v2, v11, 2, v10
  v_add_u32 v3, 1064960, v2
  v_add_u32 v2, 1060864, v2
  v_bfe_u32 v11, v0, 3, 1
  v_lshl_add_u32 v4, v11, 2, v10
  v_add_u32 v4, 1069056, v4
  v_cmp_lt_u32 vcc, 31, v0
  s_nop 1
  v_cndmask_b32 v3, v3, v4, vcc
  s_mul_i32 s46, s43, 6
  s_add_u32 s46, s46, s48
  s_lshl_b32 s46, s46, 7
  s_add_u32 s46, s46, 1073152
  v_mov_b32 v15, s46
  v_mov_b32 v11, 2146435072
  s_cmp_eq_u32 s42, 0
  s_cselect_b64 vcc, 1, 0
  v_cndmask_b32 v15, v11, v15, vcc
  s_mul_i32 s46, s42, 10240
  v_add_u32 v5, s46, v1
  v_add_u32 v6, s51, v1
  s_mul_i32 s63, s52, 40
  s_add_u32 s63, s63, s62
  s_lshl_b32 s63, s63, 16
  s_lshl_b32 s46, s42, 14
  s_add_u32 s63, s63, s46
  s_add_u32 s63, s63, s3
  s_add_u32 s63, s63, 81788928
  s_lshl_b32 s65, s52, 18
  s_add_u32 s65, s65, s3
  s_add_u32 s65, s65, 14680064
  s_lshl_b32 s67, s62, 14
  s_lshl_b32 s46, s42, 11
  s_add_u32 s67, s67, s46
  s_mov_b32 s58, s52
  s_mul_i32 s66, s52, 81920
  v_and_b32 v10, 15, v0
  v_mul_u32_u24 v10, 2560, v10
  v_lshrrev_b32 v11, 4, v0
  v_lshl_add_u32 v10, v11, 3, v10
  s_add_u32 s46, s42, 0
  s_cmp_ge_u32 s46, 5
  s_cselect_b32 s47, 40800, 0
  s_add_u32 s48, s46, s62
  s_lshl_b32 s48, s48, 5
  s_add_u32 s47, s47, s48
  s_add_u32 s47, s47, 1280
  s_cmp_ge_u32 s46, 10
  s_cselect_b32 s47, 2146435072, s47
  v_add_u32 v7, s47, v10
  s_add_u32 s46, s42, 4
  s_cmp_ge_u32 s46, 5
  s_cselect_b32 s47, 40800, 0
  s_add_u32 s48, s46, s62
  s_lshl_b32 s48, s48, 5
  s_add_u32 s47, s47, s48
  s_add_u32 s47, s47, 1280
  s_cmp_ge_u32 s46, 10
  s_cselect_b32 s47, 2146435072, s47
  v_add_u32 v8, s47, v10
  s_add_u32 s46, s42, 8
  s_cmp_ge_u32 s46, 5
  s_cselect_b32 s47, 40800, 0
  s_add_u32 s48, s46, s62
  s_lshl_b32 s48, s48, 5
  s_add_u32 s47, s47, s48
  s_add_u32 s47, s47, 1280
  s_cmp_ge_u32 s46, 10
  s_cselect_b32 s47, 2146435072, s47
  v_add_u32 v9, s47, v10
  v_mov_b32 v224, -1
  v_mov_b32 v225, -1
  v_mov_b32 v226, -1
  v_mov_b32 v227, -1
  s_mov_b32 s54, 0
  s_lshl_b32 s64, s54, 21
  s_mul_i32 s46, s58, 655360
  s_add_u32 s64, s64, s46
  s_add_u32 s64, s64, s3
  s_add_u32 s64, s64, 4194304
  s_lshr_b32 s46, s64, 8
  s_and_b32 s46, s46, 0x2000
  s_xor_b32 s64, s64, s46
  s_add_u32 s64, s64, s67
  s_add_u32 s46, s64, 0
  buffer_store_dwordx4 v[224:227], v1, s[8:11], s46 offen offset:0 sc1
  buffer_store_dwordx4 v[224:227], v1, s[8:11], s46 offen offset:1024 sc1
  s_add_u32 s46, s64, 16384
  buffer_store_dwordx4 v[224:227], v1, s[8:11], s46 offen offset:0 sc1
  buffer_store_dwordx4 v[224:227], v1, s[8:11], s46 offen offset:1024 sc1
  s_add_u32 s46, s64, 32768
  buffer_store_dwordx4 v[224:227], v1, s[8:11], s46 offen offset:0 sc1
  buffer_store_dwordx4 v[224:227], v1, s[8:11], s46 offen offset:1024 sc1
  s_add_u32 s46, s64, 49152
  buffer_store_dwordx4 v[224:227], v1, s[8:11], s46 offen offset:0 sc1
  buffer_store_dwordx4 v[224:227], v1, s[8:11], s46 offen offset:1024 sc1
  s_add_u32 s46, s64, 65536
  buffer_store_dwordx4 v[224:227], v1, s[8:11], s46 offen offset:0 sc1
  buffer_store_dwordx4 v[224:227], v1, s[8:11], s46 offen offset:1024 sc1
  s_mov_b32 s54, 1
  s_lshl_b32 s64, s54, 21
  s_mul_i32 s46, s58, 655360
  s_add_u32 s64, s64, s46
  s_add_u32 s64, s64, s3
  s_add_u32 s64, s64, 4194304
  s_lshr_b32 s46, s64, 8
  s_and_b32 s46, s46, 0x2000
  s_xor_b32 s64, s64, s46
  s_add_u32 s64, s64, s67
  s_add_u32 s46, s64, 0
  buffer_store_dwordx4 v[224:227], v1, s[8:11], s46 offen offset:0 sc1
  buffer_store_dwordx4 v[224:227], v1, s[8:11], s46 offen offset:1024 sc1
  s_add_u32 s46, s64, 16384
  buffer_store_dwordx4 v[224:227], v1, s[8:11], s46 offen offset:0 sc1
  buffer_store_dwordx4 v[224:227], v1, s[8:11], s46 offen offset:1024 sc1
  s_add_u32 s46, s64, 32768
  buffer_store_dwordx4 v[224:227], v1, s[8:11], s46 offen offset:0 sc1
  buffer_store_dwordx4 v[224:227], v1, s[8:11], s46 offen offset:1024 sc1
  s_add_u32 s46, s64, 49152
  buffer_store_dwordx4 v[224:227], v1, s[8:11], s46 offen offset:0 sc1
  buffer_store_dwordx4 v[224:227], v1, s[8:11], s46 offen offset:1024 sc1
  s_add_u32 s46, s64, 65536
  buffer_store_dwordx4 v[224:227], v1, s[8:11], s46 offen offset:0 sc1
  buffer_store_dwordx4 v[224:227], v1, s[8:11], s46 offen offset:1024 sc1
  s_mov_b32 s54, 2
  s_lshl_b32 s64, s54, 21
  s_mul_i32 s46, s58, 655360
  s_add_u32 s64, s64, s46
  s_add_u32 s64, s64, s3
  s_add_u32 s64, s64, 4194304
  s_lshr_b32 s46, s64, 8
  s_and_b32 s46, s46, 0x2000
  s_xor_b32 s64, s64, s46
  s_add_u32 s64, s64, s67
  s_add_u32 s46, s64, 0
  buffer_store_dwordx4 v[224:227], v1, s[8:11], s46 offen offset:0 sc1
  buffer_store_dwordx4 v[224:227], v1, s[8:11], s46 offen offset:1024 sc1
  s_add_u32 s46, s64, 16384
  buffer_store_dwordx4 v[224:227], v1, s[8:11], s46 offen offset:0 sc1
  buffer_store_dwordx4 v[224:227], v1, s[8:11], s46 offen offset:1024 sc1
  s_add_u32 s46, s64, 32768
  buffer_store_dwordx4 v[224:227], v1, s[8:11], s46 offen offset:0 sc1
  buffer_store_dwordx4 v[224:227], v1, s[8:11], s46 offen offset:1024 sc1
  s_add_u32 s46, s64, 49152
  buffer_store_dwordx4 v[224:227], v1, s[8:11], s46 offen offset:0 sc1
  buffer_store_dwordx4 v[224:227], v1, s[8:11], s46 offen offset:1024 sc1
  s_add_u32 s46, s64, 65536
  buffer_store_dwordx4 v[224:227], v1, s[8:11], s46 offen offset:0 sc1
  buffer_store_dwordx4 v[224:227], v1, s[8:11], s46 offen offset:1024 sc1
  v_and_b32 v11, 3, v0
  v_lshlrev_b32 v11, 2, v11
  s_mov_b32 s50, 0
ss_53:
  global_load_dword v10, v11, s[38:39] sc1
  s_add_u32 s50, s50, 1
  s_cmp_gt_u32 s50, 131072
  s_cbranch_scc1 L_fail
  s_waitcnt vmcnt(0)
  v_readlane_b32 s46, v10, 0
  v_readlane_b32 s47, v10, 2
  s_cmp_lg_u32 s46, 0
  s_cselect_b32 s48, 7, 0
  s_add_u32 s46, s46, s2
  s_xor_b32 s49, s46, s43
  s_and_b32 s49, s49, s48
  s_cbranch_scc1 L_reroll
  s_cmp_lg_u32 s47, 0
  s_cbranch_scc1 ss_ok_54
  s_sleep 10
  s_branch ss_53
ss_ok_54:
  v_readlane_b32 s3, v10, 1
  s_nop 0
  s_and_b32 s3, s3, 0x2000
  s_add_u32 s46, s52, 6
  v_mov_b32 v10, s46
  s_waitcnt vmcnt(0)
  s_barrier
  buffer_store_dword v10, v15, s[8:11], 0 offen sc1
  s_mov_b32 s60, 0
  s_mov_b32 s61, 0
  s_mov_b32 s54, 0
  v_lshlrev_b32 v228, 7, v0
  s_mul_i32 s76, s43, 6
  s_add_u32 s76, s76, s44
  s_sub_u32 s76, s76, 26
  s_lshl_b32 s76, s76, 2
  s_add_u32 s76, s76, s42
  s_lshl_b32 s76, s76, 13
  s_mov_b32 s77, 2457600
  s_mov_b32 s78, 819200
xo_loop:
  s_add_u32 s53, s52, 1
  s_cmp_ge_u32 s60, s53
  s_cbranch_scc1 wf_done_55
  s_mov_b32 s50, 0
wf_loop_56:
  buffer_load_dword v10, v2, s[8:11], 0 offen sc1
  s_add_u32 s50, s50, 1
  s_cmp_gt_u32 s50, 131072
  s_cbranch_scc1 L_fail
  s_waitcnt vmcnt(0)
  v_min_u32_dpp v10, v10, v10 row_ror:8 row_mask:0xf bank_mask:0xf
  s_nop 1
  v_min_u32_dpp v10, v10, v10 row_ror:4 row_mask:0xf bank_mask:0xf
  s_nop 1
  v_min_u32_dpp v10, v10, v10 row_ror:2 row_mask:0xf bank_mask:0xf
  s_nop 1
  v_min_u32_dpp v10, v10, v10 row_ror:1 row_mask:0xf bank_mask:0xf
  v_mov_b32 v11, v10
  s_nop 1
  v_permlane16_swap_b32 v11, v10
  v_min_u32 v10, v10, v11
  v_mov_b32 v11, v10
  s_nop 1
  v_permlane32_swap_b32 v11, v10
  v_min_u32 v10, v10, v11
  s_nop 0
  v_readfirstlane_b32 s60, v10
  s_nop 0
  s_cmp_ge_u32 s60, s53
  s_cbranch_scc1 wf_done_55
  s_sleep 2
  s_branch wf_loop_56
wf_done_55:
  s_add_u32 s46, s63, 0
  s_lshr_b32 s47, s46, 8
  s_and_b32 s47, s47, 0x2000
  s_xor_b32 s46, s46, s47
  buffer_load_dwordx4 a[0:3], v1, s[8:11], s46 offen offset:0 sc1
  buffer_load_dwordx4 a[4:7], v1, s[8:11], s46 offen offset:1024 sc1
  buffer_load_dwordx4 a[8:11], v1, s[8:11], s46 offen offset:2048 sc1
  buffer_load_dwordx4 a[12:15], v1, s[8:11], s46 offen offset:3072 sc1
  s_add_u32 s46, s46, 4096
  buffer_load_dwordx4 a[16:19], v1, s[8:11], s46 offen offset:0 sc1
  buffer_load_dwordx4 a[20:23], v1, s[8:11], s46 offen offset:1024 sc1
  buffer_load_dwordx4 a[24:27], v1, s[8:11], s46 offen offset:2048 sc1
  buffer_load_dwordx4 a[28:31], v1, s[8:11], s46 offen offset:3072 sc1
  s_add_u32 s46, s63, 65536
  s_lshr_b32 s47, s46, 8
  s_and_b32 s47, s47, 0x2000
  s_xor_b32 s46, s46, s47
  buffer_load_dwordx4 a[32:35], v1, s[8:11], s46 offen offset:0 sc1
  buffer_load_dwordx4 a[36:39], v1, s[8:11], s46 offen offset:1024 sc1
  buffer_load_dwordx4 a[40:43], v1, s[8:11], s46 offen offset:2048 sc1
  buffer_load_dwordx4 a[44:47], v1, s[8:11], s46 offen offset:3072 sc1
  s_add_u32 s46, s46, 4096
  buffer_load_dwordx4 a[48:51], v1, s[8:11], s46 offen offset:0 sc1
  buffer_load_dwordx4 a[52:55], v1, s[8:11], s46 offen offset:1024 sc1
  buffer_load_dwordx4 a[56:59], v1, s[8:11], s46 offen offset:2048 sc1
  buffer_load_dwordx4 a[60:63], v1, s[8:11], s46 offen offset:3072 sc1
  s_add_u32 s46, s63, 131072
  s_lshr_b32 s47, s46, 8
  s_and_b32 s47, s47, 0x2000
  s_xor_b32 s46, s46, s47
  buffer_load_dwordx4 a[64:67], v1, s[8:11], s46 offen offset:0 sc1
  buffer_load_dwordx4 a[68:71], v1, s[8:11], s46 offen offset:1024 sc1
  buffer_load_dwordx4 a[72:75], v1, s[8:11], s46 offen offset:2048 sc1
  buffer_load_dwordx4 a[76:79], v1, s[8:11], s46 offen offset:3072 sc1
  s_add_u32 s46, s46, 4096
  buffer_load_dwordx4 a[80:83], v1, s[8:11], s46 offen offset:0 sc1
  buffer_load_dwordx4 a[84:87], v1, s[8:11], s46 offen offset:1024 sc1
  buffer_load_dwordx4 a[88:91], v1, s[8:11], s46 offen offset:2048 sc1
  buffer_load_dwordx4 a[92:95], v1, s[8:11], s46 offen offset:3072 sc1
  s_add_u32 s46, s63, 196608
  s_lshr_b32 s47, s46, 8
  s_and_b32 s47, s47, 0x2000
  s_xor_b32 s46, s46, s47
  buffer_load_dwordx4 a[96:99], v1, s[8:11], s46 offen offset:0 sc1
  buffer_load_dwordx4 a[100:103], v1, s[8:11], s46 offen offset:1024 sc1
  buffer_load_dwordx4 a[104:107], v1, s[8:11], s46 offen offset:2048 sc1
  buffer_load_dwordx4 a[108:111], v1, s[8:11], s46 offen offset:3072 sc1
  s_add_u32 s46, s46, 4096
  buffer_load_dwordx4 a[112:115], v1, s[8:11], s46 offen offset:0 sc1
  buffer_load_dwordx4 a[116:119], v1, s[8:11], s46 offen offset:1024 sc1
  buffer_load_dwordx4 a[120:123], v1, s[8:11], s46 offen offset:2048 sc1
  buffer_load_dwordx4 a[124:127], v1, s[8:11], s46 offen offset:3072 sc1
  s_add_u32 s46, s63, 262144
  s_lshr_b32 s47, s46, 8
  s_and_b32 s47, s47, 0x2000
  s_xor_b32 s46, s46, s47
  buffer_load_dwordx4 a[128:131], v1, s[8:11], s46 offen offset:0 sc1
  buffer_load_dwordx4 a[132:135], v1, s[8:11], s46 offen offset:1024 sc1
  buffer_load_dwordx4 a[136:139], v1, s[8:11], s46 offen offset:2048 sc1
  buffer_load_dwordx4 a[140:143], v1, s[8:11], s46 offen offset:3072 sc1
  s_add_u32 s46, s46, 4096
  buffer_load_dwordx4 a[144:147], v1, s[8:11], s46 offen offset:0 sc1
  buffer_load_dwordx4 a[148:151], v1, s[8:11], s46 offen offset:1024 sc1
  buffer_load_dwordx4 a[152:155], v1, s[8:11], s46 offen offset:2048 sc1
  buffer_load_dwordx4 a[156:159], v1, s[8:11], s46 offen offset:3072 sc1
  s_waitcnt vmcnt(24)
  s_add_u32 s53, s52, 2
  s_cmp_ge_u32 s52, 61
  s_cbranch_scc1 xo_last
  s_cmp_lg_u32 s42, 0
  s_cbranch_scc1 xo_go
  s_cmp_ge_u32 s61, s53
  s_cbranch_scc1 wf_done_57
  s_mov_b32 s50, 0
wf_loop_58:
  buffer_load_dword v10, v14, s[8:11], 0 offen sc1
  s_add_u32 s50, s50, 1
  s_cmp_gt_u32 s50, 131072
  s_cbranch_scc1 L_fail
  s_waitcnt vmcnt(0)
  v_readfirstlane_b32 s61, v10
  s_nop 0
  s_cmp_ge_u32 s61, s53
  s_cbranch_scc1 wf_done_57
  s_sleep 2
  s_branch wf_loop_58
wf_done_57:
  s_branch xo_go
xo_last:
  s_mov_b32 s53, 64
  s_mov_b32 s61, 0
  s_cmp_ge_u32 s61, s53
  s_cbranch_scc1 wf_done_59
  s_mov_b32 s50, 0
wf_loop_60:
  buffer_load_dword v10, v3, s[8:11], 0 offen sc1
  s_add_u32 s50, s50, 1
  s_cmp_gt_u32 s50, 131072
  s_cbranch_scc1 L_fail
  s_waitcnt vmcnt(0)
  v_min_u32_dpp v10, v10, v10 row_ror:8 row_mask:0xf bank_mask:0xf
  s_nop 1
  v_min_u32_dpp v10, v10, v10 row_ror:4 row_mask:0xf bank_mask:0xf
  s_nop 1
  v_min_u32_dpp v10, v10, v10 row_ror:2 row_mask:0xf bank_mask:0xf
  s_nop 1
  v_min_u32_dpp v10, v10, v10 row_ror:1 row_mask:0xf bank_mask:0xf
  v_mov_b32 v11, v10
  s_nop 1
  v_permlane16_swap_b32 v11, v10
  v_min_u32 v10, v10, v11
  v_mov_b32 v11, v10
  s_nop 1
  v_permlane32_swap_b32 v11, v10
  v_min_u32 v10, v10, v11
  s_nop 0
  v_readfirstlane_b32 s61, v10
  s_nop 0
  s_cmp_ge_u32 s61, s53
  s_cbranch_scc1 wf_done_59
  s_sleep 2
  s_branch wf_loop_60
wf_done_59:
xo_go:
  s_barrier
  s_lshl_b32 s64, s54, 21
  s_mul_i32 s46, s58, 655360
  s_add_u32 s64, s64, s46
  s_add_u32 s64, s64, s3
  s_add_u32 s64, s64, 4194304
  s_lshr_b32 s46, s64, 8
  s_and_b32 s46, s46, 0x2000
  s_xor_b32 s64, s64, s46
  s_add_u32 s64, s64, s67
  s_mov_b32 s49, s65
  s_lshr_b32 s46, s49, 8
  s_and_b32 s46, s46, 0x2000
  s_xor_b32 s49, s49, s46
  s_lshl_b32 s47, s42, 14
  s_add_u32 s47, s47, s49
  s_lshl_b32 s48, s42, 11
  s_add_u32 s48, s48, s49
  s_add_u32 s46, s47, 0
  buffer_load_dwordx4 v[56:59], v1, s[8:11], s46 offen sc1
  s_add_u32 s46, s47, 81920
  buffer_load_dwordx4 v[60:63], v1, s[8:11], s46 offen sc1
  s_add_u32 s46, s47, 1024
  buffer_load_dwordx4 v[64:67], v1, s[8:11], s46 offen sc1
  s_add_u32 s46, s47, 82944
  buffer_load_dwordx4 v[68:71], v1, s[8:11], s46 offen sc1
  s_add_u32 s46, s47, 2048
  buffer_load_dwordx4 v[72:75], v1, s[8:11], s46 offen sc1
  s_add_u32 s46, s47, 83968
  buffer_load_dwordx4 v[76:79], v1, s[8:11], s46 offen sc1
  s_add_u32 s46, s47, 3072
  buffer_load_dwordx4 v[80:83], v1, s[8:11], s46 offen sc1
  s_add_u32 s46, s47, 84992
  buffer_load_dwordx4 v[84:87], v1, s[8:11], s46 offen sc1
  s_add_u32 s46, s47, 4096
  buffer_load_dwordx4 v[88:91], v1, s[8:11], s46 offen sc1
  s_add_u32 s46, s47, 86016
  buffer_load_dwordx4 v[92:95], v1, s[8:11], s46 offen sc1
  s_add_u32 s46, s47, 5120
  buffer_load_dwordx4 v[96:99], v1, s[8:11], s46 offen sc1
  s_add_u32 s46, s47, 87040
  buffer_load_dwordx4 v[100:103], v1, s[8:11], s46 offen sc1
  s_add_u32 s46, s47, 6144
  buffer_load_dwordx4 v[104:107], v1, s[8:11], s46 offen sc1
  s_add_u32 s46, s47, 88064
  buffer_load_dwordx4 v[108:111], v1, s[8:11], s46 offen sc1
  s_add_u32 s46, s47, 7168
  buffer_load_dwordx4 v[112:115], v1, s[8:11], s46 offen sc1
  s_add_u32 s46, s47, 89088
  buffer_load_dwordx4 v[116:119], v1, s[8:11], s46 offen sc1
  s_add_u32 s46, s48, 65536
  buffer_load_dwordx4 v[120:123], v1, s[8:11], s46 offen sc1
  s_add_u32 s46, s48, 147456
  buffer_load_dwordx4 v[124:127], v1, s[8:11], s46 offen sc1
  s_add_u32 s46, s48, 66560
  buffer_load_dwordx4 v[128:131], v1, s[8:11], s46 offen sc1
  s_add_u32 s46, s48, 148480
  buffer_load_dwordx4 v[132:135], v1, s[8:11], s46 offen sc1
  s_add_u32 s46, s64, 0
  buffer_load_dwordx4 v[16:19], v1, s[8:11], s46 offen offset:0 sc1
  buffer_load_dwordx4 v[20:23], v1, s[8:11], s46 offen offset:1024 sc1
  s_add_u32 s46, s64, 16384
  buffer_load_dwordx4 v[24:27], v1, s[8:11], s46 offen offset:0 sc1
  buffer_load_dwordx4 v[28:31], v1, s[8:11], s46 offen offset:1024 sc1
  s_add_u32 s46, s64, 32768
  buffer_load_dwordx4 v[32:35], v1, s[8:11], s46 offen offset:0 sc1
  buffer_load_dwordx4 v[36:39], v1, s[8:11], s46 offen offset:1024 sc1
  s_add_u32 s46, s64, 49152
  buffer_load_dwordx4 v[40:43], v1, s[8:11], s46 offen offset:0 sc1
  buffer_load_dwordx4 v[44:47], v1, s[8:11], s46 offen offset:1024 sc1
  s_add_u32 s46, s64, 65536
  buffer_load_dwordx4 v[48:51], v1, s[8:11], s46 offen offset:0 sc1
  buffer_load_dwordx4 v[52:55], v1, s[8:11], s46 offen offset:1024 sc1
  s_waitcnt vmcnt(29)
  v_mfma_f32_16x16x32_bf16 v[136:139], a[0:3], v[56:59], 0
  v_mfma_f32_16x16x32_bf16 v[140:143], a[32:35], v[56:59], 0
  v_mfma_f32_16x16x32_bf16 v[144:147], a[64:67], v[56:59], 0
  v_mfma_f32_16x16x32_bf16 v[148:151], a[96:99], v[56:59], 0
  v_mfma_f32_16x16x32_bf16 v[152:155], a[128:131], v[56:59], 0
  s_waitcnt vmcnt(28)
  v_mfma_f32_16x16x32_bf16 v[156:159], a[0:3], v[60:63], 0
  v_mfma_f32_16x16x32_bf16 v[160:163], a[32:35], v[60:63], 0
  v_mfma_f32_16x16x32_bf16 v[164:167], a[64:67], v[60:63], 0
  v_mfma_f32_16x16x32_bf16 v[168:171], a[96:99], v[60:63], 0
  v_mfma_f32_16x16x32_bf16 v[172:175], a[128:131], v[60:63], 0
  s_waitcnt vmcnt(27)
  v_mfma_f32_16x16x32_bf16 v[136:139], a[4:7], v[64:67], v[136:139]
  v_mfma_f32_16x16x32_bf16 v[140:143], a[36:39], v[64:67], v[140:143]
  v_mfma_f32_16x16x32_bf16 v[144:147], a[68:71], v[64:67], v[144:147]
  v_mfma_f32_16x16x32_bf16 v[148:151], a[100:103], v[64:67], v[148:151]
  v_mfma_f32_16x16x32_bf16 v[152:155], a[132:135], v[64:67], v[152:155]
  s_waitcnt vmcnt(26)
  v_mfma_f32_16x16x32_bf16 v[156:159], a[4:7], v[68:71], v[156:159]
  v_mfma_f32_16x16x32_bf16 v[160:163], a[36:39], v[68:71], v[160:163]
  v_mfma_f32_16x16x32_bf16 v[164:167], a[68:71], v[68:71], v[164:167]
  v_mfma_f32_16x16x32_bf16 v[168:171], a[100:103], v[68:71], v[168:171]
  v_mfma_f32_16x16x32_bf16 v[172:175], a[132:135], v[68:71], v[172:175]
  s_waitcnt vmcnt(25)
  v_mfma_f32_16x16x32_bf16 v[136:139], a[8:11], v[72:75], v[136:139]
  v_mfma_f32_16x16x32_bf16 v[140:143], a[40:43], v[72:75], v[140:143]
  v_mfma_f32_16x16x32_bf16 v[144:147], a[72:75], v[72:75], v[144:147]
  v_mfma_f32_16x16x32_bf16 v[148:151], a[104:107], v[72:75], v[148:151]
  v_mfma_f32_16x16x32_bf16 v[152:155], a[136:139], v[72:75], v[152:155]
  s_waitcnt vmcnt(24)
  v_mfma_f32_16x16x32_bf16 v[156:159], a[8:11], v[76:79], v[156:159]
  v_mfma_f32_16x16x32_bf16 v[160:163], a[40:43], v[76:79], v[160:163]
  v_mfma_f32_16x16x32_bf16 v[164:167], a[72:75], v[76:79], v[164:167]
  v_mfma_f32_16x16x32_bf16 v[168:171], a[104:107], v[76:79], v[168:171]
  v_mfma_f32_16x16x32_bf16 v[172:175], a[136:139], v[76:79], v[172:175]
  s_waitcnt vmcnt(23)
  v_mfma_f32_16x16x32_bf16 v[136:139], a[12:15], v[80:83], v[136:139]
  v_mfma_f32_16x16x32_bf16 v[140:143], a[44:47], v[80:83], v[140:143]
  v_mfma_f32_16x16x32_bf16 v[144:147], a[76:79], v[80:83], v[144:147]
  v_mfma_f32_16x16x32_bf16 v[148:151], a[108:111], v[80:83], v[148:151]
  v_mfma_f32_16x16x32_bf16 v[152:155], a[140:143], v[80:83], v[152:155]
  s_waitcnt vmcnt(22)
  v_mfma_f32_16x16x32_bf16 v[156:159], a[12:15], v[84:87], v[156:159]
  v_mfma_f32_16x16x32_bf16 v[160:163], a[44:47], v[84:87], v[160:163]
  v_mfma_f32_16x16x32_bf16 v[164:167], a[76:79], v[84:87], v[164:167]
  v_mfma_f32_16x16x32_bf16 v[168:171], a[108:111], v[84:87], v[168:171]
  v_mfma_f32_16x16x32_bf16 v[172:175], a[140:143], v[84:87], v[172:175]
  s_waitcnt vmcnt(21)
  v_mfma_f32_16x16x32_bf16 v[136:139], a[16:19], v[88:91], v[136:139]
  v_mfma_f32_16x16x32_bf16 v[140:143], a[48:51], v[88:91], v[140:143]
  v_mfma_f32_16x16x32_bf16 v[144:147], a[80:83], v[88:91], v[144:147]
  v_mfma_f32_16x16x32_bf16 v[148:151], a[112:115], v[88:91], v[148:151]
  v_mfma_f32_16x16x32_bf16 v[152:155], a[144:147], v[88:91], v[152:155]
  s_waitcnt vmcnt(20)
  v_mfma_f32_16x16x32_bf16 v[156:159], a[16:19], v[92:95], v[156:159]
  v_mfma_f32_16x16x32_bf16 v[160:163], a[48:51], v[92:95], v[160:163]
  v_mfma_f32_16x16x32_bf16 v[164:167], a[80:83], v[92:95], v[164:167]
  v_mfma_f32_16x16x32_bf16 v[168:171], a[112:115], v[92:95], v[168:171]
  v_mfma_f32_16x16x32_bf16 v[172:175], a[144:147], v[92:95], v[172:175]
  s_waitcnt vmcnt(19)
  v_mfma_f32_16x16x32_bf16 v[136:139], a[20:23], v[96:99], v[136:139]
  v_mfma_f32_16x16x32_bf16 v[140:143], a[52:55], v[96:99], v[140:143]
  v_mfma_f32_16x16x32_bf16 v[144:147], a[84:87], v[96:99], v[144:147]
  v_mfma_f32_16x16x32_bf16 v[148:151], a[116:119], v[96:99], v[148:151]
  v_mfma_f32_16x16x32_bf16 v[152:155], a[148:151], v[96:99], v[152:155]
  s_waitcnt vmcnt(18)
  v_mfma_f32_16x16x32_bf16 v[156:159], a[20:23], v[100:103], v[156:159]
  v_mfma_f32_16x16x32_bf16 v[160:163], a[52:55], v[100:103], v[160:163]
  v_mfma_f32_16x16x32_bf16 v[164:167], a[84:87], v[100:103], v[164:167]
  v_mfma_f32_16x16x32_bf16 v[168:171], a[116:119], v[100:103], v[168:171]
  v_mfma_f32_16x16x32_bf16 v[172:175], a[148:151], v[100:103], v[172:175]
  s_waitcnt vmcnt(17)
  v_mfma_f32_16x16x32_bf16 v[136:139], a[24:27], v[104:107], v[136:139]
  v_mfma_f32_16x16x32_bf16 v[140:143], a[56:59], v[104:107], v[140:143]
  v_mfma_f32_16x16x32_bf16 v[144:147], a[88:91], v[104:107], v[144:147]
  v_mfma_f32_16x16x32_bf16 v[148:151], a[120:123], v[104:107], v[148:151]
  v_mfma_f32_16x16x32_bf16 v[152:155], a[152:155], v[104:107], v[152:155]
  s_waitcnt vmcnt(16)
  v_mfma_f32_16x16x32_bf16 v[156:159], a[24:27], v[108:111], v[156:159]
  v_mfma_f32_16x16x32_bf16 v[160:163], a[56:59], v[108:111], v[160:163]
  v_mfma_f32_16x16x32_bf16 v[164:167], a[88:91], v[108:111], v[164:167]
  v_mfma_f32_16x16x32_bf16 v[168:171], a[120:123], v[108:111], v[168:171]
  v_mfma_f32_16x16x32_bf16 v[172:175], a[152:155], v[108:111], v[172:175]
  s_waitcnt vmcnt(15)
  v_mfma_f32_16x16x32_bf16 v[136:139], a[28:31], v[112:115], v[136:139]
  v_mfma_f32_16x16x32_bf16 v[140:143], a[60:63], v[112:115], v[140:143]
  v_mfma_f32_16x16x32_bf16 v[144:147], a[92:95], v[112:115], v[144:147]
  v_mfma_f32_16x16x32_bf16 v[148:151], a[124:127], v[112:115], v[148:151]
  v_mfma_f32_16x16x32_bf16 v[152:155], a[156:159], v[112:115], v[152:155]
  s_waitcnt vmcnt(14)
  v_mfma_f32_16x16x32_bf16 v[156:159], a[28:31], v[116:119], v[156:159]
  v_mfma_f32_16x16x32_bf16 v[160:163], a[60:63], v[116:119], v[160:163]
  v_mfma_f32_16x16x32_bf16 v[164:167], a[92:95], v[116:119], v[164:167]
  v_mfma_f32_16x16x32_bf16 v[168:171], a[124:127], v[116:119], v[168:171]
  v_mfma_f32_16x16x32_bf16 v[172:175], a[156:159], v[116:119], v[172:175]
  s_waitcnt vmcnt(8)
  v_mfma_f32_16x16x32_bf16 v[136:139], v[16:19], v[120:123], v[136:139]
  v_mfma_f32_16x16x32_bf16 v[156:159], v[16:19], v[124:127], v[156:159]
  v_mfma_f32_16x16x32_bf16 v[136:139], v[20:23], v[128:131], v[136:139]
  v_mfma_f32_16x16x32_bf16 v[156:159], v[20:23], v[132:135], v[156:159]
  s_waitcnt vmcnt(6)
  v_mfma_f32_16x16x32_bf16 v[140:143], v[24:27], v[120:123], v[140:143]
  v_mfma_f32_16x16x32_bf16 v[160:163], v[24:27], v[124:127], v[160:163]
  v_mfma_f32_16x16x32_bf16 v[140:143], v[28:31], v[128:131], v[140:143]
  v_mfma_f32_16x16x32_bf16 v[160:163], v[28:31], v[132:135], v[160:163]
  s_waitcnt vmcnt(4)
  v_mfma_f32_16x16x32_bf16 v[144:147], v[32:35], v[120:123], v[144:147]
  v_mfma_f32_16x16x32_bf16 v[164:167], v[32:35], v[124:127], v[164:167]
  v_mfma_f32_16x16x32_bf16 v[144:147], v[36:39], v[128:131], v[144:147]
  v_mfma_f32_16x16x32_bf16 v[164:167], v[36:39], v[132:135], v[164:167]
  s_waitcnt vmcnt(2)
  v_mfma_f32_16x16x32_bf16 v[148:151], v[40:43], v[120:123], v[148:151]
  v_mfma_f32_16x16x32_bf16 v[168:171], v[40:43], v[124:127], v[168:171]
  v_mfma_f32_16x16x32_bf16 v[148:151], v[44:47], v[128:131], v[148:151]
  v_mfma_f32_16x16x32_bf16 v[168:171], v[44:47], v[132:135], v[168:171]
  s_waitcnt vmcnt(0)
  v_mfma_f32_16x16x32_bf16 v[152:155], v[48:51], v[120:123], v[152:155]
  v_mfma_f32_16x16x32_bf16 v[172:175], v[48:51], v[124:127], v[172:175]
  v_mfma_f32_16x16x32_bf16 v[152:155], v[52:55], v[128:131], v[152:155]
  v_mfma_f32_16x16x32_bf16 v[172:175], v[52:55], v[132:135], v[172:175]
  s_add_u32 s46, s64, 0
  buffer_store_dwordx4 v[224:227], v1, s[8:11], s46 offen offset:0 sc1
  buffer_store_dwordx4 v[224:227], v1, s[8:11], s46 offen offset:1024 sc1
  s_add_u32 s46, s64, 16384
  buffer_store_dwordx4 v[224:227], v1, s[8:11], s46 offen offset:0 sc1
  buffer_store_dwordx4 v[224:227], v1, s[8:11], s46 offen offset:1024 sc1
  s_add_u32 s46, s64, 32768
  buffer_store_dwordx4 v[224:227], v1, s[8:11], s46 offen offset:0 sc1
  buffer_store_dwordx4 v[224:227], v1, s[8:11], s46 offen offset:1024 sc1
  s_add_u32 s46, s64, 49152
  buffer_store_dwordx4 v[224:227], v1, s[8:11], s46 offen offset:0 sc1
  buffer_store_dwordx4 v[224:227], v1, s[8:11], s46 offen offset:1024 sc1
  s_add_u32 s46, s64, 65536
  buffer_store_dwordx4 v[224:227], v1, s[8:11], s46 offen offset:0 sc1
  buffer_store_dwordx4 v[224:227], v1, s[8:11], s46 offen offset:1024 sc1
  ds_write_b128 v5, v[136:139] offset:0
  ds_write_b128 v5, v[140:143] offset:1024
  ds_write_b128 v5, v[144:147] offset:2048
  ds_write_b128 v5, v[148:151] offset:3072
  ds_write_b128 v5, v[152:155] offset:4096
  ds_write_b128 v5, v[156:159] offset:5120
  ds_write_b128 v5, v[160:163] offset:6144
  ds_write_b128 v5, v[164:167] offset:7168
  ds_write_b128 v5, v[168:171] offset:8192
  ds_write_b128 v5, v[172:175] offset:9216
  s_waitcnt lgkmcnt(0)
  s_barrier
  ds_read_b128 v[176:179], v6 offset:0
  ds_read_b128 v[180:183], v6 offset:10240
  ds_read_b128 v[184:187], v6 offset:20480
  ds_read_b128 v[188:191], v6 offset:30720
  ds_read_b128 v[192:195], v6 offset:4096
  ds_read_b128 v[196:199], v6 offset:14336
  ds_read_b128 v[200:203], v6 offset:24576
  ds_read_b128 v[204:207], v6 offset:34816
  ds_read_b128 v[208:211], v6 offset:8192
  ds_read_b128 v[212:215], v6 offset:18432
  ds_read_b128 v[216:219], v6 offset:28672
  ds_read_b128 v[220:223], v6 offset:38912
  s_waitcnt lgkmcnt(8)
  v_add_f32 v176, v176, v180
  v_add_f32 v184, v184, v188
  v_add_f32 v176, v176, v184
  v_add_f32 v177, v177, v181
  v_add_f32 v185, v185, v189
  v_add_f32 v177, v177, v185
  v_add_f32 v178, v178, v182
  v_add_f32 v186, v186, v190
  v_add_f32 v178, v178, v186
  v_add_f32 v179, v179, v183
  v_add_f32 v187, v187, v191
  v_add_f32 v179, v179, v187
  v_cvt_pk_bf16_f32 v176, v176, v177
  v_cvt_pk_bf16_f32 v177, v178, v179
  buffer_store_dwordx2 v[176:177], v7, s[12:15], s66 offen
  s_waitcnt lgkmcnt(4)
  v_add_f32 v192, v192, v196
  v_add_f32 v200, v200, v204
  v_add_f32 v192, v192, v200
  v_add_f32 v193, v193, v197
  v_add_f32 v201, v201, v205
  v_add_f32 v193, v193, v201
  v_add_f32 v194, v194, v198
  v_add_f32 v202, v202, v206
  v_add_f32 v194, v194, v202
  v_add_f32 v195, v195, v199
  v_add_f32 v203, v203, v207
  v_add_f32 v195, v195, v203
  v_cvt_pk_bf16_f32 v192, v192, v193
  v_cvt_pk_bf16_f32 v193, v194, v195
  buffer_store_dwordx2 v[192:193], v8, s[12:15], s66 offen
  s_waitcnt lgkmcnt(0)
  v_add_f32 v208, v208, v212
  v_add_f32 v216, v216, v220
  v_add_f32 v208, v208, v216
  v_add_f32 v209, v209, v213
  v_add_f32 v217, v217, v221
  v_add_f32 v209, v209, v217
  v_add_f32 v210, v210, v214
  v_add_f32 v218, v218, v222
  v_add_f32 v210, v210, v218
  v_add_f32 v211, v211, v215
  v_add_f32 v219, v219, v223
  v_add_f32 v211, v211, v219
  v_cvt_pk_bf16_f32 v208, v208, v209
  v_cvt_pk_bf16_f32 v209, v210, v211
  buffer_store_dwordx2 v[208:209], v9, s[12:15], s66 offen
  s_add_u32 s46, s52, 9
  v_mov_b32 v10, s46
  s_waitcnt vmcnt(0)
  s_barrier
  buffer_store_dword v10, v15, s[8:11], 0 offen sc1
  s_add_u32 s54, s54, 1
  s_cmp_eq_u32 s54, 3
  s_cselect_b32 s54, 0, s54
  s_add_u32 s63, s63, 7864320
  s_cmp_ge_u32 s63, 165675008
  s_cselect_b32 s46, 83886080, 0
  s_sub_u32 s63, s63, s46
  s_add_u32 s65, s65, 786432
  s_cmp_ge_u32 s65, 16777216
  s_cselect_b32 s46, 2097152, 0
  s_sub_u32 s65, s65, s46
  s_add_u32 s66, s66, 245760
  s_add_u32 s52, s52, 3
  s_cmp_lt_u32 s52, 64
  s_cbranch_scc1 xo_loop
  s_endpgm
L_end:
  s_endpgm
L_fail:
  s_mov_b32 s4, s38
  s_mov_b32 s5, s39
  s_mov_b32 s6, 256
  s_mov_b32 s7, 0x20000
  s_lshl_b32 s46, s43, 8
  s_or_b32 s46, s46, s44
  s_or_b32 s46, s46, 0x10000
  v_mov_b32 v1, 32
  v_mov_b32 v2, s46
  s_mov_b64 exec, 1
  buffer_store_dword v2, v1, s[4:7], 0 offen sc1
  s_waitcnt vmcnt(0)
  s_endpgm
.section .rodata,"a"
.p2align 6
.amdhsa_kernel concat_heads__sliding_local_dilated__memory_aug_recurrent_mem_tr__prompt_kernel
  .amdhsa_next_free_vgpr 512
  .amdhsa_next_free_sgpr 102
  .amdhsa_accum_offset 256
  .amdhsa_group_segment_fixed_size 0
  .amdhsa_kernarg_size 104
  .amdhsa_user_sgpr_count 2
  .amdhsa_user_sgpr_kernarg_segment_ptr 1
  .amdhsa_system_sgpr_workgroup_id_x 1
.end_amdhsa_kernel
```

```asm
; @launch grid=(256,1,1) block=(256,1,1) lds=163840
.amdgcn_target "amdgcn-amd-amdhsa--gfx950"
.text
.globl concat_heads__sliding_local_dilated__memory_aug_recurrent_mem_tr__prompt_kernel
.p2align 8
.type concat_heads__sliding_local_dilated__memory_aug_recurrent_mem_tr__prompt_kernel,@function
concat_heads__sliding_local_dilated__memory_aug_recurrent_mem_tr__prompt_kernel:
  s_cmp_ge_u32 s2, 256
  s_cbranch_scc1 L_end
  v_lshrrev_b32 v1, 6, v0
  v_and_b32 v0, 63, v0
  v_readfirstlane_b32 s42, v1
  s_getreg_b32 s46, hwreg(HW_REG_XCC_ID)
  s_lshr_b32 s44, s2, 3
  s_lshl_b32 s51, s42, 10
  s_mov_b32 s3, 0
L_reroll:
  s_load_dwordx16 s[16:31], s[0:1], 0
  s_load_dwordx8 s[32:39], s[0:1], 64
  s_load_dwordx2 s[40:41], s[0:1], 96
  s_and_b32 s43, s46, 7
  s_and_b32 s46, s44, 7
  s_lshl_b32 s46, s46, 2
  s_and_b32 s47, s43, 3
  s_add_u32 s45, s46, s47
  s_waitcnt lgkmcnt(0)
  s_add_u32 s8, s40, 0x1fffff
  s_addc_u32 s9, s41, 0
  s_and_b32 s8, s8, 0xffe00000
  s_mov_b32 s10, 266338304
  s_mov_b32 s11, 0x20000
  s_mov_b32 s4, s38
  s_mov_b32 s5, s39
  s_mov_b32 s6, 256
  s_mov_b32 s7, 0x20000
  s_mov_b32 s12, s22
  s_mov_b32 s13, s23
  s_mov_b32 s14, 2621440
  s_mov_b32 s15, 0x20000
  s_or_b32 s46, s2, s42
  s_cbranch_scc1 L_norot
  v_mov_b32 v1, 0
  s_or_b32 s46, s43, 8
  v_mov_b32 v2, s46
  buffer_store_dword v2, v1, s[4:7], 0 offen sc1
L_norot:
  s_cmp_lt_u32 s43, 4
  s_cbranch_scc1 L_recur
  s_cmp_ge_u32 s44, 24
  s_cbranch_scc1 L_uw
  s_lshr_b32 s48, s44, 3
  s_cmp_eq_u32 s48, 0
  s_cselect_b32 s4, s26, s28
  s_cselect_b32 s5, s27, s29
  s_cmp_eq_u32 s48, 2
  s_cselect_b32 s4, s30, s4
  s_cselect_b32 s5, s31, s5
  s_mov_b32 s6, 7864320
  s_mul_i32 s60, s45, 384
  s_mov_b32 s61, 0
  s_mov_b32 s62, 64
  s_cselect_b32 s63, 50331648, 0
  s_add_u32 s63, s63, 31457280
  s_cmp_lg_u32 s48, 1
  s_cselect_b32 s46, 0x2000, 0
  s_add_u32 s63, s63, s46
  s_mov_b32 s67, s45
  s_lshl_b32 s64, s48, 5
  s_add_u32 s64, s64, s45
  s_lshl_b32 s64, s64, 7
  s_add_u32 s64, s64, 1048576
  v_lshrrev_b32 v10, 3, v0
  v_lshrrev_b32 v11, 2, v10
  v_lshlrev_b32 v11, 3, v11
  v_and_b32 v1, 3, v10
  v_add_u32 v1, v1, v11
  s_and_b32 s46, s42, 1
  s_lshl_b32 s46, s46, 2
  s_lshr_b32 s47, s42, 1
  s_lshl_b32 s47, s47, 4
  s_add_u32 s46, s46, s47
  v_add_u32 v1, s46, v1
  v_mul_u32_u24 v1, 12288, v1
  v_lshrrev_b32 v10, 1, v10
  v_bfe_u32 v11, v0, 1, 2
  v_xor_b32 v10, v10, v11
  v_lshlrev_b32 v10, 5, v10
  v_and_b32 v11, 1, v0
  v_lshlrev_b32 v11, 4, v11
  v_add3_u32 v1, v1, v10, v11
  v_lshrrev_b32 v10, 5, v0
  v_lshlrev_b32 v2, 11, v10
  v_bfe_u32 v10, v0, 2, 3
  v_lshl_add_u32 v2, v10, 7, v2
  v_lshrrev_b32 v10, 1, v10
  v_xor_b32 v10, s42, v10
  v_lshl_add_u32 v2, v10, 5, v2
  v_and_b32 v10, 3, v0
  v_lshl_add_u32 v2, v10, 3, v2
  v_add_u32 v3, 0x10000, v2
  v_add_u32 v4, 0x20000, v2
  v_lshrrev_b32 v10, 3, v0
  s_lshl_b32 s46, s42, 3
  v_add_u32 v10, s46, v10
  v_mul_u32_u24 v5, 1280, v10
  v_bfe_u32 v10, v10, 1, 3
  v_and_b32 v11, 7, v0
  v_xor_b32 v10, v10, v11
  v_lshl_add_u32 v5, v10, 4, v5
  v_and_b32 v10, 15, v0
  v_lshlrev_b32 v6, 7, v10
  v_lshrrev_b32 v10, 1, v10
  v_lshrrev_b32 v11, 4, v0
  v_xor_b32 v10, v10, v11
  v_lshl_add_u32 v6, v10, 4, v6
  v_add_u32 v6, 122880, v6
  v_xor_b32 v7, 64, v6
  v_and_b32 v10, 15, v0
  v_lshlrev_b32 v8, 4, v10
  v_bfe_u32 v10, v0, 4, 1
  v_lshlrev_b32 v10, 11, v10
  v_lshrrev_b32 v11, 5, v0
  v_lshlrev_b32 v11, 8, v11
  v_add3_u32 v8, v8, v10, v11
  s_lshl_b32 s46, s42, 9
  v_add_u32 v8, s46, v8
  v_mov_b32 v9, s64
  v_mov_b32 v10, 2146435072
  s_cmp_eq_u32 s42, 0
  s_cselect_b64 vcc, 1, 0
  v_cndmask_b32 v9, v10, v9, vcc
  s_lshl_b32 s46, s43, 7
  s_add_u32 s46, s46, 1076736
  v_mov_b32 v14, s46
  s_mov_b32 s68, 0
  s_lshr_b32 s70, s44, 5
  s_add_u32 s70, s70, 60
  s_mov_b32 s52, s61
  s_mul_i32 s53, s52, 40960
  s_add_u32 s54, s51, 122880
  s_add_u32 m0, s54, 0
  s_nop 0
  buffer_load_dwordx4 v5, s[12:15], s53 offen offset:0 lds
  s_add_u32 m0, s54, 3968
  s_nop 0
  buffer_load_dwordx4 v5, s[12:15], s53 offen offset:128 lds
  s_add_u32 m0, s54, 7936
  s_nop 0
  buffer_load_dwordx4 v5, s[12:15], s53 offen offset:256 lds
  s_add_u32 m0, s54, 11904
  s_nop 0
  buffer_load_dwordx4 v5, s[12:15], s53 offen offset:384 lds
  s_add_u32 m0, s54, 15872
  s_nop 0
  buffer_load_dwordx4 v5, s[12:15], s53 offen offset:512 lds
  s_add_u32 m0, s54, 19840
  s_nop 0
  buffer_load_dwordx4 v5, s[12:15], s53 offen offset:640 lds
  s_add_u32 m0, s54, 23808
  s_nop 0
  buffer_load_dwordx4 v5, s[12:15], s53 offen offset:768 lds
  s_add_u32 m0, s54, 27776
  s_nop 0
  buffer_load_dwordx4 v5, s[12:15], s53 offen offset:896 lds
  s_add_u32 m0, s54, 31744
  s_nop 0
  buffer_load_dwordx4 v5, s[12:15], s53 offen offset:1024 lds
  s_add_u32 m0, s54, 35712
  s_nop 0
  buffer_load_dwordx4 v5, s[12:15], s53 offen offset:1152 lds
  s_add_u32 m0, s51, 0
  s_add_u32 s46, s60, 0
  buffer_load_dwordx4 v1, s[4:7], s46 offen lds
  s_add_u32 m0, s51, 4096
  s_add_u32 s46, s60, 128
  buffer_load_dwordx4 v1, s[4:7], s46 offen lds
  s_add_u32 m0, s51, 8192
  s_add_u32 s46, s60, 256
  buffer_load_dwordx4 v1, s[4:7], s46 offen lds
  s_add_u32 m0, s51, 12288
  s_add_u32 s46, s60, 393216
  buffer_load_dwordx4 v1, s[4:7], s46 offen lds
  s_add_u32 m0, s51, 16384
  s_add_u32 s46, s60, 393344
  buffer_load_dwordx4 v1, s[4:7], s46 offen lds
  s_add_u32 m0, s51, 20480
  s_add_u32 s46, s60, 393472
  buffer_load_dwordx4 v1, s[4:7], s46 offen lds
  s_add_u32 m0, s51, 24576
  s_add_u32 s46, s60, 786432
  buffer_load_dwordx4 v1, s[4:7], s46 offen lds
  s_add_u32 m0, s51, 28672
  s_add_u32 s46, s60, 786560
  buffer_load_dwordx4 v1, s[4:7], s46 offen lds
  s_add_u32 m0, s51, 32768
  s_add_u32 s46, s60, 786688
  buffer_load_dwordx4 v1, s[4:7], s46 offen lds
  s_add_u32 m0, s51, 36864
  s_add_u32 s46, s60, 1179648
  buffer_load_dwordx4 v1, s[4:7], s46 offen lds
  s_add_u32 m0, s51, 40960
  s_add_u32 s46, s60, 1179776
  buffer_load_dwordx4 v1, s[4:7], s46 offen lds
  s_add_u32 m0, s51, 45056
  s_add_u32 s46, s60, 1179904
  buffer_load_dwordx4 v1, s[4:7], s46 offen lds
  s_add_u32 m0, s51, 49152
  s_add_u32 s46, s60, 1572864
  buffer_load_dwordx4 v1, s[4:7], s46 offen lds
  s_add_u32 m0, s51, 53248
  s_add_u32 s46, s60, 1572992
  buffer_load_dwordx4 v1, s[4:7], s46 offen lds
  s_add_u32 m0, s51, 57344
  s_add_u32 s46, s60, 1573120
  buffer_load_dwordx4 v1, s[4:7], s46 offen lds
  s_add_u32 m0, s51, 61440
  s_add_u32 s46, s60, 1966080
  buffer_load_dwordx4 v1, s[4:7], s46 offen lds
  s_add_u32 m0, s51, 65536
  s_add_u32 s46, s60, 1966208
  buffer_load_dwordx4 v1, s[4:7], s46 offen lds
  s_add_u32 m0, s51, 69632
  s_add_u32 s46, s60, 1966336
  buffer_load_dwordx4 v1, s[4:7], s46 offen lds
  s_add_u32 m0, s51, 73728
  s_add_u32 s46, s60, 2359296
  buffer_load_dwordx4 v1, s[4:7], s46 offen lds
  s_add_u32 m0, s51, 77824
  s_add_u32 s46, s60, 2359424
  buffer_load_dwordx4 v1, s[4:7], s46 offen lds
  s_add_u32 m0, s51, 81920
  s_add_u32 s46, s60, 2359552
  buffer_load_dwordx4 v1, s[4:7], s46 offen lds
  s_add_u32 m0, s51, 86016
  s_add_u32 s46, s60, 2752512
  buffer_load_dwordx4 v1, s[4:7], s46 offen lds
  s_add_u32 m0, s51, 90112
  s_add_u32 s46, s60, 2752640
  buffer_load_dwordx4 v1, s[4:7], s46 offen lds
  s_add_u32 m0, s51, 94208
  s_add_u32 s46, s60, 2752768
  buffer_load_dwordx4 v1, s[4:7], s46 offen lds
  s_waitcnt vmcnt(18)
  s_barrier
  s_add_u32 m0, s51, 98304
  s_add_u32 s46, s60, 3145728
  buffer_load_dwordx4 v1, s[4:7], s46 offen lds
  s_add_u32 m0, s51, 102400
  s_add_u32 s46, s60, 3145856
  buffer_load_dwordx4 v1, s[4:7], s46 offen lds
  s_add_u32 m0, s51, 106496
  s_add_u32 s46, s60, 3145984
  buffer_load_dwordx4 v1, s[4:7], s46 offen lds
  s_add_u32 m0, s51, 110592
  s_add_u32 s46, s60, 3538944
  buffer_load_dwordx4 v1, s[4:7], s46 offen lds
  s_add_u32 m0, s51, 114688
  s_add_u32 s46, s60, 3539072
  buffer_load_dwordx4 v1, s[4:7], s46 offen lds
  s_add_u32 m0, s51, 118784
  s_add_u32 s46, s60, 3539200
  buffer_load_dwordx4 v1, s[4:7], s46 offen lds
  ds_read_b64_tr_b16 a[0:1], v2 offset:0
  ds_read_b64_tr_b16 a[2:3], v2 offset:1024
  ds_read_b64_tr_b16 a[4:5], v2 offset:4096
  ds_read_b64_tr_b16 a[6:7], v2 offset:5120
  ds_read_b64_tr_b16 a[8:9], v2 offset:8192
  ds_read_b64_tr_b16 a[10:11], v2 offset:9216
  ds_read_b64_tr_b16 a[12:13], v2 offset:12288
  ds_read_b64_tr_b16 a[14:15], v2 offset:13312
  ds_read_b64_tr_b16 a[16:17], v2 offset:16384
  ds_read_b64_tr_b16 a[18:19], v2 offset:17408
  ds_read_b64_tr_b16 a[20:21], v2 offset:20480
  ds_read_b64_tr_b16 a[22:23], v2 offset:21504
  s_waitcnt lgkmcnt(0)
  s_waitcnt vmcnt(18)
  s_barrier
  s_add_u32 m0, s51, 0
  s_add_u32 s46, s60, 3932160
  buffer_load_dwordx4 v1, s[4:7], s46 offen lds
  s_add_u32 m0, s51, 4096
  s_add_u32 s46, s60, 3932288
  buffer_load_dwordx4 v1, s[4:7], s46 offen lds
  s_add_u32 m0, s51, 8192
  s_add_u32 s46, s60, 3932416
  buffer_load_dwordx4 v1, s[4:7], s46 offen lds
  s_add_u32 m0, s51, 12288
  s_add_u32 s46, s60, 4325376
  buffer_load_dwordx4 v1, s[4:7], s46 offen lds
  s_add_u32 m0, s51, 16384
  s_add_u32 s46, s60, 4325504
  buffer_load_dwordx4 v1, s[4:7], s46 offen lds
  s_add_u32 m0, s51, 20480
  s_add_u32 s46, s60, 4325632
  buffer_load_dwordx4 v1, s[4:7], s46 offen lds
  ds_read_b64_tr_b16 a[24:25], v2 offset:24576
  ds_read_b64_tr_b16 a[26:27], v2 offset:25600
  ds_read_b64_tr_b16 a[28:29], v2 offset:28672
  ds_read_b64_tr_b16 a[30:31], v2 offset:29696
  ds_read_b64_tr_b16 a[32:33], v2 offset:32768
  ds_read_b64_tr_b16 a[34:35], v2 offset:33792
  ds_read_b64_tr_b16 a[36:37], v2 offset:36864
  ds_read_b64_tr_b16 a[38:39], v2 offset:37888
  ds_read_b64_tr_b16 a[40:41], v2 offset:40960
  ds_read_b64_tr_b16 a[42:43], v2 offset:41984
  ds_read_b64_tr_b16 a[44:45], v2 offset:45056
  ds_read_b64_tr_b16 a[46:47], v2 offset:46080
  s_waitcnt lgkmcnt(0)
  s_waitcnt vmcnt(18)
  s_barrier
  s_add_u32 m0, s51, 24576
  s_add_u32 s46, s60, 4718592
  buffer_load_dwordx4 v1, s[4:7], s46 offen lds
  s_add_u32 m0, s51, 28672
  s_add_u32 s46, s60, 4718720
  buffer_load_dwordx4 v1, s[4:7], s46 offen lds
  s_add_u32 m0, s51, 32768
  s_add_u32 s46, s60, 4718848
  buffer_load_dwordx4 v1, s[4:7], s46 offen lds
  s_add_u32 m0, s51, 36864
  s_add_u32 s46, s60, 5111808
  buffer_load_dwordx4 v1, s[4:7], s46 offen lds
  s_add_u32 m0, s51, 40960
  s_add_u32 s46, s60, 5111936
  buffer_load_dwordx4 v1, s[4:7], s46 offen lds
  s_add_u32 m0, s51, 45056
  s_add_u32 s46, s60, 5112064
  buffer_load_dwordx4 v1, s[4:7], s46 offen lds
  ds_read_b64_tr_b16 a[48:49], v2 offset:49152
  ds_read_b64_tr_b16 a[50:51], v2 offset:50176
  ds_read_b64_tr_b16 a[52:53], v2 offset:53248
  ds_read_b64_tr_b16 a[54:55], v2 offset:54272
  ds_read_b64_tr_b16 a[56:57], v2 offset:57344
  ds_read_b64_tr_b16 a[58:59], v2 offset:58368
  ds_read_b64_tr_b16 a[60:61], v2 offset:61440
  ds_read_b64_tr_b16 a[62:63], v2 offset:62464
  ds_read_b64_tr_b16 a[64:65], v3 offset:0
  ds_read_b64_tr_b16 a[66:67], v3 offset:1024
  ds_read_b64_tr_b16 a[68:69], v3 offset:4096
  ds_read_b64_tr_b16 a[70:71], v3 offset:5120
  s_waitcnt lgkmcnt(0)
  s_waitcnt vmcnt(18)
  s_barrier
  s_add_u32 m0, s51, 49152
  s_add_u32 s46, s60, 5505024
  buffer_load_dwordx4 v1, s[4:7], s46 offen lds
  s_add_u32 m0, s51, 53248
  s_add_u32 s46, s60, 5505152
  buffer_load_dwordx4 v1, s[4:7], s46 offen lds
  s_add_u32 m0, s51, 57344
  s_add_u32 s46, s60, 5505280
  buffer_load_dwordx4 v1, s[4:7], s46 offen lds
  s_add_u32 m0, s51, 61440
  s_add_u32 s46, s60, 5898240
  buffer_load_dwordx4 v1, s[4:7], s46 offen lds
  s_add_u32 m0, s51, 65536
  s_add_u32 s46, s60, 5898368
  buffer_load_dwordx4 v1, s[4:7], s46 offen lds
  s_add_u32 m0, s51, 69632
  s_add_u32 s46, s60, 5898496
  buffer_load_dwordx4 v1, s[4:7], s46 offen lds
  ds_read_b64_tr_b16 a[72:73], v3 offset:8192
  ds_read_b64_tr_b16 a[74:75], v3 offset:9216
  ds_read_b64_tr_b16 a[76:77], v3 offset:12288
  ds_read_b64_tr_b16 a[78:79], v3 offset:13312
  ds_read_b64_tr_b16 a[80:81], v3 offset:16384
  ds_read_b64_tr_b16 a[82:83], v3 offset:17408
  ds_read_b64_tr_b16 a[84:85], v3 offset:20480
  ds_read_b64_tr_b16 a[86:87], v3 offset:21504
  ds_read_b64_tr_b16 a[88:89], v3 offset:24576
  ds_read_b64_tr_b16 a[90:91], v3 offset:25600
  ds_read_b64_tr_b16 a[92:93], v3 offset:28672
  ds_read_b64_tr_b16 a[94:95], v3 offset:29696
  s_waitcnt lgkmcnt(0)
  s_waitcnt vmcnt(18)
  s_barrier
  s_add_u32 m0, s51, 73728
  s_add_u32 s46, s60, 6291456
  buffer_load_dwordx4 v1, s[4:7], s46 offen lds
  s_add_u32 m0, s51, 77824
  s_add_u32 s46, s60, 6291584
  buffer_load_dwordx4 v1, s[4:7], s46 offen lds
  s_add_u32 m0, s51, 81920
  s_add_u32 s46, s60, 6291712
  buffer_load_dwordx4 v1, s[4:7], s46 offen lds
  s_add_u32 m0, s51, 86016
  s_add_u32 s46, s60, 6684672
  buffer_load_dwordx4 v1, s[4:7], s46 offen lds
  s_add_u32 m0, s51, 90112
  s_add_u32 s46, s60, 6684800
  buffer_load_dwordx4 v1, s[4:7], s46 offen lds
  s_add_u32 m0, s51, 94208
  s_add_u32 s46, s60, 6684928
  buffer_load_dwordx4 v1, s[4:7], s46 offen lds
  ds_read_b64_tr_b16 a[96:97], v3 offset:32768
  ds_read_b64_tr_b16 a[98:99], v3 offset:33792
  ds_read_b64_tr_b16 a[100:101], v3 offset:36864
  ds_read_b64_tr_b16 a[102:103], v3 offset:37888
  ds_read_b64_tr_b16 a[104:105], v3 offset:40960
  ds_read_b64_tr_b16 a[106:107], v3 offset:41984
  ds_read_b64_tr_b16 a[108:109], v3 offset:45056
  ds_read_b64_tr_b16 a[110:111], v3 offset:46080
  ds_read_b64_tr_b16 a[112:113], v3 offset:49152
  ds_read_b64_tr_b16 a[114:115], v3 offset:50176
  ds_read_b64_tr_b16 a[116:117], v3 offset:53248
  ds_read_b64_tr_b16 a[118:119], v3 offset:54272
  s_waitcnt lgkmcnt(0)
  s_waitcnt vmcnt(18)
  s_barrier
  s_add_u32 m0, s51, 98304
  s_add_u32 s46, s60, 7077888
  buffer_load_dwordx4 v1, s[4:7], s46 offen lds
  s_add_u32 m0, s51, 102400
  s_add_u32 s46, s60, 7078016
  buffer_load_dwordx4 v1, s[4:7], s46 offen lds
  s_add_u32 m0, s51, 106496
  s_add_u32 s46, s60, 7078144
  buffer_load_dwordx4 v1, s[4:7], s46 offen lds
  s_add_u32 m0, s51, 110592
  s_add_u32 s46, s60, 7471104
  buffer_load_dwordx4 v1, s[4:7], s46 offen lds
  s_add_u32 m0, s51, 114688
  s_add_u32 s46, s60, 7471232
  buffer_load_dwordx4 v1, s[4:7], s46 offen lds
  s_add_u32 m0, s51, 118784
  s_add_u32 s46, s60, 7471360
  buffer_load_dwordx4 v1, s[4:7], s46 offen lds
  ds_read_b64_tr_b16 a[120:121], v2 offset:0
  ds_read_b64_tr_b16 a[122:123], v2 offset:1024
  ds_read_b64_tr_b16 a[124:125], v2 offset:4096
  ds_read_b64_tr_b16 a[126:127], v2 offset:5120
  ds_read_b64_tr_b16 a[128:129], v2 offset:8192
  ds_read_b64_tr_b16 a[130:131], v2 offset:9216
  ds_read_b64_tr_b16 a[132:133], v2 offset:12288
  ds_read_b64_tr_b16 a[134:135], v2 offset:13312
  ds_read_b64_tr_b16 a[136:137], v2 offset:16384
  ds_read_b64_tr_b16 a[138:139], v2 offset:17408
  ds_read_b64_tr_b16 a[140:141], v2 offset:20480
  ds_read_b64_tr_b16 a[142:143], v2 offset:21504
  s_waitcnt lgkmcnt(0)
  s_waitcnt vmcnt(18)
  s_barrier
  ds_read_b64_tr_b16 a[144:145], v2 offset:24576
  ds_read_b64_tr_b16 a[146:147], v2 offset:25600
  ds_read_b64_tr_b16 a[148:149], v2 offset:28672
  ds_read_b64_tr_b16 a[150:151], v2 offset:29696
  ds_read_b64_tr_b16 a[152:153], v2 offset:32768
  ds_read_b64_tr_b16 a[154:155], v2 offset:33792
  ds_read_b64_tr_b16 a[156:157], v2 offset:36864
  ds_read_b64_tr_b16 a[158:159], v2 offset:37888
  ds_read_b64_tr_b16 a[160:161], v2 offset:40960
  ds_read_b64_tr_b16 a[162:163], v2 offset:41984
  ds_read_b64_tr_b16 a[164:165], v2 offset:45056
  ds_read_b64_tr_b16 a[166:167], v2 offset:46080
  s_waitcnt lgkmcnt(0)
  s_waitcnt vmcnt(12)
  s_barrier
  ds_read_b64_tr_b16 a[168:169], v2 offset:49152
  ds_read_b64_tr_b16 a[170:171], v2 offset:50176
  ds_read_b64_tr_b16 a[172:173], v2 offset:53248
  ds_read_b64_tr_b16 a[174:175], v2 offset:54272
  ds_read_b64_tr_b16 a[176:177], v2 offset:57344
  ds_read_b64_tr_b16 a[178:179], v2 offset:58368
  ds_read_b64_tr_b16 a[180:181], v2 offset:61440
  ds_read_b64_tr_b16 a[182:183], v2 offset:62464
  ds_read_b64_tr_b16 a[184:185], v3 offset:0
  ds_read_b64_tr_b16 a[186:187], v3 offset:1024
  ds_read_b64_tr_b16 a[188:189], v3 offset:4096
  ds_read_b64_tr_b16 a[190:191], v3 offset:5120
  s_waitcnt lgkmcnt(0)
  s_waitcnt vmcnt(6)
  s_barrier
  ds_read_b64_tr_b16 a[192:193], v3 offset:8192
  ds_read_b64_tr_b16 a[194:195], v3 offset:9216
  ds_read_b64_tr_b16 a[196:197], v3 offset:12288
  ds_read_b64_tr_b16 a[198:199], v3 offset:13312
  ds_read_b64_tr_b16 a[200:201], v3 offset:16384
  ds_read_b64_tr_b16 a[202:203], v3 offset:17408
  ds_read_b64_tr_b16 a[204:205], v3 offset:20480
  ds_read_b64_tr_b16 a[206:207], v3 offset:21504
  ds_read_b64_tr_b16 a[208:209], v3 offset:24576
  ds_read_b64_tr_b16 a[210:211], v3 offset:25600
  ds_read_b64_tr_b16 a[212:213], v3 offset:28672
  ds_read_b64_tr_b16 a[214:215], v3 offset:29696
  s_waitcnt lgkmcnt(0)
  s_waitcnt vmcnt(0)
  s_barrier
  ds_read_b64_tr_b16 a[216:217], v3 offset:32768
  ds_read_b64_tr_b16 a[218:219], v3 offset:33792
  ds_read_b64_tr_b16 a[220:221], v3 offset:36864
  ds_read_b64_tr_b16 a[222:223], v3 offset:37888
  ds_read_b64_tr_b16 a[224:225], v3 offset:40960
  ds_read_b64_tr_b16 a[226:227], v3 offset:41984
  ds_read_b64_tr_b16 a[228:229], v3 offset:45056
  ds_read_b64_tr_b16 a[230:231], v3 offset:46080
  ds_read_b64_tr_b16 a[232:233], v3 offset:49152
  ds_read_b64_tr_b16 a[234:235], v3 offset:50176
  ds_read_b64_tr_b16 a[236:237], v3 offset:53248
  ds_read_b64_tr_b16 a[238:239], v3 offset:54272
  s_waitcnt lgkmcnt(0)
  s_barrier
  v_and_b32 v11, 3, v0
  v_lshlrev_b32 v11, 2, v11
  s_mov_b32 s50, 0
ss_1:
  global_load_dword v10, v11, s[38:39] sc1
  s_add_u32 s50, s50, 1
  s_cmp_gt_u32 s50, 131072
  s_cbranch_scc1 L_fail
  s_waitcnt vmcnt(0)
  v_readlane_b32 s46, v10, 0
  v_readlane_b32 s47, v10, 2
  s_cmp_lg_u32 s46, 0
  s_cselect_b32 s48, 7, 0
  s_add_u32 s46, s46, s2
  s_xor_b32 s49, s46, s43
  s_and_b32 s49, s49, s48
  s_cbranch_scc1 L_reroll
  s_cmp_lg_u32 s47, 0
  s_cbranch_scc1 ss_ok_2
  s_sleep 10
  s_branch ss_1
ss_ok_2:
  v_readlane_b32 s3, v10, 1
  s_nop 0
  s_and_b32 s3, s3, 0x2000
  s_mov_b32 s54, s51
  s_add_u32 s53, s53, 40960
  s_add_u32 m0, s54, 0
  s_nop 0
  buffer_load_dwordx4 v5, s[12:15], s53 offen offset:0 lds
  s_add_u32 m0, s54, 3968
  s_nop 0
  buffer_load_dwordx4 v5, s[12:15], s53 offen offset:128 lds
  s_add_u32 m0, s54, 7936
  s_nop 0
  buffer_load_dwordx4 v5, s[12:15], s53 offen offset:256 lds
  s_add_u32 m0, s54, 11904
  s_nop 0
  buffer_load_dwordx4 v5, s[12:15], s53 offen offset:384 lds
  s_add_u32 m0, s54, 15872
  s_nop 0
  buffer_load_dwordx4 v5, s[12:15], s53 offen offset:512 lds
  s_add_u32 m0, s54, 19840
  s_nop 0
  buffer_load_dwordx4 v5, s[12:15], s53 offen offset:640 lds
  s_add_u32 m0, s54, 23808
  s_nop 0
  buffer_load_dwordx4 v5, s[12:15], s53 offen offset:768 lds
  s_add_u32 m0, s54, 27776
  s_nop 0
  buffer_load_dwordx4 v5, s[12:15], s53 offen offset:896 lds
  s_add_u32 m0, s54, 31744
  s_nop 0
  buffer_load_dwordx4 v5, s[12:15], s53 offen offset:1024 lds
  s_add_u32 m0, s54, 35712
  s_nop 0
  buffer_load_dwordx4 v5, s[12:15], s53 offen offset:1152 lds
  s_mov_b32 s55, 2146435072
  s_mov_b32 s56, 2146435072
  s_mov_b32 s57, 2146435072
  s_xor_b32 s63, s63, s3
  s_mov_b32 s58, 122880
  ds_read_b128 v[16:19], v6 offset:0
  ds_read_b128 v[20:23], v7 offset:0
  ds_read_b128 v[24:27], v6 offset:4096
  ds_read_b128 v[28:31], v7 offset:4096
  s_waitcnt lgkmcnt(3)
pj_loop_3:
  v_mfma_f32_16x16x32_bf16 v[40:43], a[0:3], v[16:19], 0
  ds_read_b128 v[32:35], v6 offset:8192
  v_mfma_f32_16x16x32_bf16 v[48:51], a[4:7], v[16:19], 0
  v_mfma_f32_16x16x32_bf16 v[56:59], a[8:11], v[16:19], 0
  s_waitcnt lgkmcnt(3)
  v_cvt_pk_bf16_f32 v66, v44, v45
  v_mfma_f32_16x16x32_bf16 v[40:43], a[12:15], v[20:23], v[40:43]
  ds_read_b128 v[16:19], v7 offset:8192
  v_cvt_pk_bf16_f32 v67, v46, v47
  v_mfma_f32_16x16x32_bf16 v[48:51], a[16:19], v[20:23], v[48:51]
  v_cvt_pk_bf16_f32 v70, v52, v53
  v_mfma_f32_16x16x32_bf16 v[56:59], a[20:23], v[20:23], v[56:59]
  s_waitcnt lgkmcnt(3)
  v_cvt_pk_bf16_f32 v71, v54, v55
  v_mfma_f32_16x16x32_bf16 v[40:43], a[24:27], v[24:27], v[40:43]
  ds_read_b128 v[20:23], v6 offset:12288
  v_cvt_pk_bf16_f32 v74, v60, v61
  v_mfma_f32_16x16x32_bf16 v[48:51], a[28:31], v[24:27], v[48:51]
  v_cvt_pk_bf16_f32 v75, v62, v63
  v_mfma_f32_16x16x32_bf16 v[56:59], a[32:35], v[24:27], v[56:59]
  s_waitcnt lgkmcnt(3)
  v_mfma_f32_16x16x32_bf16 v[40:43], a[36:39], v[28:31], v[40:43]
  ds_read_b128 v[24:27], v7 offset:12288
  v_permlane16_swap_b32 v64, v66
  v_mfma_f32_16x16x32_bf16 v[48:51], a[40:43], v[28:31], v[48:51]
  v_permlane16_swap_b32 v65, v67
  v_mfma_f32_16x16x32_bf16 v[56:59], a[44:47], v[28:31], v[56:59]
  buffer_store_dwordx4 v[64:67], v8, s[8:11], s55 offen sc1
  s_waitcnt lgkmcnt(3)
  v_mfma_f32_16x16x32_bf16 v[40:43], a[48:51], v[32:35], v[40:43]
  ds_read_b128 v[28:31], v6 offset:16384
  v_permlane16_swap_b32 v68, v70
  v_mfma_f32_16x16x32_bf16 v[48:51], a[52:55], v[32:35], v[48:51]
  v_permlane16_swap_b32 v69, v71
  v_mfma_f32_16x16x32_bf16 v[56:59], a[56:59], v[32:35], v[56:59]
  buffer_store_dwordx4 v[68:71], v8, s[8:11], s56 offen sc1
  s_waitcnt lgkmcnt(3)
  v_mfma_f32_16x16x32_bf16 v[40:43], a[60:63], v[16:19], v[40:43]
  ds_read_b128 v[32:35], v7 offset:16384
  v_permlane16_swap_b32 v72, v74
  v_mfma_f32_16x16x32_bf16 v[48:51], a[64:67], v[16:19], v[48:51]
  v_permlane16_swap_b32 v73, v75
  v_mfma_f32_16x16x32_bf16 v[56:59], a[68:71], v[16:19], v[56:59]
  buffer_store_dwordx4 v[72:75], v8, s[8:11], s57 offen sc1
  s_waitcnt lgkmcnt(3)
  v_mfma_f32_16x16x32_bf16 v[40:43], a[72:75], v[20:23], v[40:43]
  ds_read_b128 v[16:19], v6 offset:20480
  v_mfma_f32_16x16x32_bf16 v[48:51], a[76:79], v[20:23], v[48:51]
  v_mfma_f32_16x16x32_bf16 v[56:59], a[80:83], v[20:23], v[56:59]
  s_waitcnt lgkmcnt(3)
  v_mfma_f32_16x16x32_bf16 v[40:43], a[84:87], v[24:27], v[40:43]
  ds_read_b128 v[20:23], v7 offset:20480
  v_mfma_f32_16x16x32_bf16 v[48:51], a[88:91], v[24:27], v[48:51]
  v_mov_b32 v10, s52
  v_mfma_f32_16x16x32_bf16 v[56:59], a[92:95], v[24:27], v[56:59]
  s_waitcnt lgkmcnt(3)
  v_mfma_f32_16x16x32_bf16 v[40:43], a[96:99], v[28:31], v[40:43]
  ds_read_b128 v[24:27], v6 offset:24576
  v_mfma_f32_16x16x32_bf16 v[48:51], a[100:103], v[28:31], v[48:51]
  s_add_u32 s53, s53, 40960
  s_add_u32 s54, s54, 40960
  v_mfma_f32_16x16x32_bf16 v[56:59], a[104:107], v[28:31], v[56:59]
  s_waitcnt lgkmcnt(3)
  v_mfma_f32_16x16x32_bf16 v[40:43], a[108:111], v[32:35], v[40:43]
  ds_read_b128 v[28:31], v7 offset:24576
  v_mfma_f32_16x16x32_bf16 v[48:51], a[112:115], v[32:35], v[48:51]
  s_cmp_ge_u32 s54, 163840
  s_cselect_b32 s54, s51, s54
  v_mfma_f32_16x16x32_bf16 v[56:59], a[116:119], v[32:35], v[56:59]
  s_waitcnt lgkmcnt(3)
  v_mfma_f32_16x16x32_bf16 v[40:43], a[120:123], v[16:19], v[40:43]
  ds_read_b128 v[32:35], v6 offset:28672
  v_mfma_f32_16x16x32_bf16 v[48:51], a[124:127], v[16:19], v[48:51]
  s_cmp_eq_u32 s58, 122880
  s_cselect_b32 s59, 163840, 0
  v_mfma_f32_16x16x32_bf16 v[56:59], a[128:131], v[16:19], v[56:59]
  s_waitcnt lgkmcnt(3)
  v_mfma_f32_16x16x32_bf16 v[40:43], a[132:135], v[20:23], v[40:43]
  ds_read_b128 v[16:19], v7 offset:28672
  v_mfma_f32_16x16x32_bf16 v[48:51], a[136:139], v[20:23], v[48:51]
  s_sub_u32 s59, 40960, s59
  s_add_u32 s58, s58, s59
  v_mfma_f32_16x16x32_bf16 v[56:59], a[140:143], v[20:23], v[56:59]
  s_waitcnt lgkmcnt(3)
  v_mfma_f32_16x16x32_bf16 v[40:43], a[144:147], v[24:27], v[40:43]
  ds_read_b128 v[20:23], v6 offset:32768
  v_mfma_f32_16x16x32_bf16 v[48:51], a[148:151], v[24:27], v[48:51]
  s_lshr_b32 s55, s67, 1
  v_mfma_f32_16x16x32_bf16 v[56:59], a[152:155], v[24:27], v[56:59]
  s_lshl_b32 s55, s55, 14
  s_waitcnt lgkmcnt(3)
  v_mfma_f32_16x16x32_bf16 v[40:43], a[156:159], v[28:31], v[40:43]
  ds_read_b128 v[24:27], v7 offset:32768
  v_mfma_f32_16x16x32_bf16 v[48:51], a[160:163], v[28:31], v[48:51]
  s_and_b32 s56, s67, 1
  v_mfma_f32_16x16x32_bf16 v[56:59], a[164:167], v[28:31], v[56:59]
  s_lshl_b32 s56, s56, 12
  s_waitcnt lgkmcnt(3)
  v_mfma_f32_16x16x32_bf16 v[40:43], a[168:171], v[32:35], v[40:43]
  ds_read_b128 v[28:31], v6 offset:36864
  v_mfma_f32_16x16x32_bf16 v[48:51], a[172:175], v[32:35], v[48:51]
  s_add_u32 s55, s55, s56
  v_mfma_f32_16x16x32_bf16 v[56:59], a[176:179], v[32:35], v[56:59]
  s_add_u32 s55, s55, s63
  s_waitcnt lgkmcnt(3)
  v_mfma_f32_16x16x32_bf16 v[40:43], a[180:183], v[16:19], v[40:43]
  ds_read_b128 v[32:35], v7 offset:36864
  v_mfma_f32_16x16x32_bf16 v[48:51], a[184:187], v[16:19], v[48:51]
  s_lshr_b32 s56, s55, 8
  v_mfma_f32_16x16x32_bf16 v[56:59], a[188:191], v[16:19], v[56:59]
  s_and_b32 s56, s56, 0x2000
  s_waitcnt lgkmcnt(3)
  v_mfma_f32_16x16x32_bf16 v[40:43], a[192:195], v[20:23], v[40:43]
  ds_read_b128 v[16:19], v6 offset:2048
  v_mfma_f32_16x16x32_bf16 v[48:51], a[196:199], v[20:23], v[48:51]
  s_xor_b32 s55, s55, s56
  v_mfma_f32_16x16x32_bf16 v[56:59], a[200:203], v[20:23], v[56:59]
  s_add_u32 s67, s67, 32
  s_waitcnt lgkmcnt(3)
  v_mfma_f32_16x16x32_bf16 v[40:43], a[204:207], v[24:27], v[40:43]
  ds_read_b128 v[20:23], v7 offset:2048
  v_mfma_f32_16x16x32_bf16 v[48:51], a[208:211], v[24:27], v[48:51]
  s_cmp_ge_u32 s67, 1024
  s_cselect_b32 s56, 1024, 0
  v_mfma_f32_16x16x32_bf16 v[56:59], a[212:215], v[24:27], v[56:59]
  s_sub_u32 s67, s67, s56
  s_waitcnt lgkmcnt(3)
  v_mfma_f32_16x16x32_bf16 v[40:43], a[216:219], v[28:31], v[40:43]
  ds_read_b128 v[24:27], v6 offset:6144
  v_mfma_f32_16x16x32_bf16 v[48:51], a[220:223], v[28:31], v[48:51]
  s_add_u32 s56, s55, 16777216
  v_mfma_f32_16x16x32_bf16 v[56:59], a[224:227], v[28:31], v[56:59]
  s_add_u32 s57, s55, 33554432
  s_waitcnt lgkmcnt(3)
  v_mfma_f32_16x16x32_bf16 v[40:43], a[228:231], v[32:35], v[40:43]
  ds_read_b128 v[28:31], v7 offset:6144
  v_mfma_f32_16x16x32_bf16 v[48:51], a[232:235], v[32:35], v[48:51]
  v_mfma_f32_16x16x32_bf16 v[56:59], a[236:239], v[32:35], v[56:59]
  s_waitcnt lgkmcnt(3)
  v_mfma_f32_16x16x32_bf16 v[44:47], a[0:3], v[16:19], 0
  ds_read_b128 v[32:35], v6 offset:10240
  v_mfma_f32_16x16x32_bf16 v[52:55], a[4:7], v[16:19], 0
  v_mfma_f32_16x16x32_bf16 v[60:63], a[8:11], v[16:19], 0
  s_waitcnt lgkmcnt(3)
  v_cvt_pk_bf16_f32 v64, v40, v41
  v_mfma_f32_16x16x32_bf16 v[44:47], a[12:15], v[20:23], v[44:47]
  ds_read_b128 v[16:19], v7 offset:10240
  v_cvt_pk_bf16_f32 v65, v42, v43
  v_mfma_f32_16x16x32_bf16 v[52:55], a[16:19], v[20:23], v[52:55]
  v_cvt_pk_bf16_f32 v68, v48, v49
  v_mfma_f32_16x16x32_bf16 v[60:63], a[20:23], v[20:23], v[60:63]
  s_waitcnt lgkmcnt(3)
  v_cvt_pk_bf16_f32 v69, v50, v51
  v_mfma_f32_16x16x32_bf16 v[44:47], a[24:27], v[24:27], v[44:47]
  ds_read_b128 v[20:23], v6 offset:14336
  v_cvt_pk_bf16_f32 v72, v56, v57
  v_mfma_f32_16x16x32_bf16 v[52:55], a[28:31], v[24:27], v[52:55]
  v_cvt_pk_bf16_f32 v73, v58, v59
  v_mfma_f32_16x16x32_bf16 v[60:63], a[32:35], v[24:27], v[60:63]
  s_waitcnt lgkmcnt(3)
  v_mfma_f32_16x16x32_bf16 v[44:47], a[36:39], v[28:31], v[44:47]
  ds_read_b128 v[24:27], v7 offset:14336
  v_mfma_f32_16x16x32_bf16 v[52:55], a[40:43], v[28:31], v[52:55]
  s_waitcnt vmcnt(0)
  s_barrier
  v_mfma_f32_16x16x32_bf16 v[60:63], a[44:47], v[28:31], v[60:63]
  buffer_store_dword v10, v9, s[8:11], 0 offen sc1
  s_waitcnt lgkmcnt(3)
  v_mfma_f32_16x16x32_bf16 v[44:47], a[48:51], v[32:35], v[44:47]
  ds_read_b128 v[28:31], v6 offset:18432
  s_add_u32 m0, s54, 0
  v_mfma_f32_16x16x32_bf16 v[52:55], a[52:55], v[32:35], v[52:55]
  buffer_load_dwordx4 v5, s[12:15], s53 offen offset:0 lds
  v_mfma_f32_16x16x32_bf16 v[60:63], a[56:59], v[32:35], v[60:63]
  s_waitcnt lgkmcnt(3)
  v_mfma_f32_16x16x32_bf16 v[44:47], a[60:63], v[16:19], v[44:47]
  ds_read_b128 v[32:35], v7 offset:18432
  s_add_u32 m0, s54, 3968
  v_mfma_f32_16x16x32_bf16 v[52:55], a[64:67], v[16:19], v[52:55]
  buffer_load_dwordx4 v5, s[12:15], s53 offen offset:128 lds
  v_mfma_f32_16x16x32_bf16 v[60:63], a[68:71], v[16:19], v[60:63]
  s_waitcnt lgkmcnt(3)
  v_mfma_f32_16x16x32_bf16 v[44:47], a[72:75], v[20:23], v[44:47]
  ds_read_b128 v[16:19], v6 offset:22528
  s_add_u32 m0, s54, 7936
  v_mfma_f32_16x16x32_bf16 v[52:55], a[76:79], v[20:23], v[52:55]
  buffer_load_dwordx4 v5, s[12:15], s53 offen offset:256 lds
  v_mfma_f32_16x16x32_bf16 v[60:63], a[80:83], v[20:23], v[60:63]
  s_waitcnt lgkmcnt(3)
  v_mfma_f32_16x16x32_bf16 v[44:47], a[84:87], v[24:27], v[44:47]
  ds_read_b128 v[20:23], v7 offset:22528
  s_add_u32 m0, s54, 11904
  v_mfma_f32_16x16x32_bf16 v[52:55], a[88:91], v[24:27], v[52:55]
  buffer_load_dwordx4 v5, s[12:15], s53 offen offset:384 lds
  v_mfma_f32_16x16x32_bf16 v[60:63], a[92:95], v[24:27], v[60:63]
  s_waitcnt lgkmcnt(3)
  v_mfma_f32_16x16x32_bf16 v[44:47], a[96:99], v[28:31], v[44:47]
  ds_read_b128 v[24:27], v6 offset:26624
  s_add_u32 m0, s54, 15872
  v_mfma_f32_16x16x32_bf16 v[52:55], a[100:103], v[28:31], v[52:55]
  buffer_load_dwordx4 v5, s[12:15], s53 offen offset:512 lds
  v_mfma_f32_16x16x32_bf16 v[60:63], a[104:107], v[28:31], v[60:63]
  s_waitcnt lgkmcnt(3)
  v_mfma_f32_16x16x32_bf16 v[44:47], a[108:111], v[32:35], v[44:47]
  ds_read_b128 v[28:31], v7 offset:26624
  s_add_u32 m0, s54, 19840
  v_mfma_f32_16x16x32_bf16 v[52:55], a[112:115], v[32:35], v[52:55]
  buffer_load_dwordx4 v5, s[12:15], s53 offen offset:640 lds
  v_mfma_f32_16x16x32_bf16 v[60:63], a[116:119], v[32:35], v[60:63]
  s_waitcnt lgkmcnt(3)
  v_mfma_f32_16x16x32_bf16 v[44:47], a[120:123], v[16:19], v[44:47]
  ds_read_b128 v[32:35], v6 offset:30720
  s_add_u32 m0, s54, 23808
  v_mfma_f32_16x16x32_bf16 v[52:55], a[124:127], v[16:19], v[52:55]
  buffer_load_dwordx4 v5, s[12:15], s53 offen offset:768 lds
  v_mfma_f32_16x16x32_bf16 v[60:63], a[128:131], v[16:19], v[60:63]
  s_waitcnt lgkmcnt(3)
  v_mfma_f32_16x16x32_bf16 v[44:47], a[132:135], v[20:23], v[44:47]
  ds_read_b128 v[16:19], v7 offset:30720
  s_add_u32 m0, s54, 27776
  v_mfma_f32_16x16x32_bf16 v[52:55], a[136:139], v[20:23], v[52:55]
  buffer_load_dwordx4 v5, s[12:15], s53 offen offset:896 lds
  v_mfma_f32_16x16x32_bf16 v[60:63], a[140:143], v[20:23], v[60:63]
  s_waitcnt lgkmcnt(3)
  v_mfma_f32_16x16x32_bf16 v[44:47], a[144:147], v[24:27], v[44:47]
  ds_read_b128 v[20:23], v6 offset:34816
  s_add_u32 m0, s54, 31744
  v_mfma_f32_16x16x32_bf16 v[52:55], a[148:151], v[24:27], v[52:55]
  buffer_load_dwordx4 v5, s[12:15], s53 offen offset:1024 lds
  v_mfma_f32_16x16x32_bf16 v[60:63], a[152:155], v[24:27], v[60:63]
  s_waitcnt lgkmcnt(3)
  v_mfma_f32_16x16x32_bf16 v[44:47], a[156:159], v[28:31], v[44:47]
  ds_read_b128 v[24:27], v7 offset:34816
  s_add_u32 m0, s54, 35712
  v_mfma_f32_16x16x32_bf16 v[52:55], a[160:163], v[28:31], v[52:55]
  buffer_load_dwordx4 v5, s[12:15], s53 offen offset:1152 lds
  v_mfma_f32_16x16x32_bf16 v[60:63], a[164:167], v[28:31], v[60:63]
  s_waitcnt lgkmcnt(3)
  v_mfma_f32_16x16x32_bf16 v[44:47], a[168:171], v[32:35], v[44:47]
  ds_read_b128 v[28:31], v6 offset:38912
  v_mfma_f32_16x16x32_bf16 v[52:55], a[172:175], v[32:35], v[52:55]
  s_max_u32 s69, s52, 25
  s_sub_u32 s69, s69, 25
  v_mfma_f32_16x16x32_bf16 v[60:63], a[176:179], v[32:35], v[60:63]
  s_cmp_eq_u32 s52, s70
  s_cbranch_scc1 pj_warm
pj_wback:
  s_waitcnt lgkmcnt(3)
  v_mfma_f32_16x16x32_bf16 v[44:47], a[180:183], v[16:19], v[44:47]
  ds_read_b128 v[32:35], v7 offset:38912
  v_mfma_f32_16x16x32_bf16 v[52:55], a[184:187], v[16:19], v[52:55]
  v_add_u32 v6, s59, v6
  v_add_u32 v7, s59, v7
  v_mfma_f32_16x16x32_bf16 v[60:63], a[188:191], v[16:19], v[60:63]
  s_waitcnt lgkmcnt(3)
  v_mfma_f32_16x16x32_bf16 v[44:47], a[192:195], v[20:23], v[44:47]
  ds_read_b128 v[16:19], v6 offset:0
  v_mfma_f32_16x16x32_bf16 v[52:55], a[196:199], v[20:23], v[52:55]
  s_cmp_lt_u32 s68, s69
  s_cbranch_scc1 pj_slow
pj_back:
  v_mfma_f32_16x16x32_bf16 v[60:63], a[200:203], v[20:23], v[60:63]
  s_waitcnt lgkmcnt(3)
  v_mfma_f32_16x16x32_bf16 v[44:47], a[204:207], v[24:27], v[44:47]
  ds_read_b128 v[20:23], v7 offset:0
  v_mfma_f32_16x16x32_bf16 v[52:55], a[208:211], v[24:27], v[52:55]
  s_add_u32 s52, s52, 1
  v_mfma_f32_16x16x32_bf16 v[60:63], a[212:215], v[24:27], v[60:63]
  s_waitcnt lgkmcnt(3)
  v_mfma_f32_16x16x32_bf16 v[44:47], a[216:219], v[28:31], v[44:47]
  ds_read_b128 v[24:27], v6 offset:4096
  v_mfma_f32_16x16x32_bf16 v[52:55], a[220:223], v[28:31], v[52:55]
  v_mfma_f32_16x16x32_bf16 v[60:63], a[224:227], v[28:31], v[60:63]
  s_waitcnt lgkmcnt(3)
  v_mfma_f32_16x16x32_bf16 v[44:47], a[228:231], v[32:35], v[44:47]
  ds_read_b128 v[28:31], v7 offset:4096
  v_mfma_f32_16x16x32_bf16 v[52:55], a[232:235], v[32:35], v[52:55]
  s_cmp_lt_u32 s52, s62
  v_mfma_f32_16x16x32_bf16 v[60:63], a[236:239], v[32:35], v[60:63]
  s_waitcnt lgkmcnt(3)
  s_cbranch_scc1 pj_loop_3
  v_cvt_pk_bf16_f32 v66, v44, v45
  v_cvt_pk_bf16_f32 v67, v46, v47
  s_nop 1
  v_cvt_pk_bf16_f32 v70, v52, v53
  v_cvt_pk_bf16_f32 v71, v54, v55
  v_cvt_pk_bf16_f32 v74, v60, v61
  v_cvt_pk_bf16_f32 v75, v62, v63
  v_permlane16_swap_b32 v64, v66
  v_permlane16_swap_b32 v65, v67
  v_permlane16_swap_b32 v68, v70
  v_permlane16_swap_b32 v69, v71
  v_permlane16_swap_b32 v72, v74
  v_permlane16_swap_b32 v73, v75
  buffer_store_dwordx4 v[64:67], v8, s[8:11], s55 offen sc1
  buffer_store_dwordx4 v[68:71], v8, s[8:11], s56 offen sc1
  buffer_store_dwordx4 v[72:75], v8, s[8:11], s57 offen sc1
  v_mov_b32 v10, s52
  s_waitcnt vmcnt(0) lgkmcnt(0)
  s_barrier
  buffer_store_dword v10, v9, s[8:11], 0 offen sc1
  s_branch pj_done
pj_slow:
  s_cmp_ge_u32 s68, s69
  s_cbranch_scc1 wf_done_4
  s_mov_b32 s50, 0
wf_loop_5:
  buffer_load_dword v11, v14, s[8:11], 0 offen sc1
  s_add_u32 s50, s50, 1
  s_cmp_gt_u32 s50, 131072
  s_cbranch_scc1 L_fail
  s_waitcnt vmcnt(0)
  v_readfirstlane_b32 s68, v11
  s_nop 0
  s_cmp_ge_u32 s68, s69
  s_cbranch_scc1 wf_done_4
  s_sleep 2
  s_branch wf_loop_5
wf_done_4:
  s_branch pj_back
pj_warm:
  s_lshl_b32 s46, s44, 2
  s_add_u32 s46, s46, s43
  s_sub_u32 s46, s46, 4
  s_lshl_b32 s46, s46, 2
  s_add_u32 s46, s46, s42
  s_lshl_b32 s46, s46, 13
  v_lshlrev_b32 v11, 7, v0
  s_mov_b32 s4, s16
  s_mov_b32 s5, s17
  s_mov_b32 s6, 2621440
  s_mov_b32 s7, 0x20000
  buffer_load_dword v12, v11, s[4:7], s46 offen
  s_mov_b32 s4, s18
  s_mov_b32 s5, s19
  s_mov_b32 s6, 2457600
  s_mov_b32 s7, 0x20000
  buffer_load_dword v12, v11, s[4:7], s46 offen
  s_mov_b32 s4, s20
  s_mov_b32 s5, s21
  s_mov_b32 s6, 819200
  s_mov_b32 s7, 0x20000
  buffer_load_dword v12, v11, s[4:7], s46 offen
  s_branch pj_wback
pj_done:
  s_branch L_parta
L_uw:
  s_mov_b32 s4, s32
  s_mov_b32 s5, s33
  s_mov_b32 s6, 7864320
  s_mov_b32 s7, 0x20000
  v_lshrrev_b32 v8, 3, v0
  v_lshrrev_b32 v9, 2, v8
  v_lshlrev_b32 v9, 3, v9
  v_and_b32 v1, 3, v8
  v_add_u32 v1, v1, v9
  s_and_b32 s46, s42, 1
  s_lshl_b32 s46, s46, 2
  s_lshr_b32 s47, s42, 1
  s_lshl_b32 s47, s47, 4
  s_add_u32 s46, s46, s47
  v_add_u32 v1, s46, v1
  v_mul_u32_u24 v1, 1280, v1
  v_lshrrev_b32 v8, 1, v8
  v_bfe_u32 v9, v0, 1, 2
  v_xor_b32 v8, v8, v9
  v_lshlrev_b32 v8, 5, v8
  v_and_b32 v9, 1, v0
  v_lshlrev_b32 v9, 4, v9
  v_add3_u32 v1, v1, v8, v9
  v_lshrrev_b32 v8, 5, v0
  v_lshlrev_b32 v2, 11, v8
  v_bfe_u32 v8, v0, 2, 3
  v_lshl_add_u32 v2, v8, 7, v2
  v_lshrrev_b32 v8, 1, v8
  v_xor_b32 v8, s42, v8
  v_lshl_add_u32 v2, v8, 5, v2
  v_and_b32 v8, 3, v0
  v_lshl_add_u32 v2, v8, 3, v2
  v_add_u32 v3, 0x10000, v2
  v_add_u32 v4, 0x20000, v2
  s_mul_i32 s53, s45, 245760
  v_lshlrev_b32 v5, 4, v0
  s_lshl_b32 s46, s45, 7
  s_add_u32 s47, s46, 1056768
  v_mov_b32 v6, s47
  s_lshl_b32 s47, s42, 2
  s_add_u32 s46, s46, s47
  s_add_u32 s46, s46, 1060864
  v_mov_b32 v7, s46
  v_mov_b32 v8, 2146435072
  v_cmp_eq_u32 vcc, 0, v0
  s_nop 1
  v_cndmask_b32 v7, v8, v7, vcc
  v_cndmask_b32 v6, v8, v6, vcc
  s_mov_b32 s60, s51
  s_add_u32 s61, s51, 81797120
  s_mov_b32 s62, s45
  v_mov_b32 v12, v5
  s_lshr_b32 s55, s45, 3
  s_lshl_b32 s55, s55, 14
  s_and_b32 s46, s45, 7
  s_lshl_b32 s46, s46, 10
  s_add_u32 s55, s55, s46
  s_lshl_b32 s46, s42, 16
  s_add_u32 s55, s55, s46
  s_add_u32 s55, s55, 81788928
  s_mov_b32 s52, 0
  s_mov_b32 s56, 0
  s_add_u32 m0, s51, 0
  s_add_u32 s46, s53, 0
  buffer_load_dwordx4 v1, s[4:7], s46 offen lds
  s_add_u32 m0, s51, 4096
  s_add_u32 s46, s53, 128
  buffer_load_dwordx4 v1, s[4:7], s46 offen lds
  s_add_u32 m0, s51, 8192
  s_add_u32 s46, s53, 256
  buffer_load_dwordx4 v1, s[4:7], s46 offen lds
  s_add_u32 m0, s51, 12288
  s_add_u32 s46, s53, 384
  buffer_load_dwordx4 v1, s[4:7], s46 offen lds
  s_add_u32 m0, s51, 16384
  s_add_u32 s46, s53, 512
  buffer_load_dwordx4 v1, s[4:7], s46 offen lds
  s_add_u32 m0, s51, 20480
  s_add_u32 s46, s53, 640
  buffer_load_dwordx4 v1, s[4:7], s46 offen lds
  s_add_u32 m0, s51, 24576
  s_add_u32 s46, s53, 768
  buffer_load_dwordx4 v1, s[4:7], s46 offen lds
  s_add_u32 m0, s51, 28672
  s_add_u32 s46, s53, 896
  buffer_load_dwordx4 v1, s[4:7], s46 offen lds
  s_add_u32 m0, s51, 32768
  s_add_u32 s46, s53, 1024
  buffer_load_dwordx4 v1, s[4:7], s46 offen lds
  s_add_u32 m0, s51, 36864
  s_add_u32 s46, s53, 1152
  buffer_load_dwordx4 v1, s[4:7], s46 offen lds
  s_add_u32 m0, s51, 40960
  s_add_u32 s46, s53, 40960
  buffer_load_dwordx4 v1, s[4:7], s46 offen lds
  s_add_u32 m0, s51, 45056
  s_add_u32 s46, s53, 41088
  buffer_load_dwordx4 v1, s[4:7], s46 offen lds
  s_add_u32 m0, s51, 49152
  s_add_u32 s46, s53, 41216
  buffer_load_dwordx4 v1, s[4:7], s46 offen lds
  s_add_u32 m0, s51, 53248
  s_add_u32 s46, s53, 41344
  buffer_load_dwordx4 v1, s[4:7], s46 offen lds
  s_add_u32 m0, s51, 57344
  s_add_u32 s46, s53, 41472
  buffer_load_dwordx4 v1, s[4:7], s46 offen lds
  s_add_u32 m0, s51, 61440
  s_add_u32 s46, s53, 41600
  buffer_load_dwordx4 v1, s[4:7], s46 offen lds
  s_add_u32 m0, s51, 65536
  s_add_u32 s46, s53, 41728
  buffer_load_dwordx4 v1, s[4:7], s46 offen lds
  s_add_u32 m0, s51, 69632
  s_add_u32 s46, s53, 41856
  buffer_load_dwordx4 v1, s[4:7], s46 offen lds
  s_add_u32 m0, s51, 73728
  s_add_u32 s46, s53, 41984
  buffer_load_dwordx4 v1, s[4:7], s46 offen lds
  s_add_u32 m0, s51, 77824
  s_add_u32 s46, s53, 42112
  buffer_load_dwordx4 v1, s[4:7], s46 offen lds
  s_add_u32 m0, s51, 81920
  s_add_u32 s46, s53, 81920
  buffer_load_dwordx4 v1, s[4:7], s46 offen lds
  s_add_u32 m0, s51, 86016
  s_add_u32 s46, s53, 82048
  buffer_load_dwordx4 v1, s[4:7], s46 offen lds
  s_add_u32 m0, s51, 90112
  s_add_u32 s46, s53, 82176
  buffer_load_dwordx4 v1, s[4:7], s46 offen lds
  s_add_u32 m0, s51, 94208
  s_add_u32 s46, s53, 82304
  buffer_load_dwordx4 v1, s[4:7], s46 offen lds
  s_add_u32 m0, s51, 98304
  s_add_u32 s46, s53, 82432
  buffer_load_dwordx4 v1, s[4:7], s46 offen lds
  s_add_u32 m0, s51, 102400
  s_add_u32 s46, s53, 82560
  buffer_load_dwordx4 v1, s[4:7], s46 offen lds
  s_add_u32 m0, s51, 106496
  s_add_u32 s46, s53, 82688
  buffer_load_dwordx4 v1, s[4:7], s46 offen lds
  s_add_u32 m0, s51, 110592
  s_add_u32 s46, s53, 82816
  buffer_load_dwordx4 v1, s[4:7], s46 offen lds
  s_add_u32 m0, s51, 114688
  s_add_u32 s46, s53, 82944
  buffer_load_dwordx4 v1, s[4:7], s46 offen lds
  s_add_u32 m0, s51, 118784
  s_add_u32 s46, s53, 83072
  buffer_load_dwordx4 v1, s[4:7], s46 offen lds
  s_waitcnt vmcnt(24)
  s_barrier
  s_add_u32 m0, s51, 122880
  s_add_u32 s46, s53, 122880
  buffer_load_dwordx4 v1, s[4:7], s46 offen lds
  s_add_u32 m0, s51, 126976
  s_add_u32 s46, s53, 123008
  buffer_load_dwordx4 v1, s[4:7], s46 offen lds
  s_add_u32 m0, s51, 131072
  s_add_u32 s46, s53, 123136
  buffer_load_dwordx4 v1, s[4:7], s46 offen lds
  s_add_u32 m0, s51, 135168
  s_add_u32 s46, s53, 123264
  buffer_load_dwordx4 v1, s[4:7], s46 offen lds
  s_add_u32 m0, s51, 139264
  s_add_u32 s46, s53, 123392
  buffer_load_dwordx4 v1, s[4:7], s46 offen lds
  s_add_u32 m0, s51, 143360
  s_add_u32 s46, s53, 123520
  buffer_load_dwordx4 v1, s[4:7], s46 offen lds
  ds_read_b64_tr_b16 a[0:1], v2 offset:0
  ds_read_b64_tr_b16 a[2:3], v2 offset:1024
  ds_read_b64_tr_b16 a[24:25], v2 offset:4096
  ds_read_b64_tr_b16 a[26:27], v2 offset:5120
  ds_read_b64_tr_b16 a[48:49], v2 offset:8192
  ds_read_b64_tr_b16 a[50:51], v2 offset:9216
  ds_read_b64_tr_b16 a[72:73], v2 offset:12288
  ds_read_b64_tr_b16 a[74:75], v2 offset:13312
  ds_read_b64_tr_b16 a[96:97], v2 offset:16384
  ds_read_b64_tr_b16 a[98:99], v2 offset:17408
  ds_read_b64_tr_b16 a[120:121], v2 offset:20480
  ds_read_b64_tr_b16 a[122:123], v2 offset:21504
  s_waitcnt lgkmcnt(0)
  s_waitcnt vmcnt(24)
  s_barrier
  s_add_u32 m0, s51, 0
  s_add_u32 s46, s53, 123648
  buffer_load_dwordx4 v1, s[4:7], s46 offen lds
  s_add_u32 m0, s51, 4096
  s_add_u32 s46, s53, 123776
  buffer_load_dwordx4 v1, s[4:7], s46 offen lds
  s_add_u32 m0, s51, 8192
  s_add_u32 s46, s53, 123904
  buffer_load_dwordx4 v1, s[4:7], s46 offen lds
  s_add_u32 m0, s51, 12288
  s_add_u32 s46, s53, 124032
  buffer_load_dwordx4 v1, s[4:7], s46 offen lds
  s_add_u32 m0, s51, 16384
  s_add_u32 s46, s53, 163840
  buffer_load_dwordx4 v1, s[4:7], s46 offen lds
  s_add_u32 m0, s51, 20480
  s_add_u32 s46, s53, 163968
  buffer_load_dwordx4 v1, s[4:7], s46 offen lds
  ds_read_b64_tr_b16 a[144:145], v2 offset:24576
  ds_read_b64_tr_b16 a[146:147], v2 offset:25600
  ds_read_b64_tr_b16 a[168:169], v2 offset:28672
  ds_read_b64_tr_b16 a[170:171], v2 offset:29696
  ds_read_b64_tr_b16 a[192:193], v2 offset:32768
  ds_read_b64_tr_b16 a[194:195], v2 offset:33792
  ds_read_b64_tr_b16 a[216:217], v2 offset:36864
  ds_read_b64_tr_b16 a[218:219], v2 offset:37888
  ds_read_b64_tr_b16 a[4:5], v2 offset:40960
  ds_read_b64_tr_b16 a[6:7], v2 offset:41984
  ds_read_b64_tr_b16 a[28:29], v2 offset:45056
  ds_read_b64_tr_b16 a[30:31], v2 offset:46080
  s_waitcnt lgkmcnt(0)
  s_waitcnt vmcnt(24)
  s_barrier
  s_add_u32 m0, s51, 24576
  s_add_u32 s46, s53, 164096
  buffer_load_dwordx4 v1, s[4:7], s46 offen lds
  s_add_u32 m0, s51, 28672
  s_add_u32 s46, s53, 164224
  buffer_load_dwordx4 v1, s[4:7], s46 offen lds
  s_add_u32 m0, s51, 32768
  s_add_u32 s46, s53, 164352
  buffer_load_dwordx4 v1, s[4:7], s46 offen lds
  s_add_u32 m0, s51, 36864
  s_add_u32 s46, s53, 164480
  buffer_load_dwordx4 v1, s[4:7], s46 offen lds
  s_add_u32 m0, s51, 40960
  s_add_u32 s46, s53, 164608
  buffer_load_dwordx4 v1, s[4:7], s46 offen lds
  s_add_u32 m0, s51, 45056
  s_add_u32 s46, s53, 164736
  buffer_load_dwordx4 v1, s[4:7], s46 offen lds
  ds_read_b64_tr_b16 a[52:53], v2 offset:49152
  ds_read_b64_tr_b16 a[54:55], v2 offset:50176
  ds_read_b64_tr_b16 a[76:77], v2 offset:53248
  ds_read_b64_tr_b16 a[78:79], v2 offset:54272
  ds_read_b64_tr_b16 a[100:101], v2 offset:57344
  ds_read_b64_tr_b16 a[102:103], v2 offset:58368
  ds_read_b64_tr_b16 a[124:125], v2 offset:61440
  ds_read_b64_tr_b16 a[126:127], v2 offset:62464
  ds_read_b64_tr_b16 a[148:149], v3 offset:0
  ds_read_b64_tr_b16 a[150:151], v3 offset:1024
  ds_read_b64_tr_b16 a[172:173], v3 offset:4096
  ds_read_b64_tr_b16 a[174:175], v3 offset:5120
  s_waitcnt lgkmcnt(0)
  s_waitcnt vmcnt(24)
  s_barrier
  s_add_u32 m0, s51, 49152
  s_add_u32 s46, s53, 164864
  buffer_load_dwordx4 v1, s[4:7], s46 offen lds
  s_add_u32 m0, s51, 53248
  s_add_u32 s46, s53, 164992
  buffer_load_dwordx4 v1, s[4:7], s46 offen lds
  s_add_u32 m0, s51, 57344
  s_add_u32 s46, s53, 204800
  buffer_load_dwordx4 v1, s[4:7], s46 offen lds
  s_add_u32 m0, s51, 61440
  s_add_u32 s46, s53, 204928
  buffer_load_dwordx4 v1, s[4:7], s46 offen lds
  s_add_u32 m0, s51, 65536
  s_add_u32 s46, s53, 205056
  buffer_load_dwordx4 v1, s[4:7], s46 offen lds
  s_add_u32 m0, s51, 69632
  s_add_u32 s46, s53, 205184
  buffer_load_dwordx4 v1, s[4:7], s46 offen lds
  ds_read_b64_tr_b16 a[196:197], v3 offset:8192
  ds_read_b64_tr_b16 a[198:199], v3 offset:9216
  ds_read_b64_tr_b16 a[220:221], v3 offset:12288
  ds_read_b64_tr_b16 a[222:223], v3 offset:13312
  ds_read_b64_tr_b16 a[8:9], v3 offset:16384
  ds_read_b64_tr_b16 a[10:11], v3 offset:17408
  ds_read_b64_tr_b16 a[32:33], v3 offset:20480
  ds_read_b64_tr_b16 a[34:35], v3 offset:21504
  ds_read_b64_tr_b16 a[56:57], v3 offset:24576
  ds_read_b64_tr_b16 a[58:59], v3 offset:25600
  ds_read_b64_tr_b16 a[80:81], v3 offset:28672
  ds_read_b64_tr_b16 a[82:83], v3 offset:29696
  s_waitcnt lgkmcnt(0)
  s_waitcnt vmcnt(24)
  s_barrier
  s_add_u32 m0, s51, 73728
  s_add_u32 s46, s53, 205312
  buffer_load_dwordx4 v1, s[4:7], s46 offen lds
  s_add_u32 m0, s51, 77824
  s_add_u32 s46, s53, 205440
  buffer_load_dwordx4 v1, s[4:7], s46 offen lds
  s_add_u32 m0, s51, 81920
  s_add_u32 s46, s53, 205568
  buffer_load_dwordx4 v1, s[4:7], s46 offen lds
  s_add_u32 m0, s51, 86016
  s_add_u32 s46, s53, 205696
  buffer_load_dwordx4 v1, s[4:7], s46 offen lds
  s_add_u32 m0, s51, 90112
  s_add_u32 s46, s53, 205824
  buffer_load_dwordx4 v1, s[4:7], s46 offen lds
  s_add_u32 m0, s51, 94208
  s_add_u32 s46, s53, 205952
  buffer_load_dwordx4 v1, s[4:7], s46 offen lds
  ds_read_b64_tr_b16 a[104:105], v3 offset:32768
  ds_read_b64_tr_b16 a[106:107], v3 offset:33792
  ds_read_b64_tr_b16 a[128:129], v3 offset:36864
  ds_read_b64_tr_b16 a[130:131], v3 offset:37888
  ds_read_b64_tr_b16 a[152:153], v3 offset:40960
  ds_read_b64_tr_b16 a[154:155], v3 offset:41984
  ds_read_b64_tr_b16 a[176:177], v3 offset:45056
  ds_read_b64_tr_b16 a[178:179], v3 offset:46080
  ds_read_b64_tr_b16 a[200:201], v3 offset:49152
  ds_read_b64_tr_b16 a[202:203], v3 offset:50176
  ds_read_b64_tr_b16 a[224:225], v3 offset:53248
  ds_read_b64_tr_b16 a[226:227], v3 offset:54272
  s_waitcnt lgkmcnt(0)
  s_waitcnt vmcnt(24)
  s_barrier
  ds_read_b64_tr_b16 a[12:13], v3 offset:57344
  ds_read_b64_tr_b16 a[14:15], v3 offset:58368
  ds_read_b64_tr_b16 a[36:37], v3 offset:61440
  ds_read_b64_tr_b16 a[38:39], v3 offset:62464
  ds_read_b64_tr_b16 a[60:61], v4 offset:0
  ds_read_b64_tr_b16 a[62:63], v4 offset:1024
  ds_read_b64_tr_b16 a[84:85], v4 offset:4096
  ds_read_b64_tr_b16 a[86:87], v4 offset:5120
  ds_read_b64_tr_b16 a[108:109], v4 offset:8192
  ds_read_b64_tr_b16 a[110:111], v4 offset:9216
  ds_read_b64_tr_b16 a[132:133], v4 offset:12288
  ds_read_b64_tr_b16 a[134:135], v4 offset:13312
  s_waitcnt lgkmcnt(0)
  s_waitcnt vmcnt(18)
  s_barrier
  ds_read_b64_tr_b16 a[156:157], v2 offset:0
  ds_read_b64_tr_b16 a[158:159], v2 offset:1024
  ds_read_b64_tr_b16 a[180:181], v2 offset:4096
  ds_read_b64_tr_b16 a[182:183], v2 offset:5120
  ds_read_b64_tr_b16 a[204:205], v2 offset:8192
  ds_read_b64_tr_b16 a[206:207], v2 offset:9216
  ds_read_b64_tr_b16 a[228:229], v2 offset:12288
  ds_read_b64_tr_b16 a[230:231], v2 offset:13312
  ds_read_b64_tr_b16 a[16:17], v2 offset:16384
  ds_read_b64_tr_b16 a[18:19], v2 offset:17408
  ds_read_b64_tr_b16 a[40:41], v2 offset:20480
  ds_read_b64_tr_b16 a[42:43], v2 offset:21504
  s_waitcnt lgkmcnt(0)
  s_waitcnt vmcnt(12)
  s_barrier
  ds_read_b64_tr_b16 a[64:65], v2 offset:24576
  ds_read_b64_tr_b16 a[66:67], v2 offset:25600
  ds_read_b64_tr_b16 a[88:89], v2 offset:28672
  ds_read_b64_tr_b16 a[90:91], v2 offset:29696
  ds_read_b64_tr_b16 a[112:113], v2 offset:32768
  ds_read_b64_tr_b16 a[114:115], v2 offset:33792
  ds_read_b64_tr_b16 a[136:137], v2 offset:36864
  ds_read_b64_tr_b16 a[138:139], v2 offset:37888
  ds_read_b64_tr_b16 a[160:161], v2 offset:40960
  ds_read_b64_tr_b16 a[162:163], v2 offset:41984
  ds_read_b64_tr_b16 a[184:185], v2 offset:45056
  ds_read_b64_tr_b16 a[186:187], v2 offset:46080
  s_waitcnt lgkmcnt(0)
  s_waitcnt vmcnt(6)
  s_barrier
  ds_read_b64_tr_b16 a[208:209], v2 offset:49152
  ds_read_b64_tr_b16 a[210:211], v2 offset:50176
  ds_read_b64_tr_b16 a[232:233], v2 offset:53248
  ds_read_b64_tr_b16 a[234:235], v2 offset:54272
  ds_read_b64_tr_b16 a[20:21], v2 offset:57344
  ds_read_b64_tr_b16 a[22:23], v2 offset:58368
  ds_read_b64_tr_b16 a[44:45], v2 offset:61440
  ds_read_b64_tr_b16 a[46:47], v2 offset:62464
  ds_read_b64_tr_b16 a[68:69], v3 offset:0
  ds_read_b64_tr_b16 a[70:71], v3 offset:1024
  ds_read_b64_tr_b16 a[92:93], v3 offset:4096
  ds_read_b64_tr_b16 a[94:95], v3 offset:5120
  s_waitcnt lgkmcnt(0)
  s_waitcnt vmcnt(0)
  s_barrier
  ds_read_b64_tr_b16 a[116:117], v3 offset:8192
  ds_read_b64_tr_b16 a[118:119], v3 offset:9216
  ds_read_b64_tr_b16 a[140:141], v3 offset:12288
  ds_read_b64_tr_b16 a[142:143], v3 offset:13312
  ds_read_b64_tr_b16 a[164:165], v3 offset:16384
  ds_read_b64_tr_b16 a[166:167], v3 offset:17408
  ds_read_b64_tr_b16 a[188:189], v3 offset:20480
  ds_read_b64_tr_b16 a[190:191], v3 offset:21504
  ds_read_b64_tr_b16 a[212:213], v3 offset:24576
  ds_read_b64_tr_b16 a[214:215], v3 offset:25600
  ds_read_b64_tr_b16 a[236:237], v3 offset:28672
  ds_read_b64_tr_b16 a[238:239], v3 offset:29696
  s_waitcnt lgkmcnt(0)
  s_barrier
  v_and_b32 v9, 3, v0
  v_lshlrev_b32 v9, 2, v9
  s_mov_b32 s50, 0
ss_6:
  global_load_dword v8, v9, s[38:39] sc1
  s_add_u32 s50, s50, 1
  s_cmp_gt_u32 s50, 131072
  s_cbranch_scc1 L_fail
  s_waitcnt vmcnt(0)
  v_readlane_b32 s46, v8, 0
  v_readlane_b32 s47, v8, 2
  s_cmp_lg_u32 s46, 0
  s_cselect_b32 s48, 7, 0
  s_add_u32 s46, s46, s2
  s_xor_b32 s49, s46, s43
  s_and_b32 s49, s49, s48
  s_cbranch_scc1 L_reroll
  s_cmp_lg_u32 s47, 0
  s_cbranch_scc1 ss_ok_7
  s_sleep 10
  s_branch ss_6
ss_ok_7:
  v_readlane_b32 s3, v8, 1
  s_nop 0
  s_and_b32 s3, s3, 0x2000
  s_xor_b32 s61, s61, s3
  s_xor_b32 s55, s55, s3
  s_mov_b32 s57, 1
  s_cmp_ge_u32 s56, s57
  s_cbranch_scc1 wf_done_8
  s_mov_b32 s50, 0
wf_loop_9:
  buffer_load_dword v13, v6, s[8:11], 0 offen sc1
  s_add_u32 s50, s50, 1
  s_cmp_gt_u32 s50, 131072
  s_cbranch_scc1 L_fail
  s_waitcnt vmcnt(0)
  v_readfirstlane_b32 s56, v13
  s_nop 0
  s_cmp_ge_u32 s56, s57
  s_cbranch_scc1 wf_done_8
  s_sleep 2
  s_branch wf_loop_9
wf_done_8:
  s_lshr_b32 s54, s62, 1
  s_lshl_b32 s54, s54, 14
  s_and_b32 s47, s62, 1
  s_lshl_b32 s47, s47, 12
  s_add_u32 s54, s54, s47
  s_add_u32 s54, s54, s61
  s_lshr_b32 s47, s54, 8
  s_and_b32 s47, s47, 0x2000
  s_xor_b32 s54, s54, s47
  s_add_u32 m0, s60, 0
  s_add_u32 s47, s54, 0
  buffer_load_dwordx4 v5, s[8:11], s47 offen sc1 lds
  s_add_u32 m0, s60, 4096
  s_add_u32 s47, s54, 16777216
  buffer_load_dwordx4 v5, s[8:11], s47 offen sc1 lds
  s_add_u32 m0, s60, 8192
  s_add_u32 s47, s54, 33554432
  buffer_load_dwordx4 v5, s[8:11], s47 offen sc1 lds
  s_mov_b32 s59, 2146435072
  s_waitcnt vmcnt(0)
  s_barrier
  ds_read_b128 v[16:19], v12 offset:0
  ds_read_b128 v[40:43], v12 offset:2048
  ds_read_b128 v[20:23], v12 offset:1024
  ds_read_b128 v[44:47], v12 offset:3072
  ds_read_b128 v[24:27], v12 offset:4096
  ds_read_b128 v[48:51], v12 offset:6144
  ds_read_b128 v[28:31], v12 offset:5120
  ds_read_b128 v[52:55], v12 offset:7168
  ds_read_b128 v[32:35], v12 offset:8192
  ds_read_b128 v[56:59], v12 offset:10240
  ds_read_b128 v[36:39], v12 offset:9216
  ds_read_b128 v[60:63], v12 offset:11264
u_loop:
  s_waitcnt lgkmcnt(8)
  v_mfma_f32_16x16x32_bf16 v[64:67], v[16:19], a[0:3], 0
  buffer_load_dword v13, v6, s[8:11], 0 offen sc1
  v_mfma_f32_16x16x32_bf16 v[68:71], v[40:43], a[0:3], 0
  v_mfma_f32_16x16x32_bf16 v[64:67], v[20:23], a[4:7], v[64:67]
  v_cvt_pk_bf16_f32 v84, v72, v73
  v_mfma_f32_16x16x32_bf16 v[68:71], v[44:47], a[4:7], v[68:71]
  s_waitcnt lgkmcnt(4)
  v_cvt_pk_bf16_f32 v85, v74, v75
  v_mfma_f32_16x16x32_bf16 v[64:67], v[24:27], a[8:11], v[64:67]
  v_cvt_pk_bf16_f32 v86, v76, v77
  v_mfma_f32_16x16x32_bf16 v[68:71], v[48:51], a[8:11], v[68:71]
  v_cvt_pk_bf16_f32 v87, v78, v79
  v_mfma_f32_16x16x32_bf16 v[64:67], v[28:31], a[12:15], v[64:67]
  buffer_store_dwordx4 v[84:87], v5, s[8:11], s59 offen sc1
  v_mfma_f32_16x16x32_bf16 v[68:71], v[52:55], a[12:15], v[68:71]
  s_add_u32 s58, s55, 0
  s_waitcnt lgkmcnt(0)
  v_mfma_f32_16x16x32_bf16 v[64:67], v[32:35], a[16:19], v[64:67]
  s_lshr_b32 s46, s58, 8
  v_mfma_f32_16x16x32_bf16 v[68:71], v[56:59], a[16:19], v[68:71]
  s_and_b32 s46, s46, 0x2000
  v_mfma_f32_16x16x32_bf16 v[64:67], v[36:39], a[20:23], v[64:67]
  s_xor_b32 s58, s58, s46
  v_mfma_f32_16x16x32_bf16 v[68:71], v[60:63], a[20:23], v[68:71]
  v_mfma_f32_16x16x32_bf16 v[72:75], v[16:19], a[24:27], 0
  s_add_u32 s59, s55, 2359296
  v_mfma_f32_16x16x32_bf16 v[76:79], v[40:43], a[24:27], 0
  s_lshr_b32 s46, s59, 8
  v_mfma_f32_16x16x32_bf16 v[72:75], v[20:23], a[28:31], v[72:75]
  s_and_b32 s46, s46, 0x2000
  v_cvt_pk_bf16_f32 v80, v64, v65
  v_mfma_f32_16x16x32_bf16 v[76:79], v[44:47], a[28:31], v[76:79]
  s_xor_b32 s59, s59, s46
  v_cvt_pk_bf16_f32 v81, v66, v67
  v_mfma_f32_16x16x32_bf16 v[72:75], v[24:27], a[32:35], v[72:75]
  v_cvt_pk_bf16_f32 v82, v68, v69
  v_mfma_f32_16x16x32_bf16 v[76:79], v[48:51], a[32:35], v[76:79]
  s_add_u32 s57, s52, 2
  s_min_u32 s57, s57, 64
  v_cvt_pk_bf16_f32 v83, v70, v71
  v_mfma_f32_16x16x32_bf16 v[72:75], v[28:31], a[36:39], v[72:75]
  buffer_store_dwordx4 v[80:83], v5, s[8:11], s58 offen sc1
  v_mfma_f32_16x16x32_bf16 v[76:79], v[52:55], a[36:39], v[76:79]
  s_add_u32 s58, s55, 262144
  v_mfma_f32_16x16x32_bf16 v[72:75], v[32:35], a[40:43], v[72:75]
  s_lshr_b32 s46, s58, 8
  v_mfma_f32_16x16x32_bf16 v[76:79], v[56:59], a[40:43], v[76:79]
  s_and_b32 s46, s46, 0x2000
  v_mfma_f32_16x16x32_bf16 v[72:75], v[36:39], a[44:47], v[72:75]
  s_xor_b32 s58, s58, s46
  v_mfma_f32_16x16x32_bf16 v[76:79], v[60:63], a[44:47], v[76:79]
  s_xor_b32 s60, s60, 0x4000
  v_mov_b32 v8, s52
  v_mfma_f32_16x16x32_bf16 v[64:67], v[16:19], a[48:51], 0
  s_add_u32 s62, s62, 32
  v_xor_b32 v12, 0x4000, v12
  v_mfma_f32_16x16x32_bf16 v[68:71], v[40:43], a[48:51], 0
  s_cmp_ge_u32 s62, 1024
  s_cselect_b32 s47, 1024, 0
  v_mfma_f32_16x16x32_bf16 v[64:67], v[20:23], a[52:55], v[64:67]
  s_sub_u32 s62, s62, s47
  v_cvt_pk_bf16_f32 v84, v72, v73
  v_mfma_f32_16x16x32_bf16 v[68:71], v[44:47], a[52:55], v[68:71]
  s_lshr_b32 s54, s62, 1
  v_cvt_pk_bf16_f32 v85, v74, v75
  v_mfma_f32_16x16x32_bf16 v[64:67], v[24:27], a[56:59], v[64:67]
  s_lshl_b32 s54, s54, 14
  v_cvt_pk_bf16_f32 v86, v76, v77
  v_mfma_f32_16x16x32_bf16 v[68:71], v[48:51], a[56:59], v[68:71]
  s_and_b32 s47, s62, 1
  v_cvt_pk_bf16_f32 v87, v78, v79
  v_mfma_f32_16x16x32_bf16 v[64:67], v[28:31], a[60:63], v[64:67]
  buffer_store_dwordx4 v[84:87], v5, s[8:11], s58 offen sc1
  s_lshl_b32 s47, s47, 12
  v_mfma_f32_16x16x32_bf16 v[68:71], v[52:55], a[60:63], v[68:71]
  s_add_u32 s58, s55, 524288
  s_add_u32 s54, s54, s47
  v_mfma_f32_16x16x32_bf16 v[64:67], v[32:35], a[64:67], v[64:67]
  s_lshr_b32 s46, s58, 8
  s_add_u32 s54, s54, s61
  v_mfma_f32_16x16x32_bf16 v[68:71], v[56:59], a[64:67], v[68:71]
  s_and_b32 s46, s46, 0x2000
  s_lshr_b32 s47, s54, 8
  v_mfma_f32_16x16x32_bf16 v[64:67], v[36:39], a[68:71], v[64:67]
  s_xor_b32 s58, s58, s46
  s_and_b32 s47, s47, 0x2000
  v_mfma_f32_16x16x32_bf16 v[68:71], v[60:63], a[68:71], v[68:71]
  s_xor_b32 s54, s54, s47
  v_mfma_f32_16x16x32_bf16 v[72:75], v[16:19], a[72:75], 0
  v_mfma_f32_16x16x32_bf16 v[76:79], v[40:43], a[72:75], 0
  v_mfma_f32_16x16x32_bf16 v[72:75], v[20:23], a[76:79], v[72:75]
  v_cvt_pk_bf16_f32 v80, v64, v65
  v_mfma_f32_16x16x32_bf16 v[76:79], v[44:47], a[76:79], v[76:79]
  v_cvt_pk_bf16_f32 v81, v66, v67
  v_mfma_f32_16x16x32_bf16 v[72:75], v[24:27], a[80:83], v[72:75]
  v_cvt_pk_bf16_f32 v82, v68, v69
  v_mfma_f32_16x16x32_bf16 v[76:79], v[48:51], a[80:83], v[76:79]
  v_cvt_pk_bf16_f32 v83, v70, v71
  v_mfma_f32_16x16x32_bf16 v[72:75], v[28:31], a[84:87], v[72:75]
  buffer_store_dwordx4 v[80:83], v5, s[8:11], s58 offen sc1
  v_mfma_f32_16x16x32_bf16 v[76:79], v[52:55], a[84:87], v[76:79]
  s_add_u32 s58, s55, 786432
  v_mfma_f32_16x16x32_bf16 v[72:75], v[32:35], a[88:91], v[72:75]
  s_lshr_b32 s46, s58, 8
  v_mfma_f32_16x16x32_bf16 v[76:79], v[56:59], a[88:91], v[76:79]
  s_and_b32 s46, s46, 0x2000
  v_mfma_f32_16x16x32_bf16 v[72:75], v[36:39], a[92:95], v[72:75]
  s_xor_b32 s58, s58, s46
  s_waitcnt vmcnt(3)
  v_readfirstlane_b32 s56, v13
  v_mfma_f32_16x16x32_bf16 v[76:79], v[60:63], a[92:95], v[76:79]
  buffer_store_dword v8, v7, s[8:11], 0 offen sc1
  v_mfma_f32_16x16x32_bf16 v[64:67], v[16:19], a[96:99], 0
  s_cmp_lt_u32 s56, s57
  s_cbranch_scc1 u_slow
u_back:
  v_mfma_f32_16x16x32_bf16 v[68:71], v[40:43], a[96:99], 0
  s_add_u32 m0, s60, 0
  s_add_u32 s47, s54, 0
  buffer_load_dwordx4 v5, s[8:11], s47 offen sc1 lds
  v_mfma_f32_16x16x32_bf16 v[64:67], v[20:23], a[100:103], v[64:67]
  s_add_u32 m0, s60, 4096
  s_add_u32 s47, s54, 16777216
  buffer_load_dwordx4 v5, s[8:11], s47 offen sc1 lds
  v_cvt_pk_bf16_f32 v84, v72, v73
  v_mfma_f32_16x16x32_bf16 v[68:71], v[44:47], a[100:103], v[68:71]
  s_add_u32 m0, s60, 8192
  s_add_u32 s47, s54, 33554432
  buffer_load_dwordx4 v5, s[8:11], s47 offen sc1 lds
  v_cvt_pk_bf16_f32 v85, v74, v75
  v_mfma_f32_16x16x32_bf16 v[64:67], v[24:27], a[104:107], v[64:67]
  v_cvt_pk_bf16_f32 v86, v76, v77
  v_mfma_f32_16x16x32_bf16 v[68:71], v[48:51], a[104:107], v[68:71]
  v_cvt_pk_bf16_f32 v87, v78, v79
  v_mfma_f32_16x16x32_bf16 v[64:67], v[28:31], a[108:111], v[64:67]
  buffer_store_dwordx4 v[84:87], v5, s[8:11], s58 offen sc1
  v_mfma_f32_16x16x32_bf16 v[68:71], v[52:55], a[108:111], v[68:71]
  s_add_u32 s58, s55, 1048576
  v_mfma_f32_16x16x32_bf16 v[64:67], v[32:35], a[112:115], v[64:67]
  s_lshr_b32 s46, s58, 8
  v_mfma_f32_16x16x32_bf16 v[68:71], v[56:59], a[112:115], v[68:71]
  s_and_b32 s46, s46, 0x2000
  v_mfma_f32_16x16x32_bf16 v[64:67], v[36:39], a[116:119], v[64:67]
  s_xor_b32 s58, s58, s46
  v_mfma_f32_16x16x32_bf16 v[68:71], v[60:63], a[116:119], v[68:71]
  v_mfma_f32_16x16x32_bf16 v[72:75], v[16:19], a[120:123], 0
  v_mfma_f32_16x16x32_bf16 v[76:79], v[40:43], a[120:123], 0
  v_mfma_f32_16x16x32_bf16 v[72:75], v[20:23], a[124:127], v[72:75]
  v_cvt_pk_bf16_f32 v80, v64, v65
  v_mfma_f32_16x16x32_bf16 v[76:79], v[44:47], a[124:127], v[76:79]
  v_cvt_pk_bf16_f32 v81, v66, v67
  v_mfma_f32_16x16x32_bf16 v[72:75], v[24:27], a[128:131], v[72:75]
  v_cvt_pk_bf16_f32 v82, v68, v69
  v_mfma_f32_16x16x32_bf16 v[76:79], v[48:51], a[128:131], v[76:79]
  v_cvt_pk_bf16_f32 v83, v70, v71
  v_mfma_f32_16x16x32_bf16 v[72:75], v[28:31], a[132:135], v[72:75]
  buffer_store_dwordx4 v[80:83], v5, s[8:11], s58 offen sc1
  v_mfma_f32_16x16x32_bf16 v[76:79], v[52:55], a[132:135], v[76:79]
  s_add_u32 s58, s55, 1310720
  v_mfma_f32_16x16x32_bf16 v[72:75], v[32:35], a[136:139], v[72:75]
  s_lshr_b32 s46, s58, 8
  v_mfma_f32_16x16x32_bf16 v[76:79], v[56:59], a[136:139], v[76:79]
  s_and_b32 s46, s46, 0x2000
  v_mfma_f32_16x16x32_bf16 v[72:75], v[36:39], a[140:143], v[72:75]
  s_xor_b32 s58, s58, s46
  v_mfma_f32_16x16x32_bf16 v[76:79], v[60:63], a[140:143], v[76:79]
  v_mfma_f32_16x16x32_bf16 v[64:67], v[16:19], a[144:147], 0
  v_mfma_f32_16x16x32_bf16 v[68:71], v[40:43], a[144:147], 0
  v_mfma_f32_16x16x32_bf16 v[64:67], v[20:23], a[148:151], v[64:67]
  v_cvt_pk_bf16_f32 v84, v72, v73
  v_mfma_f32_16x16x32_bf16 v[68:71], v[44:47], a[148:151], v[68:71]
  v_cvt_pk_bf16_f32 v85, v74, v75
  v_mfma_f32_16x16x32_bf16 v[64:67], v[24:27], a[152:155], v[64:67]
  v_cvt_pk_bf16_f32 v86, v76, v77
  v_mfma_f32_16x16x32_bf16 v[68:71], v[48:51], a[152:155], v[68:71]
  v_cvt_pk_bf16_f32 v87, v78, v79
  v_mfma_f32_16x16x32_bf16 v[64:67], v[28:31], a[156:159], v[64:67]
  buffer_store_dwordx4 v[84:87], v5, s[8:11], s58 offen sc1
  v_mfma_f32_16x16x32_bf16 v[68:71], v[52:55], a[156:159], v[68:71]
  s_add_u32 s58, s55, 1572864
  v_mfma_f32_16x16x32_bf16 v[64:67], v[32:35], a[160:163], v[64:67]
  s_lshr_b32 s46, s58, 8
  v_mfma_f32_16x16x32_bf16 v[68:71], v[56:59], a[160:163], v[68:71]
  s_and_b32 s46, s46, 0x2000
  v_mfma_f32_16x16x32_bf16 v[64:67], v[36:39], a[164:167], v[64:67]
  s_xor_b32 s58, s58, s46
  v_mfma_f32_16x16x32_bf16 v[68:71], v[60:63], a[164:167], v[68:71]
  v_mfma_f32_16x16x32_bf16 v[72:75], v[16:19], a[168:171], 0
  v_mfma_f32_16x16x32_bf16 v[76:79], v[40:43], a[168:171], 0
  v_mfma_f32_16x16x32_bf16 v[72:75], v[20:23], a[172:175], v[72:75]
  v_cvt_pk_bf16_f32 v80, v64, v65
  v_mfma_f32_16x16x32_bf16 v[76:79], v[44:47], a[172:175], v[76:79]
  v_cvt_pk_bf16_f32 v81, v66, v67
  v_mfma_f32_16x16x32_bf16 v[72:75], v[24:27], a[176:179], v[72:75]
  v_cvt_pk_bf16_f32 v82, v68, v69
  v_mfma_f32_16x16x32_bf16 v[76:79], v[48:51], a[176:179], v[76:79]
  v_cvt_pk_bf16_f32 v83, v70, v71
  v_mfma_f32_16x16x32_bf16 v[72:75], v[28:31], a[180:183], v[72:75]
  buffer_store_dwordx4 v[80:83], v5, s[8:11], s58 offen sc1
  v_mfma_f32_16x16x32_bf16 v[76:79], v[52:55], a[180:183], v[76:79]
  s_add_u32 s58, s55, 1835008
  v_mfma_f32_16x16x32_bf16 v[72:75], v[32:35], a[184:187], v[72:75]
  s_lshr_b32 s46, s58, 8
  v_mfma_f32_16x16x32_bf16 v[76:79], v[56:59], a[184:187], v[76:79]
  s_and_b32 s46, s46, 0x2000
  v_mfma_f32_16x16x32_bf16 v[72:75], v[36:39], a[188:191], v[72:75]
  s_xor_b32 s58, s58, s46
  v_mfma_f32_16x16x32_bf16 v[76:79], v[60:63], a[188:191], v[76:79]
  v_mfma_f32_16x16x32_bf16 v[64:67], v[16:19], a[192:195], 0
  v_mfma_f32_16x16x32_bf16 v[68:71], v[40:43], a[192:195], 0
  v_mfma_f32_16x16x32_bf16 v[64:67], v[20:23], a[196:199], v[64:67]
  v_cvt_pk_bf16_f32 v84, v72, v73
  v_mfma_f32_16x16x32_bf16 v[68:71], v[44:47], a[196:199], v[68:71]
  v_cvt_pk_bf16_f32 v85, v74, v75
  v_mfma_f32_16x16x32_bf16 v[64:67], v[24:27], a[200:203], v[64:67]
  v_cvt_pk_bf16_f32 v86, v76, v77
  v_mfma_f32_16x16x32_bf16 v[68:71], v[48:51], a[200:203], v[68:71]
  v_cvt_pk_bf16_f32 v87, v78, v79
  v_mfma_f32_16x16x32_bf16 v[64:67], v[28:31], a[204:207], v[64:67]
  buffer_store_dwordx4 v[84:87], v5, s[8:11], s58 offen sc1
  v_mfma_f32_16x16x32_bf16 v[68:71], v[52:55], a[204:207], v[68:71]
  s_add_u32 s58, s55, 2097152
  v_mfma_f32_16x16x32_bf16 v[64:67], v[32:35], a[208:211], v[64:67]
  s_lshr_b32 s46, s58, 8
  v_mfma_f32_16x16x32_bf16 v[68:71], v[56:59], a[208:211], v[68:71]
  s_and_b32 s46, s46, 0x2000
  v_mfma_f32_16x16x32_bf16 v[64:67], v[36:39], a[212:215], v[64:67]
  s_xor_b32 s58, s58, s46
  s_waitcnt vmcnt(5)
  s_barrier
  v_mfma_f32_16x16x32_bf16 v[68:71], v[60:63], a[212:215], v[68:71]
  s_add_u32 s55, s55, 2621440
  v_mfma_f32_16x16x32_bf16 v[72:75], v[16:19], a[216:219], 0
  ds_read_b128 v[16:19], v12 offset:0
  v_mfma_f32_16x16x32_bf16 v[76:79], v[40:43], a[216:219], 0
  ds_read_b128 v[40:43], v12 offset:2048
  v_mfma_f32_16x16x32_bf16 v[72:75], v[20:23], a[220:223], v[72:75]
  ds_read_b128 v[20:23], v12 offset:1024
  v_cvt_pk_bf16_f32 v80, v64, v65
  v_mfma_f32_16x16x32_bf16 v[76:79], v[44:47], a[220:223], v[76:79]
  ds_read_b128 v[44:47], v12 offset:3072
  v_cvt_pk_bf16_f32 v81, v66, v67
  v_mfma_f32_16x16x32_bf16 v[72:75], v[24:27], a[224:227], v[72:75]
  ds_read_b128 v[24:27], v12 offset:4096
  v_cvt_pk_bf16_f32 v82, v68, v69
  v_mfma_f32_16x16x32_bf16 v[76:79], v[48:51], a[224:227], v[76:79]
  ds_read_b128 v[48:51], v12 offset:6144
  v_cvt_pk_bf16_f32 v83, v70, v71
  v_mfma_f32_16x16x32_bf16 v[72:75], v[28:31], a[228:231], v[72:75]
  buffer_store_dwordx4 v[80:83], v5, s[8:11], s58 offen sc1
  ds_read_b128 v[28:31], v12 offset:5120
  v_mfma_f32_16x16x32_bf16 v[76:79], v[52:55], a[228:231], v[76:79]
  ds_read_b128 v[52:55], v12 offset:7168
  s_cmp_ge_u32 s55, 165675008
  s_cselect_b32 s46, 83886080, 0
  v_mfma_f32_16x16x32_bf16 v[72:75], v[32:35], a[232:235], v[72:75]
  ds_read_b128 v[32:35], v12 offset:8192
  s_sub_u32 s55, s55, s46
  v_mfma_f32_16x16x32_bf16 v[76:79], v[56:59], a[232:235], v[76:79]
  ds_read_b128 v[56:59], v12 offset:10240
  s_add_u32 s52, s52, 1
  v_mfma_f32_16x16x32_bf16 v[72:75], v[36:39], a[236:239], v[72:75]
  ds_read_b128 v[36:39], v12 offset:9216
  s_cmp_lt_u32 s52, 64
  v_mfma_f32_16x16x32_bf16 v[76:79], v[60:63], a[236:239], v[76:79]
  ds_read_b128 v[60:63], v12 offset:11264
  s_cbranch_scc1 u_loop
  s_nop 2
  v_cvt_pk_bf16_f32 v84, v72, v73
  v_cvt_pk_bf16_f32 v85, v74, v75
  s_nop 0
  v_cvt_pk_bf16_f32 v86, v76, v77
  v_cvt_pk_bf16_f32 v87, v78, v79
  buffer_store_dwordx4 v[84:87], v5, s[8:11], s59 offen sc1
  v_mov_b32 v8, s52
  s_waitcnt vmcnt(0) lgkmcnt(0)
  buffer_store_dword v8, v7, s[8:11], 0 offen sc1
  s_branch u_done
u_slow:
  s_cmp_ge_u32 s56, s57
  s_cbranch_scc1 wf_done_10
  s_mov_b32 s50, 0
wf_loop_11:
  buffer_load_dword v13, v6, s[8:11], 0 offen sc1
  s_add_u32 s50, s50, 1
  s_cmp_gt_u32 s50, 131072
  s_cbranch_scc1 L_fail
  s_waitcnt vmcnt(0)
  v_readfirstlane_b32 s56, v13
  s_nop 0
  s_cmp_ge_u32 s56, s57
  s_cbranch_scc1 wf_done_10
  s_sleep 2
  s_branch wf_loop_11
wf_done_10:
  s_branch u_back
u_done:
L_parta:
  s_barrier
  s_lshl_b32 s65, s44, 2
  s_add_u32 s65, s65, s43
  s_sub_u32 s65, s65, 4
  s_cmp_ge_u32 s65, 120
  s_cbranch_scc1 pa_att
  s_mov_b32 s4, s18
  s_mov_b32 s5, s19
  s_mov_b32 s6, 2457600
  s_mov_b32 s7, 0x20000
  s_mov_b32 s12, s16
  s_mov_b32 s13, s17
  s_mov_b32 s14, 2621440
  s_mov_b32 s15, 0x20000
  s_mul_i32 s46, s65, 205
  s_lshr_b32 s46, s46, 11
  s_mul_i32 s47, s46, 10
  s_sub_u32 s47, s65, s47
  s_mul_i32 s60, s47, 384
  s_lshl_b32 s67, s47, 6
  s_mov_b32 s63, 132128768
  s_mul_i32 s61, s46, 6
  s_add_u32 s62, s61, 6
  s_mul_i32 s48, s46, 3
  s_add_u32 s49, s48, 31
  s_add_u32 s48, s48, 28
  s_min_u32 s61, s61, s48
  s_min_u32 s62, s62, s49
  s_add_u32 s67, s67, s61
  s_lshl_b32 s64, s65, 7
  s_add_u32 s64, s64, 1081344
  v_lshrrev_b32 v10, 3, v0
  v_lshrrev_b32 v11, 2, v10
  v_lshlrev_b32 v11, 3, v11
  v_and_b32 v1, 3, v10
  v_add_u32 v1, v1, v11
  s_and_b32 s46, s42, 1
  s_lshl_b32 s46, s46, 2
  s_lshr_b32 s47, s42, 1
  s_lshl_b32 s47, s47, 4
  s_add_u32 s46, s46, s47
  v_add_u32 v1, s46, v1
  v_mul_u32_u24 v1, 3840, v1
  v_lshrrev_b32 v10, 1, v10
  v_bfe_u32 v11, v0, 1, 2
  v_xor_b32 v10, v10, v11
  v_lshlrev_b32 v10, 5, v10
  v_and_b32 v11, 1, v0
  v_lshlrev_b32 v11, 4, v11
  v_add3_u32 v1, v1, v10, v11
  v_lshrrev_b32 v10, 5, v0
  v_lshlrev_b32 v2, 11, v10
  v_bfe_u32 v10, v0, 2, 3
  v_lshl_add_u32 v2, v10, 7, v2
  v_lshrrev_b32 v10, 1, v10
  v_xor_b32 v10, s42, v10
  v_lshl_add_u32 v2, v10, 5, v2
  v_and_b32 v10, 3, v0
  v_lshl_add_u32 v2, v10, 3, v2
  v_add_u32 v3, 0x10000, v2
  v_add_u32 v4, 0x20000, v2
  v_lshrrev_b32 v10, 3, v0
  s_lshl_b32 s46, s42, 3
  v_add_u32 v10, s46, v10
  v_mul_u32_u24 v5, 1280, v10
  v_bfe_u32 v10, v10, 1, 3
  v_and_b32 v11, 7, v0
  v_xor_b32 v10, v10, v11
  v_lshl_add_u32 v5, v10, 4, v5
  v_and_b32 v10, 15, v0
  v_lshlrev_b32 v6, 7, v10
  v_lshrrev_b32 v10, 1, v10
  v_lshrrev_b32 v11, 4, v0
  v_xor_b32 v10, v10, v11
  v_lshl_add_u32 v6, v10, 4, v6
  v_add_u32 v6, 122880, v6
  v_xor_b32 v7, 64, v6
  v_and_b32 v10, 15, v0
  v_lshlrev_b32 v8, 4, v10
  v_bfe_u32 v10, v0, 4, 1
  v_lshlrev_b32 v10, 11, v10
  v_lshrrev_b32 v11, 5, v0
  v_lshlrev_b32 v11, 8, v11
  v_add3_u32 v8, v8, v10, v11
  s_lshl_b32 s46, s42, 9
  v_add_u32 v8, s46, v8
  v_mov_b32 v9, s64
  v_mov_b32 v10, 2146435072
  s_cmp_eq_u32 s42, 0
  s_cselect_b64 vcc, 1, 0
  v_cndmask_b32 v9, v10, v9, vcc
  s_lshl_b32 s46, s43, 7
  s_add_u32 s46, s46, 1076736
  v_mov_b32 v14, s46
  s_mov_b32 s68, 0
  s_lshr_b32 s70, s44, 5
  s_add_u32 s70, s70, 60
  s_mov_b32 s52, s61
  s_mul_i32 s53, s52, 40960
  s_add_u32 s54, s51, 122880
  s_add_u32 m0, s54, 0
  s_nop 0
  buffer_load_dwordx4 v5, s[12:15], s53 offen offset:0 lds
  s_add_u32 m0, s54, 3968
  s_nop 0
  buffer_load_dwordx4 v5, s[12:15], s53 offen offset:128 lds
  s_add_u32 m0, s54, 7936
  s_nop 0
  buffer_load_dwordx4 v5, s[12:15], s53 offen offset:256 lds
  s_add_u32 m0, s54, 11904
  s_nop 0
  buffer_load_dwordx4 v5, s[12:15], s53 offen offset:384 lds
  s_add_u32 m0, s54, 15872
  s_nop 0
  buffer_load_dwordx4 v5, s[12:15], s53 offen offset:512 lds
  s_add_u32 m0, s54, 19840
  s_nop 0
  buffer_load_dwordx4 v5, s[12:15], s53 offen offset:640 lds
  s_add_u32 m0, s54, 23808
  s_nop 0
  buffer_load_dwordx4 v5, s[12:15], s53 offen offset:768 lds
  s_add_u32 m0, s54, 27776
  s_nop 0
  buffer_load_dwordx4 v5, s[12:15], s53 offen offset:896 lds
  s_add_u32 m0, s54, 31744
  s_nop 0
  buffer_load_dwordx4 v5, s[12:15], s53 offen offset:1024 lds
  s_add_u32 m0, s54, 35712
  s_nop 0
  buffer_load_dwordx4 v5, s[12:15], s53 offen offset:1152 lds
  s_add_u32 m0, s51, 0
  s_add_u32 s46, s60, 0
  buffer_load_dwordx4 v1, s[4:7], s46 offen lds
  s_add_u32 m0, s51, 4096
  s_add_u32 s46, s60, 128
  buffer_load_dwordx4 v1, s[4:7], s46 offen lds
  s_add_u32 m0, s51, 8192
  s_add_u32 s46, s60, 256
  buffer_load_dwordx4 v1, s[4:7], s46 offen lds
  s_add_u32 m0, s51, 12288
  s_add_u32 s46, s60, 122880
  buffer_load_dwordx4 v1, s[4:7], s46 offen lds
  s_add_u32 m0, s51, 16384
  s_add_u32 s46, s60, 123008
  buffer_load_dwordx4 v1, s[4:7], s46 offen lds
  s_add_u32 m0, s51, 20480
  s_add_u32 s46, s60, 123136
  buffer_load_dwordx4 v1, s[4:7], s46 offen lds
  s_add_u32 m0, s51, 24576
  s_add_u32 s46, s60, 245760
  buffer_load_dwordx4 v1, s[4:7], s46 offen lds
  s_add_u32 m0, s51, 28672
  s_add_u32 s46, s60, 245888
  buffer_load_dwordx4 v1, s[4:7], s46 offen lds
  s_add_u32 m0, s51, 32768
  s_add_u32 s46, s60, 246016
  buffer_load_dwordx4 v1, s[4:7], s46 offen lds
  s_add_u32 m0, s51, 36864
  s_add_u32 s46, s60, 368640
  buffer_load_dwordx4 v1, s[4:7], s46 offen lds
  s_add_u32 m0, s51, 40960
  s_add_u32 s46, s60, 368768
  buffer_load_dwordx4 v1, s[4:7], s46 offen lds
  s_add_u32 m0, s51, 45056
  s_add_u32 s46, s60, 368896
  buffer_load_dwordx4 v1, s[4:7], s46 offen lds
  s_add_u32 m0, s51, 49152
  s_add_u32 s46, s60, 491520
  buffer_load_dwordx4 v1, s[4:7], s46 offen lds
  s_add_u32 m0, s51, 53248
  s_add_u32 s46, s60, 491648
  buffer_load_dwordx4 v1, s[4:7], s46 offen lds
  s_add_u32 m0, s51, 57344
  s_add_u32 s46, s60, 491776
  buffer_load_dwordx4 v1, s[4:7], s46 offen lds
  s_add_u32 m0, s51, 61440
  s_add_u32 s46, s60, 614400
  buffer_load_dwordx4 v1, s[4:7], s46 offen lds
  s_add_u32 m0, s51, 65536
  s_add_u32 s46, s60, 614528
  buffer_load_dwordx4 v1, s[4:7], s46 offen lds
  s_add_u32 m0, s51, 69632
  s_add_u32 s46, s60, 614656
  buffer_load_dwordx4 v1, s[4:7], s46 offen lds
  s_add_u32 m0, s51, 73728
  s_add_u32 s46, s60, 737280
  buffer_load_dwordx4 v1, s[4:7], s46 offen lds
  s_add_u32 m0, s51, 77824
  s_add_u32 s46, s60, 737408
  buffer_load_dwordx4 v1, s[4:7], s46 offen lds
  s_add_u32 m0, s51, 81920
  s_add_u32 s46, s60, 737536
  buffer_load_dwordx4 v1, s[4:7], s46 offen lds
  s_add_u32 m0, s51, 86016
  s_add_u32 s46, s60, 860160
  buffer_load_dwordx4 v1, s[4:7], s46 offen lds
  s_add_u32 m0, s51, 90112
  s_add_u32 s46, s60, 860288
  buffer_load_dwordx4 v1, s[4:7], s46 offen lds
  s_add_u32 m0, s51, 94208
  s_add_u32 s46, s60, 860416
  buffer_load_dwordx4 v1, s[4:7], s46 offen lds
  s_waitcnt vmcnt(18)
  s_barrier
  s_add_u32 m0, s51, 98304
  s_add_u32 s46, s60, 983040
  buffer_load_dwordx4 v1, s[4:7], s46 offen lds
  s_add_u32 m0, s51, 102400
  s_add_u32 s46, s60, 983168
  buffer_load_dwordx4 v1, s[4:7], s46 offen lds
  s_add_u32 m0, s51, 106496
  s_add_u32 s46, s60, 983296
  buffer_load_dwordx4 v1, s[4:7], s46 offen lds
  s_add_u32 m0, s51, 110592
  s_add_u32 s46, s60, 1105920
  buffer_load_dwordx4 v1, s[4:7], s46 offen lds
  s_add_u32 m0, s51, 114688
  s_add_u32 s46, s60, 1106048
  buffer_load_dwordx4 v1, s[4:7], s46 offen lds
  s_add_u32 m0, s51, 118784
  s_add_u32 s46, s60, 1106176
  buffer_load_dwordx4 v1, s[4:7], s46 offen lds
  ds_read_b64_tr_b16 a[0:1], v2 offset:0
  ds_read_b64_tr_b16 a[2:3], v2 offset:1024
  ds_read_b64_tr_b16 a[4:5], v2 offset:4096
  ds_read_b64_tr_b16 a[6:7], v2 offset:5120
  ds_read_b64_tr_b16 a[8:9], v2 offset:8192
  ds_read_b64_tr_b16 a[10:11], v2 offset:9216
  ds_read_b64_tr_b16 a[12:13], v2 offset:12288
  ds_read_b64_tr_b16 a[14:15], v2 offset:13312
  ds_read_b64_tr_b16 a[16:17], v2 offset:16384
  ds_read_b64_tr_b16 a[18:19], v2 offset:17408
  ds_read_b64_tr_b16 a[20:21], v2 offset:20480
  ds_read_b64_tr_b16 a[22:23], v2 offset:21504
  s_waitcnt lgkmcnt(0)
  s_waitcnt vmcnt(18)
  s_barrier
  s_add_u32 m0, s51, 0
  s_add_u32 s46, s60, 1228800
  buffer_load_dwordx4 v1, s[4:7], s46 offen lds
  s_add_u32 m0, s51, 4096
  s_add_u32 s46, s60, 1228928
  buffer_load_dwordx4 v1, s[4:7], s46 offen lds
  s_add_u32 m0, s51, 8192
  s_add_u32 s46, s60, 1229056
  buffer_load_dwordx4 v1, s[4:7], s46 offen lds
  s_add_u32 m0, s51, 12288
  s_add_u32 s46, s60, 1351680
  buffer_load_dwordx4 v1, s[4:7], s46 offen lds
  s_add_u32 m0, s51, 16384
  s_add_u32 s46, s60, 1351808
  buffer_load_dwordx4 v1, s[4:7], s46 offen lds
  s_add_u32 m0, s51, 20480
  s_add_u32 s46, s60, 1351936
  buffer_load_dwordx4 v1, s[4:7], s46 offen lds
  ds_read_b64_tr_b16 a[24:25], v2 offset:24576
  ds_read_b64_tr_b16 a[26:27], v2 offset:25600
  ds_read_b64_tr_b16 a[28:29], v2 offset:28672
  ds_read_b64_tr_b16 a[30:31], v2 offset:29696
  ds_read_b64_tr_b16 a[32:33], v2 offset:32768
  ds_read_b64_tr_b16 a[34:35], v2 offset:33792
  ds_read_b64_tr_b16 a[36:37], v2 offset:36864
  ds_read_b64_tr_b16 a[38:39], v2 offset:37888
  ds_read_b64_tr_b16 a[40:41], v2 offset:40960
  ds_read_b64_tr_b16 a[42:43], v2 offset:41984
  ds_read_b64_tr_b16 a[44:45], v2 offset:45056
  ds_read_b64_tr_b16 a[46:47], v2 offset:46080
  s_waitcnt lgkmcnt(0)
  s_waitcnt vmcnt(18)
  s_barrier
  s_add_u32 m0, s51, 24576
  s_add_u32 s46, s60, 1474560
  buffer_load_dwordx4 v1, s[4:7], s46 offen lds
  s_add_u32 m0, s51, 28672
  s_add_u32 s46, s60, 1474688
  buffer_load_dwordx4 v1, s[4:7], s46 offen lds
  s_add_u32 m0, s51, 32768
  s_add_u32 s46, s60, 1474816
  buffer_load_dwordx4 v1, s[4:7], s46 offen lds
  s_add_u32 m0, s51, 36864
  s_add_u32 s46, s60, 1597440
  buffer_load_dwordx4 v1, s[4:7], s46 offen lds
  s_add_u32 m0, s51, 40960
  s_add_u32 s46, s60, 1597568
  buffer_load_dwordx4 v1, s[4:7], s46 offen lds
  s_add_u32 m0, s51, 45056
  s_add_u32 s46, s60, 1597696
  buffer_load_dwordx4 v1, s[4:7], s46 offen lds
  ds_read_b64_tr_b16 a[48:49], v2 offset:49152
  ds_read_b64_tr_b16 a[50:51], v2 offset:50176
  ds_read_b64_tr_b16 a[52:53], v2 offset:53248
  ds_read_b64_tr_b16 a[54:55], v2 offset:54272
  ds_read_b64_tr_b16 a[56:57], v2 offset:57344
  ds_read_b64_tr_b16 a[58:59], v2 offset:58368
  ds_read_b64_tr_b16 a[60:61], v2 offset:61440
  ds_read_b64_tr_b16 a[62:63], v2 offset:62464
  ds_read_b64_tr_b16 a[64:65], v3 offset:0
  ds_read_b64_tr_b16 a[66:67], v3 offset:1024
  ds_read_b64_tr_b16 a[68:69], v3 offset:4096
  ds_read_b64_tr_b16 a[70:71], v3 offset:5120
  s_waitcnt lgkmcnt(0)
  s_waitcnt vmcnt(18)
  s_barrier
  s_add_u32 m0, s51, 49152
  s_add_u32 s46, s60, 1720320
  buffer_load_dwordx4 v1, s[4:7], s46 offen lds
  s_add_u32 m0, s51, 53248
  s_add_u32 s46, s60, 1720448
  buffer_load_dwordx4 v1, s[4:7], s46 offen lds
  s_add_u32 m0, s51, 57344
  s_add_u32 s46, s60, 1720576
  buffer_load_dwordx4 v1, s[4:7], s46 offen lds
  s_add_u32 m0, s51, 61440
  s_add_u32 s46, s60, 1843200
  buffer_load_dwordx4 v1, s[4:7], s46 offen lds
  s_add_u32 m0, s51, 65536
  s_add_u32 s46, s60, 1843328
  buffer_load_dwordx4 v1, s[4:7], s46 offen lds
  s_add_u32 m0, s51, 69632
  s_add_u32 s46, s60, 1843456
  buffer_load_dwordx4 v1, s[4:7], s46 offen lds
  ds_read_b64_tr_b16 a[72:73], v3 offset:8192
  ds_read_b64_tr_b16 a[74:75], v3 offset:9216
  ds_read_b64_tr_b16 a[76:77], v3 offset:12288
  ds_read_b64_tr_b16 a[78:79], v3 offset:13312
  ds_read_b64_tr_b16 a[80:81], v3 offset:16384
  ds_read_b64_tr_b16 a[82:83], v3 offset:17408
  ds_read_b64_tr_b16 a[84:85], v3 offset:20480
  ds_read_b64_tr_b16 a[86:87], v3 offset:21504
  ds_read_b64_tr_b16 a[88:89], v3 offset:24576
  ds_read_b64_tr_b16 a[90:91], v3 offset:25600
  ds_read_b64_tr_b16 a[92:93], v3 offset:28672
  ds_read_b64_tr_b16 a[94:95], v3 offset:29696
  s_waitcnt lgkmcnt(0)
  s_waitcnt vmcnt(18)
  s_barrier
  s_add_u32 m0, s51, 73728
  s_add_u32 s46, s60, 1966080
  buffer_load_dwordx4 v1, s[4:7], s46 offen lds
  s_add_u32 m0, s51, 77824
  s_add_u32 s46, s60, 1966208
  buffer_load_dwordx4 v1, s[4:7], s46 offen lds
  s_add_u32 m0, s51, 81920
  s_add_u32 s46, s60, 1966336
  buffer_load_dwordx4 v1, s[4:7], s46 offen lds
  s_add_u32 m0, s51, 86016
  s_add_u32 s46, s60, 2088960
  buffer_load_dwordx4 v1, s[4:7], s46 offen lds
  s_add_u32 m0, s51, 90112
  s_add_u32 s46, s60, 2089088
  buffer_load_dwordx4 v1, s[4:7], s46 offen lds
  s_add_u32 m0, s51, 94208
  s_add_u32 s46, s60, 2089216
  buffer_load_dwordx4 v1, s[4:7], s46 offen lds
  ds_read_b64_tr_b16 a[96:97], v3 offset:32768
  ds_read_b64_tr_b16 a[98:99], v3 offset:33792
  ds_read_b64_tr_b16 a[100:101], v3 offset:36864
  ds_read_b64_tr_b16 a[102:103], v3 offset:37888
  ds_read_b64_tr_b16 a[104:105], v3 offset:40960
  ds_read_b64_tr_b16 a[106:107], v3 offset:41984
  ds_read_b64_tr_b16 a[108:109], v3 offset:45056
  ds_read_b64_tr_b16 a[110:111], v3 offset:46080
  ds_read_b64_tr_b16 a[112:113], v3 offset:49152
  ds_read_b64_tr_b16 a[114:115], v3 offset:50176
  ds_read_b64_tr_b16 a[116:117], v3 offset:53248
  ds_read_b64_tr_b16 a[118:119], v3 offset:54272
  s_waitcnt lgkmcnt(0)
  s_waitcnt vmcnt(18)
  s_barrier
  s_add_u32 m0, s51, 98304
  s_add_u32 s46, s60, 2211840
  buffer_load_dwordx4 v1, s[4:7], s46 offen lds
  s_add_u32 m0, s51, 102400
  s_add_u32 s46, s60, 2211968
  buffer_load_dwordx4 v1, s[4:7], s46 offen lds
  s_add_u32 m0, s51, 106496
  s_add_u32 s46, s60, 2212096
  buffer_load_dwordx4 v1, s[4:7], s46 offen lds
  s_add_u32 m0, s51, 110592
  s_add_u32 s46, s60, 2334720
  buffer_load_dwordx4 v1, s[4:7], s46 offen lds
  s_add_u32 m0, s51, 114688
  s_add_u32 s46, s60, 2334848
  buffer_load_dwordx4 v1, s[4:7], s46 offen lds
  s_add_u32 m0, s51, 118784
  s_add_u32 s46, s60, 2334976
  buffer_load_dwordx4 v1, s[4:7], s46 offen lds
  ds_read_b64_tr_b16 a[120:121], v2 offset:0
  ds_read_b64_tr_b16 a[122:123], v2 offset:1024
  ds_read_b64_tr_b16 a[124:125], v2 offset:4096
  ds_read_b64_tr_b16 a[126:127], v2 offset:5120
  ds_read_b64_tr_b16 a[128:129], v2 offset:8192
  ds_read_b64_tr_b16 a[130:131], v2 offset:9216
  ds_read_b64_tr_b16 a[132:133], v2 offset:12288
  ds_read_b64_tr_b16 a[134:135], v2 offset:13312
  ds_read_b64_tr_b16 a[136:137], v2 offset:16384
  ds_read_b64_tr_b16 a[138:139], v2 offset:17408
  ds_read_b64_tr_b16 a[140:141], v2 offset:20480
  ds_read_b64_tr_b16 a[142:143], v2 offset:21504
  s_waitcnt lgkmcnt(0)
  s_waitcnt vmcnt(18)
  s_barrier
  ds_read_b64_tr_b16 a[144:145], v2 offset:24576
  ds_read_b64_tr_b16 a[146:147], v2 offset:25600
  ds_read_b64_tr_b16 a[148:149], v2 offset:28672
  ds_read_b64_tr_b16 a[150:151], v2 offset:29696
  ds_read_b64_tr_b16 a[152:153], v2 offset:32768
  ds_read_b64_tr_b16 a[154:155], v2 offset:33792
  ds_read_b64_tr_b16 a[156:157], v2 offset:36864
  ds_read_b64_tr_b16 a[158:159], v2 offset:37888
  ds_read_b64_tr_b16 a[160:161], v2 offset:40960
  ds_read_b64_tr_b16 a[162:163], v2 offset:41984
  ds_read_b64_tr_b16 a[164:165], v2 offset:45056
  ds_read_b64_tr_b16 a[166:167], v2 offset:46080
  s_waitcnt lgkmcnt(0)
  s_waitcnt vmcnt(12)
  s_barrier
  ds_read_b64_tr_b16 a[168:169], v2 offset:49152
  ds_read_b64_tr_b16 a[170:171], v2 offset:50176
  ds_read_b64_tr_b16 a[172:173], v2 offset:53248
  ds_read_b64_tr_b16 a[174:175], v2 offset:54272
  ds_read_b64_tr_b16 a[176:177], v2 offset:57344
  ds_read_b64_tr_b16 a[178:179], v2 offset:58368
  ds_read_b64_tr_b16 a[180:181], v2 offset:61440
  ds_read_b64_tr_b16 a[182:183], v2 offset:62464
  ds_read_b64_tr_b16 a[184:185], v3 offset:0
  ds_read_b64_tr_b16 a[186:187], v3 offset:1024
  ds_read_b64_tr_b16 a[188:189], v3 offset:4096
  ds_read_b64_tr_b16 a[190:191], v3 offset:5120
  s_waitcnt lgkmcnt(0)
  s_waitcnt vmcnt(6)
  s_barrier
  ds_read_b64_tr_b16 a[192:193], v3 offset:8192
  ds_read_b64_tr_b16 a[194:195], v3 offset:9216
  ds_read_b64_tr_b16 a[196:197], v3 offset:12288
  ds_read_b64_tr_b16 a[198:199], v3 offset:13312
  ds_read_b64_tr_b16 a[200:201], v3 offset:16384
  ds_read_b64_tr_b16 a[202:203], v3 offset:17408
  ds_read_b64_tr_b16 a[204:205], v3 offset:20480
  ds_read_b64_tr_b16 a[206:207], v3 offset:21504
  ds_read_b64_tr_b16 a[208:209], v3 offset:24576
  ds_read_b64_tr_b16 a[210:211], v3 offset:25600
  ds_read_b64_tr_b16 a[212:213], v3 offset:28672
  ds_read_b64_tr_b16 a[214:215], v3 offset:29696
  s_waitcnt lgkmcnt(0)
  s_waitcnt vmcnt(0)
  s_barrier
  ds_read_b64_tr_b16 a[216:217], v3 offset:32768
  ds_read_b64_tr_b16 a[218:219], v3 offset:33792
  ds_read_b64_tr_b16 a[220:221], v3 offset:36864
  ds_read_b64_tr_b16 a[222:223], v3 offset:37888
  ds_read_b64_tr_b16 a[224:225], v3 offset:40960
  ds_read_b64_tr_b16 a[226:227], v3 offset:41984
  ds_read_b64_tr_b16 a[228:229], v3 offset:45056
  ds_read_b64_tr_b16 a[230:231], v3 offset:46080
  ds_read_b64_tr_b16 a[232:233], v3 offset:49152
  ds_read_b64_tr_b16 a[234:235], v3 offset:50176
  ds_read_b64_tr_b16 a[236:237], v3 offset:53248
  ds_read_b64_tr_b16 a[238:239], v3 offset:54272
  s_waitcnt lgkmcnt(0)
  s_barrier
  s_mov_b32 s54, s51
  s_add_u32 s53, s53, 40960
  s_add_u32 m0, s54, 0
  s_nop 0
  buffer_load_dwordx4 v5, s[12:15], s53 offen offset:0 lds
  s_add_u32 m0, s54, 3968
  s_nop 0
  buffer_load_dwordx4 v5, s[12:15], s53 offen offset:128 lds
  s_add_u32 m0, s54, 7936
  s_nop 0
  buffer_load_dwordx4 v5, s[12:15], s53 offen offset:256 lds
  s_add_u32 m0, s54, 11904
  s_nop 0
  buffer_load_dwordx4 v5, s[12:15], s53 offen offset:384 lds
  s_add_u32 m0, s54, 15872
  s_nop 0
  buffer_load_dwordx4 v5, s[12:15], s53 offen offset:512 lds
  s_add_u32 m0, s54, 19840
  s_nop 0
  buffer_load_dwordx4 v5, s[12:15], s53 offen offset:640 lds
  s_add_u32 m0, s54, 23808
  s_nop 0
  buffer_load_dwordx4 v5, s[12:15], s53 offen offset:768 lds
  s_add_u32 m0, s54, 27776
  s_nop 0
  buffer_load_dwordx4 v5, s[12:15], s53 offen offset:896 lds
  s_add_u32 m0, s54, 31744
  s_nop 0
  buffer_load_dwordx4 v5, s[12:15], s53 offen offset:1024 lds
  s_add_u32 m0, s54, 35712
  s_nop 0
  buffer_load_dwordx4 v5, s[12:15], s53 offen offset:1152 lds
  s_mov_b32 s55, 2146435072
  s_mov_b32 s56, 2146435072
  s_mov_b32 s57, 2146435072
  s_xor_b32 s63, s63, s3
  s_mov_b32 s58, 122880
  ds_read_b128 v[16:19], v6 offset:0
  ds_read_b128 v[20:23], v7 offset:0
  ds_read_b128 v[24:27], v6 offset:4096
  ds_read_b128 v[28:31], v7 offset:4096
  s_waitcnt lgkmcnt(3)
pa_loop_12:
  v_mfma_f32_16x16x32_bf16 v[40:43], a[0:3], v[16:19], 0
  ds_read_b128 v[32:35], v6 offset:8192
  v_mfma_f32_16x16x32_bf16 v[48:51], a[4:7], v[16:19], 0
  v_mfma_f32_16x16x32_bf16 v[56:59], a[8:11], v[16:19], 0
  s_waitcnt lgkmcnt(3)
  v_cvt_pk_bf16_f32 v66, v44, v45
  v_mfma_f32_16x16x32_bf16 v[40:43], a[12:15], v[20:23], v[40:43]
  ds_read_b128 v[16:19], v7 offset:8192
  v_cvt_pk_bf16_f32 v67, v46, v47
  v_mfma_f32_16x16x32_bf16 v[48:51], a[16:19], v[20:23], v[48:51]
  v_cvt_pk_bf16_f32 v70, v52, v53
  v_mfma_f32_16x16x32_bf16 v[56:59], a[20:23], v[20:23], v[56:59]
  s_waitcnt lgkmcnt(3)
  v_cvt_pk_bf16_f32 v71, v54, v55
  v_mfma_f32_16x16x32_bf16 v[40:43], a[24:27], v[24:27], v[40:43]
  ds_read_b128 v[20:23], v6 offset:12288
  v_cvt_pk_bf16_f32 v74, v60, v61
  v_mfma_f32_16x16x32_bf16 v[48:51], a[28:31], v[24:27], v[48:51]
  v_cvt_pk_bf16_f32 v75, v62, v63
  v_mfma_f32_16x16x32_bf16 v[56:59], a[32:35], v[24:27], v[56:59]
  s_waitcnt lgkmcnt(3)
  v_mfma_f32_16x16x32_bf16 v[40:43], a[36:39], v[28:31], v[40:43]
  ds_read_b128 v[24:27], v7 offset:12288
  v_permlane16_swap_b32 v64, v66
  v_mfma_f32_16x16x32_bf16 v[48:51], a[40:43], v[28:31], v[48:51]
  v_permlane16_swap_b32 v65, v67
  v_mfma_f32_16x16x32_bf16 v[56:59], a[44:47], v[28:31], v[56:59]
  buffer_store_dwordx4 v[64:67], v8, s[8:11], s55 offen sc1
  s_waitcnt lgkmcnt(3)
  v_mfma_f32_16x16x32_bf16 v[40:43], a[48:51], v[32:35], v[40:43]
  ds_read_b128 v[28:31], v6 offset:16384
  v_permlane16_swap_b32 v68, v70
  v_mfma_f32_16x16x32_bf16 v[48:51], a[52:55], v[32:35], v[48:51]
  v_permlane16_swap_b32 v69, v71
  v_mfma_f32_16x16x32_bf16 v[56:59], a[56:59], v[32:35], v[56:59]
  buffer_store_dwordx4 v[68:71], v8, s[8:11], s56 offen sc1
  s_waitcnt lgkmcnt(3)
  v_mfma_f32_16x16x32_bf16 v[40:43], a[60:63], v[16:19], v[40:43]
  ds_read_b128 v[32:35], v7 offset:16384
  v_permlane16_swap_b32 v72, v74
  v_mfma_f32_16x16x32_bf16 v[48:51], a[64:67], v[16:19], v[48:51]
  v_permlane16_swap_b32 v73, v75
  v_mfma_f32_16x16x32_bf16 v[56:59], a[68:71], v[16:19], v[56:59]
  buffer_store_dwordx4 v[72:75], v8, s[8:11], s57 offen sc1
  s_waitcnt lgkmcnt(3)
  v_mfma_f32_16x16x32_bf16 v[40:43], a[72:75], v[20:23], v[40:43]
  ds_read_b128 v[16:19], v6 offset:20480
  v_mfma_f32_16x16x32_bf16 v[48:51], a[76:79], v[20:23], v[48:51]
  v_mfma_f32_16x16x32_bf16 v[56:59], a[80:83], v[20:23], v[56:59]
  s_waitcnt lgkmcnt(3)
  v_mfma_f32_16x16x32_bf16 v[40:43], a[84:87], v[24:27], v[40:43]
  ds_read_b128 v[20:23], v7 offset:20480
  v_mfma_f32_16x16x32_bf16 v[48:51], a[88:91], v[24:27], v[48:51]
  v_mov_b32 v10, s52
  v_mfma_f32_16x16x32_bf16 v[56:59], a[92:95], v[24:27], v[56:59]
  s_waitcnt lgkmcnt(3)
  v_mfma_f32_16x16x32_bf16 v[40:43], a[96:99], v[28:31], v[40:43]
  ds_read_b128 v[24:27], v6 offset:24576
  v_mfma_f32_16x16x32_bf16 v[48:51], a[100:103], v[28:31], v[48:51]
  s_add_u32 s53, s53, 40960
  s_add_u32 s54, s54, 40960
  v_mfma_f32_16x16x32_bf16 v[56:59], a[104:107], v[28:31], v[56:59]
  s_waitcnt lgkmcnt(3)
  v_mfma_f32_16x16x32_bf16 v[40:43], a[108:111], v[32:35], v[40:43]
  ds_read_b128 v[28:31], v7 offset:24576
  v_mfma_f32_16x16x32_bf16 v[48:51], a[112:115], v[32:35], v[48:51]
  s_cmp_ge_u32 s54, 163840
  s_cselect_b32 s54, s51, s54
  v_mfma_f32_16x16x32_bf16 v[56:59], a[116:119], v[32:35], v[56:59]
  s_waitcnt lgkmcnt(3)
  v_mfma_f32_16x16x32_bf16 v[40:43], a[120:123], v[16:19], v[40:43]
  ds_read_b128 v[32:35], v6 offset:28672
  v_mfma_f32_16x16x32_bf16 v[48:51], a[124:127], v[16:19], v[48:51]
  s_cmp_eq_u32 s58, 122880
  s_cselect_b32 s59, 163840, 0
  v_mfma_f32_16x16x32_bf16 v[56:59], a[128:131], v[16:19], v[56:59]
  s_waitcnt lgkmcnt(3)
  v_mfma_f32_16x16x32_bf16 v[40:43], a[132:135], v[20:23], v[40:43]
  ds_read_b128 v[16:19], v7 offset:28672
  v_mfma_f32_16x16x32_bf16 v[48:51], a[136:139], v[20:23], v[48:51]
  s_sub_u32 s59, 40960, s59
  s_add_u32 s58, s58, s59
  v_mfma_f32_16x16x32_bf16 v[56:59], a[140:143], v[20:23], v[56:59]
  s_waitcnt lgkmcnt(3)
  v_mfma_f32_16x16x32_bf16 v[40:43], a[144:147], v[24:27], v[40:43]
  ds_read_b128 v[20:23], v6 offset:32768
  v_mfma_f32_16x16x32_bf16 v[48:51], a[148:151], v[24:27], v[48:51]
  s_lshr_b32 s55, s67, 1
  v_mfma_f32_16x16x32_bf16 v[56:59], a[152:155], v[24:27], v[56:59]
  s_lshl_b32 s55, s55, 14
  s_waitcnt lgkmcnt(3)
  v_mfma_f32_16x16x32_bf16 v[40:43], a[156:159], v[28:31], v[40:43]
  ds_read_b128 v[24:27], v7 offset:32768
  v_mfma_f32_16x16x32_bf16 v[48:51], a[160:163], v[28:31], v[48:51]
  s_and_b32 s56, s67, 1
  v_mfma_f32_16x16x32_bf16 v[56:59], a[164:167], v[28:31], v[56:59]
  s_lshl_b32 s56, s56, 12
  s_waitcnt lgkmcnt(3)
  v_mfma_f32_16x16x32_bf16 v[40:43], a[168:171], v[32:35], v[40:43]
  ds_read_b128 v[28:31], v6 offset:36864
  v_mfma_f32_16x16x32_bf16 v[48:51], a[172:175], v[32:35], v[48:51]
  s_add_u32 s55, s55, s56
  v_mfma_f32_16x16x32_bf16 v[56:59], a[176:179], v[32:35], v[56:59]
  s_add_u32 s55, s55, s63
  s_waitcnt lgkmcnt(3)
  v_mfma_f32_16x16x32_bf16 v[40:43], a[180:183], v[16:19], v[40:43]
  ds_read_b128 v[32:35], v7 offset:36864
  v_mfma_f32_16x16x32_bf16 v[48:51], a[184:187], v[16:19], v[48:51]
  s_lshr_b32 s56, s55, 8
  v_mfma_f32_16x16x32_bf16 v[56:59], a[188:191], v[16:19], v[56:59]
  s_and_b32 s56, s56, 0x2000
  s_waitcnt lgkmcnt(3)
  v_mfma_f32_16x16x32_bf16 v[40:43], a[192:195], v[20:23], v[40:43]
  ds_read_b128 v[16:19], v6 offset:2048
  v_mfma_f32_16x16x32_bf16 v[48:51], a[196:199], v[20:23], v[48:51]
  s_xor_b32 s55, s55, s56
  v_mfma_f32_16x16x32_bf16 v[56:59], a[200:203], v[20:23], v[56:59]
  s_add_u32 s67, s67, 1
  s_waitcnt lgkmcnt(3)
  v_mfma_f32_16x16x32_bf16 v[40:43], a[204:207], v[24:27], v[40:43]
  ds_read_b128 v[20:23], v7 offset:2048
  v_mfma_f32_16x16x32_bf16 v[48:51], a[208:211], v[24:27], v[48:51]
  s_add_u32 s56, s55, 16777216
  v_mfma_f32_16x16x32_bf16 v[56:59], a[212:215], v[24:27], v[56:59]
  s_add_u32 s57, s55, 33554432
  s_waitcnt lgkmcnt(3)
  v_mfma_f32_16x16x32_bf16 v[40:43], a[216:219], v[28:31], v[40:43]
  ds_read_b128 v[24:27], v6 offset:6144
  v_mfma_f32_16x16x32_bf16 v[48:51], a[220:223], v[28:31], v[48:51]
  v_mfma_f32_16x16x32_bf16 v[56:59], a[224:227], v[28:31], v[56:59]
  s_waitcnt lgkmcnt(3)
  v_mfma_f32_16x16x32_bf16 v[40:43], a[228:231], v[32:35], v[40:43]
  ds_read_b128 v[28:31], v7 offset:6144
  v_mfma_f32_16x16x32_bf16 v[48:51], a[232:235], v[32:35], v[48:51]
  v_mfma_f32_16x16x32_bf16 v[56:59], a[236:239], v[32:35], v[56:59]
  s_waitcnt lgkmcnt(3)
  v_mfma_f32_16x16x32_bf16 v[44:47], a[0:3], v[16:19], 0
  ds_read_b128 v[32:35], v6 offset:10240
  v_mfma_f32_16x16x32_bf16 v[52:55], a[4:7], v[16:19], 0
  v_mfma_f32_16x16x32_bf16 v[60:63], a[8:11], v[16:19], 0
  s_waitcnt lgkmcnt(3)
  v_cvt_pk_bf16_f32 v64, v40, v41
  v_mfma_f32_16x16x32_bf16 v[44:47], a[12:15], v[20:23], v[44:47]
  ds_read_b128 v[16:19], v7 offset:10240
  v_cvt_pk_bf16_f32 v65, v42, v43
  v_mfma_f32_16x16x32_bf16 v[52:55], a[16:19], v[20:23], v[52:55]
  v_cvt_pk_bf16_f32 v68, v48, v49
  v_mfma_f32_16x16x32_bf16 v[60:63], a[20:23], v[20:23], v[60:63]
  s_waitcnt lgkmcnt(3)
  v_cvt_pk_bf16_f32 v69, v50, v51
  v_mfma_f32_16x16x32_bf16 v[44:47], a[24:27], v[24:27], v[44:47]
  ds_read_b128 v[20:23], v6 offset:14336
  v_cvt_pk_bf16_f32 v72, v56, v57
  v_mfma_f32_16x16x32_bf16 v[52:55], a[28:31], v[24:27], v[52:55]
  v_cvt_pk_bf16_f32 v73, v58, v59
  v_mfma_f32_16x16x32_bf16 v[60:63], a[32:35], v[24:27], v[60:63]
  s_waitcnt lgkmcnt(3)
  v_mfma_f32_16x16x32_bf16 v[44:47], a[36:39], v[28:31], v[44:47]
  ds_read_b128 v[24:27], v7 offset:14336
  v_mfma_f32_16x16x32_bf16 v[52:55], a[40:43], v[28:31], v[52:55]
  s_waitcnt vmcnt(0)
  s_barrier
  v_mfma_f32_16x16x32_bf16 v[60:63], a[44:47], v[28:31], v[60:63]
  buffer_store_dword v10, v9, s[8:11], 0 offen sc1
  s_waitcnt lgkmcnt(3)
  v_mfma_f32_16x16x32_bf16 v[44:47], a[48:51], v[32:35], v[44:47]
  ds_read_b128 v[28:31], v6 offset:18432
  s_add_u32 m0, s54, 0
  v_mfma_f32_16x16x32_bf16 v[52:55], a[52:55], v[32:35], v[52:55]
  buffer_load_dwordx4 v5, s[12:15], s53 offen offset:0 lds
  v_mfma_f32_16x16x32_bf16 v[60:63], a[56:59], v[32:35], v[60:63]
  s_waitcnt lgkmcnt(3)
  v_mfma_f32_16x16x32_bf16 v[44:47], a[60:63], v[16:19], v[44:47]
  ds_read_b128 v[32:35], v7 offset:18432
  s_add_u32 m0, s54, 3968
  v_mfma_f32_16x16x32_bf16 v[52:55], a[64:67], v[16:19], v[52:55]
  buffer_load_dwordx4 v5, s[12:15], s53 offen offset:128 lds
  v_mfma_f32_16x16x32_bf16 v[60:63], a[68:71], v[16:19], v[60:63]
  s_waitcnt lgkmcnt(3)
  v_mfma_f32_16x16x32_bf16 v[44:47], a[72:75], v[20:23], v[44:47]
  ds_read_b128 v[16:19], v6 offset:22528
  s_add_u32 m0, s54, 7936
  v_mfma_f32_16x16x32_bf16 v[52:55], a[76:79], v[20:23], v[52:55]
  buffer_load_dwordx4 v5, s[12:15], s53 offen offset:256 lds
  v_mfma_f32_16x16x32_bf16 v[60:63], a[80:83], v[20:23], v[60:63]
  s_waitcnt lgkmcnt(3)
  v_mfma_f32_16x16x32_bf16 v[44:47], a[84:87], v[24:27], v[44:47]
  ds_read_b128 v[20:23], v7 offset:22528
  s_add_u32 m0, s54, 11904
  v_mfma_f32_16x16x32_bf16 v[52:55], a[88:91], v[24:27], v[52:55]
  buffer_load_dwordx4 v5, s[12:15], s53 offen offset:384 lds
  v_mfma_f32_16x16x32_bf16 v[60:63], a[92:95], v[24:27], v[60:63]
  s_waitcnt lgkmcnt(3)
  v_mfma_f32_16x16x32_bf16 v[44:47], a[96:99], v[28:31], v[44:47]
  ds_read_b128 v[24:27], v6 offset:26624
  s_add_u32 m0, s54, 15872
  v_mfma_f32_16x16x32_bf16 v[52:55], a[100:103], v[28:31], v[52:55]
  buffer_load_dwordx4 v5, s[12:15], s53 offen offset:512 lds
  v_mfma_f32_16x16x32_bf16 v[60:63], a[104:107], v[28:31], v[60:63]
  s_waitcnt lgkmcnt(3)
  v_mfma_f32_16x16x32_bf16 v[44:47], a[108:111], v[32:35], v[44:47]
  ds_read_b128 v[28:31], v7 offset:26624
  s_add_u32 m0, s54, 19840
  v_mfma_f32_16x16x32_bf16 v[52:55], a[112:115], v[32:35], v[52:55]
  buffer_load_dwordx4 v5, s[12:15], s53 offen offset:640 lds
  v_mfma_f32_16x16x32_bf16 v[60:63], a[116:119], v[32:35], v[60:63]
  s_waitcnt lgkmcnt(3)
  v_mfma_f32_16x16x32_bf16 v[44:47], a[120:123], v[16:19], v[44:47]
  ds_read_b128 v[32:35], v6 offset:30720
  s_add_u32 m0, s54, 23808
  v_mfma_f32_16x16x32_bf16 v[52:55], a[124:127], v[16:19], v[52:55]
  buffer_load_dwordx4 v5, s[12:15], s53 offen offset:768 lds
  v_mfma_f32_16x16x32_bf16 v[60:63], a[128:131], v[16:19], v[60:63]
  s_waitcnt lgkmcnt(3)
  v_mfma_f32_16x16x32_bf16 v[44:47], a[132:135], v[20:23], v[44:47]
  ds_read_b128 v[16:19], v7 offset:30720
  s_add_u32 m0, s54, 27776
  v_mfma_f32_16x16x32_bf16 v[52:55], a[136:139], v[20:23], v[52:55]
  buffer_load_dwordx4 v5, s[12:15], s53 offen offset:896 lds
  v_mfma_f32_16x16x32_bf16 v[60:63], a[140:143], v[20:23], v[60:63]
  s_waitcnt lgkmcnt(3)
  v_mfma_f32_16x16x32_bf16 v[44:47], a[144:147], v[24:27], v[44:47]
  ds_read_b128 v[20:23], v6 offset:34816
  s_add_u32 m0, s54, 31744
  v_mfma_f32_16x16x32_bf16 v[52:55], a[148:151], v[24:27], v[52:55]
  buffer_load_dwordx4 v5, s[12:15], s53 offen offset:1024 lds
  v_mfma_f32_16x16x32_bf16 v[60:63], a[152:155], v[24:27], v[60:63]
  s_waitcnt lgkmcnt(3)
  v_mfma_f32_16x16x32_bf16 v[44:47], a[156:159], v[28:31], v[44:47]
  ds_read_b128 v[24:27], v7 offset:34816
  s_add_u32 m0, s54, 35712
  v_mfma_f32_16x16x32_bf16 v[52:55], a[160:163], v[28:31], v[52:55]
  buffer_load_dwordx4 v5, s[12:15], s53 offen offset:1152 lds
  v_mfma_f32_16x16x32_bf16 v[60:63], a[164:167], v[28:31], v[60:63]
  s_waitcnt lgkmcnt(3)
  v_mfma_f32_16x16x32_bf16 v[44:47], a[168:171], v[32:35], v[44:47]
  ds_read_b128 v[28:31], v6 offset:38912
  v_mfma_f32_16x16x32_bf16 v[52:55], a[172:175], v[32:35], v[52:55]
  v_mfma_f32_16x16x32_bf16 v[60:63], a[176:179], v[32:35], v[60:63]
  s_waitcnt lgkmcnt(3)
  v_mfma_f32_16x16x32_bf16 v[44:47], a[180:183], v[16:19], v[44:47]
  ds_read_b128 v[32:35], v7 offset:38912
  v_mfma_f32_16x16x32_bf16 v[52:55], a[184:187], v[16:19], v[52:55]
  v_add_u32 v6, s59, v6
  v_add_u32 v7, s59, v7
  v_mfma_f32_16x16x32_bf16 v[60:63], a[188:191], v[16:19], v[60:63]
  s_waitcnt lgkmcnt(3)
  v_mfma_f32_16x16x32_bf16 v[44:47], a[192:195], v[20:23], v[44:47]
  ds_read_b128 v[16:19], v6 offset:0
  v_mfma_f32_16x16x32_bf16 v[52:55], a[196:199], v[20:23], v[52:55]
  v_mfma_f32_16x16x32_bf16 v[60:63], a[200:203], v[20:23], v[60:63]
  s_waitcnt lgkmcnt(3)
  v_mfma_f32_16x16x32_bf16 v[44:47], a[204:207], v[24:27], v[44:47]
  ds_read_b128 v[20:23], v7 offset:0
  v_mfma_f32_16x16x32_bf16 v[52:55], a[208:211], v[24:27], v[52:55]
  s_add_u32 s52, s52, 1
  v_mfma_f32_16x16x32_bf16 v[60:63], a[212:215], v[24:27], v[60:63]
  s_waitcnt lgkmcnt(3)
  v_mfma_f32_16x16x32_bf16 v[44:47], a[216:219], v[28:31], v[44:47]
  ds_read_b128 v[24:27], v6 offset:4096
  v_mfma_f32_16x16x32_bf16 v[52:55], a[220:223], v[28:31], v[52:55]
  v_mfma_f32_16x16x32_bf16 v[60:63], a[224:227], v[28:31], v[60:63]
  s_waitcnt lgkmcnt(3)
  v_mfma_f32_16x16x32_bf16 v[44:47], a[228:231], v[32:35], v[44:47]
  ds_read_b128 v[28:31], v7 offset:4096
  v_mfma_f32_16x16x32_bf16 v[52:55], a[232:235], v[32:35], v[52:55]
  s_cmp_lt_u32 s52, s62
  v_mfma_f32_16x16x32_bf16 v[60:63], a[236:239], v[32:35], v[60:63]
  s_waitcnt lgkmcnt(3)
  s_cbranch_scc1 pa_loop_12
  v_cvt_pk_bf16_f32 v66, v44, v45
  v_cvt_pk_bf16_f32 v67, v46, v47
  s_nop 1
  v_cvt_pk_bf16_f32 v70, v52, v53
  v_cvt_pk_bf16_f32 v71, v54, v55
  v_cvt_pk_bf16_f32 v74, v60, v61
  v_cvt_pk_bf16_f32 v75, v62, v63
  v_permlane16_swap_b32 v64, v66
  v_permlane16_swap_b32 v65, v67
  v_permlane16_swap_b32 v68, v70
  v_permlane16_swap_b32 v69, v71
  v_permlane16_swap_b32 v72, v74
  v_permlane16_swap_b32 v73, v75
  buffer_store_dwordx4 v[64:67], v8, s[8:11], s55 offen sc1
  buffer_store_dwordx4 v[68:71], v8, s[8:11], s56 offen sc1
  buffer_store_dwordx4 v[72:75], v8, s[8:11], s57 offen sc1
  v_mov_b32 v10, s52
  s_waitcnt vmcnt(0) lgkmcnt(0)
  s_barrier
  buffer_store_dword v10, v9, s[8:11], 0 offen sc1
pa_att:
  v_min_u32 v1, 19, v0
  v_cmp_lt_u32 vcc, 9, v1
  s_lshl_b32 s46, s65, 4
  s_max_u32 s47, s46, 14
  s_sub_u32 s47, s47, 14
  s_lshr_b32 s47, s47, 5
  s_lshr_b32 s48, s46, 5
  v_mov_b32 v2, s47
  v_mov_b32 v3, s48
  v_cndmask_b32 v2, v2, v3, vcc
  v_subrev_u32 v3, 10, v1
  v_cndmask_b32 v1, v1, v3, vcc
  v_mul_u32_u24 v3, 171, v2
  v_lshrrev_b32 v3, 10, v3
  v_max_u32 v4, 28, v2
  v_subrev_u32 v4, 28, v4
  v_mul_u32_u24 v4, 171, v4
  v_lshrrev_b32 v4, 9, v4
  v_max_u32 v3, v3, v4
  v_mul_u32_u24 v3, 10, v3
  v_add_u32 v1, v1, v3
  v_lshlrev_b32 v1, 7, v1
  v_add_u32 v1, 1081344, v1
  v_lshrrev_b32 v3, 4, v0
  s_lshl_b32 s47, s42, 2
  v_add_u32 v3, s47, v3
  v_mul_u32_u24 v3, 5, v3
  s_xor_b32 s47, s3, 132128768
  v_add_u32 v8, 0, v3
  v_mul_u32_u24 v4, 171, v8
  v_lshrrev_b32 v4, 12, v4
  v_mul_u32_u24 v5, 3, v4
  v_lshrrev_b32 v6, 3, v8
  v_sub_u32 v5, v6, v5
  v_and_b32 v8, 7, v8
  v_lshl_add_u32 v8, v8, 8, s47
  v_lshl_add_u32 v8, v4, 19, v8
  v_lshl_add_u32 v8, v5, 24, v8
  v_lshrrev_b32 v4, 8, v8
  v_and_b32 v4, 0x2000, v4
  v_xor_b32 v8, v8, v4
  v_add_u32 v9, 1, v3
  v_mul_u32_u24 v4, 171, v9
  v_lshrrev_b32 v4, 12, v4
  v_mul_u32_u24 v5, 3, v4
  v_lshrrev_b32 v6, 3, v9
  v_sub_u32 v5, v6, v5
  v_and_b32 v9, 7, v9
  v_lshl_add_u32 v9, v9, 8, s47
  v_lshl_add_u32 v9, v4, 19, v9
  v_lshl_add_u32 v9, v5, 24, v9
  v_lshrrev_b32 v4, 8, v9
  v_and_b32 v4, 0x2000, v4
  v_xor_b32 v9, v9, v4
  v_add_u32 v10, 2, v3
  v_mul_u32_u24 v4, 171, v10
  v_lshrrev_b32 v4, 12, v4
  v_mul_u32_u24 v5, 3, v4
  v_lshrrev_b32 v6, 3, v10
  v_sub_u32 v5, v6, v5
  v_and_b32 v10, 7, v10
  v_lshl_add_u32 v10, v10, 8, s47
  v_lshl_add_u32 v10, v4, 19, v10
  v_lshl_add_u32 v10, v5, 24, v10
  v_lshrrev_b32 v4, 8, v10
  v_and_b32 v4, 0x2000, v4
  v_xor_b32 v10, v10, v4
  v_add_u32 v11, 3, v3
  v_mul_u32_u24 v4, 171, v11
  v_lshrrev_b32 v4, 12, v4
  v_mul_u32_u24 v5, 3, v4
  v_lshrrev_b32 v6, 3, v11
  v_sub_u32 v5, v6, v5
  v_and_b32 v11, 7, v11
  v_lshl_add_u32 v11, v11, 8, s47
  v_lshl_add_u32 v11, v4, 19, v11
  v_lshl_add_u32 v11, v5, 24, v11
  v_lshrrev_b32 v4, 8, v11
  v_and_b32 v4, 0x2000, v4
  v_xor_b32 v11, v11, v4
  v_add_u32 v12, 4, v3
  v_mul_u32_u24 v4, 171, v12
  v_lshrrev_b32 v4, 12, v4
  v_mul_u32_u24 v5, 3, v4
  v_lshrrev_b32 v6, 3, v12
  v_sub_u32 v5, v6, v5
  v_and_b32 v12, 7, v12
  v_lshl_add_u32 v12, v12, 8, s47
  v_lshl_add_u32 v12, v4, 19, v12
  v_lshl_add_u32 v12, v5, 24, v12
  v_lshrrev_b32 v4, 8, v12
  v_and_b32 v4, 0x2000, v4
  v_xor_b32 v12, v12, v4
  v_add_u32 v13, 80, v3
  v_mul_u32_u24 v4, 171, v13
  v_lshrrev_b32 v4, 12, v4
  v_mul_u32_u24 v5, 3, v4
  v_lshrrev_b32 v6, 3, v13
  v_sub_u32 v5, v6, v5
  v_and_b32 v13, 7, v13
  v_lshl_add_u32 v13, v13, 8, s47
  v_lshl_add_u32 v13, v4, 19, v13
  v_lshl_add_u32 v13, v5, 24, v13
  v_lshrrev_b32 v4, 8, v13
  v_and_b32 v4, 0x2000, v4
  v_xor_b32 v13, v13, v4
  v_add_u32 v14, 81, v3
  v_mul_u32_u24 v4, 171, v14
  v_lshrrev_b32 v4, 12, v4
  v_mul_u32_u24 v5, 3, v4
  v_lshrrev_b32 v6, 3, v14
  v_sub_u32 v5, v6, v5
  v_and_b32 v14, 7, v14
  v_lshl_add_u32 v14, v14, 8, s47
  v_lshl_add_u32 v14, v4, 19, v14
  v_lshl_add_u32 v14, v5, 24, v14
  v_lshrrev_b32 v4, 8, v14
  v_and_b32 v4, 0x2000, v4
  v_xor_b32 v14, v14, v4
  v_add_u32 v15, 82, v3
  v_mul_u32_u24 v4, 171, v15
  v_lshrrev_b32 v4, 12, v4
  v_mul_u32_u24 v5, 3, v4
  v_lshrrev_b32 v6, 3, v15
  v_sub_u32 v5, v6, v5
  v_and_b32 v15, 7, v15
  v_lshl_add_u32 v15, v15, 8, s47
  v_lshl_add_u32 v15, v4, 19, v15
  v_lshl_add_u32 v15, v5, 24, v15
  v_lshrrev_b32 v4, 8, v15
  v_and_b32 v4, 0x2000, v4
  v_xor_b32 v15, v15, v4
  v_add_u32 v16, 83, v3
  v_mul_u32_u24 v4, 171, v16
  v_lshrrev_b32 v4, 12, v4
  v_mul_u32_u24 v5, 3, v4
  v_lshrrev_b32 v6, 3, v16
  v_sub_u32 v5, v6, v5
  v_and_b32 v16, 7, v16
  v_lshl_add_u32 v16, v16, 8, s47
  v_lshl_add_u32 v16, v4, 19, v16
  v_lshl_add_u32 v16, v5, 24, v16
  v_lshrrev_b32 v4, 8, v16
  v_and_b32 v4, 0x2000, v4
  v_xor_b32 v16, v16, v4
  v_add_u32 v17, 84, v3
  v_mul_u32_u24 v4, 171, v17
  v_lshrrev_b32 v4, 12, v4
  v_mul_u32_u24 v5, 3, v4
  v_lshrrev_b32 v6, 3, v17
  v_sub_u32 v5, v6, v5
  v_and_b32 v17, 7, v17
  v_lshl_add_u32 v17, v17, 8, s47
  v_lshl_add_u32 v17, v4, 19, v17
  v_lshl_add_u32 v17, v5, 24, v17
  v_lshrrev_b32 v4, 8, v17
  v_and_b32 v4, 0x2000, v4
  v_xor_b32 v17, v17, v4
  v_add_u32 v18, 160, v3
  v_mul_u32_u24 v4, 171, v18
  v_lshrrev_b32 v4, 12, v4
  v_mul_u32_u24 v5, 3, v4
  v_lshrrev_b32 v6, 3, v18
  v_sub_u32 v5, v6, v5
  v_and_b32 v18, 7, v18
  v_lshl_add_u32 v18, v18, 8, s47
  v_lshl_add_u32 v18, v4, 19, v18
  v_lshl_add_u32 v18, v5, 24, v18
  v_lshrrev_b32 v4, 8, v18
  v_and_b32 v4, 0x2000, v4
  v_xor_b32 v18, v18, v4
  v_add_u32 v19, 161, v3
  v_mul_u32_u24 v4, 171, v19
  v_lshrrev_b32 v4, 12, v4
  v_mul_u32_u24 v5, 3, v4
  v_lshrrev_b32 v6, 3, v19
  v_sub_u32 v5, v6, v5
  v_and_b32 v19, 7, v19
  v_lshl_add_u32 v19, v19, 8, s47
  v_lshl_add_u32 v19, v4, 19, v19
  v_lshl_add_u32 v19, v5, 24, v19
  v_lshrrev_b32 v4, 8, v19
  v_and_b32 v4, 0x2000, v4
  v_xor_b32 v19, v19, v4
  v_add_u32 v20, 162, v3
  v_mul_u32_u24 v4, 171, v20
  v_lshrrev_b32 v4, 12, v4
  v_mul_u32_u24 v5, 3, v4
  v_lshrrev_b32 v6, 3, v20
  v_sub_u32 v5, v6, v5
  v_and_b32 v20, 7, v20
  v_lshl_add_u32 v20, v20, 8, s47
  v_lshl_add_u32 v20, v4, 19, v20
  v_lshl_add_u32 v20, v5, 24, v20
  v_lshrrev_b32 v4, 8, v20
  v_and_b32 v4, 0x2000, v4
  v_xor_b32 v20, v20, v4
  v_add_u32 v21, 163, v3
  v_mul_u32_u24 v4, 171, v21
  v_lshrrev_b32 v4, 12, v4
  v_mul_u32_u24 v5, 3, v4
  v_lshrrev_b32 v6, 3, v21
  v_sub_u32 v5, v6, v5
  v_and_b32 v21, 7, v21
  v_lshl_add_u32 v21, v21, 8, s47
  v_lshl_add_u32 v21, v4, 19, v21
  v_lshl_add_u32 v21, v5, 24, v21
  v_lshrrev_b32 v4, 8, v21
  v_and_b32 v4, 0x2000, v4
  v_xor_b32 v21, v21, v4
  v_add_u32 v22, 164, v3
  v_mul_u32_u24 v4, 171, v22
  v_lshrrev_b32 v4, 12, v4
  v_mul_u32_u24 v5, 3, v4
  v_lshrrev_b32 v6, 3, v22
  v_sub_u32 v5, v6, v5
  v_and_b32 v22, 7, v22
  v_lshl_add_u32 v22, v22, 8, s47
  v_lshl_add_u32 v22, v4, 19, v22
  v_lshl_add_u32 v22, v5, 24, v22
  v_lshrrev_b32 v4, 8, v22
  v_and_b32 v4, 0x2000, v4
  v_xor_b32 v22, v22, v4
  v_and_b32 v5, 15, v0
  v_add_u32 v6, s46, v5
  v_subrev_u32 v4, 0, v6
  v_max_i32 v4, 0, v4
  v_and_b32 v23, 15, v4
  v_lshlrev_b32 v23, 4, v23
  v_bfe_u32 v7, v4, 4, 2
  v_lshl_add_u32 v23, v7, 11, v23
  v_lshrrev_b32 v4, 6, v4
  v_lshl_add_u32 v23, v4, 14, v23
  v_cmp_gt_u32 s[72:73], 0, v6
  v_subrev_u32 v4, 2, v6
  v_max_i32 v4, 0, v4
  v_and_b32 v24, 15, v4
  v_lshlrev_b32 v24, 4, v24
  v_bfe_u32 v7, v4, 4, 2
  v_lshl_add_u32 v24, v7, 11, v24
  v_lshrrev_b32 v4, 6, v4
  v_lshl_add_u32 v24, v4, 14, v24
  v_cmp_gt_u32 s[74:75], 2, v6
  v_subrev_u32 v4, 4, v6
  v_max_i32 v4, 0, v4
  v_and_b32 v25, 15, v4
  v_lshlrev_b32 v25, 4, v25
  v_bfe_u32 v7, v4, 4, 2
  v_lshl_add_u32 v25, v7, 11, v25
  v_lshrrev_b32 v4, 6, v4
  v_lshl_add_u32 v25, v4, 14, v25
  v_cmp_gt_u32 s[76:77], 4, v6
  v_subrev_u32 v4, 6, v6
  v_max_i32 v4, 0, v4
  v_and_b32 v26, 15, v4
  v_lshlrev_b32 v26, 4, v26
  v_bfe_u32 v7, v4, 4, 2
  v_lshl_add_u32 v26, v7, 11, v26
  v_lshrrev_b32 v4, 6, v4
  v_lshl_add_u32 v26, v4, 14, v26
  v_cmp_gt_u32 s[78:79], 6, v6
  v_subrev_u32 v4, 8, v6
  v_max_i32 v4, 0, v4
  v_and_b32 v27, 15, v4
  v_lshlrev_b32 v27, 4, v27
  v_bfe_u32 v7, v4, 4, 2
  v_lshl_add_u32 v27, v7, 11, v27
  v_lshrrev_b32 v4, 6, v4
  v_lshl_add_u32 v27, v4, 14, v27
  v_cmp_gt_u32 s[80:81], 8, v6
  v_subrev_u32 v4, 10, v6
  v_max_i32 v4, 0, v4
  v_and_b32 v28, 15, v4
  v_lshlrev_b32 v28, 4, v28
  v_bfe_u32 v7, v4, 4, 2
  v_lshl_add_u32 v28, v7, 11, v28
  v_lshrrev_b32 v4, 6, v4
  v_lshl_add_u32 v28, v4, 14, v28
  v_cmp_gt_u32 s[82:83], 10, v6
  v_subrev_u32 v4, 12, v6
  v_max_i32 v4, 0, v4
  v_and_b32 v29, 15, v4
  v_lshlrev_b32 v29, 4, v29
  v_bfe_u32 v7, v4, 4, 2
  v_lshl_add_u32 v29, v7, 11, v29
  v_lshrrev_b32 v4, 6, v4
  v_lshl_add_u32 v29, v4, 14, v29
  v_cmp_gt_u32 s[84:85], 12, v6
  v_subrev_u32 v4, 14, v6
  v_max_i32 v4, 0, v4
  v_and_b32 v30, 15, v4
  v_lshlrev_b32 v30, 4, v30
  v_bfe_u32 v7, v4, 4, 2
  v_lshl_add_u32 v30, v7, 11, v30
  v_lshrrev_b32 v4, 6, v4
  v_lshl_add_u32 v30, v4, 14, v30
  v_cmp_gt_u32 s[86:87], 14, v6
  s_mov_b32 s50, 0
  s_mov_b32 s66, 0
pa_wait:
  buffer_load_dword v4, v1, s[8:11], 0 offen sc1
  s_add_u32 s50, s50, 1
  s_cmp_gt_u32 s50, 131072
  s_cbranch_scc1 L_fail
  s_waitcnt vmcnt(0)
  v_cmp_le_u32 vcc, v4, v2
  s_cbranch_vccnz pa_wait
  v_add_u32 v232, v8, v23
  buffer_load_dwordx4 v[32:35], v232, s[8:11], s66 offen sc1
  v_add_u32 v233, v9, v23
  buffer_load_dwordx4 v[36:39], v233, s[8:11], s66 offen sc1
  v_add_u32 v234, v10, v23
  buffer_load_dwordx4 v[40:43], v234, s[8:11], s66 offen sc1
  v_add_u32 v235, v11, v23
  buffer_load_dwordx4 v[44:47], v235, s[8:11], s66 offen sc1
  v_add_u32 v236, v12, v23
  buffer_load_dwordx4 v[48:51], v236, s[8:11], s66 offen sc1
  v_add_u32 v232, v13, v23
  buffer_load_dwordx4 v[72:75], v232, s[8:11], s66 offen sc1
  v_add_u32 v233, v14, v23
  buffer_load_dwordx4 v[76:79], v233, s[8:11], s66 offen sc1
  v_add_u32 v234, v15, v23
  buffer_load_dwordx4 v[80:83], v234, s[8:11], s66 offen sc1
  v_add_u32 v235, v16, v23
  buffer_load_dwordx4 v[84:87], v235, s[8:11], s66 offen sc1
  v_add_u32 v236, v17, v23
  buffer_load_dwordx4 v[88:91], v236, s[8:11], s66 offen sc1
  v_add_u32 v232, v13, v24
  buffer_load_dwordx4 v[92:95], v232, s[8:11], s66 offen sc1
  v_add_u32 v233, v14, v24
  buffer_load_dwordx4 v[96:99], v233, s[8:11], s66 offen sc1
  v_add_u32 v234, v15, v24
  buffer_load_dwordx4 v[100:103], v234, s[8:11], s66 offen sc1
  v_add_u32 v235, v16, v24
  buffer_load_dwordx4 v[104:107], v235, s[8:11], s66 offen sc1
  v_add_u32 v236, v17, v24
  buffer_load_dwordx4 v[108:111], v236, s[8:11], s66 offen sc1
  v_add_u32 v232, v13, v25
  buffer_load_dwordx4 v[112:115], v232, s[8:11], s66 offen sc1
  v_add_u32 v233, v14, v25
  buffer_load_dwordx4 v[116:119], v233, s[8:11], s66 offen sc1
  v_add_u32 v234, v15, v25
  buffer_load_dwordx4 v[120:123], v234, s[8:11], s66 offen sc1
  v_add_u32 v235, v16, v25
  buffer_load_dwordx4 v[124:127], v235, s[8:11], s66 offen sc1
  v_add_u32 v236, v17, v25
  buffer_load_dwordx4 v[128:131], v236, s[8:11], s66 offen sc1
  v_add_u32 v232, v13, v26
  buffer_load_dwordx4 v[132:135], v232, s[8:11], s66 offen sc1
  v_add_u32 v233, v14, v26
  buffer_load_dwordx4 v[136:139], v233, s[8:11], s66 offen sc1
  v_add_u32 v234, v15, v26
  buffer_load_dwordx4 v[140:143], v234, s[8:11], s66 offen sc1
  v_add_u32 v235, v16, v26
  buffer_load_dwordx4 v[144:147], v235, s[8:11], s66 offen sc1
  v_add_u32 v236, v17, v26
  buffer_load_dwordx4 v[148:151], v236, s[8:11], s66 offen sc1
  v_add_u32 v232, v13, v27
  buffer_load_dwordx4 v[152:155], v232, s[8:11], s66 offen sc1
  v_add_u32 v233, v14, v27
  buffer_load_dwordx4 v[156:159], v233, s[8:11], s66 offen sc1
  v_add_u32 v234, v15, v27
  buffer_load_dwordx4 v[160:163], v234, s[8:11], s66 offen sc1
  v_add_u32 v235, v16, v27
  buffer_load_dwordx4 v[164:167], v235, s[8:11], s66 offen sc1
  v_add_u32 v236, v17, v27
  buffer_load_dwordx4 v[168:171], v236, s[8:11], s66 offen sc1
  v_add_u32 v232, v13, v28
  buffer_load_dwordx4 v[172:175], v232, s[8:11], s66 offen sc1
  v_add_u32 v233, v14, v28
  buffer_load_dwordx4 v[176:179], v233, s[8:11], s66 offen sc1
  v_add_u32 v234, v15, v28
  buffer_load_dwordx4 v[180:183], v234, s[8:11], s66 offen sc1
  v_add_u32 v235, v16, v28
  buffer_load_dwordx4 v[184:187], v235, s[8:11], s66 offen sc1
  v_add_u32 v236, v17, v28
  buffer_load_dwordx4 v[188:191], v236, s[8:11], s66 offen sc1
  v_add_u32 v232, v13, v29
  buffer_load_dwordx4 v[192:195], v232, s[8:11], s66 offen sc1
  v_add_u32 v233, v14, v29
  buffer_load_dwordx4 v[196:199], v233, s[8:11], s66 offen sc1
  v_add_u32 v234, v15, v29
  buffer_load_dwordx4 v[200:203], v234, s[8:11], s66 offen sc1
  v_add_u32 v235, v16, v29
  buffer_load_dwordx4 v[204:207], v235, s[8:11], s66 offen sc1
  v_add_u32 v236, v17, v29
  buffer_load_dwordx4 v[208:211], v236, s[8:11], s66 offen sc1
  v_add_u32 v232, v13, v30
  buffer_load_dwordx4 v[212:215], v232, s[8:11], s66 offen sc1
  v_add_u32 v233, v14, v30
  buffer_load_dwordx4 v[216:219], v233, s[8:11], s66 offen sc1
  v_add_u32 v234, v15, v30
  buffer_load_dwordx4 v[220:223], v234, s[8:11], s66 offen sc1
  v_add_u32 v235, v16, v30
  buffer_load_dwordx4 v[224:227], v235, s[8:11], s66 offen sc1
  v_add_u32 v236, v17, v30
  buffer_load_dwordx4 v[228:231], v236, s[8:11], s66 offen sc1
  s_waitcnt vmcnt(35)
  v_dot2_f32_bf16 v52, v32, v72, 0
  v_dot2_f32_bf16 v60, v42, v82, 0
  v_dot2_f32_bf16 v52, v33, v73, v52
  v_dot2_f32_bf16 v60, v43, v83, v60
  v_dot2_f32_bf16 v52, v34, v74, v52
  v_dot2_f32_bf16 v60, v44, v84, v60
  v_dot2_f32_bf16 v52, v35, v75, v52
  v_dot2_f32_bf16 v60, v45, v85, v60
  v_dot2_f32_bf16 v52, v36, v76, v52
  v_dot2_f32_bf16 v60, v46, v86, v60
  v_dot2_f32_bf16 v52, v37, v77, v52
  v_dot2_f32_bf16 v60, v47, v87, v60
  v_dot2_f32_bf16 v52, v38, v78, v52
  v_dot2_f32_bf16 v60, v48, v88, v60
  v_dot2_f32_bf16 v52, v39, v79, v52
  v_dot2_f32_bf16 v60, v49, v89, v60
  v_dot2_f32_bf16 v52, v40, v80, v52
  v_dot2_f32_bf16 v60, v50, v90, v60
  v_dot2_f32_bf16 v52, v41, v81, v52
  v_dot2_f32_bf16 v60, v51, v91, v60
  v_add_u32 v232, v18, v23
  buffer_load_dwordx4 v[72:75], v232, s[8:11], s66 offen sc1
  v_add_u32 v233, v19, v23
  buffer_load_dwordx4 v[76:79], v233, s[8:11], s66 offen sc1
  v_add_u32 v234, v20, v23
  buffer_load_dwordx4 v[80:83], v234, s[8:11], s66 offen sc1
  v_add_u32 v235, v21, v23
  buffer_load_dwordx4 v[84:87], v235, s[8:11], s66 offen sc1
  v_add_u32 v236, v22, v23
  buffer_load_dwordx4 v[88:91], v236, s[8:11], s66 offen sc1
  s_waitcnt vmcnt(35)
  v_dot2_f32_bf16 v53, v32, v92, 0
  v_dot2_f32_bf16 v61, v42, v102, 0
  v_dot2_f32_bf16 v53, v33, v93, v53
  v_dot2_f32_bf16 v61, v43, v103, v61
  v_dot2_f32_bf16 v53, v34, v94, v53
  v_dot2_f32_bf16 v61, v44, v104, v61
  v_dot2_f32_bf16 v53, v35, v95, v53
  v_dot2_f32_bf16 v61, v45, v105, v61
  v_dot2_f32_bf16 v53, v36, v96, v53
  v_dot2_f32_bf16 v61, v46, v106, v61
  v_dot2_f32_bf16 v53, v37, v97, v53
  v_dot2_f32_bf16 v61, v47, v107, v61
  v_dot2_f32_bf16 v53, v38, v98, v53
  v_dot2_f32_bf16 v61, v48, v108, v61
  v_dot2_f32_bf16 v53, v39, v99, v53
  v_dot2_f32_bf16 v61, v49, v109, v61
  v_dot2_f32_bf16 v53, v40, v100, v53
  v_dot2_f32_bf16 v61, v50, v110, v61
  v_dot2_f32_bf16 v53, v41, v101, v53
  v_dot2_f32_bf16 v61, v51, v111, v61
  v_add_u32 v232, v18, v24
  buffer_load_dwordx4 v[92:95], v232, s[8:11], s66 offen sc1
  v_add_u32 v233, v19, v24
  buffer_load_dwordx4 v[96:99], v233, s[8:11], s66 offen sc1
  v_add_u32 v234, v20, v24
  buffer_load_dwordx4 v[100:103], v234, s[8:11], s66 offen sc1
  v_add_u32 v235, v21, v24
  buffer_load_dwordx4 v[104:107], v235, s[8:11], s66 offen sc1
  v_add_u32 v236, v22, v24
  buffer_load_dwordx4 v[108:111], v236, s[8:11], s66 offen sc1
  s_waitcnt vmcnt(35)
  v_dot2_f32_bf16 v54, v32, v112, 0
  v_dot2_f32_bf16 v62, v42, v122, 0
  v_dot2_f32_bf16 v54, v33, v113, v54
  v_dot2_f32_bf16 v62, v43, v123, v62
  v_dot2_f32_bf16 v54, v34, v114, v54
  v_dot2_f32_bf16 v62, v44, v124, v62
  v_dot2_f32_bf16 v54, v35, v115, v54
  v_dot2_f32_bf16 v62, v45, v125, v62
  v_dot2_f32_bf16 v54, v36, v116, v54
  v_dot2_f32_bf16 v62, v46, v126, v62
  v_dot2_f32_bf16 v54, v37, v117, v54
  v_dot2_f32_bf16 v62, v47, v127, v62
  v_dot2_f32_bf16 v54, v38, v118, v54
  v_dot2_f32_bf16 v62, v48, v128, v62
  v_dot2_f32_bf16 v54, v39, v119, v54
  v_dot2_f32_bf16 v62, v49, v129, v62
  v_dot2_f32_bf16 v54, v40, v120, v54
  v_dot2_f32_bf16 v62, v50, v130, v62
  v_dot2_f32_bf16 v54, v41, v121, v54
  v_dot2_f32_bf16 v62, v51, v131, v62
  v_add_u32 v232, v18, v25
  buffer_load_dwordx4 v[112:115], v232, s[8:11], s66 offen sc1
  v_add_u32 v233, v19, v25
  buffer_load_dwordx4 v[116:119], v233, s[8:11], s66 offen sc1
  v_add_u32 v234, v20, v25
  buffer_load_dwordx4 v[120:123], v234, s[8:11], s66 offen sc1
  v_add_u32 v235, v21, v25
  buffer_load_dwordx4 v[124:127], v235, s[8:11], s66 offen sc1
  v_add_u32 v236, v22, v25
  buffer_load_dwordx4 v[128:131], v236, s[8:11], s66 offen sc1
  s_waitcnt vmcnt(35)
  v_dot2_f32_bf16 v55, v32, v132, 0
  v_dot2_f32_bf16 v63, v42, v142, 0
  v_dot2_f32_bf16 v55, v33, v133, v55
  v_dot2_f32_bf16 v63, v43, v143, v63
  v_dot2_f32_bf16 v55, v34, v134, v55
  v_dot2_f32_bf16 v63, v44, v144, v63
  v_dot2_f32_bf16 v55, v35, v135, v55
  v_dot2_f32_bf16 v63, v45, v145, v63
  v_dot2_f32_bf16 v55, v36, v136, v55
  v_dot2_f32_bf16 v63, v46, v146, v63
  v_dot2_f32_bf16 v55, v37, v137, v55
  v_dot2_f32_bf16 v63, v47, v147, v63
  v_dot2_f32_bf16 v55, v38, v138, v55
  v_dot2_f32_bf16 v63, v48, v148, v63
  v_dot2_f32_bf16 v55, v39, v139, v55
  v_dot2_f32_bf16 v63, v49, v149, v63
  v_dot2_f32_bf16 v55, v40, v140, v55
  v_dot2_f32_bf16 v63, v50, v150, v63
  v_dot2_f32_bf16 v55, v41, v141, v55
  v_dot2_f32_bf16 v63, v51, v151, v63
  v_add_u32 v232, v18, v26
  buffer_load_dwordx4 v[132:135], v232, s[8:11], s66 offen sc1
  v_add_u32 v233, v19, v26
  buffer_load_dwordx4 v[136:139], v233, s[8:11], s66 offen sc1
  v_add_u32 v234, v20, v26
  buffer_load_dwordx4 v[140:143], v234, s[8:11], s66 offen sc1
  v_add_u32 v235, v21, v26
  buffer_load_dwordx4 v[144:147], v235, s[8:11], s66 offen sc1
  v_add_u32 v236, v22, v26
  buffer_load_dwordx4 v[148:151], v236, s[8:11], s66 offen sc1
  s_waitcnt vmcnt(35)
  v_dot2_f32_bf16 v56, v32, v152, 0
  v_dot2_f32_bf16 v64, v42, v162, 0
  v_dot2_f32_bf16 v56, v33, v153, v56
  v_dot2_f32_bf16 v64, v43, v163, v64
  v_dot2_f32_bf16 v56, v34, v154, v56
  v_dot2_f32_bf16 v64, v44, v164, v64
  v_dot2_f32_bf16 v56, v35, v155, v56
  v_dot2_f32_bf16 v64, v45, v165, v64
  v_dot2_f32_bf16 v56, v36, v156, v56
  v_dot2_f32_bf16 v64, v46, v166, v64
  v_dot2_f32_bf16 v56, v37, v157, v56
  v_dot2_f32_bf16 v64, v47, v167, v64
  v_dot2_f32_bf16 v56, v38, v158, v56
  v_dot2_f32_bf16 v64, v48, v168, v64
  v_dot2_f32_bf16 v56, v39, v159, v56
  v_dot2_f32_bf16 v64, v49, v169, v64
  v_dot2_f32_bf16 v56, v40, v160, v56
  v_dot2_f32_bf16 v64, v50, v170, v64
  v_dot2_f32_bf16 v56, v41, v161, v56
  v_dot2_f32_bf16 v64, v51, v171, v64
  v_add_u32 v232, v18, v27
  buffer_load_dwordx4 v[152:155], v232, s[8:11], s66 offen sc1
  v_add_u32 v233, v19, v27
  buffer_load_dwordx4 v[156:159], v233, s[8:11], s66 offen sc1
  v_add_u32 v234, v20, v27
  buffer_load_dwordx4 v[160:163], v234, s[8:11], s66 offen sc1
  v_add_u32 v235, v21, v27
  buffer_load_dwordx4 v[164:167], v235, s[8:11], s66 offen sc1
  v_add_u32 v236, v22, v27
  buffer_load_dwordx4 v[168:171], v236, s[8:11], s66 offen sc1
  s_waitcnt vmcnt(35)
  v_dot2_f32_bf16 v57, v32, v172, 0
  v_dot2_f32_bf16 v65, v42, v182, 0
  v_dot2_f32_bf16 v57, v33, v173, v57
  v_dot2_f32_bf16 v65, v43, v183, v65
  v_dot2_f32_bf16 v57, v34, v174, v57
  v_dot2_f32_bf16 v65, v44, v184, v65
  v_dot2_f32_bf16 v57, v35, v175, v57
  v_dot2_f32_bf16 v65, v45, v185, v65
  v_dot2_f32_bf16 v57, v36, v176, v57
  v_dot2_f32_bf16 v65, v46, v186, v65
  v_dot2_f32_bf16 v57, v37, v177, v57
  v_dot2_f32_bf16 v65, v47, v187, v65
  v_dot2_f32_bf16 v57, v38, v178, v57
  v_dot2_f32_bf16 v65, v48, v188, v65
  v_dot2_f32_bf16 v57, v39, v179, v57
  v_dot2_f32_bf16 v65, v49, v189, v65
  v_dot2_f32_bf16 v57, v40, v180, v57
  v_dot2_f32_bf16 v65, v50, v190, v65
  v_dot2_f32_bf16 v57, v41, v181, v57
  v_dot2_f32_bf16 v65, v51, v191, v65
  v_add_u32 v232, v18, v28
  buffer_load_dwordx4 v[172:175], v232, s[8:11], s66 offen sc1
  v_add_u32 v233, v19, v28
  buffer_load_dwordx4 v[176:179], v233, s[8:11], s66 offen sc1
  v_add_u32 v234, v20, v28
  buffer_load_dwordx4 v[180:183], v234, s[8:11], s66 offen sc1
  v_add_u32 v235, v21, v28
  buffer_load_dwordx4 v[184:187], v235, s[8:11], s66 offen sc1
  v_add_u32 v236, v22, v28
  buffer_load_dwordx4 v[188:191], v236, s[8:11], s66 offen sc1
  s_waitcnt vmcnt(35)
  v_dot2_f32_bf16 v58, v32, v192, 0
  v_dot2_f32_bf16 v66, v42, v202, 0
  v_dot2_f32_bf16 v58, v33, v193, v58
  v_dot2_f32_bf16 v66, v43, v203, v66
  v_dot2_f32_bf16 v58, v34, v194, v58
  v_dot2_f32_bf16 v66, v44, v204, v66
  v_dot2_f32_bf16 v58, v35, v195, v58
  v_dot2_f32_bf16 v66, v45, v205, v66
  v_dot2_f32_bf16 v58, v36, v196, v58
  v_dot2_f32_bf16 v66, v46, v206, v66
  v_dot2_f32_bf16 v58, v37, v197, v58
  v_dot2_f32_bf16 v66, v47, v207, v66
  v_dot2_f32_bf16 v58, v38, v198, v58
  v_dot2_f32_bf16 v66, v48, v208, v66
  v_dot2_f32_bf16 v58, v39, v199, v58
  v_dot2_f32_bf16 v66, v49, v209, v66
  v_dot2_f32_bf16 v58, v40, v200, v58
  v_dot2_f32_bf16 v66, v50, v210, v66
  v_dot2_f32_bf16 v58, v41, v201, v58
  v_dot2_f32_bf16 v66, v51, v211, v66
  v_add_u32 v232, v18, v29
  buffer_load_dwordx4 v[192:195], v232, s[8:11], s66 offen sc1
  v_add_u32 v233, v19, v29
  buffer_load_dwordx4 v[196:199], v233, s[8:11], s66 offen sc1
  v_add_u32 v234, v20, v29
  buffer_load_dwordx4 v[200:203], v234, s[8:11], s66 offen sc1
  v_add_u32 v235, v21, v29
  buffer_load_dwordx4 v[204:207], v235, s[8:11], s66 offen sc1
  v_add_u32 v236, v22, v29
  buffer_load_dwordx4 v[208:211], v236, s[8:11], s66 offen sc1
  s_waitcnt vmcnt(35)
  v_dot2_f32_bf16 v59, v32, v212, 0
  v_dot2_f32_bf16 v67, v42, v222, 0
  v_dot2_f32_bf16 v59, v33, v213, v59
  v_dot2_f32_bf16 v67, v43, v223, v67
  v_dot2_f32_bf16 v59, v34, v214, v59
  v_dot2_f32_bf16 v67, v44, v224, v67
  v_dot2_f32_bf16 v59, v35, v215, v59
  v_dot2_f32_bf16 v67, v45, v225, v67
  v_dot2_f32_bf16 v59, v36, v216, v59
  v_dot2_f32_bf16 v67, v46, v226, v67
  v_dot2_f32_bf16 v59, v37, v217, v59
  v_dot2_f32_bf16 v67, v47, v227, v67
  v_dot2_f32_bf16 v59, v38, v218, v59
  v_dot2_f32_bf16 v67, v48, v228, v67
  v_dot2_f32_bf16 v59, v39, v219, v59
  v_dot2_f32_bf16 v67, v49, v229, v67
  v_dot2_f32_bf16 v59, v40, v220, v59
  v_dot2_f32_bf16 v67, v50, v230, v67
  v_dot2_f32_bf16 v59, v41, v221, v59
  v_dot2_f32_bf16 v67, v51, v231, v67
  v_add_u32 v232, v18, v30
  buffer_load_dwordx4 v[212:215], v232, s[8:11], s66 offen sc1
  v_add_u32 v233, v19, v30
  buffer_load_dwordx4 v[216:219], v233, s[8:11], s66 offen sc1
  v_add_u32 v234, v20, v30
  buffer_load_dwordx4 v[220:223], v234, s[8:11], s66 offen sc1
  v_add_u32 v235, v21, v30
  buffer_load_dwordx4 v[224:227], v235, s[8:11], s66 offen sc1
  v_add_u32 v236, v22, v30
  buffer_load_dwordx4 v[228:231], v236, s[8:11], s66 offen sc1
  s_mov_b32 s46, 1051011932
  v_mov_b32 v232, 3481618353
  v_cndmask_b32 v53, v53, v232, s[74:75]
  v_cndmask_b32 v54, v54, v232, s[76:77]
  v_cndmask_b32 v55, v55, v232, s[78:79]
  v_cndmask_b32 v56, v56, v232, s[80:81]
  v_cndmask_b32 v57, v57, v232, s[82:83]
  v_cndmask_b32 v58, v58, v232, s[84:85]
  v_cndmask_b32 v59, v59, v232, s[86:87]
  v_max_f32 v233, v52, v53
  v_max3_f32 v233, v233, v54, v55
  v_max3_f32 v233, v233, v56, v57
  v_max3_f32 v233, v233, v58, v59
  v_mul_f32 v233, s46, v233
  v_fma_f32 v52, v52, s46, -v233
  v_fma_f32 v53, v53, s46, -v233
  v_fma_f32 v54, v54, s46, -v233
  v_fma_f32 v55, v55, s46, -v233
  v_fma_f32 v56, v56, s46, -v233
  v_fma_f32 v57, v57, s46, -v233
  v_fma_f32 v58, v58, s46, -v233
  v_fma_f32 v59, v59, s46, -v233
  v_exp_f32 v52, v52
  v_exp_f32 v53, v53
  v_exp_f32 v54, v54
  v_exp_f32 v55, v55
  v_exp_f32 v56, v56
  v_exp_f32 v57, v57
  v_exp_f32 v58, v58
  v_exp_f32 v59, v59
  v_add_f32 v233, v52, v53
  v_add_f32 v233, v233, v54
  v_add_f32 v233, v233, v55
  v_add_f32 v233, v233, v56
  v_add_f32 v233, v233, v57
  v_add_f32 v233, v233, v58
  v_add_f32 v233, v233, v59
  v_rcp_f32 v233, v233
  s_nop 0
  v_mul_f32 v52, v52, v233
  v_mul_f32 v53, v53, v233
  v_mul_f32 v54, v54, v233
  v_mul_f32 v55, v55, v233
  v_mul_f32 v56, v56, v233
  v_mul_f32 v57, v57, v233
  v_mul_f32 v58, v58, v233
  v_mul_f32 v59, v59, v233
  v_cndmask_b32 v61, v61, v232, s[74:75]
  v_cndmask_b32 v62, v62, v232, s[76:77]
  v_cndmask_b32 v63, v63, v232, s[78:79]
  v_cndmask_b32 v64, v64, v232, s[80:81]
  v_cndmask_b32 v65, v65, v232, s[82:83]
  v_cndmask_b32 v66, v66, v232, s[84:85]
  v_cndmask_b32 v67, v67, v232, s[86:87]
  v_max_f32 v233, v60, v61
  v_max3_f32 v233, v233, v62, v63
  v_max3_f32 v233, v233, v64, v65
  v_max3_f32 v233, v233, v66, v67
  v_mul_f32 v233, s46, v233
  v_fma_f32 v60, v60, s46, -v233
  v_fma_f32 v61, v61, s46, -v233
  v_fma_f32 v62, v62, s46, -v233
  v_fma_f32 v63, v63, s46, -v233
  v_fma_f32 v64, v64, s46, -v233
  v_fma_f32 v65, v65, s46, -v233
  v_fma_f32 v66, v66, s46, -v233
  v_fma_f32 v67, v67, s46, -v233
  v_exp_f32 v60, v60
  v_exp_f32 v61, v61
  v_exp_f32 v62, v62
  v_exp_f32 v63, v63
  v_exp_f32 v64, v64
  v_exp_f32 v65, v65
  v_exp_f32 v66, v66
  v_exp_f32 v67, v67
  v_add_f32 v233, v60, v61
  v_add_f32 v233, v233, v62
  v_add_f32 v233, v233, v63
  v_add_f32 v233, v233, v64
  v_add_f32 v233, v233, v65
  v_add_f32 v233, v233, v66
  v_add_f32 v233, v233, v67
  v_rcp_f32 v233, v233
  s_nop 0
  v_mul_f32 v60, v60, v233
  v_mul_f32 v61, v61, v233
  v_mul_f32 v62, v62, v233
  v_mul_f32 v63, v63, v233
  v_mul_f32 v64, v64, v233
  v_mul_f32 v65, v65, v233
  v_mul_f32 v66, v66, v233
  v_mul_f32 v67, v67, v233
  v_cvt_pk_bf16_f32 v52, v52, 0
  v_lshlrev_b32 v236, 16, v52
  v_cvt_pk_bf16_f32 v53, v53, 0
  v_lshlrev_b32 v237, 16, v53
  v_cvt_pk_bf16_f32 v54, v54, 0
  v_lshlrev_b32 v238, 16, v54
  v_cvt_pk_bf16_f32 v55, v55, 0
  v_lshlrev_b32 v239, 16, v55
  v_cvt_pk_bf16_f32 v56, v56, 0
  v_lshlrev_b32 v240, 16, v56
  v_cvt_pk_bf16_f32 v57, v57, 0
  v_lshlrev_b32 v241, 16, v57
  v_cvt_pk_bf16_f32 v58, v58, 0
  v_lshlrev_b32 v242, 16, v58
  v_cvt_pk_bf16_f32 v59, v59, 0
  v_lshlrev_b32 v243, 16, v59
  v_cvt_pk_bf16_f32 v60, v60, 0
  v_lshlrev_b32 v244, 16, v60
  v_cvt_pk_bf16_f32 v61, v61, 0
  v_lshlrev_b32 v245, 16, v61
  v_cvt_pk_bf16_f32 v62, v62, 0
  v_lshlrev_b32 v246, 16, v62
  v_cvt_pk_bf16_f32 v63, v63, 0
  v_lshlrev_b32 v247, 16, v63
  v_cvt_pk_bf16_f32 v64, v64, 0
  v_lshlrev_b32 v248, 16, v64
  v_cvt_pk_bf16_f32 v65, v65, 0
  v_lshlrev_b32 v249, 16, v65
  v_cvt_pk_bf16_f32 v66, v66, 0
  v_lshlrev_b32 v250, 16, v66
  v_cvt_pk_bf16_f32 v67, v67, 0
  v_lshlrev_b32 v251, 16, v67
  s_waitcnt vmcnt(35)
  v_dot2_f32_bf16 v8, v72, v52, 0
  v_dot2_f32_bf16 v9, v72, v236, 0
  v_dot2_f32_bf16 v10, v73, v52, 0
  v_dot2_f32_bf16 v11, v73, v236, 0
  v_dot2_f32_bf16 v12, v74, v52, 0
  v_dot2_f32_bf16 v13, v74, v236, 0
  v_dot2_f32_bf16 v14, v75, v52, 0
  v_dot2_f32_bf16 v15, v75, v236, 0
  v_dot2_f32_bf16 v16, v76, v52, 0
  v_dot2_f32_bf16 v17, v76, v236, 0
  v_dot2_f32_bf16 v18, v77, v52, 0
  v_dot2_f32_bf16 v19, v77, v236, 0
  v_dot2_f32_bf16 v20, v78, v52, 0
  v_dot2_f32_bf16 v21, v78, v236, 0
  v_dot2_f32_bf16 v22, v79, v52, 0
  v_dot2_f32_bf16 v23, v79, v236, 0
  v_dot2_f32_bf16 v24, v80, v52, 0
  v_dot2_f32_bf16 v25, v80, v236, 0
  v_dot2_f32_bf16 v26, v81, v52, 0
  v_dot2_f32_bf16 v27, v81, v236, 0
  v_dot2_f32_bf16 v28, v82, v60, 0
  v_dot2_f32_bf16 v29, v82, v244, 0
  v_dot2_f32_bf16 v30, v83, v60, 0
  v_dot2_f32_bf16 v31, v83, v244, 0
  v_dot2_f32_bf16 v32, v84, v60, 0
  v_dot2_f32_bf16 v33, v84, v244, 0
  v_dot2_f32_bf16 v34, v85, v60, 0
  v_dot2_f32_bf16 v35, v85, v244, 0
  v_dot2_f32_bf16 v36, v86, v60, 0
  v_dot2_f32_bf16 v37, v86, v244, 0
  v_dot2_f32_bf16 v38, v87, v60, 0
  v_dot2_f32_bf16 v39, v87, v244, 0
  v_dot2_f32_bf16 v40, v88, v60, 0
  v_dot2_f32_bf16 v41, v88, v244, 0
  v_dot2_f32_bf16 v42, v89, v60, 0
  v_dot2_f32_bf16 v43, v89, v244, 0
  v_dot2_f32_bf16 v44, v90, v60, 0
  v_dot2_f32_bf16 v45, v90, v244, 0
  v_dot2_f32_bf16 v46, v91, v60, 0
  v_dot2_f32_bf16 v47, v91, v244, 0
  s_waitcnt vmcnt(30)
  v_dot2_f32_bf16 v8, v92, v53, v8
  v_dot2_f32_bf16 v9, v92, v237, v9
  v_dot2_f32_bf16 v10, v93, v53, v10
  v_dot2_f32_bf16 v11, v93, v237, v11
  v_dot2_f32_bf16 v12, v94, v53, v12
  v_dot2_f32_bf16 v13, v94, v237, v13
  v_dot2_f32_bf16 v14, v95, v53, v14
  v_dot2_f32_bf16 v15, v95, v237, v15
  v_dot2_f32_bf16 v16, v96, v53, v16
  v_dot2_f32_bf16 v17, v96, v237, v17
  v_dot2_f32_bf16 v18, v97, v53, v18
  v_dot2_f32_bf16 v19, v97, v237, v19
  v_dot2_f32_bf16 v20, v98, v53, v20
  v_dot2_f32_bf16 v21, v98, v237, v21
  v_dot2_f32_bf16 v22, v99, v53, v22
  v_dot2_f32_bf16 v23, v99, v237, v23
  v_dot2_f32_bf16 v24, v100, v53, v24
  v_dot2_f32_bf16 v25, v100, v237, v25
  v_dot2_f32_bf16 v26, v101, v53, v26
  v_dot2_f32_bf16 v27, v101, v237, v27
  v_dot2_f32_bf16 v28, v102, v61, v28
  v_dot2_f32_bf16 v29, v102, v245, v29
  v_dot2_f32_bf16 v30, v103, v61, v30
  v_dot2_f32_bf16 v31, v103, v245, v31
  v_dot2_f32_bf16 v32, v104, v61, v32
  v_dot2_f32_bf16 v33, v104, v245, v33
  v_dot2_f32_bf16 v34, v105, v61, v34
  v_dot2_f32_bf16 v35, v105, v245, v35
  v_dot2_f32_bf16 v36, v106, v61, v36
  v_dot2_f32_bf16 v37, v106, v245, v37
  v_dot2_f32_bf16 v38, v107, v61, v38
  v_dot2_f32_bf16 v39, v107, v245, v39
  v_dot2_f32_bf16 v40, v108, v61, v40
  v_dot2_f32_bf16 v41, v108, v245, v41
  v_dot2_f32_bf16 v42, v109, v61, v42
  v_dot2_f32_bf16 v43, v109, v245, v43
  v_dot2_f32_bf16 v44, v110, v61, v44
  v_dot2_f32_bf16 v45, v110, v245, v45
  v_dot2_f32_bf16 v46, v111, v61, v46
  v_dot2_f32_bf16 v47, v111, v245, v47
  s_waitcnt vmcnt(25)
  v_dot2_f32_bf16 v8, v112, v54, v8
  v_dot2_f32_bf16 v9, v112, v238, v9
  v_dot2_f32_bf16 v10, v113, v54, v10
  v_dot2_f32_bf16 v11, v113, v238, v11
  v_dot2_f32_bf16 v12, v114, v54, v12
  v_dot2_f32_bf16 v13, v114, v238, v13
  v_dot2_f32_bf16 v14, v115, v54, v14
  v_dot2_f32_bf16 v15, v115, v238, v15
  v_dot2_f32_bf16 v16, v116, v54, v16
  v_dot2_f32_bf16 v17, v116, v238, v17
  v_dot2_f32_bf16 v18, v117, v54, v18
  v_dot2_f32_bf16 v19, v117, v238, v19
  v_dot2_f32_bf16 v20, v118, v54, v20
  v_dot2_f32_bf16 v21, v118, v238, v21
  v_dot2_f32_bf16 v22, v119, v54, v22
  v_dot2_f32_bf16 v23, v119, v238, v23
  v_dot2_f32_bf16 v24, v120, v54, v24
  v_dot2_f32_bf16 v25, v120, v238, v25
  v_dot2_f32_bf16 v26, v121, v54, v26
  v_dot2_f32_bf16 v27, v121, v238, v27
  v_dot2_f32_bf16 v28, v122, v62, v28
  v_dot2_f32_bf16 v29, v122, v246, v29
  v_dot2_f32_bf16 v30, v123, v62, v30
  v_dot2_f32_bf16 v31, v123, v246, v31
  v_dot2_f32_bf16 v32, v124, v62, v32
  v_dot2_f32_bf16 v33, v124, v246, v33
  v_dot2_f32_bf16 v34, v125, v62, v34
  v_dot2_f32_bf16 v35, v125, v246, v35
  v_dot2_f32_bf16 v36, v126, v62, v36
  v_dot2_f32_bf16 v37, v126, v246, v37
  v_dot2_f32_bf16 v38, v127, v62, v38
  v_dot2_f32_bf16 v39, v127, v246, v39
  v_dot2_f32_bf16 v40, v128, v62, v40
  v_dot2_f32_bf16 v41, v128, v246, v41
  v_dot2_f32_bf16 v42, v129, v62, v42
  v_dot2_f32_bf16 v43, v129, v246, v43
  v_dot2_f32_bf16 v44, v130, v62, v44
  v_dot2_f32_bf16 v45, v130, v246, v45
  v_dot2_f32_bf16 v46, v131, v62, v46
  v_dot2_f32_bf16 v47, v131, v246, v47
  s_waitcnt vmcnt(20)
  v_dot2_f32_bf16 v8, v132, v55, v8
  v_dot2_f32_bf16 v9, v132, v239, v9
  v_dot2_f32_bf16 v10, v133, v55, v10
  v_dot2_f32_bf16 v11, v133, v239, v11
  v_dot2_f32_bf16 v12, v134, v55, v12
  v_dot2_f32_bf16 v13, v134, v239, v13
  v_dot2_f32_bf16 v14, v135, v55, v14
  v_dot2_f32_bf16 v15, v135, v239, v15
  v_dot2_f32_bf16 v16, v136, v55, v16
  v_dot2_f32_bf16 v17, v136, v239, v17
  v_dot2_f32_bf16 v18, v137, v55, v18
  v_dot2_f32_bf16 v19, v137, v239, v19
  v_dot2_f32_bf16 v20, v138, v55, v20
  v_dot2_f32_bf16 v21, v138, v239, v21
  v_dot2_f32_bf16 v22, v139, v55, v22
  v_dot2_f32_bf16 v23, v139, v239, v23
  v_dot2_f32_bf16 v24, v140, v55, v24
  v_dot2_f32_bf16 v25, v140, v239, v25
  v_dot2_f32_bf16 v26, v141, v55, v26
  v_dot2_f32_bf16 v27, v141, v239, v27
  v_dot2_f32_bf16 v28, v142, v63, v28
  v_dot2_f32_bf16 v29, v142, v247, v29
  v_dot2_f32_bf16 v30, v143, v63, v30
  v_dot2_f32_bf16 v31, v143, v247, v31
  v_dot2_f32_bf16 v32, v144, v63, v32
  v_dot2_f32_bf16 v33, v144, v247, v33
  v_dot2_f32_bf16 v34, v145, v63, v34
  v_dot2_f32_bf16 v35, v145, v247, v35
  v_dot2_f32_bf16 v36, v146, v63, v36
  v_dot2_f32_bf16 v37, v146, v247, v37
  v_dot2_f32_bf16 v38, v147, v63, v38
  v_dot2_f32_bf16 v39, v147, v247, v39
  v_dot2_f32_bf16 v40, v148, v63, v40
  v_dot2_f32_bf16 v41, v148, v247, v41
  v_dot2_f32_bf16 v42, v149, v63, v42
  v_dot2_f32_bf16 v43, v149, v247, v43
  v_dot2_f32_bf16 v44, v150, v63, v44
  v_dot2_f32_bf16 v45, v150, v247, v45
  v_dot2_f32_bf16 v46, v151, v63, v46
  v_dot2_f32_bf16 v47, v151, v247, v47
  s_waitcnt vmcnt(15)
  v_dot2_f32_bf16 v8, v152, v56, v8
  v_dot2_f32_bf16 v9, v152, v240, v9
  v_dot2_f32_bf16 v10, v153, v56, v10
  v_dot2_f32_bf16 v11, v153, v240, v11
  v_dot2_f32_bf16 v12, v154, v56, v12
  v_dot2_f32_bf16 v13, v154, v240, v13
  v_dot2_f32_bf16 v14, v155, v56, v14
  v_dot2_f32_bf16 v15, v155, v240, v15
  v_dot2_f32_bf16 v16, v156, v56, v16
  v_dot2_f32_bf16 v17, v156, v240, v17
  v_dot2_f32_bf16 v18, v157, v56, v18
  v_dot2_f32_bf16 v19, v157, v240, v19
  v_dot2_f32_bf16 v20, v158, v56, v20
  v_dot2_f32_bf16 v21, v158, v240, v21
  v_dot2_f32_bf16 v22, v159, v56, v22
  v_dot2_f32_bf16 v23, v159, v240, v23
  v_dot2_f32_bf16 v24, v160, v56, v24
  v_dot2_f32_bf16 v25, v160, v240, v25
  v_dot2_f32_bf16 v26, v161, v56, v26
  v_dot2_f32_bf16 v27, v161, v240, v27
  v_dot2_f32_bf16 v28, v162, v64, v28
  v_dot2_f32_bf16 v29, v162, v248, v29
  v_dot2_f32_bf16 v30, v163, v64, v30
  v_dot2_f32_bf16 v31, v163, v248, v31
  v_dot2_f32_bf16 v32, v164, v64, v32
  v_dot2_f32_bf16 v33, v164, v248, v33
  v_dot2_f32_bf16 v34, v165, v64, v34
  v_dot2_f32_bf16 v35, v165, v248, v35
  v_dot2_f32_bf16 v36, v166, v64, v36
  v_dot2_f32_bf16 v37, v166, v248, v37
  v_dot2_f32_bf16 v38, v167, v64, v38
  v_dot2_f32_bf16 v39, v167, v248, v39
  v_dot2_f32_bf16 v40, v168, v64, v40
  v_dot2_f32_bf16 v41, v168, v248, v41
  v_dot2_f32_bf16 v42, v169, v64, v42
  v_dot2_f32_bf16 v43, v169, v248, v43
  v_dot2_f32_bf16 v44, v170, v64, v44
  v_dot2_f32_bf16 v45, v170, v248, v45
  v_dot2_f32_bf16 v46, v171, v64, v46
  v_dot2_f32_bf16 v47, v171, v248, v47
  s_waitcnt vmcnt(10)
  v_dot2_f32_bf16 v8, v172, v57, v8
  v_dot2_f32_bf16 v9, v172, v241, v9
  v_dot2_f32_bf16 v10, v173, v57, v10
  v_dot2_f32_bf16 v11, v173, v241, v11
  v_dot2_f32_bf16 v12, v174, v57, v12
  v_dot2_f32_bf16 v13, v174, v241, v13
  v_dot2_f32_bf16 v14, v175, v57, v14
  v_dot2_f32_bf16 v15, v175, v241, v15
  v_dot2_f32_bf16 v16, v176, v57, v16
  v_dot2_f32_bf16 v17, v176, v241, v17
  v_dot2_f32_bf16 v18, v177, v57, v18
  v_dot2_f32_bf16 v19, v177, v241, v19
  v_dot2_f32_bf16 v20, v178, v57, v20
  v_dot2_f32_bf16 v21, v178, v241, v21
  v_dot2_f32_bf16 v22, v179, v57, v22
  v_dot2_f32_bf16 v23, v179, v241, v23
  v_dot2_f32_bf16 v24, v180, v57, v24
  v_dot2_f32_bf16 v25, v180, v241, v25
  v_dot2_f32_bf16 v26, v181, v57, v26
  v_dot2_f32_bf16 v27, v181, v241, v27
  v_dot2_f32_bf16 v28, v182, v65, v28
  v_dot2_f32_bf16 v29, v182, v249, v29
  v_dot2_f32_bf16 v30, v183, v65, v30
  v_dot2_f32_bf16 v31, v183, v249, v31
  v_dot2_f32_bf16 v32, v184, v65, v32
  v_dot2_f32_bf16 v33, v184, v249, v33
  v_dot2_f32_bf16 v34, v185, v65, v34
  v_dot2_f32_bf16 v35, v185, v249, v35
  v_dot2_f32_bf16 v36, v186, v65, v36
  v_dot2_f32_bf16 v37, v186, v249, v37
  v_dot2_f32_bf16 v38, v187, v65, v38
  v_dot2_f32_bf16 v39, v187, v249, v39
  v_dot2_f32_bf16 v40, v188, v65, v40
  v_dot2_f32_bf16 v41, v188, v249, v41
  v_dot2_f32_bf16 v42, v189, v65, v42
  v_dot2_f32_bf16 v43, v189, v249, v43
  v_dot2_f32_bf16 v44, v190, v65, v44
  v_dot2_f32_bf16 v45, v190, v249, v45
  v_dot2_f32_bf16 v46, v191, v65, v46
  v_dot2_f32_bf16 v47, v191, v249, v47
  s_waitcnt vmcnt(5)
  v_dot2_f32_bf16 v8, v192, v58, v8
  v_dot2_f32_bf16 v9, v192, v242, v9
  v_dot2_f32_bf16 v10, v193, v58, v10
  v_dot2_f32_bf16 v11, v193, v242, v11
  v_dot2_f32_bf16 v12, v194, v58, v12
  v_dot2_f32_bf16 v13, v194, v242, v13
  v_dot2_f32_bf16 v14, v195, v58, v14
  v_dot2_f32_bf16 v15, v195, v242, v15
  v_dot2_f32_bf16 v16, v196, v58, v16
  v_dot2_f32_bf16 v17, v196, v242, v17
  v_dot2_f32_bf16 v18, v197, v58, v18
  v_dot2_f32_bf16 v19, v197, v242, v19
  v_dot2_f32_bf16 v20, v198, v58, v20
  v_dot2_f32_bf16 v21, v198, v242, v21
  v_dot2_f32_bf16 v22, v199, v58, v22
  v_dot2_f32_bf16 v23, v199, v242, v23
  v_dot2_f32_bf16 v24, v200, v58, v24
  v_dot2_f32_bf16 v25, v200, v242, v25
  v_dot2_f32_bf16 v26, v201, v58, v26
  v_dot2_f32_bf16 v27, v201, v242, v27
  v_dot2_f32_bf16 v28, v202, v66, v28
  v_dot2_f32_bf16 v29, v202, v250, v29
  v_dot2_f32_bf16 v30, v203, v66, v30
  v_dot2_f32_bf16 v31, v203, v250, v31
  v_dot2_f32_bf16 v32, v204, v66, v32
  v_dot2_f32_bf16 v33, v204, v250, v33
  v_dot2_f32_bf16 v34, v205, v66, v34
  v_dot2_f32_bf16 v35, v205, v250, v35
  v_dot2_f32_bf16 v36, v206, v66, v36
  v_dot2_f32_bf16 v37, v206, v250, v37
  v_dot2_f32_bf16 v38, v207, v66, v38
  v_dot2_f32_bf16 v39, v207, v250, v39
  v_dot2_f32_bf16 v40, v208, v66, v40
  v_dot2_f32_bf16 v41, v208, v250, v41
  v_dot2_f32_bf16 v42, v209, v66, v42
  v_dot2_f32_bf16 v43, v209, v250, v43
  v_dot2_f32_bf16 v44, v210, v66, v44
  v_dot2_f32_bf16 v45, v210, v250, v45
  v_dot2_f32_bf16 v46, v211, v66, v46
  v_dot2_f32_bf16 v47, v211, v250, v47
  s_waitcnt vmcnt(0)
  v_dot2_f32_bf16 v8, v212, v59, v8
  v_dot2_f32_bf16 v9, v212, v243, v9
  v_dot2_f32_bf16 v10, v213, v59, v10
  v_dot2_f32_bf16 v11, v213, v243, v11
  v_dot2_f32_bf16 v12, v214, v59, v12
  v_dot2_f32_bf16 v13, v214, v243, v13
  v_dot2_f32_bf16 v14, v215, v59, v14
  v_dot2_f32_bf16 v15, v215, v243, v15
  v_dot2_f32_bf16 v16, v216, v59, v16
  v_dot2_f32_bf16 v17, v216, v243, v17
  v_dot2_f32_bf16 v18, v217, v59, v18
  v_dot2_f32_bf16 v19, v217, v243, v19
  v_dot2_f32_bf16 v20, v218, v59, v20
  v_dot2_f32_bf16 v21, v218, v243, v21
  v_dot2_f32_bf16 v22, v219, v59, v22
  v_dot2_f32_bf16 v23, v219, v243, v23
  v_dot2_f32_bf16 v24, v220, v59, v24
  v_dot2_f32_bf16 v25, v220, v243, v25
  v_dot2_f32_bf16 v26, v221, v59, v26
  v_dot2_f32_bf16 v27, v221, v243, v27
  v_dot2_f32_bf16 v28, v222, v67, v28
  v_dot2_f32_bf16 v29, v222, v251, v29
  v_dot2_f32_bf16 v30, v223, v67, v30
  v_dot2_f32_bf16 v31, v223, v251, v31
  v_dot2_f32_bf16 v32, v224, v67, v32
  v_dot2_f32_bf16 v33, v224, v251, v33
  v_dot2_f32_bf16 v34, v225, v67, v34
  v_dot2_f32_bf16 v35, v225, v251, v35
  v_dot2_f32_bf16 v36, v226, v67, v36
  v_dot2_f32_bf16 v37, v226, v251, v37
  v_dot2_f32_bf16 v38, v227, v67, v38
  v_dot2_f32_bf16 v39, v227, v251, v39
  v_dot2_f32_bf16 v40, v228, v67, v40
  v_dot2_f32_bf16 v41, v228, v251, v41
  v_dot2_f32_bf16 v42, v229, v67, v42
  v_dot2_f32_bf16 v43, v229, v251, v43
  v_dot2_f32_bf16 v44, v230, v67, v44
  v_dot2_f32_bf16 v45, v230, v251, v45
  v_dot2_f32_bf16 v46, v231, v67, v46
  v_dot2_f32_bf16 v47, v231, v251, v47
  v_cvt_pk_bf16_f32 v72, v8, v9
  v_cvt_pk_bf16_f32 v73, v10, v11
  v_cvt_pk_bf16_f32 v74, v12, v13
  v_cvt_pk_bf16_f32 v75, v14, v15
  v_cvt_pk_bf16_f32 v76, v16, v17
  v_cvt_pk_bf16_f32 v77, v18, v19
  v_cvt_pk_bf16_f32 v78, v20, v21
  v_cvt_pk_bf16_f32 v79, v22, v23
  v_cvt_pk_bf16_f32 v80, v24, v25
  v_cvt_pk_bf16_f32 v81, v26, v27
  v_cvt_pk_bf16_f32 v82, v28, v29
  v_cvt_pk_bf16_f32 v83, v30, v31
  v_cvt_pk_bf16_f32 v84, v32, v33
  v_cvt_pk_bf16_f32 v85, v34, v35
  v_cvt_pk_bf16_f32 v86, v36, v37
  v_cvt_pk_bf16_f32 v87, v38, v39
  v_cvt_pk_bf16_f32 v88, v40, v41
  v_cvt_pk_bf16_f32 v89, v42, v43
  v_cvt_pk_bf16_f32 v90, v44, v45
  v_cvt_pk_bf16_f32 v91, v46, v47
  v_lshlrev_b32 v3, 8, v3
  v_lshl_add_u32 v3, v5, 4, v3
  v_add_u32 v3, 122880, v3
  ds_write_b128 v3, v[72:75] offset:0
  ds_write_b128 v3, v[76:79] offset:256
  ds_write_b128 v3, v[80:83] offset:512
  ds_write_b128 v3, v[84:87] offset:768
  ds_write_b128 v3, v[88:91] offset:1024
  s_waitcnt lgkmcnt(0)
  s_barrier
  v_lshlrev_b32 v13, 4, v0
  v_add_u32 v13, 122880, v13
  ds_read_b128 v[20:23], v13 offset:0
  ds_read_b128 v[24:27], v13 offset:1024
  ds_read_b128 v[28:31], v13 offset:2048
  ds_read_b128 v[32:35], v13 offset:3072
  ds_read_b128 v[36:39], v13 offset:4096
  ds_read_b128 v[40:43], v13 offset:5120
  ds_read_b128 v[44:47], v13 offset:6144
  ds_read_b128 v[48:51], v13 offset:7168
  ds_read_b128 v[52:55], v13 offset:8192
  ds_read_b128 v[56:59], v13 offset:9216
  ds_read_b128 v[60:63], v13 offset:10240
  ds_read_b128 v[64:67], v13 offset:11264
  s_waitcnt lgkmcnt(4)
  ds_read_b128 v[68:71], v13 offset:12288
  ds_read_b128 v[72:75], v13 offset:13312
  ds_read_b128 v[76:79], v13 offset:14336
  ds_read_b128 v[80:83], v13 offset:15360
  ds_read_b128 v[84:87], v13 offset:16384
  ds_read_b128 v[88:91], v13 offset:17408
  ds_read_b128 v[92:95], v13 offset:18432
  ds_read_b128 v[96:99], v13 offset:19456
  s_mov_b32 s4, s20
  s_mov_b32 s5, s21
  s_mov_b32 s6, 819200
  s_mov_b32 s7, 0x20000
  s_mov_b32 s12, s36
  s_mov_b32 s13, s37
  s_mov_b32 s14, 5242880
  s_mov_b32 s15, 0x20000
  v_mul_u32_u24 v12, 2560, v6
  v_lshrrev_b32 v14, 4, v0
  v_lshl_add_u32 v12, v14, 3, v12
  s_lshl_b32 s46, s42, 5
  v_add_u32 v12, s46, v12
  s_mov_b32 s66, 0
  s_waitcnt lgkmcnt(0)
  v_lshrrev_b32 v13, 3, v0
  v_lshrrev_b32 v14, 2, v13
  v_lshlrev_b32 v14, 3, v14
  v_and_b32 v8, 3, v13
  v_add_u32 v8, v8, v14
  s_and_b32 s46, s42, 1
  s_lshl_b32 s46, s46, 2
  s_lshr_b32 s47, s42, 1
  s_lshl_b32 s47, s47, 4
  s_add_u32 s46, s46, s47
  v_add_u32 v8, s46, v8
  v_mul_u32_u24 v8, 1280, v8
  v_lshrrev_b32 v13, 1, v13
  v_bfe_u32 v14, v0, 1, 2
  v_xor_b32 v13, v13, v14
  v_lshlrev_b32 v13, 5, v13
  v_and_b32 v14, 1, v0
  v_lshlrev_b32 v14, 4, v14
  v_add3_u32 v8, v8, v13, v14
  v_lshrrev_b32 v13, 5, v0
  v_lshlrev_b32 v9, 11, v13
  v_bfe_u32 v13, v0, 2, 3
  v_lshl_add_u32 v9, v13, 7, v9
  v_lshrrev_b32 v13, 1, v13
  v_xor_b32 v13, s42, v13
  v_lshl_add_u32 v9, v13, 5, v9
  v_and_b32 v13, 3, v0
  v_lshl_add_u32 v9, v13, 3, v9
  v_add_u32 v10, 0x10000, v9
  v_add_u32 v11, 0x20000, v9
  s_add_u32 m0, s51, 0
  s_add_u32 s46, s66, 0
  buffer_load_dwordx4 v8, s[4:7], s46 offen lds
  s_add_u32 m0, s51, 4096
  s_add_u32 s46, s66, 128
  buffer_load_dwordx4 v8, s[4:7], s46 offen lds
  s_add_u32 m0, s51, 8192
  s_add_u32 s46, s66, 256
  buffer_load_dwordx4 v8, s[4:7], s46 offen lds
  s_add_u32 m0, s51, 12288
  s_add_u32 s46, s66, 384
  buffer_load_dwordx4 v8, s[4:7], s46 offen lds
  s_add_u32 m0, s51, 16384
  s_add_u32 s46, s66, 512
  buffer_load_dwordx4 v8, s[4:7], s46 offen lds
  s_add_u32 m0, s51, 20480
  s_add_u32 s46, s66, 640
  buffer_load_dwordx4 v8, s[4:7], s46 offen lds
  s_add_u32 m0, s51, 24576
  s_add_u32 s46, s66, 768
  buffer_load_dwordx4 v8, s[4:7], s46 offen lds
  s_add_u32 m0, s51, 28672
  s_add_u32 s46, s66, 896
  buffer_load_dwordx4 v8, s[4:7], s46 offen lds
  s_add_u32 m0, s51, 32768
  s_add_u32 s46, s66, 1024
  buffer_load_dwordx4 v8, s[4:7], s46 offen lds
  s_add_u32 m0, s51, 36864
  s_add_u32 s46, s66, 1152
  buffer_load_dwordx4 v8, s[4:7], s46 offen lds
  s_add_u32 m0, s51, 40960
  s_add_u32 s46, s66, 40960
  buffer_load_dwordx4 v8, s[4:7], s46 offen lds
  s_add_u32 m0, s51, 45056
  s_add_u32 s46, s66, 41088
  buffer_load_dwordx4 v8, s[4:7], s46 offen lds
  s_add_u32 m0, s51, 49152
  s_add_u32 s46, s66, 41216
  buffer_load_dwordx4 v8, s[4:7], s46 offen lds
  s_add_u32 m0, s51, 53248
  s_add_u32 s46, s66, 41344
  buffer_load_dwordx4 v8, s[4:7], s46 offen lds
  s_add_u32 m0, s51, 57344
  s_add_u32 s46, s66, 41472
  buffer_load_dwordx4 v8, s[4:7], s46 offen lds
  s_add_u32 m0, s51, 61440
  s_add_u32 s46, s66, 41600
  buffer_load_dwordx4 v8, s[4:7], s46 offen lds
  s_add_u32 m0, s51, 65536
  s_add_u32 s46, s66, 41728
  buffer_load_dwordx4 v8, s[4:7], s46 offen lds
  s_add_u32 m0, s51, 69632
  s_add_u32 s46, s66, 41856
  buffer_load_dwordx4 v8, s[4:7], s46 offen lds
  s_add_u32 m0, s51, 73728
  s_add_u32 s46, s66, 41984
  buffer_load_dwordx4 v8, s[4:7], s46 offen lds
  s_add_u32 m0, s51, 77824
  s_add_u32 s46, s66, 42112
  buffer_load_dwordx4 v8, s[4:7], s46 offen lds
  s_add_u32 m0, s51, 81920
  s_add_u32 s46, s66, 81920
  buffer_load_dwordx4 v8, s[4:7], s46 offen lds
  s_add_u32 m0, s51, 86016
  s_add_u32 s46, s66, 82048
  buffer_load_dwordx4 v8, s[4:7], s46 offen lds
  s_add_u32 m0, s51, 90112
  s_add_u32 s46, s66, 82176
  buffer_load_dwordx4 v8, s[4:7], s46 offen lds
  s_add_u32 m0, s51, 94208
  s_add_u32 s46, s66, 82304
  buffer_load_dwordx4 v8, s[4:7], s46 offen lds
  s_add_u32 m0, s51, 98304
  s_add_u32 s46, s66, 82432
  buffer_load_dwordx4 v8, s[4:7], s46 offen lds
  s_waitcnt vmcnt(20)
  s_barrier
  s_add_u32 m0, s51, 102400
  s_add_u32 s46, s66, 82560
  buffer_load_dwordx4 v8, s[4:7], s46 offen lds
  s_add_u32 m0, s51, 106496
  s_add_u32 s46, s66, 82688
  buffer_load_dwordx4 v8, s[4:7], s46 offen lds
  s_add_u32 m0, s51, 110592
  s_add_u32 s46, s66, 82816
  buffer_load_dwordx4 v8, s[4:7], s46 offen lds
  s_add_u32 m0, s51, 114688
  s_add_u32 s46, s66, 82944
  buffer_load_dwordx4 v8, s[4:7], s46 offen lds
  s_add_u32 m0, s51, 118784
  s_add_u32 s46, s66, 83072
  buffer_load_dwordx4 v8, s[4:7], s46 offen lds
  ds_read_b64_tr_b16 v[100:101], v9 offset:0
  ds_read_b64_tr_b16 v[102:103], v9 offset:1024
  ds_read_b64_tr_b16 v[104:105], v9 offset:4096
  ds_read_b64_tr_b16 v[106:107], v9 offset:5120
  ds_read_b64_tr_b16 v[108:109], v9 offset:8192
  ds_read_b64_tr_b16 v[110:111], v9 offset:9216
  ds_read_b64_tr_b16 v[112:113], v9 offset:12288
  ds_read_b64_tr_b16 v[114:115], v9 offset:13312
  ds_read_b64_tr_b16 v[116:117], v9 offset:16384
  ds_read_b64_tr_b16 v[118:119], v9 offset:17408
  s_waitcnt lgkmcnt(0)
  v_mfma_f32_16x16x32_bf16 v[140:143], v[100:103], v[20:23], 0
  v_mfma_f32_16x16x32_bf16 v[144:147], v[104:107], v[20:23], 0
  v_mfma_f32_16x16x32_bf16 v[148:151], v[108:111], v[20:23], 0
  v_mfma_f32_16x16x32_bf16 v[152:155], v[112:115], v[20:23], 0
  v_mfma_f32_16x16x32_bf16 v[156:159], v[116:119], v[20:23], 0
  s_waitcnt vmcnt(20)
  s_barrier
  s_add_u32 m0, s51, 0
  s_add_u32 s46, s66, 122880
  buffer_load_dwordx4 v8, s[4:7], s46 offen lds
  s_add_u32 m0, s51, 4096
  s_add_u32 s46, s66, 123008
  buffer_load_dwordx4 v8, s[4:7], s46 offen lds
  s_add_u32 m0, s51, 8192
  s_add_u32 s46, s66, 123136
  buffer_load_dwordx4 v8, s[4:7], s46 offen lds
  s_add_u32 m0, s51, 12288
  s_add_u32 s46, s66, 123264
  buffer_load_dwordx4 v8, s[4:7], s46 offen lds
  s_add_u32 m0, s51, 16384
  s_add_u32 s46, s66, 123392
  buffer_load_dwordx4 v8, s[4:7], s46 offen lds
  ds_read_b64_tr_b16 v[120:121], v9 offset:20480
  ds_read_b64_tr_b16 v[122:123], v9 offset:21504
  ds_read_b64_tr_b16 v[124:125], v9 offset:24576
  ds_read_b64_tr_b16 v[126:127], v9 offset:25600
  ds_read_b64_tr_b16 v[128:129], v9 offset:28672
  ds_read_b64_tr_b16 v[130:131], v9 offset:29696
  ds_read_b64_tr_b16 v[132:133], v9 offset:32768
  ds_read_b64_tr_b16 v[134:135], v9 offset:33792
  ds_read_b64_tr_b16 v[136:137], v9 offset:36864
  ds_read_b64_tr_b16 v[138:139], v9 offset:37888
  s_waitcnt lgkmcnt(0)
  v_mfma_f32_16x16x32_bf16 v[160:163], v[120:123], v[20:23], 0
  v_mfma_f32_16x16x32_bf16 v[164:167], v[124:127], v[20:23], 0
  v_mfma_f32_16x16x32_bf16 v[168:171], v[128:131], v[20:23], 0
  v_mfma_f32_16x16x32_bf16 v[172:175], v[132:135], v[20:23], 0
  v_mfma_f32_16x16x32_bf16 v[176:179], v[136:139], v[20:23], 0
  s_waitcnt vmcnt(20)
  s_barrier
  s_add_u32 m0, s51, 20480
  s_add_u32 s46, s66, 123520
  buffer_load_dwordx4 v8, s[4:7], s46 offen lds
  s_add_u32 m0, s51, 24576
  s_add_u32 s46, s66, 123648
  buffer_load_dwordx4 v8, s[4:7], s46 offen lds
  s_add_u32 m0, s51, 28672
  s_add_u32 s46, s66, 123776
  buffer_load_dwordx4 v8, s[4:7], s46 offen lds
  s_add_u32 m0, s51, 32768
  s_add_u32 s46, s66, 123904
  buffer_load_dwordx4 v8, s[4:7], s46 offen lds
  s_add_u32 m0, s51, 36864
  s_add_u32 s46, s66, 124032
  buffer_load_dwordx4 v8, s[4:7], s46 offen lds
  ds_read_b64_tr_b16 v[100:101], v9 offset:40960
  ds_read_b64_tr_b16 v[102:103], v9 offset:41984
  ds_read_b64_tr_b16 v[104:105], v9 offset:45056
  ds_read_b64_tr_b16 v[106:107], v9 offset:46080
  ds_read_b64_tr_b16 v[108:109], v9 offset:49152
  ds_read_b64_tr_b16 v[110:111], v9 offset:50176
  ds_read_b64_tr_b16 v[112:113], v9 offset:53248
  ds_read_b64_tr_b16 v[114:115], v9 offset:54272
  ds_read_b64_tr_b16 v[116:117], v9 offset:57344
  ds_read_b64_tr_b16 v[118:119], v9 offset:58368
  s_waitcnt lgkmcnt(0)
  v_mfma_f32_16x16x32_bf16 v[140:143], v[100:103], v[24:27], v[140:143]
  v_mfma_f32_16x16x32_bf16 v[144:147], v[104:107], v[24:27], v[144:147]
  v_mfma_f32_16x16x32_bf16 v[148:151], v[108:111], v[24:27], v[148:151]
  v_mfma_f32_16x16x32_bf16 v[152:155], v[112:115], v[24:27], v[152:155]
  v_mfma_f32_16x16x32_bf16 v[156:159], v[116:119], v[24:27], v[156:159]
  s_waitcnt vmcnt(20)
  s_barrier
  s_add_u32 m0, s51, 40960
  s_add_u32 s46, s66, 163840
  buffer_load_dwordx4 v8, s[4:7], s46 offen lds
  s_add_u32 m0, s51, 45056
  s_add_u32 s46, s66, 163968
  buffer_load_dwordx4 v8, s[4:7], s46 offen lds
  s_add_u32 m0, s51, 49152
  s_add_u32 s46, s66, 164096
  buffer_load_dwordx4 v8, s[4:7], s46 offen lds
  s_add_u32 m0, s51, 53248
  s_add_u32 s46, s66, 164224
  buffer_load_dwordx4 v8, s[4:7], s46 offen lds
  s_add_u32 m0, s51, 57344
  s_add_u32 s46, s66, 164352
  buffer_load_dwordx4 v8, s[4:7], s46 offen lds
  ds_read_b64_tr_b16 v[120:121], v9 offset:61440
  ds_read_b64_tr_b16 v[122:123], v9 offset:62464
  ds_read_b64_tr_b16 v[124:125], v10 offset:0
  ds_read_b64_tr_b16 v[126:127], v10 offset:1024
  ds_read_b64_tr_b16 v[128:129], v10 offset:4096
  ds_read_b64_tr_b16 v[130:131], v10 offset:5120
  ds_read_b64_tr_b16 v[132:133], v10 offset:8192
  ds_read_b64_tr_b16 v[134:135], v10 offset:9216
  ds_read_b64_tr_b16 v[136:137], v10 offset:12288
  ds_read_b64_tr_b16 v[138:139], v10 offset:13312
  s_waitcnt lgkmcnt(0)
  v_mfma_f32_16x16x32_bf16 v[160:163], v[120:123], v[24:27], v[160:163]
  v_mfma_f32_16x16x32_bf16 v[164:167], v[124:127], v[24:27], v[164:167]
  v_mfma_f32_16x16x32_bf16 v[168:171], v[128:131], v[24:27], v[168:171]
  v_mfma_f32_16x16x32_bf16 v[172:175], v[132:135], v[24:27], v[172:175]
  v_mfma_f32_16x16x32_bf16 v[176:179], v[136:139], v[24:27], v[176:179]
  s_waitcnt vmcnt(20)
  s_barrier
  s_add_u32 m0, s51, 61440
  s_add_u32 s46, s66, 164480
  buffer_load_dwordx4 v8, s[4:7], s46 offen lds
  s_add_u32 m0, s51, 65536
  s_add_u32 s46, s66, 164608
  buffer_load_dwordx4 v8, s[4:7], s46 offen lds
  s_add_u32 m0, s51, 69632
  s_add_u32 s46, s66, 164736
  buffer_load_dwordx4 v8, s[4:7], s46 offen lds
  s_add_u32 m0, s51, 73728
  s_add_u32 s46, s66, 164864
  buffer_load_dwordx4 v8, s[4:7], s46 offen lds
  s_add_u32 m0, s51, 77824
  s_add_u32 s46, s66, 164992
  buffer_load_dwordx4 v8, s[4:7], s46 offen lds
  ds_read_b64_tr_b16 v[100:101], v10 offset:16384
  ds_read_b64_tr_b16 v[102:103], v10 offset:17408
  ds_read_b64_tr_b16 v[104:105], v10 offset:20480
  ds_read_b64_tr_b16 v[106:107], v10 offset:21504
  ds_read_b64_tr_b16 v[108:109], v10 offset:24576
  ds_read_b64_tr_b16 v[110:111], v10 offset:25600
  ds_read_b64_tr_b16 v[112:113], v10 offset:28672
  ds_read_b64_tr_b16 v[114:115], v10 offset:29696
  ds_read_b64_tr_b16 v[116:117], v10 offset:32768
  ds_read_b64_tr_b16 v[118:119], v10 offset:33792
  s_waitcnt lgkmcnt(0)
  v_mfma_f32_16x16x32_bf16 v[140:143], v[100:103], v[28:31], v[140:143]
  v_mfma_f32_16x16x32_bf16 v[144:147], v[104:107], v[28:31], v[144:147]
  v_mfma_f32_16x16x32_bf16 v[148:151], v[108:111], v[28:31], v[148:151]
  v_mfma_f32_16x16x32_bf16 v[152:155], v[112:115], v[28:31], v[152:155]
  v_mfma_f32_16x16x32_bf16 v[156:159], v[116:119], v[28:31], v[156:159]
  s_waitcnt vmcnt(20)
  s_barrier
  s_add_u32 m0, s51, 81920
  s_add_u32 s46, s66, 204800
  buffer_load_dwordx4 v8, s[4:7], s46 offen lds
  s_add_u32 m0, s51, 86016
  s_add_u32 s46, s66, 204928
  buffer_load_dwordx4 v8, s[4:7], s46 offen lds
  s_add_u32 m0, s51, 90112
  s_add_u32 s46, s66, 205056
  buffer_load_dwordx4 v8, s[4:7], s46 offen lds
  s_add_u32 m0, s51, 94208
  s_add_u32 s46, s66, 205184
  buffer_load_dwordx4 v8, s[4:7], s46 offen lds
  s_add_u32 m0, s51, 98304
  s_add_u32 s46, s66, 205312
  buffer_load_dwordx4 v8, s[4:7], s46 offen lds
  ds_read_b64_tr_b16 v[120:121], v10 offset:36864
  ds_read_b64_tr_b16 v[122:123], v10 offset:37888
  ds_read_b64_tr_b16 v[124:125], v10 offset:40960
  ds_read_b64_tr_b16 v[126:127], v10 offset:41984
  ds_read_b64_tr_b16 v[128:129], v10 offset:45056
  ds_read_b64_tr_b16 v[130:131], v10 offset:46080
  ds_read_b64_tr_b16 v[132:133], v10 offset:49152
  ds_read_b64_tr_b16 v[134:135], v10 offset:50176
  ds_read_b64_tr_b16 v[136:137], v10 offset:53248
  ds_read_b64_tr_b16 v[138:139], v10 offset:54272
  s_waitcnt lgkmcnt(0)
  v_mfma_f32_16x16x32_bf16 v[160:163], v[120:123], v[28:31], v[160:163]
  v_mfma_f32_16x16x32_bf16 v[164:167], v[124:127], v[28:31], v[164:167]
  v_mfma_f32_16x16x32_bf16 v[168:171], v[128:131], v[28:31], v[168:171]
  v_mfma_f32_16x16x32_bf16 v[172:175], v[132:135], v[28:31], v[172:175]
  v_mfma_f32_16x16x32_bf16 v[176:179], v[136:139], v[28:31], v[176:179]
  s_waitcnt vmcnt(20)
  s_barrier
  s_add_u32 m0, s51, 102400
  s_add_u32 s46, s66, 205440
  buffer_load_dwordx4 v8, s[4:7], s46 offen lds
  s_add_u32 m0, s51, 106496
  s_add_u32 s46, s66, 205568
  buffer_load_dwordx4 v8, s[4:7], s46 offen lds
  s_add_u32 m0, s51, 110592
  s_add_u32 s46, s66, 205696
  buffer_load_dwordx4 v8, s[4:7], s46 offen lds
  s_add_u32 m0, s51, 114688
  s_add_u32 s46, s66, 205824
  buffer_load_dwordx4 v8, s[4:7], s46 offen lds
  s_add_u32 m0, s51, 118784
  s_add_u32 s46, s66, 205952
  buffer_load_dwordx4 v8, s[4:7], s46 offen lds
  ds_read_b64_tr_b16 v[100:101], v9 offset:0
  ds_read_b64_tr_b16 v[102:103], v9 offset:1024
  ds_read_b64_tr_b16 v[104:105], v9 offset:4096
  ds_read_b64_tr_b16 v[106:107], v9 offset:5120
  ds_read_b64_tr_b16 v[108:109], v9 offset:8192
  ds_read_b64_tr_b16 v[110:111], v9 offset:9216
  ds_read_b64_tr_b16 v[112:113], v9 offset:12288
  ds_read_b64_tr_b16 v[114:115], v9 offset:13312
  ds_read_b64_tr_b16 v[116:117], v9 offset:16384
  ds_read_b64_tr_b16 v[118:119], v9 offset:17408
  s_waitcnt lgkmcnt(0)
  v_mfma_f32_16x16x32_bf16 v[140:143], v[100:103], v[32:35], v[140:143]
  v_mfma_f32_16x16x32_bf16 v[144:147], v[104:107], v[32:35], v[144:147]
  v_mfma_f32_16x16x32_bf16 v[148:151], v[108:111], v[32:35], v[148:151]
  v_mfma_f32_16x16x32_bf16 v[152:155], v[112:115], v[32:35], v[152:155]
  v_mfma_f32_16x16x32_bf16 v[156:159], v[116:119], v[32:35], v[156:159]
  s_waitcnt vmcnt(20)
  s_barrier
  s_add_u32 m0, s51, 0
  s_add_u32 s46, s66, 245760
  buffer_load_dwordx4 v8, s[4:7], s46 offen lds
  s_add_u32 m0, s51, 4096
  s_add_u32 s46, s66, 245888
  buffer_load_dwordx4 v8, s[4:7], s46 offen lds
  s_add_u32 m0, s51, 8192
  s_add_u32 s46, s66, 246016
  buffer_load_dwordx4 v8, s[4:7], s46 offen lds
  s_add_u32 m0, s51, 12288
  s_add_u32 s46, s66, 246144
  buffer_load_dwordx4 v8, s[4:7], s46 offen lds
  s_add_u32 m0, s51, 16384
  s_add_u32 s46, s66, 246272
  buffer_load_dwordx4 v8, s[4:7], s46 offen lds
  ds_read_b64_tr_b16 v[120:121], v9 offset:20480
  ds_read_b64_tr_b16 v[122:123], v9 offset:21504
  ds_read_b64_tr_b16 v[124:125], v9 offset:24576
  ds_read_b64_tr_b16 v[126:127], v9 offset:25600
  ds_read_b64_tr_b16 v[128:129], v9 offset:28672
  ds_read_b64_tr_b16 v[130:131], v9 offset:29696
  ds_read_b64_tr_b16 v[132:133], v9 offset:32768
  ds_read_b64_tr_b16 v[134:135], v9 offset:33792
  ds_read_b64_tr_b16 v[136:137], v9 offset:36864
  ds_read_b64_tr_b16 v[138:139], v9 offset:37888
  s_waitcnt lgkmcnt(0)
  v_mfma_f32_16x16x32_bf16 v[160:163], v[120:123], v[32:35], v[160:163]
  v_mfma_f32_16x16x32_bf16 v[164:167], v[124:127], v[32:35], v[164:167]
  v_mfma_f32_16x16x32_bf16 v[168:171], v[128:131], v[32:35], v[168:171]
  v_mfma_f32_16x16x32_bf16 v[172:175], v[132:135], v[32:35], v[172:175]
  v_mfma_f32_16x16x32_bf16 v[176:179], v[136:139], v[32:35], v[176:179]
  s_waitcnt vmcnt(20)
  s_barrier
  s_add_u32 m0, s51, 20480
  s_add_u32 s46, s66, 246400
  buffer_load_dwordx4 v8, s[4:7], s46 offen lds
  s_add_u32 m0, s51, 24576
  s_add_u32 s46, s66, 246528
  buffer_load_dwordx4 v8, s[4:7], s46 offen lds
  s_add_u32 m0, s51, 28672
  s_add_u32 s46, s66, 246656
  buffer_load_dwordx4 v8, s[4:7], s46 offen lds
  s_add_u32 m0, s51, 32768
  s_add_u32 s46, s66, 246784
  buffer_load_dwordx4 v8, s[4:7], s46 offen lds
  s_add_u32 m0, s51, 36864
  s_add_u32 s46, s66, 246912
  buffer_load_dwordx4 v8, s[4:7], s46 offen lds
  ds_read_b64_tr_b16 v[100:101], v9 offset:40960
  ds_read_b64_tr_b16 v[102:103], v9 offset:41984
  ds_read_b64_tr_b16 v[104:105], v9 offset:45056
  ds_read_b64_tr_b16 v[106:107], v9 offset:46080
  ds_read_b64_tr_b16 v[108:109], v9 offset:49152
  ds_read_b64_tr_b16 v[110:111], v9 offset:50176
  ds_read_b64_tr_b16 v[112:113], v9 offset:53248
  ds_read_b64_tr_b16 v[114:115], v9 offset:54272
  ds_read_b64_tr_b16 v[116:117], v9 offset:57344
  ds_read_b64_tr_b16 v[118:119], v9 offset:58368
  s_waitcnt lgkmcnt(0)
  v_mfma_f32_16x16x32_bf16 v[140:143], v[100:103], v[36:39], v[140:143]
  v_mfma_f32_16x16x32_bf16 v[144:147], v[104:107], v[36:39], v[144:147]
  v_mfma_f32_16x16x32_bf16 v[148:151], v[108:111], v[36:39], v[148:151]
  v_mfma_f32_16x16x32_bf16 v[152:155], v[112:115], v[36:39], v[152:155]
  v_mfma_f32_16x16x32_bf16 v[156:159], v[116:119], v[36:39], v[156:159]
  s_waitcnt vmcnt(20)
  s_barrier
  s_add_u32 m0, s51, 40960
  s_add_u32 s46, s66, 286720
  buffer_load_dwordx4 v8, s[4:7], s46 offen lds
  s_add_u32 m0, s51, 45056
  s_add_u32 s46, s66, 286848
  buffer_load_dwordx4 v8, s[4:7], s46 offen lds
  s_add_u32 m0, s51, 49152
  s_add_u32 s46, s66, 286976
  buffer_load_dwordx4 v8, s[4:7], s46 offen lds
  s_add_u32 m0, s51, 53248
  s_add_u32 s46, s66, 287104
  buffer_load_dwordx4 v8, s[4:7], s46 offen lds
  s_add_u32 m0, s51, 57344
  s_add_u32 s46, s66, 287232
  buffer_load_dwordx4 v8, s[4:7], s46 offen lds
  ds_read_b64_tr_b16 v[120:121], v9 offset:61440
  ds_read_b64_tr_b16 v[122:123], v9 offset:62464
  ds_read_b64_tr_b16 v[124:125], v10 offset:0
  ds_read_b64_tr_b16 v[126:127], v10 offset:1024
  ds_read_b64_tr_b16 v[128:129], v10 offset:4096
  ds_read_b64_tr_b16 v[130:131], v10 offset:5120
  ds_read_b64_tr_b16 v[132:133], v10 offset:8192
  ds_read_b64_tr_b16 v[134:135], v10 offset:9216
  ds_read_b64_tr_b16 v[136:137], v10 offset:12288
  ds_read_b64_tr_b16 v[138:139], v10 offset:13312
  s_waitcnt lgkmcnt(0)
  v_mfma_f32_16x16x32_bf16 v[160:163], v[120:123], v[36:39], v[160:163]
  v_mfma_f32_16x16x32_bf16 v[164:167], v[124:127], v[36:39], v[164:167]
  v_mfma_f32_16x16x32_bf16 v[168:171], v[128:131], v[36:39], v[168:171]
  v_mfma_f32_16x16x32_bf16 v[172:175], v[132:135], v[36:39], v[172:175]
  v_mfma_f32_16x16x32_bf16 v[176:179], v[136:139], v[36:39], v[176:179]
  s_waitcnt vmcnt(20)
  s_barrier
  s_add_u32 m0, s51, 61440
  s_add_u32 s46, s66, 287360
  buffer_load_dwordx4 v8, s[4:7], s46 offen lds
  s_add_u32 m0, s51, 65536
  s_add_u32 s46, s66, 287488
  buffer_load_dwordx4 v8, s[4:7], s46 offen lds
  s_add_u32 m0, s51, 69632
  s_add_u32 s46, s66, 287616
  buffer_load_dwordx4 v8, s[4:7], s46 offen lds
  s_add_u32 m0, s51, 73728
  s_add_u32 s46, s66, 287744
  buffer_load_dwordx4 v8, s[4:7], s46 offen lds
  s_add_u32 m0, s51, 77824
  s_add_u32 s46, s66, 287872
  buffer_load_dwordx4 v8, s[4:7], s46 offen lds
  ds_read_b64_tr_b16 v[100:101], v10 offset:16384
  ds_read_b64_tr_b16 v[102:103], v10 offset:17408
  ds_read_b64_tr_b16 v[104:105], v10 offset:20480
  ds_read_b64_tr_b16 v[106:107], v10 offset:21504
  ds_read_b64_tr_b16 v[108:109], v10 offset:24576
  ds_read_b64_tr_b16 v[110:111], v10 offset:25600
  ds_read_b64_tr_b16 v[112:113], v10 offset:28672
  ds_read_b64_tr_b16 v[114:115], v10 offset:29696
  ds_read_b64_tr_b16 v[116:117], v10 offset:32768
  ds_read_b64_tr_b16 v[118:119], v10 offset:33792
  s_waitcnt lgkmcnt(0)
  v_mfma_f32_16x16x32_bf16 v[140:143], v[100:103], v[40:43], v[140:143]
  v_mfma_f32_16x16x32_bf16 v[144:147], v[104:107], v[40:43], v[144:147]
  v_mfma_f32_16x16x32_bf16 v[148:151], v[108:111], v[40:43], v[148:151]
  v_mfma_f32_16x16x32_bf16 v[152:155], v[112:115], v[40:43], v[152:155]
  v_mfma_f32_16x16x32_bf16 v[156:159], v[116:119], v[40:43], v[156:159]
  s_waitcnt vmcnt(20)
  s_barrier
  s_add_u32 m0, s51, 81920
  s_add_u32 s46, s66, 327680
  buffer_load_dwordx4 v8, s[4:7], s46 offen lds
  s_add_u32 m0, s51, 86016
  s_add_u32 s46, s66, 327808
  buffer_load_dwordx4 v8, s[4:7], s46 offen lds
  s_add_u32 m0, s51, 90112
  s_add_u32 s46, s66, 327936
  buffer_load_dwordx4 v8, s[4:7], s46 offen lds
  s_add_u32 m0, s51, 94208
  s_add_u32 s46, s66, 328064
  buffer_load_dwordx4 v8, s[4:7], s46 offen lds
  s_add_u32 m0, s51, 98304
  s_add_u32 s46, s66, 328192
  buffer_load_dwordx4 v8, s[4:7], s46 offen lds
  ds_read_b64_tr_b16 v[120:121], v10 offset:36864
  ds_read_b64_tr_b16 v[122:123], v10 offset:37888
  ds_read_b64_tr_b16 v[124:125], v10 offset:40960
  ds_read_b64_tr_b16 v[126:127], v10 offset:41984
  ds_read_b64_tr_b16 v[128:129], v10 offset:45056
  ds_read_b64_tr_b16 v[130:131], v10 offset:46080
  ds_read_b64_tr_b16 v[132:133], v10 offset:49152
  ds_read_b64_tr_b16 v[134:135], v10 offset:50176
  ds_read_b64_tr_b16 v[136:137], v10 offset:53248
  ds_read_b64_tr_b16 v[138:139], v10 offset:54272
  s_waitcnt lgkmcnt(0)
  v_mfma_f32_16x16x32_bf16 v[160:163], v[120:123], v[40:43], v[160:163]
  v_mfma_f32_16x16x32_bf16 v[164:167], v[124:127], v[40:43], v[164:167]
  v_mfma_f32_16x16x32_bf16 v[168:171], v[128:131], v[40:43], v[168:171]
  v_mfma_f32_16x16x32_bf16 v[172:175], v[132:135], v[40:43], v[172:175]
  v_mfma_f32_16x16x32_bf16 v[176:179], v[136:139], v[40:43], v[176:179]
  s_waitcnt vmcnt(20)
  s_barrier
  s_add_u32 m0, s51, 102400
  s_add_u32 s46, s66, 328320
  buffer_load_dwordx4 v8, s[4:7], s46 offen lds
  s_add_u32 m0, s51, 106496
  s_add_u32 s46, s66, 328448
  buffer_load_dwordx4 v8, s[4:7], s46 offen lds
  s_add_u32 m0, s51, 110592
  s_add_u32 s46, s66, 328576
  buffer_load_dwordx4 v8, s[4:7], s46 offen lds
  s_add_u32 m0, s51, 114688
  s_add_u32 s46, s66, 328704
  buffer_load_dwordx4 v8, s[4:7], s46 offen lds
  s_add_u32 m0, s51, 118784
  s_add_u32 s46, s66, 328832
  buffer_load_dwordx4 v8, s[4:7], s46 offen lds
  ds_read_b64_tr_b16 v[100:101], v9 offset:0
  ds_read_b64_tr_b16 v[102:103], v9 offset:1024
  ds_read_b64_tr_b16 v[104:105], v9 offset:4096
  ds_read_b64_tr_b16 v[106:107], v9 offset:5120
  ds_read_b64_tr_b16 v[108:109], v9 offset:8192
  ds_read_b64_tr_b16 v[110:111], v9 offset:9216
  ds_read_b64_tr_b16 v[112:113], v9 offset:12288
  ds_read_b64_tr_b16 v[114:115], v9 offset:13312
  ds_read_b64_tr_b16 v[116:117], v9 offset:16384
  ds_read_b64_tr_b16 v[118:119], v9 offset:17408
  s_waitcnt lgkmcnt(0)
  v_mfma_f32_16x16x32_bf16 v[140:143], v[100:103], v[44:47], v[140:143]
  v_mfma_f32_16x16x32_bf16 v[144:147], v[104:107], v[44:47], v[144:147]
  v_mfma_f32_16x16x32_bf16 v[148:151], v[108:111], v[44:47], v[148:151]
  v_mfma_f32_16x16x32_bf16 v[152:155], v[112:115], v[44:47], v[152:155]
  v_mfma_f32_16x16x32_bf16 v[156:159], v[116:119], v[44:47], v[156:159]
  s_waitcnt vmcnt(20)
  s_barrier
  s_add_u32 m0, s51, 0
  s_add_u32 s46, s66, 368640
  buffer_load_dwordx4 v8, s[4:7], s46 offen lds
  s_add_u32 m0, s51, 4096
  s_add_u32 s46, s66, 368768
  buffer_load_dwordx4 v8, s[4:7], s46 offen lds
  s_add_u32 m0, s51, 8192
  s_add_u32 s46, s66, 368896
  buffer_load_dwordx4 v8, s[4:7], s46 offen lds
  s_add_u32 m0, s51, 12288
  s_add_u32 s46, s66, 369024
  buffer_load_dwordx4 v8, s[4:7], s46 offen lds
  s_add_u32 m0, s51, 16384
  s_add_u32 s46, s66, 369152
  buffer_load_dwordx4 v8, s[4:7], s46 offen lds
  ds_read_b64_tr_b16 v[120:121], v9 offset:20480
  ds_read_b64_tr_b16 v[122:123], v9 offset:21504
  ds_read_b64_tr_b16 v[124:125], v9 offset:24576
  ds_read_b64_tr_b16 v[126:127], v9 offset:25600
  ds_read_b64_tr_b16 v[128:129], v9 offset:28672
  ds_read_b64_tr_b16 v[130:131], v9 offset:29696
  ds_read_b64_tr_b16 v[132:133], v9 offset:32768
  ds_read_b64_tr_b16 v[134:135], v9 offset:33792
  ds_read_b64_tr_b16 v[136:137], v9 offset:36864
  ds_read_b64_tr_b16 v[138:139], v9 offset:37888
  s_waitcnt lgkmcnt(0)
  v_mfma_f32_16x16x32_bf16 v[160:163], v[120:123], v[44:47], v[160:163]
  v_mfma_f32_16x16x32_bf16 v[164:167], v[124:127], v[44:47], v[164:167]
  v_mfma_f32_16x16x32_bf16 v[168:171], v[128:131], v[44:47], v[168:171]
  v_mfma_f32_16x16x32_bf16 v[172:175], v[132:135], v[44:47], v[172:175]
  v_mfma_f32_16x16x32_bf16 v[176:179], v[136:139], v[44:47], v[176:179]
  s_waitcnt vmcnt(20)
  s_barrier
  s_add_u32 m0, s51, 20480
  s_add_u32 s46, s66, 369280
  buffer_load_dwordx4 v8, s[4:7], s46 offen lds
  s_add_u32 m0, s51, 24576
  s_add_u32 s46, s66, 369408
  buffer_load_dwordx4 v8, s[4:7], s46 offen lds
  s_add_u32 m0, s51, 28672
  s_add_u32 s46, s66, 369536
  buffer_load_dwordx4 v8, s[4:7], s46 offen lds
  s_add_u32 m0, s51, 32768
  s_add_u32 s46, s66, 369664
  buffer_load_dwordx4 v8, s[4:7], s46 offen lds
  s_add_u32 m0, s51, 36864
  s_add_u32 s46, s66, 369792
  buffer_load_dwordx4 v8, s[4:7], s46 offen lds
  ds_read_b64_tr_b16 v[100:101], v9 offset:40960
  ds_read_b64_tr_b16 v[102:103], v9 offset:41984
  ds_read_b64_tr_b16 v[104:105], v9 offset:45056
  ds_read_b64_tr_b16 v[106:107], v9 offset:46080
  ds_read_b64_tr_b16 v[108:109], v9 offset:49152
  ds_read_b64_tr_b16 v[110:111], v9 offset:50176
  ds_read_b64_tr_b16 v[112:113], v9 offset:53248
  ds_read_b64_tr_b16 v[114:115], v9 offset:54272
  ds_read_b64_tr_b16 v[116:117], v9 offset:57344
  ds_read_b64_tr_b16 v[118:119], v9 offset:58368
  s_waitcnt lgkmcnt(0)
  v_mfma_f32_16x16x32_bf16 v[140:143], v[100:103], v[48:51], v[140:143]
  v_mfma_f32_16x16x32_bf16 v[144:147], v[104:107], v[48:51], v[144:147]
  v_mfma_f32_16x16x32_bf16 v[148:151], v[108:111], v[48:51], v[148:151]
  v_mfma_f32_16x16x32_bf16 v[152:155], v[112:115], v[48:51], v[152:155]
  v_mfma_f32_16x16x32_bf16 v[156:159], v[116:119], v[48:51], v[156:159]
  s_waitcnt vmcnt(20)
  s_barrier
  s_add_u32 m0, s51, 40960
  s_add_u32 s46, s66, 409600
  buffer_load_dwordx4 v8, s[4:7], s46 offen lds
  s_add_u32 m0, s51, 45056
  s_add_u32 s46, s66, 409728
  buffer_load_dwordx4 v8, s[4:7], s46 offen lds
  s_add_u32 m0, s51, 49152
  s_add_u32 s46, s66, 409856
  buffer_load_dwordx4 v8, s[4:7], s46 offen lds
  s_add_u32 m0, s51, 53248
  s_add_u32 s46, s66, 409984
  buffer_load_dwordx4 v8, s[4:7], s46 offen lds
  s_add_u32 m0, s51, 57344
  s_add_u32 s46, s66, 410112
  buffer_load_dwordx4 v8, s[4:7], s46 offen lds
  ds_read_b64_tr_b16 v[120:121], v9 offset:61440
  ds_read_b64_tr_b16 v[122:123], v9 offset:62464
  ds_read_b64_tr_b16 v[124:125], v10 offset:0
  ds_read_b64_tr_b16 v[126:127], v10 offset:1024
  ds_read_b64_tr_b16 v[128:129], v10 offset:4096
  ds_read_b64_tr_b16 v[130:131], v10 offset:5120
  ds_read_b64_tr_b16 v[132:133], v10 offset:8192
  ds_read_b64_tr_b16 v[134:135], v10 offset:9216
  ds_read_b64_tr_b16 v[136:137], v10 offset:12288
  ds_read_b64_tr_b16 v[138:139], v10 offset:13312
  s_waitcnt lgkmcnt(0)
  v_mfma_f32_16x16x32_bf16 v[160:163], v[120:123], v[48:51], v[160:163]
  v_mfma_f32_16x16x32_bf16 v[164:167], v[124:127], v[48:51], v[164:167]
  v_mfma_f32_16x16x32_bf16 v[168:171], v[128:131], v[48:51], v[168:171]
  v_mfma_f32_16x16x32_bf16 v[172:175], v[132:135], v[48:51], v[172:175]
  v_mfma_f32_16x16x32_bf16 v[176:179], v[136:139], v[48:51], v[176:179]
  s_waitcnt vmcnt(20)
  s_barrier
  s_add_u32 m0, s51, 61440
  s_add_u32 s46, s66, 410240
  buffer_load_dwordx4 v8, s[4:7], s46 offen lds
  s_add_u32 m0, s51, 65536
  s_add_u32 s46, s66, 410368
  buffer_load_dwordx4 v8, s[4:7], s46 offen lds
  s_add_u32 m0, s51, 69632
  s_add_u32 s46, s66, 410496
  buffer_load_dwordx4 v8, s[4:7], s46 offen lds
  s_add_u32 m0, s51, 73728
  s_add_u32 s46, s66, 410624
  buffer_load_dwordx4 v8, s[4:7], s46 offen lds
  s_add_u32 m0, s51, 77824
  s_add_u32 s46, s66, 410752
  buffer_load_dwordx4 v8, s[4:7], s46 offen lds
  ds_read_b64_tr_b16 v[100:101], v10 offset:16384
  ds_read_b64_tr_b16 v[102:103], v10 offset:17408
  ds_read_b64_tr_b16 v[104:105], v10 offset:20480
  ds_read_b64_tr_b16 v[106:107], v10 offset:21504
  ds_read_b64_tr_b16 v[108:109], v10 offset:24576
  ds_read_b64_tr_b16 v[110:111], v10 offset:25600
  ds_read_b64_tr_b16 v[112:113], v10 offset:28672
  ds_read_b64_tr_b16 v[114:115], v10 offset:29696
  ds_read_b64_tr_b16 v[116:117], v10 offset:32768
  ds_read_b64_tr_b16 v[118:119], v10 offset:33792
  s_waitcnt lgkmcnt(0)
  v_mfma_f32_16x16x32_bf16 v[140:143], v[100:103], v[52:55], v[140:143]
  v_mfma_f32_16x16x32_bf16 v[144:147], v[104:107], v[52:55], v[144:147]
  v_mfma_f32_16x16x32_bf16 v[148:151], v[108:111], v[52:55], v[148:151]
  v_mfma_f32_16x16x32_bf16 v[152:155], v[112:115], v[52:55], v[152:155]
  v_mfma_f32_16x16x32_bf16 v[156:159], v[116:119], v[52:55], v[156:159]
  s_waitcnt vmcnt(20)
  s_barrier
  s_add_u32 m0, s51, 81920
  s_add_u32 s46, s66, 450560
  buffer_load_dwordx4 v8, s[4:7], s46 offen lds
  s_add_u32 m0, s51, 86016
  s_add_u32 s46, s66, 450688
  buffer_load_dwordx4 v8, s[4:7], s46 offen lds
  s_add_u32 m0, s51, 90112
  s_add_u32 s46, s66, 450816
  buffer_load_dwordx4 v8, s[4:7], s46 offen lds
  s_add_u32 m0, s51, 94208
  s_add_u32 s46, s66, 450944
  buffer_load_dwordx4 v8, s[4:7], s46 offen lds
  s_add_u32 m0, s51, 98304
  s_add_u32 s46, s66, 451072
  buffer_load_dwordx4 v8, s[4:7], s46 offen lds
  ds_read_b64_tr_b16 v[120:121], v10 offset:36864
  ds_read_b64_tr_b16 v[122:123], v10 offset:37888
  ds_read_b64_tr_b16 v[124:125], v10 offset:40960
  ds_read_b64_tr_b16 v[126:127], v10 offset:41984
  ds_read_b64_tr_b16 v[128:129], v10 offset:45056
  ds_read_b64_tr_b16 v[130:131], v10 offset:46080
  ds_read_b64_tr_b16 v[132:133], v10 offset:49152
  ds_read_b64_tr_b16 v[134:135], v10 offset:50176
  ds_read_b64_tr_b16 v[136:137], v10 offset:53248
  ds_read_b64_tr_b16 v[138:139], v10 offset:54272
  s_waitcnt lgkmcnt(0)
  v_mfma_f32_16x16x32_bf16 v[160:163], v[120:123], v[52:55], v[160:163]
  v_mfma_f32_16x16x32_bf16 v[164:167], v[124:127], v[52:55], v[164:167]
  v_mfma_f32_16x16x32_bf16 v[168:171], v[128:131], v[52:55], v[168:171]
  v_mfma_f32_16x16x32_bf16 v[172:175], v[132:135], v[52:55], v[172:175]
  v_mfma_f32_16x16x32_bf16 v[176:179], v[136:139], v[52:55], v[176:179]
  s_waitcnt vmcnt(20)
  s_barrier
  s_add_u32 m0, s51, 102400
  s_add_u32 s46, s66, 451200
  buffer_load_dwordx4 v8, s[4:7], s46 offen lds
  s_add_u32 m0, s51, 106496
  s_add_u32 s46, s66, 451328
  buffer_load_dwordx4 v8, s[4:7], s46 offen lds
  s_add_u32 m0, s51, 110592
  s_add_u32 s46, s66, 451456
  buffer_load_dwordx4 v8, s[4:7], s46 offen lds
  s_add_u32 m0, s51, 114688
  s_add_u32 s46, s66, 451584
  buffer_load_dwordx4 v8, s[4:7], s46 offen lds
  s_add_u32 m0, s51, 118784
  s_add_u32 s46, s66, 451712
  buffer_load_dwordx4 v8, s[4:7], s46 offen lds
  ds_read_b64_tr_b16 v[100:101], v9 offset:0
  ds_read_b64_tr_b16 v[102:103], v9 offset:1024
  ds_read_b64_tr_b16 v[104:105], v9 offset:4096
  ds_read_b64_tr_b16 v[106:107], v9 offset:5120
  ds_read_b64_tr_b16 v[108:109], v9 offset:8192
  ds_read_b64_tr_b16 v[110:111], v9 offset:9216
  ds_read_b64_tr_b16 v[112:113], v9 offset:12288
  ds_read_b64_tr_b16 v[114:115], v9 offset:13312
  ds_read_b64_tr_b16 v[116:117], v9 offset:16384
  ds_read_b64_tr_b16 v[118:119], v9 offset:17408
  s_waitcnt lgkmcnt(0)
  v_mfma_f32_16x16x32_bf16 v[140:143], v[100:103], v[56:59], v[140:143]
  v_mfma_f32_16x16x32_bf16 v[144:147], v[104:107], v[56:59], v[144:147]
  v_mfma_f32_16x16x32_bf16 v[148:151], v[108:111], v[56:59], v[148:151]
  v_mfma_f32_16x16x32_bf16 v[152:155], v[112:115], v[56:59], v[152:155]
  v_mfma_f32_16x16x32_bf16 v[156:159], v[116:119], v[56:59], v[156:159]
  s_waitcnt vmcnt(20)
  s_barrier
  s_add_u32 m0, s51, 0
  s_add_u32 s46, s66, 491520
  buffer_load_dwordx4 v8, s[4:7], s46 offen lds
  s_add_u32 m0, s51, 4096
  s_add_u32 s46, s66, 491648
  buffer_load_dwordx4 v8, s[4:7], s46 offen lds
  s_add_u32 m0, s51, 8192
  s_add_u32 s46, s66, 491776
  buffer_load_dwordx4 v8, s[4:7], s46 offen lds
  s_add_u32 m0, s51, 12288
  s_add_u32 s46, s66, 491904
  buffer_load_dwordx4 v8, s[4:7], s46 offen lds
  s_add_u32 m0, s51, 16384
  s_add_u32 s46, s66, 492032
  buffer_load_dwordx4 v8, s[4:7], s46 offen lds
  ds_read_b64_tr_b16 v[120:121], v9 offset:20480
  ds_read_b64_tr_b16 v[122:123], v9 offset:21504
  ds_read_b64_tr_b16 v[124:125], v9 offset:24576
  ds_read_b64_tr_b16 v[126:127], v9 offset:25600
  ds_read_b64_tr_b16 v[128:129], v9 offset:28672
  ds_read_b64_tr_b16 v[130:131], v9 offset:29696
  ds_read_b64_tr_b16 v[132:133], v9 offset:32768
  ds_read_b64_tr_b16 v[134:135], v9 offset:33792
  ds_read_b64_tr_b16 v[136:137], v9 offset:36864
  ds_read_b64_tr_b16 v[138:139], v9 offset:37888
  s_waitcnt lgkmcnt(0)
  v_mfma_f32_16x16x32_bf16 v[160:163], v[120:123], v[56:59], v[160:163]
  v_mfma_f32_16x16x32_bf16 v[164:167], v[124:127], v[56:59], v[164:167]
  v_mfma_f32_16x16x32_bf16 v[168:171], v[128:131], v[56:59], v[168:171]
  v_mfma_f32_16x16x32_bf16 v[172:175], v[132:135], v[56:59], v[172:175]
  v_mfma_f32_16x16x32_bf16 v[176:179], v[136:139], v[56:59], v[176:179]
  s_waitcnt vmcnt(20)
  s_barrier
  s_add_u32 m0, s51, 20480
  s_add_u32 s46, s66, 492160
  buffer_load_dwordx4 v8, s[4:7], s46 offen lds
  s_add_u32 m0, s51, 24576
  s_add_u32 s46, s66, 492288
  buffer_load_dwordx4 v8, s[4:7], s46 offen lds
  s_add_u32 m0, s51, 28672
  s_add_u32 s46, s66, 492416
  buffer_load_dwordx4 v8, s[4:7], s46 offen lds
  s_add_u32 m0, s51, 32768
  s_add_u32 s46, s66, 492544
  buffer_load_dwordx4 v8, s[4:7], s46 offen lds
  s_add_u32 m0, s51, 36864
  s_add_u32 s46, s66, 492672
  buffer_load_dwordx4 v8, s[4:7], s46 offen lds
  ds_read_b64_tr_b16 v[100:101], v9 offset:40960
  ds_read_b64_tr_b16 v[102:103], v9 offset:41984
  ds_read_b64_tr_b16 v[104:105], v9 offset:45056
  ds_read_b64_tr_b16 v[106:107], v9 offset:46080
  ds_read_b64_tr_b16 v[108:109], v9 offset:49152
  ds_read_b64_tr_b16 v[110:111], v9 offset:50176
  ds_read_b64_tr_b16 v[112:113], v9 offset:53248
  ds_read_b64_tr_b16 v[114:115], v9 offset:54272
  ds_read_b64_tr_b16 v[116:117], v9 offset:57344
  ds_read_b64_tr_b16 v[118:119], v9 offset:58368
  s_waitcnt lgkmcnt(0)
  v_mfma_f32_16x16x32_bf16 v[140:143], v[100:103], v[60:63], v[140:143]
  v_mfma_f32_16x16x32_bf16 v[144:147], v[104:107], v[60:63], v[144:147]
  v_mfma_f32_16x16x32_bf16 v[148:151], v[108:111], v[60:63], v[148:151]
  v_mfma_f32_16x16x32_bf16 v[152:155], v[112:115], v[60:63], v[152:155]
  v_mfma_f32_16x16x32_bf16 v[156:159], v[116:119], v[60:63], v[156:159]
  s_waitcnt vmcnt(20)
  s_barrier
  s_add_u32 m0, s51, 40960
  s_add_u32 s46, s66, 532480
  buffer_load_dwordx4 v8, s[4:7], s46 offen lds
  s_add_u32 m0, s51, 45056
  s_add_u32 s46, s66, 532608
  buffer_load_dwordx4 v8, s[4:7], s46 offen lds
  s_add_u32 m0, s51, 49152
  s_add_u32 s46, s66, 532736
  buffer_load_dwordx4 v8, s[4:7], s46 offen lds
  s_add_u32 m0, s51, 53248
  s_add_u32 s46, s66, 532864
  buffer_load_dwordx4 v8, s[4:7], s46 offen lds
  s_add_u32 m0, s51, 57344
  s_add_u32 s46, s66, 532992
  buffer_load_dwordx4 v8, s[4:7], s46 offen lds
  ds_read_b64_tr_b16 v[120:121], v9 offset:61440
  ds_read_b64_tr_b16 v[122:123], v9 offset:62464
  ds_read_b64_tr_b16 v[124:125], v10 offset:0
  ds_read_b64_tr_b16 v[126:127], v10 offset:1024
  ds_read_b64_tr_b16 v[128:129], v10 offset:4096
  ds_read_b64_tr_b16 v[130:131], v10 offset:5120
  ds_read_b64_tr_b16 v[132:133], v10 offset:8192
  ds_read_b64_tr_b16 v[134:135], v10 offset:9216
  ds_read_b64_tr_b16 v[136:137], v10 offset:12288
  ds_read_b64_tr_b16 v[138:139], v10 offset:13312
  s_waitcnt lgkmcnt(0)
  v_mfma_f32_16x16x32_bf16 v[160:163], v[120:123], v[60:63], v[160:163]
  v_mfma_f32_16x16x32_bf16 v[164:167], v[124:127], v[60:63], v[164:167]
  v_mfma_f32_16x16x32_bf16 v[168:171], v[128:131], v[60:63], v[168:171]
  v_mfma_f32_16x16x32_bf16 v[172:175], v[132:135], v[60:63], v[172:175]
  v_mfma_f32_16x16x32_bf16 v[176:179], v[136:139], v[60:63], v[176:179]
  s_waitcnt vmcnt(20)
  s_barrier
  s_add_u32 m0, s51, 61440
  s_add_u32 s46, s66, 533120
  buffer_load_dwordx4 v8, s[4:7], s46 offen lds
  s_add_u32 m0, s51, 65536
  s_add_u32 s46, s66, 533248
  buffer_load_dwordx4 v8, s[4:7], s46 offen lds
  s_add_u32 m0, s51, 69632
  s_add_u32 s46, s66, 533376
  buffer_load_dwordx4 v8, s[4:7], s46 offen lds
  s_add_u32 m0, s51, 73728
  s_add_u32 s46, s66, 533504
  buffer_load_dwordx4 v8, s[4:7], s46 offen lds
  s_add_u32 m0, s51, 77824
  s_add_u32 s46, s66, 533632
  buffer_load_dwordx4 v8, s[4:7], s46 offen lds
  ds_read_b64_tr_b16 v[100:101], v10 offset:16384
  ds_read_b64_tr_b16 v[102:103], v10 offset:17408
  ds_read_b64_tr_b16 v[104:105], v10 offset:20480
  ds_read_b64_tr_b16 v[106:107], v10 offset:21504
  ds_read_b64_tr_b16 v[108:109], v10 offset:24576
  ds_read_b64_tr_b16 v[110:111], v10 offset:25600
  ds_read_b64_tr_b16 v[112:113], v10 offset:28672
  ds_read_b64_tr_b16 v[114:115], v10 offset:29696
  ds_read_b64_tr_b16 v[116:117], v10 offset:32768
  ds_read_b64_tr_b16 v[118:119], v10 offset:33792
  s_waitcnt lgkmcnt(0)
  v_mfma_f32_16x16x32_bf16 v[140:143], v[100:103], v[64:67], v[140:143]
  v_mfma_f32_16x16x32_bf16 v[144:147], v[104:107], v[64:67], v[144:147]
  v_mfma_f32_16x16x32_bf16 v[148:151], v[108:111], v[64:67], v[148:151]
  v_mfma_f32_16x16x32_bf16 v[152:155], v[112:115], v[64:67], v[152:155]
  v_mfma_f32_16x16x32_bf16 v[156:159], v[116:119], v[64:67], v[156:159]
  s_waitcnt vmcnt(20)
  s_barrier
  s_add_u32 m0, s51, 81920
  s_add_u32 s46, s66, 573440
  buffer_load_dwordx4 v8, s[4:7], s46 offen lds
  s_add_u32 m0, s51, 86016
  s_add_u32 s46, s66, 573568
  buffer_load_dwordx4 v8, s[4:7], s46 offen lds
  s_add_u32 m0, s51, 90112
  s_add_u32 s46, s66, 573696
  buffer_load_dwordx4 v8, s[4:7], s46 offen lds
  s_add_u32 m0, s51, 94208
  s_add_u32 s46, s66, 573824
  buffer_load_dwordx4 v8, s[4:7], s46 offen lds
  s_add_u32 m0, s51, 98304
  s_add_u32 s46, s66, 573952
  buffer_load_dwordx4 v8, s[4:7], s46 offen lds
  ds_read_b64_tr_b16 v[120:121], v10 offset:36864
  ds_read_b64_tr_b16 v[122:123], v10 offset:37888
  ds_read_b64_tr_b16 v[124:125], v10 offset:40960
  ds_read_b64_tr_b16 v[126:127], v10 offset:41984
  ds_read_b64_tr_b16 v[128:129], v10 offset:45056
  ds_read_b64_tr_b16 v[130:131], v10 offset:46080
  ds_read_b64_tr_b16 v[132:133], v10 offset:49152
  ds_read_b64_tr_b16 v[134:135], v10 offset:50176
  ds_read_b64_tr_b16 v[136:137], v10 offset:53248
  ds_read_b64_tr_b16 v[138:139], v10 offset:54272
  s_waitcnt lgkmcnt(0)
  v_mfma_f32_16x16x32_bf16 v[160:163], v[120:123], v[64:67], v[160:163]
  v_mfma_f32_16x16x32_bf16 v[164:167], v[124:127], v[64:67], v[164:167]
  v_mfma_f32_16x16x32_bf16 v[168:171], v[128:131], v[64:67], v[168:171]
  v_mfma_f32_16x16x32_bf16 v[172:175], v[132:135], v[64:67], v[172:175]
  v_mfma_f32_16x16x32_bf16 v[176:179], v[136:139], v[64:67], v[176:179]
  s_waitcnt vmcnt(20)
  s_barrier
  s_add_u32 m0, s51, 102400
  s_add_u32 s46, s66, 574080
  buffer_load_dwordx4 v8, s[4:7], s46 offen lds
  s_add_u32 m0, s51, 106496
  s_add_u32 s46, s66, 574208
  buffer_load_dwordx4 v8, s[4:7], s46 offen lds
  s_add_u32 m0, s51, 110592
  s_add_u32 s46, s66, 574336
  buffer_load_dwordx4 v8, s[4:7], s46 offen lds
  s_add_u32 m0, s51, 114688
  s_add_u32 s46, s66, 574464
  buffer_load_dwordx4 v8, s[4:7], s46 offen lds
  s_add_u32 m0, s51, 118784
  s_add_u32 s46, s66, 574592
  buffer_load_dwordx4 v8, s[4:7], s46 offen lds
  ds_read_b64_tr_b16 v[100:101], v9 offset:0
  ds_read_b64_tr_b16 v[102:103], v9 offset:1024
  ds_read_b64_tr_b16 v[104:105], v9 offset:4096
  ds_read_b64_tr_b16 v[106:107], v9 offset:5120
  ds_read_b64_tr_b16 v[108:109], v9 offset:8192
  ds_read_b64_tr_b16 v[110:111], v9 offset:9216
  ds_read_b64_tr_b16 v[112:113], v9 offset:12288
  ds_read_b64_tr_b16 v[114:115], v9 offset:13312
  ds_read_b64_tr_b16 v[116:117], v9 offset:16384
  ds_read_b64_tr_b16 v[118:119], v9 offset:17408
  s_waitcnt lgkmcnt(0)
  v_mfma_f32_16x16x32_bf16 v[140:143], v[100:103], v[68:71], v[140:143]
  v_mfma_f32_16x16x32_bf16 v[144:147], v[104:107], v[68:71], v[144:147]
  v_mfma_f32_16x16x32_bf16 v[148:151], v[108:111], v[68:71], v[148:151]
  v_mfma_f32_16x16x32_bf16 v[152:155], v[112:115], v[68:71], v[152:155]
  v_mfma_f32_16x16x32_bf16 v[156:159], v[116:119], v[68:71], v[156:159]
  s_waitcnt vmcnt(20)
  s_barrier
  s_add_u32 m0, s51, 0
  s_add_u32 s46, s66, 614400
  buffer_load_dwordx4 v8, s[4:7], s46 offen lds
  s_add_u32 m0, s51, 4096
  s_add_u32 s46, s66, 614528
  buffer_load_dwordx4 v8, s[4:7], s46 offen lds
  s_add_u32 m0, s51, 8192
  s_add_u32 s46, s66, 614656
  buffer_load_dwordx4 v8, s[4:7], s46 offen lds
  s_add_u32 m0, s51, 12288
  s_add_u32 s46, s66, 614784
  buffer_load_dwordx4 v8, s[4:7], s46 offen lds
  s_add_u32 m0, s51, 16384
  s_add_u32 s46, s66, 614912
  buffer_load_dwordx4 v8, s[4:7], s46 offen lds
  ds_read_b64_tr_b16 v[120:121], v9 offset:20480
  ds_read_b64_tr_b16 v[122:123], v9 offset:21504
  ds_read_b64_tr_b16 v[124:125], v9 offset:24576
  ds_read_b64_tr_b16 v[126:127], v9 offset:25600
  ds_read_b64_tr_b16 v[128:129], v9 offset:28672
  ds_read_b64_tr_b16 v[130:131], v9 offset:29696
  ds_read_b64_tr_b16 v[132:133], v9 offset:32768
  ds_read_b64_tr_b16 v[134:135], v9 offset:33792
  ds_read_b64_tr_b16 v[136:137], v9 offset:36864
  ds_read_b64_tr_b16 v[138:139], v9 offset:37888
  s_waitcnt lgkmcnt(0)
  v_mfma_f32_16x16x32_bf16 v[160:163], v[120:123], v[68:71], v[160:163]
  v_mfma_f32_16x16x32_bf16 v[164:167], v[124:127], v[68:71], v[164:167]
  v_mfma_f32_16x16x32_bf16 v[168:171], v[128:131], v[68:71], v[168:171]
  v_mfma_f32_16x16x32_bf16 v[172:175], v[132:135], v[68:71], v[172:175]
  v_mfma_f32_16x16x32_bf16 v[176:179], v[136:139], v[68:71], v[176:179]
  s_waitcnt vmcnt(20)
  s_barrier
  s_add_u32 m0, s51, 20480
  s_add_u32 s46, s66, 615040
  buffer_load_dwordx4 v8, s[4:7], s46 offen lds
  s_add_u32 m0, s51, 24576
  s_add_u32 s46, s66, 615168
  buffer_load_dwordx4 v8, s[4:7], s46 offen lds
  s_add_u32 m0, s51, 28672
  s_add_u32 s46, s66, 615296
  buffer_load_dwordx4 v8, s[4:7], s46 offen lds
  s_add_u32 m0, s51, 32768
  s_add_u32 s46, s66, 615424
  buffer_load_dwordx4 v8, s[4:7], s46 offen lds
  s_add_u32 m0, s51, 36864
  s_add_u32 s46, s66, 615552
  buffer_load_dwordx4 v8, s[4:7], s46 offen lds
  ds_read_b64_tr_b16 v[100:101], v9 offset:40960
  ds_read_b64_tr_b16 v[102:103], v9 offset:41984
  ds_read_b64_tr_b16 v[104:105], v9 offset:45056
  ds_read_b64_tr_b16 v[106:107], v9 offset:46080
  ds_read_b64_tr_b16 v[108:109], v9 offset:49152
  ds_read_b64_tr_b16 v[110:111], v9 offset:50176
  ds_read_b64_tr_b16 v[112:113], v9 offset:53248
  ds_read_b64_tr_b16 v[114:115], v9 offset:54272
  ds_read_b64_tr_b16 v[116:117], v9 offset:57344
  ds_read_b64_tr_b16 v[118:119], v9 offset:58368
  s_waitcnt lgkmcnt(0)
  v_mfma_f32_16x16x32_bf16 v[140:143], v[100:103], v[72:75], v[140:143]
  v_mfma_f32_16x16x32_bf16 v[144:147], v[104:107], v[72:75], v[144:147]
  v_mfma_f32_16x16x32_bf16 v[148:151], v[108:111], v[72:75], v[148:151]
  v_mfma_f32_16x16x32_bf16 v[152:155], v[112:115], v[72:75], v[152:155]
  v_mfma_f32_16x16x32_bf16 v[156:159], v[116:119], v[72:75], v[156:159]
  s_waitcnt vmcnt(20)
  s_barrier
  s_add_u32 m0, s51, 40960
  s_add_u32 s46, s66, 655360
  buffer_load_dwordx4 v8, s[4:7], s46 offen lds
  s_add_u32 m0, s51, 45056
  s_add_u32 s46, s66, 655488
  buffer_load_dwordx4 v8, s[4:7], s46 offen lds
  s_add_u32 m0, s51, 49152
  s_add_u32 s46, s66, 655616
  buffer_load_dwordx4 v8, s[4:7], s46 offen lds
  s_add_u32 m0, s51, 53248
  s_add_u32 s46, s66, 655744
  buffer_load_dwordx4 v8, s[4:7], s46 offen lds
  s_add_u32 m0, s51, 57344
  s_add_u32 s46, s66, 655872
  buffer_load_dwordx4 v8, s[4:7], s46 offen lds
  ds_read_b64_tr_b16 v[120:121], v9 offset:61440
  ds_read_b64_tr_b16 v[122:123], v9 offset:62464
  ds_read_b64_tr_b16 v[124:125], v10 offset:0
  ds_read_b64_tr_b16 v[126:127], v10 offset:1024
  ds_read_b64_tr_b16 v[128:129], v10 offset:4096
  ds_read_b64_tr_b16 v[130:131], v10 offset:5120
  ds_read_b64_tr_b16 v[132:133], v10 offset:8192
  ds_read_b64_tr_b16 v[134:135], v10 offset:9216
  ds_read_b64_tr_b16 v[136:137], v10 offset:12288
  ds_read_b64_tr_b16 v[138:139], v10 offset:13312
  s_waitcnt lgkmcnt(0)
  v_mfma_f32_16x16x32_bf16 v[160:163], v[120:123], v[72:75], v[160:163]
  v_mfma_f32_16x16x32_bf16 v[164:167], v[124:127], v[72:75], v[164:167]
  v_mfma_f32_16x16x32_bf16 v[168:171], v[128:131], v[72:75], v[168:171]
  v_mfma_f32_16x16x32_bf16 v[172:175], v[132:135], v[72:75], v[172:175]
  v_mfma_f32_16x16x32_bf16 v[176:179], v[136:139], v[72:75], v[176:179]
  s_waitcnt vmcnt(20)
  s_barrier
  s_add_u32 m0, s51, 61440
  s_add_u32 s46, s66, 656000
  buffer_load_dwordx4 v8, s[4:7], s46 offen lds
  s_add_u32 m0, s51, 65536
  s_add_u32 s46, s66, 656128
  buffer_load_dwordx4 v8, s[4:7], s46 offen lds
  s_add_u32 m0, s51, 69632
  s_add_u32 s46, s66, 656256
  buffer_load_dwordx4 v8, s[4:7], s46 offen lds
  s_add_u32 m0, s51, 73728
  s_add_u32 s46, s66, 656384
  buffer_load_dwordx4 v8, s[4:7], s46 offen lds
  s_add_u32 m0, s51, 77824
  s_add_u32 s46, s66, 656512
  buffer_load_dwordx4 v8, s[4:7], s46 offen lds
  ds_read_b64_tr_b16 v[100:101], v10 offset:16384
  ds_read_b64_tr_b16 v[102:103], v10 offset:17408
  ds_read_b64_tr_b16 v[104:105], v10 offset:20480
  ds_read_b64_tr_b16 v[106:107], v10 offset:21504
  ds_read_b64_tr_b16 v[108:109], v10 offset:24576
  ds_read_b64_tr_b16 v[110:111], v10 offset:25600
  ds_read_b64_tr_b16 v[112:113], v10 offset:28672
  ds_read_b64_tr_b16 v[114:115], v10 offset:29696
  ds_read_b64_tr_b16 v[116:117], v10 offset:32768
  ds_read_b64_tr_b16 v[118:119], v10 offset:33792
  s_waitcnt lgkmcnt(0)
  v_mfma_f32_16x16x32_bf16 v[140:143], v[100:103], v[76:79], v[140:143]
  v_mfma_f32_16x16x32_bf16 v[144:147], v[104:107], v[76:79], v[144:147]
  v_mfma_f32_16x16x32_bf16 v[148:151], v[108:111], v[76:79], v[148:151]
  v_mfma_f32_16x16x32_bf16 v[152:155], v[112:115], v[76:79], v[152:155]
  v_mfma_f32_16x16x32_bf16 v[156:159], v[116:119], v[76:79], v[156:159]
  s_waitcnt vmcnt(20)
  s_barrier
  s_add_u32 m0, s51, 81920
  s_add_u32 s46, s66, 696320
  buffer_load_dwordx4 v8, s[4:7], s46 offen lds
  s_add_u32 m0, s51, 86016
  s_add_u32 s46, s66, 696448
  buffer_load_dwordx4 v8, s[4:7], s46 offen lds
  s_add_u32 m0, s51, 90112
  s_add_u32 s46, s66, 696576
  buffer_load_dwordx4 v8, s[4:7], s46 offen lds
  s_add_u32 m0, s51, 94208
  s_add_u32 s46, s66, 696704
  buffer_load_dwordx4 v8, s[4:7], s46 offen lds
  s_add_u32 m0, s51, 98304
  s_add_u32 s46, s66, 696832
  buffer_load_dwordx4 v8, s[4:7], s46 offen lds
  ds_read_b64_tr_b16 v[120:121], v10 offset:36864
  ds_read_b64_tr_b16 v[122:123], v10 offset:37888
  ds_read_b64_tr_b16 v[124:125], v10 offset:40960
  ds_read_b64_tr_b16 v[126:127], v10 offset:41984
  ds_read_b64_tr_b16 v[128:129], v10 offset:45056
  ds_read_b64_tr_b16 v[130:131], v10 offset:46080
  ds_read_b64_tr_b16 v[132:133], v10 offset:49152
  ds_read_b64_tr_b16 v[134:135], v10 offset:50176
  ds_read_b64_tr_b16 v[136:137], v10 offset:53248
  ds_read_b64_tr_b16 v[138:139], v10 offset:54272
  s_waitcnt lgkmcnt(0)
  v_mfma_f32_16x16x32_bf16 v[160:163], v[120:123], v[76:79], v[160:163]
  v_mfma_f32_16x16x32_bf16 v[164:167], v[124:127], v[76:79], v[164:167]
  v_mfma_f32_16x16x32_bf16 v[168:171], v[128:131], v[76:79], v[168:171]
  v_mfma_f32_16x16x32_bf16 v[172:175], v[132:135], v[76:79], v[172:175]
  v_mfma_f32_16x16x32_bf16 v[176:179], v[136:139], v[76:79], v[176:179]
  s_waitcnt vmcnt(20)
  s_barrier
  s_add_u32 m0, s51, 102400
  s_add_u32 s46, s66, 696960
  buffer_load_dwordx4 v8, s[4:7], s46 offen lds
  s_add_u32 m0, s51, 106496
  s_add_u32 s46, s66, 697088
  buffer_load_dwordx4 v8, s[4:7], s46 offen lds
  s_add_u32 m0, s51, 110592
  s_add_u32 s46, s66, 697216
  buffer_load_dwordx4 v8, s[4:7], s46 offen lds
  s_add_u32 m0, s51, 114688
  s_add_u32 s46, s66, 697344
  buffer_load_dwordx4 v8, s[4:7], s46 offen lds
  s_add_u32 m0, s51, 118784
  s_add_u32 s46, s66, 697472
  buffer_load_dwordx4 v8, s[4:7], s46 offen lds
  ds_read_b64_tr_b16 v[100:101], v9 offset:0
  ds_read_b64_tr_b16 v[102:103], v9 offset:1024
  ds_read_b64_tr_b16 v[104:105], v9 offset:4096
  ds_read_b64_tr_b16 v[106:107], v9 offset:5120
  ds_read_b64_tr_b16 v[108:109], v9 offset:8192
  ds_read_b64_tr_b16 v[110:111], v9 offset:9216
  ds_read_b64_tr_b16 v[112:113], v9 offset:12288
  ds_read_b64_tr_b16 v[114:115], v9 offset:13312
  ds_read_b64_tr_b16 v[116:117], v9 offset:16384
  ds_read_b64_tr_b16 v[118:119], v9 offset:17408
  s_waitcnt lgkmcnt(0)
  v_mfma_f32_16x16x32_bf16 v[140:143], v[100:103], v[80:83], v[140:143]
  v_mfma_f32_16x16x32_bf16 v[144:147], v[104:107], v[80:83], v[144:147]
  v_mfma_f32_16x16x32_bf16 v[148:151], v[108:111], v[80:83], v[148:151]
  v_mfma_f32_16x16x32_bf16 v[152:155], v[112:115], v[80:83], v[152:155]
  v_mfma_f32_16x16x32_bf16 v[156:159], v[116:119], v[80:83], v[156:159]
  s_waitcnt vmcnt(20)
  s_barrier
  s_add_u32 m0, s51, 0
  s_add_u32 s46, s66, 737280
  buffer_load_dwordx4 v8, s[4:7], s46 offen lds
  s_add_u32 m0, s51, 4096
  s_add_u32 s46, s66, 737408
  buffer_load_dwordx4 v8, s[4:7], s46 offen lds
  s_add_u32 m0, s51, 8192
  s_add_u32 s46, s66, 737536
  buffer_load_dwordx4 v8, s[4:7], s46 offen lds
  s_add_u32 m0, s51, 12288
  s_add_u32 s46, s66, 737664
  buffer_load_dwordx4 v8, s[4:7], s46 offen lds
  s_add_u32 m0, s51, 16384
  s_add_u32 s46, s66, 737792
  buffer_load_dwordx4 v8, s[4:7], s46 offen lds
  ds_read_b64_tr_b16 v[120:121], v9 offset:20480
  ds_read_b64_tr_b16 v[122:123], v9 offset:21504
  ds_read_b64_tr_b16 v[124:125], v9 offset:24576
  ds_read_b64_tr_b16 v[126:127], v9 offset:25600
  ds_read_b64_tr_b16 v[128:129], v9 offset:28672
  ds_read_b64_tr_b16 v[130:131], v9 offset:29696
  ds_read_b64_tr_b16 v[132:133], v9 offset:32768
  ds_read_b64_tr_b16 v[134:135], v9 offset:33792
  ds_read_b64_tr_b16 v[136:137], v9 offset:36864
  ds_read_b64_tr_b16 v[138:139], v9 offset:37888
  s_waitcnt lgkmcnt(0)
  v_mfma_f32_16x16x32_bf16 v[160:163], v[120:123], v[80:83], v[160:163]
  v_mfma_f32_16x16x32_bf16 v[164:167], v[124:127], v[80:83], v[164:167]
  v_mfma_f32_16x16x32_bf16 v[168:171], v[128:131], v[80:83], v[168:171]
  v_mfma_f32_16x16x32_bf16 v[172:175], v[132:135], v[80:83], v[172:175]
  v_mfma_f32_16x16x32_bf16 v[176:179], v[136:139], v[80:83], v[176:179]
  s_waitcnt vmcnt(20)
  s_barrier
  s_add_u32 m0, s51, 20480
  s_add_u32 s46, s66, 737920
  buffer_load_dwordx4 v8, s[4:7], s46 offen lds
  s_add_u32 m0, s51, 24576
  s_add_u32 s46, s66, 738048
  buffer_load_dwordx4 v8, s[4:7], s46 offen lds
  s_add_u32 m0, s51, 28672
  s_add_u32 s46, s66, 738176
  buffer_load_dwordx4 v8, s[4:7], s46 offen lds
  s_add_u32 m0, s51, 32768
  s_add_u32 s46, s66, 738304
  buffer_load_dwordx4 v8, s[4:7], s46 offen lds
  s_add_u32 m0, s51, 36864
  s_add_u32 s46, s66, 738432
  buffer_load_dwordx4 v8, s[4:7], s46 offen lds
  ds_read_b64_tr_b16 v[100:101], v9 offset:40960
  ds_read_b64_tr_b16 v[102:103], v9 offset:41984
  ds_read_b64_tr_b16 v[104:105], v9 offset:45056
  ds_read_b64_tr_b16 v[106:107], v9 offset:46080
  ds_read_b64_tr_b16 v[108:109], v9 offset:49152
  ds_read_b64_tr_b16 v[110:111], v9 offset:50176
  ds_read_b64_tr_b16 v[112:113], v9 offset:53248
  ds_read_b64_tr_b16 v[114:115], v9 offset:54272
  ds_read_b64_tr_b16 v[116:117], v9 offset:57344
  ds_read_b64_tr_b16 v[118:119], v9 offset:58368
  s_waitcnt lgkmcnt(0)
  v_mfma_f32_16x16x32_bf16 v[140:143], v[100:103], v[84:87], v[140:143]
  v_mfma_f32_16x16x32_bf16 v[144:147], v[104:107], v[84:87], v[144:147]
  v_mfma_f32_16x16x32_bf16 v[148:151], v[108:111], v[84:87], v[148:151]
  v_mfma_f32_16x16x32_bf16 v[152:155], v[112:115], v[84:87], v[152:155]
  v_mfma_f32_16x16x32_bf16 v[156:159], v[116:119], v[84:87], v[156:159]
  s_waitcnt vmcnt(20)
  s_barrier
  s_add_u32 m0, s51, 40960
  s_add_u32 s46, s66, 778240
  buffer_load_dwordx4 v8, s[4:7], s46 offen lds
  s_add_u32 m0, s51, 45056
  s_add_u32 s46, s66, 778368
  buffer_load_dwordx4 v8, s[4:7], s46 offen lds
  s_add_u32 m0, s51, 49152
  s_add_u32 s46, s66, 778496
  buffer_load_dwordx4 v8, s[4:7], s46 offen lds
  s_add_u32 m0, s51, 53248
  s_add_u32 s46, s66, 778624
  buffer_load_dwordx4 v8, s[4:7], s46 offen lds
  s_add_u32 m0, s51, 57344
  s_add_u32 s46, s66, 778752
  buffer_load_dwordx4 v8, s[4:7], s46 offen lds
  ds_read_b64_tr_b16 v[120:121], v9 offset:61440
  ds_read_b64_tr_b16 v[122:123], v9 offset:62464
  ds_read_b64_tr_b16 v[124:125], v10 offset:0
  ds_read_b64_tr_b16 v[126:127], v10 offset:1024
  ds_read_b64_tr_b16 v[128:129], v10 offset:4096
  ds_read_b64_tr_b16 v[130:131], v10 offset:5120
  ds_read_b64_tr_b16 v[132:133], v10 offset:8192
  ds_read_b64_tr_b16 v[134:135], v10 offset:9216
  ds_read_b64_tr_b16 v[136:137], v10 offset:12288
  ds_read_b64_tr_b16 v[138:139], v10 offset:13312
  s_waitcnt lgkmcnt(0)
  v_mfma_f32_16x16x32_bf16 v[160:163], v[120:123], v[84:87], v[160:163]
  v_mfma_f32_16x16x32_bf16 v[164:167], v[124:127], v[84:87], v[164:167]
  v_mfma_f32_16x16x32_bf16 v[168:171], v[128:131], v[84:87], v[168:171]
  v_mfma_f32_16x16x32_bf16 v[172:175], v[132:135], v[84:87], v[172:175]
  v_mfma_f32_16x16x32_bf16 v[176:179], v[136:139], v[84:87], v[176:179]
  s_waitcnt vmcnt(20)
  s_barrier
  s_add_u32 m0, s51, 61440
  s_add_u32 s46, s66, 778880
  buffer_load_dwordx4 v8, s[4:7], s46 offen lds
  s_add_u32 m0, s51, 65536
  s_add_u32 s46, s66, 779008
  buffer_load_dwordx4 v8, s[4:7], s46 offen lds
  s_add_u32 m0, s51, 69632
  s_add_u32 s46, s66, 779136
  buffer_load_dwordx4 v8, s[4:7], s46 offen lds
  s_add_u32 m0, s51, 73728
  s_add_u32 s46, s66, 779264
  buffer_load_dwordx4 v8, s[4:7], s46 offen lds
  s_add_u32 m0, s51, 77824
  s_add_u32 s46, s66, 779392
  buffer_load_dwordx4 v8, s[4:7], s46 offen lds
  ds_read_b64_tr_b16 v[100:101], v10 offset:16384
  ds_read_b64_tr_b16 v[102:103], v10 offset:17408
  ds_read_b64_tr_b16 v[104:105], v10 offset:20480
  ds_read_b64_tr_b16 v[106:107], v10 offset:21504
  ds_read_b64_tr_b16 v[108:109], v10 offset:24576
  ds_read_b64_tr_b16 v[110:111], v10 offset:25600
  ds_read_b64_tr_b16 v[112:113], v10 offset:28672
  ds_read_b64_tr_b16 v[114:115], v10 offset:29696
  ds_read_b64_tr_b16 v[116:117], v10 offset:32768
  ds_read_b64_tr_b16 v[118:119], v10 offset:33792
  s_waitcnt lgkmcnt(0)
  v_mfma_f32_16x16x32_bf16 v[140:143], v[100:103], v[88:91], v[140:143]
  v_mfma_f32_16x16x32_bf16 v[144:147], v[104:107], v[88:91], v[144:147]
  v_mfma_f32_16x16x32_bf16 v[148:151], v[108:111], v[88:91], v[148:151]
  v_mfma_f32_16x16x32_bf16 v[152:155], v[112:115], v[88:91], v[152:155]
  v_mfma_f32_16x16x32_bf16 v[156:159], v[116:119], v[88:91], v[156:159]
  s_waitcnt vmcnt(20)
  s_barrier
  ds_read_b64_tr_b16 v[120:121], v10 offset:36864
  ds_read_b64_tr_b16 v[122:123], v10 offset:37888
  ds_read_b64_tr_b16 v[124:125], v10 offset:40960
  ds_read_b64_tr_b16 v[126:127], v10 offset:41984
  ds_read_b64_tr_b16 v[128:129], v10 offset:45056
  ds_read_b64_tr_b16 v[130:131], v10 offset:46080
  ds_read_b64_tr_b16 v[132:133], v10 offset:49152
  ds_read_b64_tr_b16 v[134:135], v10 offset:50176
  ds_read_b64_tr_b16 v[136:137], v10 offset:53248
  ds_read_b64_tr_b16 v[138:139], v10 offset:54272
  s_waitcnt lgkmcnt(0)
  v_mfma_f32_16x16x32_bf16 v[160:163], v[120:123], v[88:91], v[160:163]
  v_mfma_f32_16x16x32_bf16 v[164:167], v[124:127], v[88:91], v[164:167]
  v_mfma_f32_16x16x32_bf16 v[168:171], v[128:131], v[88:91], v[168:171]
  v_mfma_f32_16x16x32_bf16 v[172:175], v[132:135], v[88:91], v[172:175]
  v_mfma_f32_16x16x32_bf16 v[176:179], v[136:139], v[88:91], v[176:179]
  s_waitcnt vmcnt(15)
  s_barrier
  ds_read_b64_tr_b16 v[100:101], v9 offset:0
  ds_read_b64_tr_b16 v[102:103], v9 offset:1024
  ds_read_b64_tr_b16 v[104:105], v9 offset:4096
  ds_read_b64_tr_b16 v[106:107], v9 offset:5120
  ds_read_b64_tr_b16 v[108:109], v9 offset:8192
  ds_read_b64_tr_b16 v[110:111], v9 offset:9216
  ds_read_b64_tr_b16 v[112:113], v9 offset:12288
  ds_read_b64_tr_b16 v[114:115], v9 offset:13312
  ds_read_b64_tr_b16 v[116:117], v9 offset:16384
  ds_read_b64_tr_b16 v[118:119], v9 offset:17408
  s_waitcnt lgkmcnt(0)
  v_mfma_f32_16x16x32_bf16 v[140:143], v[100:103], v[92:95], v[140:143]
  v_mfma_f32_16x16x32_bf16 v[144:147], v[104:107], v[92:95], v[144:147]
  v_mfma_f32_16x16x32_bf16 v[148:151], v[108:111], v[92:95], v[148:151]
  v_mfma_f32_16x16x32_bf16 v[152:155], v[112:115], v[92:95], v[152:155]
  v_mfma_f32_16x16x32_bf16 v[156:159], v[116:119], v[92:95], v[156:159]
  s_waitcnt vmcnt(10)
  s_barrier
  ds_read_b64_tr_b16 v[120:121], v9 offset:20480
  ds_read_b64_tr_b16 v[122:123], v9 offset:21504
  ds_read_b64_tr_b16 v[124:125], v9 offset:24576
  ds_read_b64_tr_b16 v[126:127], v9 offset:25600
  ds_read_b64_tr_b16 v[128:129], v9 offset:28672
  ds_read_b64_tr_b16 v[130:131], v9 offset:29696
  ds_read_b64_tr_b16 v[132:133], v9 offset:32768
  ds_read_b64_tr_b16 v[134:135], v9 offset:33792
  ds_read_b64_tr_b16 v[136:137], v9 offset:36864
  ds_read_b64_tr_b16 v[138:139], v9 offset:37888
  s_waitcnt lgkmcnt(0)
  v_mfma_f32_16x16x32_bf16 v[160:163], v[120:123], v[92:95], v[160:163]
  v_mfma_f32_16x16x32_bf16 v[164:167], v[124:127], v[92:95], v[164:167]
  v_mfma_f32_16x16x32_bf16 v[168:171], v[128:131], v[92:95], v[168:171]
  v_mfma_f32_16x16x32_bf16 v[172:175], v[132:135], v[92:95], v[172:175]
  v_mfma_f32_16x16x32_bf16 v[176:179], v[136:139], v[92:95], v[176:179]
  s_waitcnt vmcnt(5)
  s_barrier
  ds_read_b64_tr_b16 v[100:101], v9 offset:40960
  ds_read_b64_tr_b16 v[102:103], v9 offset:41984
  ds_read_b64_tr_b16 v[104:105], v9 offset:45056
  ds_read_b64_tr_b16 v[106:107], v9 offset:46080
  ds_read_b64_tr_b16 v[108:109], v9 offset:49152
  ds_read_b64_tr_b16 v[110:111], v9 offset:50176
  ds_read_b64_tr_b16 v[112:113], v9 offset:53248
  ds_read_b64_tr_b16 v[114:115], v9 offset:54272
  ds_read_b64_tr_b16 v[116:117], v9 offset:57344
  ds_read_b64_tr_b16 v[118:119], v9 offset:58368
  s_waitcnt lgkmcnt(0)
  v_mfma_f32_16x16x32_bf16 v[140:143], v[100:103], v[96:99], v[140:143]
  v_mfma_f32_16x16x32_bf16 v[144:147], v[104:107], v[96:99], v[144:147]
  v_mfma_f32_16x16x32_bf16 v[148:151], v[108:111], v[96:99], v[148:151]
  v_mfma_f32_16x16x32_bf16 v[152:155], v[112:115], v[96:99], v[152:155]
  v_mfma_f32_16x16x32_bf16 v[156:159], v[116:119], v[96:99], v[156:159]
  s_waitcnt vmcnt(0)
  s_barrier
  ds_read_b64_tr_b16 v[120:121], v9 offset:61440
  ds_read_b64_tr_b16 v[122:123], v9 offset:62464
  ds_read_b64_tr_b16 v[124:125], v10 offset:0
  ds_read_b64_tr_b16 v[126:127], v10 offset:1024
  ds_read_b64_tr_b16 v[128:129], v10 offset:4096
  ds_read_b64_tr_b16 v[130:131], v10 offset:5120
  ds_read_b64_tr_b16 v[132:133], v10 offset:8192
  ds_read_b64_tr_b16 v[134:135], v10 offset:9216
  ds_read_b64_tr_b16 v[136:137], v10 offset:12288
  ds_read_b64_tr_b16 v[138:139], v10 offset:13312
  s_waitcnt lgkmcnt(0)
  v_mfma_f32_16x16x32_bf16 v[160:163], v[120:123], v[96:99], v[160:163]
  v_mfma_f32_16x16x32_bf16 v[164:167], v[124:127], v[96:99], v[164:167]
  v_mfma_f32_16x16x32_bf16 v[168:171], v[128:131], v[96:99], v[168:171]
  v_mfma_f32_16x16x32_bf16 v[172:175], v[132:135], v[96:99], v[172:175]
  v_mfma_f32_16x16x32_bf16 v[176:179], v[136:139], v[96:99], v[176:179]
  s_barrier
  v_cvt_pk_bf16_f32 v140, v140, v141
  v_cvt_pk_bf16_f32 v141, v142, v143
  buffer_store_dwordx2 v[140:141], v12, s[12:15], 0 offen offset:0
  v_cvt_pk_bf16_f32 v144, v144, v145
  v_cvt_pk_bf16_f32 v145, v146, v147
  buffer_store_dwordx2 v[144:145], v12, s[12:15], 0 offen offset:128
  v_cvt_pk_bf16_f32 v148, v148, v149
  v_cvt_pk_bf16_f32 v149, v150, v151
  buffer_store_dwordx2 v[148:149], v12, s[12:15], 0 offen offset:256
  v_cvt_pk_bf16_f32 v152, v152, v153
  v_cvt_pk_bf16_f32 v153, v154, v155
  buffer_store_dwordx2 v[152:153], v12, s[12:15], 0 offen offset:384
  v_cvt_pk_bf16_f32 v156, v156, v157
  v_cvt_pk_bf16_f32 v157, v158, v159
  buffer_store_dwordx2 v[156:157], v12, s[12:15], 0 offen offset:512
  v_cvt_pk_bf16_f32 v160, v160, v161
  v_cvt_pk_bf16_f32 v161, v162, v163
  buffer_store_dwordx2 v[160:161], v12, s[12:15], 0 offen offset:640
  v_cvt_pk_bf16_f32 v164, v164, v165
  v_cvt_pk_bf16_f32 v165, v166, v167
  buffer_store_dwordx2 v[164:165], v12, s[12:15], 0 offen offset:768
  v_cvt_pk_bf16_f32 v168, v168, v169
  v_cvt_pk_bf16_f32 v169, v170, v171
  buffer_store_dwordx2 v[168:169], v12, s[12:15], 0 offen offset:896
  v_cvt_pk_bf16_f32 v172, v172, v173
  v_cvt_pk_bf16_f32 v173, v174, v175
  buffer_store_dwordx2 v[172:173], v12, s[12:15], 0 offen offset:1024
  v_cvt_pk_bf16_f32 v176, v176, v177
  v_cvt_pk_bf16_f32 v177, v178, v179
  buffer_store_dwordx2 v[176:177], v12, s[12:15], 0 offen offset:1152
  s_endpgm
L_recur:
  s_cmp_lt_u32 s44, 8
  s_cbranch_scc1 L_score
  s_cmp_lt_u32 s44, 16
  s_cbranch_scc1 L_value
  v_and_b32 v3, 3, v0
  v_lshlrev_b32 v3, 2, v3
  s_mov_b32 s50, 0
ss_13:
  global_load_dword v2, v3, s[38:39] sc1
  s_add_u32 s50, s50, 1
  s_cmp_gt_u32 s50, 131072
  s_cbranch_scc1 L_fail
  s_waitcnt vmcnt(0)
  v_readlane_b32 s46, v2, 0
  v_readlane_b32 s47, v2, 0
  s_cmp_lg_u32 s46, 0
  s_cselect_b32 s48, 7, 0
  s_add_u32 s46, s46, s2
  s_xor_b32 s49, s46, s43
  s_and_b32 s49, s49, s48
  s_cbranch_scc1 L_reroll
  s_cmp_lg_u32 s47, 0
  s_cbranch_scc1 ss_ok_14
  s_sleep 10
  s_branch ss_13
ss_ok_14:
  s_cmp_lt_u32 s42, 2
  s_cbranch_scc1 rc_nowarm
  s_lshl_b32 s46, s44, 2
  s_add_u32 s46, s46, s43
  s_lshl_b32 s46, s46, 1
  s_add_u32 s46, s46, s42
  s_sub_u32 s46, s46, 130
  s_mul_i32 s46, s46, 20480
  v_lshlrev_b32 v1, 7, v0
  s_add_u32 s47, s46, 0
  buffer_load_dword v2, v1, s[12:15], s47 offen
  s_add_u32 s47, s46, 8192
  buffer_load_dword v2, v1, s[12:15], s47 offen
  s_add_u32 s47, s46, 12288
  buffer_load_dword v2, v1, s[12:15], s47 offen
  s_waitcnt vmcnt(0)
rc_nowarm:
  s_cmp_lt_u32 s44, 26
  s_cbranch_scc1 L_owner
  s_branch L_xowner
L_score:
  s_mov_b32 s4, s26
  s_mov_b32 s5, s27
  s_mov_b32 s6, 7864320
  s_mov_b32 s7, 0x20000
  s_mov_b32 s12, s28
  s_mov_b32 s13, s29
  s_mov_b32 s14, 7864320
  s_mov_b32 s15, 0x20000
  v_lshrrev_b32 v136, 3, v0
  v_lshrrev_b32 v137, 2, v136
  v_lshlrev_b32 v137, 3, v137
  v_and_b32 v64, 3, v136
  v_add_u32 v64, v64, v137
  s_and_b32 s46, s42, 1
  s_lshl_b32 s46, s46, 2
  s_lshr_b32 s47, s42, 1
  s_lshl_b32 s47, s47, 4
  s_add_u32 s46, s46, s47
  v_add_u32 v64, s46, v64
  v_mul_u32_u24 v64, 12288, v64
  v_lshrrev_b32 v136, 1, v136
  v_bfe_u32 v137, v0, 1, 2
  v_xor_b32 v136, v136, v137
  v_lshlrev_b32 v136, 5, v136
  v_and_b32 v137, 1, v0
  v_lshlrev_b32 v137, 4, v137
  v_add3_u32 v64, v64, v136, v137
  v_lshrrev_b32 v136, 5, v0
  v_lshlrev_b32 v65, 11, v136
  v_bfe_u32 v136, v0, 2, 3
  v_lshl_add_u32 v65, v136, 7, v65
  v_lshrrev_b32 v136, 1, v136
  v_xor_b32 v136, s42, v136
  v_lshl_add_u32 v65, v136, 5, v65
  v_and_b32 v136, 3, v0
  v_lshl_add_u32 v65, v136, 3, v65
  v_add_u32 v66, 0x10000, v65
  v_add_u32 v67, 0x20000, v65
  v_lshlrev_b32 v1, 4, v0
  v_add_u32 v2, s51, v1
  v_add_u32 v3, 0x10000, v2
  s_mul_i32 s62, s45, 384
  s_mov_b32 s24, 4096
  s_mov_b32 s25, 49152
  s_add_u32 m0, s51, 73728
  s_add_u32 s46, s62, 786432
  buffer_load_dwordx4 v64, s[12:15], s46 offen lds
  s_add_u32 m0, s51, 77824
  s_add_u32 s46, s62, 1179648
  buffer_load_dwordx4 v64, s[12:15], s46 offen lds
  s_add_u32 m0, s51, 81920
  s_add_u32 s46, s62, 786560
  buffer_load_dwordx4 v64, s[12:15], s46 offen lds
  s_add_u32 m0, s51, 86016
  s_add_u32 s46, s62, 1179776
  buffer_load_dwordx4 v64, s[12:15], s46 offen lds
  s_add_u32 m0, s51, 90112
  s_add_u32 s46, s62, 786688
  buffer_load_dwordx4 v64, s[12:15], s46 offen lds
  s_add_u32 m0, s51, 94208
  s_add_u32 s46, s62, 1179904
  buffer_load_dwordx4 v64, s[12:15], s46 offen lds
  s_add_u32 m0, s51, 98304
  s_add_u32 s46, s62, 1572864
  buffer_load_dwordx4 v64, s[12:15], s46 offen lds
  s_add_u32 m0, s51, 102400
  s_add_u32 s46, s62, 1966080
  buffer_load_dwordx4 v64, s[12:15], s46 offen lds
  s_add_u32 m0, s51, 106496
  s_add_u32 s46, s62, 1572992
  buffer_load_dwordx4 v64, s[12:15], s46 offen lds
  s_add_u32 m0, s51, 110592
  s_add_u32 s46, s62, 1966208
  buffer_load_dwordx4 v64, s[12:15], s46 offen lds
  s_add_u32 m0, s51, 114688
  s_add_u32 s46, s62, 1573120
  buffer_load_dwordx4 v64, s[12:15], s46 offen lds
  s_add_u32 m0, s51, 118784
  s_add_u32 s46, s62, 1966336
  buffer_load_dwordx4 v64, s[12:15], s46 offen lds
  s_add_u32 m0, s51, 122880
  s_add_u32 s46, s62, 2359296
  buffer_load_dwordx4 v64, s[12:15], s46 offen lds
  s_add_u32 m0, s51, 126976
  s_add_u32 s46, s62, 2752512
  buffer_load_dwordx4 v64, s[12:15], s46 offen lds
  s_add_u32 m0, s51, 131072
  s_add_u32 s46, s62, 2359424
  buffer_load_dwordx4 v64, s[12:15], s46 offen lds
  s_add_u32 m0, s51, 135168
  s_add_u32 s46, s62, 2752640
  buffer_load_dwordx4 v64, s[12:15], s46 offen lds
  s_add_u32 m0, s51, 139264
  s_add_u32 s46, s62, 2359552
  buffer_load_dwordx4 v64, s[12:15], s46 offen lds
  s_add_u32 m0, s51, 143360
  s_add_u32 s46, s62, 2752768
  buffer_load_dwordx4 v64, s[12:15], s46 offen lds
  s_add_u32 m0, s51, 0
  s_add_u32 s46, s62, 3145728
  buffer_load_dwordx4 v64, s[12:15], s46 offen lds
  s_add_u32 m0, s51, 4096
  s_add_u32 s46, s62, 3538944
  buffer_load_dwordx4 v64, s[12:15], s46 offen lds
  s_add_u32 m0, s51, 8192
  s_add_u32 s46, s62, 3145856
  buffer_load_dwordx4 v64, s[12:15], s46 offen lds
  s_add_u32 m0, s51, 12288
  s_add_u32 s46, s62, 3539072
  buffer_load_dwordx4 v64, s[12:15], s46 offen lds
  s_add_u32 m0, s51, 16384
  s_add_u32 s46, s62, 3145984
  buffer_load_dwordx4 v64, s[12:15], s46 offen lds
  s_add_u32 m0, s51, 20480
  s_add_u32 s46, s62, 3539200
  buffer_load_dwordx4 v64, s[12:15], s46 offen lds
  s_add_u32 m0, s51, 24576
  s_add_u32 s46, s62, 4718592
  buffer_load_dwordx4 v64, s[12:15], s46 offen lds
  s_add_u32 m0, s51, 28672
  s_add_u32 s46, s62, 5111808
  buffer_load_dwordx4 v64, s[12:15], s46 offen lds
  s_add_u32 m0, s51, 32768
  s_add_u32 s46, s62, 4718720
  buffer_load_dwordx4 v64, s[12:15], s46 offen lds
  s_add_u32 m0, s51, 36864
  s_add_u32 s46, s62, 5111936
  buffer_load_dwordx4 v64, s[12:15], s46 offen lds
  s_add_u32 m0, s51, 40960
  s_add_u32 s46, s62, 4718848
  buffer_load_dwordx4 v64, s[12:15], s46 offen lds
  s_add_u32 m0, s51, 45056
  s_add_u32 s46, s62, 5112064
  buffer_load_dwordx4 v64, s[12:15], s46 offen lds
  s_waitcnt vmcnt(24)
  s_barrier
  s_add_u32 m0, s51, 49152
  s_add_u32 s46, s62, 5505024
  buffer_load_dwordx4 v64, s[12:15], s46 offen lds
  s_add_u32 m0, s51, 53248
  s_add_u32 s46, s62, 5898240
  buffer_load_dwordx4 v64, s[12:15], s46 offen lds
  s_add_u32 m0, s51, 57344
  s_add_u32 s46, s62, 5505152
  buffer_load_dwordx4 v64, s[12:15], s46 offen lds
  s_add_u32 m0, s51, 61440
  s_add_u32 s46, s62, 5898368
  buffer_load_dwordx4 v64, s[12:15], s46 offen lds
  s_add_u32 m0, s51, 65536
  s_add_u32 s46, s62, 5505280
  buffer_load_dwordx4 v64, s[12:15], s46 offen lds
  s_add_u32 m0, s51, 69632
  s_add_u32 s46, s62, 5898496
  buffer_load_dwordx4 v64, s[12:15], s46 offen lds
  ds_read_b64_tr_b16 a[0:1], v66 offset:8192
  ds_read_b64_tr_b16 a[2:3], v66 offset:9216
  ds_read_b64_tr_b16 a[4:5], v66 offset:12288
  ds_read_b64_tr_b16 a[6:7], v66 offset:13312
  ds_read_b64_tr_b16 a[8:9], v66 offset:16384
  ds_read_b64_tr_b16 a[10:11], v66 offset:17408
  ds_read_b64_tr_b16 a[12:13], v66 offset:20480
  ds_read_b64_tr_b16 a[14:15], v66 offset:21504
  ds_read_b64_tr_b16 a[16:17], v66 offset:24576
  ds_read_b64_tr_b16 a[18:19], v66 offset:25600
  ds_read_b64_tr_b16 a[20:21], v66 offset:28672
  ds_read_b64_tr_b16 a[22:23], v66 offset:29696
  s_waitcnt lgkmcnt(0)
  s_waitcnt vmcnt(24)
  s_barrier
  s_add_u32 m0, s51, 73728
  s_add_u32 s46, s62, 6291456
  buffer_load_dwordx4 v64, s[12:15], s46 offen lds
  s_add_u32 m0, s51, 77824
  s_add_u32 s46, s62, 6684672
  buffer_load_dwordx4 v64, s[12:15], s46 offen lds
  s_add_u32 m0, s51, 81920
  s_add_u32 s46, s62, 6291584
  buffer_load_dwordx4 v64, s[12:15], s46 offen lds
  s_add_u32 m0, s51, 86016
  s_add_u32 s46, s62, 6684800
  buffer_load_dwordx4 v64, s[12:15], s46 offen lds
  s_add_u32 m0, s51, 90112
  s_add_u32 s46, s62, 6291712
  buffer_load_dwordx4 v64, s[12:15], s46 offen lds
  s_add_u32 m0, s51, 94208
  s_add_u32 s46, s62, 6684928
  buffer_load_dwordx4 v64, s[12:15], s46 offen lds
  ds_read_b64_tr_b16 a[24:25], v66 offset:32768
  ds_read_b64_tr_b16 a[26:27], v66 offset:33792
  ds_read_b64_tr_b16 a[28:29], v66 offset:36864
  ds_read_b64_tr_b16 a[30:31], v66 offset:37888
  ds_read_b64_tr_b16 a[32:33], v66 offset:40960
  ds_read_b64_tr_b16 a[34:35], v66 offset:41984
  ds_read_b64_tr_b16 a[36:37], v66 offset:45056
  ds_read_b64_tr_b16 a[38:39], v66 offset:46080
  ds_read_b64_tr_b16 a[40:41], v66 offset:49152
  ds_read_b64_tr_b16 a[42:43], v66 offset:50176
  ds_read_b64_tr_b16 a[44:45], v66 offset:53248
  ds_read_b64_tr_b16 a[46:47], v66 offset:54272
  s_waitcnt lgkmcnt(0)
  s_waitcnt vmcnt(24)
  s_barrier
  s_add_u32 m0, s51, 98304
  s_add_u32 s46, s62, 7077888
  buffer_load_dwordx4 v64, s[12:15], s46 offen lds
  s_add_u32 m0, s51, 102400
  s_add_u32 s46, s62, 7471104
  buffer_load_dwordx4 v64, s[12:15], s46 offen lds
  s_add_u32 m0, s51, 106496
  s_add_u32 s46, s62, 7078016
  buffer_load_dwordx4 v64, s[12:15], s46 offen lds
  s_add_u32 m0, s51, 110592
  s_add_u32 s46, s62, 7471232
  buffer_load_dwordx4 v64, s[12:15], s46 offen lds
  s_add_u32 m0, s51, 114688
  s_add_u32 s46, s62, 7078144
  buffer_load_dwordx4 v64, s[12:15], s46 offen lds
  s_add_u32 m0, s51, 118784
  s_add_u32 s46, s62, 7471360
  buffer_load_dwordx4 v64, s[12:15], s46 offen lds
  ds_read_b64_tr_b16 a[48:49], v66 offset:57344
  ds_read_b64_tr_b16 a[50:51], v66 offset:58368
  ds_read_b64_tr_b16 a[52:53], v66 offset:61440
  ds_read_b64_tr_b16 a[54:55], v66 offset:62464
  ds_read_b64_tr_b16 a[56:57], v67 offset:0
  ds_read_b64_tr_b16 a[58:59], v67 offset:1024
  ds_read_b64_tr_b16 a[60:61], v67 offset:4096
  ds_read_b64_tr_b16 a[62:63], v67 offset:5120
  ds_read_b64_tr_b16 a[64:65], v67 offset:8192
  ds_read_b64_tr_b16 a[66:67], v67 offset:9216
  ds_read_b64_tr_b16 a[68:69], v67 offset:12288
  ds_read_b64_tr_b16 a[70:71], v67 offset:13312
  s_waitcnt lgkmcnt(0)
  s_waitcnt vmcnt(24)
  s_barrier
  s_add_u32 m0, s51, 122880
  s_add_u32 s46, s62, 0
  buffer_load_dwordx4 v64, s[4:7], s46 offen lds
  s_add_u32 m0, s51, 126976
  s_add_u32 s46, s62, 393216
  buffer_load_dwordx4 v64, s[4:7], s46 offen lds
  s_add_u32 m0, s51, 131072
  s_add_u32 s46, s62, 128
  buffer_load_dwordx4 v64, s[4:7], s46 offen lds
  s_add_u32 m0, s51, 135168
  s_add_u32 s46, s62, 393344
  buffer_load_dwordx4 v64, s[4:7], s46 offen lds
  s_add_u32 m0, s51, 139264
  s_add_u32 s46, s62, 256
  buffer_load_dwordx4 v64, s[4:7], s46 offen lds
  s_add_u32 m0, s51, 143360
  s_add_u32 s46, s62, 393472
  buffer_load_dwordx4 v64, s[4:7], s46 offen lds
  ds_read_b64_tr_b16 a[72:73], v65 offset:0
  ds_read_b64_tr_b16 a[74:75], v65 offset:1024
  ds_read_b64_tr_b16 a[76:77], v65 offset:4096
  ds_read_b64_tr_b16 a[78:79], v65 offset:5120
  ds_read_b64_tr_b16 a[80:81], v65 offset:8192
  ds_read_b64_tr_b16 a[82:83], v65 offset:9216
  ds_read_b64_tr_b16 a[84:85], v65 offset:12288
  ds_read_b64_tr_b16 a[86:87], v65 offset:13312
  ds_read_b64_tr_b16 a[88:89], v65 offset:16384
  ds_read_b64_tr_b16 a[90:91], v65 offset:17408
  ds_read_b64_tr_b16 a[92:93], v65 offset:20480
  ds_read_b64_tr_b16 a[94:95], v65 offset:21504
  s_waitcnt lgkmcnt(0)
  s_waitcnt vmcnt(24)
  s_barrier
  s_add_u32 m0, s51, 0
  s_add_u32 s46, s62, 786432
  buffer_load_dwordx4 v64, s[4:7], s46 offen lds
  s_add_u32 m0, s51, 4096
  s_add_u32 s46, s62, 1179648
  buffer_load_dwordx4 v64, s[4:7], s46 offen lds
  s_add_u32 m0, s51, 8192
  s_add_u32 s46, s62, 786560
  buffer_load_dwordx4 v64, s[4:7], s46 offen lds
  s_add_u32 m0, s51, 12288
  s_add_u32 s46, s62, 1179776
  buffer_load_dwordx4 v64, s[4:7], s46 offen lds
  s_add_u32 m0, s51, 16384
  s_add_u32 s46, s62, 786688
  buffer_load_dwordx4 v64, s[4:7], s46 offen lds
  s_add_u32 m0, s51, 20480
  s_add_u32 s46, s62, 1179904
  buffer_load_dwordx4 v64, s[4:7], s46 offen lds
  ds_read_b64_tr_b16 a[96:97], v65 offset:24576
  ds_read_b64_tr_b16 a[98:99], v65 offset:25600
  ds_read_b64_tr_b16 a[100:101], v65 offset:28672
  ds_read_b64_tr_b16 a[102:103], v65 offset:29696
  ds_read_b64_tr_b16 a[104:105], v65 offset:32768
  ds_read_b64_tr_b16 a[106:107], v65 offset:33792
  ds_read_b64_tr_b16 a[108:109], v65 offset:36864
  ds_read_b64_tr_b16 a[110:111], v65 offset:37888
  ds_read_b64_tr_b16 a[112:113], v65 offset:40960
  ds_read_b64_tr_b16 a[114:115], v65 offset:41984
  ds_read_b64_tr_b16 a[116:117], v65 offset:45056
  ds_read_b64_tr_b16 a[118:119], v65 offset:46080
  s_waitcnt lgkmcnt(0)
  s_waitcnt vmcnt(24)
  s_barrier
  s_add_u32 m0, s51, 24576
  s_add_u32 s46, s62, 1572864
  buffer_load_dwordx4 v64, s[4:7], s46 offen lds
  s_add_u32 m0, s51, 28672
  s_add_u32 s46, s62, 1966080
  buffer_load_dwordx4 v64, s[4:7], s46 offen lds
  s_add_u32 m0, s51, 32768
  s_add_u32 s46, s62, 1572992
  buffer_load_dwordx4 v64, s[4:7], s46 offen lds
  s_add_u32 m0, s51, 36864
  s_add_u32 s46, s62, 1966208
  buffer_load_dwordx4 v64, s[4:7], s46 offen lds
  s_add_u32 m0, s51, 40960
  s_add_u32 s46, s62, 1573120
  buffer_load_dwordx4 v64, s[4:7], s46 offen lds
  s_add_u32 m0, s51, 45056
  s_add_u32 s46, s62, 1966336
  buffer_load_dwordx4 v64, s[4:7], s46 offen lds
  ds_read_b64_tr_b16 a[120:121], v65 offset:49152
  ds_read_b64_tr_b16 a[122:123], v65 offset:50176
  ds_read_b64_tr_b16 a[124:125], v65 offset:53248
  ds_read_b64_tr_b16 a[126:127], v65 offset:54272
  ds_read_b64_tr_b16 a[128:129], v65 offset:57344
  ds_read_b64_tr_b16 a[130:131], v65 offset:58368
  ds_read_b64_tr_b16 a[132:133], v65 offset:61440
  ds_read_b64_tr_b16 a[134:135], v65 offset:62464
  ds_read_b64_tr_b16 a[136:137], v66 offset:0
  ds_read_b64_tr_b16 a[138:139], v66 offset:1024
  ds_read_b64_tr_b16 a[140:141], v66 offset:4096
  ds_read_b64_tr_b16 a[142:143], v66 offset:5120
  s_waitcnt lgkmcnt(0)
  s_waitcnt vmcnt(24)
  s_barrier
  s_add_u32 m0, s51, 49152
  s_add_u32 s46, s62, 3145728
  buffer_load_dwordx4 v64, s[4:7], s46 offen lds
  s_add_u32 m0, s51, 53248
  s_add_u32 s46, s62, 3538944
  buffer_load_dwordx4 v64, s[4:7], s46 offen lds
  s_add_u32 m0, s51, 57344
  s_add_u32 s46, s62, 3145856
  buffer_load_dwordx4 v64, s[4:7], s46 offen lds
  s_add_u32 m0, s51, 61440
  s_add_u32 s46, s62, 3539072
  buffer_load_dwordx4 v64, s[4:7], s46 offen lds
  s_add_u32 m0, s51, 65536
  s_add_u32 s46, s62, 3145984
  buffer_load_dwordx4 v64, s[4:7], s46 offen lds
  s_add_u32 m0, s51, 69632
  s_add_u32 s46, s62, 3539200
  buffer_load_dwordx4 v64, s[4:7], s46 offen lds
  ds_read_b64_tr_b16 a[144:145], v66 offset:8192
  ds_read_b64_tr_b16 a[146:147], v66 offset:9216
  ds_read_b64_tr_b16 a[148:149], v66 offset:12288
  ds_read_b64_tr_b16 a[150:151], v66 offset:13312
  ds_read_b64_tr_b16 a[152:153], v66 offset:16384
  ds_read_b64_tr_b16 a[154:155], v66 offset:17408
  ds_read_b64_tr_b16 a[156:157], v66 offset:20480
  ds_read_b64_tr_b16 a[158:159], v66 offset:21504
  ds_read_b64_tr_b16 a[160:161], v66 offset:24576
  ds_read_b64_tr_b16 a[162:163], v66 offset:25600
  ds_read_b64_tr_b16 a[164:165], v66 offset:28672
  ds_read_b64_tr_b16 a[166:167], v66 offset:29696
  s_waitcnt lgkmcnt(0)
  s_waitcnt vmcnt(24)
  s_barrier
  s_add_u32 m0, s51, 73728
  s_add_u32 s46, s62, 3932160
  buffer_load_dwordx4 v64, s[4:7], s46 offen lds
  s_add_u32 m0, s51, 77824
  s_add_u32 s46, s62, 4325376
  buffer_load_dwordx4 v64, s[4:7], s46 offen lds
  s_add_u32 m0, s51, 81920
  s_add_u32 s46, s62, 3932288
  buffer_load_dwordx4 v64, s[4:7], s46 offen lds
  s_add_u32 m0, s51, 86016
  s_add_u32 s46, s62, 4325504
  buffer_load_dwordx4 v64, s[4:7], s46 offen lds
  s_add_u32 m0, s51, 90112
  s_add_u32 s46, s62, 3932416
  buffer_load_dwordx4 v64, s[4:7], s46 offen lds
  s_add_u32 m0, s51, 94208
  s_add_u32 s46, s62, 4325632
  buffer_load_dwordx4 v64, s[4:7], s46 offen lds
  ds_read_b64_tr_b16 a[168:169], v66 offset:32768
  ds_read_b64_tr_b16 a[170:171], v66 offset:33792
  ds_read_b64_tr_b16 a[172:173], v66 offset:36864
  ds_read_b64_tr_b16 a[174:175], v66 offset:37888
  ds_read_b64_tr_b16 a[176:177], v66 offset:40960
  ds_read_b64_tr_b16 a[178:179], v66 offset:41984
  ds_read_b64_tr_b16 a[180:181], v66 offset:45056
  ds_read_b64_tr_b16 a[182:183], v66 offset:46080
  ds_read_b64_tr_b16 a[184:185], v66 offset:49152
  ds_read_b64_tr_b16 a[186:187], v66 offset:50176
  ds_read_b64_tr_b16 a[188:189], v66 offset:53248
  ds_read_b64_tr_b16 a[190:191], v66 offset:54272
  s_waitcnt lgkmcnt(0)
  s_waitcnt vmcnt(24)
  s_barrier
  s_add_u32 m0, s51, 98304
  s_add_u32 s46, s62, 5505024
  buffer_load_dwordx4 v64, s[4:7], s46 offen lds
  s_add_u32 m0, s51, 102400
  s_add_u32 s46, s62, 5898240
  buffer_load_dwordx4 v64, s[4:7], s46 offen lds
  s_add_u32 m0, s51, 106496
  s_add_u32 s46, s62, 5505152
  buffer_load_dwordx4 v64, s[4:7], s46 offen lds
  s_add_u32 m0, s51, 110592
  s_add_u32 s46, s62, 5898368
  buffer_load_dwordx4 v64, s[4:7], s46 offen lds
  s_add_u32 m0, s51, 114688
  s_add_u32 s46, s62, 5505280
  buffer_load_dwordx4 v64, s[4:7], s46 offen lds
  s_add_u32 m0, s51, 118784
  s_add_u32 s46, s62, 5898496
  buffer_load_dwordx4 v64, s[4:7], s46 offen lds
  ds_read_b64_tr_b16 a[192:193], v66 offset:57344
  ds_read_b64_tr_b16 a[194:195], v66 offset:58368
  ds_read_b64_tr_b16 a[196:197], v66 offset:61440
  ds_read_b64_tr_b16 a[198:199], v66 offset:62464
  ds_read_b64_tr_b16 a[200:201], v67 offset:0
  ds_read_b64_tr_b16 a[202:203], v67 offset:1024
  ds_read_b64_tr_b16 a[204:205], v67 offset:4096
  ds_read_b64_tr_b16 a[206:207], v67 offset:5120
  ds_read_b64_tr_b16 a[208:209], v67 offset:8192
  ds_read_b64_tr_b16 a[210:211], v67 offset:9216
  ds_read_b64_tr_b16 a[212:213], v67 offset:12288
  ds_read_b64_tr_b16 a[214:215], v67 offset:13312
  s_waitcnt lgkmcnt(0)
  s_waitcnt vmcnt(24)
  s_barrier
  s_add_u32 m0, s51, 122880
  s_add_u32 s46, s62, 6291456
  buffer_load_dwordx4 v64, s[4:7], s46 offen lds
  s_add_u32 m0, s51, 126976
  s_add_u32 s46, s62, 6684672
  buffer_load_dwordx4 v64, s[4:7], s46 offen lds
  s_add_u32 m0, s51, 131072
  s_add_u32 s46, s62, 6291584
  buffer_load_dwordx4 v64, s[4:7], s46 offen lds
  s_add_u32 m0, s51, 135168
  s_add_u32 s46, s62, 6684800
  buffer_load_dwordx4 v64, s[4:7], s46 offen lds
  s_add_u32 m0, s51, 139264
  s_add_u32 s46, s62, 6291712
  buffer_load_dwordx4 v64, s[4:7], s46 offen lds
  s_add_u32 m0, s51, 143360
  s_add_u32 s46, s62, 6684928
  buffer_load_dwordx4 v64, s[4:7], s46 offen lds
  ds_read_b64_tr_b16 a[216:217], v65 offset:0
  ds_read_b64_tr_b16 a[218:219], v65 offset:1024
  ds_read_b64_tr_b16 a[220:221], v65 offset:4096
  ds_read_b64_tr_b16 a[222:223], v65 offset:5120
  ds_read_b64_tr_b16 a[224:225], v65 offset:8192
  ds_read_b64_tr_b16 a[226:227], v65 offset:9216
  ds_read_b64_tr_b16 a[228:229], v65 offset:12288
  ds_read_b64_tr_b16 a[230:231], v65 offset:13312
  ds_read_b64_tr_b16 a[232:233], v65 offset:16384
  ds_read_b64_tr_b16 a[234:235], v65 offset:17408
  ds_read_b64_tr_b16 a[236:237], v65 offset:20480
  ds_read_b64_tr_b16 a[238:239], v65 offset:21504
  s_waitcnt lgkmcnt(0)
  s_waitcnt vmcnt(24)
  s_barrier
  s_add_u32 m0, s51, 0
  s_add_u32 s46, s62, 0
  buffer_load_dwordx4 v64, s[12:15], s46 offen lds
  s_add_u32 m0, s51, 4096
  s_add_u32 s46, s62, 393216
  buffer_load_dwordx4 v64, s[12:15], s46 offen lds
  s_add_u32 m0, s51, 8192
  s_add_u32 s46, s62, 128
  buffer_load_dwordx4 v64, s[12:15], s46 offen lds
  s_add_u32 m0, s51, 12288
  s_add_u32 s46, s62, 393344
  buffer_load_dwordx4 v64, s[12:15], s46 offen lds
  s_add_u32 m0, s51, 16384
  s_add_u32 s46, s62, 256
  buffer_load_dwordx4 v64, s[12:15], s46 offen lds
  s_add_u32 m0, s51, 20480
  s_add_u32 s46, s62, 393472
  buffer_load_dwordx4 v64, s[12:15], s46 offen lds
  ds_read_b64_tr_b16 a[240:241], v65 offset:24576
  ds_read_b64_tr_b16 a[242:243], v65 offset:25600
  ds_read_b64_tr_b16 a[244:245], v65 offset:28672
  ds_read_b64_tr_b16 a[246:247], v65 offset:29696
  ds_read_b64_tr_b16 a[248:249], v65 offset:32768
  ds_read_b64_tr_b16 a[250:251], v65 offset:33792
  ds_read_b64_tr_b16 a[252:253], v65 offset:36864
  ds_read_b64_tr_b16 a[254:255], v65 offset:37888
  ds_read_b64_tr_b16 v[152:153], v65 offset:40960
  ds_read_b64_tr_b16 v[154:155], v65 offset:41984
  ds_read_b64_tr_b16 v[156:157], v65 offset:45056
  ds_read_b64_tr_b16 v[158:159], v65 offset:46080
  s_waitcnt lgkmcnt(0)
  s_waitcnt vmcnt(24)
  s_barrier
  s_add_u32 m0, s51, 24576
  s_add_u32 s46, s62, 3932160
  buffer_load_dwordx4 v64, s[12:15], s46 offen lds
  s_add_u32 m0, s51, 28672
  s_add_u32 s46, s62, 4325376
  buffer_load_dwordx4 v64, s[12:15], s46 offen lds
  s_add_u32 m0, s51, 32768
  s_add_u32 s46, s62, 3932288
  buffer_load_dwordx4 v64, s[12:15], s46 offen lds
  s_add_u32 m0, s51, 36864
  s_add_u32 s46, s62, 4325504
  buffer_load_dwordx4 v64, s[12:15], s46 offen lds
  s_add_u32 m0, s51, 40960
  s_add_u32 s46, s62, 3932416
  buffer_load_dwordx4 v64, s[12:15], s46 offen lds
  s_add_u32 m0, s51, 45056
  s_add_u32 s46, s62, 4325632
  buffer_load_dwordx4 v64, s[12:15], s46 offen lds
  ds_read_b64_tr_b16 v[160:161], v65 offset:49152
  ds_read_b64_tr_b16 v[162:163], v65 offset:50176
  ds_read_b64_tr_b16 v[164:165], v65 offset:53248
  ds_read_b64_tr_b16 v[166:167], v65 offset:54272
  ds_read_b64_tr_b16 v[168:169], v65 offset:57344
  ds_read_b64_tr_b16 v[170:171], v65 offset:58368
  ds_read_b64_tr_b16 v[172:173], v65 offset:61440
  ds_read_b64_tr_b16 v[174:175], v65 offset:62464
  ds_read_b64_tr_b16 v[176:177], v66 offset:0
  ds_read_b64_tr_b16 v[178:179], v66 offset:1024
  ds_read_b64_tr_b16 v[180:181], v66 offset:4096
  ds_read_b64_tr_b16 v[182:183], v66 offset:5120
  s_waitcnt lgkmcnt(0)
  s_waitcnt vmcnt(24)
  s_barrier
  s_add_u32 m0, s51, 49152
  s_add_u32 s46, s62, 2359296
  buffer_load_dwordx4 v64, s[4:7], s46 offen lds
  s_add_u32 m0, s51, 53248
  s_add_u32 s46, s62, 2752512
  buffer_load_dwordx4 v64, s[4:7], s46 offen lds
  s_add_u32 m0, s51, 57344
  s_add_u32 s46, s62, 2359424
  buffer_load_dwordx4 v64, s[4:7], s46 offen lds
  s_add_u32 m0, s51, 61440
  s_add_u32 s46, s62, 2752640
  buffer_load_dwordx4 v64, s[4:7], s46 offen lds
  s_add_u32 m0, s51, 65536
  s_add_u32 s46, s62, 2359552
  buffer_load_dwordx4 v64, s[4:7], s46 offen lds
  s_add_u32 m0, s51, 69632
  s_add_u32 s46, s62, 2752768
  buffer_load_dwordx4 v64, s[4:7], s46 offen lds
  ds_read_b64_tr_b16 v[184:185], v66 offset:8192
  ds_read_b64_tr_b16 v[186:187], v66 offset:9216
  ds_read_b64_tr_b16 v[188:189], v66 offset:12288
  ds_read_b64_tr_b16 v[190:191], v66 offset:13312
  ds_read_b64_tr_b16 v[192:193], v66 offset:16384
  ds_read_b64_tr_b16 v[194:195], v66 offset:17408
  ds_read_b64_tr_b16 v[196:197], v66 offset:20480
  ds_read_b64_tr_b16 v[198:199], v66 offset:21504
  ds_read_b64_tr_b16 v[200:201], v66 offset:24576
  ds_read_b64_tr_b16 v[202:203], v66 offset:25600
  ds_read_b64_tr_b16 v[204:205], v66 offset:28672
  ds_read_b64_tr_b16 v[206:207], v66 offset:29696
  s_waitcnt lgkmcnt(0)
  s_waitcnt vmcnt(24)
  s_barrier
  s_add_u32 m0, s51, 73728
  s_add_u32 s46, s62, 4718592
  buffer_load_dwordx4 v64, s[4:7], s46 offen lds
  s_add_u32 m0, s51, 77824
  s_add_u32 s46, s62, 5111808
  buffer_load_dwordx4 v64, s[4:7], s46 offen lds
  s_add_u32 m0, s51, 81920
  s_add_u32 s46, s62, 4718720
  buffer_load_dwordx4 v64, s[4:7], s46 offen lds
  s_add_u32 m0, s51, 86016
  s_add_u32 s46, s62, 5111936
  buffer_load_dwordx4 v64, s[4:7], s46 offen lds
  s_add_u32 m0, s51, 90112
  s_add_u32 s46, s62, 4718848
  buffer_load_dwordx4 v64, s[4:7], s46 offen lds
  s_add_u32 m0, s51, 94208
  s_add_u32 s46, s62, 5112064
  buffer_load_dwordx4 v64, s[4:7], s46 offen lds
  ds_read_b64_tr_b16 v[208:209], v66 offset:32768
  ds_read_b64_tr_b16 v[210:211], v66 offset:33792
  ds_read_b64_tr_b16 v[212:213], v66 offset:36864
  ds_read_b64_tr_b16 v[214:215], v66 offset:37888
  ds_read_b64_tr_b16 v[216:217], v66 offset:40960
  ds_read_b64_tr_b16 v[218:219], v66 offset:41984
  ds_read_b64_tr_b16 v[220:221], v66 offset:45056
  ds_read_b64_tr_b16 v[222:223], v66 offset:46080
  ds_read_b64_tr_b16 v[224:225], v66 offset:49152
  ds_read_b64_tr_b16 v[226:227], v66 offset:50176
  ds_read_b64_tr_b16 v[228:229], v66 offset:53248
  ds_read_b64_tr_b16 v[230:231], v66 offset:54272
  s_waitcnt lgkmcnt(0)
  s_waitcnt vmcnt(24)
  s_barrier
  s_add_u32 m0, s51, 98304
  s_add_u32 s46, s62, 7077888
  buffer_load_dwordx4 v64, s[4:7], s46 offen lds
  s_add_u32 m0, s51, 102400
  s_add_u32 s46, s62, 7471104
  buffer_load_dwordx4 v64, s[4:7], s46 offen lds
  s_add_u32 m0, s51, 106496
  s_add_u32 s46, s62, 7078016
  buffer_load_dwordx4 v64, s[4:7], s46 offen lds
  s_add_u32 m0, s51, 110592
  s_add_u32 s46, s62, 7471232
  buffer_load_dwordx4 v64, s[4:7], s46 offen lds
  s_add_u32 m0, s51, 114688
  s_add_u32 s46, s62, 7078144
  buffer_load_dwordx4 v64, s[4:7], s46 offen lds
  s_add_u32 m0, s51, 118784
  s_add_u32 s46, s62, 7471360
  buffer_load_dwordx4 v64, s[4:7], s46 offen lds
  ds_read_b64_tr_b16 v[232:233], v66 offset:57344
  ds_read_b64_tr_b16 v[234:235], v66 offset:58368
  ds_read_b64_tr_b16 v[236:237], v66 offset:61440
  ds_read_b64_tr_b16 v[238:239], v66 offset:62464
  ds_read_b64_tr_b16 v[240:241], v67 offset:0
  ds_read_b64_tr_b16 v[242:243], v67 offset:1024
  ds_read_b64_tr_b16 v[244:245], v67 offset:4096
  ds_read_b64_tr_b16 v[246:247], v67 offset:5120
  ds_read_b64_tr_b16 v[248:249], v67 offset:8192
  ds_read_b64_tr_b16 v[250:251], v67 offset:9216
  ds_read_b64_tr_b16 v[252:253], v67 offset:12288
  ds_read_b64_tr_b16 v[254:255], v67 offset:13312
  s_waitcnt lgkmcnt(0)
  s_waitcnt vmcnt(24)
  s_barrier
  ds_read_b64_tr_b16 v[40:41], v65 offset:0
  ds_read_b64_tr_b16 v[42:43], v65 offset:1024
  ds_read_b64_tr_b16 v[44:45], v65 offset:4096
  ds_read_b64_tr_b16 v[46:47], v65 offset:5120
  ds_read_b64_tr_b16 v[48:49], v65 offset:8192
  ds_read_b64_tr_b16 v[50:51], v65 offset:9216
  ds_read_b64_tr_b16 v[52:53], v65 offset:12288
  ds_read_b64_tr_b16 v[54:55], v65 offset:13312
  ds_read_b64_tr_b16 v[56:57], v65 offset:16384
  ds_read_b64_tr_b16 v[58:59], v65 offset:17408
  ds_read_b64_tr_b16 v[60:61], v65 offset:20480
  ds_read_b64_tr_b16 v[62:63], v65 offset:21504
  s_waitcnt lgkmcnt(0)
  s_waitcnt vmcnt(18)
  s_barrier
  ds_write_b128 v2, v[40:43] offset:0
  ds_write_b128 v2, v[44:47] offset:4096
  ds_write_b128 v2, v[48:51] offset:8192
  ds_write_b128 v2, v[52:55] offset:12288
  ds_write_b128 v2, v[56:59] offset:16384
  ds_write_b128 v2, v[60:63] offset:20480
  ds_read_b64_tr_b16 v[16:17], v65 offset:24576
  ds_read_b64_tr_b16 v[18:19], v65 offset:25600
  ds_read_b64_tr_b16 v[20:21], v65 offset:28672
  ds_read_b64_tr_b16 v[22:23], v65 offset:29696
  ds_read_b64_tr_b16 v[24:25], v65 offset:32768
  ds_read_b64_tr_b16 v[26:27], v65 offset:33792
  ds_read_b64_tr_b16 v[28:29], v65 offset:36864
  ds_read_b64_tr_b16 v[30:31], v65 offset:37888
  ds_read_b64_tr_b16 v[32:33], v65 offset:40960
  ds_read_b64_tr_b16 v[34:35], v65 offset:41984
  ds_read_b64_tr_b16 v[36:37], v65 offset:45056
  ds_read_b64_tr_b16 v[38:39], v65 offset:46080
  s_waitcnt lgkmcnt(0)
  s_waitcnt vmcnt(12)
  s_barrier
  ds_write_b128 v2, v[16:19] offset:24576
  ds_write_b128 v2, v[20:23] offset:28672
  ds_write_b128 v2, v[24:27] offset:32768
  ds_write_b128 v2, v[28:31] offset:36864
  ds_write_b128 v2, v[32:35] offset:40960
  ds_write_b128 v2, v[36:39] offset:45056
  ds_read_b64_tr_b16 v[40:41], v65 offset:49152
  ds_read_b64_tr_b16 v[42:43], v65 offset:50176
  ds_read_b64_tr_b16 v[44:45], v65 offset:53248
  ds_read_b64_tr_b16 v[46:47], v65 offset:54272
  ds_read_b64_tr_b16 v[48:49], v65 offset:57344
  ds_read_b64_tr_b16 v[50:51], v65 offset:58368
  ds_read_b64_tr_b16 v[52:53], v65 offset:61440
  ds_read_b64_tr_b16 v[54:55], v65 offset:62464
  ds_read_b64_tr_b16 v[56:57], v66 offset:0
  ds_read_b64_tr_b16 v[58:59], v66 offset:1024
  ds_read_b64_tr_b16 v[60:61], v66 offset:4096
  ds_read_b64_tr_b16 v[62:63], v66 offset:5120
  s_waitcnt lgkmcnt(0)
  s_waitcnt vmcnt(6)
  s_barrier
  ds_write_b128 v2, v[40:43] offset:49152
  ds_write_b128 v2, v[44:47] offset:53248
  ds_write_b128 v2, v[48:51] offset:57344
  ds_write_b128 v2, v[52:55] offset:61440
  ds_write_b128 v3, v[56:59] offset:0
  ds_write_b128 v3, v[60:63] offset:4096
  ds_read_b64_tr_b16 v[16:17], v66 offset:8192
  ds_read_b64_tr_b16 v[18:19], v66 offset:9216
  ds_read_b64_tr_b16 v[20:21], v66 offset:12288
  ds_read_b64_tr_b16 v[22:23], v66 offset:13312
  ds_read_b64_tr_b16 v[24:25], v66 offset:16384
  ds_read_b64_tr_b16 v[26:27], v66 offset:17408
  ds_read_b64_tr_b16 v[28:29], v66 offset:20480
  ds_read_b64_tr_b16 v[30:31], v66 offset:21504
  ds_read_b64_tr_b16 v[32:33], v66 offset:24576
  ds_read_b64_tr_b16 v[34:35], v66 offset:25600
  ds_read_b64_tr_b16 v[36:37], v66 offset:28672
  ds_read_b64_tr_b16 v[38:39], v66 offset:29696
  s_waitcnt lgkmcnt(0)
  s_waitcnt vmcnt(0)
  s_barrier
  ds_write_b128 v3, v[16:19] offset:8192
  ds_write_b128 v3, v[20:23] offset:12288
  ds_write_b128 v3, v[24:27] offset:16384
  ds_write_b128 v3, v[28:31] offset:20480
  ds_write_b128 v3, v[32:35] offset:24576
  ds_write_b128 v3, v[36:39] offset:28672
  ds_read_b64_tr_b16 v[40:41], v66 offset:32768
  ds_read_b64_tr_b16 v[42:43], v66 offset:33792
  ds_read_b64_tr_b16 v[44:45], v66 offset:36864
  ds_read_b64_tr_b16 v[46:47], v66 offset:37888
  ds_read_b64_tr_b16 v[48:49], v66 offset:40960
  ds_read_b64_tr_b16 v[50:51], v66 offset:41984
  ds_read_b64_tr_b16 v[52:53], v66 offset:45056
  ds_read_b64_tr_b16 v[54:55], v66 offset:46080
  ds_read_b64_tr_b16 v[56:57], v66 offset:49152
  ds_read_b64_tr_b16 v[58:59], v66 offset:50176
  ds_read_b64_tr_b16 v[60:61], v66 offset:53248
  ds_read_b64_tr_b16 v[62:63], v66 offset:54272
  s_waitcnt lgkmcnt(0)
  s_barrier
  ds_write_b128 v3, v[40:43] offset:32768
  ds_write_b128 v3, v[44:47] offset:36864
  ds_write_b128 v3, v[48:51] offset:40960
  ds_write_b128 v3, v[52:55] offset:45056
  ds_write_b128 v3, v[56:59] offset:49152
  ds_write_b128 v3, v[60:63] offset:53248
  s_waitcnt lgkmcnt(0)
  v_and_b32 v137, 3, v0
  v_lshlrev_b32 v137, 2, v137
  s_mov_b32 s50, 0
ss_15:
  global_load_dword v136, v137, s[38:39] sc1
  s_add_u32 s50, s50, 1
  s_cmp_gt_u32 s50, 131072
  s_cbranch_scc1 L_fail
  s_waitcnt vmcnt(0)
  v_readlane_b32 s46, v136, 0
  v_readlane_b32 s47, v136, 2
  s_cmp_lg_u32 s46, 0
  s_cselect_b32 s48, 7, 0
  s_add_u32 s46, s46, s2
  s_xor_b32 s49, s46, s43
  s_and_b32 s49, s49, s48
  s_cbranch_scc1 L_reroll
  s_cmp_lg_u32 s47, 0
  s_cbranch_scc1 ss_ok_16
  s_sleep 10
  s_branch ss_15
ss_ok_16:
  v_readlane_b32 s3, v136, 1
  s_nop 0
  s_and_b32 s3, s3, 0x2000
  v_and_b32 v136, 3, v0
  s_lshl_b32 s46, s43, 9
  s_add_u32 s46, s46, s3
  s_add_u32 s46, s46, 13369344
  v_lshl_add_u32 v10, v136, 7, s46
  s_lshl_b32 s46, s43, 7
  s_add_u32 s46, s46, s3
  s_add_u32 s46, s46, 13371392
  v_lshl_add_u32 v11, v136, 9, s46
  v_mov_b32 v7, 0x44444444
  v_mov_b32 v136, 0xeeeeeeee
  v_and_b32 v137, 2, v0
  v_cmp_ne_u32 vcc, 0, v137
  s_nop 1
  v_cndmask_b32 v7, v7, v136, vcc
  s_mov_b32 s69, 1037384597
  s_mov_b32 s70, 3494803967
  v_and_b32 v136, 15, v0
  v_lshrrev_b32 v138, 4, v0
  v_lshlrev_b32 v4, 4, v136
  v_lshl_add_u32 v4, v138, 2, v4
  s_lshl_b32 s46, s42, 8
  s_add_u32 s46, s46, 147456
  v_add_u32 v4, s46, v4
  v_lshlrev_b32 v5, 7, v138
  v_bfe_u32 v137, v0, 2, 2
  v_lshl_add_u32 v5, v137, 4, v5
  v_and_b32 v137, 1, v0
  v_lshl_add_u32 v5, v137, 3, v5
  v_add_u32 v5, 147456, v5
  v_add_u32 v13, 122880, v1
  v_add_u32 v149, 153600, v1
  v_bfe_u32 v140, v0, 1, 2
  v_lshl_add_u32 v140, v140, 2, v137
  v_bfe_u32 v137, v0, 3, 1
  v_lshl_add_u32 v140, v137, 1, v140
  v_cmp_eq_u32 s[18:19], 1, v137
  s_add_u32 s46, s3, 12582912
  s_lshr_b32 s47, s45, 4
  s_add_u32 s47, s47, 1
  s_lshl_b32 s47, s47, 14
  s_and_b32 s48, s45, 15
  s_lshl_b32 s48, s48, 9
  s_add_u32 s47, s47, s48
  s_add_u32 s47, s47, s46
  v_lshrrev_b32 v137, 1, v138
  v_and_b32 v139, 1, v138
  v_lshl_add_u32 v8, v137, 4, v140
  v_lshlrev_b32 v8, 4, v8
  v_lshl_add_u32 v8, v139, 3, v8
  v_add_u32 v8, s47, v8
  s_lshl_b32 s47, s45, 7
  s_add_u32 s47, s47, s46
  s_add_u32 s47, s47, 51200
  v_lshlrev_b32 v9, 3, v140
  v_lshl_add_u32 v9, v139, 2, v9
  v_add_u32 v9, s47, v9
  v_lshl_add_u32 v9, v137, 30, v9
  v_mov_b32 v140, 2146435072
  s_cmp_eq_u32 s44, 0
  s_cselect_b64 vcc, 15, 0
  v_cndmask_b32 v11, v140, v11, vcc
  v_lshlrev_b32 v14, 4, v136
  v_lshl_add_u32 v14, v139, 3, v14
  v_lshl_add_u32 v14, v137, 2, v14
  s_lshl_b32 s47, s45, 8
  s_add_u32 s47, s47, 65536
  v_add_u32 v14, s47, v14
  s_lshl_b32 s47, s42, 4
  v_add_u32 v136, s47, v136
  v_lshlrev_b32 v138, 2, v138
  v_sub_u32 v136, v136, v138
  v_cmp_gt_i32 s[72:73], 0, v136
  v_cmp_gt_i32 s[74:75], 1, v136
  v_cmp_gt_i32 s[76:77], 2, v136
  v_cmp_gt_i32 s[78:79], 3, v136
  v_cmp_gt_i32 s[80:81], 16, v136
  v_cmp_gt_i32 s[82:83], 17, v136
  v_cmp_gt_i32 s[84:85], 18, v136
  v_cmp_gt_i32 s[86:87], 19, v136
  s_lshl_b32 s46, s45, 7
  s_lshl_b32 s47, s42, 2
  s_add_u32 s47, s47, s46
  s_add_u32 s47, s47, 1069056
  v_mov_b32 v15, s47
  s_cmp_lg_u32 s42, 2
  s_cbranch_scc1 sc_fl
  v_and_b32 v15, 1, v0
  v_lshlrev_b32 v15, 12, v15
  s_add_u32 s46, s46, 1048576
  v_add_u32 v15, s46, v15
sc_fl:
  s_mov_b32 s23, s45
  s_lshl_b32 s20, s42, 24
  s_add_u32 s20, s20, s3
  s_add_u32 s20, s20, 31457280
  s_lshl_b32 s26, s42, 11
  s_lshl_b32 s46, s42, 24
  s_sub_u32 s26, s26, s46
  s_cmp_eq_u32 s42, 2
  s_cselect_b32 s26, 2012217344, s26
  s_lshl_b32 s21, s42, 12
  s_add_u32 s21, s21, 122880
  s_mov_b32 s22, 12288
  s_mul_i32 s64, s42, 81920
  s_add_u32 s64, s64, s3
  s_add_u32 s64, s64, 14680064
  s_lshr_b32 s27, s45, 3
  s_lshl_b32 s27, s27, 14
  s_and_b32 s46, s45, 7
  s_lshl_b32 s46, s46, 10
  s_add_u32 s27, s27, s46
  s_mov_b32 s61, 0
  s_mov_b32 s52, 0
  s_mov_b32 s58, 0
  s_mov_b32 s65, 524288
  s_mov_b32 s100, 0
  s_add_u32 s46, s42, 3
  s_lshl_b32 s31, s46, 10
  s_cmp_ge_u32 s46, 8
  s_cselect_b32 s47, 40960, 0
  s_add_u32 s31, s31, s47
  s_cmp_ge_u32 s46, 10
  s_cselect_b32 s31, 2146435072, s31
  s_add_u32 s46, s42, 7
  s_lshl_b32 s32, s46, 10
  s_cmp_ge_u32 s46, 8
  s_cselect_b32 s47, 40960, 0
  s_add_u32 s32, s32, s47
  s_cmp_ge_u32 s46, 10
  s_cselect_b32 s32, 2146435072, s32
  s_cmp_lg_u32 s42, 2
  s_cbranch_scc1 sc_k0
  s_mov_b32 s53, 1
  s_cmp_ge_u32 s61, s53
  s_cbranch_scc1 wf_done_17
  s_mov_b32 s50, 0
wf_loop_18:
  buffer_load_dword v136, v15, s[8:11], 0 offen sc1
  s_add_u32 s50, s50, 1
  s_cmp_gt_u32 s50, 131072
  s_cbranch_scc1 L_fail
  s_waitcnt vmcnt(0)
  v_min_u32_dpp v136, v136, v136 row_ror:8 row_mask:0xf bank_mask:0xf
  s_nop 1
  v_min_u32_dpp v136, v136, v136 row_ror:4 row_mask:0xf bank_mask:0xf
  s_nop 1
  v_min_u32_dpp v136, v136, v136 row_ror:2 row_mask:0xf bank_mask:0xf
  s_nop 1
  v_min_u32_dpp v136, v136, v136 row_ror:1 row_mask:0xf bank_mask:0xf
  v_mov_b32 v137, v136
  s_nop 1
  v_permlane16_swap_b32 v137, v136
  v_min_u32 v136, v136, v137
  v_mov_b32 v137, v136
  s_nop 1
  v_permlane32_swap_b32 v137, v136
  v_min_u32 v136, v136, v137
  s_nop 0
  v_readfirstlane_b32 s61, v136
  s_nop 0
  s_cmp_ge_u32 s61, s53
  s_cbranch_scc1 wf_done_17
  s_sleep 2
  s_branch wf_loop_18
wf_done_17:
sc_k0:
  s_barrier
  s_cmp_eq_u32 s42, 3
  s_cbranch_scc1 scs_loop
  s_mov_b32 m0, s21
  s_lshr_b32 s63, s23, 1
  s_lshl_b32 s63, s63, 14
  s_and_b32 s46, s23, 1
  s_lshl_b32 s46, s46, 12
  s_add_u32 s63, s63, s46
  s_add_u32 s63, s63, s20
  s_lshr_b32 s46, s63, 8
  s_and_b32 s46, s46, 0x2000
  s_xor_b32 s63, s63, s46
  buffer_load_dwordx4 v1, s[8:11], s63 offen offset:0 sc1 lds
  buffer_load_dwordx4 v1, s[8:11], s63 offen offset:1024 sc1 lds
  buffer_load_dwordx4 v1, s[8:11], s63 offen offset:2048 sc1 lds
  buffer_load_dwordx4 v1, s[8:11], s63 offen offset:3072 sc1 lds
  s_waitcnt vmcnt(0)
  s_branch sch_loop
scs_loop:
  s_add_u32 s53, s52, 1
  s_lshl_b32 s56, s58, 2
  s_add_u32 s56, s56, s43
  s_lshl_b32 s56, s56, 16
  s_add_u32 s56, s56, s3
  s_add_u32 s56, s56, 12582912
  v_add_u32 v12, s56, v1
  s_lshl_b32 s66, s58, 18
  s_mov_b64 s[16:17], -1
  s_mov_b32 s71, 0
  ds_read_b128 v[56:59], v2 offset:0
  ds_read_b128 v[60:63], v2 offset:4096
  ds_read_b128 v[64:67], v2 offset:8192
  ds_read_b128 v[68:71], v2 offset:12288
  ds_read_b128 v[72:75], v2 offset:16384
  ds_read_b128 v[76:79], v2 offset:20480
  ds_read_b128 v[80:83], v2 offset:49152
  ds_read_b128 v[84:87], v2 offset:53248
  v_mov_b32 v88, 0
  v_mov_b32 v89, 0
  v_mov_b32 v90, 0
  v_mov_b32 v91, 0
  v_mov_b32 v92, 0
  v_mov_b32 v93, 0
  v_mov_b32 v94, 0
  v_mov_b32 v95, 0
  v_mov_b32 v96, 0
  v_mov_b32 v97, 0
  v_mov_b32 v98, 0
  v_mov_b32 v99, 0
  v_mov_b32 v100, 0
  v_mov_b32 v101, 0
  v_mov_b32 v102, 0
  v_mov_b32 v103, 0
  v_mov_b32 v104, 0
  v_mov_b32 v105, 0
  v_mov_b32 v106, 0
  v_mov_b32 v107, 0
  v_mov_b32 v108, 0
  v_mov_b32 v109, 0
  v_mov_b32 v110, 0
  v_mov_b32 v111, 0
  v_mov_b32 v6, s53
  s_mov_b32 s50, 0
scs_top:
  s_waitcnt lgkmcnt(0)
  s_barrier
  buffer_load_dwordx4 v[16:19], v12, s[8:11], 0 offen offset:0 sc1
  s_add_u32 m0, s51, 153600
  s_barrier
  buffer_load_dwordx4 v[20:23], v12, s[8:11], 0 offen offset:1024 sc1
  s_barrier
  buffer_load_dwordx4 v[24:27], v12, s[8:11], 0 offen offset:2048 sc1
  s_barrier
  buffer_load_dwordx4 v12, s[8:11], s31 offen sc1 lds
  s_add_u32 m0, s51, 157696
  s_barrier
  buffer_load_dwordx4 v12, s[8:11], s32 offen sc1 lds
  s_waitcnt vmcnt(4)
scs_go:
  v_smfmac_f32_16x16x64_bf16 v[88:91], v[16:19], a[192:199], v7
  v_smfmac_f32_16x16x64_bf16 v[92:95], v[16:19], a[200:207], v7
  v_smfmac_f32_16x16x64_bf16 v[96:99], v[16:19], a[208:215], v7
  v_smfmac_f32_16x16x64_bf16 v[100:103], v[16:19], v[56:63], v7
  v_smfmac_f32_16x16x64_bf16 v[104:107], v[16:19], v[64:71], v7
  ds_read_b128 v[56:59], v2 offset:57344
  v_smfmac_f32_16x16x64_bf16 v[108:111], v[16:19], v[72:79], v7
  s_waitcnt vmcnt(3)
  ds_read_b128 v[60:63], v2 offset:61440
  v_smfmac_f32_16x16x64_bf16 v[88:91], v[20:23], a[216:223], v7
  ds_read_b128 v[64:67], v3 offset:0
  v_smfmac_f32_16x16x64_bf16 v[92:95], v[20:23], a[224:231], v7
  ds_read_b128 v[68:71], v3 offset:4096
  v_smfmac_f32_16x16x64_bf16 v[96:99], v[20:23], a[232:239], v7
  s_waitcnt vmcnt(2)
  v_max3_u32 v136, v16, v20, v24
  v_smfmac_f32_16x16x64_bf16 v[100:103], v[20:23], a[0:7], v7
  ds_read_b128 v[72:75], v3 offset:8192
  v_cmp_eq_u32 vcc, -1, v136
  v_smfmac_f32_16x16x64_bf16 v[104:107], v[20:23], a[8:15], v7
  ds_read_b128 v[76:79], v3 offset:12288
  v_smfmac_f32_16x16x64_bf16 v[108:111], v[20:23], a[16:23], v7
  s_cbranch_vccnz scs_ha
  v_smfmac_f32_16x16x64_bf16 v[88:91], v[24:27], a[240:247], v7
  s_waitcnt vmcnt(1)
  s_barrier
  ds_read_b128 v[28:31], v149 offset:0
  v_smfmac_f32_16x16x64_bf16 v[92:95], v[24:27], a[248:255], v7
  ds_read_b128 v[32:35], v149 offset:1024
  v_smfmac_f32_16x16x64_bf16 v[96:99], v[24:27], v[152:159], v7
  ds_read_b128 v[36:39], v149 offset:2048
  v_smfmac_f32_16x16x64_bf16 v[100:103], v[24:27], a[24:31], v7
  ds_read_b128 v[40:43], v149 offset:3072
  v_smfmac_f32_16x16x64_bf16 v[104:107], v[24:27], a[32:39], v7
  v_smfmac_f32_16x16x64_bf16 v[108:111], v[24:27], a[40:47], v7
  s_waitcnt vmcnt(0)
  s_barrier
  s_waitcnt lgkmcnt(3)
  v_smfmac_f32_16x16x64_bf16 v[88:91], v[28:31], v[80:87], v7
  ds_read_b128 v[44:47], v149 offset:4096
  v_smfmac_f32_16x16x64_bf16 v[92:95], v[28:31], v[56:63], v7
  ds_read_b128 v[48:51], v149 offset:5120
  v_smfmac_f32_16x16x64_bf16 v[96:99], v[28:31], v[64:71], v7
  ds_read_b128 v[52:55], v149 offset:6144
  s_waitcnt lgkmcnt(3)
  v_smfmac_f32_16x16x64_bf16 v[88:91], v[32:35], v[160:167], v7
  ds_read_b128 v[80:83], v3 offset:32768
  ds_read_b128 v[16:19], v13 offset:8192
  v_smfmac_f32_16x16x64_bf16 v[92:95], v[32:35], v[168:175], v7
  ds_read_b128 v[84:87], v3 offset:36864
  ds_read_b128 v[20:23], v13 offset:10240
  v_smfmac_f32_16x16x64_bf16 v[96:99], v[32:35], v[176:183], v7
  ds_read_b128 v[56:59], v3 offset:16384
  ds_read_b128 v[24:27], v13 offset:9216
  v_smfmac_f32_16x16x64_bf16 v[88:91], v[36:39], v[184:191], v7
  s_waitcnt lgkmcnt(6)
  v_max3_u32 v136, v28, v32, v36
  v_smfmac_f32_16x16x64_bf16 v[92:95], v[36:39], v[192:199], v7
  ds_read_b128 v[60:63], v3 offset:20480
  v_max3_u32 v136, v136, v40, v44
  v_smfmac_f32_16x16x64_bf16 v[96:99], v[36:39], v[200:207], v7
  ds_read_b128 v[64:67], v3 offset:40960
  v_max3_u32 v136, v136, v48, v52
  v_smfmac_f32_16x16x64_bf16 v[88:91], v[44:47], v[208:215], v7
  ds_read_b128 v[68:71], v3 offset:45056
  v_cmp_eq_u32 vcc, -1, v136
  v_smfmac_f32_16x16x64_bf16 v[88:91], v[48:51], v[232:239], v7
  v_smfmac_f32_16x16x64_bf16 v[88:91], v[40:43], v[72:79], v7
  s_cbranch_vccnz scs_hb
  s_waitcnt lgkmcnt(3)
  v_smfmac_f32_16x16x64_bf16 v[88:91], v[52:55], v[80:87], v7
  ds_read_b128 v[72:75], v3 offset:24576
scs_join:
  v_smfmac_f32_16x16x64_bf16 v[92:95], v[44:47], v[216:223], v7
  ds_read_b128 v[76:79], v3 offset:28672
  v_smfmac_f32_16x16x64_bf16 v[92:95], v[48:51], v[240:247], v7
  ds_read_b128 v[80:83], v3 offset:49152
  s_waitcnt lgkmcnt(3)
  v_add_f32 v88, v88, v90
  v_smfmac_f32_16x16x64_bf16 v[92:95], v[40:43], v[56:63], v7
  ds_read_b128 v[84:87], v3 offset:53248
  v_add_f32 v89, v89, v91
  v_smfmac_f32_16x16x64_bf16 v[92:95], v[52:55], v[64:71], v7
  ds_read_b128 v[56:59], v2 offset:24576
  v_cmp_u_f32 vcc, v88, v89
  v_smfmac_f32_16x16x64_bf16 v[96:99], v[44:47], v[224:231], v7
  ds_read_b128 v[60:63], v2 offset:28672
  v_cvt_pk_bf16_f32 v136, v88, v89
  v_smfmac_f32_16x16x64_bf16 v[96:99], v[48:51], v[248:255], v7
  s_and_b64 vcc, vcc, s[16:17]
  s_cbranch_scc1 scs_redo
  s_waitcnt lgkmcnt(4)
  v_add_f32 v92, v92, v94
  v_smfmac_f32_16x16x64_bf16 v[96:99], v[40:43], v[72:79], v7
  ds_read_b128 v[64:67], v2 offset:32768
  s_waitcnt lgkmcnt(3)
  v_add_f32 v93, v93, v95
  v_smfmac_f32_16x16x64_bf16 v[96:99], v[52:55], v[80:87], v7
  ds_read_b128 v[68:71], v2 offset:36864
  v_cvt_pk_bf16_f32 v137, v92, v93
  v_smfmac_f32_16x16x64_bf16 v[100:103], v[28:31], a[48:55], v7
  ds_write2st64_b32 v4, v136, v137 offset0:0 offset1:4
  v_smfmac_f32_16x16x64_bf16 v[100:103], v[32:35], a[72:79], v7
  ds_read_b128 v[72:75], v2 offset:40960
  v_add_f32 v96, v96, v98
  v_smfmac_f32_16x16x64_bf16 v[100:103], v[40:43], a[96:103], v7
  ds_read_b128 v[76:79], v2 offset:45056
  s_waitcnt lgkmcnt(5)
  v_add_f32 v97, v97, v99
  v_smfmac_f32_16x16x64_bf16 v[100:103], v[36:39], v[56:63], v7
  ds_read_b128 v[80:83], v13 offset:5120
  v_cvt_pk_bf16_f32 v138, v96, v97
  v_smfmac_f32_16x16x64_bf16 v[100:103], v[44:47], a[120:127], v7
  ds_write_b32 v4, v138 offset:2048
  v_smfmac_f32_16x16x64_bf16 v[100:103], v[48:51], a[144:151], v7
  ds_read_b128 v[84:87], v13 offset:7168
  ds_read_b128 v[56:59], v13 offset:0
  s_waitcnt lgkmcnt(6)
  v_smfmac_f32_16x16x64_bf16 v[104:107], v[36:39], v[64:71], v7
  ds_read_b128 v[60:63], v13 offset:2048
  s_waitcnt lgkmcnt(5)
  v_smfmac_f32_16x16x64_bf16 v[108:111], v[36:39], v[72:79], v7
  ds_read_b128 v[64:67], v13 offset:1024
  ds_read_b128 v[68:71], v13 offset:3072
  v_smfmac_f32_16x16x64_bf16 v[100:103], v[52:55], a[168:175], v7
  s_waitcnt lgkmcnt(5)
  s_barrier
  v_smfmac_f32_16x16x64_bf16 v[104:107], v[28:31], a[56:63], v7
  ds_read_b64_tr_b16 v[112:113], v5 offset:0
  ds_read_b64_tr_b16 v[114:115], v5 offset:64
  v_smfmac_f32_16x16x64_bf16 v[104:107], v[32:35], a[80:87], v7
  ds_read_b64_tr_b16 v[116:117], v5 offset:512
  ds_read_b64_tr_b16 v[118:119], v5 offset:576
  v_smfmac_f32_16x16x64_bf16 v[104:107], v[40:43], a[104:111], v7
  ds_read_b64_tr_b16 v[120:121], v5 offset:1024
  ds_read_b64_tr_b16 v[122:123], v5 offset:1088
  v_smfmac_f32_16x16x64_bf16 v[104:107], v[44:47], a[128:135], v7
  ds_read_b64_tr_b16 v[124:125], v5 offset:1536
  ds_read_b64_tr_b16 v[126:127], v5 offset:1600
  v_smfmac_f32_16x16x64_bf16 v[104:107], v[48:51], a[152:159], v7
  ds_read_b64_tr_b16 v[128:129], v5 offset:2048
  ds_read_b64_tr_b16 v[130:131], v5 offset:2112
  v_smfmac_f32_16x16x64_bf16 v[104:107], v[52:55], a[176:183], v7
  ds_read_b64_tr_b16 v[132:133], v5 offset:2560
  ds_read_b64_tr_b16 v[134:135], v5 offset:2624
  v_smfmac_f32_16x16x64_bf16 v[108:111], v[28:31], a[64:71], v7
  ds_read_b128 v[72:75], v13 offset:4096
  v_add_f32 v100, v100, v102
  v_smfmac_f32_16x16x64_bf16 v[108:111], v[32:35], a[88:95], v7
  ds_read_b128 v[76:79], v13 offset:6144
  v_add_f32 v101, v101, v103
  v_smfmac_f32_16x16x64_bf16 v[108:111], v[40:43], a[112:119], v7
  ds_read_b128 v[36:39], v13 offset:11264
  v_cvt_pk_bf16_f32 v139, v100, v101
  v_smfmac_f32_16x16x64_bf16 v[108:111], v[44:47], a[136:143], v7
  buffer_store_dword v6, v11, s[8:11], 0 offen sc1
  v_add_f32 v104, v104, v106
  v_smfmac_f32_16x16x64_bf16 v[108:111], v[48:51], a[160:167], v7
  v_add_f32 v105, v105, v107
  v_smfmac_f32_16x16x64_bf16 v[108:111], v[52:55], a[184:191], v7
  s_waitcnt lgkmcnt(2)
  v_cvt_pk_bf16_f32 v140, v104, v105
  v_mfma_f32_16x16x32_bf16 v[88:91], v[56:59], v[112:115], 0
  ds_write2st64_b32 v4, v139, v140 offset0:12 offset1:16
  v_mfma_f32_16x16x32_bf16 v[92:95], v[60:63], v[112:115], 0
  v_add_f32 v108, v108, v110
  v_add_f32 v109, v109, v111
  v_mfma_f32_16x16x32_bf16 v[88:91], v[64:67], v[116:119], v[88:91]
  v_cvt_pk_bf16_f32 v141, v108, v109
  v_mfma_f32_16x16x32_bf16 v[92:95], v[68:71], v[116:119], v[92:95]
  ds_write_b32 v4, v141 offset:5120
  v_mfma_f32_16x16x32_bf16 v[88:91], v[72:75], v[120:123], v[88:91]
  s_waitcnt lgkmcnt(1)
  s_barrier
  v_mfma_f32_16x16x32_bf16 v[92:95], v[76:79], v[120:123], v[92:95]
  ds_read_b64_tr_b16 v[28:29], v5 offset:3072
  ds_read_b64_tr_b16 v[30:31], v5 offset:3136
  v_mfma_f32_16x16x32_bf16 v[88:91], v[80:83], v[124:127], v[88:91]
  ds_read_b64_tr_b16 v[32:33], v5 offset:3584
  ds_read_b64_tr_b16 v[34:35], v5 offset:3648
  v_mfma_f32_16x16x32_bf16 v[92:95], v[84:87], v[124:127], v[92:95]
  s_waitcnt lgkmcnt(4)
  s_barrier
  v_mfma_f32_16x16x32_bf16 v[88:91], v[16:19], v[128:131], v[88:91]
  ds_read_b64_tr_b16 v[40:41], v5 offset:4096
  ds_read_b64_tr_b16 v[42:43], v5 offset:4160
  v_mfma_f32_16x16x32_bf16 v[92:95], v[20:23], v[128:131], v[92:95]
  ds_read_b64_tr_b16 v[44:45], v5 offset:4608
  ds_read_b64_tr_b16 v[46:47], v5 offset:4672
  v_mfma_f32_16x16x32_bf16 v[88:91], v[24:27], v[132:135], v[88:91]
  ds_read_b64_tr_b16 v[48:49], v5 offset:5120
  ds_read_b64_tr_b16 v[50:51], v5 offset:5184
  v_mfma_f32_16x16x32_bf16 v[92:95], v[36:39], v[132:135], v[92:95]
  ds_read_b64_tr_b16 v[52:53], v5 offset:5632
  s_waitcnt lgkmcnt(7)
  v_mfma_f32_16x16x32_bf16 v[96:99], v[28:31], v[112:115], 0
  ds_read_b64_tr_b16 v[54:55], v5 offset:5696
  v_mfma_f32_16x16x32_bf16 v[96:99], v[32:35], v[116:119], v[96:99]
  s_waitcnt lgkmcnt(6)
  v_cndmask_b32 v136, v88, v90, s[18:19]
  v_cndmask_b32 v137, v89, v91, s[18:19]
  v_mfma_f32_16x16x32_bf16 v[96:99], v[40:43], v[120:123], v[96:99]
  s_waitcnt lgkmcnt(4)
  v_cndmask_b32 v138, v92, v94, s[18:19]
  v_cndmask_b32 v139, v93, v95, s[18:19]
  v_mfma_f32_16x16x32_bf16 v[96:99], v[44:47], v[124:127], v[96:99]
  s_waitcnt lgkmcnt(2)
  v_max3_f32 v142, v136, v137, v138
  v_max_f32 v142, v142, v139
  v_mfma_f32_16x16x32_bf16 v[96:99], v[48:51], v[128:131], v[96:99]
  s_barrier
  s_waitcnt lgkmcnt(0)
  v_mov_b32 v143, v142
  v_mfma_f32_16x16x32_bf16 v[96:99], v[52:55], v[132:135], v[96:99]
  s_nop 0
  v_permlane32_swap_b32 v143, v142
  v_max_f32 v142, v142, v143
  s_nop 4
  v_cndmask_b32 v140, v96, v98, s[18:19]
  v_cndmask_b32 v141, v97, v99, s[18:19]
  v_max3_f32 v142, v142, v140, v141
  s_nop 1
  v_max_f32_dpp v142, v142, v142 row_ror:8 row_mask:0xf bank_mask:0xf
  v_mov_b32 v143, v142
  s_nop 1
  v_permlane16_swap_b32 v143, v142
  v_max_f32 v142, v142, v143
  v_mul_f32 v142, s69, v142
  v_fma_f32 v136, v136, s69, -v142
  v_fma_f32 v137, v137, s69, -v142
  v_fma_f32 v138, v138, s69, -v142
  v_fma_f32 v139, v139, s69, -v142
  v_fma_f32 v140, v140, s69, -v142
  v_fma_f32 v141, v141, s69, -v142
  v_exp_f32 v136, v136
  v_exp_f32 v137, v137
  v_exp_f32 v138, v138
  v_exp_f32 v139, v139
  v_add_f32 v142, v136, v137
  v_add_f32 v143, v138, v139
  v_add_f32 v142, v142, v143
  v_mov_b32 v143, v142
  v_exp_f32 v140, v140
  v_exp_f32 v141, v141
  v_permlane32_swap_b32 v143, v142
  v_add_f32 v144, v140, v141
  v_add_f32 v142, v142, v143
  v_add_f32 v142, v142, v144
  s_nop 1
  v_add_f32_dpp v142, v142, v142 row_ror:8 row_mask:0xf bank_mask:0xf
  v_mov_b32 v143, v142
  s_nop 1
  v_permlane16_swap_b32 v143, v142
  v_add_f32 v142, v142, v143
  v_rcp_f32 v142, v142
  s_nop 0
  v_mul_f32 v136, v136, v142
  v_mul_f32 v137, v137, v142
  v_mul_f32 v138, v138, v142
  v_mul_f32 v139, v139, v142
  v_cvt_pk_bf16_f32 v146, v136, v137
  v_cvt_pk_bf16_f32 v147, v138, v139
  buffer_store_dwordx2 v[146:147], v8, s[8:11], s66 offen sc1
  v_mul_f32 v140, v140, v142
  v_mul_f32 v141, v141, v142
  v_cvt_pk_bf16_f32 v148, v140, v141
  buffer_store_dword v148, v9, s[8:11], s66 offen sc1
  v_mov_b32 v150, -1
  v_mov_b32 v151, -1
  s_add_u32 s46, s65, 0
  buffer_store_dwordx2 v[150:151], v8, s[8:11], s46 offen sc1
  buffer_store_dword v150, v9, s[8:11], s46 offen sc1
  s_mov_b32 s65, s66
  v_add_u32 v13, s22, v13
  s_sub_u32 s22, 0, s22
  s_add_u32 s58, s58, 1
  s_cmp_eq_u32 s58, 3
  s_cselect_b32 s58, 0, s58
  s_mov_b32 s52, s53
  s_cmp_lt_u32 s52, 64
  s_cbranch_scc1 scs_loop
  s_endpgm
sch_loop:
  s_add_u32 s53, s52, 1
  s_lshl_b32 s56, s58, 2
  s_add_u32 s56, s56, s43
  s_lshl_b32 s56, s56, 16
  s_add_u32 s56, s56, s3
  s_add_u32 s56, s56, 12582912
  v_add_u32 v12, s56, v1
  s_lshl_b32 s66, s58, 18
  s_mov_b64 s[16:17], -1
  s_mov_b32 s71, 0
  ds_read_b128 v[56:59], v2 offset:0
  ds_read_b128 v[60:63], v2 offset:4096
  ds_read_b128 v[64:67], v2 offset:8192
  ds_read_b128 v[68:71], v2 offset:12288
  ds_read_b128 v[72:75], v2 offset:16384
  ds_read_b128 v[76:79], v2 offset:20480
  ds_read_b128 v[80:83], v2 offset:49152
  ds_read_b128 v[84:87], v2 offset:53248
  v_mov_b32 v88, 0
  v_mov_b32 v89, 0
  v_mov_b32 v90, 0
  v_mov_b32 v91, 0
  v_mov_b32 v92, 0
  v_mov_b32 v93, 0
  v_mov_b32 v94, 0
  v_mov_b32 v95, 0
  v_mov_b32 v96, 0
  v_mov_b32 v97, 0
  v_mov_b32 v98, 0
  v_mov_b32 v99, 0
  v_mov_b32 v100, 0
  v_mov_b32 v101, 0
  v_mov_b32 v102, 0
  v_mov_b32 v103, 0
  v_mov_b32 v104, 0
  v_mov_b32 v105, 0
  v_mov_b32 v106, 0
  v_mov_b32 v107, 0
  v_mov_b32 v108, 0
  v_mov_b32 v109, 0
  v_mov_b32 v110, 0
  v_mov_b32 v111, 0
  s_xor_b32 s28, s63, 0x2000
  s_add_u32 s28, s28, s26
  s_add_u32 s29, s28, 16777216
  s_add_u32 s30, s28, 33554432
  s_add_u32 s23, s23, 32
  s_cmp_ge_u32 s23, 1024
  s_cselect_b32 s46, 1024, 0
  s_sub_u32 s23, s23, s46
  s_lshr_b32 s63, s23, 1
  s_lshl_b32 s63, s63, 14
  s_and_b32 s46, s23, 1
  s_lshl_b32 s46, s46, 12
  s_add_u32 s63, s63, s46
  s_add_u32 s63, s63, s20
  s_lshr_b32 s46, s63, 8
  s_and_b32 s46, s46, 0x2000
  s_xor_b32 s63, s63, s46
  s_add_u32 s21, s21, s22
  s_cmp_lg_u32 s42, 2
  s_cbranch_scc1 sc_nobell
  s_add_u32 s49, s52, 2
  s_min_u32 s49, s49, 64
  s_cmp_ge_u32 s61, s49
  s_cbranch_scc1 wf_done_19
  s_mov_b32 s50, 0
wf_loop_20:
  buffer_load_dword v136, v15, s[8:11], 0 offen sc1
  s_add_u32 s50, s50, 1
  s_cmp_gt_u32 s50, 131072
  s_cbranch_scc1 L_fail
  s_waitcnt vmcnt(0)
  v_min_u32_dpp v136, v136, v136 row_ror:8 row_mask:0xf bank_mask:0xf
  s_nop 1
  v_min_u32_dpp v136, v136, v136 row_ror:4 row_mask:0xf bank_mask:0xf
  s_nop 1
  v_min_u32_dpp v136, v136, v136 row_ror:2 row_mask:0xf bank_mask:0xf
  s_nop 1
  v_min_u32_dpp v136, v136, v136 row_ror:1 row_mask:0xf bank_mask:0xf
  v_mov_b32 v137, v136
  s_nop 1
  v_permlane16_swap_b32 v137, v136
  v_min_u32 v136, v136, v137
  v_mov_b32 v137, v136
  s_nop 1
  v_permlane32_swap_b32 v137, v136
  v_min_u32 v136, v136, v137
  s_nop 0
  v_readfirstlane_b32 s61, v136
  s_nop 0
  s_cmp_ge_u32 s61, s49
  s_cbranch_scc1 wf_done_19
  s_sleep 2
  s_branch wf_loop_20
wf_done_19:
  s_mov_b32 s50, 0
  s_mov_b64 exec, 15
  buffer_load_dword v112, v10, s[8:11], 0 offen sc1
  s_nop 11
  buffer_load_dword v113, v10, s[8:11], 0 offen sc1
  s_nop 11
  buffer_load_dword v114, v10, s[8:11], 0 offen sc1
  s_nop 11
  buffer_load_dword v115, v10, s[8:11], 0 offen sc1
  s_nop 11
  buffer_load_dword v116, v10, s[8:11], 0 offen sc1
  s_nop 11
  buffer_load_dword v117, v10, s[8:11], 0 offen sc1
  s_nop 11
  buffer_load_dword v118, v10, s[8:11], 0 offen sc1
  s_nop 11
  buffer_load_dword v119, v10, s[8:11], 0 offen sc1
  s_nop 11
  buffer_load_dword v120, v10, s[8:11], 0 offen sc1
  s_nop 11
bell_21:
  buffer_load_dword v121, v10, s[8:11], 0 offen sc1
  s_waitcnt vmcnt(9)
  v_cmp_gt_u32 vcc, s53, v112
  s_cbranch_vccz bell_x_22
  s_nop 7
  buffer_load_dword v112, v10, s[8:11], 0 offen sc1
  s_waitcnt vmcnt(9)
  v_cmp_gt_u32 vcc, s53, v113
  s_cbranch_vccz bell_x_22
  s_nop 7
  buffer_load_dword v113, v10, s[8:11], 0 offen sc1
  s_waitcnt vmcnt(9)
  v_cmp_gt_u32 vcc, s53, v114
  s_cbranch_vccz bell_x_22
  s_nop 7
  buffer_load_dword v114, v10, s[8:11], 0 offen sc1
  s_waitcnt vmcnt(9)
  v_cmp_gt_u32 vcc, s53, v115
  s_cbranch_vccz bell_x_22
  s_nop 7
  buffer_load_dword v115, v10, s[8:11], 0 offen sc1
  s_waitcnt vmcnt(9)
  v_cmp_gt_u32 vcc, s53, v116
  s_cbranch_vccz bell_x_22
  s_nop 7
  buffer_load_dword v116, v10, s[8:11], 0 offen sc1
  s_waitcnt vmcnt(9)
  v_cmp_gt_u32 vcc, s53, v117
  s_cbranch_vccz bell_x_22
  s_nop 7
  buffer_load_dword v117, v10, s[8:11], 0 offen sc1
  s_waitcnt vmcnt(9)
  v_cmp_gt_u32 vcc, s53, v118
  s_cbranch_vccz bell_x_22
  s_nop 7
  buffer_load_dword v118, v10, s[8:11], 0 offen sc1
  s_waitcnt vmcnt(9)
  v_cmp_gt_u32 vcc, s53, v119
  s_cbranch_vccz bell_x_22
  s_nop 7
  buffer_load_dword v119, v10, s[8:11], 0 offen sc1
  s_waitcnt vmcnt(9)
  v_cmp_gt_u32 vcc, s53, v120
  s_cbranch_vccz bell_x_22
  s_nop 7
  buffer_load_dword v120, v10, s[8:11], 0 offen sc1
  s_waitcnt vmcnt(9)
  v_cmp_gt_u32 vcc, s53, v121
  s_cbranch_vccz bell_x_22
  s_add_u32 s50, s50, 1
  s_cmp_gt_u32 s50, 131072
  s_cbranch_scc1 L_fail
  s_branch bell_21
bell_x_22:
  s_mov_b64 exec, -1
sc_nobell:
  s_mov_b32 s50, 0
sch_top:
  s_waitcnt lgkmcnt(0)
  s_barrier
  buffer_load_dwordx4 v[16:19], v12, s[8:11], 0 offen offset:0 sc1
  s_add_u32 m0, s51, 153600
  s_barrier
  buffer_load_dwordx4 v[20:23], v12, s[8:11], 0 offen offset:1024 sc1
  s_barrier
  buffer_load_dwordx4 v[24:27], v12, s[8:11], 0 offen offset:2048 sc1
  s_barrier
  buffer_load_dwordx4 v12, s[8:11], s31 offen sc1 lds
  s_add_u32 m0, s51, 157696
  s_barrier
  buffer_load_dwordx4 v12, s[8:11], s32 offen sc1 lds
  s_waitcnt vmcnt(4)
sch_go:
  v_smfmac_f32_16x16x64_bf16 v[88:91], v[16:19], a[192:199], v7
  v_smfmac_f32_16x16x64_bf16 v[92:95], v[16:19], a[200:207], v7
  v_smfmac_f32_16x16x64_bf16 v[96:99], v[16:19], a[208:215], v7
  v_smfmac_f32_16x16x64_bf16 v[100:103], v[16:19], v[56:63], v7
  v_smfmac_f32_16x16x64_bf16 v[104:107], v[16:19], v[64:71], v7
  ds_read_b128 v[56:59], v2 offset:57344
  v_smfmac_f32_16x16x64_bf16 v[108:111], v[16:19], v[72:79], v7
  s_waitcnt vmcnt(3)
  ds_read_b128 v[60:63], v2 offset:61440
  v_smfmac_f32_16x16x64_bf16 v[88:91], v[20:23], a[216:223], v7
  ds_read_b128 v[64:67], v3 offset:0
  v_smfmac_f32_16x16x64_bf16 v[92:95], v[20:23], a[224:231], v7
  ds_read_b128 v[68:71], v3 offset:4096
  v_smfmac_f32_16x16x64_bf16 v[96:99], v[20:23], a[232:239], v7
  s_waitcnt vmcnt(2)
  v_max3_u32 v136, v16, v20, v24
  v_smfmac_f32_16x16x64_bf16 v[100:103], v[20:23], a[0:7], v7
  ds_read_b128 v[72:75], v3 offset:8192
  v_cmp_eq_u32 vcc, -1, v136
  v_smfmac_f32_16x16x64_bf16 v[104:107], v[20:23], a[8:15], v7
  ds_read_b128 v[76:79], v3 offset:12288
  v_smfmac_f32_16x16x64_bf16 v[108:111], v[20:23], a[16:23], v7
  s_cbranch_vccnz sch_ha
  v_smfmac_f32_16x16x64_bf16 v[88:91], v[24:27], a[240:247], v7
  s_waitcnt vmcnt(1)
  s_barrier
  ds_read_b128 v[28:31], v149 offset:0
  v_smfmac_f32_16x16x64_bf16 v[92:95], v[24:27], a[248:255], v7
  ds_read_b128 v[32:35], v149 offset:1024
  v_smfmac_f32_16x16x64_bf16 v[96:99], v[24:27], v[152:159], v7
  ds_read_b128 v[36:39], v149 offset:2048
  v_smfmac_f32_16x16x64_bf16 v[100:103], v[24:27], a[24:31], v7
  ds_read_b128 v[40:43], v149 offset:3072
  v_smfmac_f32_16x16x64_bf16 v[104:107], v[24:27], a[32:39], v7
  v_smfmac_f32_16x16x64_bf16 v[108:111], v[24:27], a[40:47], v7
  s_waitcnt vmcnt(0)
  s_barrier
  s_waitcnt lgkmcnt(3)
  v_smfmac_f32_16x16x64_bf16 v[88:91], v[28:31], v[80:87], v7
  ds_read_b128 v[44:47], v149 offset:4096
  v_smfmac_f32_16x16x64_bf16 v[92:95], v[28:31], v[56:63], v7
  ds_read_b128 v[48:51], v149 offset:5120
  v_smfmac_f32_16x16x64_bf16 v[96:99], v[28:31], v[64:71], v7
  ds_read_b128 v[52:55], v149 offset:6144
  s_waitcnt lgkmcnt(3)
  v_smfmac_f32_16x16x64_bf16 v[88:91], v[32:35], v[160:167], v7
  ds_read_b128 v[80:83], v3 offset:32768
  v_smfmac_f32_16x16x64_bf16 v[92:95], v[32:35], v[168:175], v7
  ds_read_b128 v[84:87], v3 offset:36864
  v_smfmac_f32_16x16x64_bf16 v[96:99], v[32:35], v[176:183], v7
  ds_read_b128 v[56:59], v3 offset:16384
  v_smfmac_f32_16x16x64_bf16 v[88:91], v[36:39], v[184:191], v7
  s_waitcnt lgkmcnt(3)
  v_max3_u32 v136, v28, v32, v36
  v_smfmac_f32_16x16x64_bf16 v[92:95], v[36:39], v[192:199], v7
  ds_read_b128 v[60:63], v3 offset:20480
  v_max3_u32 v136, v136, v40, v44
  v_smfmac_f32_16x16x64_bf16 v[96:99], v[36:39], v[200:207], v7
  ds_read_b128 v[64:67], v3 offset:40960
  v_max3_u32 v136, v136, v48, v52
  v_smfmac_f32_16x16x64_bf16 v[88:91], v[44:47], v[208:215], v7
  ds_read_b128 v[68:71], v3 offset:45056
  v_cmp_eq_u32 vcc, -1, v136
  v_smfmac_f32_16x16x64_bf16 v[88:91], v[48:51], v[232:239], v7
  v_smfmac_f32_16x16x64_bf16 v[88:91], v[40:43], v[72:79], v7
  s_cbranch_vccnz sch_hb
  s_waitcnt lgkmcnt(3)
  v_smfmac_f32_16x16x64_bf16 v[88:91], v[52:55], v[80:87], v7
  ds_read_b128 v[72:75], v3 offset:24576
  s_mov_b32 m0, s21
sch_join:
  v_smfmac_f32_16x16x64_bf16 v[92:95], v[44:47], v[216:223], v7
  ds_read_b128 v[76:79], v3 offset:28672
  buffer_load_dwordx4 v[112:115], v1, s[8:11], s28 offen offset:0 sc1
  v_smfmac_f32_16x16x64_bf16 v[92:95], v[48:51], v[240:247], v7
  ds_read_b128 v[80:83], v3 offset:49152
  s_waitcnt lgkmcnt(3)
  v_add_f32 v88, v88, v90
  v_smfmac_f32_16x16x64_bf16 v[92:95], v[40:43], v[56:63], v7
  ds_read_b128 v[84:87], v3 offset:53248
  v_add_f32 v89, v89, v91
  v_smfmac_f32_16x16x64_bf16 v[92:95], v[52:55], v[64:71], v7
  ds_read_b128 v[56:59], v2 offset:24576
  buffer_load_dwordx4 v[116:119], v1, s[8:11], s28 offen offset:1024 sc1
  v_cmp_u_f32 vcc, v88, v89
  v_smfmac_f32_16x16x64_bf16 v[96:99], v[44:47], v[224:231], v7
  ds_read_b128 v[60:63], v2 offset:28672
  v_cvt_pk_bf16_f32 v136, v88, v89
  v_smfmac_f32_16x16x64_bf16 v[96:99], v[48:51], v[248:255], v7
  s_and_b64 vcc, vcc, s[16:17]
  s_cbranch_scc1 sch_redo
  s_waitcnt lgkmcnt(4)
  v_add_f32 v92, v92, v94
  v_smfmac_f32_16x16x64_bf16 v[96:99], v[40:43], v[72:79], v7
  ds_read_b128 v[64:67], v2 offset:32768
  buffer_load_dwordx4 v[120:123], v1, s[8:11], s29 offen offset:0 sc1
  s_waitcnt lgkmcnt(3)
  v_add_f32 v93, v93, v95
  v_smfmac_f32_16x16x64_bf16 v[96:99], v[52:55], v[80:87], v7
  ds_read_b128 v[68:71], v2 offset:36864
  v_cvt_pk_bf16_f32 v137, v92, v93
  v_smfmac_f32_16x16x64_bf16 v[100:103], v[28:31], a[48:55], v7
  ds_write2st64_b32 v4, v136, v137 offset0:0 offset1:4
  v_smfmac_f32_16x16x64_bf16 v[100:103], v[32:35], a[72:79], v7
  ds_read_b128 v[72:75], v2 offset:40960
  buffer_load_dwordx4 v[124:127], v1, s[8:11], s29 offen offset:1024 sc1
  v_add_f32 v96, v96, v98
  v_smfmac_f32_16x16x64_bf16 v[100:103], v[40:43], a[96:103], v7
  ds_read_b128 v[76:79], v2 offset:45056
  s_waitcnt lgkmcnt(5)
  v_add_f32 v97, v97, v99
  v_smfmac_f32_16x16x64_bf16 v[100:103], v[36:39], v[56:63], v7
  v_cvt_pk_bf16_f32 v138, v96, v97
  v_smfmac_f32_16x16x64_bf16 v[100:103], v[44:47], a[120:127], v7
  ds_write_b32 v4, v138 offset:2048
  buffer_load_dwordx4 v[128:131], v1, s[8:11], s30 offen offset:0 sc1
  v_smfmac_f32_16x16x64_bf16 v[100:103], v[48:51], a[144:151], v7
  s_waitcnt lgkmcnt(3)
  v_smfmac_f32_16x16x64_bf16 v[104:107], v[36:39], v[64:71], v7
  s_waitcnt lgkmcnt(1)
  v_smfmac_f32_16x16x64_bf16 v[108:111], v[36:39], v[72:79], v7
  buffer_load_dwordx4 v[132:135], v1, s[8:11], s30 offen offset:1024 sc1
  v_smfmac_f32_16x16x64_bf16 v[100:103], v[52:55], a[168:175], v7
  s_waitcnt lgkmcnt(0)
  s_barrier
  v_smfmac_f32_16x16x64_bf16 v[104:107], v[28:31], a[56:63], v7
  v_smfmac_f32_16x16x64_bf16 v[104:107], v[32:35], a[80:87], v7
  buffer_load_dwordx4 v1, s[8:11], s63 offen offset:0 sc1 lds
  v_smfmac_f32_16x16x64_bf16 v[104:107], v[40:43], a[104:111], v7
  v_smfmac_f32_16x16x64_bf16 v[104:107], v[44:47], a[128:135], v7
  v_smfmac_f32_16x16x64_bf16 v[104:107], v[48:51], a[152:159], v7
  buffer_load_dwordx4 v1, s[8:11], s63 offen offset:1024 sc1 lds
  v_smfmac_f32_16x16x64_bf16 v[104:107], v[52:55], a[176:183], v7
  v_smfmac_f32_16x16x64_bf16 v[108:111], v[28:31], a[64:71], v7
  v_add_f32 v100, v100, v102
  v_smfmac_f32_16x16x64_bf16 v[108:111], v[32:35], a[88:95], v7
  buffer_load_dwordx4 v1, s[8:11], s63 offen offset:2048 sc1 lds
  v_add_f32 v101, v101, v103
  v_smfmac_f32_16x16x64_bf16 v[108:111], v[40:43], a[112:119], v7
  v_cvt_pk_bf16_f32 v139, v100, v101
  v_smfmac_f32_16x16x64_bf16 v[108:111], v[44:47], a[136:143], v7
  v_add_f32 v104, v104, v106
  v_smfmac_f32_16x16x64_bf16 v[108:111], v[48:51], a[160:167], v7
  buffer_load_dwordx4 v1, s[8:11], s63 offen offset:3072 sc1 lds
  v_add_f32 v105, v105, v107
  v_smfmac_f32_16x16x64_bf16 v[108:111], v[52:55], a[184:191], v7
  v_cvt_pk_bf16_f32 v140, v104, v105
  ds_write2st64_b32 v4, v139, v140 offset0:12 offset1:16
  s_nop 5
  v_add_f32 v108, v108, v110
  v_add_f32 v109, v109, v111
  v_cvt_pk_bf16_f32 v141, v108, v109
  ds_write_b32 v4, v141 offset:5120
  s_waitcnt lgkmcnt(0)
  s_barrier
  s_barrier
  s_barrier
  s_cmp_ge_u32 s42, 2
  s_cbranch_scc1 sc_nox
  ds_read_b128 v[56:59], v13 offset:0
  ds_read_b128 v[60:63], v13 offset:2048
  ds_read_b128 v[64:67], v13 offset:1024
  ds_read_b128 v[68:71], v13 offset:3072
  ds_read_b128 v[72:75], v13 offset:4096
  ds_read_b128 v[76:79], v13 offset:6144
  ds_read_b128 v[80:83], v13 offset:5120
  ds_read_b128 v[84:87], v13 offset:7168
  ds_read_b128 v[16:19], v13 offset:8192
  ds_read_b128 v[20:23], v13 offset:10240
  ds_read_b128 v[24:27], v13 offset:9216
  ds_read_b128 v[36:39], v13 offset:11264
  s_waitcnt vmcnt(4)
  s_waitcnt lgkmcnt(11)
  v_mfma_f32_16x16x32_bf16 v[88:91], v[56:59], v[112:115], 0
  ds_read_b64_tr_b16 v[28:29], v5 offset:3072
  s_waitcnt lgkmcnt(11)
  v_mfma_f32_16x16x32_bf16 v[92:95], v[60:63], v[112:115], 0
  ds_read_b64_tr_b16 v[30:31], v5 offset:3136
  s_waitcnt lgkmcnt(11)
  v_mfma_f32_16x16x32_bf16 v[88:91], v[64:67], v[116:119], v[88:91]
  ds_read_b64_tr_b16 v[32:33], v5 offset:3584
  s_waitcnt lgkmcnt(11)
  v_mfma_f32_16x16x32_bf16 v[92:95], v[68:71], v[116:119], v[92:95]
  ds_read_b64_tr_b16 v[34:35], v5 offset:3648
  s_waitcnt lgkmcnt(11)
  v_mfma_f32_16x16x32_bf16 v[88:91], v[72:75], v[120:123], v[88:91]
  ds_read_b64_tr_b16 v[40:41], v5 offset:4096
  s_waitcnt lgkmcnt(5)
  v_mfma_f32_16x16x32_bf16 v[92:95], v[76:79], v[120:123], v[92:95]
  ds_read_b64_tr_b16 v[42:43], v5 offset:4160
  v_mfma_f32_16x16x32_bf16 v[88:91], v[80:83], v[124:127], v[88:91]
  ds_read_b64_tr_b16 v[44:45], v5 offset:4608
  v_mfma_f32_16x16x32_bf16 v[92:95], v[84:87], v[124:127], v[92:95]
  ds_read_b64_tr_b16 v[46:47], v5 offset:4672
  v_mfma_f32_16x16x32_bf16 v[88:91], v[16:19], v[128:131], v[88:91]
  ds_read_b64_tr_b16 v[48:49], v5 offset:5120
  v_mfma_f32_16x16x32_bf16 v[92:95], v[20:23], v[128:131], v[92:95]
  ds_read_b64_tr_b16 v[50:51], v5 offset:5184
  v_mfma_f32_16x16x32_bf16 v[88:91], v[24:27], v[132:135], v[88:91]
  ds_read_b64_tr_b16 v[52:53], v5 offset:5632
  v_mfma_f32_16x16x32_bf16 v[92:95], v[36:39], v[132:135], v[92:95]
  ds_read_b64_tr_b16 v[54:55], v5 offset:5696
  s_waitcnt lgkmcnt(5)
  v_mfma_f32_16x16x32_bf16 v[96:99], v[28:31], v[112:115], 0
  v_mfma_f32_16x16x32_bf16 v[96:99], v[32:35], v[116:119], v[96:99]
  v_mfma_f32_16x16x32_bf16 v[96:99], v[40:43], v[120:123], v[96:99]
  s_waitcnt lgkmcnt(2)
  v_mfma_f32_16x16x32_bf16 v[96:99], v[44:47], v[124:127], v[96:99]
  v_mfma_f32_16x16x32_bf16 v[96:99], v[48:51], v[128:131], v[96:99]
  s_waitcnt lgkmcnt(0)
  v_mfma_f32_16x16x32_bf16 v[96:99], v[52:55], v[132:135], v[96:99]
  s_waitcnt vmcnt(0)
  v_mov_b32 v143, s70
  v_cndmask_b32 v88, v88, v143, s[72:73]
  v_cndmask_b32 v89, v89, v143, s[74:75]
  v_cndmask_b32 v90, v90, v143, s[76:77]
  v_cndmask_b32 v91, v91, v143, s[78:79]
  v_cndmask_b32 v92, v92, v143, s[80:81]
  v_cndmask_b32 v93, v93, v143, s[82:83]
  v_cndmask_b32 v94, v94, v143, s[84:85]
  v_cndmask_b32 v95, v95, v143, s[86:87]
  s_mov_b32 vcc_lo, 0
  s_mov_b32 vcc_hi, -1
  v_cndmask_b32 v96, v96, v98, vcc
  v_cndmask_b32 v97, v97, v99, vcc
  v_max_f32 v142, v88, v89
  v_max3_f32 v142, v142, v90, v91
  v_max3_f32 v142, v142, v92, v93
  v_max3_f32 v142, v142, v94, v95
  v_max3_f32 v142, v142, v96, v97
  v_mov_b32 v143, v142
  s_nop 1
  v_permlane16_swap_b32 v143, v142
  v_max_f32 v142, v142, v143
  v_mov_b32 v143, v142
  s_nop 1
  v_permlane32_swap_b32 v143, v142
  v_max_f32 v142, v142, v143
  v_mul_f32 v142, s69, v142
  v_fma_f32 v88, v88, s69, -v142
  v_fma_f32 v89, v89, s69, -v142
  v_fma_f32 v90, v90, s69, -v142
  v_fma_f32 v91, v91, s69, -v142
  v_fma_f32 v92, v92, s69, -v142
  v_fma_f32 v93, v93, s69, -v142
  v_fma_f32 v94, v94, s69, -v142
  v_fma_f32 v95, v95, s69, -v142
  v_fma_f32 v96, v96, s69, -v142
  v_fma_f32 v97, v97, s69, -v142
  v_exp_f32 v88, v88
  v_exp_f32 v89, v89
  v_exp_f32 v90, v90
  v_exp_f32 v91, v91
  v_exp_f32 v92, v92
  v_exp_f32 v93, v93
  v_exp_f32 v94, v94
  v_exp_f32 v95, v95
  v_exp_f32 v96, v96
  v_exp_f32 v97, v97
  v_add_f32 v142, v88, v89
  v_add_f32 v142, v142, v90
  v_add_f32 v142, v142, v91
  v_add_f32 v142, v142, v92
  v_add_f32 v142, v142, v93
  v_add_f32 v142, v142, v94
  v_add_f32 v142, v142, v95
  v_add_f32 v142, v142, v96
  v_add_f32 v142, v142, v97
  v_mov_b32 v143, v142
  s_nop 1
  v_permlane16_swap_b32 v143, v142
  v_add_f32 v142, v142, v143
  v_mov_b32 v143, v142
  s_nop 1
  v_permlane32_swap_b32 v143, v142
  v_add_f32 v142, v142, v143
  v_rcp_f32 v142, v142
  s_nop 0
  v_mul_f32 v88, v88, v142
  v_mul_f32 v89, v89, v142
  v_mul_f32 v90, v90, v142
  v_mul_f32 v91, v91, v142
  v_mul_f32 v92, v92, v142
  v_mul_f32 v93, v93, v142
  v_mul_f32 v94, v94, v142
  v_mul_f32 v95, v95, v142
  v_mul_f32 v96, v96, v142
  v_mul_f32 v97, v97, v142
  v_cvt_pk_bf16_f32 v144, v88, v89
  v_cvt_pk_bf16_f32 v145, v90, v91
  v_cvt_pk_bf16_f32 v146, v92, v93
  v_cvt_pk_bf16_f32 v147, v94, v95
  v_cvt_pk_bf16_f32 v148, v96, v97
  s_mov_b32 s47, s64
  s_lshr_b32 s46, s47, 8
  s_and_b32 s46, s46, 0x2000
  s_xor_b32 s47, s47, s46
  s_add_u32 s46, s47, s27
  buffer_store_dwordx4 v[144:147], v1, s[8:11], s46 offen sc1
  buffer_store_dword v148, v14, s[8:11], s47 offen sc1
  s_add_u32 s64, s64, 262144
  s_cmp_ge_u32 s64, 16777216
  s_cselect_b32 s46, 2097152, 0
  s_sub_u32 s64, s64, s46
  s_branch sc_join
sc_nox:
  s_waitcnt vmcnt(0)
sc_join:
  v_add_u32 v13, s22, v13
  s_sub_u32 s22, 0, s22
  s_add_u32 s58, s58, 1
  s_cmp_eq_u32 s58, 3
  s_cselect_b32 s58, 0, s58
  s_mov_b32 s52, s53
  s_cmp_lt_u32 s52, 64
  s_cbranch_scc1 sch_loop
  s_waitcnt vmcnt(0)
  s_cmp_ge_u32 s42, 2
  s_cbranch_scc1 L_end
  v_mov_b32 v136, s52
  s_mov_b64 exec, 1
  buffer_store_dword v136, v15, s[8:11], 0 offen sc1
  s_mov_b64 exec, -1
  s_endpgm
scs_ha:
  s_waitcnt lgkmcnt(0)
  ds_read_b128 v[56:59], v2 offset:0
  ds_read_b128 v[60:63], v2 offset:4096
  ds_read_b128 v[64:67], v2 offset:8192
  ds_read_b128 v[68:71], v2 offset:12288
  ds_read_b128 v[72:75], v2 offset:16384
  ds_read_b128 v[76:79], v2 offset:20480
  ds_read_b128 v[80:83], v2 offset:49152
  ds_read_b128 v[84:87], v2 offset:53248
  v_mov_b32 v88, 0
  v_mov_b32 v89, 0
  v_mov_b32 v90, 0
  v_mov_b32 v91, 0
  v_mov_b32 v92, 0
  v_mov_b32 v93, 0
  v_mov_b32 v94, 0
  v_mov_b32 v95, 0
  v_mov_b32 v96, 0
  v_mov_b32 v97, 0
  v_mov_b32 v98, 0
  v_mov_b32 v99, 0
  v_mov_b32 v100, 0
  v_mov_b32 v101, 0
  v_mov_b32 v102, 0
  v_mov_b32 v103, 0
  v_mov_b32 v104, 0
  v_mov_b32 v105, 0
  v_mov_b32 v106, 0
  v_mov_b32 v107, 0
  v_mov_b32 v108, 0
  v_mov_b32 v109, 0
  v_mov_b32 v110, 0
  v_mov_b32 v111, 0
scs_ra:
  buffer_load_dwordx4 v[16:19], v12, s[8:11], 0 offen offset:0 sc1
  buffer_load_dwordx4 v[20:23], v12, s[8:11], 0 offen offset:1024 sc1
  buffer_load_dwordx4 v[24:27], v12, s[8:11], 0 offen offset:2048 sc1
  s_add_u32 s50, s50, 1
  s_cmp_gt_u32 s50, 131072
  s_cbranch_scc1 L_fail
  s_waitcnt vmcnt(0) lgkmcnt(0)
  v_max3_u32 v136, v16, v20, v24
  v_cmp_eq_u32 vcc, -1, v136
  s_cbranch_vccnz scs_ra
  s_branch scs_go
scs_hb:
  s_waitcnt lgkmcnt(0)
  s_add_u32 s50, s50, 1
  s_cmp_gt_u32 s50, 131072
  s_cbranch_scc1 L_fail
  ds_read_b128 v[56:59], v2 offset:0
  ds_read_b128 v[60:63], v2 offset:4096
  ds_read_b128 v[64:67], v2 offset:8192
  ds_read_b128 v[68:71], v2 offset:12288
  ds_read_b128 v[72:75], v2 offset:16384
  ds_read_b128 v[76:79], v2 offset:20480
  ds_read_b128 v[80:83], v2 offset:49152
  ds_read_b128 v[84:87], v2 offset:53248
  v_mov_b32 v88, 0
  v_mov_b32 v89, 0
  v_mov_b32 v90, 0
  v_mov_b32 v91, 0
  v_mov_b32 v92, 0
  v_mov_b32 v93, 0
  v_mov_b32 v94, 0
  v_mov_b32 v95, 0
  v_mov_b32 v96, 0
  v_mov_b32 v97, 0
  v_mov_b32 v98, 0
  v_mov_b32 v99, 0
  v_mov_b32 v100, 0
  v_mov_b32 v101, 0
  v_mov_b32 v102, 0
  v_mov_b32 v103, 0
  v_mov_b32 v104, 0
  v_mov_b32 v105, 0
  v_mov_b32 v106, 0
  v_mov_b32 v107, 0
  v_mov_b32 v108, 0
  v_mov_b32 v109, 0
  v_mov_b32 v110, 0
  v_mov_b32 v111, 0
  s_branch scs_top
scs_redo:
  s_waitcnt lgkmcnt(0)
  s_mov_b32 s50, 0
scs_poll:
  buffer_load_dwordx4 v[16:19], v12, s[8:11], 0 offen offset:0 sc1
  buffer_load_dwordx4 v[20:23], v12, s[8:11], 0 offen offset:1024 sc1
  buffer_load_dwordx4 v[24:27], v12, s[8:11], 0 offen offset:2048 sc1
  buffer_load_dwordx4 v[28:31], v12, s[8:11], 0 offen offset:3072 sc1
  buffer_load_dwordx4 v[32:35], v12, s[8:11], s24 offen offset:0 sc1
  buffer_load_dwordx4 v[36:39], v12, s[8:11], s24 offen offset:1024 sc1
  buffer_load_dwordx4 v[40:43], v12, s[8:11], s24 offen offset:2048 sc1
  buffer_load_dwordx4 v[44:47], v12, s[8:11], s24 offen offset:3072 sc1
  buffer_load_dwordx4 v[48:51], v12, s[8:11], s25 offen offset:0 sc1
  buffer_load_dwordx4 v[52:55], v12, s[8:11], s25 offen offset:1024 sc1
  s_add_u32 s50, s50, 1
  s_cmp_gt_u32 s50, 131072
  s_cbranch_scc1 L_fail
  s_waitcnt vmcnt(0) lgkmcnt(0)
  v_max_u32 v136, v16, v17
  v_max3_u32 v136, v18, v19, v136
  v_max3_u32 v136, v20, v21, v136
  v_max3_u32 v136, v22, v23, v136
  v_max3_u32 v136, v24, v25, v136
  v_max3_u32 v136, v26, v27, v136
  v_max3_u32 v136, v28, v29, v136
  v_max3_u32 v136, v30, v31, v136
  v_max3_u32 v136, v32, v33, v136
  v_max3_u32 v136, v34, v35, v136
  v_max3_u32 v136, v36, v37, v136
  v_max3_u32 v136, v38, v39, v136
  v_max3_u32 v136, v40, v41, v136
  v_max3_u32 v136, v42, v43, v136
  v_max3_u32 v136, v44, v45, v136
  v_max3_u32 v136, v46, v47, v136
  v_max3_u32 v136, v48, v49, v136
  v_max3_u32 v136, v50, v51, v136
  v_max3_u32 v136, v52, v53, v136
  v_max3_u32 v136, v54, v55, v136
  v_cmp_eq_u32 vcc, -1, v136
  s_cbranch_vccnz scs_poll
  s_mov_b64 s[16:17], 0
  ds_read_b128 v[56:59], v2 offset:0
  ds_read_b128 v[60:63], v2 offset:4096
  ds_read_b128 v[64:67], v2 offset:8192
  ds_read_b128 v[68:71], v2 offset:12288
  ds_read_b128 v[72:75], v2 offset:16384
  ds_read_b128 v[76:79], v2 offset:20480
  ds_read_b128 v[80:83], v2 offset:49152
  ds_read_b128 v[84:87], v2 offset:53248
  v_mov_b32 v88, 0
  v_mov_b32 v89, 0
  v_mov_b32 v90, 0
  v_mov_b32 v91, 0
  v_mov_b32 v92, 0
  v_mov_b32 v93, 0
  v_mov_b32 v94, 0
  v_mov_b32 v95, 0
  v_mov_b32 v96, 0
  v_mov_b32 v97, 0
  v_mov_b32 v98, 0
  v_mov_b32 v99, 0
  v_mov_b32 v100, 0
  v_mov_b32 v101, 0
  v_mov_b32 v102, 0
  v_mov_b32 v103, 0
  v_mov_b32 v104, 0
  v_mov_b32 v105, 0
  v_mov_b32 v106, 0
  v_mov_b32 v107, 0
  v_mov_b32 v108, 0
  v_mov_b32 v109, 0
  v_mov_b32 v110, 0
  v_mov_b32 v111, 0
  s_waitcnt lgkmcnt(0)
  v_smfmac_f32_16x16x64_bf16 v[88:91], v[16:19], a[192:199], v7
  v_smfmac_f32_16x16x64_bf16 v[92:95], v[16:19], a[200:207], v7
  v_smfmac_f32_16x16x64_bf16 v[96:99], v[16:19], a[208:215], v7
  v_smfmac_f32_16x16x64_bf16 v[100:103], v[16:19], v[56:63], v7
  v_smfmac_f32_16x16x64_bf16 v[104:107], v[16:19], v[64:71], v7
  ds_read_b128 v[56:59], v2 offset:57344
  v_smfmac_f32_16x16x64_bf16 v[108:111], v[16:19], v[72:79], v7
  ds_read_b128 v[60:63], v2 offset:61440
  v_smfmac_f32_16x16x64_bf16 v[88:91], v[20:23], a[216:223], v7
  ds_read_b128 v[64:67], v3 offset:0
  v_smfmac_f32_16x16x64_bf16 v[92:95], v[20:23], a[224:231], v7
  ds_read_b128 v[68:71], v3 offset:4096
  v_smfmac_f32_16x16x64_bf16 v[96:99], v[20:23], a[232:239], v7
  v_smfmac_f32_16x16x64_bf16 v[100:103], v[20:23], a[0:7], v7
  ds_read_b128 v[72:75], v3 offset:8192
  v_smfmac_f32_16x16x64_bf16 v[104:107], v[20:23], a[8:15], v7
  ds_read_b128 v[76:79], v3 offset:12288
  v_smfmac_f32_16x16x64_bf16 v[108:111], v[20:23], a[16:23], v7
  v_smfmac_f32_16x16x64_bf16 v[88:91], v[24:27], a[240:247], v7
  v_smfmac_f32_16x16x64_bf16 v[92:95], v[24:27], a[248:255], v7
  v_smfmac_f32_16x16x64_bf16 v[96:99], v[24:27], v[152:159], v7
  v_smfmac_f32_16x16x64_bf16 v[100:103], v[24:27], a[24:31], v7
  v_smfmac_f32_16x16x64_bf16 v[104:107], v[24:27], a[32:39], v7
  v_smfmac_f32_16x16x64_bf16 v[108:111], v[24:27], a[40:47], v7
  v_smfmac_f32_16x16x64_bf16 v[88:91], v[28:31], v[80:87], v7
  s_waitcnt lgkmcnt(0)
  v_smfmac_f32_16x16x64_bf16 v[92:95], v[28:31], v[56:63], v7
  v_smfmac_f32_16x16x64_bf16 v[96:99], v[28:31], v[64:71], v7
  v_smfmac_f32_16x16x64_bf16 v[88:91], v[32:35], v[160:167], v7
  ds_read_b128 v[80:83], v3 offset:32768
  ds_read_b128 v[16:19], v13 offset:8192
  v_smfmac_f32_16x16x64_bf16 v[92:95], v[32:35], v[168:175], v7
  ds_read_b128 v[84:87], v3 offset:36864
  ds_read_b128 v[20:23], v13 offset:10240
  v_smfmac_f32_16x16x64_bf16 v[96:99], v[32:35], v[176:183], v7
  ds_read_b128 v[56:59], v3 offset:16384
  ds_read_b128 v[24:27], v13 offset:9216
  v_smfmac_f32_16x16x64_bf16 v[88:91], v[36:39], v[184:191], v7
  v_smfmac_f32_16x16x64_bf16 v[92:95], v[36:39], v[192:199], v7
  ds_read_b128 v[60:63], v3 offset:20480
  v_smfmac_f32_16x16x64_bf16 v[96:99], v[36:39], v[200:207], v7
  ds_read_b128 v[64:67], v3 offset:40960
  v_smfmac_f32_16x16x64_bf16 v[88:91], v[44:47], v[208:215], v7
  ds_read_b128 v[68:71], v3 offset:45056
  v_smfmac_f32_16x16x64_bf16 v[88:91], v[48:51], v[232:239], v7
  v_smfmac_f32_16x16x64_bf16 v[88:91], v[40:43], v[72:79], v7
  s_waitcnt lgkmcnt(3)
  v_smfmac_f32_16x16x64_bf16 v[88:91], v[52:55], v[80:87], v7
  ds_read_b128 v[72:75], v3 offset:24576
  s_waitcnt lgkmcnt(0)
  s_branch scs_join
sch_ha:
  s_waitcnt lgkmcnt(0)
  ds_read_b128 v[56:59], v2 offset:0
  ds_read_b128 v[60:63], v2 offset:4096
  ds_read_b128 v[64:67], v2 offset:8192
  ds_read_b128 v[68:71], v2 offset:12288
  ds_read_b128 v[72:75], v2 offset:16384
  ds_read_b128 v[76:79], v2 offset:20480
  ds_read_b128 v[80:83], v2 offset:49152
  ds_read_b128 v[84:87], v2 offset:53248
  v_mov_b32 v88, 0
  v_mov_b32 v89, 0
  v_mov_b32 v90, 0
  v_mov_b32 v91, 0
  v_mov_b32 v92, 0
  v_mov_b32 v93, 0
  v_mov_b32 v94, 0
  v_mov_b32 v95, 0
  v_mov_b32 v96, 0
  v_mov_b32 v97, 0
  v_mov_b32 v98, 0
  v_mov_b32 v99, 0
  v_mov_b32 v100, 0
  v_mov_b32 v101, 0
  v_mov_b32 v102, 0
  v_mov_b32 v103, 0
  v_mov_b32 v104, 0
  v_mov_b32 v105, 0
  v_mov_b32 v106, 0
  v_mov_b32 v107, 0
  v_mov_b32 v108, 0
  v_mov_b32 v109, 0
  v_mov_b32 v110, 0
  v_mov_b32 v111, 0
sch_ra:
  buffer_load_dwordx4 v[16:19], v12, s[8:11], 0 offen offset:0 sc1
  buffer_load_dwordx4 v[20:23], v12, s[8:11], 0 offen offset:1024 sc1
  buffer_load_dwordx4 v[24:27], v12, s[8:11], 0 offen offset:2048 sc1
  s_add_u32 s50, s50, 1
  s_cmp_gt_u32 s50, 131072
  s_cbranch_scc1 L_fail
  s_waitcnt vmcnt(0) lgkmcnt(0)
  v_max3_u32 v136, v16, v20, v24
  v_cmp_eq_u32 vcc, -1, v136
  s_cbranch_vccnz sch_ra
  s_branch sch_go
sch_hb:
  s_waitcnt lgkmcnt(0)
  s_add_u32 s50, s50, 1
  s_cmp_gt_u32 s50, 131072
  s_cbranch_scc1 L_fail
  ds_read_b128 v[56:59], v2 offset:0
  ds_read_b128 v[60:63], v2 offset:4096
  ds_read_b128 v[64:67], v2 offset:8192
  ds_read_b128 v[68:71], v2 offset:12288
  ds_read_b128 v[72:75], v2 offset:16384
  ds_read_b128 v[76:79], v2 offset:20480
  ds_read_b128 v[80:83], v2 offset:49152
  ds_read_b128 v[84:87], v2 offset:53248
  v_mov_b32 v88, 0
  v_mov_b32 v89, 0
  v_mov_b32 v90, 0
  v_mov_b32 v91, 0
  v_mov_b32 v92, 0
  v_mov_b32 v93, 0
  v_mov_b32 v94, 0
  v_mov_b32 v95, 0
  v_mov_b32 v96, 0
  v_mov_b32 v97, 0
  v_mov_b32 v98, 0
  v_mov_b32 v99, 0
  v_mov_b32 v100, 0
  v_mov_b32 v101, 0
  v_mov_b32 v102, 0
  v_mov_b32 v103, 0
  v_mov_b32 v104, 0
  v_mov_b32 v105, 0
  v_mov_b32 v106, 0
  v_mov_b32 v107, 0
  v_mov_b32 v108, 0
  v_mov_b32 v109, 0
  v_mov_b32 v110, 0
  v_mov_b32 v111, 0
  s_branch sch_top
sch_redo:
  s_waitcnt lgkmcnt(0)
  s_mov_b32 s50, 0
sch_poll:
  buffer_load_dwordx4 v[16:19], v12, s[8:11], 0 offen offset:0 sc1
  buffer_load_dwordx4 v[20:23], v12, s[8:11], 0 offen offset:1024 sc1
  buffer_load_dwordx4 v[24:27], v12, s[8:11], 0 offen offset:2048 sc1
  buffer_load_dwordx4 v[28:31], v12, s[8:11], 0 offen offset:3072 sc1
  buffer_load_dwordx4 v[32:35], v12, s[8:11], s24 offen offset:0 sc1
  buffer_load_dwordx4 v[36:39], v12, s[8:11], s24 offen offset:1024 sc1
  buffer_load_dwordx4 v[40:43], v12, s[8:11], s24 offen offset:2048 sc1
  buffer_load_dwordx4 v[44:47], v12, s[8:11], s24 offen offset:3072 sc1
  buffer_load_dwordx4 v[48:51], v12, s[8:11], s25 offen offset:0 sc1
  buffer_load_dwordx4 v[52:55], v12, s[8:11], s25 offen offset:1024 sc1
  s_add_u32 s50, s50, 1
  s_cmp_gt_u32 s50, 131072
  s_cbranch_scc1 L_fail
  s_waitcnt vmcnt(0) lgkmcnt(0)
  v_max_u32 v136, v16, v17
  v_max3_u32 v136, v18, v19, v136
  v_max3_u32 v136, v20, v21, v136
  v_max3_u32 v136, v22, v23, v136
  v_max3_u32 v136, v24, v25, v136
  v_max3_u32 v136, v26, v27, v136
  v_max3_u32 v136, v28, v29, v136
  v_max3_u32 v136, v30, v31, v136
  v_max3_u32 v136, v32, v33, v136
  v_max3_u32 v136, v34, v35, v136
  v_max3_u32 v136, v36, v37, v136
  v_max3_u32 v136, v38, v39, v136
  v_max3_u32 v136, v40, v41, v136
  v_max3_u32 v136, v42, v43, v136
  v_max3_u32 v136, v44, v45, v136
  v_max3_u32 v136, v46, v47, v136
  v_max3_u32 v136, v48, v49, v136
  v_max3_u32 v136, v50, v51, v136
  v_max3_u32 v136, v52, v53, v136
  v_max3_u32 v136, v54, v55, v136
  v_cmp_eq_u32 vcc, -1, v136
  s_cbranch_vccnz sch_poll
  s_mov_b64 s[16:17], 0
  ds_read_b128 v[56:59], v2 offset:0
  ds_read_b128 v[60:63], v2 offset:4096
  ds_read_b128 v[64:67], v2 offset:8192
  ds_read_b128 v[68:71], v2 offset:12288
  ds_read_b128 v[72:75], v2 offset:16384
  ds_read_b128 v[76:79], v2 offset:20480
  ds_read_b128 v[80:83], v2 offset:49152
  ds_read_b128 v[84:87], v2 offset:53248
  v_mov_b32 v88, 0
  v_mov_b32 v89, 0
  v_mov_b32 v90, 0
  v_mov_b32 v91, 0
  v_mov_b32 v92, 0
  v_mov_b32 v93, 0
  v_mov_b32 v94, 0
  v_mov_b32 v95, 0
  v_mov_b32 v96, 0
  v_mov_b32 v97, 0
  v_mov_b32 v98, 0
  v_mov_b32 v99, 0
  v_mov_b32 v100, 0
  v_mov_b32 v101, 0
  v_mov_b32 v102, 0
  v_mov_b32 v103, 0
  v_mov_b32 v104, 0
  v_mov_b32 v105, 0
  v_mov_b32 v106, 0
  v_mov_b32 v107, 0
  v_mov_b32 v108, 0
  v_mov_b32 v109, 0
  v_mov_b32 v110, 0
  v_mov_b32 v111, 0
  s_waitcnt lgkmcnt(0)
  v_smfmac_f32_16x16x64_bf16 v[88:91], v[16:19], a[192:199], v7
  v_smfmac_f32_16x16x64_bf16 v[92:95], v[16:19], a[200:207], v7
  v_smfmac_f32_16x16x64_bf16 v[96:99], v[16:19], a[208:215], v7
  v_smfmac_f32_16x16x64_bf16 v[100:103], v[16:19], v[56:63], v7
  v_smfmac_f32_16x16x64_bf16 v[104:107], v[16:19], v[64:71], v7
  ds_read_b128 v[56:59], v2 offset:57344
  v_smfmac_f32_16x16x64_bf16 v[108:111], v[16:19], v[72:79], v7
  ds_read_b128 v[60:63], v2 offset:61440
  v_smfmac_f32_16x16x64_bf16 v[88:91], v[20:23], a[216:223], v7
  ds_read_b128 v[64:67], v3 offset:0
  v_smfmac_f32_16x16x64_bf16 v[92:95], v[20:23], a[224:231], v7
  ds_read_b128 v[68:71], v3 offset:4096
  v_smfmac_f32_16x16x64_bf16 v[96:99], v[20:23], a[232:239], v7
  v_smfmac_f32_16x16x64_bf16 v[100:103], v[20:23], a[0:7], v7
  ds_read_b128 v[72:75], v3 offset:8192
  v_smfmac_f32_16x16x64_bf16 v[104:107], v[20:23], a[8:15], v7
  ds_read_b128 v[76:79], v3 offset:12288
  v_smfmac_f32_16x16x64_bf16 v[108:111], v[20:23], a[16:23], v7
  v_smfmac_f32_16x16x64_bf16 v[88:91], v[24:27], a[240:247], v7
  v_smfmac_f32_16x16x64_bf16 v[92:95], v[24:27], a[248:255], v7
  v_smfmac_f32_16x16x64_bf16 v[96:99], v[24:27], v[152:159], v7
  v_smfmac_f32_16x16x64_bf16 v[100:103], v[24:27], a[24:31], v7
  v_smfmac_f32_16x16x64_bf16 v[104:107], v[24:27], a[32:39], v7
  v_smfmac_f32_16x16x64_bf16 v[108:111], v[24:27], a[40:47], v7
  v_smfmac_f32_16x16x64_bf16 v[88:91], v[28:31], v[80:87], v7
  s_waitcnt lgkmcnt(0)
  v_smfmac_f32_16x16x64_bf16 v[92:95], v[28:31], v[56:63], v7
  v_smfmac_f32_16x16x64_bf16 v[96:99], v[28:31], v[64:71], v7
  v_smfmac_f32_16x16x64_bf16 v[88:91], v[32:35], v[160:167], v7
  ds_read_b128 v[80:83], v3 offset:32768
  v_smfmac_f32_16x16x64_bf16 v[92:95], v[32:35], v[168:175], v7
  ds_read_b128 v[84:87], v3 offset:36864
  v_smfmac_f32_16x16x64_bf16 v[96:99], v[32:35], v[176:183], v7
  ds_read_b128 v[56:59], v3 offset:16384
  v_smfmac_f32_16x16x64_bf16 v[88:91], v[36:39], v[184:191], v7
  v_smfmac_f32_16x16x64_bf16 v[92:95], v[36:39], v[192:199], v7
  ds_read_b128 v[60:63], v3 offset:20480
  v_smfmac_f32_16x16x64_bf16 v[96:99], v[36:39], v[200:207], v7
  ds_read_b128 v[64:67], v3 offset:40960
  v_smfmac_f32_16x16x64_bf16 v[88:91], v[44:47], v[208:215], v7
  ds_read_b128 v[68:71], v3 offset:45056
  v_smfmac_f32_16x16x64_bf16 v[88:91], v[48:51], v[232:239], v7
  v_smfmac_f32_16x16x64_bf16 v[88:91], v[40:43], v[72:79], v7
  s_waitcnt lgkmcnt(3)
  v_smfmac_f32_16x16x64_bf16 v[88:91], v[52:55], v[80:87], v7
  ds_read_b128 v[72:75], v3 offset:24576
  s_mov_b32 m0, s21
  s_waitcnt lgkmcnt(0)
  s_branch sch_join
L_value:
  s_mov_b32 s4, s30
  s_mov_b32 s5, s31
  s_mov_b32 s6, 7864320
  s_mov_b32 s7, 0x20000
  s_mov_b32 s12, s32
  s_mov_b32 s13, s33
  s_mov_b32 s14, 7864320
  s_mov_b32 s15, 0x20000
  v_lshrrev_b32 v148, 3, v0
  v_lshrrev_b32 v149, 2, v148
  v_lshlrev_b32 v149, 3, v149
  v_and_b32 v64, 3, v148
  v_add_u32 v64, v64, v149
  s_and_b32 s46, s42, 1
  s_lshl_b32 s46, s46, 2
  s_lshr_b32 s47, s42, 1
  s_lshl_b32 s47, s47, 4
  s_add_u32 s46, s46, s47
  v_add_u32 v64, s46, v64
  v_mul_u32_u24 v64, 12288, v64
  v_lshrrev_b32 v148, 1, v148
  v_bfe_u32 v149, v0, 1, 2
  v_xor_b32 v148, v148, v149
  v_lshlrev_b32 v148, 5, v148
  v_and_b32 v149, 1, v0
  v_lshlrev_b32 v149, 4, v149
  v_add3_u32 v64, v64, v148, v149
  v_lshrrev_b32 v148, 3, v0
  v_lshrrev_b32 v149, 2, v148
  v_lshlrev_b32 v149, 3, v149
  v_and_b32 v65, 3, v148
  v_add_u32 v65, v65, v149
  s_and_b32 s46, s42, 1
  s_lshl_b32 s46, s46, 2
  s_lshr_b32 s47, s42, 1
  s_lshl_b32 s47, s47, 4
  s_add_u32 s46, s46, s47
  v_add_u32 v65, s46, v65
  v_mul_u32_u24 v65, 1280, v65
  v_lshrrev_b32 v148, 1, v148
  v_bfe_u32 v149, v0, 1, 2
  v_xor_b32 v148, v148, v149
  v_lshlrev_b32 v148, 5, v148
  v_and_b32 v149, 1, v0
  v_lshlrev_b32 v149, 4, v149
  v_add3_u32 v65, v65, v148, v149
  v_lshrrev_b32 v148, 5, v0
  v_lshlrev_b32 v66, 11, v148
  v_bfe_u32 v148, v0, 2, 3
  v_lshl_add_u32 v66, v148, 7, v66
  v_lshrrev_b32 v148, 1, v148
  v_xor_b32 v148, s42, v148
  v_lshl_add_u32 v66, v148, 5, v66
  v_and_b32 v148, 3, v0
  v_lshl_add_u32 v66, v148, 3, v66
  v_add_u32 v67, 0x10000, v66
  v_add_u32 v68, 0x20000, v66
  v_lshlrev_b32 v1, 4, v0
  v_add_u32 v2, s51, v1
  v_add_u32 v3, 0x10000, v2
  s_mul_i32 s62, s45, 384
  s_mul_i32 s63, s45, 245760
  s_mov_b32 s24, 4096
  s_mov_b32 s25, 49152
  s_add_u32 m0, s51, 73728
  s_add_u32 s46, s62, 0
  buffer_load_dwordx4 v64, s[4:7], s46 offen lds
  s_add_u32 m0, s51, 77824
  s_add_u32 s46, s62, 393216
  buffer_load_dwordx4 v64, s[4:7], s46 offen lds
  s_add_u32 m0, s51, 81920
  s_add_u32 s46, s62, 128
  buffer_load_dwordx4 v64, s[4:7], s46 offen lds
  s_add_u32 m0, s51, 86016
  s_add_u32 s46, s62, 393344
  buffer_load_dwordx4 v64, s[4:7], s46 offen lds
  s_add_u32 m0, s51, 90112
  s_add_u32 s46, s62, 256
  buffer_load_dwordx4 v64, s[4:7], s46 offen lds
  s_add_u32 m0, s51, 94208
  s_add_u32 s46, s62, 393472
  buffer_load_dwordx4 v64, s[4:7], s46 offen lds
  s_add_u32 m0, s51, 98304
  s_add_u32 s46, s62, 786432
  buffer_load_dwordx4 v64, s[4:7], s46 offen lds
  s_add_u32 m0, s51, 102400
  s_add_u32 s46, s62, 1179648
  buffer_load_dwordx4 v64, s[4:7], s46 offen lds
  s_add_u32 m0, s51, 106496
  s_add_u32 s46, s62, 786560
  buffer_load_dwordx4 v64, s[4:7], s46 offen lds
  s_add_u32 m0, s51, 110592
  s_add_u32 s46, s62, 1179776
  buffer_load_dwordx4 v64, s[4:7], s46 offen lds
  s_add_u32 m0, s51, 114688
  s_add_u32 s46, s62, 786688
  buffer_load_dwordx4 v64, s[4:7], s46 offen lds
  s_add_u32 m0, s51, 118784
  s_add_u32 s46, s62, 1179904
  buffer_load_dwordx4 v64, s[4:7], s46 offen lds
  s_add_u32 m0, s51, 122880
  s_add_u32 s46, s62, 2359296
  buffer_load_dwordx4 v64, s[4:7], s46 offen lds
  s_add_u32 m0, s51, 126976
  s_add_u32 s46, s62, 2752512
  buffer_load_dwordx4 v64, s[4:7], s46 offen lds
  s_add_u32 m0, s51, 131072
  s_add_u32 s46, s62, 2359424
  buffer_load_dwordx4 v64, s[4:7], s46 offen lds
  s_add_u32 m0, s51, 135168
  s_add_u32 s46, s62, 2752640
  buffer_load_dwordx4 v64, s[4:7], s46 offen lds
  s_add_u32 m0, s51, 139264
  s_add_u32 s46, s62, 2359552
  buffer_load_dwordx4 v64, s[4:7], s46 offen lds
  s_add_u32 m0, s51, 143360
  s_add_u32 s46, s62, 2752768
  buffer_load_dwordx4 v64, s[4:7], s46 offen lds
  s_add_u32 m0, s51, 0
  s_add_u32 s46, s62, 3145728
  buffer_load_dwordx4 v64, s[4:7], s46 offen lds
  s_add_u32 m0, s51, 4096
  s_add_u32 s46, s62, 3538944
  buffer_load_dwordx4 v64, s[4:7], s46 offen lds
  s_add_u32 m0, s51, 8192
  s_add_u32 s46, s62, 3145856
  buffer_load_dwordx4 v64, s[4:7], s46 offen lds
  s_add_u32 m0, s51, 12288
  s_add_u32 s46, s62, 3539072
  buffer_load_dwordx4 v64, s[4:7], s46 offen lds
  s_add_u32 m0, s51, 16384
  s_add_u32 s46, s62, 3145984
  buffer_load_dwordx4 v64, s[4:7], s46 offen lds
  s_add_u32 m0, s51, 20480
  s_add_u32 s46, s62, 3539200
  buffer_load_dwordx4 v64, s[4:7], s46 offen lds
  s_add_u32 m0, s51, 24576
  s_add_u32 s46, s62, 4718592
  buffer_load_dwordx4 v64, s[4:7], s46 offen lds
  s_add_u32 m0, s51, 28672
  s_add_u32 s46, s62, 5111808
  buffer_load_dwordx4 v64, s[4:7], s46 offen lds
  s_add_u32 m0, s51, 32768
  s_add_u32 s46, s62, 4718720
  buffer_load_dwordx4 v64, s[4:7], s46 offen lds
  s_add_u32 m0, s51, 36864
  s_add_u32 s46, s62, 5111936
  buffer_load_dwordx4 v64, s[4:7], s46 offen lds
  s_add_u32 m0, s51, 40960
  s_add_u32 s46, s62, 4718848
  buffer_load_dwordx4 v64, s[4:7], s46 offen lds
  s_add_u32 m0, s51, 45056
  s_add_u32 s46, s62, 5112064
  buffer_load_dwordx4 v64, s[4:7], s46 offen lds
  s_waitcnt vmcnt(24)
  s_barrier
  s_add_u32 m0, s51, 49152
  s_add_u32 s46, s62, 5505024
  buffer_load_dwordx4 v64, s[4:7], s46 offen lds
  s_add_u32 m0, s51, 53248
  s_add_u32 s46, s62, 5898240
  buffer_load_dwordx4 v64, s[4:7], s46 offen lds
  s_add_u32 m0, s51, 57344
  s_add_u32 s46, s62, 5505152
  buffer_load_dwordx4 v64, s[4:7], s46 offen lds
  s_add_u32 m0, s51, 61440
  s_add_u32 s46, s62, 5898368
  buffer_load_dwordx4 v64, s[4:7], s46 offen lds
  s_add_u32 m0, s51, 65536
  s_add_u32 s46, s62, 5505280
  buffer_load_dwordx4 v64, s[4:7], s46 offen lds
  s_add_u32 m0, s51, 69632
  s_add_u32 s46, s62, 5898496
  buffer_load_dwordx4 v64, s[4:7], s46 offen lds
  ds_read_b64_tr_b16 a[0:1], v67 offset:8192
  ds_read_b64_tr_b16 a[2:3], v67 offset:9216
  ds_read_b64_tr_b16 a[4:5], v67 offset:12288
  ds_read_b64_tr_b16 a[6:7], v67 offset:13312
  ds_read_b64_tr_b16 a[8:9], v67 offset:16384
  ds_read_b64_tr_b16 a[10:11], v67 offset:17408
  ds_read_b64_tr_b16 a[12:13], v67 offset:20480
  ds_read_b64_tr_b16 a[14:15], v67 offset:21504
  ds_read_b64_tr_b16 a[16:17], v67 offset:24576
  ds_read_b64_tr_b16 a[18:19], v67 offset:25600
  ds_read_b64_tr_b16 a[20:21], v67 offset:28672
  ds_read_b64_tr_b16 a[22:23], v67 offset:29696
  s_waitcnt lgkmcnt(0)
  s_waitcnt vmcnt(24)
  s_barrier
  s_add_u32 m0, s51, 73728
  s_add_u32 s46, s62, 7077888
  buffer_load_dwordx4 v64, s[4:7], s46 offen lds
  s_add_u32 m0, s51, 77824
  s_add_u32 s46, s62, 7471104
  buffer_load_dwordx4 v64, s[4:7], s46 offen lds
  s_add_u32 m0, s51, 81920
  s_add_u32 s46, s62, 7078016
  buffer_load_dwordx4 v64, s[4:7], s46 offen lds
  s_add_u32 m0, s51, 86016
  s_add_u32 s46, s62, 7471232
  buffer_load_dwordx4 v64, s[4:7], s46 offen lds
  s_add_u32 m0, s51, 90112
  s_add_u32 s46, s62, 7078144
  buffer_load_dwordx4 v64, s[4:7], s46 offen lds
  s_add_u32 m0, s51, 94208
  s_add_u32 s46, s62, 7471360
  buffer_load_dwordx4 v64, s[4:7], s46 offen lds
  ds_read_b64_tr_b16 a[24:25], v67 offset:32768
  ds_read_b64_tr_b16 a[26:27], v67 offset:33792
  ds_read_b64_tr_b16 a[28:29], v67 offset:36864
  ds_read_b64_tr_b16 a[30:31], v67 offset:37888
  ds_read_b64_tr_b16 a[32:33], v67 offset:40960
  ds_read_b64_tr_b16 a[34:35], v67 offset:41984
  ds_read_b64_tr_b16 a[36:37], v67 offset:45056
  ds_read_b64_tr_b16 a[38:39], v67 offset:46080
  ds_read_b64_tr_b16 a[40:41], v67 offset:49152
  ds_read_b64_tr_b16 a[42:43], v67 offset:50176
  ds_read_b64_tr_b16 a[44:45], v67 offset:53248
  ds_read_b64_tr_b16 a[46:47], v67 offset:54272
  s_waitcnt lgkmcnt(0)
  s_waitcnt vmcnt(24)
  s_barrier
  s_add_u32 m0, s51, 98304
  s_add_u32 s46, s63, 0
  buffer_load_dwordx4 v65, s[12:15], s46 offen lds
  s_add_u32 m0, s51, 102400
  s_add_u32 s46, s63, 40960
  buffer_load_dwordx4 v65, s[12:15], s46 offen lds
  s_add_u32 m0, s51, 106496
  s_add_u32 s46, s63, 81920
  buffer_load_dwordx4 v65, s[12:15], s46 offen lds
  s_add_u32 m0, s51, 110592
  s_add_u32 s46, s63, 122880
  buffer_load_dwordx4 v65, s[12:15], s46 offen lds
  s_add_u32 m0, s51, 114688
  s_add_u32 s46, s63, 163840
  buffer_load_dwordx4 v65, s[12:15], s46 offen lds
  s_add_u32 m0, s51, 118784
  s_add_u32 s46, s63, 204800
  buffer_load_dwordx4 v65, s[12:15], s46 offen lds
  ds_read_b64_tr_b16 a[48:49], v67 offset:57344
  ds_read_b64_tr_b16 a[50:51], v67 offset:58368
  ds_read_b64_tr_b16 a[52:53], v67 offset:61440
  ds_read_b64_tr_b16 a[54:55], v67 offset:62464
  ds_read_b64_tr_b16 a[56:57], v68 offset:0
  ds_read_b64_tr_b16 a[58:59], v68 offset:1024
  ds_read_b64_tr_b16 a[60:61], v68 offset:4096
  ds_read_b64_tr_b16 a[62:63], v68 offset:5120
  ds_read_b64_tr_b16 a[64:65], v68 offset:8192
  ds_read_b64_tr_b16 a[66:67], v68 offset:9216
  ds_read_b64_tr_b16 a[68:69], v68 offset:12288
  ds_read_b64_tr_b16 a[70:71], v68 offset:13312
  s_waitcnt lgkmcnt(0)
  s_waitcnt vmcnt(24)
  s_barrier
  s_add_u32 m0, s51, 122880
  s_add_u32 s46, s63, 128
  buffer_load_dwordx4 v65, s[12:15], s46 offen lds
  s_add_u32 m0, s51, 126976
  s_add_u32 s46, s63, 41088
  buffer_load_dwordx4 v65, s[12:15], s46 offen lds
  s_add_u32 m0, s51, 131072
  s_add_u32 s46, s63, 82048
  buffer_load_dwordx4 v65, s[12:15], s46 offen lds
  s_add_u32 m0, s51, 135168
  s_add_u32 s46, s63, 123008
  buffer_load_dwordx4 v65, s[12:15], s46 offen lds
  s_add_u32 m0, s51, 139264
  s_add_u32 s46, s63, 163968
  buffer_load_dwordx4 v65, s[12:15], s46 offen lds
  s_add_u32 m0, s51, 143360
  s_add_u32 s46, s63, 204928
  buffer_load_dwordx4 v65, s[12:15], s46 offen lds
  ds_read_b64_tr_b16 a[72:73], v66 offset:0
  ds_read_b64_tr_b16 a[74:75], v66 offset:1024
  ds_read_b64_tr_b16 a[76:77], v66 offset:4096
  ds_read_b64_tr_b16 a[78:79], v66 offset:5120
  ds_read_b64_tr_b16 a[80:81], v66 offset:8192
  ds_read_b64_tr_b16 a[82:83], v66 offset:9216
  ds_read_b64_tr_b16 a[84:85], v66 offset:12288
  ds_read_b64_tr_b16 a[86:87], v66 offset:13312
  ds_read_b64_tr_b16 a[88:89], v66 offset:16384
  ds_read_b64_tr_b16 a[90:91], v66 offset:17408
  ds_read_b64_tr_b16 a[92:93], v66 offset:20480
  ds_read_b64_tr_b16 a[94:95], v66 offset:21504
  s_waitcnt lgkmcnt(0)
  s_waitcnt vmcnt(24)
  s_barrier
  s_add_u32 m0, s51, 0
  s_add_u32 s46, s63, 256
  buffer_load_dwordx4 v65, s[12:15], s46 offen lds
  s_add_u32 m0, s51, 4096
  s_add_u32 s46, s63, 41216
  buffer_load_dwordx4 v65, s[12:15], s46 offen lds
  s_add_u32 m0, s51, 8192
  s_add_u32 s46, s63, 82176
  buffer_load_dwordx4 v65, s[12:15], s46 offen lds
  s_add_u32 m0, s51, 12288
  s_add_u32 s46, s63, 123136
  buffer_load_dwordx4 v65, s[12:15], s46 offen lds
  s_add_u32 m0, s51, 16384
  s_add_u32 s46, s63, 164096
  buffer_load_dwordx4 v65, s[12:15], s46 offen lds
  s_add_u32 m0, s51, 20480
  s_add_u32 s46, s63, 205056
  buffer_load_dwordx4 v65, s[12:15], s46 offen lds
  ds_read_b64_tr_b16 a[96:97], v66 offset:24576
  ds_read_b64_tr_b16 a[98:99], v66 offset:25600
  ds_read_b64_tr_b16 a[100:101], v66 offset:28672
  ds_read_b64_tr_b16 a[102:103], v66 offset:29696
  ds_read_b64_tr_b16 a[104:105], v66 offset:32768
  ds_read_b64_tr_b16 a[106:107], v66 offset:33792
  ds_read_b64_tr_b16 a[108:109], v66 offset:36864
  ds_read_b64_tr_b16 a[110:111], v66 offset:37888
  ds_read_b64_tr_b16 a[112:113], v66 offset:40960
  ds_read_b64_tr_b16 a[114:115], v66 offset:41984
  ds_read_b64_tr_b16 a[116:117], v66 offset:45056
  ds_read_b64_tr_b16 a[118:119], v66 offset:46080
  s_waitcnt lgkmcnt(0)
  s_waitcnt vmcnt(24)
  s_barrier
  s_add_u32 m0, s51, 24576
  s_add_u32 s46, s63, 384
  buffer_load_dwordx4 v65, s[12:15], s46 offen lds
  s_add_u32 m0, s51, 28672
  s_add_u32 s46, s63, 41344
  buffer_load_dwordx4 v65, s[12:15], s46 offen lds
  s_add_u32 m0, s51, 32768
  s_add_u32 s46, s63, 82304
  buffer_load_dwordx4 v65, s[12:15], s46 offen lds
  s_add_u32 m0, s51, 36864
  s_add_u32 s46, s63, 123264
  buffer_load_dwordx4 v65, s[12:15], s46 offen lds
  s_add_u32 m0, s51, 40960
  s_add_u32 s46, s63, 164224
  buffer_load_dwordx4 v65, s[12:15], s46 offen lds
  s_add_u32 m0, s51, 45056
  s_add_u32 s46, s63, 205184
  buffer_load_dwordx4 v65, s[12:15], s46 offen lds
  ds_read_b64_tr_b16 a[120:121], v66 offset:49152
  ds_read_b64_tr_b16 a[122:123], v66 offset:50176
  ds_read_b64_tr_b16 a[124:125], v66 offset:53248
  ds_read_b64_tr_b16 a[126:127], v66 offset:54272
  ds_read_b64_tr_b16 a[128:129], v66 offset:57344
  ds_read_b64_tr_b16 a[130:131], v66 offset:58368
  ds_read_b64_tr_b16 a[132:133], v66 offset:61440
  ds_read_b64_tr_b16 a[134:135], v66 offset:62464
  ds_read_b64_tr_b16 a[136:137], v67 offset:0
  ds_read_b64_tr_b16 a[138:139], v67 offset:1024
  ds_read_b64_tr_b16 a[140:141], v67 offset:4096
  ds_read_b64_tr_b16 a[142:143], v67 offset:5120
  s_waitcnt lgkmcnt(0)
  s_waitcnt vmcnt(24)
  s_barrier
  s_add_u32 m0, s51, 49152
  s_add_u32 s46, s63, 640
  buffer_load_dwordx4 v65, s[12:15], s46 offen lds
  s_add_u32 m0, s51, 53248
  s_add_u32 s46, s63, 41600
  buffer_load_dwordx4 v65, s[12:15], s46 offen lds
  s_add_u32 m0, s51, 57344
  s_add_u32 s46, s63, 82560
  buffer_load_dwordx4 v65, s[12:15], s46 offen lds
  s_add_u32 m0, s51, 61440
  s_add_u32 s46, s63, 123520
  buffer_load_dwordx4 v65, s[12:15], s46 offen lds
  s_add_u32 m0, s51, 65536
  s_add_u32 s46, s63, 164480
  buffer_load_dwordx4 v65, s[12:15], s46 offen lds
  s_add_u32 m0, s51, 69632
  s_add_u32 s46, s63, 205440
  buffer_load_dwordx4 v65, s[12:15], s46 offen lds
  ds_read_b64_tr_b16 a[144:145], v67 offset:8192
  ds_read_b64_tr_b16 a[146:147], v67 offset:9216
  ds_read_b64_tr_b16 a[148:149], v67 offset:12288
  ds_read_b64_tr_b16 a[150:151], v67 offset:13312
  ds_read_b64_tr_b16 a[152:153], v67 offset:16384
  ds_read_b64_tr_b16 a[154:155], v67 offset:17408
  ds_read_b64_tr_b16 a[156:157], v67 offset:20480
  ds_read_b64_tr_b16 a[158:159], v67 offset:21504
  ds_read_b64_tr_b16 a[160:161], v67 offset:24576
  ds_read_b64_tr_b16 a[162:163], v67 offset:25600
  ds_read_b64_tr_b16 a[164:165], v67 offset:28672
  ds_read_b64_tr_b16 a[166:167], v67 offset:29696
  s_waitcnt lgkmcnt(0)
  s_waitcnt vmcnt(24)
  s_barrier
  s_add_u32 m0, s51, 73728
  s_add_u32 s46, s63, 768
  buffer_load_dwordx4 v65, s[12:15], s46 offen lds
  s_add_u32 m0, s51, 77824
  s_add_u32 s46, s63, 41728
  buffer_load_dwordx4 v65, s[12:15], s46 offen lds
  s_add_u32 m0, s51, 81920
  s_add_u32 s46, s63, 82688
  buffer_load_dwordx4 v65, s[12:15], s46 offen lds
  s_add_u32 m0, s51, 86016
  s_add_u32 s46, s63, 123648
  buffer_load_dwordx4 v65, s[12:15], s46 offen lds
  s_add_u32 m0, s51, 90112
  s_add_u32 s46, s63, 164608
  buffer_load_dwordx4 v65, s[12:15], s46 offen lds
  s_add_u32 m0, s51, 94208
  s_add_u32 s46, s63, 205568
  buffer_load_dwordx4 v65, s[12:15], s46 offen lds
  ds_read_b64_tr_b16 a[168:169], v67 offset:32768
  ds_read_b64_tr_b16 a[170:171], v67 offset:33792
  ds_read_b64_tr_b16 a[172:173], v67 offset:36864
  ds_read_b64_tr_b16 a[174:175], v67 offset:37888
  ds_read_b64_tr_b16 a[176:177], v67 offset:40960
  ds_read_b64_tr_b16 a[178:179], v67 offset:41984
  ds_read_b64_tr_b16 a[180:181], v67 offset:45056
  ds_read_b64_tr_b16 a[182:183], v67 offset:46080
  ds_read_b64_tr_b16 a[184:185], v67 offset:49152
  ds_read_b64_tr_b16 a[186:187], v67 offset:50176
  ds_read_b64_tr_b16 a[188:189], v67 offset:53248
  ds_read_b64_tr_b16 a[190:191], v67 offset:54272
  s_waitcnt lgkmcnt(0)
  s_waitcnt vmcnt(24)
  s_barrier
  s_add_u32 m0, s51, 98304
  s_add_u32 s46, s63, 896
  buffer_load_dwordx4 v65, s[12:15], s46 offen lds
  s_add_u32 m0, s51, 102400
  s_add_u32 s46, s63, 41856
  buffer_load_dwordx4 v65, s[12:15], s46 offen lds
  s_add_u32 m0, s51, 106496
  s_add_u32 s46, s63, 82816
  buffer_load_dwordx4 v65, s[12:15], s46 offen lds
  s_add_u32 m0, s51, 110592
  s_add_u32 s46, s63, 123776
  buffer_load_dwordx4 v65, s[12:15], s46 offen lds
  s_add_u32 m0, s51, 114688
  s_add_u32 s46, s63, 164736
  buffer_load_dwordx4 v65, s[12:15], s46 offen lds
  s_add_u32 m0, s51, 118784
  s_add_u32 s46, s63, 205696
  buffer_load_dwordx4 v65, s[12:15], s46 offen lds
  ds_read_b64_tr_b16 a[192:193], v67 offset:57344
  ds_read_b64_tr_b16 a[194:195], v67 offset:58368
  ds_read_b64_tr_b16 a[196:197], v67 offset:61440
  ds_read_b64_tr_b16 a[198:199], v67 offset:62464
  ds_read_b64_tr_b16 a[200:201], v68 offset:0
  ds_read_b64_tr_b16 a[202:203], v68 offset:1024
  ds_read_b64_tr_b16 a[204:205], v68 offset:4096
  ds_read_b64_tr_b16 a[206:207], v68 offset:5120
  ds_read_b64_tr_b16 a[208:209], v68 offset:8192
  ds_read_b64_tr_b16 a[210:211], v68 offset:9216
  ds_read_b64_tr_b16 a[212:213], v68 offset:12288
  ds_read_b64_tr_b16 a[214:215], v68 offset:13312
  s_waitcnt lgkmcnt(0)
  s_waitcnt vmcnt(24)
  s_barrier
  s_add_u32 m0, s51, 122880
  s_add_u32 s46, s63, 1152
  buffer_load_dwordx4 v65, s[12:15], s46 offen lds
  s_add_u32 m0, s51, 126976
  s_add_u32 s46, s63, 42112
  buffer_load_dwordx4 v65, s[12:15], s46 offen lds
  s_add_u32 m0, s51, 131072
  s_add_u32 s46, s63, 83072
  buffer_load_dwordx4 v65, s[12:15], s46 offen lds
  s_add_u32 m0, s51, 135168
  s_add_u32 s46, s63, 124032
  buffer_load_dwordx4 v65, s[12:15], s46 offen lds
  s_add_u32 m0, s51, 139264
  s_add_u32 s46, s63, 164992
  buffer_load_dwordx4 v65, s[12:15], s46 offen lds
  s_add_u32 m0, s51, 143360
  s_add_u32 s46, s63, 205952
  buffer_load_dwordx4 v65, s[12:15], s46 offen lds
  ds_read_b64_tr_b16 a[216:217], v66 offset:0
  ds_read_b64_tr_b16 a[218:219], v66 offset:1024
  ds_read_b64_tr_b16 a[220:221], v66 offset:4096
  ds_read_b64_tr_b16 a[222:223], v66 offset:5120
  ds_read_b64_tr_b16 a[224:225], v66 offset:8192
  ds_read_b64_tr_b16 a[226:227], v66 offset:9216
  ds_read_b64_tr_b16 a[228:229], v66 offset:12288
  ds_read_b64_tr_b16 a[230:231], v66 offset:13312
  ds_read_b64_tr_b16 a[232:233], v66 offset:16384
  ds_read_b64_tr_b16 a[234:235], v66 offset:17408
  ds_read_b64_tr_b16 a[236:237], v66 offset:20480
  ds_read_b64_tr_b16 a[238:239], v66 offset:21504
  s_waitcnt lgkmcnt(0)
  s_waitcnt vmcnt(24)
  s_barrier
  s_add_u32 m0, s51, 0
  s_add_u32 s46, s62, 1572864
  buffer_load_dwordx4 v64, s[4:7], s46 offen lds
  s_add_u32 m0, s51, 4096
  s_add_u32 s46, s62, 1966080
  buffer_load_dwordx4 v64, s[4:7], s46 offen lds
  s_add_u32 m0, s51, 8192
  s_add_u32 s46, s62, 1572992
  buffer_load_dwordx4 v64, s[4:7], s46 offen lds
  s_add_u32 m0, s51, 12288
  s_add_u32 s46, s62, 1966208
  buffer_load_dwordx4 v64, s[4:7], s46 offen lds
  s_add_u32 m0, s51, 16384
  s_add_u32 s46, s62, 1573120
  buffer_load_dwordx4 v64, s[4:7], s46 offen lds
  s_add_u32 m0, s51, 20480
  s_add_u32 s46, s62, 1966336
  buffer_load_dwordx4 v64, s[4:7], s46 offen lds
  ds_read_b64_tr_b16 a[240:241], v66 offset:24576
  ds_read_b64_tr_b16 a[242:243], v66 offset:25600
  ds_read_b64_tr_b16 a[244:245], v66 offset:28672
  ds_read_b64_tr_b16 a[246:247], v66 offset:29696
  ds_read_b64_tr_b16 a[248:249], v66 offset:32768
  ds_read_b64_tr_b16 a[250:251], v66 offset:33792
  ds_read_b64_tr_b16 a[252:253], v66 offset:36864
  ds_read_b64_tr_b16 a[254:255], v66 offset:37888
  ds_read_b64_tr_b16 v[152:153], v66 offset:40960
  ds_read_b64_tr_b16 v[154:155], v66 offset:41984
  ds_read_b64_tr_b16 v[156:157], v66 offset:45056
  ds_read_b64_tr_b16 v[158:159], v66 offset:46080
  s_waitcnt lgkmcnt(0)
  s_waitcnt vmcnt(24)
  s_barrier
  s_add_u32 m0, s51, 24576
  s_add_u32 s46, s62, 3932160
  buffer_load_dwordx4 v64, s[4:7], s46 offen lds
  s_add_u32 m0, s51, 28672
  s_add_u32 s46, s62, 4325376
  buffer_load_dwordx4 v64, s[4:7], s46 offen lds
  s_add_u32 m0, s51, 32768
  s_add_u32 s46, s62, 3932288
  buffer_load_dwordx4 v64, s[4:7], s46 offen lds
  s_add_u32 m0, s51, 36864
  s_add_u32 s46, s62, 4325504
  buffer_load_dwordx4 v64, s[4:7], s46 offen lds
  s_add_u32 m0, s51, 40960
  s_add_u32 s46, s62, 3932416
  buffer_load_dwordx4 v64, s[4:7], s46 offen lds
  s_add_u32 m0, s51, 45056
  s_add_u32 s46, s62, 4325632
  buffer_load_dwordx4 v64, s[4:7], s46 offen lds
  ds_read_b64_tr_b16 v[160:161], v66 offset:49152
  ds_read_b64_tr_b16 v[162:163], v66 offset:50176
  ds_read_b64_tr_b16 v[164:165], v66 offset:53248
  ds_read_b64_tr_b16 v[166:167], v66 offset:54272
  ds_read_b64_tr_b16 v[168:169], v66 offset:57344
  ds_read_b64_tr_b16 v[170:171], v66 offset:58368
  ds_read_b64_tr_b16 v[172:173], v66 offset:61440
  ds_read_b64_tr_b16 v[174:175], v66 offset:62464
  ds_read_b64_tr_b16 v[176:177], v67 offset:0
  ds_read_b64_tr_b16 v[178:179], v67 offset:1024
  ds_read_b64_tr_b16 v[180:181], v67 offset:4096
  ds_read_b64_tr_b16 v[182:183], v67 offset:5120
  s_waitcnt lgkmcnt(0)
  s_waitcnt vmcnt(24)
  s_barrier
  s_add_u32 m0, s51, 49152
  s_add_u32 s46, s62, 6291456
  buffer_load_dwordx4 v64, s[4:7], s46 offen lds
  s_add_u32 m0, s51, 53248
  s_add_u32 s46, s62, 6684672
  buffer_load_dwordx4 v64, s[4:7], s46 offen lds
  s_add_u32 m0, s51, 57344
  s_add_u32 s46, s62, 6291584
  buffer_load_dwordx4 v64, s[4:7], s46 offen lds
  s_add_u32 m0, s51, 61440
  s_add_u32 s46, s62, 6684800
  buffer_load_dwordx4 v64, s[4:7], s46 offen lds
  s_add_u32 m0, s51, 65536
  s_add_u32 s46, s62, 6291712
  buffer_load_dwordx4 v64, s[4:7], s46 offen lds
  s_add_u32 m0, s51, 69632
  s_add_u32 s46, s62, 6684928
  buffer_load_dwordx4 v64, s[4:7], s46 offen lds
  ds_read_b64_tr_b16 v[184:185], v67 offset:8192
  ds_read_b64_tr_b16 v[186:187], v67 offset:9216
  ds_read_b64_tr_b16 v[188:189], v67 offset:12288
  ds_read_b64_tr_b16 v[190:191], v67 offset:13312
  ds_read_b64_tr_b16 v[192:193], v67 offset:16384
  ds_read_b64_tr_b16 v[194:195], v67 offset:17408
  ds_read_b64_tr_b16 v[196:197], v67 offset:20480
  ds_read_b64_tr_b16 v[198:199], v67 offset:21504
  ds_read_b64_tr_b16 v[200:201], v67 offset:24576
  ds_read_b64_tr_b16 v[202:203], v67 offset:25600
  ds_read_b64_tr_b16 v[204:205], v67 offset:28672
  ds_read_b64_tr_b16 v[206:207], v67 offset:29696
  s_waitcnt lgkmcnt(0)
  s_waitcnt vmcnt(24)
  s_barrier
  s_add_u32 m0, s51, 73728
  s_add_u32 s46, s63, 512
  buffer_load_dwordx4 v65, s[12:15], s46 offen lds
  s_add_u32 m0, s51, 77824
  s_add_u32 s46, s63, 41472
  buffer_load_dwordx4 v65, s[12:15], s46 offen lds
  s_add_u32 m0, s51, 81920
  s_add_u32 s46, s63, 82432
  buffer_load_dwordx4 v65, s[12:15], s46 offen lds
  s_add_u32 m0, s51, 86016
  s_add_u32 s46, s63, 123392
  buffer_load_dwordx4 v65, s[12:15], s46 offen lds
  s_add_u32 m0, s51, 90112
  s_add_u32 s46, s63, 164352
  buffer_load_dwordx4 v65, s[12:15], s46 offen lds
  s_add_u32 m0, s51, 94208
  s_add_u32 s46, s63, 205312
  buffer_load_dwordx4 v65, s[12:15], s46 offen lds
  ds_read_b64_tr_b16 v[208:209], v67 offset:32768
  ds_read_b64_tr_b16 v[210:211], v67 offset:33792
  ds_read_b64_tr_b16 v[212:213], v67 offset:36864
  ds_read_b64_tr_b16 v[214:215], v67 offset:37888
  ds_read_b64_tr_b16 v[216:217], v67 offset:40960
  ds_read_b64_tr_b16 v[218:219], v67 offset:41984
  ds_read_b64_tr_b16 v[220:221], v67 offset:45056
  ds_read_b64_tr_b16 v[222:223], v67 offset:46080
  ds_read_b64_tr_b16 v[224:225], v67 offset:49152
  ds_read_b64_tr_b16 v[226:227], v67 offset:50176
  ds_read_b64_tr_b16 v[228:229], v67 offset:53248
  ds_read_b64_tr_b16 v[230:231], v67 offset:54272
  s_waitcnt lgkmcnt(0)
  s_waitcnt vmcnt(24)
  s_barrier
  s_add_u32 m0, s51, 98304
  s_add_u32 s46, s63, 1024
  buffer_load_dwordx4 v65, s[12:15], s46 offen lds
  s_add_u32 m0, s51, 102400
  s_add_u32 s46, s63, 41984
  buffer_load_dwordx4 v65, s[12:15], s46 offen lds
  s_add_u32 m0, s51, 106496
  s_add_u32 s46, s63, 82944
  buffer_load_dwordx4 v65, s[12:15], s46 offen lds
  s_add_u32 m0, s51, 110592
  s_add_u32 s46, s63, 123904
  buffer_load_dwordx4 v65, s[12:15], s46 offen lds
  s_add_u32 m0, s51, 114688
  s_add_u32 s46, s63, 164864
  buffer_load_dwordx4 v65, s[12:15], s46 offen lds
  s_add_u32 m0, s51, 118784
  s_add_u32 s46, s63, 205824
  buffer_load_dwordx4 v65, s[12:15], s46 offen lds
  ds_read_b64_tr_b16 v[232:233], v67 offset:57344
  ds_read_b64_tr_b16 v[234:235], v67 offset:58368
  ds_read_b64_tr_b16 v[236:237], v67 offset:61440
  ds_read_b64_tr_b16 v[238:239], v67 offset:62464
  ds_read_b64_tr_b16 v[240:241], v68 offset:0
  ds_read_b64_tr_b16 v[242:243], v68 offset:1024
  ds_read_b64_tr_b16 v[244:245], v68 offset:4096
  ds_read_b64_tr_b16 v[246:247], v68 offset:5120
  ds_read_b64_tr_b16 v[248:249], v68 offset:8192
  ds_read_b64_tr_b16 v[250:251], v68 offset:9216
  ds_read_b64_tr_b16 v[252:253], v68 offset:12288
  ds_read_b64_tr_b16 v[254:255], v68 offset:13312
  s_waitcnt lgkmcnt(0)
  s_waitcnt vmcnt(24)
  s_barrier
  ds_read_b64_tr_b16 v[40:41], v66 offset:0
  ds_read_b64_tr_b16 v[42:43], v66 offset:1024
  ds_read_b64_tr_b16 v[44:45], v66 offset:4096
  ds_read_b64_tr_b16 v[46:47], v66 offset:5120
  ds_read_b64_tr_b16 v[48:49], v66 offset:8192
  ds_read_b64_tr_b16 v[50:51], v66 offset:9216
  ds_read_b64_tr_b16 v[52:53], v66 offset:12288
  ds_read_b64_tr_b16 v[54:55], v66 offset:13312
  ds_read_b64_tr_b16 v[56:57], v66 offset:16384
  ds_read_b64_tr_b16 v[58:59], v66 offset:17408
  ds_read_b64_tr_b16 v[60:61], v66 offset:20480
  ds_read_b64_tr_b16 v[62:63], v66 offset:21504
  s_waitcnt lgkmcnt(0)
  s_waitcnt vmcnt(18)
  s_barrier
  ds_write_b128 v2, v[40:43] offset:0
  ds_write_b128 v2, v[44:47] offset:4096
  ds_write_b128 v2, v[48:51] offset:8192
  ds_write_b128 v2, v[52:55] offset:12288
  ds_write_b128 v2, v[56:59] offset:16384
  ds_write_b128 v2, v[60:63] offset:20480
  ds_read_b64_tr_b16 v[16:17], v66 offset:24576
  ds_read_b64_tr_b16 v[18:19], v66 offset:25600
  ds_read_b64_tr_b16 v[20:21], v66 offset:28672
  ds_read_b64_tr_b16 v[22:23], v66 offset:29696
  ds_read_b64_tr_b16 v[24:25], v66 offset:32768
  ds_read_b64_tr_b16 v[26:27], v66 offset:33792
  ds_read_b64_tr_b16 v[28:29], v66 offset:36864
  ds_read_b64_tr_b16 v[30:31], v66 offset:37888
  ds_read_b64_tr_b16 v[32:33], v66 offset:40960
  ds_read_b64_tr_b16 v[34:35], v66 offset:41984
  ds_read_b64_tr_b16 v[36:37], v66 offset:45056
  ds_read_b64_tr_b16 v[38:39], v66 offset:46080
  s_waitcnt lgkmcnt(0)
  s_waitcnt vmcnt(12)
  s_barrier
  ds_write_b128 v2, v[16:19] offset:24576
  ds_write_b128 v2, v[20:23] offset:28672
  ds_write_b128 v2, v[24:27] offset:32768
  ds_write_b128 v2, v[28:31] offset:36864
  ds_write_b128 v2, v[32:35] offset:40960
  ds_write_b128 v2, v[36:39] offset:45056
  ds_read_b64_tr_b16 v[40:41], v66 offset:49152
  ds_read_b64_tr_b16 v[42:43], v66 offset:50176
  ds_read_b64_tr_b16 v[44:45], v66 offset:53248
  ds_read_b64_tr_b16 v[46:47], v66 offset:54272
  ds_read_b64_tr_b16 v[48:49], v66 offset:57344
  ds_read_b64_tr_b16 v[50:51], v66 offset:58368
  ds_read_b64_tr_b16 v[52:53], v66 offset:61440
  ds_read_b64_tr_b16 v[54:55], v66 offset:62464
  ds_read_b64_tr_b16 v[56:57], v67 offset:0
  ds_read_b64_tr_b16 v[58:59], v67 offset:1024
  ds_read_b64_tr_b16 v[60:61], v67 offset:4096
  ds_read_b64_tr_b16 v[62:63], v67 offset:5120
  s_waitcnt lgkmcnt(0)
  s_waitcnt vmcnt(6)
  s_barrier
  ds_write_b128 v2, v[40:43] offset:49152
  ds_write_b128 v2, v[44:47] offset:53248
  ds_write_b128 v2, v[48:51] offset:57344
  ds_write_b128 v2, v[52:55] offset:61440
  ds_write_b128 v3, v[56:59] offset:0
  ds_write_b128 v3, v[60:63] offset:4096
  ds_read_b64_tr_b16 v[16:17], v67 offset:8192
  ds_read_b64_tr_b16 v[18:19], v67 offset:9216
  ds_read_b64_tr_b16 v[20:21], v67 offset:12288
  ds_read_b64_tr_b16 v[22:23], v67 offset:13312
  ds_read_b64_tr_b16 v[24:25], v67 offset:16384
  ds_read_b64_tr_b16 v[26:27], v67 offset:17408
  ds_read_b64_tr_b16 v[28:29], v67 offset:20480
  ds_read_b64_tr_b16 v[30:31], v67 offset:21504
  ds_read_b64_tr_b16 v[32:33], v67 offset:24576
  ds_read_b64_tr_b16 v[34:35], v67 offset:25600
  ds_read_b64_tr_b16 v[36:37], v67 offset:28672
  ds_read_b64_tr_b16 v[38:39], v67 offset:29696
  s_waitcnt lgkmcnt(0)
  s_waitcnt vmcnt(0)
  s_barrier
  ds_write_b128 v3, v[16:19] offset:8192
  ds_write_b128 v3, v[20:23] offset:12288
  ds_write_b128 v3, v[24:27] offset:16384
  ds_write_b128 v3, v[28:31] offset:20480
  ds_write_b128 v3, v[32:35] offset:24576
  ds_write_b128 v3, v[36:39] offset:28672
  ds_read_b64_tr_b16 v[40:41], v67 offset:32768
  ds_read_b64_tr_b16 v[42:43], v67 offset:33792
  ds_read_b64_tr_b16 v[44:45], v67 offset:36864
  ds_read_b64_tr_b16 v[46:47], v67 offset:37888
  ds_read_b64_tr_b16 v[48:49], v67 offset:40960
  ds_read_b64_tr_b16 v[50:51], v67 offset:41984
  ds_read_b64_tr_b16 v[52:53], v67 offset:45056
  ds_read_b64_tr_b16 v[54:55], v67 offset:46080
  ds_read_b64_tr_b16 v[56:57], v67 offset:49152
  ds_read_b64_tr_b16 v[58:59], v67 offset:50176
  ds_read_b64_tr_b16 v[60:61], v67 offset:53248
  ds_read_b64_tr_b16 v[62:63], v67 offset:54272
  s_waitcnt lgkmcnt(0)
  s_barrier
  ds_write_b128 v3, v[40:43] offset:32768
  ds_write_b128 v3, v[44:47] offset:36864
  ds_write_b128 v3, v[48:51] offset:40960
  ds_write_b128 v3, v[52:55] offset:45056
  ds_write_b128 v3, v[56:59] offset:49152
  ds_write_b128 v3, v[60:63] offset:53248
  s_waitcnt lgkmcnt(0)
  s_add_u32 s46, s42, 1
  s_lshl_b32 s31, s46, 10
  s_cmp_ge_u32 s46, 8
  s_cselect_b32 s47, 40960, 0
  s_add_u32 s31, s31, s47
  s_cmp_ge_u32 s46, 10
  s_cselect_b32 s31, 2146435072, s31
  s_add_u32 s46, s42, 5
  s_lshl_b32 s32, s46, 10
  s_cmp_ge_u32 s46, 8
  s_cselect_b32 s47, 40960, 0
  s_add_u32 s32, s32, s47
  s_cmp_ge_u32 s46, 10
  s_cselect_b32 s32, 2146435072, s32
  s_add_u32 s46, s42, 9
  s_lshl_b32 s33, s46, 10
  s_cmp_ge_u32 s46, 8
  s_cselect_b32 s47, 40960, 0
  s_add_u32 s33, s33, s47
  s_cmp_ge_u32 s46, 10
  s_cselect_b32 s33, 2146435072, s33
  v_add_u32 v9, 126976, v1
  v_and_b32 v149, 3, v0
  v_lshlrev_b32 v149, 2, v149
  s_mov_b32 s50, 0
ss_23:
  global_load_dword v148, v149, s[38:39] sc1
  s_add_u32 s50, s50, 1
  s_cmp_gt_u32 s50, 131072
  s_cbranch_scc1 L_fail
  s_waitcnt vmcnt(0)
  v_readlane_b32 s46, v148, 0
  v_readlane_b32 s47, v148, 2
  s_cmp_lg_u32 s46, 0
  s_cselect_b32 s48, 7, 0
  s_add_u32 s46, s46, s2
  s_xor_b32 s49, s46, s43
  s_and_b32 s49, s49, s48
  s_cbranch_scc1 L_reroll
  s_cmp_lg_u32 s47, 0
  s_cbranch_scc1 ss_ok_24
  s_sleep 10
  s_branch ss_23
ss_ok_24:
  v_readlane_b32 s3, v148, 1
  s_nop 0
  s_and_b32 s3, s3, 0x2000
  v_and_b32 v148, 3, v0
  s_lshl_b32 s46, s43, 9
  s_add_u32 s46, s46, s3
  s_add_u32 s46, s46, 13369344
  v_lshl_add_u32 v10, v148, 7, s46
  v_mov_b32 v7, 0x44444444
  v_mov_b32 v148, 0xeeeeeeee
  v_and_b32 v149, 2, v0
  v_cmp_ne_u32 vcc, 0, v149
  s_nop 1
  v_cndmask_b32 v7, v7, v148, vcc
  v_and_b32 v148, 15, v0
  v_lshrrev_b32 v149, 4, v0
  v_lshlrev_b32 v8, 4, v148
  v_lshrrev_b32 v150, 1, v149
  v_lshl_add_u32 v8, v150, 3, v8
  v_and_b32 v151, 1, v149
  v_lshrrev_b32 v150, 2, v148
  v_lshlrev_b32 v4, 6, v150
  v_and_b32 v150, 1, v148
  v_lshl_add_u32 v4, v150, 5, v4
  v_lshl_add_u32 v4, v149, 3, v4
  v_bfe_u32 v150, v148, 1, 1
  v_lshl_add_u32 v4, v150, 2, v4
  s_and_b32 s46, s42, 1
  s_lshl_b32 s46, s46, 7
  v_xor_b32 v4, s46, v4
  s_lshl_b32 s46, s42, 8
  s_add_u32 s46, s46, 122880
  v_add_u32 v4, s46, v4
  s_lshl_b32 s46, s45, 8
  s_lshl_b32 s47, s42, 14
  s_add_u32 s47, s47, s46
  v_lshl_add_u32 v8, v151, 16, v8
  v_add_u32 v8, s47, v8
  v_lshlrev_b32 v5, 8, v149
  v_and_b32 v150, 1, v149
  v_lshl_add_u32 v5, v150, 7, v5
  v_lshl_add_u32 v5, v148, 3, v5
  v_xor_b32 v6, 0x80, v5
  v_add_u32 v5, 122880, v5
  v_add_u32 v6, 122880, v6
  s_lshl_b32 s46, s45, 7
  s_lshl_b32 s47, s42, 2
  s_add_u32 s47, s47, s46
  s_add_u32 s47, s47, 1064960
  v_mov_b32 v15, s47
  s_mov_b32 s52, 0
  s_mov_b32 s58, 0
  s_mov_b32 s54, 0
  s_mov_b32 s100, 0
va_loop:
  s_add_u32 s53, s52, 1
  s_lshl_b32 s56, s58, 2
  s_add_u32 s56, s56, s43
  s_lshl_b32 s56, s56, 16
  s_add_u32 s56, s56, s3
  s_add_u32 s56, s56, 12582912
  s_lshl_b32 s66, s54, 21
  s_mul_i32 s46, s58, 655360
  s_add_u32 s66, s66, s46
  s_add_u32 s66, s66, s3
  s_add_u32 s66, s66, 4194304
  s_lshr_b32 s46, s66, 8
  s_and_b32 s46, s46, 0x2000
  s_xor_b32 s66, s66, s46
  v_add_u32 v11, s56, v1
  s_mov_b64 s[16:17], -1
  s_mov_b32 s71, 0
  ds_read_b128 v[56:59], v2 offset:0
  ds_read_b128 v[60:63], v2 offset:4096
  ds_read_b128 v[64:67], v2 offset:8192
  ds_read_b128 v[68:71], v2 offset:12288
  ds_read_b128 v[72:75], v2 offset:16384
  ds_read_b128 v[76:79], v2 offset:20480
  ds_read_b128 v[80:83], v2 offset:24576
  ds_read_b128 v[84:87], v2 offset:28672
  ds_read_b128 v[88:91], v2 offset:32768
  ds_read_b128 v[92:95], v2 offset:36864
  ds_read_b128 v[96:99], v2 offset:40960
  ds_read_b128 v[100:103], v2 offset:45056
  v_mov_b32 v104, 0
  v_mov_b32 v105, 0
  v_mov_b32 v106, 0
  v_mov_b32 v107, 0
  v_mov_b32 v108, 0
  v_mov_b32 v109, 0
  v_mov_b32 v110, 0
  v_mov_b32 v111, 0
  v_mov_b32 v112, 0
  v_mov_b32 v113, 0
  v_mov_b32 v114, 0
  v_mov_b32 v115, 0
  v_mov_b32 v128, 0
  v_mov_b32 v129, 0
  v_mov_b32 v130, 0
  v_mov_b32 v131, 0
  v_mov_b32 v132, 0
  v_mov_b32 v133, 0
  v_mov_b32 v134, 0
  v_mov_b32 v135, 0
  v_mov_b32 v136, 0
  v_mov_b32 v137, 0
  v_mov_b32 v138, 0
  v_mov_b32 v139, 0
  v_mov_b32 v140, 0
  v_mov_b32 v141, 0
  v_mov_b32 v142, 0
  v_mov_b32 v143, 0
  v_mov_b32 v144, 0
  v_mov_b32 v145, 0
  v_mov_b32 v146, 0
  v_mov_b32 v147, 0
  s_cmp_lg_u32 s42, 3
  s_cbranch_scc1 va_nobell
  s_mov_b32 s50, 0
  s_mov_b64 exec, 15
  buffer_load_dword v116, v10, s[8:11], 0 offen sc1
  s_nop 11
  buffer_load_dword v117, v10, s[8:11], 0 offen sc1
  s_nop 11
  buffer_load_dword v118, v10, s[8:11], 0 offen sc1
  s_nop 11
  buffer_load_dword v119, v10, s[8:11], 0 offen sc1
  s_nop 11
  buffer_load_dword v120, v10, s[8:11], 0 offen sc1
  s_nop 11
  buffer_load_dword v121, v10, s[8:11], 0 offen sc1
  s_nop 11
  buffer_load_dword v122, v10, s[8:11], 0 offen sc1
  s_nop 11
  buffer_load_dword v123, v10, s[8:11], 0 offen sc1
  s_nop 11
  buffer_load_dword v124, v10, s[8:11], 0 offen sc1
  s_nop 11
bell_25:
  buffer_load_dword v125, v10, s[8:11], 0 offen sc1
  s_waitcnt vmcnt(9)
  v_cmp_gt_u32 vcc, s53, v116
  s_cbranch_vccz bell_x_26
  s_nop 7
  buffer_load_dword v116, v10, s[8:11], 0 offen sc1
  s_waitcnt vmcnt(9)
  v_cmp_gt_u32 vcc, s53, v117
  s_cbranch_vccz bell_x_26
  s_nop 7
  buffer_load_dword v117, v10, s[8:11], 0 offen sc1
  s_waitcnt vmcnt(9)
  v_cmp_gt_u32 vcc, s53, v118
  s_cbranch_vccz bell_x_26
  s_nop 7
  buffer_load_dword v118, v10, s[8:11], 0 offen sc1
  s_waitcnt vmcnt(9)
  v_cmp_gt_u32 vcc, s53, v119
  s_cbranch_vccz bell_x_26
  s_nop 7
  buffer_load_dword v119, v10, s[8:11], 0 offen sc1
  s_waitcnt vmcnt(9)
  v_cmp_gt_u32 vcc, s53, v120
  s_cbranch_vccz bell_x_26
  s_nop 7
  buffer_load_dword v120, v10, s[8:11], 0 offen sc1
  s_waitcnt vmcnt(9)
  v_cmp_gt_u32 vcc, s53, v121
  s_cbranch_vccz bell_x_26
  s_nop 7
  buffer_load_dword v121, v10, s[8:11], 0 offen sc1
  s_waitcnt vmcnt(9)
  v_cmp_gt_u32 vcc, s53, v122
  s_cbranch_vccz bell_x_26
  s_nop 7
  buffer_load_dword v122, v10, s[8:11], 0 offen sc1
  s_waitcnt vmcnt(9)
  v_cmp_gt_u32 vcc, s53, v123
  s_cbranch_vccz bell_x_26
  s_nop 7
  buffer_load_dword v123, v10, s[8:11], 0 offen sc1
  s_waitcnt vmcnt(9)
  v_cmp_gt_u32 vcc, s53, v124
  s_cbranch_vccz bell_x_26
  s_nop 7
  buffer_load_dword v124, v10, s[8:11], 0 offen sc1
  s_waitcnt vmcnt(9)
  v_cmp_gt_u32 vcc, s53, v125
  s_cbranch_vccz bell_x_26
  s_add_u32 s50, s50, 1
  s_cmp_gt_u32 s50, 131072
  s_cbranch_scc1 L_fail
  s_branch bell_25
bell_x_26:
  s_mov_b64 exec, -1
va_nobell:
  s_mov_b32 s50, 0
va_top:
  s_add_u32 m0, s51, 126976
  s_waitcnt lgkmcnt(0)
  s_barrier
  buffer_load_dwordx4 v11, s[8:11], s31 offen sc1 lds
  s_add_u32 m0, s51, 131072
  s_barrier
  buffer_load_dwordx4 v[16:19], v11, s[8:11], 0 offen offset:0 sc1
  s_barrier
  buffer_load_dwordx4 v11, s[8:11], s32 offen sc1 lds
  s_add_u32 m0, s51, 135168
  s_nop 0
  buffer_load_dwordx4 v11, s[8:11], s33 offen sc1 lds
  s_waitcnt vmcnt(3)
  s_barrier
  ds_read_b128 v[20:23], v9 offset:0
  ds_read_b128 v[24:27], v9 offset:1024
  ds_read_b128 v[28:31], v9 offset:2048
  ds_read_b128 v[32:35], v9 offset:3072
  s_waitcnt vmcnt(2)
va_go:
  v_smfmac_f32_16x16x64_bf16 v[104:107], v[16:19], a[0:7], v7
  v_cmp_eq_u32 vcc, -1, v16
  v_smfmac_f32_16x16x64_bf16 v[108:111], v[16:19], a[8:15], v7
  v_smfmac_f32_16x16x64_bf16 v[112:115], v[16:19], a[16:23], v7
  s_cbranch_vccnz va_ha
  s_waitcnt lgkmcnt(3)
  v_smfmac_f32_16x16x64_bf16 v[104:107], v[20:23], a[24:31], v7
  v_smfmac_f32_16x16x64_bf16 v[108:111], v[20:23], a[32:39], v7
  s_waitcnt vmcnt(0)
  s_barrier
  ds_read_b128 v[36:39], v9 offset:4096
  v_smfmac_f32_16x16x64_bf16 v[112:115], v[20:23], a[40:47], v7
  ds_read_b128 v[40:43], v9 offset:5120
  s_waitcnt lgkmcnt(2)
  v_smfmac_f32_16x16x64_bf16 v[104:107], v[24:27], v[56:63], v7
  ds_read_b128 v[44:47], v9 offset:6144
  v_smfmac_f32_16x16x64_bf16 v[108:111], v[24:27], v[64:71], v7
  ds_read_b128 v[48:51], v9 offset:7168
  v_smfmac_f32_16x16x64_bf16 v[112:115], v[24:27], v[72:79], v7
  ds_read_b128 v[52:55], v9 offset:8192
  v_smfmac_f32_16x16x64_bf16 v[104:107], v[28:31], a[48:55], v7
  ds_read_b128 v[56:59], v2 offset:49152
  v_smfmac_f32_16x16x64_bf16 v[108:111], v[28:31], a[56:63], v7
  ds_read_b128 v[60:63], v2 offset:53248
  v_max3_u32 v12, v20, v24, v28
  v_smfmac_f32_16x16x64_bf16 v[112:115], v[28:31], a[64:71], v7
  s_waitcnt lgkmcnt(4)
  v_max3_u32 v12, v12, v32, v36
  v_smfmac_f32_16x16x64_bf16 v[104:107], v[32:35], a[72:79], v7
  ds_read_b128 v[64:67], v2 offset:57344
  v_max3_u32 v12, v12, v40, v44
  v_smfmac_f32_16x16x64_bf16 v[108:111], v[32:35], a[80:87], v7
  s_waitcnt lgkmcnt(3)
  v_max3_u32 v12, v12, v48, v52
  v_smfmac_f32_16x16x64_bf16 v[112:115], v[32:35], a[88:95], v7
  ds_read_b128 v[68:71], v2 offset:61440
  v_cmp_eq_u32 vcc, -1, v12
  v_smfmac_f32_16x16x64_bf16 v[104:107], v[36:39], v[80:87], v7
  ds_read_b128 v[72:75], v3 offset:0
  v_mov_b32 v16, 0
  v_smfmac_f32_16x16x64_bf16 v[108:111], v[36:39], v[88:95], v7
  s_cbranch_vccnz va_hb
  v_smfmac_f32_16x16x64_bf16 v[112:115], v[36:39], v[96:103], v7
  ds_read_b128 v[76:79], v3 offset:4096
  v_mov_b32 v17, 0
  v_smfmac_f32_16x16x64_bf16 v[104:107], v[40:43], a[96:103], v7
  ds_read_b128 v[80:83], v3 offset:8192
  v_mov_b32 v18, 0
  v_smfmac_f32_16x16x64_bf16 v[108:111], v[40:43], a[104:111], v7
  ds_read_b128 v[84:87], v3 offset:12288
  v_mov_b32 v19, 0
  v_smfmac_f32_16x16x64_bf16 v[112:115], v[40:43], a[112:119], v7
  ds_read_b128 v[88:91], v3 offset:16384
  v_mov_b32 v20, 0
  v_smfmac_f32_16x16x64_bf16 v[104:107], v[44:47], a[120:127], v7
  ds_read_b128 v[92:95], v3 offset:20480
  v_mov_b32 v21, 0
  v_smfmac_f32_16x16x64_bf16 v[108:111], v[44:47], a[128:135], v7
  ds_read_b128 v[96:99], v3 offset:24576
  v_mov_b32 v22, 0
  v_smfmac_f32_16x16x64_bf16 v[112:115], v[44:47], a[136:143], v7
  ds_read_b128 v[100:103], v3 offset:28672
  s_waitcnt lgkmcnt(5)
  v_mov_b32 v23, 0
  v_smfmac_f32_16x16x64_bf16 v[104:107], v[48:51], v[56:63], v7
  v_mov_b32 v24, 0
  v_smfmac_f32_16x16x64_bf16 v[108:111], v[48:51], v[64:71], v7
  v_mov_b32 v25, 0
  v_smfmac_f32_16x16x64_bf16 v[112:115], v[48:51], v[72:79], v7
  v_mov_b32 v26, 0
  v_smfmac_f32_16x16x64_bf16 v[104:107], v[52:55], a[144:151], v7
  v_mov_b32 v27, 0
  v_smfmac_f32_16x16x64_bf16 v[108:111], v[52:55], a[152:159], v7
  v_mov_b32 v28, 0
  v_smfmac_f32_16x16x64_bf16 v[112:115], v[52:55], a[160:167], v7
  v_mov_b32 v29, 0
va_join:
  v_add_f32 v104, v104, v106
  v_add_f32 v105, v105, v107
  v_cmp_u_f32 vcc, v104, v105
  v_cvt_pk_bf16_f32 v106, v104, v105
  s_nop 0
  v_add_f32 v108, v108, v110
  v_add_f32 v109, v109, v111
  v_cvt_pk_bf16_f32 v110, v108, v109
  v_add_f32 v112, v112, v114
  v_add_f32 v113, v113, v115
  v_cvt_pk_bf16_f32 v114, v112, v113
  s_and_b64 vcc, vcc, s[16:17]
  s_cbranch_scc1 va_redo
  ds_write_b32 v4, v106 offset:0
  ds_write_b32 v4, v110 offset:1024
  ds_write_b32 v4, v114 offset:2048
  v_mov_b32 v30, 0
  v_mov_b32 v31, 0
  s_waitcnt lgkmcnt(0)
  s_barrier
  ds_read_b64_tr_b16 v[116:117], v5 offset:0
  ds_read_b64_tr_b16 v[118:119], v6 offset:0
  ds_read_b64_tr_b16 v[120:121], v5 offset:1024
  ds_read_b64_tr_b16 v[122:123], v6 offset:1024
  ds_read_b64_tr_b16 v[124:125], v5 offset:2048
  ds_read_b64_tr_b16 v[126:127], v6 offset:2048
  s_waitcnt lgkmcnt(4)
  v_smfmac_f32_16x16x64_bf16 v[128:131], v[116:119], a[168:175], v7
  s_waitcnt lgkmcnt(2)
  v_mov_b32 v32, 0
  v_smfmac_f32_16x16x64_bf16 v[128:131], v[120:123], a[176:183], v7
  s_waitcnt lgkmcnt(0)
  v_mov_b32 v33, 0
  v_smfmac_f32_16x16x64_bf16 v[128:131], v[124:127], a[184:191], v7
  ds_read_b128 v[56:59], v3 offset:32768
  v_mov_b32 v34, 0
  v_smfmac_f32_16x16x64_bf16 v[132:135], v[116:119], a[192:199], v7
  ds_read_b128 v[60:63], v3 offset:36864
  v_mov_b32 v35, 0
  v_smfmac_f32_16x16x64_bf16 v[132:135], v[120:123], a[200:207], v7
  ds_read_b128 v[64:67], v3 offset:40960
  v_add_f32 v128, v128, v130
  v_smfmac_f32_16x16x64_bf16 v[132:135], v[124:127], a[208:215], v7
  ds_read_b128 v[68:71], v3 offset:45056
  v_add_f32 v129, v129, v131
  v_smfmac_f32_16x16x64_bf16 v[136:139], v[116:119], a[216:223], v7
  ds_read_b128 v[72:75], v3 offset:49152
  v_cvt_pk_bf16_f32 v130, v128, v129
  v_smfmac_f32_16x16x64_bf16 v[136:139], v[120:123], a[224:231], v7
  ds_read_b128 v[76:79], v3 offset:53248
  v_add_f32 v132, v132, v134
  v_smfmac_f32_16x16x64_bf16 v[136:139], v[124:127], a[232:239], v7
  s_add_u32 s46, s66, 0
  v_add_f32 v133, v133, v135
  v_smfmac_f32_16x16x64_bf16 v[140:143], v[116:119], a[240:247], v7
  v_cvt_pk_bf16_f32 v131, v132, v133
  v_smfmac_f32_16x16x64_bf16 v[140:143], v[120:123], a[248:255], v7
  v_add_f32 v136, v136, v138
  v_smfmac_f32_16x16x64_bf16 v[140:143], v[124:127], v[152:159], v7
  v_permlane16_swap_b32 v130, v131
  v_add_f32 v137, v137, v139
  v_smfmac_f32_16x16x64_bf16 v[144:147], v[116:119], v[80:87], v7
  buffer_store_dwordx2 v[130:131], v8, s[8:11], s46 offen sc1
  v_cvt_pk_bf16_f32 v138, v136, v137
  v_smfmac_f32_16x16x64_bf16 v[144:147], v[120:123], v[88:95], v7
  v_add_f32 v140, v140, v142
  v_smfmac_f32_16x16x64_bf16 v[144:147], v[124:127], v[96:103], v7
  s_add_u32 s46, s66, 131072
  v_add_f32 v141, v141, v143
  v_smfmac_f32_16x16x64_bf16 v[16:19], v[116:119], v[160:167], v7
  v_cvt_pk_bf16_f32 v139, v140, v141
  v_smfmac_f32_16x16x64_bf16 v[16:19], v[120:123], v[168:175], v7
  v_add_f32 v144, v144, v146
  v_smfmac_f32_16x16x64_bf16 v[16:19], v[124:127], v[176:183], v7
  v_permlane16_swap_b32 v138, v139
  v_add_f32 v145, v145, v147
  v_smfmac_f32_16x16x64_bf16 v[20:23], v[116:119], v[184:191], v7
  buffer_store_dwordx2 v[138:139], v8, s[8:11], s46 offen sc1
  v_cvt_pk_bf16_f32 v146, v144, v145
  v_smfmac_f32_16x16x64_bf16 v[20:23], v[120:123], v[192:199], v7
  v_add_f32 v16, v16, v18
  v_smfmac_f32_16x16x64_bf16 v[20:23], v[124:127], v[200:207], v7
  s_add_u32 s46, s66, 262144
  v_add_f32 v17, v17, v19
  v_smfmac_f32_16x16x64_bf16 v[24:27], v[116:119], v[208:215], v7
  v_cvt_pk_bf16_f32 v147, v16, v17
  v_smfmac_f32_16x16x64_bf16 v[24:27], v[120:123], v[216:223], v7
  v_add_f32 v20, v20, v22
  v_smfmac_f32_16x16x64_bf16 v[24:27], v[124:127], v[224:231], v7
  s_waitcnt lgkmcnt(0)
  v_permlane16_swap_b32 v146, v147
  v_add_f32 v21, v21, v23
  v_smfmac_f32_16x16x64_bf16 v[28:31], v[116:119], v[56:63], v7
  buffer_store_dwordx2 v[146:147], v8, s[8:11], s46 offen sc1
  v_cvt_pk_bf16_f32 v22, v20, v21
  v_smfmac_f32_16x16x64_bf16 v[28:31], v[120:123], v[64:71], v7
  v_add_f32 v24, v24, v26
  v_smfmac_f32_16x16x64_bf16 v[28:31], v[124:127], v[72:79], v7
  s_add_u32 s46, s66, 393216
  v_add_f32 v25, v25, v27
  v_smfmac_f32_16x16x64_bf16 v[32:35], v[116:119], v[232:239], v7
  v_cvt_pk_bf16_f32 v23, v24, v25
  v_smfmac_f32_16x16x64_bf16 v[32:35], v[120:123], v[240:247], v7
  v_add_f32 v28, v28, v30
  v_smfmac_f32_16x16x64_bf16 v[32:35], v[124:127], v[248:255], v7
  v_permlane16_swap_b32 v22, v23
  buffer_store_dwordx2 v[22:23], v8, s[8:11], s46 offen sc1
  v_add_f32 v29, v29, v31
  v_cvt_pk_bf16_f32 v30, v28, v29
  s_nop 3
  v_add_f32 v32, v32, v34
  v_add_f32 v33, v33, v35
  s_add_u32 s46, s66, 524288
  v_cvt_pk_bf16_f32 v31, v32, v33
  s_nop 1
  v_permlane16_swap_b32 v30, v31
  buffer_store_dwordx2 v[30:31], v8, s[8:11], s46 offen sc1
  s_add_u32 s58, s58, 1
  s_cmp_eq_u32 s58, 3
  s_cselect_b32 s58, 0, s58
  s_cmp_eq_u32 s58, 0
  s_addc_u32 s54, s54, 0
  s_cmp_eq_u32 s54, 3
  s_cselect_b32 s54, 0, s54
  s_mov_b32 s52, s53
  s_cmp_lt_u32 s52, 64
  s_cbranch_scc1 va_loop
  s_waitcnt vmcnt(0)
  v_mov_b32 v148, s52
  s_mov_b64 exec, 1
  buffer_store_dword v148, v15, s[8:11], 0 offen sc1
  s_mov_b64 exec, -1
  s_endpgm
va_ha:
  s_waitcnt lgkmcnt(0)
  ds_read_b128 v[56:59], v2 offset:0
  ds_read_b128 v[60:63], v2 offset:4096
  ds_read_b128 v[64:67], v2 offset:8192
  ds_read_b128 v[68:71], v2 offset:12288
  ds_read_b128 v[72:75], v2 offset:16384
  ds_read_b128 v[76:79], v2 offset:20480
  ds_read_b128 v[80:83], v2 offset:24576
  ds_read_b128 v[84:87], v2 offset:28672
  ds_read_b128 v[88:91], v2 offset:32768
  ds_read_b128 v[92:95], v2 offset:36864
  ds_read_b128 v[96:99], v2 offset:40960
  ds_read_b128 v[100:103], v2 offset:45056
  v_mov_b32 v104, 0
  v_mov_b32 v105, 0
  v_mov_b32 v106, 0
  v_mov_b32 v107, 0
  v_mov_b32 v108, 0
  v_mov_b32 v109, 0
  v_mov_b32 v110, 0
  v_mov_b32 v111, 0
  v_mov_b32 v112, 0
  v_mov_b32 v113, 0
  v_mov_b32 v114, 0
  v_mov_b32 v115, 0
  v_mov_b32 v128, 0
  v_mov_b32 v129, 0
  v_mov_b32 v130, 0
  v_mov_b32 v131, 0
  v_mov_b32 v132, 0
  v_mov_b32 v133, 0
  v_mov_b32 v134, 0
  v_mov_b32 v135, 0
  v_mov_b32 v136, 0
  v_mov_b32 v137, 0
  v_mov_b32 v138, 0
  v_mov_b32 v139, 0
  v_mov_b32 v140, 0
  v_mov_b32 v141, 0
  v_mov_b32 v142, 0
  v_mov_b32 v143, 0
  v_mov_b32 v144, 0
  v_mov_b32 v145, 0
  v_mov_b32 v146, 0
  v_mov_b32 v147, 0
va_ra:
  buffer_load_dwordx4 v[16:19], v11, s[8:11], 0 offen offset:0 sc1
  s_add_u32 s50, s50, 1
  s_cmp_gt_u32 s50, 131072
  s_cbranch_scc1 L_fail
  s_waitcnt vmcnt(0) lgkmcnt(0)
  v_cmp_eq_u32 vcc, -1, v16
  s_cbranch_vccnz va_ra
  s_branch va_go
va_hb:
  s_waitcnt lgkmcnt(0)
  s_add_u32 s50, s50, 1
  s_cmp_gt_u32 s50, 131072
  s_cbranch_scc1 L_fail
  ds_read_b128 v[56:59], v2 offset:0
  ds_read_b128 v[60:63], v2 offset:4096
  ds_read_b128 v[64:67], v2 offset:8192
  ds_read_b128 v[68:71], v2 offset:12288
  ds_read_b128 v[72:75], v2 offset:16384
  ds_read_b128 v[76:79], v2 offset:20480
  ds_read_b128 v[80:83], v2 offset:24576
  ds_read_b128 v[84:87], v2 offset:28672
  ds_read_b128 v[88:91], v2 offset:32768
  ds_read_b128 v[92:95], v2 offset:36864
  ds_read_b128 v[96:99], v2 offset:40960
  ds_read_b128 v[100:103], v2 offset:45056
  v_mov_b32 v104, 0
  v_mov_b32 v105, 0
  v_mov_b32 v106, 0
  v_mov_b32 v107, 0
  v_mov_b32 v108, 0
  v_mov_b32 v109, 0
  v_mov_b32 v110, 0
  v_mov_b32 v111, 0
  v_mov_b32 v112, 0
  v_mov_b32 v113, 0
  v_mov_b32 v114, 0
  v_mov_b32 v115, 0
  v_mov_b32 v128, 0
  v_mov_b32 v129, 0
  v_mov_b32 v130, 0
  v_mov_b32 v131, 0
  v_mov_b32 v132, 0
  v_mov_b32 v133, 0
  v_mov_b32 v134, 0
  v_mov_b32 v135, 0
  v_mov_b32 v136, 0
  v_mov_b32 v137, 0
  v_mov_b32 v138, 0
  v_mov_b32 v139, 0
  v_mov_b32 v140, 0
  v_mov_b32 v141, 0
  v_mov_b32 v142, 0
  v_mov_b32 v143, 0
  v_mov_b32 v144, 0
  v_mov_b32 v145, 0
  v_mov_b32 v146, 0
  v_mov_b32 v147, 0
  s_branch va_top
va_redo:
  s_waitcnt lgkmcnt(0)
  s_mov_b32 s50, 0
va_poll:
  buffer_load_dwordx4 v[16:19], v11, s[8:11], 0 offen offset:0 sc1
  buffer_load_dwordx4 v[20:23], v11, s[8:11], 0 offen offset:1024 sc1
  buffer_load_dwordx4 v[24:27], v11, s[8:11], 0 offen offset:2048 sc1
  buffer_load_dwordx4 v[28:31], v11, s[8:11], 0 offen offset:3072 sc1
  buffer_load_dwordx4 v[32:35], v11, s[8:11], s24 offen offset:0 sc1
  buffer_load_dwordx4 v[36:39], v11, s[8:11], s24 offen offset:1024 sc1
  buffer_load_dwordx4 v[40:43], v11, s[8:11], s24 offen offset:2048 sc1
  buffer_load_dwordx4 v[44:47], v11, s[8:11], s24 offen offset:3072 sc1
  buffer_load_dwordx4 v[48:51], v11, s[8:11], s25 offen offset:0 sc1
  buffer_load_dwordx4 v[52:55], v11, s[8:11], s25 offen offset:1024 sc1
  s_add_u32 s50, s50, 1
  s_cmp_gt_u32 s50, 131072
  s_cbranch_scc1 L_fail
  s_waitcnt vmcnt(0) lgkmcnt(0)
  v_max_u32 v12, v16, v17
  v_max3_u32 v12, v18, v19, v12
  v_max3_u32 v12, v20, v21, v12
  v_max3_u32 v12, v22, v23, v12
  v_max3_u32 v12, v24, v25, v12
  v_max3_u32 v12, v26, v27, v12
  v_max3_u32 v12, v28, v29, v12
  v_max3_u32 v12, v30, v31, v12
  v_max3_u32 v12, v32, v33, v12
  v_max3_u32 v12, v34, v35, v12
  v_max3_u32 v12, v36, v37, v12
  v_max3_u32 v12, v38, v39, v12
  v_max3_u32 v12, v40, v41, v12
  v_max3_u32 v12, v42, v43, v12
  v_max3_u32 v12, v44, v45, v12
  v_max3_u32 v12, v46, v47, v12
  v_max3_u32 v12, v48, v49, v12
  v_max3_u32 v12, v50, v51, v12
  v_max3_u32 v12, v52, v53, v12
  v_max3_u32 v12, v54, v55, v12
  v_cmp_eq_u32 vcc, -1, v12
  s_cbranch_vccnz va_poll
  s_mov_b64 s[16:17], 0
  ds_read_b128 v[56:59], v2 offset:0
  ds_read_b128 v[60:63], v2 offset:4096
  ds_read_b128 v[64:67], v2 offset:8192
  ds_read_b128 v[68:71], v2 offset:12288
  ds_read_b128 v[72:75], v2 offset:16384
  ds_read_b128 v[76:79], v2 offset:20480
  ds_read_b128 v[80:83], v2 offset:24576
  ds_read_b128 v[84:87], v2 offset:28672
  ds_read_b128 v[88:91], v2 offset:32768
  ds_read_b128 v[92:95], v2 offset:36864
  ds_read_b128 v[96:99], v2 offset:40960
  ds_read_b128 v[100:103], v2 offset:45056
  v_mov_b32 v104, 0
  v_mov_b32 v105, 0
  v_mov_b32 v106, 0
  v_mov_b32 v107, 0
  v_mov_b32 v108, 0
  v_mov_b32 v109, 0
  v_mov_b32 v110, 0
  v_mov_b32 v111, 0
  v_mov_b32 v112, 0
  v_mov_b32 v113, 0
  v_mov_b32 v114, 0
  v_mov_b32 v115, 0
  v_mov_b32 v128, 0
  v_mov_b32 v129, 0
  v_mov_b32 v130, 0
  v_mov_b32 v131, 0
  v_mov_b32 v132, 0
  v_mov_b32 v133, 0
  v_mov_b32 v134, 0
  v_mov_b32 v135, 0
  v_mov_b32 v136, 0
  v_mov_b32 v137, 0
  v_mov_b32 v138, 0
  v_mov_b32 v139, 0
  v_mov_b32 v140, 0
  v_mov_b32 v141, 0
  v_mov_b32 v142, 0
  v_mov_b32 v143, 0
  v_mov_b32 v144, 0
  v_mov_b32 v145, 0
  v_mov_b32 v146, 0
  v_mov_b32 v147, 0
  s_waitcnt lgkmcnt(0)
  v_smfmac_f32_16x16x64_bf16 v[104:107], v[16:19], a[0:7], v7
  v_smfmac_f32_16x16x64_bf16 v[108:111], v[16:19], a[8:15], v7
  v_smfmac_f32_16x16x64_bf16 v[112:115], v[16:19], a[16:23], v7
  v_smfmac_f32_16x16x64_bf16 v[104:107], v[20:23], a[24:31], v7
  v_smfmac_f32_16x16x64_bf16 v[108:111], v[20:23], a[32:39], v7
  v_smfmac_f32_16x16x64_bf16 v[112:115], v[20:23], a[40:47], v7
  v_smfmac_f32_16x16x64_bf16 v[104:107], v[24:27], v[56:63], v7
  v_smfmac_f32_16x16x64_bf16 v[108:111], v[24:27], v[64:71], v7
  v_smfmac_f32_16x16x64_bf16 v[112:115], v[24:27], v[72:79], v7
  v_smfmac_f32_16x16x64_bf16 v[104:107], v[28:31], a[48:55], v7
  ds_read_b128 v[56:59], v2 offset:49152
  v_smfmac_f32_16x16x64_bf16 v[108:111], v[28:31], a[56:63], v7
  ds_read_b128 v[60:63], v2 offset:53248
  v_smfmac_f32_16x16x64_bf16 v[112:115], v[28:31], a[64:71], v7
  v_smfmac_f32_16x16x64_bf16 v[104:107], v[32:35], a[72:79], v7
  ds_read_b128 v[64:67], v2 offset:57344
  v_smfmac_f32_16x16x64_bf16 v[108:111], v[32:35], a[80:87], v7
  v_smfmac_f32_16x16x64_bf16 v[112:115], v[32:35], a[88:95], v7
  ds_read_b128 v[68:71], v2 offset:61440
  v_smfmac_f32_16x16x64_bf16 v[104:107], v[36:39], v[80:87], v7
  ds_read_b128 v[72:75], v3 offset:0
  v_mov_b32 v16, 0
  v_smfmac_f32_16x16x64_bf16 v[108:111], v[36:39], v[88:95], v7
  v_smfmac_f32_16x16x64_bf16 v[112:115], v[36:39], v[96:103], v7
  ds_read_b128 v[76:79], v3 offset:4096
  v_mov_b32 v17, 0
  v_smfmac_f32_16x16x64_bf16 v[104:107], v[40:43], a[96:103], v7
  ds_read_b128 v[80:83], v3 offset:8192
  v_mov_b32 v18, 0
  v_smfmac_f32_16x16x64_bf16 v[108:111], v[40:43], a[104:111], v7
  ds_read_b128 v[84:87], v3 offset:12288
  v_mov_b32 v19, 0
  v_smfmac_f32_16x16x64_bf16 v[112:115], v[40:43], a[112:119], v7
  ds_read_b128 v[88:91], v3 offset:16384
  v_mov_b32 v20, 0
  v_smfmac_f32_16x16x64_bf16 v[104:107], v[44:47], a[120:127], v7
  ds_read_b128 v[92:95], v3 offset:20480
  v_mov_b32 v21, 0
  v_smfmac_f32_16x16x64_bf16 v[108:111], v[44:47], a[128:135], v7
  ds_read_b128 v[96:99], v3 offset:24576
  v_mov_b32 v22, 0
  v_smfmac_f32_16x16x64_bf16 v[112:115], v[44:47], a[136:143], v7
  ds_read_b128 v[100:103], v3 offset:28672
  s_waitcnt lgkmcnt(5)
  v_mov_b32 v23, 0
  v_smfmac_f32_16x16x64_bf16 v[104:107], v[48:51], v[56:63], v7
  v_mov_b32 v24, 0
  v_smfmac_f32_16x16x64_bf16 v[108:111], v[48:51], v[64:71], v7
  v_mov_b32 v25, 0
  v_smfmac_f32_16x16x64_bf16 v[112:115], v[48:51], v[72:79], v7
  v_mov_b32 v26, 0
  v_smfmac_f32_16x16x64_bf16 v[104:107], v[52:55], a[144:151], v7
  v_mov_b32 v27, 0
  v_smfmac_f32_16x16x64_bf16 v[108:111], v[52:55], a[152:159], v7
  v_mov_b32 v28, 0
  v_smfmac_f32_16x16x64_bf16 v[112:115], v[52:55], a[160:167], v7
  v_mov_b32 v29, 0
  s_waitcnt lgkmcnt(0)
  s_branch va_join
L_owner:
  s_cmp_ge_u32 s42, 2
  s_cbranch_scc1 L_end
  s_mul_i32 s62, s43, 10
  s_add_u32 s62, s62, s44
  s_sub_u32 s62, s62, 16
  s_mov_b32 s12, s24
  s_mov_b32 s13, s25
  s_mov_b32 s14, 10240
  s_mov_b32 s15, 0x20000
  v_and_b32 v11, 3, v0
  v_lshlrev_b32 v11, 2, v11
  s_mov_b32 s50, 0
ss_27:
  global_load_dword v10, v11, s[38:39] sc1
  s_add_u32 s50, s50, 1
  s_cmp_gt_u32 s50, 131072
  s_cbranch_scc1 L_fail
  s_waitcnt vmcnt(0)
  v_readlane_b32 s46, v10, 0
  v_readlane_b32 s47, v10, 1
  s_cmp_lg_u32 s46, 0
  s_cselect_b32 s48, 7, 0
  s_add_u32 s46, s46, s2
  s_xor_b32 s49, s46, s43
  s_and_b32 s49, s49, s48
  s_cbranch_scc1 L_reroll
  s_cmp_lg_u32 s47, 0
  s_cbranch_scc1 ss_ok_28
  s_sleep 10
  s_branch ss_27
ss_ok_28:
  v_readlane_b32 s3, v10, 1
  s_nop 0
  s_and_b32 s3, s3, 0x2000
  v_and_b32 v10, 3, v0
  s_lshl_b32 s46, s43, 9
  s_add_u32 s46, s46, s3
  s_add_u32 s46, s46, 13371392
  v_lshl_add_u32 v6, v10, 7, s46
  s_lshl_b32 s46, s43, 7
  s_add_u32 s46, s46, s3
  s_add_u32 s46, s46, 13369344
  v_lshl_add_u32 v7, v10, 9, s46
  v_mov_b32 v17, 0
  v_mov_b32 v14, 2146435072
  s_cmp_eq_u32 s44, 16
  s_cselect_b64 vcc, 15, 0
  v_cndmask_b32 v7, v14, v7, vcc
  v_lshlrev_b32 v9, 7, v0
  s_and_b32 s46, s62, 3
  s_lshl_b32 s46, s46, 2
  s_add_u32 s46, s46, 1060864
  v_add_u32 v9, s46, v9
  v_and_b32 v18, 3, v0
  v_min_u32 v18, 2, v18
  v_lshlrev_b32 v18, 8, v18
  s_mul_i32 s46, s43, 768
  s_cmp_ge_u32 s44, 21
  s_cselect_b32 s47, 128, 0
  s_add_u32 s46, s46, s47
  s_add_u32 s46, s46, 1073152
  v_add_u32 v18, s46, v18
  v_cmp_lt_u32 vcc, 31, v0
  s_nop 1
  v_cndmask_b32 v9, v9, v18, vcc
  s_cmp_eq_u32 s42, 0
  s_cbranch_scc1 ow_main
  v_mov_b32 v14, 2146435072
  s_lshl_b32 s46, s43, 7
  s_add_u32 s46, s46, s3
  s_add_u32 s46, s46, 13373440
  v_mov_b32 v19, s46
  s_lshl_b32 s46, s43, 7
  s_add_u32 s46, s46, 1077248
  v_writelane_b32 v19, s46, 1
  s_cmp_eq_u32 s44, 17
  s_cselect_b64 vcc, 3, 0
  v_cndmask_b32 v19, v14, v19, vcc
  s_barrier
  s_mov_b32 s53, 1
ow_listen:
  buffer_load_dword v12, v9, s[8:11], 0 offen sc1
  s_waitcnt vmcnt(0)
  v_min_u32_dpp v12, v12, v12 row_ror:8 row_mask:0xf bank_mask:0xf
  s_nop 1
  v_min_u32_dpp v12, v12, v12 row_ror:4 row_mask:0xf bank_mask:0xf
  s_nop 1
  v_min_u32_dpp v12, v12, v12 row_ror:2 row_mask:0xf bank_mask:0xf
  s_nop 1
  v_min_u32_dpp v12, v12, v12 row_ror:1 row_mask:0xf bank_mask:0xf
  v_mov_b32 v13, v12
  s_nop 1
  v_permlane16_swap_b32 v13, v12
  v_min_u32 v12, v12, v13
  v_mov_b32 v13, v12
  s_nop 1
  v_permlane32_swap_b32 v13, v12
  v_min_u32 v12, v12, v13
  ds_write_b32 v17, v12
  s_waitcnt lgkmcnt(0)
  s_add_u32 s46, s53, 1
  v_mov_b32 v16, s46
  s_mov_b32 s50, 0
  s_mov_b64 exec, 15
  buffer_load_dword v136, v6, s[8:11], 0 offen sc1
  s_nop 11
  buffer_load_dword v137, v6, s[8:11], 0 offen sc1
  s_nop 11
  buffer_load_dword v138, v6, s[8:11], 0 offen sc1
  s_nop 11
  buffer_load_dword v139, v6, s[8:11], 0 offen sc1
  s_nop 11
  buffer_load_dword v140, v6, s[8:11], 0 offen sc1
  s_nop 11
  buffer_load_dword v141, v6, s[8:11], 0 offen sc1
  s_nop 11
  buffer_load_dword v142, v6, s[8:11], 0 offen sc1
  s_nop 11
  buffer_load_dword v143, v6, s[8:11], 0 offen sc1
  s_nop 11
  buffer_load_dword v144, v6, s[8:11], 0 offen sc1
  s_nop 11
bell_29:
  buffer_load_dword v145, v6, s[8:11], 0 offen sc1
  s_waitcnt vmcnt(9)
  v_cmp_gt_u32 vcc, s53, v136
  s_cbranch_vccz bell_x_30
  s_nop 7
  buffer_load_dword v136, v6, s[8:11], 0 offen sc1
  s_waitcnt vmcnt(9)
  v_cmp_gt_u32 vcc, s53, v137
  s_cbranch_vccz bell_x_30
  s_nop 7
  buffer_load_dword v137, v6, s[8:11], 0 offen sc1
  s_waitcnt vmcnt(9)
  v_cmp_gt_u32 vcc, s53, v138
  s_cbranch_vccz bell_x_30
  s_nop 7
  buffer_load_dword v138, v6, s[8:11], 0 offen sc1
  s_waitcnt vmcnt(9)
  v_cmp_gt_u32 vcc, s53, v139
  s_cbranch_vccz bell_x_30
  s_nop 7
  buffer_load_dword v139, v6, s[8:11], 0 offen sc1
  s_waitcnt vmcnt(9)
  v_cmp_gt_u32 vcc, s53, v140
  s_cbranch_vccz bell_x_30
  s_nop 7
  buffer_load_dword v140, v6, s[8:11], 0 offen sc1
  s_waitcnt vmcnt(9)
  v_cmp_gt_u32 vcc, s53, v141
  s_cbranch_vccz bell_x_30
  s_nop 7
  buffer_load_dword v141, v6, s[8:11], 0 offen sc1
  s_waitcnt vmcnt(9)
  v_cmp_gt_u32 vcc, s53, v142
  s_cbranch_vccz bell_x_30
  s_nop 7
  buffer_load_dword v142, v6, s[8:11], 0 offen sc1
  s_waitcnt vmcnt(9)
  v_cmp_gt_u32 vcc, s53, v143
  s_cbranch_vccz bell_x_30
  s_nop 7
  buffer_load_dword v143, v6, s[8:11], 0 offen sc1
  s_waitcnt vmcnt(9)
  v_cmp_gt_u32 vcc, s53, v144
  s_cbranch_vccz bell_x_30
  s_nop 7
  buffer_load_dword v144, v6, s[8:11], 0 offen sc1
  s_waitcnt vmcnt(9)
  v_cmp_gt_u32 vcc, s53, v145
  s_cbranch_vccz bell_x_30
  s_add_u32 s50, s50, 1
  s_cmp_gt_u32 s50, 131072
  s_cbranch_scc1 L_fail
  s_branch bell_29
bell_x_30:
  s_mov_b64 exec, -1
  s_barrier
  s_sub_u32 s46, s53, 1
  v_mov_b32 v12, s46
  s_barrier
  s_sleep 0
  buffer_store_dword v12, v19, s[8:11], 0 offen sc1
  s_sleep 8
  s_add_u32 s53, s53, 1
  s_cmp_lt_u32 s53, 64
  s_cbranch_scc1 ow_listen
  s_endpgm
ow_main:
  v_mov_b32 v5, 0x44444444
  v_mov_b32 v10, 0xeeeeeeee
  v_and_b32 v11, 2, v0
  v_cmp_ne_u32 vcc, 0, v11
  s_nop 1
  v_cndmask_b32 v5, v5, v10, vcc
  v_lshlrev_b32 v1, 4, v0
  v_and_b32 v10, 15, v0
  v_lshrrev_b32 v11, 4, v0
  v_lshlrev_b32 v2, 3, v10
  v_lshl_add_u32 v2, v11, 8, v2
  v_and_b32 v13, 1, v10
  v_lshl_add_u32 v12, v11, 1, v13
  v_mov_b32 v4, 0x05040100
  v_mov_b32 v14, 0x03020706
  v_cmp_eq_u32 vcc, 1, v13
  s_nop 1
  v_cndmask_b32 v4, v4, v14, vcc
  v_and_b32 v13, 3, v10
  v_lshl_add_u32 v3, v11, 2, v13
  v_lshlrev_b32 v3, 4, v3
  v_lshrrev_b32 v13, 2, v10
  v_lshl_add_u32 v3, v13, 2, v3
  s_lshl_b32 s46, s62, 8
  s_cmp_ge_u32 s62, 32
  s_cselect_b32 s47, 40960, 0
  s_add_u32 s46, s46, s47
  s_add_u32 s46, s46, s3
  s_add_u32 s46, s46, 12582912
  v_add_u32 v3, s46, v3
  v_mul_u32_u24 v12, 1280, v12
  v_and_b32 v13, 14, v10
  v_lshl_add_u32 v12, v13, 1, v12
  s_lshl_b32 s46, s62, 5
  buffer_load_dword v15, v12, s[12:15], s46 offen
  s_lshl_b32 s63, s62, 16
  s_add_u32 s63, s63, s3
  s_add_u32 s63, s63, 81788928
  s_mov_b32 s61, 0
  s_mov_b32 s52, 0
  s_mov_b32 s58, 0
  s_mov_b32 s54, 0
  s_mov_b32 s100, 0
  v_mov_b32 v20, -1
  v_mov_b32 v24, 0
  v_mov_b32 v21, -1
  v_mov_b32 v25, 0
  v_mov_b32 v22, -1
  v_mov_b32 v26, 0
  v_mov_b32 v23, -1
  v_mov_b32 v27, 0
  s_mov_b32 s46, 0
  buffer_store_dword v20, v3, s[8:11], s46 offen sc1
  s_mov_b32 s46, 65536
  buffer_store_dword v20, v3, s[8:11], s46 offen sc1
  s_mov_b32 s46, 131072
  buffer_store_dword v20, v3, s[8:11], s46 offen sc1
  s_mov_b32 s46, 196608
  buffer_store_dword v20, v3, s[8:11], s46 offen sc1
  s_mov_b32 s46, 262144
  buffer_store_dword v20, v3, s[8:11], s46 offen sc1
  s_mov_b32 s46, 327680
  buffer_store_dword v20, v3, s[8:11], s46 offen sc1
  s_mov_b32 s46, 393216
  buffer_store_dword v20, v3, s[8:11], s46 offen sc1
  s_mov_b32 s46, 458752
  buffer_store_dword v20, v3, s[8:11], s46 offen sc1
  s_mov_b32 s46, 524288
  buffer_store_dword v20, v3, s[8:11], s46 offen sc1
  s_mov_b32 s46, 589824
  buffer_store_dword v20, v3, s[8:11], s46 offen sc1
  s_mov_b32 s46, 655360
  buffer_store_dword v20, v3, s[8:11], s46 offen sc1
  s_mov_b32 s46, 720896
  buffer_store_dword v20, v3, s[8:11], s46 offen sc1
  s_lshl_b32 s46, s62, 9
  s_cmp_ge_u32 s62, 16
  s_cselect_b32 s47, 8192, 0
  s_add_u32 s46, s46, s47
  s_cmp_ge_u32 s62, 32
  s_cselect_b32 s47, 10240, 0
  s_add_u32 s46, s46, s47
  s_add_u32 s46, s46, s3
  s_add_u32 s46, s46, 12599296
  v_lshlrev_b32 v13, 3, v0
  buffer_store_dwordx2 v[20:21], v13, s[8:11], s46 offen sc1
  s_add_u32 s46, s46, 262144
  buffer_store_dwordx2 v[20:21], v13, s[8:11], s46 offen sc1
  s_add_u32 s46, s46, 262144
  buffer_store_dwordx2 v[20:21], v13, s[8:11], s46 offen sc1
  s_add_u32 s46, s46, 262144
  v_min_u32 v13, 12, v0
  v_lshlrev_b32 v13, 7, v13
  s_mul_i32 s46, s62, 1664
  s_add_u32 s46, s46, 1048576
  buffer_store_dwordx4 v[24:27], v13, s[8:11], s46 offen sc1
  s_lshl_b32 s46, s62, 7
  s_add_u32 s46, s46, s3
  s_add_u32 s46, s46, 13369344
  buffer_store_dword v24, v24, s[8:11], s46 offen sc1
  v_mov_b32 v13, 140
  v_mov_b32 v14, 1
  s_waitcnt vmcnt(0)
  s_mov_b64 exec, 1
  global_atomic_add v12, v13, v14, s[38:39] sc0 sc1
  s_waitcnt vmcnt(0)
  v_readfirstlane_b32 s46, v12
  s_nop 0
  s_cmp_lg_u32 s46, 39
  s_cbranch_scc1 ow_notlast
  v_mov_b32 v13, 8
  global_store_dword v13, v14, s[38:39] sc1
ow_notlast:
  s_mov_b64 exec, -1
  v_and_b32 v13, 3, v0
  v_lshlrev_b32 v13, 2, v13
  s_mov_b32 s50, 0
ss_31:
  global_load_dword v12, v13, s[38:39] sc1
  s_add_u32 s50, s50, 1
  s_cmp_gt_u32 s50, 131072
  s_cbranch_scc1 L_fail
  s_waitcnt vmcnt(0)
  v_readlane_b32 s46, v12, 0
  v_readlane_b32 s47, v12, 2
  s_cmp_lg_u32 s46, 0
  s_cselect_b32 s48, 7, 0
  s_add_u32 s46, s46, s2
  s_xor_b32 s49, s46, s43
  s_and_b32 s49, s49, s48
  s_cbranch_scc1 L_reroll
  s_cmp_lg_u32 s47, 0
  s_cbranch_scc1 ss_ok_32
  s_sleep 10
  s_branch ss_31
ss_ok_32:
  v_readlane_b32 s3, v12, 1
  s_nop 0
  s_and_b32 s3, s3, 0x2000
  s_barrier
  s_mov_b32 s49, 1
  s_cmp_ge_u32 s61, s49
  s_cbranch_scc1 wf_done_33
  s_mov_b32 s50, 0
wf_loop_34:
  buffer_load_dword v12, v18, s[8:11], 0 offen sc1
  s_add_u32 s50, s50, 1
  s_cmp_gt_u32 s50, 131072
  s_cbranch_scc1 L_fail
  s_waitcnt vmcnt(0)
  v_min_u32_dpp v12, v12, v12 row_ror:8 row_mask:0xf bank_mask:0xf
  s_nop 1
  v_min_u32_dpp v12, v12, v12 row_ror:4 row_mask:0xf bank_mask:0xf
  s_nop 1
  v_min_u32_dpp v12, v12, v12 row_ror:2 row_mask:0xf bank_mask:0xf
  s_nop 1
  v_min_u32_dpp v12, v12, v12 row_ror:1 row_mask:0xf bank_mask:0xf
  v_mov_b32 v13, v12
  s_nop 1
  v_permlane16_swap_b32 v13, v12
  v_min_u32 v12, v12, v13
  v_mov_b32 v13, v12
  s_nop 1
  v_permlane32_swap_b32 v13, v12
  v_min_u32 v12, v12, v13
  s_nop 0
  v_readfirstlane_b32 s61, v12
  s_nop 0
  s_cmp_ge_u32 s61, s49
  s_cbranch_scc1 wf_done_33
  s_sleep 2
  s_branch wf_loop_34
wf_done_33:
  s_mov_b32 s61, 0
  v_min_u32 v15, -2, v15
  s_mov_b32 s46, 0
  buffer_store_dword v15, v3, s[8:11], s46 offen sc1
  s_mov_b32 s46, 65536
  buffer_store_dword v15, v3, s[8:11], s46 offen sc1
  s_mov_b32 s46, 131072
  buffer_store_dword v15, v3, s[8:11], s46 offen sc1
  s_mov_b32 s46, 196608
  buffer_store_dword v15, v3, s[8:11], s46 offen sc1
  v_mov_b32 v16, 1
  buffer_store_dword v16, v7, s[8:11], 0 offen sc1
  s_mov_b32 s49, 1
  s_cmp_ge_u32 s61, s49
  s_cbranch_scc1 wf_done_35
  s_mov_b32 s50, 0
wf_loop_36:
  buffer_load_dword v12, v9, s[8:11], 0 offen sc1
  s_add_u32 s50, s50, 1
  s_cmp_gt_u32 s50, 131072
  s_cbranch_scc1 L_fail
  s_waitcnt vmcnt(0)
  v_min_u32_dpp v12, v12, v12 row_ror:8 row_mask:0xf bank_mask:0xf
  s_nop 1
  v_min_u32_dpp v12, v12, v12 row_ror:4 row_mask:0xf bank_mask:0xf
  s_nop 1
  v_min_u32_dpp v12, v12, v12 row_ror:2 row_mask:0xf bank_mask:0xf
  s_nop 1
  v_min_u32_dpp v12, v12, v12 row_ror:1 row_mask:0xf bank_mask:0xf
  v_mov_b32 v13, v12
  s_nop 1
  v_permlane16_swap_b32 v13, v12
  v_min_u32 v12, v12, v13
  v_mov_b32 v13, v12
  s_nop 1
  v_permlane32_swap_b32 v13, v12
  v_min_u32 v12, v12, v13
  s_nop 0
  v_readfirstlane_b32 s61, v12
  s_nop 0
  s_cmp_ge_u32 s61, s49
  s_cbranch_scc1 wf_done_35
  s_sleep 2
  s_branch wf_loop_36
wf_done_35:
  s_mov_b32 s65, s63
  s_lshr_b32 s46, s65, 8
  s_and_b32 s46, s46, 0x2000
  s_xor_b32 s65, s65, s46
  s_add_u32 s63, s63, 2621440
  s_cmp_ge_u32 s63, 165675008
  s_cselect_b32 s46, 83886080, 0
  s_sub_u32 s63, s63, s46
  s_add_u32 s46, s65, 0
  buffer_load_dwordx4 a[0:3], v1, s[8:11], s46 offen offset:0 sc1
  buffer_load_dwordx4 a[4:7], v1, s[8:11], s46 offen offset:1024 sc1
  buffer_load_dwordx4 a[8:11], v1, s[8:11], s46 offen offset:2048 sc1
  buffer_load_dwordx4 a[12:15], v1, s[8:11], s46 offen offset:3072 sc1
  s_add_u32 s46, s65, 4096
  buffer_load_dwordx4 a[16:19], v1, s[8:11], s46 offen offset:0 sc1
  buffer_load_dwordx4 a[20:23], v1, s[8:11], s46 offen offset:1024 sc1
  buffer_load_dwordx4 a[24:27], v1, s[8:11], s46 offen offset:2048 sc1
  buffer_load_dwordx4 a[28:31], v1, s[8:11], s46 offen offset:3072 sc1
  s_add_u32 s46, s65, 16384
  buffer_load_dwordx4 a[32:35], v1, s[8:11], s46 offen offset:0 sc1
  buffer_load_dwordx4 a[36:39], v1, s[8:11], s46 offen offset:1024 sc1
  buffer_load_dwordx4 a[40:43], v1, s[8:11], s46 offen offset:2048 sc1
  buffer_load_dwordx4 a[44:47], v1, s[8:11], s46 offen offset:3072 sc1
  s_add_u32 s46, s65, 20480
  buffer_load_dwordx4 a[48:51], v1, s[8:11], s46 offen offset:0 sc1
  buffer_load_dwordx4 a[52:55], v1, s[8:11], s46 offen offset:1024 sc1
  buffer_load_dwordx4 a[56:59], v1, s[8:11], s46 offen offset:2048 sc1
  buffer_load_dwordx4 a[60:63], v1, s[8:11], s46 offen offset:3072 sc1
  s_add_u32 s46, s65, 32768
  buffer_load_dwordx4 a[64:67], v1, s[8:11], s46 offen offset:0 sc1
  buffer_load_dwordx4 a[68:71], v1, s[8:11], s46 offen offset:1024 sc1
  buffer_load_dwordx4 a[72:75], v1, s[8:11], s46 offen offset:2048 sc1
  buffer_load_dwordx4 a[76:79], v1, s[8:11], s46 offen offset:3072 sc1
  s_add_u32 s46, s65, 36864
  buffer_load_dwordx4 a[80:83], v1, s[8:11], s46 offen offset:0 sc1
  buffer_load_dwordx4 a[84:87], v1, s[8:11], s46 offen offset:1024 sc1
  buffer_load_dwordx4 a[88:91], v1, s[8:11], s46 offen offset:2048 sc1
  buffer_load_dwordx4 a[92:95], v1, s[8:11], s46 offen offset:3072 sc1
  s_add_u32 s46, s65, 49152
  buffer_load_dwordx4 a[96:99], v1, s[8:11], s46 offen offset:0 sc1
  buffer_load_dwordx4 a[100:103], v1, s[8:11], s46 offen offset:1024 sc1
  buffer_load_dwordx4 a[104:107], v1, s[8:11], s46 offen offset:2048 sc1
  buffer_load_dwordx4 a[108:111], v1, s[8:11], s46 offen offset:3072 sc1
  s_add_u32 s46, s65, 53248
  buffer_load_dwordx4 a[112:115], v1, s[8:11], s46 offen offset:0 sc1
  buffer_load_dwordx4 a[116:119], v1, s[8:11], s46 offen offset:1024 sc1
  buffer_load_dwordx4 a[120:123], v1, s[8:11], s46 offen offset:2048 sc1
  buffer_load_dwordx4 a[124:127], v1, s[8:11], s46 offen offset:3072 sc1
ow_loop:
  s_add_u32 s53, s52, 1
  s_lshl_b32 s56, s58, 2
  s_add_u32 s56, s56, s43
  s_lshl_b32 s56, s56, 16
  s_add_u32 s56, s56, s3
  s_add_u32 s56, s56, 12582912
  s_add_u32 s66, s58, 1
  s_cmp_eq_u32 s66, 3
  s_cselect_b32 s66, 0, s66
  s_lshl_b32 s72, s54, 21
  s_mul_i32 s46, s58, 655360
  s_add_u32 s72, s72, s46
  s_add_u32 s72, s72, s3
  s_add_u32 s72, s72, 4194304
  s_lshr_b32 s46, s72, 8
  s_and_b32 s46, s46, 0x2000
  s_xor_b32 s72, s72, s46
  s_lshl_b32 s46, s62, 14
  s_add_u32 s72, s72, s46
  s_add_u32 s73, s72, 4096
  s_and_b32 s46, s43, 3
  s_lshl_b32 s46, s46, 16
  s_sub_u32 s56, s56, s46
  s_add_u32 s74, s56, 16384
  s_add_u32 s75, s56, 20480
  s_add_u32 s76, s56, 32768
  s_add_u32 s77, s56, 36864
  s_add_u32 s78, s56, 51200
  s_lshl_b32 s80, s66, 18
  s_add_u32 s81, s80, 65536
  s_add_u32 s82, s80, 131072
  s_add_u32 s83, s80, 196608
  s_add_u32 s64, s52, 2
  v_mov_b32 v16, s64
  s_mov_b64 s[16:17], -1
  s_mov_b32 s71, 0
  v_mov_b32 v20, 0
  v_mov_b32 v21, 0
  v_mov_b32 v22, 0
  v_mov_b32 v23, 0
  s_waitcnt vmcnt(0)
  s_barrier
  buffer_load_dwordx4 v[24:27], v1, s[8:11], s72 offen offset:0 sc1
  buffer_load_dwordx4 v[28:31], v1, s[8:11], s72 offen offset:1024 sc1
  buffer_load_dwordx4 v[32:35], v1, s[8:11], s72 offen offset:2048 sc1
  buffer_load_dwordx4 v[36:39], v1, s[8:11], s72 offen offset:3072 sc1
  buffer_load_dwordx4 v[40:43], v1, s[8:11], s73 offen offset:0 sc1
  buffer_load_dwordx4 v[44:47], v1, s[8:11], s73 offen offset:1024 sc1
  buffer_load_dwordx4 v[48:51], v1, s[8:11], s73 offen offset:2048 sc1
  buffer_load_dwordx4 v[52:55], v1, s[8:11], s73 offen offset:3072 sc1
  buffer_load_dwordx2 v[56:57], v2, s[8:11], s78 offen offset:0 sc1
  buffer_load_dwordx2 v[58:59], v2, s[8:11], s78 offen offset:128 sc1
  buffer_load_dwordx2 v[60:61], v2, s[8:11], s78 offen offset:1024 sc1
  buffer_load_dwordx2 v[62:63], v2, s[8:11], s78 offen offset:1152 sc1
  buffer_load_dwordx2 v[64:65], v2, s[8:11], s78 offen offset:2048 sc1
  buffer_load_dwordx2 v[66:67], v2, s[8:11], s78 offen offset:2176 sc1
  buffer_load_dwordx2 v[68:69], v2, s[8:11], s78 offen offset:3072 sc1
  buffer_load_dwordx2 v[70:71], v2, s[8:11], s78 offen offset:3200 sc1
  buffer_load_dwordx4 v[72:75], v1, s[8:11], s74 offen offset:0 sc1
  buffer_load_dwordx4 v[76:79], v1, s[8:11], s74 offen offset:1024 sc1
  buffer_load_dwordx4 v[80:83], v1, s[8:11], s74 offen offset:2048 sc1
  buffer_load_dwordx4 v[84:87], v1, s[8:11], s74 offen offset:3072 sc1
  buffer_load_dwordx4 v[88:91], v1, s[8:11], s75 offen offset:0 sc1
  buffer_load_dwordx4 v[92:95], v1, s[8:11], s75 offen offset:1024 sc1
  buffer_load_dwordx4 v[96:99], v1, s[8:11], s75 offen offset:2048 sc1
  buffer_load_dwordx4 v[100:103], v1, s[8:11], s75 offen offset:3072 sc1
  buffer_load_dwordx4 v[104:107], v1, s[8:11], s76 offen offset:0 sc1
  buffer_load_dwordx4 v[108:111], v1, s[8:11], s76 offen offset:1024 sc1
  buffer_load_dwordx4 v[112:115], v1, s[8:11], s76 offen offset:2048 sc1
  buffer_load_dwordx4 v[116:119], v1, s[8:11], s76 offen offset:3072 sc1
  buffer_load_dwordx4 v[120:123], v1, s[8:11], s77 offen offset:0 sc1
  buffer_load_dwordx4 v[124:127], v1, s[8:11], s77 offen offset:1024 sc1
  buffer_load_dwordx4 v[128:131], v1, s[8:11], s77 offen offset:2048 sc1
  buffer_load_dwordx4 v[132:135], v1, s[8:11], s77 offen offset:3072 sc1
ow_go:
  s_waitcnt vmcnt(22)
  v_smfmac_f32_16x16x64_bf16 v[20:23], v[56:59], v[24:31], v5
  s_waitcnt vmcnt(20)
  v_smfmac_f32_16x16x64_bf16 v[20:23], v[60:63], v[32:39], v5
  buffer_store_dword v16, v7, s[8:11], 0 offen sc1
  s_waitcnt vmcnt(19)
  v_smfmac_f32_16x16x64_bf16 v[20:23], v[64:67], v[40:47], v5
  s_waitcnt vmcnt(17)
  v_smfmac_f32_16x16x64_bf16 v[20:23], v[68:71], v[48:55], v5
  s_waitcnt vmcnt(16)
  v_smfmac_f32_16x16x64_bf16 v[20:23], v[72:75], a[0:7], v5
  s_waitcnt vmcnt(15)
  v_smfmac_f32_16x16x64_bf16 v[20:23], v[76:79], a[8:15], v5
  s_waitcnt vmcnt(14)
  v_smfmac_f32_16x16x64_bf16 v[20:23], v[80:83], a[16:23], v5
  s_waitcnt vmcnt(13)
  v_smfmac_f32_16x16x64_bf16 v[20:23], v[84:87], a[24:31], v5
  s_waitcnt vmcnt(12)
  v_smfmac_f32_16x16x64_bf16 v[20:23], v[88:91], a[32:39], v5
  s_waitcnt vmcnt(11)
  v_smfmac_f32_16x16x64_bf16 v[20:23], v[92:95], a[40:47], v5
  s_waitcnt vmcnt(10)
  v_smfmac_f32_16x16x64_bf16 v[20:23], v[96:99], a[48:55], v5
  s_waitcnt vmcnt(9)
  v_smfmac_f32_16x16x64_bf16 v[20:23], v[100:103], a[56:63], v5
  s_waitcnt vmcnt(8)
  v_smfmac_f32_16x16x64_bf16 v[20:23], v[104:107], a[64:71], v5
  s_waitcnt vmcnt(7)
  v_smfmac_f32_16x16x64_bf16 v[20:23], v[108:111], a[72:79], v5
  s_waitcnt vmcnt(6)
  v_smfmac_f32_16x16x64_bf16 v[20:23], v[112:115], a[80:87], v5
  s_waitcnt vmcnt(5)
  v_smfmac_f32_16x16x64_bf16 v[20:23], v[116:119], a[88:95], v5
  s_waitcnt vmcnt(4)
  v_smfmac_f32_16x16x64_bf16 v[20:23], v[120:123], a[96:103], v5
  s_waitcnt vmcnt(3)
  v_smfmac_f32_16x16x64_bf16 v[20:23], v[124:127], a[104:111], v5
  s_waitcnt vmcnt(2)
  v_smfmac_f32_16x16x64_bf16 v[20:23], v[128:131], a[112:119], v5
  s_waitcnt vmcnt(1)
  v_smfmac_f32_16x16x64_bf16 v[20:23], v[132:135], a[120:127], v5
  s_nop 7
  v_add_f32 v20, v20, v22
  v_add_f32 v21, v21, v23
  v_cvt_pk_bf16_f32 v10, v20, v21
  v_cmp_u_f32 vcc, v20, v21
  s_nop 0
  v_mov_b32_dpp v11, v10 quad_perm:[1,0,3,2] row_mask:0xf bank_mask:0xf
  v_perm_b32 v10, v11, v10, v4
  s_and_b64 vcc, vcc, s[16:17]
  s_cbranch_scc1 ow_redo
  buffer_store_dword v10, v3, s[8:11], s80 offen sc1
  buffer_store_dword v10, v3, s[8:11], s81 offen sc1
  buffer_store_dword v10, v3, s[8:11], s82 offen sc1
  buffer_store_dword v10, v3, s[8:11], s83 offen sc1
  s_barrier
  s_add_u32 s49, s52, 2
  v_mov_b32 v11, -1
  s_lshl_b32 s47, s58, 18
  s_add_u32 s46, s47, 0
  buffer_store_dword v11, v3, s[8:11], s46 offen sc1
  s_add_u32 s46, s47, 65536
  buffer_store_dword v11, v3, s[8:11], s46 offen sc1
  s_add_u32 s46, s47, 131072
  buffer_store_dword v11, v3, s[8:11], s46 offen sc1
  s_add_u32 s46, s47, 196608
  buffer_store_dword v11, v3, s[8:11], s46 offen sc1
  s_waitcnt vmcnt(0)
  ds_read_b32 v12, v17
  s_waitcnt lgkmcnt(0)
  v_readfirstlane_b32 s46, v12
  s_nop 0
  s_max_u32 s61, s61, s46
  s_cmp_ge_u32 s61, s49
  s_cbranch_scc1 wf_done_37
  s_mov_b32 s50, 0
wf_loop_38:
  buffer_load_dword v12, v9, s[8:11], 0 offen sc1
  s_add_u32 s50, s50, 1
  s_cmp_gt_u32 s50, 131072
  s_cbranch_scc1 L_fail
  s_waitcnt vmcnt(0)
  v_min_u32_dpp v12, v12, v12 row_ror:8 row_mask:0xf bank_mask:0xf
  s_nop 1
  v_min_u32_dpp v12, v12, v12 row_ror:4 row_mask:0xf bank_mask:0xf
  s_nop 1
  v_min_u32_dpp v12, v12, v12 row_ror:2 row_mask:0xf bank_mask:0xf
  s_nop 1
  v_min_u32_dpp v12, v12, v12 row_ror:1 row_mask:0xf bank_mask:0xf
  v_mov_b32 v13, v12
  s_nop 1
  v_permlane16_swap_b32 v13, v12
  v_min_u32 v12, v12, v13
  v_mov_b32 v13, v12
  s_nop 1
  v_permlane32_swap_b32 v13, v12
  v_min_u32 v12, v12, v13
  s_nop 0
  v_readfirstlane_b32 s61, v12
  s_nop 0
  s_cmp_ge_u32 s61, s49
  s_cbranch_scc1 wf_done_37
  s_sleep 2
  s_branch wf_loop_38
wf_done_37:
  s_mov_b32 s65, s63
  s_lshr_b32 s46, s65, 8
  s_and_b32 s46, s46, 0x2000
  s_xor_b32 s65, s65, s46
  s_add_u32 s63, s63, 2621440
  s_cmp_ge_u32 s63, 165675008
  s_cselect_b32 s46, 83886080, 0
  s_sub_u32 s63, s63, s46
  s_add_u32 s46, s65, 0
  buffer_load_dwordx4 a[0:3], v1, s[8:11], s46 offen offset:0 sc1
  buffer_load_dwordx4 a[4:7], v1, s[8:11], s46 offen offset:1024 sc1
  buffer_load_dwordx4 a[8:11], v1, s[8:11], s46 offen offset:2048 sc1
  buffer_load_dwordx4 a[12:15], v1, s[8:11], s46 offen offset:3072 sc1
  s_add_u32 s46, s65, 4096
  buffer_load_dwordx4 a[16:19], v1, s[8:11], s46 offen offset:0 sc1
  buffer_load_dwordx4 a[20:23], v1, s[8:11], s46 offen offset:1024 sc1
  buffer_load_dwordx4 a[24:27], v1, s[8:11], s46 offen offset:2048 sc1
  buffer_load_dwordx4 a[28:31], v1, s[8:11], s46 offen offset:3072 sc1
  s_add_u32 s46, s65, 16384
  buffer_load_dwordx4 a[32:35], v1, s[8:11], s46 offen offset:0 sc1
  buffer_load_dwordx4 a[36:39], v1, s[8:11], s46 offen offset:1024 sc1
  buffer_load_dwordx4 a[40:43], v1, s[8:11], s46 offen offset:2048 sc1
  buffer_load_dwordx4 a[44:47], v1, s[8:11], s46 offen offset:3072 sc1
  s_add_u32 s46, s65, 20480
  buffer_load_dwordx4 a[48:51], v1, s[8:11], s46 offen offset:0 sc1
  buffer_load_dwordx4 a[52:55], v1, s[8:11], s46 offen offset:1024 sc1
  buffer_load_dwordx4 a[56:59], v1, s[8:11], s46 offen offset:2048 sc1
  buffer_load_dwordx4 a[60:63], v1, s[8:11], s46 offen offset:3072 sc1
  s_add_u32 s46, s65, 32768
  buffer_load_dwordx4 a[64:67], v1, s[8:11], s46 offen offset:0 sc1
  buffer_load_dwordx4 a[68:71], v1, s[8:11], s46 offen offset:1024 sc1
  buffer_load_dwordx4 a[72:75], v1, s[8:11], s46 offen offset:2048 sc1
  buffer_load_dwordx4 a[76:79], v1, s[8:11], s46 offen offset:3072 sc1
  s_add_u32 s46, s65, 36864
  buffer_load_dwordx4 a[80:83], v1, s[8:11], s46 offen offset:0 sc1
  buffer_load_dwordx4 a[84:87], v1, s[8:11], s46 offen offset:1024 sc1
  buffer_load_dwordx4 a[88:91], v1, s[8:11], s46 offen offset:2048 sc1
  buffer_load_dwordx4 a[92:95], v1, s[8:11], s46 offen offset:3072 sc1
  s_add_u32 s46, s65, 49152
  buffer_load_dwordx4 a[96:99], v1, s[8:11], s46 offen offset:0 sc1
  buffer_load_dwordx4 a[100:103], v1, s[8:11], s46 offen offset:1024 sc1
  buffer_load_dwordx4 a[104:107], v1, s[8:11], s46 offen offset:2048 sc1
  buffer_load_dwordx4 a[108:111], v1, s[8:11], s46 offen offset:3072 sc1
  s_add_u32 s46, s65, 53248
  buffer_load_dwordx4 a[112:115], v1, s[8:11], s46 offen offset:0 sc1
  buffer_load_dwordx4 a[116:119], v1, s[8:11], s46 offen offset:1024 sc1
  buffer_load_dwordx4 a[120:123], v1, s[8:11], s46 offen offset:2048 sc1
  buffer_load_dwordx4 a[124:127], v1, s[8:11], s46 offen offset:3072 sc1
  s_mov_b32 s58, s66
  s_cmp_eq_u32 s58, 0
  s_addc_u32 s54, s54, 0
  s_cmp_eq_u32 s54, 3
  s_cselect_b32 s54, 0, s54
  s_mov_b32 s52, s53
  s_cmp_lt_u32 s52, 63
  s_cbranch_scc1 ow_loop
  s_endpgm
ow_redo:
  s_mov_b32 s50, 0
ow_poll:
  buffer_load_dwordx4 v[24:27], v1, s[8:11], s72 offen offset:0 sc1
  buffer_load_dwordx4 v[28:31], v1, s[8:11], s72 offen offset:1024 sc1
  buffer_load_dwordx4 v[32:35], v1, s[8:11], s72 offen offset:2048 sc1
  buffer_load_dwordx4 v[36:39], v1, s[8:11], s72 offen offset:3072 sc1
  buffer_load_dwordx4 v[40:43], v1, s[8:11], s73 offen offset:0 sc1
  buffer_load_dwordx4 v[44:47], v1, s[8:11], s73 offen offset:1024 sc1
  buffer_load_dwordx4 v[48:51], v1, s[8:11], s73 offen offset:2048 sc1
  buffer_load_dwordx4 v[52:55], v1, s[8:11], s73 offen offset:3072 sc1
  buffer_load_dwordx2 v[56:57], v2, s[8:11], s78 offen offset:0 sc1
  buffer_load_dwordx2 v[58:59], v2, s[8:11], s78 offen offset:128 sc1
  buffer_load_dwordx2 v[60:61], v2, s[8:11], s78 offen offset:1024 sc1
  buffer_load_dwordx2 v[62:63], v2, s[8:11], s78 offen offset:1152 sc1
  buffer_load_dwordx2 v[64:65], v2, s[8:11], s78 offen offset:2048 sc1
  buffer_load_dwordx2 v[66:67], v2, s[8:11], s78 offen offset:2176 sc1
  buffer_load_dwordx2 v[68:69], v2, s[8:11], s78 offen offset:3072 sc1
  buffer_load_dwordx2 v[70:71], v2, s[8:11], s78 offen offset:3200 sc1
  buffer_load_dwordx4 v[72:75], v1, s[8:11], s74 offen offset:0 sc1
  buffer_load_dwordx4 v[76:79], v1, s[8:11], s74 offen offset:1024 sc1
  buffer_load_dwordx4 v[80:83], v1, s[8:11], s74 offen offset:2048 sc1
  buffer_load_dwordx4 v[84:87], v1, s[8:11], s74 offen offset:3072 sc1
  buffer_load_dwordx4 v[88:91], v1, s[8:11], s75 offen offset:0 sc1
  buffer_load_dwordx4 v[92:95], v1, s[8:11], s75 offen offset:1024 sc1
  buffer_load_dwordx4 v[96:99], v1, s[8:11], s75 offen offset:2048 sc1
  buffer_load_dwordx4 v[100:103], v1, s[8:11], s75 offen offset:3072 sc1
  buffer_load_dwordx4 v[104:107], v1, s[8:11], s76 offen offset:0 sc1
  buffer_load_dwordx4 v[108:111], v1, s[8:11], s76 offen offset:1024 sc1
  buffer_load_dwordx4 v[112:115], v1, s[8:11], s76 offen offset:2048 sc1
  buffer_load_dwordx4 v[116:119], v1, s[8:11], s76 offen offset:3072 sc1
  buffer_load_dwordx4 v[120:123], v1, s[8:11], s77 offen offset:0 sc1
  buffer_load_dwordx4 v[124:127], v1, s[8:11], s77 offen offset:1024 sc1
  buffer_load_dwordx4 v[128:131], v1, s[8:11], s77 offen offset:2048 sc1
  buffer_load_dwordx4 v[132:135], v1, s[8:11], s77 offen offset:3072 sc1
  s_add_u32 s71, s71, 1
  s_cmp_le_u32 s71, 2
  s_cbranch_scc1 ow_again
  s_add_u32 s50, s50, 1
  s_cmp_gt_u32 s50, 131072
  s_cbranch_scc1 L_fail
  s_waitcnt vmcnt(0)
  v_max_u32 v8, v24, v25
  v_max3_u32 v8, v26, v27, v8
  v_max3_u32 v8, v28, v29, v8
  v_max3_u32 v8, v30, v31, v8
  v_max3_u32 v8, v32, v33, v8
  v_max3_u32 v8, v34, v35, v8
  v_max3_u32 v8, v36, v37, v8
  v_max3_u32 v8, v38, v39, v8
  v_max3_u32 v8, v40, v41, v8
  v_max3_u32 v8, v42, v43, v8
  v_max3_u32 v8, v44, v45, v8
  v_max3_u32 v8, v46, v47, v8
  v_max3_u32 v8, v48, v49, v8
  v_max3_u32 v8, v50, v51, v8
  v_max3_u32 v8, v52, v53, v8
  v_max3_u32 v8, v54, v55, v8
  v_max3_u32 v8, v56, v57, v8
  v_max3_u32 v8, v58, v59, v8
  v_max3_u32 v8, v60, v61, v8
  v_max3_u32 v8, v62, v63, v8
  v_max3_u32 v8, v64, v65, v8
  v_max3_u32 v8, v66, v67, v8
  v_max3_u32 v8, v68, v69, v8
  v_max3_u32 v8, v70, v71, v8
  v_max3_u32 v8, v72, v73, v8
  v_max3_u32 v8, v74, v75, v8
  v_max3_u32 v8, v76, v77, v8
  v_max3_u32 v8, v78, v79, v8
  v_max3_u32 v8, v80, v81, v8
  v_max3_u32 v8, v82, v83, v8
  v_max3_u32 v8, v84, v85, v8
  v_max3_u32 v8, v86, v87, v8
  v_max3_u32 v8, v88, v89, v8
  v_max3_u32 v8, v90, v91, v8
  v_max3_u32 v8, v92, v93, v8
  v_max3_u32 v8, v94, v95, v8
  v_max3_u32 v8, v96, v97, v8
  v_max3_u32 v8, v98, v99, v8
  v_max3_u32 v8, v100, v101, v8
  v_max3_u32 v8, v102, v103, v8
  v_max3_u32 v8, v104, v105, v8
  v_max3_u32 v8, v106, v107, v8
  v_max3_u32 v8, v108, v109, v8
  v_max3_u32 v8, v110, v111, v8
  v_max3_u32 v8, v112, v113, v8
  v_max3_u32 v8, v114, v115, v8
  v_max3_u32 v8, v116, v117, v8
  v_max3_u32 v8, v118, v119, v8
  v_max3_u32 v8, v120, v121, v8
  v_max3_u32 v8, v122, v123, v8
  v_max3_u32 v8, v124, v125, v8
  v_max3_u32 v8, v126, v127, v8
  v_max3_u32 v8, v128, v129, v8
  v_max3_u32 v8, v130, v131, v8
  v_max3_u32 v8, v132, v133, v8
  v_max3_u32 v8, v134, v135, v8
  v_cmp_eq_u32 vcc, -1, v8
  s_cbranch_vccnz ow_poll
  s_mov_b64 s[16:17], 0
ow_again:
  v_mov_b32 v20, 0
  v_mov_b32 v21, 0
  v_mov_b32 v22, 0
  v_mov_b32 v23, 0
  s_branch ow_go
L_xowner:
  s_mov_b32 s4, s16
  s_mov_b32 s5, s17
  s_mov_b32 s6, 2621440
  s_mov_b32 s7, 0x20000
  s_mov_b32 s12, s36
  s_mov_b32 s13, s37
  s_mov_b32 s14, 5242880
  s_mov_b32 s15, 0x20000
  s_cmp_lg_u32 s42, 0
  s_cbranch_scc1 pr_skip
  s_cmp_ge_u32 s44, 28
  s_cbranch_scc1 pr_skip
  s_lshl_b32 s62, s43, 14
  s_and_b32 s46, s44, 1
  s_lshl_b32 s46, s46, 12
  s_add_u32 s62, s62, s46
  s_add_u32 s62, s62, 6160384
  s_add_u32 s65, s62, 8192
  v_lshlrev_b32 v1, 2, v0
  s_mov_b32 s63, -1
  s_mov_b32 s64, -1
  s_memtime s[72:73]
  s_waitcnt lgkmcnt(0)
  buffer_store_dword v1, v1, s[8:11], s62 offen sc1
  s_waitcnt vmcnt(0)
  s_memtime s[74:75]
  s_waitcnt lgkmcnt(0)
  s_sub_u32 s46, s74, s72
  s_min_u32 s63, s63, s46
  s_memtime s[72:73]
  s_waitcnt lgkmcnt(0)
  buffer_store_dword v1, v1, s[8:11], s65 offen sc1
  s_waitcnt vmcnt(0)
  s_memtime s[74:75]
  s_waitcnt lgkmcnt(0)
  s_sub_u32 s46, s74, s72
  s_min_u32 s64, s64, s46
  s_memtime s[72:73]
  s_waitcnt lgkmcnt(0)
  buffer_store_dword v1, v1, s[8:11], s62 offen sc1
  s_waitcnt vmcnt(0)
  s_memtime s[74:75]
  s_waitcnt lgkmcnt(0)
  s_sub_u32 s46, s74, s72
  s_min_u32 s63, s63, s46
  s_memtime s[72:73]
  s_waitcnt lgkmcnt(0)
  buffer_store_dword v1, v1, s[8:11], s65 offen sc1
  s_waitcnt vmcnt(0)
  s_memtime s[74:75]
  s_waitcnt lgkmcnt(0)
  s_sub_u32 s46, s74, s72
  s_min_u32 s64, s64, s46
  s_memtime s[72:73]
  s_waitcnt lgkmcnt(0)
  buffer_store_dword v1, v1, s[8:11], s62 offen sc1
  s_waitcnt vmcnt(0)
  s_memtime s[74:75]
  s_waitcnt lgkmcnt(0)
  s_sub_u32 s46, s74, s72
  s_min_u32 s63, s63, s46
  s_memtime s[72:73]
  s_waitcnt lgkmcnt(0)
  buffer_store_dword v1, v1, s[8:11], s65 offen sc1
  s_waitcnt vmcnt(0)
  s_memtime s[74:75]
  s_waitcnt lgkmcnt(0)
  s_sub_u32 s46, s74, s72
  s_min_u32 s64, s64, s46
  s_memtime s[72:73]
  s_waitcnt lgkmcnt(0)
  buffer_store_dword v1, v1, s[8:11], s62 offen sc1
  s_waitcnt vmcnt(0)
  s_memtime s[74:75]
  s_waitcnt lgkmcnt(0)
  s_sub_u32 s46, s74, s72
  s_min_u32 s63, s63, s46
  s_memtime s[72:73]
  s_waitcnt lgkmcnt(0)
  buffer_store_dword v1, v1, s[8:11], s65 offen sc1
  s_waitcnt vmcnt(0)
  s_memtime s[74:75]
  s_waitcnt lgkmcnt(0)
  s_sub_u32 s46, s74, s72
  s_min_u32 s64, s64, s46
  s_not_b32 s63, s63
  s_not_b32 s64, s64
  v_mov_b32 v2, s63
  v_writelane_b32 v2, s64, 1
  v_mov_b32 v3, 1
  s_mov_b64 exec, 3
  global_atomic_umax v1, v2, s[38:39] offset:128 sc1
  s_waitcnt vmcnt(0)
  s_mov_b64 exec, 1
  global_atomic_add v2, v1, v3, s[38:39] offset:136 sc0 sc1
  s_waitcnt vmcnt(0)
  v_readfirstlane_b32 s46, v2
  s_mov_b64 exec, 3
  s_cmp_lg_u32 s46, 7
  s_cbranch_scc1 pr_done
  global_atomic_umax v2, v1, v3, s[38:39] offset:128 sc0 sc1
  s_waitcnt vmcnt(0)
  v_readlane_b32 s46, v2, 0
  v_readlane_b32 s47, v2, 1
  s_nop 0
  s_cmp_gt_u32 s47, s46
  s_cselect_b32 s46, 0x2001, 1
  v_mov_b32 v2, s46
  s_mov_b64 exec, 1
  global_store_dword v1, v2, s[38:39] offset:4 sc1
pr_done:
  s_mov_b64 exec, -1
pr_skip:
  s_barrier
  v_and_b32 v11, 3, v0
  v_lshlrev_b32 v11, 2, v11
  s_mov_b32 s50, 0
ss_39:
  global_load_dword v10, v11, s[38:39] sc1
  s_add_u32 s50, s50, 1
  s_cmp_gt_u32 s50, 131072
  s_cbranch_scc1 L_fail
  s_waitcnt vmcnt(0)
  v_readlane_b32 s46, v10, 0
  v_readlane_b32 s47, v10, 1
  s_cmp_lg_u32 s46, 0
  s_cselect_b32 s48, 7, 0
  s_add_u32 s46, s46, s2
  s_xor_b32 s49, s46, s43
  s_and_b32 s49, s49, s48
  s_cbranch_scc1 L_reroll
  s_cmp_lg_u32 s47, 0
  s_cbranch_scc1 ss_ok_40
  s_sleep 10
  s_branch ss_39
ss_ok_40:
  v_readlane_b32 s3, v10, 1
  s_nop 0
  s_and_b32 s3, s3, 0x2000
  s_lshl_b32 s46, s43, 7
  s_add_u32 s46, s46, s3
  s_add_u32 s46, s46, 13373440
  v_mov_b32 v14, s46
  s_sub_u32 s48, s44, 26
  s_and_b32 s46, s48, 1
  s_mul_i32 s46, s46, 5
  s_mul_i32 s62, s43, 10
  s_add_u32 s62, s62, s46
  s_lshr_b32 s52, s48, 1
  v_lshlrev_b32 v1, 4, v0
  v_and_b32 v10, 7, v0
  v_lshlrev_b32 v10, 7, v10
  v_add_u32 v10, s51, v10
  v_bfe_u32 v11, v0, 3, 2
  v_lshl_add_u32 v2, v11, 2, v10
  v_add_u32 v3, 1064960, v2
  v_add_u32 v2, 1060864, v2
  v_bfe_u32 v11, v0, 3, 1
  v_lshl_add_u32 v4, v11, 2, v10
  v_add_u32 v4, 1069056, v4
  v_cmp_lt_u32 vcc, 31, v0
  s_nop 1
  v_cndmask_b32 v3, v3, v4, vcc
  s_mul_i32 s46, s43, 6
  s_add_u32 s46, s46, s48
  s_lshl_b32 s46, s46, 7
  s_add_u32 s46, s46, 1073152
  v_mov_b32 v15, s46
  v_mov_b32 v11, 2146435072
  s_cmp_eq_u32 s42, 0
  s_cselect_b64 vcc, 1, 0
  v_cndmask_b32 v15, v11, v15, vcc
  s_mul_i32 s46, s42, 10240
  v_add_u32 v5, s46, v1
  v_add_u32 v6, s51, v1
  s_mul_i32 s63, s52, 40
  s_add_u32 s63, s63, s62
  s_lshl_b32 s63, s63, 16
  s_lshl_b32 s46, s42, 14
  s_add_u32 s63, s63, s46
  s_add_u32 s63, s63, s3
  s_add_u32 s63, s63, 81788928
  s_lshl_b32 s65, s52, 18
  s_add_u32 s65, s65, s3
  s_add_u32 s65, s65, 14680064
  s_lshl_b32 s67, s62, 14
  s_lshl_b32 s46, s42, 11
  s_add_u32 s67, s67, s46
  s_mov_b32 s58, s52
  s_mul_i32 s66, s52, 81920
  v_and_b32 v10, 15, v0
  v_mul_u32_u24 v10, 2560, v10
  v_lshrrev_b32 v11, 4, v0
  v_lshl_add_u32 v10, v11, 3, v10
  s_add_u32 s46, s42, 0
  s_cmp_ge_u32 s46, 5
  s_cselect_b32 s47, 40800, 0
  s_add_u32 s48, s46, s62
  s_lshl_b32 s48, s48, 5
  s_add_u32 s47, s47, s48
  s_add_u32 s47, s47, 1280
  s_cmp_ge_u32 s46, 10
  s_cselect_b32 s47, 2146435072, s47
  v_add_u32 v7, s47, v10
  s_add_u32 s46, s42, 4
  s_cmp_ge_u32 s46, 5
  s_cselect_b32 s47, 40800, 0
  s_add_u32 s48, s46, s62
  s_lshl_b32 s48, s48, 5
  s_add_u32 s47, s47, s48
  s_add_u32 s47, s47, 1280
  s_cmp_ge_u32 s46, 10
  s_cselect_b32 s47, 2146435072, s47
  v_add_u32 v8, s47, v10
  s_add_u32 s46, s42, 8
  s_cmp_ge_u32 s46, 5
  s_cselect_b32 s47, 40800, 0
  s_add_u32 s48, s46, s62
  s_lshl_b32 s48, s48, 5
  s_add_u32 s47, s47, s48
  s_add_u32 s47, s47, 1280
  s_cmp_ge_u32 s46, 10
  s_cselect_b32 s47, 2146435072, s47
  v_add_u32 v9, s47, v10
  v_mov_b32 v224, -1
  v_mov_b32 v225, -1
  v_mov_b32 v226, -1
  v_mov_b32 v227, -1
  s_mov_b32 s54, 0
  s_lshl_b32 s64, s54, 21
  s_mul_i32 s46, s58, 655360
  s_add_u32 s64, s64, s46
  s_add_u32 s64, s64, s3
  s_add_u32 s64, s64, 4194304
  s_lshr_b32 s46, s64, 8
  s_and_b32 s46, s46, 0x2000
  s_xor_b32 s64, s64, s46
  s_add_u32 s64, s64, s67
  s_add_u32 s46, s64, 0
  buffer_store_dwordx4 v[224:227], v1, s[8:11], s46 offen offset:0 sc1
  buffer_store_dwordx4 v[224:227], v1, s[8:11], s46 offen offset:1024 sc1
  s_add_u32 s46, s64, 16384
  buffer_store_dwordx4 v[224:227], v1, s[8:11], s46 offen offset:0 sc1
  buffer_store_dwordx4 v[224:227], v1, s[8:11], s46 offen offset:1024 sc1
  s_add_u32 s46, s64, 32768
  buffer_store_dwordx4 v[224:227], v1, s[8:11], s46 offen offset:0 sc1
  buffer_store_dwordx4 v[224:227], v1, s[8:11], s46 offen offset:1024 sc1
  s_add_u32 s46, s64, 49152
  buffer_store_dwordx4 v[224:227], v1, s[8:11], s46 offen offset:0 sc1
  buffer_store_dwordx4 v[224:227], v1, s[8:11], s46 offen offset:1024 sc1
  s_add_u32 s46, s64, 65536
  buffer_store_dwordx4 v[224:227], v1, s[8:11], s46 offen offset:0 sc1
  buffer_store_dwordx4 v[224:227], v1, s[8:11], s46 offen offset:1024 sc1
  s_mov_b32 s54, 1
  s_lshl_b32 s64, s54, 21
  s_mul_i32 s46, s58, 655360
  s_add_u32 s64, s64, s46
  s_add_u32 s64, s64, s3
  s_add_u32 s64, s64, 4194304
  s_lshr_b32 s46, s64, 8
  s_and_b32 s46, s46, 0x2000
  s_xor_b32 s64, s64, s46
  s_add_u32 s64, s64, s67
  s_add_u32 s46, s64, 0
  buffer_store_dwordx4 v[224:227], v1, s[8:11], s46 offen offset:0 sc1
  buffer_store_dwordx4 v[224:227], v1, s[8:11], s46 offen offset:1024 sc1
  s_add_u32 s46, s64, 16384
  buffer_store_dwordx4 v[224:227], v1, s[8:11], s46 offen offset:0 sc1
  buffer_store_dwordx4 v[224:227], v1, s[8:11], s46 offen offset:1024 sc1
  s_add_u32 s46, s64, 32768
  buffer_store_dwordx4 v[224:227], v1, s[8:11], s46 offen offset:0 sc1
  buffer_store_dwordx4 v[224:227], v1, s[8:11], s46 offen offset:1024 sc1
  s_add_u32 s46, s64, 49152
  buffer_store_dwordx4 v[224:227], v1, s[8:11], s46 offen offset:0 sc1
  buffer_store_dwordx4 v[224:227], v1, s[8:11], s46 offen offset:1024 sc1
  s_add_u32 s46, s64, 65536
  buffer_store_dwordx4 v[224:227], v1, s[8:11], s46 offen offset:0 sc1
  buffer_store_dwordx4 v[224:227], v1, s[8:11], s46 offen offset:1024 sc1
  s_mov_b32 s54, 2
  s_lshl_b32 s64, s54, 21
  s_mul_i32 s46, s58, 655360
  s_add_u32 s64, s64, s46
  s_add_u32 s64, s64, s3
  s_add_u32 s64, s64, 4194304
  s_lshr_b32 s46, s64, 8
  s_and_b32 s46, s46, 0x2000
  s_xor_b32 s64, s64, s46
  s_add_u32 s64, s64, s67
  s_add_u32 s46, s64, 0
  buffer_store_dwordx4 v[224:227], v1, s[8:11], s46 offen offset:0 sc1
  buffer_store_dwordx4 v[224:227], v1, s[8:11], s46 offen offset:1024 sc1
  s_add_u32 s46, s64, 16384
  buffer_store_dwordx4 v[224:227], v1, s[8:11], s46 offen offset:0 sc1
  buffer_store_dwordx4 v[224:227], v1, s[8:11], s46 offen offset:1024 sc1
  s_add_u32 s46, s64, 32768
  buffer_store_dwordx4 v[224:227], v1, s[8:11], s46 offen offset:0 sc1
  buffer_store_dwordx4 v[224:227], v1, s[8:11], s46 offen offset:1024 sc1
  s_add_u32 s46, s64, 49152
  buffer_store_dwordx4 v[224:227], v1, s[8:11], s46 offen offset:0 sc1
  buffer_store_dwordx4 v[224:227], v1, s[8:11], s46 offen offset:1024 sc1
  s_add_u32 s46, s64, 65536
  buffer_store_dwordx4 v[224:227], v1, s[8:11], s46 offen offset:0 sc1
  buffer_store_dwordx4 v[224:227], v1, s[8:11], s46 offen offset:1024 sc1
  v_and_b32 v11, 3, v0
  v_lshlrev_b32 v11, 2, v11
  s_mov_b32 s50, 0
ss_41:
  global_load_dword v10, v11, s[38:39] sc1
  s_add_u32 s50, s50, 1
  s_cmp_gt_u32 s50, 131072
  s_cbranch_scc1 L_fail
  s_waitcnt vmcnt(0)
  v_readlane_b32 s46, v10, 0
  v_readlane_b32 s47, v10, 2
  s_cmp_lg_u32 s46, 0
  s_cselect_b32 s48, 7, 0
  s_add_u32 s46, s46, s2
  s_xor_b32 s49, s46, s43
  s_and_b32 s49, s49, s48
  s_cbranch_scc1 L_reroll
  s_cmp_lg_u32 s47, 0
  s_cbranch_scc1 ss_ok_42
  s_sleep 10
  s_branch ss_41
ss_ok_42:
  v_readlane_b32 s3, v10, 1
  s_nop 0
  s_and_b32 s3, s3, 0x2000
  s_add_u32 s46, s52, 6
  v_mov_b32 v10, s46
  s_waitcnt vmcnt(0)
  s_barrier
  buffer_store_dword v10, v15, s[8:11], 0 offen sc1
  s_mov_b32 s60, 0
  s_mov_b32 s61, 0
  s_mov_b32 s54, 0
  v_lshlrev_b32 v228, 7, v0
  s_mul_i32 s76, s43, 6
  s_add_u32 s76, s76, s44
  s_sub_u32 s76, s76, 26
  s_lshl_b32 s76, s76, 2
  s_add_u32 s76, s76, s42
  s_lshl_b32 s76, s76, 13
  s_mov_b32 s77, 2457600
  s_mov_b32 s78, 819200
xo_loop:
  s_add_u32 s53, s52, 1
  s_cmp_ge_u32 s60, s53
  s_cbranch_scc1 wf_done_43
  s_mov_b32 s50, 0
wf_loop_44:
  buffer_load_dword v10, v2, s[8:11], 0 offen sc1
  s_add_u32 s50, s50, 1
  s_cmp_gt_u32 s50, 131072
  s_cbranch_scc1 L_fail
  s_waitcnt vmcnt(0)
  v_min_u32_dpp v10, v10, v10 row_ror:8 row_mask:0xf bank_mask:0xf
  s_nop 1
  v_min_u32_dpp v10, v10, v10 row_ror:4 row_mask:0xf bank_mask:0xf
  s_nop 1
  v_min_u32_dpp v10, v10, v10 row_ror:2 row_mask:0xf bank_mask:0xf
  s_nop 1
  v_min_u32_dpp v10, v10, v10 row_ror:1 row_mask:0xf bank_mask:0xf
  v_mov_b32 v11, v10
  s_nop 1
  v_permlane16_swap_b32 v11, v10
  v_min_u32 v10, v10, v11
  v_mov_b32 v11, v10
  s_nop 1
  v_permlane32_swap_b32 v11, v10
  v_min_u32 v10, v10, v11
  s_nop 0
  v_readfirstlane_b32 s60, v10
  s_nop 0
  s_cmp_ge_u32 s60, s53
  s_cbranch_scc1 wf_done_43
  s_sleep 2
  s_branch wf_loop_44
wf_done_43:
  s_add_u32 s46, s63, 0
  s_lshr_b32 s47, s46, 8
  s_and_b32 s47, s47, 0x2000
  s_xor_b32 s46, s46, s47
  buffer_load_dwordx4 a[0:3], v1, s[8:11], s46 offen offset:0 sc1
  buffer_load_dwordx4 a[4:7], v1, s[8:11], s46 offen offset:1024 sc1
  buffer_load_dwordx4 a[8:11], v1, s[8:11], s46 offen offset:2048 sc1
  buffer_load_dwordx4 a[12:15], v1, s[8:11], s46 offen offset:3072 sc1
  s_add_u32 s46, s46, 4096
  buffer_load_dwordx4 a[16:19], v1, s[8:11], s46 offen offset:0 sc1
  buffer_load_dwordx4 a[20:23], v1, s[8:11], s46 offen offset:1024 sc1
  buffer_load_dwordx4 a[24:27], v1, s[8:11], s46 offen offset:2048 sc1
  buffer_load_dwordx4 a[28:31], v1, s[8:11], s46 offen offset:3072 sc1
  s_add_u32 s46, s63, 65536
  s_lshr_b32 s47, s46, 8
  s_and_b32 s47, s47, 0x2000
  s_xor_b32 s46, s46, s47
  buffer_load_dwordx4 a[32:35], v1, s[8:11], s46 offen offset:0 sc1
  buffer_load_dwordx4 a[36:39], v1, s[8:11], s46 offen offset:1024 sc1
  buffer_load_dwordx4 a[40:43], v1, s[8:11], s46 offen offset:2048 sc1
  buffer_load_dwordx4 a[44:47], v1, s[8:11], s46 offen offset:3072 sc1
  s_add_u32 s46, s46, 4096
  buffer_load_dwordx4 a[48:51], v1, s[8:11], s46 offen offset:0 sc1
  buffer_load_dwordx4 a[52:55], v1, s[8:11], s46 offen offset:1024 sc1
  buffer_load_dwordx4 a[56:59], v1, s[8:11], s46 offen offset:2048 sc1
  buffer_load_dwordx4 a[60:63], v1, s[8:11], s46 offen offset:3072 sc1
  s_add_u32 s46, s63, 131072
  s_lshr_b32 s47, s46, 8
  s_and_b32 s47, s47, 0x2000
  s_xor_b32 s46, s46, s47
  buffer_load_dwordx4 a[64:67], v1, s[8:11], s46 offen offset:0 sc1
  buffer_load_dwordx4 a[68:71], v1, s[8:11], s46 offen offset:1024 sc1
  buffer_load_dwordx4 a[72:75], v1, s[8:11], s46 offen offset:2048 sc1
  buffer_load_dwordx4 a[76:79], v1, s[8:11], s46 offen offset:3072 sc1
  s_add_u32 s46, s46, 4096
  buffer_load_dwordx4 a[80:83], v1, s[8:11], s46 offen offset:0 sc1
  buffer_load_dwordx4 a[84:87], v1, s[8:11], s46 offen offset:1024 sc1
  buffer_load_dwordx4 a[88:91], v1, s[8:11], s46 offen offset:2048 sc1
  buffer_load_dwordx4 a[92:95], v1, s[8:11], s46 offen offset:3072 sc1
  s_add_u32 s46, s63, 196608
  s_lshr_b32 s47, s46, 8
  s_and_b32 s47, s47, 0x2000
  s_xor_b32 s46, s46, s47
  buffer_load_dwordx4 a[96:99], v1, s[8:11], s46 offen offset:0 sc1
  buffer_load_dwordx4 a[100:103], v1, s[8:11], s46 offen offset:1024 sc1
  buffer_load_dwordx4 a[104:107], v1, s[8:11], s46 offen offset:2048 sc1
  buffer_load_dwordx4 a[108:111], v1, s[8:11], s46 offen offset:3072 sc1
  s_add_u32 s46, s46, 4096
  buffer_load_dwordx4 a[112:115], v1, s[8:11], s46 offen offset:0 sc1
  buffer_load_dwordx4 a[116:119], v1, s[8:11], s46 offen offset:1024 sc1
  buffer_load_dwordx4 a[120:123], v1, s[8:11], s46 offen offset:2048 sc1
  buffer_load_dwordx4 a[124:127], v1, s[8:11], s46 offen offset:3072 sc1
  s_add_u32 s46, s63, 262144
  s_lshr_b32 s47, s46, 8
  s_and_b32 s47, s47, 0x2000
  s_xor_b32 s46, s46, s47
  buffer_load_dwordx4 a[128:131], v1, s[8:11], s46 offen offset:0 sc1
  buffer_load_dwordx4 a[132:135], v1, s[8:11], s46 offen offset:1024 sc1
  buffer_load_dwordx4 a[136:139], v1, s[8:11], s46 offen offset:2048 sc1
  buffer_load_dwordx4 a[140:143], v1, s[8:11], s46 offen offset:3072 sc1
  s_add_u32 s46, s46, 4096
  buffer_load_dwordx4 a[144:147], v1, s[8:11], s46 offen offset:0 sc1
  buffer_load_dwordx4 a[148:151], v1, s[8:11], s46 offen offset:1024 sc1
  buffer_load_dwordx4 a[152:155], v1, s[8:11], s46 offen offset:2048 sc1
  buffer_load_dwordx4 a[156:159], v1, s[8:11], s46 offen offset:3072 sc1
  s_waitcnt vmcnt(24)
  s_add_u32 s53, s52, 2
  s_cmp_ge_u32 s52, 61
  s_cbranch_scc1 xo_last
  s_cmp_lg_u32 s42, 0
  s_cbranch_scc1 xo_go
  s_cmp_ge_u32 s61, s53
  s_cbranch_scc1 wf_done_45
  s_mov_b32 s50, 0
wf_loop_46:
  buffer_load_dword v10, v14, s[8:11], 0 offen sc1
  s_add_u32 s50, s50, 1
  s_cmp_gt_u32 s50, 131072
  s_cbranch_scc1 L_fail
  s_waitcnt vmcnt(0)
  v_readfirstlane_b32 s61, v10
  s_nop 0
  s_cmp_ge_u32 s61, s53
  s_cbranch_scc1 wf_done_45
  s_sleep 2
  s_branch wf_loop_46
wf_done_45:
  s_branch xo_go
xo_last:
  s_mov_b32 s53, 64
  s_mov_b32 s61, 0
  s_cmp_ge_u32 s61, s53
  s_cbranch_scc1 wf_done_47
  s_mov_b32 s50, 0
wf_loop_48:
  buffer_load_dword v10, v3, s[8:11], 0 offen sc1
  s_add_u32 s50, s50, 1
  s_cmp_gt_u32 s50, 131072
  s_cbranch_scc1 L_fail
  s_waitcnt vmcnt(0)
  v_min_u32_dpp v10, v10, v10 row_ror:8 row_mask:0xf bank_mask:0xf
  s_nop 1
  v_min_u32_dpp v10, v10, v10 row_ror:4 row_mask:0xf bank_mask:0xf
  s_nop 1
  v_min_u32_dpp v10, v10, v10 row_ror:2 row_mask:0xf bank_mask:0xf
  s_nop 1
  v_min_u32_dpp v10, v10, v10 row_ror:1 row_mask:0xf bank_mask:0xf
  v_mov_b32 v11, v10
  s_nop 1
  v_permlane16_swap_b32 v11, v10
  v_min_u32 v10, v10, v11
  v_mov_b32 v11, v10
  s_nop 1
  v_permlane32_swap_b32 v11, v10
  v_min_u32 v10, v10, v11
  s_nop 0
  v_readfirstlane_b32 s61, v10
  s_nop 0
  s_cmp_ge_u32 s61, s53
  s_cbranch_scc1 wf_done_47
  s_sleep 2
  s_branch wf_loop_48
wf_done_47:
xo_go:
  s_barrier
  s_lshl_b32 s64, s54, 21
  s_mul_i32 s46, s58, 655360
  s_add_u32 s64, s64, s46
  s_add_u32 s64, s64, s3
  s_add_u32 s64, s64, 4194304
  s_lshr_b32 s46, s64, 8
  s_and_b32 s46, s46, 0x2000
  s_xor_b32 s64, s64, s46
  s_add_u32 s64, s64, s67
  s_mov_b32 s49, s65
  s_lshr_b32 s46, s49, 8
  s_and_b32 s46, s46, 0x2000
  s_xor_b32 s49, s49, s46
  s_lshl_b32 s47, s42, 14
  s_add_u32 s47, s47, s49
  s_lshl_b32 s48, s42, 11
  s_add_u32 s48, s48, s49
  s_add_u32 s46, s47, 0
  buffer_load_dwordx4 v[56:59], v1, s[8:11], s46 offen sc1
  s_add_u32 s46, s47, 81920
  buffer_load_dwordx4 v[60:63], v1, s[8:11], s46 offen sc1
  s_add_u32 s46, s47, 1024
  buffer_load_dwordx4 v[64:67], v1, s[8:11], s46 offen sc1
  s_add_u32 s46, s47, 82944
  buffer_load_dwordx4 v[68:71], v1, s[8:11], s46 offen sc1
  s_add_u32 s46, s47, 2048
  buffer_load_dwordx4 v[72:75], v1, s[8:11], s46 offen sc1
  s_add_u32 s46, s47, 83968
  buffer_load_dwordx4 v[76:79], v1, s[8:11], s46 offen sc1
  s_add_u32 s46, s47, 3072
  buffer_load_dwordx4 v[80:83], v1, s[8:11], s46 offen sc1
  s_add_u32 s46, s47, 84992
  buffer_load_dwordx4 v[84:87], v1, s[8:11], s46 offen sc1
  s_add_u32 s46, s47, 4096
  buffer_load_dwordx4 v[88:91], v1, s[8:11], s46 offen sc1
  s_add_u32 s46, s47, 86016
  buffer_load_dwordx4 v[92:95], v1, s[8:11], s46 offen sc1
  s_add_u32 s46, s47, 5120
  buffer_load_dwordx4 v[96:99], v1, s[8:11], s46 offen sc1
  s_add_u32 s46, s47, 87040
  buffer_load_dwordx4 v[100:103], v1, s[8:11], s46 offen sc1
  s_add_u32 s46, s47, 6144
  buffer_load_dwordx4 v[104:107], v1, s[8:11], s46 offen sc1
  s_add_u32 s46, s47, 88064
  buffer_load_dwordx4 v[108:111], v1, s[8:11], s46 offen sc1
  s_add_u32 s46, s47, 7168
  buffer_load_dwordx4 v[112:115], v1, s[8:11], s46 offen sc1
  s_add_u32 s46, s47, 89088
  buffer_load_dwordx4 v[116:119], v1, s[8:11], s46 offen sc1
  s_add_u32 s46, s48, 65536
  buffer_load_dwordx4 v[120:123], v1, s[8:11], s46 offen sc1
  s_add_u32 s46, s48, 147456
  buffer_load_dwordx4 v[124:127], v1, s[8:11], s46 offen sc1
  s_add_u32 s46, s48, 66560
  buffer_load_dwordx4 v[128:131], v1, s[8:11], s46 offen sc1
  s_add_u32 s46, s48, 148480
  buffer_load_dwordx4 v[132:135], v1, s[8:11], s46 offen sc1
  s_add_u32 s46, s64, 0
  buffer_load_dwordx4 v[16:19], v1, s[8:11], s46 offen offset:0 sc1
  buffer_load_dwordx4 v[20:23], v1, s[8:11], s46 offen offset:1024 sc1
  s_add_u32 s46, s64, 16384
  buffer_load_dwordx4 v[24:27], v1, s[8:11], s46 offen offset:0 sc1
  buffer_load_dwordx4 v[28:31], v1, s[8:11], s46 offen offset:1024 sc1
  s_add_u32 s46, s64, 32768
  buffer_load_dwordx4 v[32:35], v1, s[8:11], s46 offen offset:0 sc1
  buffer_load_dwordx4 v[36:39], v1, s[8:11], s46 offen offset:1024 sc1
  s_add_u32 s46, s64, 49152
  buffer_load_dwordx4 v[40:43], v1, s[8:11], s46 offen offset:0 sc1
  buffer_load_dwordx4 v[44:47], v1, s[8:11], s46 offen offset:1024 sc1
  s_add_u32 s46, s64, 65536
  buffer_load_dwordx4 v[48:51], v1, s[8:11], s46 offen offset:0 sc1
  buffer_load_dwordx4 v[52:55], v1, s[8:11], s46 offen offset:1024 sc1
  s_waitcnt vmcnt(29)
  v_mfma_f32_16x16x32_bf16 v[136:139], a[0:3], v[56:59], 0
  v_mfma_f32_16x16x32_bf16 v[140:143], a[32:35], v[56:59], 0
  v_mfma_f32_16x16x32_bf16 v[144:147], a[64:67], v[56:59], 0
  v_mfma_f32_16x16x32_bf16 v[148:151], a[96:99], v[56:59], 0
  v_mfma_f32_16x16x32_bf16 v[152:155], a[128:131], v[56:59], 0
  s_waitcnt vmcnt(28)
  v_mfma_f32_16x16x32_bf16 v[156:159], a[0:3], v[60:63], 0
  v_mfma_f32_16x16x32_bf16 v[160:163], a[32:35], v[60:63], 0
  v_mfma_f32_16x16x32_bf16 v[164:167], a[64:67], v[60:63], 0
  v_mfma_f32_16x16x32_bf16 v[168:171], a[96:99], v[60:63], 0
  v_mfma_f32_16x16x32_bf16 v[172:175], a[128:131], v[60:63], 0
  s_waitcnt vmcnt(27)
  v_mfma_f32_16x16x32_bf16 v[136:139], a[4:7], v[64:67], v[136:139]
  v_mfma_f32_16x16x32_bf16 v[140:143], a[36:39], v[64:67], v[140:143]
  v_mfma_f32_16x16x32_bf16 v[144:147], a[68:71], v[64:67], v[144:147]
  v_mfma_f32_16x16x32_bf16 v[148:151], a[100:103], v[64:67], v[148:151]
  v_mfma_f32_16x16x32_bf16 v[152:155], a[132:135], v[64:67], v[152:155]
  s_waitcnt vmcnt(26)
  v_mfma_f32_16x16x32_bf16 v[156:159], a[4:7], v[68:71], v[156:159]
  v_mfma_f32_16x16x32_bf16 v[160:163], a[36:39], v[68:71], v[160:163]
  v_mfma_f32_16x16x32_bf16 v[164:167], a[68:71], v[68:71], v[164:167]
  v_mfma_f32_16x16x32_bf16 v[168:171], a[100:103], v[68:71], v[168:171]
  v_mfma_f32_16x16x32_bf16 v[172:175], a[132:135], v[68:71], v[172:175]
  s_waitcnt vmcnt(25)
  v_mfma_f32_16x16x32_bf16 v[136:139], a[8:11], v[72:75], v[136:139]
  v_mfma_f32_16x16x32_bf16 v[140:143], a[40:43], v[72:75], v[140:143]
  v_mfma_f32_16x16x32_bf16 v[144:147], a[72:75], v[72:75], v[144:147]
  v_mfma_f32_16x16x32_bf16 v[148:151], a[104:107], v[72:75], v[148:151]
  v_mfma_f32_16x16x32_bf16 v[152:155], a[136:139], v[72:75], v[152:155]
  s_waitcnt vmcnt(24)
  v_mfma_f32_16x16x32_bf16 v[156:159], a[8:11], v[76:79], v[156:159]
  v_mfma_f32_16x16x32_bf16 v[160:163], a[40:43], v[76:79], v[160:163]
  v_mfma_f32_16x16x32_bf16 v[164:167], a[72:75], v[76:79], v[164:167]
  v_mfma_f32_16x16x32_bf16 v[168:171], a[104:107], v[76:79], v[168:171]
  v_mfma_f32_16x16x32_bf16 v[172:175], a[136:139], v[76:79], v[172:175]
  s_waitcnt vmcnt(23)
  v_mfma_f32_16x16x32_bf16 v[136:139], a[12:15], v[80:83], v[136:139]
  v_mfma_f32_16x16x32_bf16 v[140:143], a[44:47], v[80:83], v[140:143]
  v_mfma_f32_16x16x32_bf16 v[144:147], a[76:79], v[80:83], v[144:147]
  v_mfma_f32_16x16x32_bf16 v[148:151], a[108:111], v[80:83], v[148:151]
  v_mfma_f32_16x16x32_bf16 v[152:155], a[140:143], v[80:83], v[152:155]
  s_waitcnt vmcnt(22)
  v_mfma_f32_16x16x32_bf16 v[156:159], a[12:15], v[84:87], v[156:159]
  v_mfma_f32_16x16x32_bf16 v[160:163], a[44:47], v[84:87], v[160:163]
  v_mfma_f32_16x16x32_bf16 v[164:167], a[76:79], v[84:87], v[164:167]
  v_mfma_f32_16x16x32_bf16 v[168:171], a[108:111], v[84:87], v[168:171]
  v_mfma_f32_16x16x32_bf16 v[172:175], a[140:143], v[84:87], v[172:175]
  s_waitcnt vmcnt(21)
  v_mfma_f32_16x16x32_bf16 v[136:139], a[16:19], v[88:91], v[136:139]
  v_mfma_f32_16x16x32_bf16 v[140:143], a[48:51], v[88:91], v[140:143]
  v_mfma_f32_16x16x32_bf16 v[144:147], a[80:83], v[88:91], v[144:147]
  v_mfma_f32_16x16x32_bf16 v[148:151], a[112:115], v[88:91], v[148:151]
  v_mfma_f32_16x16x32_bf16 v[152:155], a[144:147], v[88:91], v[152:155]
  s_waitcnt vmcnt(20)
  v_mfma_f32_16x16x32_bf16 v[156:159], a[16:19], v[92:95], v[156:159]
  v_mfma_f32_16x16x32_bf16 v[160:163], a[48:51], v[92:95], v[160:163]
  v_mfma_f32_16x16x32_bf16 v[164:167], a[80:83], v[92:95], v[164:167]
  v_mfma_f32_16x16x32_bf16 v[168:171], a[112:115], v[92:95], v[168:171]
  v_mfma_f32_16x16x32_bf16 v[172:175], a[144:147], v[92:95], v[172:175]
  s_waitcnt vmcnt(19)
  v_mfma_f32_16x16x32_bf16 v[136:139], a[20:23], v[96:99], v[136:139]
  v_mfma_f32_16x16x32_bf16 v[140:143], a[52:55], v[96:99], v[140:143]
  v_mfma_f32_16x16x32_bf16 v[144:147], a[84:87], v[96:99], v[144:147]
  v_mfma_f32_16x16x32_bf16 v[148:151], a[116:119], v[96:99], v[148:151]
  v_mfma_f32_16x16x32_bf16 v[152:155], a[148:151], v[96:99], v[152:155]
  s_waitcnt vmcnt(18)
  v_mfma_f32_16x16x32_bf16 v[156:159], a[20:23], v[100:103], v[156:159]
  v_mfma_f32_16x16x32_bf16 v[160:163], a[52:55], v[100:103], v[160:163]
  v_mfma_f32_16x16x32_bf16 v[164:167], a[84:87], v[100:103], v[164:167]
  v_mfma_f32_16x16x32_bf16 v[168:171], a[116:119], v[100:103], v[168:171]
  v_mfma_f32_16x16x32_bf16 v[172:175], a[148:151], v[100:103], v[172:175]
  s_waitcnt vmcnt(17)
  v_mfma_f32_16x16x32_bf16 v[136:139], a[24:27], v[104:107], v[136:139]
  v_mfma_f32_16x16x32_bf16 v[140:143], a[56:59], v[104:107], v[140:143]
  v_mfma_f32_16x16x32_bf16 v[144:147], a[88:91], v[104:107], v[144:147]
  v_mfma_f32_16x16x32_bf16 v[148:151], a[120:123], v[104:107], v[148:151]
  v_mfma_f32_16x16x32_bf16 v[152:155], a[152:155], v[104:107], v[152:155]
  s_waitcnt vmcnt(16)
  v_mfma_f32_16x16x32_bf16 v[156:159], a[24:27], v[108:111], v[156:159]
  v_mfma_f32_16x16x32_bf16 v[160:163], a[56:59], v[108:111], v[160:163]
  v_mfma_f32_16x16x32_bf16 v[164:167], a[88:91], v[108:111], v[164:167]
  v_mfma_f32_16x16x32_bf16 v[168:171], a[120:123], v[108:111], v[168:171]
  v_mfma_f32_16x16x32_bf16 v[172:175], a[152:155], v[108:111], v[172:175]
  s_waitcnt vmcnt(15)
  v_mfma_f32_16x16x32_bf16 v[136:139], a[28:31], v[112:115], v[136:139]
  v_mfma_f32_16x16x32_bf16 v[140:143], a[60:63], v[112:115], v[140:143]
  v_mfma_f32_16x16x32_bf16 v[144:147], a[92:95], v[112:115], v[144:147]
  v_mfma_f32_16x16x32_bf16 v[148:151], a[124:127], v[112:115], v[148:151]
  v_mfma_f32_16x16x32_bf16 v[152:155], a[156:159], v[112:115], v[152:155]
  s_waitcnt vmcnt(14)
  v_mfma_f32_16x16x32_bf16 v[156:159], a[28:31], v[116:119], v[156:159]
  v_mfma_f32_16x16x32_bf16 v[160:163], a[60:63], v[116:119], v[160:163]
  v_mfma_f32_16x16x32_bf16 v[164:167], a[92:95], v[116:119], v[164:167]
  v_mfma_f32_16x16x32_bf16 v[168:171], a[124:127], v[116:119], v[168:171]
  v_mfma_f32_16x16x32_bf16 v[172:175], a[156:159], v[116:119], v[172:175]
  s_waitcnt vmcnt(8)
  v_mfma_f32_16x16x32_bf16 v[136:139], v[16:19], v[120:123], v[136:139]
  v_mfma_f32_16x16x32_bf16 v[156:159], v[16:19], v[124:127], v[156:159]
  v_mfma_f32_16x16x32_bf16 v[136:139], v[20:23], v[128:131], v[136:139]
  v_mfma_f32_16x16x32_bf16 v[156:159], v[20:23], v[132:135], v[156:159]
  s_waitcnt vmcnt(6)
  v_mfma_f32_16x16x32_bf16 v[140:143], v[24:27], v[120:123], v[140:143]
  v_mfma_f32_16x16x32_bf16 v[160:163], v[24:27], v[124:127], v[160:163]
  v_mfma_f32_16x16x32_bf16 v[140:143], v[28:31], v[128:131], v[140:143]
  v_mfma_f32_16x16x32_bf16 v[160:163], v[28:31], v[132:135], v[160:163]
  s_waitcnt vmcnt(4)
  v_mfma_f32_16x16x32_bf16 v[144:147], v[32:35], v[120:123], v[144:147]
  v_mfma_f32_16x16x32_bf16 v[164:167], v[32:35], v[124:127], v[164:167]
  v_mfma_f32_16x16x32_bf16 v[144:147], v[36:39], v[128:131], v[144:147]
  v_mfma_f32_16x16x32_bf16 v[164:167], v[36:39], v[132:135], v[164:167]
  s_waitcnt vmcnt(2)
  v_mfma_f32_16x16x32_bf16 v[148:151], v[40:43], v[120:123], v[148:151]
  v_mfma_f32_16x16x32_bf16 v[168:171], v[40:43], v[124:127], v[168:171]
  v_mfma_f32_16x16x32_bf16 v[148:151], v[44:47], v[128:131], v[148:151]
  v_mfma_f32_16x16x32_bf16 v[168:171], v[44:47], v[132:135], v[168:171]
  s_waitcnt vmcnt(0)
  v_mfma_f32_16x16x32_bf16 v[152:155], v[48:51], v[120:123], v[152:155]
  v_mfma_f32_16x16x32_bf16 v[172:175], v[48:51], v[124:127], v[172:175]
  v_mfma_f32_16x16x32_bf16 v[152:155], v[52:55], v[128:131], v[152:155]
  v_mfma_f32_16x16x32_bf16 v[172:175], v[52:55], v[132:135], v[172:175]
  s_add_u32 s46, s64, 0
  buffer_store_dwordx4 v[224:227], v1, s[8:11], s46 offen offset:0 sc1
  buffer_store_dwordx4 v[224:227], v1, s[8:11], s46 offen offset:1024 sc1
  s_add_u32 s46, s64, 16384
  buffer_store_dwordx4 v[224:227], v1, s[8:11], s46 offen offset:0 sc1
  buffer_store_dwordx4 v[224:227], v1, s[8:11], s46 offen offset:1024 sc1
  s_add_u32 s46, s64, 32768
  buffer_store_dwordx4 v[224:227], v1, s[8:11], s46 offen offset:0 sc1
  buffer_store_dwordx4 v[224:227], v1, s[8:11], s46 offen offset:1024 sc1
  s_add_u32 s46, s64, 49152
  buffer_store_dwordx4 v[224:227], v1, s[8:11], s46 offen offset:0 sc1
  buffer_store_dwordx4 v[224:227], v1, s[8:11], s46 offen offset:1024 sc1
  s_add_u32 s46, s64, 65536
  buffer_store_dwordx4 v[224:227], v1, s[8:11], s46 offen offset:0 sc1
  buffer_store_dwordx4 v[224:227], v1, s[8:11], s46 offen offset:1024 sc1
  ds_write_b128 v5, v[136:139] offset:0
  ds_write_b128 v5, v[140:143] offset:1024
  ds_write_b128 v5, v[144:147] offset:2048
  ds_write_b128 v5, v[148:151] offset:3072
  ds_write_b128 v5, v[152:155] offset:4096
  ds_write_b128 v5, v[156:159] offset:5120
  ds_write_b128 v5, v[160:163] offset:6144
  ds_write_b128 v5, v[164:167] offset:7168
  ds_write_b128 v5, v[168:171] offset:8192
  ds_write_b128 v5, v[172:175] offset:9216
  s_waitcnt lgkmcnt(0)
  s_barrier
  ds_read_b128 v[176:179], v6 offset:0
  ds_read_b128 v[180:183], v6 offset:10240
  ds_read_b128 v[184:187], v6 offset:20480
  ds_read_b128 v[188:191], v6 offset:30720
  ds_read_b128 v[192:195], v6 offset:4096
  ds_read_b128 v[196:199], v6 offset:14336
  ds_read_b128 v[200:203], v6 offset:24576
  ds_read_b128 v[204:207], v6 offset:34816
  ds_read_b128 v[208:211], v6 offset:8192
  ds_read_b128 v[212:215], v6 offset:18432
  ds_read_b128 v[216:219], v6 offset:28672
  ds_read_b128 v[220:223], v6 offset:38912
  s_waitcnt lgkmcnt(8)
  v_add_f32 v176, v176, v180
  v_add_f32 v184, v184, v188
  v_add_f32 v176, v176, v184
  v_add_f32 v177, v177, v181
  v_add_f32 v185, v185, v189
  v_add_f32 v177, v177, v185
  v_add_f32 v178, v178, v182
  v_add_f32 v186, v186, v190
  v_add_f32 v178, v178, v186
  v_add_f32 v179, v179, v183
  v_add_f32 v187, v187, v191
  v_add_f32 v179, v179, v187
  v_cvt_pk_bf16_f32 v176, v176, v177
  v_cvt_pk_bf16_f32 v177, v178, v179
  buffer_store_dwordx2 v[176:177], v7, s[12:15], s66 offen
  s_waitcnt lgkmcnt(4)
  v_add_f32 v192, v192, v196
  v_add_f32 v200, v200, v204
  v_add_f32 v192, v192, v200
  v_add_f32 v193, v193, v197
  v_add_f32 v201, v201, v205
  v_add_f32 v193, v193, v201
  v_add_f32 v194, v194, v198
  v_add_f32 v202, v202, v206
  v_add_f32 v194, v194, v202
  v_add_f32 v195, v195, v199
  v_add_f32 v203, v203, v207
  v_add_f32 v195, v195, v203
  v_cvt_pk_bf16_f32 v192, v192, v193
  v_cvt_pk_bf16_f32 v193, v194, v195
  buffer_store_dwordx2 v[192:193], v8, s[12:15], s66 offen
  s_waitcnt lgkmcnt(0)
  v_add_f32 v208, v208, v212
  v_add_f32 v216, v216, v220
  v_add_f32 v208, v208, v216
  v_add_f32 v209, v209, v213
  v_add_f32 v217, v217, v221
  v_add_f32 v209, v209, v217
  v_add_f32 v210, v210, v214
  v_add_f32 v218, v218, v222
  v_add_f32 v210, v210, v218
  v_add_f32 v211, v211, v215
  v_add_f32 v219, v219, v223
  v_add_f32 v211, v211, v219
  v_cvt_pk_bf16_f32 v208, v208, v209
  v_cvt_pk_bf16_f32 v209, v210, v211
  buffer_store_dwordx2 v[208:209], v9, s[12:15], s66 offen
  s_add_u32 s46, s52, 9
  v_mov_b32 v10, s46
  s_waitcnt vmcnt(0)
  s_barrier
  buffer_store_dword v10, v15, s[8:11], 0 offen sc1
  s_add_u32 s54, s54, 1
  s_cmp_eq_u32 s54, 3
  s_cselect_b32 s54, 0, s54
  s_add_u32 s63, s63, 7864320
  s_cmp_ge_u32 s63, 165675008
  s_cselect_b32 s46, 83886080, 0
  s_sub_u32 s63, s63, s46
  s_add_u32 s65, s65, 786432
  s_cmp_ge_u32 s65, 16777216
  s_cselect_b32 s46, 2097152, 0
  s_sub_u32 s65, s65, s46
  s_add_u32 s66, s66, 245760
  s_add_u32 s52, s52, 3
  s_cmp_lt_u32 s52, 64
  s_cbranch_scc1 xo_loop
  s_endpgm
L_end:
  s_endpgm
L_fail:
  s_mov_b32 s4, s38
  s_mov_b32 s5, s39
  s_mov_b32 s6, 256
  s_mov_b32 s7, 0x20000
  s_lshl_b32 s46, s43, 8
  s_or_b32 s46, s46, s44
  s_or_b32 s46, s46, 0x10000
  v_mov_b32 v1, 32
  v_mov_b32 v2, s46
  s_mov_b64 exec, 1
  buffer_store_dword v2, v1, s[4:7], 0 offen sc1
  s_waitcnt vmcnt(0)
  s_endpgm
.section .rodata,"a"
.p2align 6
.amdhsa_kernel concat_heads__sliding_local_dilated__memory_aug_recurrent_mem_tr__prompt_kernel
  .amdhsa_next_free_vgpr 512
  .amdhsa_next_free_sgpr 102
  .amdhsa_accum_offset 256
  .amdhsa_group_segment_fixed_size 0
  .amdhsa_kernarg_size 104
  .amdhsa_user_sgpr_count 2
  .amdhsa_user_sgpr_kernarg_segment_ptr 1
  .amdhsa_system_sgpr_workgroup_id_x 1
.end_amdhsa_kernel
```

```asm
; @launch grid=(256,1,1) block=(256,1,1) lds=163840
.amdgcn_target "amdgcn-amd-amdhsa--gfx950"
.text
.globl concat_heads__sliding_local_dilated__memory_aug_recurrent_mem_tr__prompt_kernel
.p2align 8
.type concat_heads__sliding_local_dilated__memory_aug_recurrent_mem_tr__prompt_kernel,@function
concat_heads__sliding_local_dilated__memory_aug_recurrent_mem_tr__prompt_kernel:
  s_cmp_ge_u32 s2, 256
  s_cbranch_scc1 L_end
  v_lshrrev_b32 v1, 6, v0
  v_and_b32 v0, 63, v0
  v_readfirstlane_b32 s42, v1
  s_getreg_b32 s46, hwreg(HW_REG_XCC_ID)
  s_lshr_b32 s44, s2, 3
  s_lshl_b32 s51, s42, 10
  s_mov_b32 s3, 0
  s_mov_b32 s50, -1
L_reroll:
  s_load_dwordx16 s[16:31], s[0:1], 0
  s_load_dwordx8 s[32:39], s[0:1], 64
  s_load_dwordx2 s[40:41], s[0:1], 96
  s_and_b32 s43, s46, 7
  s_and_b32 s46, s44, 7
  s_lshl_b32 s46, s46, 2
  s_and_b32 s47, s43, 3
  s_add_u32 s45, s46, s47
  s_waitcnt lgkmcnt(0)
  s_add_u32 s8, s40, 0x1fffff
  s_addc_u32 s9, s41, 0
  s_and_b32 s8, s8, 0xffe00000
  s_mov_b32 s10, 266338304
  s_mov_b32 s11, 0x20000
  s_mov_b32 s4, s38
  s_mov_b32 s5, s39
  s_mov_b32 s6, 256
  s_mov_b32 s7, 0x20000
  s_mov_b32 s12, s22
  s_mov_b32 s13, s23
  s_mov_b32 s14, 2621440
  s_mov_b32 s15, 0x20000
  s_or_b32 s46, s2, s42
  s_cbranch_scc1 L_norot
  v_mov_b32 v1, 0
  s_or_b32 s46, s43, 8
  v_mov_b32 v2, s46
  buffer_store_dword v2, v1, s[4:7], 0 offen sc1
L_norot:
  s_cmp_lg_u32 s50, -1
  s_cbranch_scc1 pr_skip
  s_lshr_b32 s46, s2, 4
  s_cmp_lg_u32 s46, 13
  s_cbranch_scc1 pr_skip
  s_cmp_lg_u32 s42, 0
  s_cbranch_scc1 pr_skip
  v_lshlrev_b32 v1, 2, v0
  s_mov_b32 s66, 0x10000
  s_cmp_ge_u32 s43, 4
  s_cbranch_scc1 pr_report
  s_lshl_b32 s62, s43, 14
  s_and_b32 s46, s44, 1
  s_lshl_b32 s46, s46, 12
  s_add_u32 s62, s62, s46
  s_add_u32 s62, s62, 6160384
  s_add_u32 s65, s62, 8192
  buffer_store_dword v1, v1, s[8:11], s62 offen sc1
  buffer_store_dword v1, v1, s[8:11], s65 offen sc1
  s_mov_b32 s63, -1
  s_mov_b32 s64, -1
  s_waitcnt vmcnt(0)
  s_memtime s[72:73]
  s_waitcnt lgkmcnt(0)
  buffer_store_dword v1, v1, s[8:11], s62 offen sc1
  s_waitcnt vmcnt(0)
  s_memtime s[74:75]
  s_waitcnt lgkmcnt(0)
  s_sub_u32 s46, s74, s72
  s_min_u32 s63, s63, s46
  s_memtime s[72:73]
  s_waitcnt lgkmcnt(0)
  buffer_store_dword v1, v1, s[8:11], s65 offen sc1
  s_waitcnt vmcnt(0)
  s_memtime s[74:75]
  s_waitcnt lgkmcnt(0)
  s_sub_u32 s46, s74, s72
  s_min_u32 s64, s64, s46
  s_memtime s[72:73]
  s_waitcnt lgkmcnt(0)
  buffer_store_dword v1, v1, s[8:11], s62 offen sc1
  s_waitcnt vmcnt(0)
  s_memtime s[74:75]
  s_waitcnt lgkmcnt(0)
  s_sub_u32 s46, s74, s72
  s_min_u32 s63, s63, s46
  s_memtime s[72:73]
  s_waitcnt lgkmcnt(0)
  buffer_store_dword v1, v1, s[8:11], s65 offen sc1
  s_waitcnt vmcnt(0)
  s_memtime s[74:75]
  s_waitcnt lgkmcnt(0)
  s_sub_u32 s46, s74, s72
  s_min_u32 s64, s64, s46
  s_memtime s[72:73]
  s_waitcnt lgkmcnt(0)
  buffer_store_dword v1, v1, s[8:11], s62 offen sc1
  s_waitcnt vmcnt(0)
  s_memtime s[74:75]
  s_waitcnt lgkmcnt(0)
  s_sub_u32 s46, s74, s72
  s_min_u32 s63, s63, s46
  s_memtime s[72:73]
  s_waitcnt lgkmcnt(0)
  buffer_store_dword v1, v1, s[8:11], s65 offen sc1
  s_waitcnt vmcnt(0)
  s_memtime s[74:75]
  s_waitcnt lgkmcnt(0)
  s_sub_u32 s46, s74, s72
  s_min_u32 s64, s64, s46
  s_cmp_lt_u32 s64, s63
  s_cselect_b32 s46, 0x100, 1
  s_add_u32 s66, s66, s46
pr_report:
  v_mov_b32 v3, s66
  s_mov_b64 exec, 1
  global_atomic_add v2, v1, v3, s[38:39] offset:128 sc0 sc1
  s_waitcnt vmcnt(0)
  v_readfirstlane_b32 s46, v2
  s_nop 0
  s_add_u32 s46, s46, s66
  s_cmp_lt_u32 s46, 0x100000
  s_cbranch_scc1 pr_done
  s_bfe_u32 s47, s46, 0x80008
  s_and_b32 s46, s46, 0xff
  s_cmp_gt_u32 s47, s46
  s_cselect_b32 s46, 0x2001, 1
  v_mov_b32 v2, s46
  global_store_dword v1, v2, s[38:39] offset:4 sc1
pr_done:
  s_mov_b64 exec, -1
pr_skip:
  s_cmp_lt_u32 s43, 4
  s_cbranch_scc1 L_recur
  s_cmp_ge_u32 s44, 24
  s_cbranch_scc1 L_uw
  s_lshr_b32 s48, s44, 3
  s_cmp_eq_u32 s48, 0
  s_cselect_b32 s4, s26, s28
  s_cselect_b32 s5, s27, s29
  s_cmp_eq_u32 s48, 2
  s_cselect_b32 s4, s30, s4
  s_cselect_b32 s5, s31, s5
  s_mov_b32 s6, 7864320
  s_mul_i32 s60, s45, 384
  s_mov_b32 s61, 0
  s_mov_b32 s62, 64
  s_cselect_b32 s63, 136314880, 0
  s_add_u32 s63, s63, 31457280
  s_cmp_lg_u32 s48, 1
  s_cselect_b32 s46, 0x2000, 0
  s_add_u32 s63, s63, s46
  s_mov_b32 s67, s45
  s_lshl_b32 s64, s48, 5
  s_add_u32 s64, s64, s45
  s_lshl_b32 s64, s64, 7
  s_add_u32 s64, s64, 1048576
  v_lshrrev_b32 v10, 3, v0
  v_lshrrev_b32 v11, 2, v10
  v_lshlrev_b32 v11, 3, v11
  v_and_b32 v1, 3, v10
  v_add_u32 v1, v1, v11
  s_and_b32 s46, s42, 1
  s_lshl_b32 s46, s46, 2
  s_lshr_b32 s47, s42, 1
  s_lshl_b32 s47, s47, 4
  s_add_u32 s46, s46, s47
  v_add_u32 v1, s46, v1
  v_mul_u32_u24 v1, 12288, v1
  v_lshrrev_b32 v10, 1, v10
  v_bfe_u32 v11, v0, 1, 2
  v_xor_b32 v10, v10, v11
  v_lshlrev_b32 v10, 5, v10
  v_and_b32 v11, 1, v0
  v_lshlrev_b32 v11, 4, v11
  v_add3_u32 v1, v1, v10, v11
  v_lshrrev_b32 v10, 5, v0
  v_lshlrev_b32 v2, 11, v10
  v_bfe_u32 v10, v0, 2, 3
  v_lshl_add_u32 v2, v10, 7, v2
  v_lshrrev_b32 v10, 1, v10
  v_xor_b32 v10, s42, v10
  v_lshl_add_u32 v2, v10, 5, v2
  v_and_b32 v10, 3, v0
  v_lshl_add_u32 v2, v10, 3, v2
  v_add_u32 v3, 0x10000, v2
  v_add_u32 v4, 0x20000, v2
  v_lshrrev_b32 v10, 3, v0
  s_lshl_b32 s46, s42, 3
  v_add_u32 v10, s46, v10
  v_mul_u32_u24 v5, 1280, v10
  v_bfe_u32 v10, v10, 1, 3
  v_and_b32 v11, 7, v0
  v_xor_b32 v10, v10, v11
  v_lshl_add_u32 v5, v10, 4, v5
  v_and_b32 v10, 15, v0
  v_lshlrev_b32 v6, 7, v10
  v_lshrrev_b32 v10, 1, v10
  v_lshrrev_b32 v11, 4, v0
  v_xor_b32 v10, v10, v11
  v_lshl_add_u32 v6, v10, 4, v6
  v_add_u32 v6, 122880, v6
  v_xor_b32 v7, 64, v6
  v_and_b32 v10, 15, v0
  v_lshlrev_b32 v8, 4, v10
  v_bfe_u32 v10, v0, 4, 1
  v_lshlrev_b32 v10, 11, v10
  v_lshrrev_b32 v11, 5, v0
  v_lshlrev_b32 v11, 8, v11
  v_add3_u32 v8, v8, v10, v11
  s_lshl_b32 s46, s42, 9
  v_add_u32 v8, s46, v8
  v_mov_b32 v9, s64
  v_mov_b32 v10, 2146435072
  s_cmp_eq_u32 s42, 0
  s_cselect_b64 vcc, 1, 0
  v_cndmask_b32 v9, v10, v9, vcc
  s_lshl_b32 s46, s43, 7
  s_add_u32 s46, s46, 1076736
  v_mov_b32 v14, s46
  s_mov_b32 s68, 0
  s_lshr_b32 s70, s44, 5
  s_add_u32 s70, s70, 60
  s_mov_b32 s52, s61
  s_mul_i32 s53, s52, 40960
  s_add_u32 s54, s51, 122880
  s_add_u32 m0, s54, 0
  s_nop 0
  buffer_load_dwordx4 v5, s[12:15], s53 offen offset:0 lds
  s_add_u32 m0, s54, 3968
  s_nop 0
  buffer_load_dwordx4 v5, s[12:15], s53 offen offset:128 lds
  s_add_u32 m0, s54, 7936
  s_nop 0
  buffer_load_dwordx4 v5, s[12:15], s53 offen offset:256 lds
  s_add_u32 m0, s54, 11904
  s_nop 0
  buffer_load_dwordx4 v5, s[12:15], s53 offen offset:384 lds
  s_add_u32 m0, s54, 15872
  s_nop 0
  buffer_load_dwordx4 v5, s[12:15], s53 offen offset:512 lds
  s_add_u32 m0, s54, 19840
  s_nop 0
  buffer_load_dwordx4 v5, s[12:15], s53 offen offset:640 lds
  s_add_u32 m0, s54, 23808
  s_nop 0
  buffer_load_dwordx4 v5, s[12:15], s53 offen offset:768 lds
  s_add_u32 m0, s54, 27776
  s_nop 0
  buffer_load_dwordx4 v5, s[12:15], s53 offen offset:896 lds
  s_add_u32 m0, s54, 31744
  s_nop 0
  buffer_load_dwordx4 v5, s[12:15], s53 offen offset:1024 lds
  s_add_u32 m0, s54, 35712
  s_nop 0
  buffer_load_dwordx4 v5, s[12:15], s53 offen offset:1152 lds
  s_add_u32 m0, s51, 0
  s_add_u32 s46, s60, 0
  buffer_load_dwordx4 v1, s[4:7], s46 offen  lds
  s_add_u32 m0, s51, 4096
  s_add_u32 s46, s60, 128
  buffer_load_dwordx4 v1, s[4:7], s46 offen  lds
  s_add_u32 m0, s51, 8192
  s_add_u32 s46, s60, 256
  buffer_load_dwordx4 v1, s[4:7], s46 offen  lds
  s_add_u32 m0, s51, 12288
  s_add_u32 s46, s60, 393216
  buffer_load_dwordx4 v1, s[4:7], s46 offen  lds
  s_add_u32 m0, s51, 16384
  s_add_u32 s46, s60, 393344
  buffer_load_dwordx4 v1, s[4:7], s46 offen  lds
  s_add_u32 m0, s51, 20480
  s_add_u32 s46, s60, 393472
  buffer_load_dwordx4 v1, s[4:7], s46 offen  lds
  s_add_u32 m0, s51, 24576
  s_add_u32 s46, s60, 786432
  buffer_load_dwordx4 v1, s[4:7], s46 offen  lds
  s_add_u32 m0, s51, 28672
  s_add_u32 s46, s60, 786560
  buffer_load_dwordx4 v1, s[4:7], s46 offen  lds
  s_add_u32 m0, s51, 32768
  s_add_u32 s46, s60, 786688
  buffer_load_dwordx4 v1, s[4:7], s46 offen  lds
  s_add_u32 m0, s51, 36864
  s_add_u32 s46, s60, 1179648
  buffer_load_dwordx4 v1, s[4:7], s46 offen  lds
  s_add_u32 m0, s51, 40960
  s_add_u32 s46, s60, 1179776
  buffer_load_dwordx4 v1, s[4:7], s46 offen  lds
  s_add_u32 m0, s51, 45056
  s_add_u32 s46, s60, 1179904
  buffer_load_dwordx4 v1, s[4:7], s46 offen  lds
  s_add_u32 m0, s51, 49152
  s_add_u32 s46, s60, 1572864
  buffer_load_dwordx4 v1, s[4:7], s46 offen  lds
  s_add_u32 m0, s51, 53248
  s_add_u32 s46, s60, 1572992
  buffer_load_dwordx4 v1, s[4:7], s46 offen  lds
  s_add_u32 m0, s51, 57344
  s_add_u32 s46, s60, 1573120
  buffer_load_dwordx4 v1, s[4:7], s46 offen  lds
  s_add_u32 m0, s51, 61440
  s_add_u32 s46, s60, 1966080
  buffer_load_dwordx4 v1, s[4:7], s46 offen  lds
  s_add_u32 m0, s51, 65536
  s_add_u32 s46, s60, 1966208
  buffer_load_dwordx4 v1, s[4:7], s46 offen  lds
  s_add_u32 m0, s51, 69632
  s_add_u32 s46, s60, 1966336
  buffer_load_dwordx4 v1, s[4:7], s46 offen  lds
  s_add_u32 m0, s51, 73728
  s_add_u32 s46, s60, 2359296
  buffer_load_dwordx4 v1, s[4:7], s46 offen  lds
  s_add_u32 m0, s51, 77824
  s_add_u32 s46, s60, 2359424
  buffer_load_dwordx4 v1, s[4:7], s46 offen  lds
  s_add_u32 m0, s51, 81920
  s_add_u32 s46, s60, 2359552
  buffer_load_dwordx4 v1, s[4:7], s46 offen  lds
  s_add_u32 m0, s51, 86016
  s_add_u32 s46, s60, 2752512
  buffer_load_dwordx4 v1, s[4:7], s46 offen  lds
  s_add_u32 m0, s51, 90112
  s_add_u32 s46, s60, 2752640
  buffer_load_dwordx4 v1, s[4:7], s46 offen  lds
  s_add_u32 m0, s51, 94208
  s_add_u32 s46, s60, 2752768
  buffer_load_dwordx4 v1, s[4:7], s46 offen  lds
  s_waitcnt vmcnt(18)
  s_barrier
  s_add_u32 m0, s51, 98304
  s_add_u32 s46, s60, 3145728
  buffer_load_dwordx4 v1, s[4:7], s46 offen  lds
  s_add_u32 m0, s51, 102400
  s_add_u32 s46, s60, 3145856
  buffer_load_dwordx4 v1, s[4:7], s46 offen  lds
  s_add_u32 m0, s51, 106496
  s_add_u32 s46, s60, 3145984
  buffer_load_dwordx4 v1, s[4:7], s46 offen  lds
  s_add_u32 m0, s51, 110592
  s_add_u32 s46, s60, 3538944
  buffer_load_dwordx4 v1, s[4:7], s46 offen  lds
  s_add_u32 m0, s51, 114688
  s_add_u32 s46, s60, 3539072
  buffer_load_dwordx4 v1, s[4:7], s46 offen  lds
  s_add_u32 m0, s51, 118784
  s_add_u32 s46, s60, 3539200
  buffer_load_dwordx4 v1, s[4:7], s46 offen  lds
  ds_read_b64_tr_b16 a[0:1], v2 offset:0
  ds_read_b64_tr_b16 a[2:3], v2 offset:1024
  ds_read_b64_tr_b16 a[4:5], v2 offset:4096
  ds_read_b64_tr_b16 a[6:7], v2 offset:5120
  ds_read_b64_tr_b16 a[8:9], v2 offset:8192
  ds_read_b64_tr_b16 a[10:11], v2 offset:9216
  ds_read_b64_tr_b16 a[12:13], v2 offset:12288
  ds_read_b64_tr_b16 a[14:15], v2 offset:13312
  ds_read_b64_tr_b16 a[16:17], v2 offset:16384
  ds_read_b64_tr_b16 a[18:19], v2 offset:17408
  ds_read_b64_tr_b16 a[20:21], v2 offset:20480
  ds_read_b64_tr_b16 a[22:23], v2 offset:21504
  s_waitcnt lgkmcnt(0)
  s_waitcnt vmcnt(18)
  s_barrier
  s_add_u32 m0, s51, 0
  s_add_u32 s46, s60, 3932160
  buffer_load_dwordx4 v1, s[4:7], s46 offen  lds
  s_add_u32 m0, s51, 4096
  s_add_u32 s46, s60, 3932288
  buffer_load_dwordx4 v1, s[4:7], s46 offen  lds
  s_add_u32 m0, s51, 8192
  s_add_u32 s46, s60, 3932416
  buffer_load_dwordx4 v1, s[4:7], s46 offen  lds
  s_add_u32 m0, s51, 12288
  s_add_u32 s46, s60, 4325376
  buffer_load_dwordx4 v1, s[4:7], s46 offen  lds
  s_add_u32 m0, s51, 16384
  s_add_u32 s46, s60, 4325504
  buffer_load_dwordx4 v1, s[4:7], s46 offen  lds
  s_add_u32 m0, s51, 20480
  s_add_u32 s46, s60, 4325632
  buffer_load_dwordx4 v1, s[4:7], s46 offen  lds
  ds_read_b64_tr_b16 a[24:25], v2 offset:24576
  ds_read_b64_tr_b16 a[26:27], v2 offset:25600
  ds_read_b64_tr_b16 a[28:29], v2 offset:28672
  ds_read_b64_tr_b16 a[30:31], v2 offset:29696
  ds_read_b64_tr_b16 a[32:33], v2 offset:32768
  ds_read_b64_tr_b16 a[34:35], v2 offset:33792
  ds_read_b64_tr_b16 a[36:37], v2 offset:36864
  ds_read_b64_tr_b16 a[38:39], v2 offset:37888
  ds_read_b64_tr_b16 a[40:41], v2 offset:40960
  ds_read_b64_tr_b16 a[42:43], v2 offset:41984
  ds_read_b64_tr_b16 a[44:45], v2 offset:45056
  ds_read_b64_tr_b16 a[46:47], v2 offset:46080
  s_waitcnt lgkmcnt(0)
  s_waitcnt vmcnt(18)
  s_barrier
  s_add_u32 m0, s51, 24576
  s_add_u32 s46, s60, 4718592
  buffer_load_dwordx4 v1, s[4:7], s46 offen  lds
  s_add_u32 m0, s51, 28672
  s_add_u32 s46, s60, 4718720
  buffer_load_dwordx4 v1, s[4:7], s46 offen  lds
  s_add_u32 m0, s51, 32768
  s_add_u32 s46, s60, 4718848
  buffer_load_dwordx4 v1, s[4:7], s46 offen  lds
  s_add_u32 m0, s51, 36864
  s_add_u32 s46, s60, 5111808
  buffer_load_dwordx4 v1, s[4:7], s46 offen  lds
  s_add_u32 m0, s51, 40960
  s_add_u32 s46, s60, 5111936
  buffer_load_dwordx4 v1, s[4:7], s46 offen  lds
  s_add_u32 m0, s51, 45056
  s_add_u32 s46, s60, 5112064
  buffer_load_dwordx4 v1, s[4:7], s46 offen  lds
  ds_read_b64_tr_b16 a[48:49], v2 offset:49152
  ds_read_b64_tr_b16 a[50:51], v2 offset:50176
  ds_read_b64_tr_b16 a[52:53], v2 offset:53248
  ds_read_b64_tr_b16 a[54:55], v2 offset:54272
  ds_read_b64_tr_b16 a[56:57], v2 offset:57344
  ds_read_b64_tr_b16 a[58:59], v2 offset:58368
  ds_read_b64_tr_b16 a[60:61], v2 offset:61440
  ds_read_b64_tr_b16 a[62:63], v2 offset:62464
  ds_read_b64_tr_b16 a[64:65], v3 offset:0
  ds_read_b64_tr_b16 a[66:67], v3 offset:1024
  ds_read_b64_tr_b16 a[68:69], v3 offset:4096
  ds_read_b64_tr_b16 a[70:71], v3 offset:5120
  s_waitcnt lgkmcnt(0)
  s_waitcnt vmcnt(18)
  s_barrier
  s_add_u32 m0, s51, 49152
  s_add_u32 s46, s60, 5505024
  buffer_load_dwordx4 v1, s[4:7], s46 offen  lds
  s_add_u32 m0, s51, 53248
  s_add_u32 s46, s60, 5505152
  buffer_load_dwordx4 v1, s[4:7], s46 offen  lds
  s_add_u32 m0, s51, 57344
  s_add_u32 s46, s60, 5505280
  buffer_load_dwordx4 v1, s[4:7], s46 offen  lds
  s_add_u32 m0, s51, 61440
  s_add_u32 s46, s60, 5898240
  buffer_load_dwordx4 v1, s[4:7], s46 offen  lds
  s_add_u32 m0, s51, 65536
  s_add_u32 s46, s60, 5898368
  buffer_load_dwordx4 v1, s[4:7], s46 offen  lds
  s_add_u32 m0, s51, 69632
  s_add_u32 s46, s60, 5898496
  buffer_load_dwordx4 v1, s[4:7], s46 offen  lds
  ds_read_b64_tr_b16 a[72:73], v3 offset:8192
  ds_read_b64_tr_b16 a[74:75], v3 offset:9216
  ds_read_b64_tr_b16 a[76:77], v3 offset:12288
  ds_read_b64_tr_b16 a[78:79], v3 offset:13312
  ds_read_b64_tr_b16 a[80:81], v3 offset:16384
  ds_read_b64_tr_b16 a[82:83], v3 offset:17408
  ds_read_b64_tr_b16 a[84:85], v3 offset:20480
  ds_read_b64_tr_b16 a[86:87], v3 offset:21504
  ds_read_b64_tr_b16 a[88:89], v3 offset:24576
  ds_read_b64_tr_b16 a[90:91], v3 offset:25600
  ds_read_b64_tr_b16 a[92:93], v3 offset:28672
  ds_read_b64_tr_b16 a[94:95], v3 offset:29696
  s_waitcnt lgkmcnt(0)
  s_waitcnt vmcnt(18)
  s_barrier
  s_add_u32 m0, s51, 73728
  s_add_u32 s46, s60, 6291456
  buffer_load_dwordx4 v1, s[4:7], s46 offen  lds
  s_add_u32 m0, s51, 77824
  s_add_u32 s46, s60, 6291584
  buffer_load_dwordx4 v1, s[4:7], s46 offen  lds
  s_add_u32 m0, s51, 81920
  s_add_u32 s46, s60, 6291712
  buffer_load_dwordx4 v1, s[4:7], s46 offen  lds
  s_add_u32 m0, s51, 86016
  s_add_u32 s46, s60, 6684672
  buffer_load_dwordx4 v1, s[4:7], s46 offen  lds
  s_add_u32 m0, s51, 90112
  s_add_u32 s46, s60, 6684800
  buffer_load_dwordx4 v1, s[4:7], s46 offen  lds
  s_add_u32 m0, s51, 94208
  s_add_u32 s46, s60, 6684928
  buffer_load_dwordx4 v1, s[4:7], s46 offen  lds
  ds_read_b64_tr_b16 a[96:97], v3 offset:32768
  ds_read_b64_tr_b16 a[98:99], v3 offset:33792
  ds_read_b64_tr_b16 a[100:101], v3 offset:36864
  ds_read_b64_tr_b16 a[102:103], v3 offset:37888
  ds_read_b64_tr_b16 a[104:105], v3 offset:40960
  ds_read_b64_tr_b16 a[106:107], v3 offset:41984
  ds_read_b64_tr_b16 a[108:109], v3 offset:45056
  ds_read_b64_tr_b16 a[110:111], v3 offset:46080
  ds_read_b64_tr_b16 a[112:113], v3 offset:49152
  ds_read_b64_tr_b16 a[114:115], v3 offset:50176
  ds_read_b64_tr_b16 a[116:117], v3 offset:53248
  ds_read_b64_tr_b16 a[118:119], v3 offset:54272
  s_waitcnt lgkmcnt(0)
  s_waitcnt vmcnt(18)
  s_barrier
  s_add_u32 m0, s51, 98304
  s_add_u32 s46, s60, 7077888
  buffer_load_dwordx4 v1, s[4:7], s46 offen  lds
  s_add_u32 m0, s51, 102400
  s_add_u32 s46, s60, 7078016
  buffer_load_dwordx4 v1, s[4:7], s46 offen  lds
  s_add_u32 m0, s51, 106496
  s_add_u32 s46, s60, 7078144
  buffer_load_dwordx4 v1, s[4:7], s46 offen  lds
  s_add_u32 m0, s51, 110592
  s_add_u32 s46, s60, 7471104
  buffer_load_dwordx4 v1, s[4:7], s46 offen  lds
  s_add_u32 m0, s51, 114688
  s_add_u32 s46, s60, 7471232
  buffer_load_dwordx4 v1, s[4:7], s46 offen  lds
  s_add_u32 m0, s51, 118784
  s_add_u32 s46, s60, 7471360
  buffer_load_dwordx4 v1, s[4:7], s46 offen  lds
  ds_read_b64_tr_b16 a[120:121], v2 offset:0
  ds_read_b64_tr_b16 a[122:123], v2 offset:1024
  ds_read_b64_tr_b16 a[124:125], v2 offset:4096
  ds_read_b64_tr_b16 a[126:127], v2 offset:5120
  ds_read_b64_tr_b16 a[128:129], v2 offset:8192
  ds_read_b64_tr_b16 a[130:131], v2 offset:9216
  ds_read_b64_tr_b16 a[132:133], v2 offset:12288
  ds_read_b64_tr_b16 a[134:135], v2 offset:13312
  ds_read_b64_tr_b16 a[136:137], v2 offset:16384
  ds_read_b64_tr_b16 a[138:139], v2 offset:17408
  ds_read_b64_tr_b16 a[140:141], v2 offset:20480
  ds_read_b64_tr_b16 a[142:143], v2 offset:21504
  s_waitcnt lgkmcnt(0)
  s_waitcnt vmcnt(18)
  s_barrier
  ds_read_b64_tr_b16 a[144:145], v2 offset:24576
  ds_read_b64_tr_b16 a[146:147], v2 offset:25600
  ds_read_b64_tr_b16 a[148:149], v2 offset:28672
  ds_read_b64_tr_b16 a[150:151], v2 offset:29696
  ds_read_b64_tr_b16 a[152:153], v2 offset:32768
  ds_read_b64_tr_b16 a[154:155], v2 offset:33792
  ds_read_b64_tr_b16 a[156:157], v2 offset:36864
  ds_read_b64_tr_b16 a[158:159], v2 offset:37888
  ds_read_b64_tr_b16 a[160:161], v2 offset:40960
  ds_read_b64_tr_b16 a[162:163], v2 offset:41984
  ds_read_b64_tr_b16 a[164:165], v2 offset:45056
  ds_read_b64_tr_b16 a[166:167], v2 offset:46080
  s_waitcnt lgkmcnt(0)
  s_waitcnt vmcnt(12)
  s_barrier
  ds_read_b64_tr_b16 a[168:169], v2 offset:49152
  ds_read_b64_tr_b16 a[170:171], v2 offset:50176
  ds_read_b64_tr_b16 a[172:173], v2 offset:53248
  ds_read_b64_tr_b16 a[174:175], v2 offset:54272
  ds_read_b64_tr_b16 a[176:177], v2 offset:57344
  ds_read_b64_tr_b16 a[178:179], v2 offset:58368
  ds_read_b64_tr_b16 a[180:181], v2 offset:61440
  ds_read_b64_tr_b16 a[182:183], v2 offset:62464
  ds_read_b64_tr_b16 a[184:185], v3 offset:0
  ds_read_b64_tr_b16 a[186:187], v3 offset:1024
  ds_read_b64_tr_b16 a[188:189], v3 offset:4096
  ds_read_b64_tr_b16 a[190:191], v3 offset:5120
  s_waitcnt lgkmcnt(0)
  s_waitcnt vmcnt(6)
  s_barrier
  ds_read_b64_tr_b16 a[192:193], v3 offset:8192
  ds_read_b64_tr_b16 a[194:195], v3 offset:9216
  ds_read_b64_tr_b16 a[196:197], v3 offset:12288
  ds_read_b64_tr_b16 a[198:199], v3 offset:13312
  ds_read_b64_tr_b16 a[200:201], v3 offset:16384
  ds_read_b64_tr_b16 a[202:203], v3 offset:17408
  ds_read_b64_tr_b16 a[204:205], v3 offset:20480
  ds_read_b64_tr_b16 a[206:207], v3 offset:21504
  ds_read_b64_tr_b16 a[208:209], v3 offset:24576
  ds_read_b64_tr_b16 a[210:211], v3 offset:25600
  ds_read_b64_tr_b16 a[212:213], v3 offset:28672
  ds_read_b64_tr_b16 a[214:215], v3 offset:29696
  s_waitcnt lgkmcnt(0)
  s_waitcnt vmcnt(0)
  s_barrier
  ds_read_b64_tr_b16 a[216:217], v3 offset:32768
  ds_read_b64_tr_b16 a[218:219], v3 offset:33792
  ds_read_b64_tr_b16 a[220:221], v3 offset:36864
  ds_read_b64_tr_b16 a[222:223], v3 offset:37888
  ds_read_b64_tr_b16 a[224:225], v3 offset:40960
  ds_read_b64_tr_b16 a[226:227], v3 offset:41984
  ds_read_b64_tr_b16 a[228:229], v3 offset:45056
  ds_read_b64_tr_b16 a[230:231], v3 offset:46080
  ds_read_b64_tr_b16 a[232:233], v3 offset:49152
  ds_read_b64_tr_b16 a[234:235], v3 offset:50176
  ds_read_b64_tr_b16 a[236:237], v3 offset:53248
  ds_read_b64_tr_b16 a[238:239], v3 offset:54272
  s_waitcnt lgkmcnt(0)
  s_barrier
  v_and_b32 v11, 3, v0
  v_lshlrev_b32 v11, 2, v11
  s_mov_b32 s50, 0
ss_1:
  global_load_dword v10, v11, s[38:39] sc1
  s_add_u32 s50, s50, 1
  s_cmp_gt_u32 s50, 131072
  s_cbranch_scc1 L_fail
  s_waitcnt vmcnt(0)
  v_readlane_b32 s46, v10, 0
  v_readlane_b32 s47, v10, 2
  v_readlane_b32 s48, v10, 1
  s_nop 0
  s_min_u32 s47, s47, s48
  s_cmp_lg_u32 s46, 0
  s_cselect_b32 s48, 7, 0
  s_add_u32 s46, s46, s2
  s_xor_b32 s49, s46, s43
  s_and_b32 s49, s49, s48
  s_cbranch_scc1 L_reroll
  s_cmp_lg_u32 s47, 0
  s_cbranch_scc1 ss_ok_2
  s_sleep 6
  s_branch ss_1
ss_ok_2:
  v_readlane_b32 s3, v10, 1
  s_nop 0
  s_and_b32 s3, s3, 0x2000
  s_mov_b32 s54, s51
  s_add_u32 s53, s53, 40960
  s_add_u32 m0, s54, 0
  s_nop 0
  buffer_load_dwordx4 v5, s[12:15], s53 offen offset:0 lds
  s_add_u32 m0, s54, 3968
  s_nop 0
  buffer_load_dwordx4 v5, s[12:15], s53 offen offset:128 lds
  s_add_u32 m0, s54, 7936
  s_nop 0
  buffer_load_dwordx4 v5, s[12:15], s53 offen offset:256 lds
  s_add_u32 m0, s54, 11904
  s_nop 0
  buffer_load_dwordx4 v5, s[12:15], s53 offen offset:384 lds
  s_add_u32 m0, s54, 15872
  s_nop 0
  buffer_load_dwordx4 v5, s[12:15], s53 offen offset:512 lds
  s_add_u32 m0, s54, 19840
  s_nop 0
  buffer_load_dwordx4 v5, s[12:15], s53 offen offset:640 lds
  s_add_u32 m0, s54, 23808
  s_nop 0
  buffer_load_dwordx4 v5, s[12:15], s53 offen offset:768 lds
  s_add_u32 m0, s54, 27776
  s_nop 0
  buffer_load_dwordx4 v5, s[12:15], s53 offen offset:896 lds
  s_add_u32 m0, s54, 31744
  s_nop 0
  buffer_load_dwordx4 v5, s[12:15], s53 offen offset:1024 lds
  s_add_u32 m0, s54, 35712
  s_nop 0
  buffer_load_dwordx4 v5, s[12:15], s53 offen offset:1152 lds
  s_mov_b32 s55, 2146435072
  s_mov_b32 s56, 2146435072
  s_mov_b32 s57, 2146435072
  s_xor_b32 s63, s63, s3
  s_mov_b32 s58, 122880
  ds_read_b128 v[16:19], v6 offset:0
  ds_read_b128 v[20:23], v7 offset:0
  ds_read_b128 v[24:27], v6 offset:4096
  ds_read_b128 v[28:31], v7 offset:4096
  s_waitcnt lgkmcnt(3)
pj_loop_3:
  v_mfma_f32_16x16x32_bf16 v[40:43], a[0:3], v[16:19], 0
  ds_read_b128 v[32:35], v6 offset:8192
  v_mfma_f32_16x16x32_bf16 v[48:51], a[4:7], v[16:19], 0
  v_mfma_f32_16x16x32_bf16 v[56:59], a[8:11], v[16:19], 0
  s_waitcnt lgkmcnt(3)
  v_cvt_pk_bf16_f32 v66, v44, v45
  v_mfma_f32_16x16x32_bf16 v[40:43], a[12:15], v[20:23], v[40:43]
  ds_read_b128 v[16:19], v7 offset:8192
  v_cvt_pk_bf16_f32 v67, v46, v47
  v_mfma_f32_16x16x32_bf16 v[48:51], a[16:19], v[20:23], v[48:51]
  v_cvt_pk_bf16_f32 v70, v52, v53
  v_mfma_f32_16x16x32_bf16 v[56:59], a[20:23], v[20:23], v[56:59]
  s_waitcnt lgkmcnt(3)
  v_cvt_pk_bf16_f32 v71, v54, v55
  v_mfma_f32_16x16x32_bf16 v[40:43], a[24:27], v[24:27], v[40:43]
  ds_read_b128 v[20:23], v6 offset:12288
  v_cvt_pk_bf16_f32 v74, v60, v61
  v_mfma_f32_16x16x32_bf16 v[48:51], a[28:31], v[24:27], v[48:51]
  v_cvt_pk_bf16_f32 v75, v62, v63
  v_mfma_f32_16x16x32_bf16 v[56:59], a[32:35], v[24:27], v[56:59]
  s_waitcnt lgkmcnt(3)
  v_mfma_f32_16x16x32_bf16 v[40:43], a[36:39], v[28:31], v[40:43]
  ds_read_b128 v[24:27], v7 offset:12288
  v_permlane16_swap_b32 v64, v66
  v_mfma_f32_16x16x32_bf16 v[48:51], a[40:43], v[28:31], v[48:51]
  v_permlane16_swap_b32 v65, v67
  v_mfma_f32_16x16x32_bf16 v[56:59], a[44:47], v[28:31], v[56:59]
  buffer_store_dwordx4 v[64:67], v8, s[8:11], s55 offen sc1
  s_waitcnt lgkmcnt(3)
  v_mfma_f32_16x16x32_bf16 v[40:43], a[48:51], v[32:35], v[40:43]
  ds_read_b128 v[28:31], v6 offset:16384
  v_permlane16_swap_b32 v68, v70
  v_mfma_f32_16x16x32_bf16 v[48:51], a[52:55], v[32:35], v[48:51]
  v_permlane16_swap_b32 v69, v71
  v_mfma_f32_16x16x32_bf16 v[56:59], a[56:59], v[32:35], v[56:59]
  buffer_store_dwordx4 v[68:71], v8, s[8:11], s56 offen sc1
  s_waitcnt lgkmcnt(3)
  v_mfma_f32_16x16x32_bf16 v[40:43], a[60:63], v[16:19], v[40:43]
  ds_read_b128 v[32:35], v7 offset:16384
  v_permlane16_swap_b32 v72, v74
  v_mfma_f32_16x16x32_bf16 v[48:51], a[64:67], v[16:19], v[48:51]
  v_permlane16_swap_b32 v73, v75
  v_mfma_f32_16x16x32_bf16 v[56:59], a[68:71], v[16:19], v[56:59]
  buffer_store_dwordx4 v[72:75], v8, s[8:11], s57 offen sc1
  s_waitcnt lgkmcnt(3)
  v_mfma_f32_16x16x32_bf16 v[40:43], a[72:75], v[20:23], v[40:43]
  ds_read_b128 v[16:19], v6 offset:20480
  v_mfma_f32_16x16x32_bf16 v[48:51], a[76:79], v[20:23], v[48:51]
  v_mfma_f32_16x16x32_bf16 v[56:59], a[80:83], v[20:23], v[56:59]
  s_waitcnt lgkmcnt(3)
  v_mfma_f32_16x16x32_bf16 v[40:43], a[84:87], v[24:27], v[40:43]
  ds_read_b128 v[20:23], v7 offset:20480
  v_mfma_f32_16x16x32_bf16 v[48:51], a[88:91], v[24:27], v[48:51]
  v_mov_b32 v10, s52
  v_mfma_f32_16x16x32_bf16 v[56:59], a[92:95], v[24:27], v[56:59]
  s_waitcnt lgkmcnt(3)
  v_mfma_f32_16x16x32_bf16 v[40:43], a[96:99], v[28:31], v[40:43]
  ds_read_b128 v[24:27], v6 offset:24576
  v_mfma_f32_16x16x32_bf16 v[48:51], a[100:103], v[28:31], v[48:51]
  s_add_u32 s53, s53, 40960
  s_add_u32 s54, s54, 40960
  v_mfma_f32_16x16x32_bf16 v[56:59], a[104:107], v[28:31], v[56:59]
  s_waitcnt lgkmcnt(3)
  v_mfma_f32_16x16x32_bf16 v[40:43], a[108:111], v[32:35], v[40:43]
  ds_read_b128 v[28:31], v7 offset:24576
  v_mfma_f32_16x16x32_bf16 v[48:51], a[112:115], v[32:35], v[48:51]
  s_cmp_ge_u32 s54, 163840
  s_cselect_b32 s54, s51, s54
  v_mfma_f32_16x16x32_bf16 v[56:59], a[116:119], v[32:35], v[56:59]
  s_waitcnt lgkmcnt(3)
  v_mfma_f32_16x16x32_bf16 v[40:43], a[120:123], v[16:19], v[40:43]
  ds_read_b128 v[32:35], v6 offset:28672
  v_mfma_f32_16x16x32_bf16 v[48:51], a[124:127], v[16:19], v[48:51]
  s_cmp_eq_u32 s58, 122880
  s_cselect_b32 s59, 163840, 0
  v_mfma_f32_16x16x32_bf16 v[56:59], a[128:131], v[16:19], v[56:59]
  s_waitcnt lgkmcnt(3)
  v_mfma_f32_16x16x32_bf16 v[40:43], a[132:135], v[20:23], v[40:43]
  ds_read_b128 v[16:19], v7 offset:28672
  v_mfma_f32_16x16x32_bf16 v[48:51], a[136:139], v[20:23], v[48:51]
  s_sub_u32 s59, 40960, s59
  s_add_u32 s58, s58, s59
  v_mfma_f32_16x16x32_bf16 v[56:59], a[140:143], v[20:23], v[56:59]
  s_waitcnt lgkmcnt(3)
  v_mfma_f32_16x16x32_bf16 v[40:43], a[144:147], v[24:27], v[40:43]
  ds_read_b128 v[20:23], v6 offset:32768
  v_mfma_f32_16x16x32_bf16 v[48:51], a[148:151], v[24:27], v[48:51]
  s_lshr_b32 s55, s67, 1
  v_mfma_f32_16x16x32_bf16 v[56:59], a[152:155], v[24:27], v[56:59]
  s_lshl_b32 s55, s55, 14
  s_waitcnt lgkmcnt(3)
  v_mfma_f32_16x16x32_bf16 v[40:43], a[156:159], v[28:31], v[40:43]
  ds_read_b128 v[24:27], v7 offset:32768
  v_mfma_f32_16x16x32_bf16 v[48:51], a[160:163], v[28:31], v[48:51]
  s_and_b32 s56, s67, 1
  v_mfma_f32_16x16x32_bf16 v[56:59], a[164:167], v[28:31], v[56:59]
  s_lshl_b32 s56, s56, 12
  s_waitcnt lgkmcnt(3)
  v_mfma_f32_16x16x32_bf16 v[40:43], a[168:171], v[32:35], v[40:43]
  ds_read_b128 v[28:31], v6 offset:36864
  v_mfma_f32_16x16x32_bf16 v[48:51], a[172:175], v[32:35], v[48:51]
  s_add_u32 s55, s55, s56
  v_mfma_f32_16x16x32_bf16 v[56:59], a[176:179], v[32:35], v[56:59]
  s_add_u32 s55, s55, s63
  s_waitcnt lgkmcnt(3)
  v_mfma_f32_16x16x32_bf16 v[40:43], a[180:183], v[16:19], v[40:43]
  ds_read_b128 v[32:35], v7 offset:36864
  v_mfma_f32_16x16x32_bf16 v[48:51], a[184:187], v[16:19], v[48:51]
  s_lshr_b32 s56, s55, 8
  v_mfma_f32_16x16x32_bf16 v[56:59], a[188:191], v[16:19], v[56:59]
  s_and_b32 s56, s56, 0x2000
  s_waitcnt lgkmcnt(3)
  v_mfma_f32_16x16x32_bf16 v[40:43], a[192:195], v[20:23], v[40:43]
  ds_read_b128 v[16:19], v6 offset:2048
  v_mfma_f32_16x16x32_bf16 v[48:51], a[196:199], v[20:23], v[48:51]
  s_xor_b32 s55, s55, s56
  v_mfma_f32_16x16x32_bf16 v[56:59], a[200:203], v[20:23], v[56:59]
  s_add_u32 s67, s67, 32
  s_waitcnt lgkmcnt(3)
  v_mfma_f32_16x16x32_bf16 v[40:43], a[204:207], v[24:27], v[40:43]
  ds_read_b128 v[20:23], v7 offset:2048
  v_mfma_f32_16x16x32_bf16 v[48:51], a[208:211], v[24:27], v[48:51]
  s_cmp_ge_u32 s67, 1024
  s_cselect_b32 s56, 1024, 0
  v_mfma_f32_16x16x32_bf16 v[56:59], a[212:215], v[24:27], v[56:59]
  s_sub_u32 s67, s67, s56
  s_waitcnt lgkmcnt(3)
  v_mfma_f32_16x16x32_bf16 v[40:43], a[216:219], v[28:31], v[40:43]
  ds_read_b128 v[24:27], v6 offset:6144
  v_mfma_f32_16x16x32_bf16 v[48:51], a[220:223], v[28:31], v[48:51]
  s_add_u32 s56, s55, 16777216
  v_mfma_f32_16x16x32_bf16 v[56:59], a[224:227], v[28:31], v[56:59]
  s_add_u32 s57, s55, 33554432
  s_waitcnt lgkmcnt(3)
  v_mfma_f32_16x16x32_bf16 v[40:43], a[228:231], v[32:35], v[40:43]
  ds_read_b128 v[28:31], v7 offset:6144
  v_mfma_f32_16x16x32_bf16 v[48:51], a[232:235], v[32:35], v[48:51]
  v_mfma_f32_16x16x32_bf16 v[56:59], a[236:239], v[32:35], v[56:59]
  s_waitcnt lgkmcnt(3)
  v_mfma_f32_16x16x32_bf16 v[44:47], a[0:3], v[16:19], 0
  ds_read_b128 v[32:35], v6 offset:10240
  v_mfma_f32_16x16x32_bf16 v[52:55], a[4:7], v[16:19], 0
  v_mfma_f32_16x16x32_bf16 v[60:63], a[8:11], v[16:19], 0
  s_waitcnt lgkmcnt(3)
  v_cvt_pk_bf16_f32 v64, v40, v41
  v_mfma_f32_16x16x32_bf16 v[44:47], a[12:15], v[20:23], v[44:47]
  ds_read_b128 v[16:19], v7 offset:10240
  v_cvt_pk_bf16_f32 v65, v42, v43
  v_mfma_f32_16x16x32_bf16 v[52:55], a[16:19], v[20:23], v[52:55]
  v_cvt_pk_bf16_f32 v68, v48, v49
  v_mfma_f32_16x16x32_bf16 v[60:63], a[20:23], v[20:23], v[60:63]
  s_waitcnt lgkmcnt(3)
  v_cvt_pk_bf16_f32 v69, v50, v51
  v_mfma_f32_16x16x32_bf16 v[44:47], a[24:27], v[24:27], v[44:47]
  ds_read_b128 v[20:23], v6 offset:14336
  v_cvt_pk_bf16_f32 v72, v56, v57
  v_mfma_f32_16x16x32_bf16 v[52:55], a[28:31], v[24:27], v[52:55]
  v_cvt_pk_bf16_f32 v73, v58, v59
  v_mfma_f32_16x16x32_bf16 v[60:63], a[32:35], v[24:27], v[60:63]
  s_waitcnt lgkmcnt(3)
  v_mfma_f32_16x16x32_bf16 v[44:47], a[36:39], v[28:31], v[44:47]
  ds_read_b128 v[24:27], v7 offset:14336
  v_mfma_f32_16x16x32_bf16 v[52:55], a[40:43], v[28:31], v[52:55]
  s_waitcnt vmcnt(0)
  s_barrier
  v_mfma_f32_16x16x32_bf16 v[60:63], a[44:47], v[28:31], v[60:63]
  buffer_store_dword v10, v9, s[8:11], 0 offen sc1
  s_waitcnt lgkmcnt(3)
  v_mfma_f32_16x16x32_bf16 v[44:47], a[48:51], v[32:35], v[44:47]
  ds_read_b128 v[28:31], v6 offset:18432
  s_add_u32 m0, s54, 0
  v_mfma_f32_16x16x32_bf16 v[52:55], a[52:55], v[32:35], v[52:55]
  buffer_load_dwordx4 v5, s[12:15], s53 offen offset:0 lds
  v_mfma_f32_16x16x32_bf16 v[60:63], a[56:59], v[32:35], v[60:63]
  s_waitcnt lgkmcnt(3)
  v_mfma_f32_16x16x32_bf16 v[44:47], a[60:63], v[16:19], v[44:47]
  ds_read_b128 v[32:35], v7 offset:18432
  s_add_u32 m0, s54, 3968
  v_mfma_f32_16x16x32_bf16 v[52:55], a[64:67], v[16:19], v[52:55]
  buffer_load_dwordx4 v5, s[12:15], s53 offen offset:128 lds
  v_mfma_f32_16x16x32_bf16 v[60:63], a[68:71], v[16:19], v[60:63]
  s_waitcnt lgkmcnt(3)
  v_mfma_f32_16x16x32_bf16 v[44:47], a[72:75], v[20:23], v[44:47]
  ds_read_b128 v[16:19], v6 offset:22528
  s_add_u32 m0, s54, 7936
  v_mfma_f32_16x16x32_bf16 v[52:55], a[76:79], v[20:23], v[52:55]
  buffer_load_dwordx4 v5, s[12:15], s53 offen offset:256 lds
  v_mfma_f32_16x16x32_bf16 v[60:63], a[80:83], v[20:23], v[60:63]
  s_waitcnt lgkmcnt(3)
  v_mfma_f32_16x16x32_bf16 v[44:47], a[84:87], v[24:27], v[44:47]
  ds_read_b128 v[20:23], v7 offset:22528
  s_add_u32 m0, s54, 11904
  v_mfma_f32_16x16x32_bf16 v[52:55], a[88:91], v[24:27], v[52:55]
  buffer_load_dwordx4 v5, s[12:15], s53 offen offset:384 lds
  v_mfma_f32_16x16x32_bf16 v[60:63], a[92:95], v[24:27], v[60:63]
  s_waitcnt lgkmcnt(3)
  v_mfma_f32_16x16x32_bf16 v[44:47], a[96:99], v[28:31], v[44:47]
  ds_read_b128 v[24:27], v6 offset:26624
  s_add_u32 m0, s54, 15872
  v_mfma_f32_16x16x32_bf16 v[52:55], a[100:103], v[28:31], v[52:55]
  buffer_load_dwordx4 v5, s[12:15], s53 offen offset:512 lds
  v_mfma_f32_16x16x32_bf16 v[60:63], a[104:107], v[28:31], v[60:63]
  s_waitcnt lgkmcnt(3)
  v_mfma_f32_16x16x32_bf16 v[44:47], a[108:111], v[32:35], v[44:47]
  ds_read_b128 v[28:31], v7 offset:26624
  s_add_u32 m0, s54, 19840
  v_mfma_f32_16x16x32_bf16 v[52:55], a[112:115], v[32:35], v[52:55]
  buffer_load_dwordx4 v5, s[12:15], s53 offen offset:640 lds
  v_mfma_f32_16x16x32_bf16 v[60:63], a[116:119], v[32:35], v[60:63]
  s_waitcnt lgkmcnt(3)
  v_mfma_f32_16x16x32_bf16 v[44:47], a[120:123], v[16:19], v[44:47]
  ds_read_b128 v[32:35], v6 offset:30720
  s_add_u32 m0, s54, 23808
  v_mfma_f32_16x16x32_bf16 v[52:55], a[124:127], v[16:19], v[52:55]
  buffer_load_dwordx4 v5, s[12:15], s53 offen offset:768 lds
  v_mfma_f32_16x16x32_bf16 v[60:63], a[128:131], v[16:19], v[60:63]
  s_waitcnt lgkmcnt(3)
  v_mfma_f32_16x16x32_bf16 v[44:47], a[132:135], v[20:23], v[44:47]
  ds_read_b128 v[16:19], v7 offset:30720
  s_add_u32 m0, s54, 27776
  v_mfma_f32_16x16x32_bf16 v[52:55], a[136:139], v[20:23], v[52:55]
  buffer_load_dwordx4 v5, s[12:15], s53 offen offset:896 lds
  v_mfma_f32_16x16x32_bf16 v[60:63], a[140:143], v[20:23], v[60:63]
  s_waitcnt lgkmcnt(3)
  v_mfma_f32_16x16x32_bf16 v[44:47], a[144:147], v[24:27], v[44:47]
  ds_read_b128 v[20:23], v6 offset:34816
  s_add_u32 m0, s54, 31744
  v_mfma_f32_16x16x32_bf16 v[52:55], a[148:151], v[24:27], v[52:55]
  buffer_load_dwordx4 v5, s[12:15], s53 offen offset:1024 lds
  v_mfma_f32_16x16x32_bf16 v[60:63], a[152:155], v[24:27], v[60:63]
  s_waitcnt lgkmcnt(3)
  v_mfma_f32_16x16x32_bf16 v[44:47], a[156:159], v[28:31], v[44:47]
  ds_read_b128 v[24:27], v7 offset:34816
  s_add_u32 m0, s54, 35712
  v_mfma_f32_16x16x32_bf16 v[52:55], a[160:163], v[28:31], v[52:55]
  buffer_load_dwordx4 v5, s[12:15], s53 offen offset:1152 lds
  v_mfma_f32_16x16x32_bf16 v[60:63], a[164:167], v[28:31], v[60:63]
  s_waitcnt lgkmcnt(3)
  v_mfma_f32_16x16x32_bf16 v[44:47], a[168:171], v[32:35], v[44:47]
  ds_read_b128 v[28:31], v6 offset:38912
  v_mfma_f32_16x16x32_bf16 v[52:55], a[172:175], v[32:35], v[52:55]
  s_max_u32 s69, s52, 25
  s_sub_u32 s69, s69, 25
  v_mfma_f32_16x16x32_bf16 v[60:63], a[176:179], v[32:35], v[60:63]
  s_cmp_eq_u32 s52, s70
  s_cbranch_scc1 pj_warm
pj_wback:
  s_waitcnt lgkmcnt(3)
  v_mfma_f32_16x16x32_bf16 v[44:47], a[180:183], v[16:19], v[44:47]
  ds_read_b128 v[32:35], v7 offset:38912
  v_mfma_f32_16x16x32_bf16 v[52:55], a[184:187], v[16:19], v[52:55]
  v_add_u32 v6, s59, v6
  v_add_u32 v7, s59, v7
  v_mfma_f32_16x16x32_bf16 v[60:63], a[188:191], v[16:19], v[60:63]
  s_waitcnt lgkmcnt(3)
  v_mfma_f32_16x16x32_bf16 v[44:47], a[192:195], v[20:23], v[44:47]
  ds_read_b128 v[16:19], v6 offset:0
  v_mfma_f32_16x16x32_bf16 v[52:55], a[196:199], v[20:23], v[52:55]
  s_cmp_lt_u32 s68, s69
  s_cbranch_scc1 pj_slow
pj_back:
  v_mfma_f32_16x16x32_bf16 v[60:63], a[200:203], v[20:23], v[60:63]
  s_waitcnt lgkmcnt(3)
  v_mfma_f32_16x16x32_bf16 v[44:47], a[204:207], v[24:27], v[44:47]
  ds_read_b128 v[20:23], v7 offset:0
  v_mfma_f32_16x16x32_bf16 v[52:55], a[208:211], v[24:27], v[52:55]
  s_add_u32 s52, s52, 1
  v_mfma_f32_16x16x32_bf16 v[60:63], a[212:215], v[24:27], v[60:63]
  s_waitcnt lgkmcnt(3)
  v_mfma_f32_16x16x32_bf16 v[44:47], a[216:219], v[28:31], v[44:47]
  ds_read_b128 v[24:27], v6 offset:4096
  v_mfma_f32_16x16x32_bf16 v[52:55], a[220:223], v[28:31], v[52:55]
  v_mfma_f32_16x16x32_bf16 v[60:63], a[224:227], v[28:31], v[60:63]
  s_waitcnt lgkmcnt(3)
  v_mfma_f32_16x16x32_bf16 v[44:47], a[228:231], v[32:35], v[44:47]
  ds_read_b128 v[28:31], v7 offset:4096
  v_mfma_f32_16x16x32_bf16 v[52:55], a[232:235], v[32:35], v[52:55]
  s_cmp_lt_u32 s52, s62
  v_mfma_f32_16x16x32_bf16 v[60:63], a[236:239], v[32:35], v[60:63]
  s_waitcnt lgkmcnt(3)
  s_cbranch_scc1 pj_loop_3
  v_cvt_pk_bf16_f32 v66, v44, v45
  v_cvt_pk_bf16_f32 v67, v46, v47
  s_nop 1
  v_cvt_pk_bf16_f32 v70, v52, v53
  v_cvt_pk_bf16_f32 v71, v54, v55
  v_cvt_pk_bf16_f32 v74, v60, v61
  v_cvt_pk_bf16_f32 v75, v62, v63
  v_permlane16_swap_b32 v64, v66
  v_permlane16_swap_b32 v65, v67
  v_permlane16_swap_b32 v68, v70
  v_permlane16_swap_b32 v69, v71
  v_permlane16_swap_b32 v72, v74
  v_permlane16_swap_b32 v73, v75
  buffer_store_dwordx4 v[64:67], v8, s[8:11], s55 offen sc1
  buffer_store_dwordx4 v[68:71], v8, s[8:11], s56 offen sc1
  buffer_store_dwordx4 v[72:75], v8, s[8:11], s57 offen sc1
  v_mov_b32 v10, s52
  s_waitcnt vmcnt(0) lgkmcnt(0)
  s_barrier
  buffer_store_dword v10, v9, s[8:11], 0 offen sc1
  s_branch pj_done
pj_slow:
  s_cmp_ge_u32 s68, s69
  s_cbranch_scc1 wf_done_4
  s_mov_b32 s50, 0
wf_loop_5:
  buffer_load_dword v11, v14, s[8:11], 0 offen sc1
  s_add_u32 s50, s50, 1
  s_cmp_gt_u32 s50, 131072
  s_cbranch_scc1 L_fail
  s_waitcnt vmcnt(0)
  v_readfirstlane_b32 s68, v11
  s_nop 0
  s_cmp_ge_u32 s68, s69
  s_cbranch_scc1 wf_done_4
  s_sleep 2
  s_branch wf_loop_5
wf_done_4:
  s_branch pj_back
pj_warm:
  s_lshl_b32 s46, s44, 2
  s_add_u32 s46, s46, s43
  s_sub_u32 s46, s46, 4
  s_lshl_b32 s46, s46, 2
  s_add_u32 s46, s46, s42
  s_lshl_b32 s46, s46, 13
  v_lshlrev_b32 v11, 7, v0
  s_mov_b32 s4, s16
  s_mov_b32 s5, s17
  s_mov_b32 s6, 2621440
  s_mov_b32 s7, 0x20000
  buffer_load_dword v12, v11, s[4:7], s46 offen
  s_mov_b32 s4, s18
  s_mov_b32 s5, s19
  s_mov_b32 s6, 2457600
  s_mov_b32 s7, 0x20000
  buffer_load_dword v12, v11, s[4:7], s46 offen
  s_mov_b32 s4, s20
  s_mov_b32 s5, s21
  s_mov_b32 s6, 819200
  s_mov_b32 s7, 0x20000
  buffer_load_dword v12, v11, s[4:7], s46 offen
  s_branch pj_wback
pj_done:
  s_branch L_parta
L_uw:
  s_mov_b32 s4, s32
  s_mov_b32 s5, s33
  s_mov_b32 s6, 7864320
  s_mov_b32 s7, 0x20000
  v_lshrrev_b32 v8, 3, v0
  v_lshrrev_b32 v9, 2, v8
  v_lshlrev_b32 v9, 3, v9
  v_and_b32 v1, 3, v8
  v_add_u32 v1, v1, v9
  s_and_b32 s46, s42, 1
  s_lshl_b32 s46, s46, 2
  s_lshr_b32 s47, s42, 1
  s_lshl_b32 s47, s47, 4
  s_add_u32 s46, s46, s47
  v_add_u32 v1, s46, v1
  v_mul_u32_u24 v1, 1280, v1
  v_lshrrev_b32 v8, 1, v8
  v_bfe_u32 v9, v0, 1, 2
  v_xor_b32 v8, v8, v9
  v_lshlrev_b32 v8, 5, v8
  v_and_b32 v9, 1, v0
  v_lshlrev_b32 v9, 4, v9
  v_add3_u32 v1, v1, v8, v9
  v_lshrrev_b32 v8, 5, v0
  v_lshlrev_b32 v2, 11, v8
  v_bfe_u32 v8, v0, 2, 3
  v_lshl_add_u32 v2, v8, 7, v2
  v_lshrrev_b32 v8, 1, v8
  v_xor_b32 v8, s42, v8
  v_lshl_add_u32 v2, v8, 5, v2
  v_and_b32 v8, 3, v0
  v_lshl_add_u32 v2, v8, 3, v2
  v_add_u32 v3, 0x10000, v2
  v_add_u32 v4, 0x20000, v2
  s_mul_i32 s53, s45, 245760
  v_lshlrev_b32 v5, 4, v0
  s_lshl_b32 s46, s45, 7
  s_add_u32 s47, s46, 1056768
  v_mov_b32 v6, s47
  s_lshl_b32 s47, s42, 2
  s_add_u32 s46, s46, s47
  s_add_u32 s46, s46, 1060864
  v_mov_b32 v7, s46
  v_mov_b32 v8, 2146435072
  v_cmp_eq_u32 vcc, 0, v0
  s_nop 1
  v_cndmask_b32 v7, v8, v7, vcc
  v_cndmask_b32 v6, v8, v6, vcc
  s_mov_b32 s60, s51
  s_add_u32 s61, s51, 167780352
  s_mov_b32 s62, s45
  v_mov_b32 v12, v5
  s_lshr_b32 s55, s45, 3
  s_lshl_b32 s55, s55, 14
  s_and_b32 s46, s45, 7
  s_lshl_b32 s46, s46, 10
  s_add_u32 s55, s55, s46
  s_lshl_b32 s46, s42, 16
  s_add_u32 s55, s55, s46
  s_add_u32 s55, s55, 81788928
  s_mov_b32 s52, 0
  s_mov_b32 s56, 0
  s_add_u32 m0, s51, 0
  s_add_u32 s46, s53, 0
  buffer_load_dwordx4 v1, s[4:7], s46 offen  lds
  s_add_u32 m0, s51, 4096
  s_add_u32 s46, s53, 128
  buffer_load_dwordx4 v1, s[4:7], s46 offen  lds
  s_add_u32 m0, s51, 8192
  s_add_u32 s46, s53, 256
  buffer_load_dwordx4 v1, s[4:7], s46 offen  lds
  s_add_u32 m0, s51, 12288
  s_add_u32 s46, s53, 384
  buffer_load_dwordx4 v1, s[4:7], s46 offen  lds
  s_add_u32 m0, s51, 16384
  s_add_u32 s46, s53, 512
  buffer_load_dwordx4 v1, s[4:7], s46 offen  lds
  s_add_u32 m0, s51, 20480
  s_add_u32 s46, s53, 640
  buffer_load_dwordx4 v1, s[4:7], s46 offen  lds
  s_add_u32 m0, s51, 24576
  s_add_u32 s46, s53, 768
  buffer_load_dwordx4 v1, s[4:7], s46 offen  lds
  s_add_u32 m0, s51, 28672
  s_add_u32 s46, s53, 896
  buffer_load_dwordx4 v1, s[4:7], s46 offen  lds
  s_add_u32 m0, s51, 32768
  s_add_u32 s46, s53, 1024
  buffer_load_dwordx4 v1, s[4:7], s46 offen  lds
  s_add_u32 m0, s51, 36864
  s_add_u32 s46, s53, 1152
  buffer_load_dwordx4 v1, s[4:7], s46 offen  lds
  s_add_u32 m0, s51, 40960
  s_add_u32 s46, s53, 40960
  buffer_load_dwordx4 v1, s[4:7], s46 offen  lds
  s_add_u32 m0, s51, 45056
  s_add_u32 s46, s53, 41088
  buffer_load_dwordx4 v1, s[4:7], s46 offen  lds
  s_add_u32 m0, s51, 49152
  s_add_u32 s46, s53, 41216
  buffer_load_dwordx4 v1, s[4:7], s46 offen  lds
  s_add_u32 m0, s51, 53248
  s_add_u32 s46, s53, 41344
  buffer_load_dwordx4 v1, s[4:7], s46 offen  lds
  s_add_u32 m0, s51, 57344
  s_add_u32 s46, s53, 41472
  buffer_load_dwordx4 v1, s[4:7], s46 offen  lds
  s_add_u32 m0, s51, 61440
  s_add_u32 s46, s53, 41600
  buffer_load_dwordx4 v1, s[4:7], s46 offen  lds
  s_add_u32 m0, s51, 65536
  s_add_u32 s46, s53, 41728
  buffer_load_dwordx4 v1, s[4:7], s46 offen  lds
  s_add_u32 m0, s51, 69632
  s_add_u32 s46, s53, 41856
  buffer_load_dwordx4 v1, s[4:7], s46 offen  lds
  s_add_u32 m0, s51, 73728
  s_add_u32 s46, s53, 41984
  buffer_load_dwordx4 v1, s[4:7], s46 offen  lds
  s_add_u32 m0, s51, 77824
  s_add_u32 s46, s53, 42112
  buffer_load_dwordx4 v1, s[4:7], s46 offen  lds
  s_add_u32 m0, s51, 81920
  s_add_u32 s46, s53, 81920
  buffer_load_dwordx4 v1, s[4:7], s46 offen  lds
  s_add_u32 m0, s51, 86016
  s_add_u32 s46, s53, 82048
  buffer_load_dwordx4 v1, s[4:7], s46 offen  lds
  s_add_u32 m0, s51, 90112
  s_add_u32 s46, s53, 82176
  buffer_load_dwordx4 v1, s[4:7], s46 offen  lds
  s_add_u32 m0, s51, 94208
  s_add_u32 s46, s53, 82304
  buffer_load_dwordx4 v1, s[4:7], s46 offen  lds
  s_add_u32 m0, s51, 98304
  s_add_u32 s46, s53, 82432
  buffer_load_dwordx4 v1, s[4:7], s46 offen  lds
  s_add_u32 m0, s51, 102400
  s_add_u32 s46, s53, 82560
  buffer_load_dwordx4 v1, s[4:7], s46 offen  lds
  s_add_u32 m0, s51, 106496
  s_add_u32 s46, s53, 82688
  buffer_load_dwordx4 v1, s[4:7], s46 offen  lds
  s_add_u32 m0, s51, 110592
  s_add_u32 s46, s53, 82816
  buffer_load_dwordx4 v1, s[4:7], s46 offen  lds
  s_add_u32 m0, s51, 114688
  s_add_u32 s46, s53, 82944
  buffer_load_dwordx4 v1, s[4:7], s46 offen  lds
  s_add_u32 m0, s51, 118784
  s_add_u32 s46, s53, 83072
  buffer_load_dwordx4 v1, s[4:7], s46 offen  lds
  s_waitcnt vmcnt(24)
  s_barrier
  s_add_u32 m0, s51, 122880
  s_add_u32 s46, s53, 122880
  buffer_load_dwordx4 v1, s[4:7], s46 offen  lds
  s_add_u32 m0, s51, 126976
  s_add_u32 s46, s53, 123008
  buffer_load_dwordx4 v1, s[4:7], s46 offen  lds
  s_add_u32 m0, s51, 131072
  s_add_u32 s46, s53, 123136
  buffer_load_dwordx4 v1, s[4:7], s46 offen  lds
  s_add_u32 m0, s51, 135168
  s_add_u32 s46, s53, 123264
  buffer_load_dwordx4 v1, s[4:7], s46 offen  lds
  s_add_u32 m0, s51, 139264
  s_add_u32 s46, s53, 123392
  buffer_load_dwordx4 v1, s[4:7], s46 offen  lds
  s_add_u32 m0, s51, 143360
  s_add_u32 s46, s53, 123520
  buffer_load_dwordx4 v1, s[4:7], s46 offen  lds
  ds_read_b64_tr_b16 a[0:1], v2 offset:0
  ds_read_b64_tr_b16 a[2:3], v2 offset:1024
  ds_read_b64_tr_b16 a[24:25], v2 offset:4096
  ds_read_b64_tr_b16 a[26:27], v2 offset:5120
  ds_read_b64_tr_b16 a[48:49], v2 offset:8192
  ds_read_b64_tr_b16 a[50:51], v2 offset:9216
  ds_read_b64_tr_b16 a[72:73], v2 offset:12288
  ds_read_b64_tr_b16 a[74:75], v2 offset:13312
  ds_read_b64_tr_b16 a[96:97], v2 offset:16384
  ds_read_b64_tr_b16 a[98:99], v2 offset:17408
  ds_read_b64_tr_b16 a[120:121], v2 offset:20480
  ds_read_b64_tr_b16 a[122:123], v2 offset:21504
  s_waitcnt lgkmcnt(0)
  s_waitcnt vmcnt(24)
  s_barrier
  s_add_u32 m0, s51, 0
  s_add_u32 s46, s53, 123648
  buffer_load_dwordx4 v1, s[4:7], s46 offen  lds
  s_add_u32 m0, s51, 4096
  s_add_u32 s46, s53, 123776
  buffer_load_dwordx4 v1, s[4:7], s46 offen  lds
  s_add_u32 m0, s51, 8192
  s_add_u32 s46, s53, 123904
  buffer_load_dwordx4 v1, s[4:7], s46 offen  lds
  s_add_u32 m0, s51, 12288
  s_add_u32 s46, s53, 124032
  buffer_load_dwordx4 v1, s[4:7], s46 offen  lds
  s_add_u32 m0, s51, 16384
  s_add_u32 s46, s53, 163840
  buffer_load_dwordx4 v1, s[4:7], s46 offen  lds
  s_add_u32 m0, s51, 20480
  s_add_u32 s46, s53, 163968
  buffer_load_dwordx4 v1, s[4:7], s46 offen  lds
  ds_read_b64_tr_b16 a[144:145], v2 offset:24576
  ds_read_b64_tr_b16 a[146:147], v2 offset:25600
  ds_read_b64_tr_b16 a[168:169], v2 offset:28672
  ds_read_b64_tr_b16 a[170:171], v2 offset:29696
  ds_read_b64_tr_b16 a[192:193], v2 offset:32768
  ds_read_b64_tr_b16 a[194:195], v2 offset:33792
  ds_read_b64_tr_b16 a[216:217], v2 offset:36864
  ds_read_b64_tr_b16 a[218:219], v2 offset:37888
  ds_read_b64_tr_b16 a[4:5], v2 offset:40960
  ds_read_b64_tr_b16 a[6:7], v2 offset:41984
  ds_read_b64_tr_b16 a[28:29], v2 offset:45056
  ds_read_b64_tr_b16 a[30:31], v2 offset:46080
  s_waitcnt lgkmcnt(0)
  s_waitcnt vmcnt(24)
  s_barrier
  s_add_u32 m0, s51, 24576
  s_add_u32 s46, s53, 164096
  buffer_load_dwordx4 v1, s[4:7], s46 offen  lds
  s_add_u32 m0, s51, 28672
  s_add_u32 s46, s53, 164224
  buffer_load_dwordx4 v1, s[4:7], s46 offen  lds
  s_add_u32 m0, s51, 32768
  s_add_u32 s46, s53, 164352
  buffer_load_dwordx4 v1, s[4:7], s46 offen  lds
  s_add_u32 m0, s51, 36864
  s_add_u32 s46, s53, 164480
  buffer_load_dwordx4 v1, s[4:7], s46 offen  lds
  s_add_u32 m0, s51, 40960
  s_add_u32 s46, s53, 164608
  buffer_load_dwordx4 v1, s[4:7], s46 offen  lds
  s_add_u32 m0, s51, 45056
  s_add_u32 s46, s53, 164736
  buffer_load_dwordx4 v1, s[4:7], s46 offen  lds
  ds_read_b64_tr_b16 a[52:53], v2 offset:49152
  ds_read_b64_tr_b16 a[54:55], v2 offset:50176
  ds_read_b64_tr_b16 a[76:77], v2 offset:53248
  ds_read_b64_tr_b16 a[78:79], v2 offset:54272
  ds_read_b64_tr_b16 a[100:101], v2 offset:57344
  ds_read_b64_tr_b16 a[102:103], v2 offset:58368
  ds_read_b64_tr_b16 a[124:125], v2 offset:61440
  ds_read_b64_tr_b16 a[126:127], v2 offset:62464
  ds_read_b64_tr_b16 a[148:149], v3 offset:0
  ds_read_b64_tr_b16 a[150:151], v3 offset:1024
  ds_read_b64_tr_b16 a[172:173], v3 offset:4096
  ds_read_b64_tr_b16 a[174:175], v3 offset:5120
  s_waitcnt lgkmcnt(0)
  s_waitcnt vmcnt(24)
  s_barrier
  s_add_u32 m0, s51, 49152
  s_add_u32 s46, s53, 164864
  buffer_load_dwordx4 v1, s[4:7], s46 offen  lds
  s_add_u32 m0, s51, 53248
  s_add_u32 s46, s53, 164992
  buffer_load_dwordx4 v1, s[4:7], s46 offen  lds
  s_add_u32 m0, s51, 57344
  s_add_u32 s46, s53, 204800
  buffer_load_dwordx4 v1, s[4:7], s46 offen  lds
  s_add_u32 m0, s51, 61440
  s_add_u32 s46, s53, 204928
  buffer_load_dwordx4 v1, s[4:7], s46 offen  lds
  s_add_u32 m0, s51, 65536
  s_add_u32 s46, s53, 205056
  buffer_load_dwordx4 v1, s[4:7], s46 offen  lds
  s_add_u32 m0, s51, 69632
  s_add_u32 s46, s53, 205184
  buffer_load_dwordx4 v1, s[4:7], s46 offen  lds
  ds_read_b64_tr_b16 a[196:197], v3 offset:8192
  ds_read_b64_tr_b16 a[198:199], v3 offset:9216
  ds_read_b64_tr_b16 a[220:221], v3 offset:12288
  ds_read_b64_tr_b16 a[222:223], v3 offset:13312
  ds_read_b64_tr_b16 a[8:9], v3 offset:16384
  ds_read_b64_tr_b16 a[10:11], v3 offset:17408
  ds_read_b64_tr_b16 a[32:33], v3 offset:20480
  ds_read_b64_tr_b16 a[34:35], v3 offset:21504
  ds_read_b64_tr_b16 a[56:57], v3 offset:24576
  ds_read_b64_tr_b16 a[58:59], v3 offset:25600
  ds_read_b64_tr_b16 a[80:81], v3 offset:28672
  ds_read_b64_tr_b16 a[82:83], v3 offset:29696
  s_waitcnt lgkmcnt(0)
  s_waitcnt vmcnt(24)
  s_barrier
  s_add_u32 m0, s51, 73728
  s_add_u32 s46, s53, 205312
  buffer_load_dwordx4 v1, s[4:7], s46 offen  lds
  s_add_u32 m0, s51, 77824
  s_add_u32 s46, s53, 205440
  buffer_load_dwordx4 v1, s[4:7], s46 offen  lds
  s_add_u32 m0, s51, 81920
  s_add_u32 s46, s53, 205568
  buffer_load_dwordx4 v1, s[4:7], s46 offen  lds
  s_add_u32 m0, s51, 86016
  s_add_u32 s46, s53, 205696
  buffer_load_dwordx4 v1, s[4:7], s46 offen  lds
  s_add_u32 m0, s51, 90112
  s_add_u32 s46, s53, 205824
  buffer_load_dwordx4 v1, s[4:7], s46 offen  lds
  s_add_u32 m0, s51, 94208
  s_add_u32 s46, s53, 205952
  buffer_load_dwordx4 v1, s[4:7], s46 offen  lds
  ds_read_b64_tr_b16 a[104:105], v3 offset:32768
  ds_read_b64_tr_b16 a[106:107], v3 offset:33792
  ds_read_b64_tr_b16 a[128:129], v3 offset:36864
  ds_read_b64_tr_b16 a[130:131], v3 offset:37888
  ds_read_b64_tr_b16 a[152:153], v3 offset:40960
  ds_read_b64_tr_b16 a[154:155], v3 offset:41984
  ds_read_b64_tr_b16 a[176:177], v3 offset:45056
  ds_read_b64_tr_b16 a[178:179], v3 offset:46080
  ds_read_b64_tr_b16 a[200:201], v3 offset:49152
  ds_read_b64_tr_b16 a[202:203], v3 offset:50176
  ds_read_b64_tr_b16 a[224:225], v3 offset:53248
  ds_read_b64_tr_b16 a[226:227], v3 offset:54272
  s_waitcnt lgkmcnt(0)
  s_waitcnt vmcnt(24)
  s_barrier
  ds_read_b64_tr_b16 a[12:13], v3 offset:57344
  ds_read_b64_tr_b16 a[14:15], v3 offset:58368
  ds_read_b64_tr_b16 a[36:37], v3 offset:61440
  ds_read_b64_tr_b16 a[38:39], v3 offset:62464
  ds_read_b64_tr_b16 a[60:61], v4 offset:0
  ds_read_b64_tr_b16 a[62:63], v4 offset:1024
  ds_read_b64_tr_b16 a[84:85], v4 offset:4096
  ds_read_b64_tr_b16 a[86:87], v4 offset:5120
  ds_read_b64_tr_b16 a[108:109], v4 offset:8192
  ds_read_b64_tr_b16 a[110:111], v4 offset:9216
  ds_read_b64_tr_b16 a[132:133], v4 offset:12288
  ds_read_b64_tr_b16 a[134:135], v4 offset:13312
  s_waitcnt lgkmcnt(0)
  s_waitcnt vmcnt(18)
  s_barrier
  ds_read_b64_tr_b16 a[156:157], v2 offset:0
  ds_read_b64_tr_b16 a[158:159], v2 offset:1024
  ds_read_b64_tr_b16 a[180:181], v2 offset:4096
  ds_read_b64_tr_b16 a[182:183], v2 offset:5120
  ds_read_b64_tr_b16 a[204:205], v2 offset:8192
  ds_read_b64_tr_b16 a[206:207], v2 offset:9216
  ds_read_b64_tr_b16 a[228:229], v2 offset:12288
  ds_read_b64_tr_b16 a[230:231], v2 offset:13312
  ds_read_b64_tr_b16 a[16:17], v2 offset:16384
  ds_read_b64_tr_b16 a[18:19], v2 offset:17408
  ds_read_b64_tr_b16 a[40:41], v2 offset:20480
  ds_read_b64_tr_b16 a[42:43], v2 offset:21504
  s_waitcnt lgkmcnt(0)
  s_waitcnt vmcnt(12)
  s_barrier
  ds_read_b64_tr_b16 a[64:65], v2 offset:24576
  ds_read_b64_tr_b16 a[66:67], v2 offset:25600
  ds_read_b64_tr_b16 a[88:89], v2 offset:28672
  ds_read_b64_tr_b16 a[90:91], v2 offset:29696
  ds_read_b64_tr_b16 a[112:113], v2 offset:32768
  ds_read_b64_tr_b16 a[114:115], v2 offset:33792
  ds_read_b64_tr_b16 a[136:137], v2 offset:36864
  ds_read_b64_tr_b16 a[138:139], v2 offset:37888
  ds_read_b64_tr_b16 a[160:161], v2 offset:40960
  ds_read_b64_tr_b16 a[162:163], v2 offset:41984
  ds_read_b64_tr_b16 a[184:185], v2 offset:45056
  ds_read_b64_tr_b16 a[186:187], v2 offset:46080
  s_waitcnt lgkmcnt(0)
  s_waitcnt vmcnt(6)
  s_barrier
  ds_read_b64_tr_b16 a[208:209], v2 offset:49152
  ds_read_b64_tr_b16 a[210:211], v2 offset:50176
  ds_read_b64_tr_b16 a[232:233], v2 offset:53248
  ds_read_b64_tr_b16 a[234:235], v2 offset:54272
  ds_read_b64_tr_b16 a[20:21], v2 offset:57344
  ds_read_b64_tr_b16 a[22:23], v2 offset:58368
  ds_read_b64_tr_b16 a[44:45], v2 offset:61440
  ds_read_b64_tr_b16 a[46:47], v2 offset:62464
  ds_read_b64_tr_b16 a[68:69], v3 offset:0
  ds_read_b64_tr_b16 a[70:71], v3 offset:1024
  ds_read_b64_tr_b16 a[92:93], v3 offset:4096
  ds_read_b64_tr_b16 a[94:95], v3 offset:5120
  s_waitcnt lgkmcnt(0)
  s_waitcnt vmcnt(0)
  s_barrier
  ds_read_b64_tr_b16 a[116:117], v3 offset:8192
  ds_read_b64_tr_b16 a[118:119], v3 offset:9216
  ds_read_b64_tr_b16 a[140:141], v3 offset:12288
  ds_read_b64_tr_b16 a[142:143], v3 offset:13312
  ds_read_b64_tr_b16 a[164:165], v3 offset:16384
  ds_read_b64_tr_b16 a[166:167], v3 offset:17408
  ds_read_b64_tr_b16 a[188:189], v3 offset:20480
  ds_read_b64_tr_b16 a[190:191], v3 offset:21504
  ds_read_b64_tr_b16 a[212:213], v3 offset:24576
  ds_read_b64_tr_b16 a[214:215], v3 offset:25600
  ds_read_b64_tr_b16 a[236:237], v3 offset:28672
  ds_read_b64_tr_b16 a[238:239], v3 offset:29696
  s_waitcnt lgkmcnt(0)
  s_barrier
  v_and_b32 v9, 3, v0
  v_lshlrev_b32 v9, 2, v9
  s_mov_b32 s50, 0
ss_6:
  global_load_dword v8, v9, s[38:39] sc1
  s_add_u32 s50, s50, 1
  s_cmp_gt_u32 s50, 131072
  s_cbranch_scc1 L_fail
  s_waitcnt vmcnt(0)
  v_readlane_b32 s46, v8, 0
  v_readlane_b32 s47, v8, 2
  v_readlane_b32 s48, v8, 1
  s_nop 0
  s_min_u32 s47, s47, s48
  s_cmp_lg_u32 s46, 0
  s_cselect_b32 s48, 7, 0
  s_add_u32 s46, s46, s2
  s_xor_b32 s49, s46, s43
  s_and_b32 s49, s49, s48
  s_cbranch_scc1 L_reroll
  s_cmp_lg_u32 s47, 0
  s_cbranch_scc1 ss_ok_7
  s_sleep 6
  s_branch ss_6
ss_ok_7:
  v_readlane_b32 s3, v8, 1
  s_nop 0
  s_and_b32 s3, s3, 0x2000
  s_xor_b32 s61, s61, s3
  s_xor_b32 s55, s55, s3
  s_lshr_b32 s46, s45, 3
  s_lshr_b32 s46, 1, s46
  s_and_b32 s46, s46, 1
  s_lshl_b32 s46, s46, 13
  s_xor_b32 s55, s55, s46
  s_mov_b32 s57, 1
  s_cmp_ge_u32 s56, s57
  s_cbranch_scc1 wf_done_8
  s_mov_b32 s50, 0
wf_loop_9:
  buffer_load_dword v13, v6, s[8:11], 0 offen sc1
  s_add_u32 s50, s50, 1
  s_cmp_gt_u32 s50, 131072
  s_cbranch_scc1 L_fail
  s_waitcnt vmcnt(0)
  v_readfirstlane_b32 s56, v13
  s_nop 0
  s_cmp_ge_u32 s56, s57
  s_cbranch_scc1 wf_done_8
  s_sleep 2
  s_branch wf_loop_9
wf_done_8:
  s_lshr_b32 s54, s62, 1
  s_lshl_b32 s54, s54, 14
  s_and_b32 s47, s62, 1
  s_lshl_b32 s47, s47, 12
  s_add_u32 s54, s54, s47
  s_add_u32 s54, s54, s61
  s_lshr_b32 s47, s54, 8
  s_and_b32 s47, s47, 0x2000
  s_xor_b32 s54, s54, s47
  s_add_u32 m0, s60, 0
  s_add_u32 s47, s54, 0
  buffer_load_dwordx4 v5, s[8:11], s47 offen sc1 lds
  s_add_u32 m0, s60, 4096
  s_add_u32 s47, s54, 16777216
  buffer_load_dwordx4 v5, s[8:11], s47 offen sc1 lds
  s_add_u32 m0, s60, 8192
  s_add_u32 s47, s54, 33554432
  buffer_load_dwordx4 v5, s[8:11], s47 offen sc1 lds
  s_mov_b32 s59, 2146435072
  s_waitcnt vmcnt(0)
  s_barrier
  ds_read_b128 v[16:19], v12 offset:0
  ds_read_b128 v[40:43], v12 offset:2048
  ds_read_b128 v[20:23], v12 offset:1024
  ds_read_b128 v[44:47], v12 offset:3072
  ds_read_b128 v[24:27], v12 offset:4096
  ds_read_b128 v[48:51], v12 offset:6144
  ds_read_b128 v[28:31], v12 offset:5120
  ds_read_b128 v[52:55], v12 offset:7168
  ds_read_b128 v[32:35], v12 offset:8192
  ds_read_b128 v[56:59], v12 offset:10240
  ds_read_b128 v[36:39], v12 offset:9216
  ds_read_b128 v[60:63], v12 offset:11264
u_loop:
  s_waitcnt lgkmcnt(8)
  v_mfma_f32_16x16x32_bf16 v[64:67], v[16:19], a[0:3], 0
  buffer_load_dword v13, v6, s[8:11], 0 offen sc1
  v_mfma_f32_16x16x32_bf16 v[68:71], v[40:43], a[0:3], 0
  v_mfma_f32_16x16x32_bf16 v[64:67], v[20:23], a[4:7], v[64:67]
  v_cvt_pk_bf16_f32 v84, v72, v73
  v_mfma_f32_16x16x32_bf16 v[68:71], v[44:47], a[4:7], v[68:71]
  s_waitcnt lgkmcnt(4)
  v_cvt_pk_bf16_f32 v85, v74, v75
  v_mfma_f32_16x16x32_bf16 v[64:67], v[24:27], a[8:11], v[64:67]
  v_cvt_pk_bf16_f32 v86, v76, v77
  v_mfma_f32_16x16x32_bf16 v[68:71], v[48:51], a[8:11], v[68:71]
  v_cvt_pk_bf16_f32 v87, v78, v79
  v_mfma_f32_16x16x32_bf16 v[64:67], v[28:31], a[12:15], v[64:67]
  buffer_store_dwordx4 v[84:87], v5, s[8:11], s59 offen sc1
  v_mfma_f32_16x16x32_bf16 v[68:71], v[52:55], a[12:15], v[68:71]
  s_add_u32 s58, s55, 0
  s_waitcnt lgkmcnt(0)
  v_mfma_f32_16x16x32_bf16 v[64:67], v[32:35], a[16:19], v[64:67]
  s_lshr_b32 s46, s58, 8
  v_mfma_f32_16x16x32_bf16 v[68:71], v[56:59], a[16:19], v[68:71]
  s_and_b32 s46, s46, 0x2000
  v_mfma_f32_16x16x32_bf16 v[64:67], v[36:39], a[20:23], v[64:67]
  s_xor_b32 s58, s58, s46
  v_mfma_f32_16x16x32_bf16 v[68:71], v[60:63], a[20:23], v[68:71]
  v_mfma_f32_16x16x32_bf16 v[72:75], v[16:19], a[24:27], 0
  s_add_u32 s59, s55, 2359296
  v_mfma_f32_16x16x32_bf16 v[76:79], v[40:43], a[24:27], 0
  s_lshr_b32 s46, s59, 8
  v_mfma_f32_16x16x32_bf16 v[72:75], v[20:23], a[28:31], v[72:75]
  s_and_b32 s46, s46, 0x2000
  v_cvt_pk_bf16_f32 v80, v64, v65
  v_mfma_f32_16x16x32_bf16 v[76:79], v[44:47], a[28:31], v[76:79]
  s_xor_b32 s59, s59, s46
  v_cvt_pk_bf16_f32 v81, v66, v67
  v_mfma_f32_16x16x32_bf16 v[72:75], v[24:27], a[32:35], v[72:75]
  v_cvt_pk_bf16_f32 v82, v68, v69
  v_mfma_f32_16x16x32_bf16 v[76:79], v[48:51], a[32:35], v[76:79]
  s_add_u32 s57, s52, 2
  s_min_u32 s57, s57, 64
  v_cvt_pk_bf16_f32 v83, v70, v71
  v_mfma_f32_16x16x32_bf16 v[72:75], v[28:31], a[36:39], v[72:75]
  buffer_store_dwordx4 v[80:83], v5, s[8:11], s58 offen sc1
  v_mfma_f32_16x16x32_bf16 v[76:79], v[52:55], a[36:39], v[76:79]
  s_add_u32 s58, s55, 262144
  v_mfma_f32_16x16x32_bf16 v[72:75], v[32:35], a[40:43], v[72:75]
  s_lshr_b32 s46, s58, 8
  v_mfma_f32_16x16x32_bf16 v[76:79], v[56:59], a[40:43], v[76:79]
  s_and_b32 s46, s46, 0x2000
  v_mfma_f32_16x16x32_bf16 v[72:75], v[36:39], a[44:47], v[72:75]
  s_xor_b32 s58, s58, s46
  v_mfma_f32_16x16x32_bf16 v[76:79], v[60:63], a[44:47], v[76:79]
  s_xor_b32 s60, s60, 0x4000
  v_mov_b32 v8, s52
  v_mfma_f32_16x16x32_bf16 v[64:67], v[16:19], a[48:51], 0
  s_add_u32 s62, s62, 32
  v_xor_b32 v12, 0x4000, v12
  v_mfma_f32_16x16x32_bf16 v[68:71], v[40:43], a[48:51], 0
  s_cmp_ge_u32 s62, 1024
  s_cselect_b32 s47, 1024, 0
  v_mfma_f32_16x16x32_bf16 v[64:67], v[20:23], a[52:55], v[64:67]
  s_sub_u32 s62, s62, s47
  v_cvt_pk_bf16_f32 v84, v72, v73
  v_mfma_f32_16x16x32_bf16 v[68:71], v[44:47], a[52:55], v[68:71]
  s_lshr_b32 s54, s62, 1
  v_cvt_pk_bf16_f32 v85, v74, v75
  v_mfma_f32_16x16x32_bf16 v[64:67], v[24:27], a[56:59], v[64:67]
  s_lshl_b32 s54, s54, 14
  v_cvt_pk_bf16_f32 v86, v76, v77
  v_mfma_f32_16x16x32_bf16 v[68:71], v[48:51], a[56:59], v[68:71]
  s_and_b32 s47, s62, 1
  v_cvt_pk_bf16_f32 v87, v78, v79
  v_mfma_f32_16x16x32_bf16 v[64:67], v[28:31], a[60:63], v[64:67]
  buffer_store_dwordx4 v[84:87], v5, s[8:11], s58 offen sc1
  s_lshl_b32 s47, s47, 12
  v_mfma_f32_16x16x32_bf16 v[68:71], v[52:55], a[60:63], v[68:71]
  s_add_u32 s58, s55, 524288
  s_add_u32 s54, s54, s47
  v_mfma_f32_16x16x32_bf16 v[64:67], v[32:35], a[64:67], v[64:67]
  s_lshr_b32 s46, s58, 8
  s_add_u32 s54, s54, s61
  v_mfma_f32_16x16x32_bf16 v[68:71], v[56:59], a[64:67], v[68:71]
  s_and_b32 s46, s46, 0x2000
  s_lshr_b32 s47, s54, 8
  v_mfma_f32_16x16x32_bf16 v[64:67], v[36:39], a[68:71], v[64:67]
  s_xor_b32 s58, s58, s46
  s_and_b32 s47, s47, 0x2000
  v_mfma_f32_16x16x32_bf16 v[68:71], v[60:63], a[68:71], v[68:71]
  s_xor_b32 s54, s54, s47
  v_mfma_f32_16x16x32_bf16 v[72:75], v[16:19], a[72:75], 0
  v_mfma_f32_16x16x32_bf16 v[76:79], v[40:43], a[72:75], 0
  v_mfma_f32_16x16x32_bf16 v[72:75], v[20:23], a[76:79], v[72:75]
  v_cvt_pk_bf16_f32 v80, v64, v65
  v_mfma_f32_16x16x32_bf16 v[76:79], v[44:47], a[76:79], v[76:79]
  v_cvt_pk_bf16_f32 v81, v66, v67
  v_mfma_f32_16x16x32_bf16 v[72:75], v[24:27], a[80:83], v[72:75]
  v_cvt_pk_bf16_f32 v82, v68, v69
  v_mfma_f32_16x16x32_bf16 v[76:79], v[48:51], a[80:83], v[76:79]
  v_cvt_pk_bf16_f32 v83, v70, v71
  v_mfma_f32_16x16x32_bf16 v[72:75], v[28:31], a[84:87], v[72:75]
  buffer_store_dwordx4 v[80:83], v5, s[8:11], s58 offen sc1
  v_mfma_f32_16x16x32_bf16 v[76:79], v[52:55], a[84:87], v[76:79]
  s_add_u32 s58, s55, 786432
  v_mfma_f32_16x16x32_bf16 v[72:75], v[32:35], a[88:91], v[72:75]
  s_lshr_b32 s46, s58, 8
  v_mfma_f32_16x16x32_bf16 v[76:79], v[56:59], a[88:91], v[76:79]
  s_and_b32 s46, s46, 0x2000
  v_mfma_f32_16x16x32_bf16 v[72:75], v[36:39], a[92:95], v[72:75]
  s_xor_b32 s58, s58, s46
  s_waitcnt vmcnt(3)
  v_readfirstlane_b32 s56, v13
  v_mfma_f32_16x16x32_bf16 v[76:79], v[60:63], a[92:95], v[76:79]
  buffer_store_dword v8, v7, s[8:11], 0 offen sc1
  v_mfma_f32_16x16x32_bf16 v[64:67], v[16:19], a[96:99], 0
  s_cmp_lt_u32 s56, s57
  s_cbranch_scc1 u_slow
u_back:
  v_mfma_f32_16x16x32_bf16 v[68:71], v[40:43], a[96:99], 0
  s_add_u32 m0, s60, 0
  s_add_u32 s47, s54, 0
  buffer_load_dwordx4 v5, s[8:11], s47 offen sc1 lds
  v_mfma_f32_16x16x32_bf16 v[64:67], v[20:23], a[100:103], v[64:67]
  s_add_u32 m0, s60, 4096
  s_add_u32 s47, s54, 16777216
  buffer_load_dwordx4 v5, s[8:11], s47 offen sc1 lds
  v_cvt_pk_bf16_f32 v84, v72, v73
  v_mfma_f32_16x16x32_bf16 v[68:71], v[44:47], a[100:103], v[68:71]
  s_add_u32 m0, s60, 8192
  s_add_u32 s47, s54, 33554432
  buffer_load_dwordx4 v5, s[8:11], s47 offen sc1 lds
  v_cvt_pk_bf16_f32 v85, v74, v75
  v_mfma_f32_16x16x32_bf16 v[64:67], v[24:27], a[104:107], v[64:67]
  v_cvt_pk_bf16_f32 v86, v76, v77
  v_mfma_f32_16x16x32_bf16 v[68:71], v[48:51], a[104:107], v[68:71]
  v_cvt_pk_bf16_f32 v87, v78, v79
  v_mfma_f32_16x16x32_bf16 v[64:67], v[28:31], a[108:111], v[64:67]
  buffer_store_dwordx4 v[84:87], v5, s[8:11], s58 offen sc1
  v_mfma_f32_16x16x32_bf16 v[68:71], v[52:55], a[108:111], v[68:71]
  s_add_u32 s58, s55, 1048576
  v_mfma_f32_16x16x32_bf16 v[64:67], v[32:35], a[112:115], v[64:67]
  s_lshr_b32 s46, s58, 8
  v_mfma_f32_16x16x32_bf16 v[68:71], v[56:59], a[112:115], v[68:71]
  s_and_b32 s46, s46, 0x2000
  v_mfma_f32_16x16x32_bf16 v[64:67], v[36:39], a[116:119], v[64:67]
  s_xor_b32 s58, s58, s46
  v_mfma_f32_16x16x32_bf16 v[68:71], v[60:63], a[116:119], v[68:71]
  v_mfma_f32_16x16x32_bf16 v[72:75], v[16:19], a[120:123], 0
  v_mfma_f32_16x16x32_bf16 v[76:79], v[40:43], a[120:123], 0
  v_mfma_f32_16x16x32_bf16 v[72:75], v[20:23], a[124:127], v[72:75]
  v_cvt_pk_bf16_f32 v80, v64, v65
  v_mfma_f32_16x16x32_bf16 v[76:79], v[44:47], a[124:127], v[76:79]
  v_cvt_pk_bf16_f32 v81, v66, v67
  v_mfma_f32_16x16x32_bf16 v[72:75], v[24:27], a[128:131], v[72:75]
  v_cvt_pk_bf16_f32 v82, v68, v69
  v_mfma_f32_16x16x32_bf16 v[76:79], v[48:51], a[128:131], v[76:79]
  v_cvt_pk_bf16_f32 v83, v70, v71
  v_mfma_f32_16x16x32_bf16 v[72:75], v[28:31], a[132:135], v[72:75]
  buffer_store_dwordx4 v[80:83], v5, s[8:11], s58 offen sc1
  v_mfma_f32_16x16x32_bf16 v[76:79], v[52:55], a[132:135], v[76:79]
  s_add_u32 s58, s55, 1310720
  v_mfma_f32_16x16x32_bf16 v[72:75], v[32:35], a[136:139], v[72:75]
  s_lshr_b32 s46, s58, 8
  v_mfma_f32_16x16x32_bf16 v[76:79], v[56:59], a[136:139], v[76:79]
  s_and_b32 s46, s46, 0x2000
  v_mfma_f32_16x16x32_bf16 v[72:75], v[36:39], a[140:143], v[72:75]
  s_xor_b32 s58, s58, s46
  v_mfma_f32_16x16x32_bf16 v[76:79], v[60:63], a[140:143], v[76:79]
  v_mfma_f32_16x16x32_bf16 v[64:67], v[16:19], a[144:147], 0
  v_mfma_f32_16x16x32_bf16 v[68:71], v[40:43], a[144:147], 0
  v_mfma_f32_16x16x32_bf16 v[64:67], v[20:23], a[148:151], v[64:67]
  v_cvt_pk_bf16_f32 v84, v72, v73
  v_mfma_f32_16x16x32_bf16 v[68:71], v[44:47], a[148:151], v[68:71]
  v_cvt_pk_bf16_f32 v85, v74, v75
  v_mfma_f32_16x16x32_bf16 v[64:67], v[24:27], a[152:155], v[64:67]
  v_cvt_pk_bf16_f32 v86, v76, v77
  v_mfma_f32_16x16x32_bf16 v[68:71], v[48:51], a[152:155], v[68:71]
  v_cvt_pk_bf16_f32 v87, v78, v79
  v_mfma_f32_16x16x32_bf16 v[64:67], v[28:31], a[156:159], v[64:67]
  buffer_store_dwordx4 v[84:87], v5, s[8:11], s58 offen sc1
  v_mfma_f32_16x16x32_bf16 v[68:71], v[52:55], a[156:159], v[68:71]
  s_add_u32 s58, s55, 1572864
  v_mfma_f32_16x16x32_bf16 v[64:67], v[32:35], a[160:163], v[64:67]
  s_lshr_b32 s46, s58, 8
  v_mfma_f32_16x16x32_bf16 v[68:71], v[56:59], a[160:163], v[68:71]
  s_and_b32 s46, s46, 0x2000
  v_mfma_f32_16x16x32_bf16 v[64:67], v[36:39], a[164:167], v[64:67]
  s_xor_b32 s58, s58, s46
  v_mfma_f32_16x16x32_bf16 v[68:71], v[60:63], a[164:167], v[68:71]
  v_mfma_f32_16x16x32_bf16 v[72:75], v[16:19], a[168:171], 0
  v_mfma_f32_16x16x32_bf16 v[76:79], v[40:43], a[168:171], 0
  v_mfma_f32_16x16x32_bf16 v[72:75], v[20:23], a[172:175], v[72:75]
  v_cvt_pk_bf16_f32 v80, v64, v65
  v_mfma_f32_16x16x32_bf16 v[76:79], v[44:47], a[172:175], v[76:79]
  v_cvt_pk_bf16_f32 v81, v66, v67
  v_mfma_f32_16x16x32_bf16 v[72:75], v[24:27], a[176:179], v[72:75]
  v_cvt_pk_bf16_f32 v82, v68, v69
  v_mfma_f32_16x16x32_bf16 v[76:79], v[48:51], a[176:179], v[76:79]
  v_cvt_pk_bf16_f32 v83, v70, v71
  v_mfma_f32_16x16x32_bf16 v[72:75], v[28:31], a[180:183], v[72:75]
  buffer_store_dwordx4 v[80:83], v5, s[8:11], s58 offen sc1
  v_mfma_f32_16x16x32_bf16 v[76:79], v[52:55], a[180:183], v[76:79]
  s_add_u32 s58, s55, 1835008
  v_mfma_f32_16x16x32_bf16 v[72:75], v[32:35], a[184:187], v[72:75]
  s_lshr_b32 s46, s58, 8
  v_mfma_f32_16x16x32_bf16 v[76:79], v[56:59], a[184:187], v[76:79]
  s_and_b32 s46, s46, 0x2000
  v_mfma_f32_16x16x32_bf16 v[72:75], v[36:39], a[188:191], v[72:75]
  s_xor_b32 s58, s58, s46
  v_mfma_f32_16x16x32_bf16 v[76:79], v[60:63], a[188:191], v[76:79]
  v_mfma_f32_16x16x32_bf16 v[64:67], v[16:19], a[192:195], 0
  v_mfma_f32_16x16x32_bf16 v[68:71], v[40:43], a[192:195], 0
  v_mfma_f32_16x16x32_bf16 v[64:67], v[20:23], a[196:199], v[64:67]
  v_cvt_pk_bf16_f32 v84, v72, v73
  v_mfma_f32_16x16x32_bf16 v[68:71], v[44:47], a[196:199], v[68:71]
  v_cvt_pk_bf16_f32 v85, v74, v75
  v_mfma_f32_16x16x32_bf16 v[64:67], v[24:27], a[200:203], v[64:67]
  v_cvt_pk_bf16_f32 v86, v76, v77
  v_mfma_f32_16x16x32_bf16 v[68:71], v[48:51], a[200:203], v[68:71]
  v_cvt_pk_bf16_f32 v87, v78, v79
  v_mfma_f32_16x16x32_bf16 v[64:67], v[28:31], a[204:207], v[64:67]
  buffer_store_dwordx4 v[84:87], v5, s[8:11], s58 offen sc1
  v_mfma_f32_16x16x32_bf16 v[68:71], v[52:55], a[204:207], v[68:71]
  s_add_u32 s58, s55, 2097152
  v_mfma_f32_16x16x32_bf16 v[64:67], v[32:35], a[208:211], v[64:67]
  s_lshr_b32 s46, s58, 8
  v_mfma_f32_16x16x32_bf16 v[68:71], v[56:59], a[208:211], v[68:71]
  s_and_b32 s46, s46, 0x2000
  v_mfma_f32_16x16x32_bf16 v[64:67], v[36:39], a[212:215], v[64:67]
  s_xor_b32 s58, s58, s46
  s_waitcnt vmcnt(5)
  s_barrier
  v_mfma_f32_16x16x32_bf16 v[68:71], v[60:63], a[212:215], v[68:71]
  s_add_u32 s55, s55, 2621440
  v_mfma_f32_16x16x32_bf16 v[72:75], v[16:19], a[216:219], 0
  ds_read_b128 v[16:19], v12 offset:0
  v_mfma_f32_16x16x32_bf16 v[76:79], v[40:43], a[216:219], 0
  ds_read_b128 v[40:43], v12 offset:2048
  v_mfma_f32_16x16x32_bf16 v[72:75], v[20:23], a[220:223], v[72:75]
  ds_read_b128 v[20:23], v12 offset:1024
  v_cvt_pk_bf16_f32 v80, v64, v65
  v_mfma_f32_16x16x32_bf16 v[76:79], v[44:47], a[220:223], v[76:79]
  ds_read_b128 v[44:47], v12 offset:3072
  v_cvt_pk_bf16_f32 v81, v66, v67
  v_mfma_f32_16x16x32_bf16 v[72:75], v[24:27], a[224:227], v[72:75]
  ds_read_b128 v[24:27], v12 offset:4096
  v_cvt_pk_bf16_f32 v82, v68, v69
  v_mfma_f32_16x16x32_bf16 v[76:79], v[48:51], a[224:227], v[76:79]
  ds_read_b128 v[48:51], v12 offset:6144
  v_cvt_pk_bf16_f32 v83, v70, v71
  v_mfma_f32_16x16x32_bf16 v[72:75], v[28:31], a[228:231], v[72:75]
  buffer_store_dwordx4 v[80:83], v5, s[8:11], s58 offen sc1
  ds_read_b128 v[28:31], v12 offset:5120
  v_mfma_f32_16x16x32_bf16 v[76:79], v[52:55], a[228:231], v[76:79]
  ds_read_b128 v[52:55], v12 offset:7168
  s_cmp_ge_u32 s55, 165675008
  s_cselect_b32 s46, 83886080, 0
  v_mfma_f32_16x16x32_bf16 v[72:75], v[32:35], a[232:235], v[72:75]
  ds_read_b128 v[32:35], v12 offset:8192
  s_sub_u32 s55, s55, s46
  v_mfma_f32_16x16x32_bf16 v[76:79], v[56:59], a[232:235], v[76:79]
  ds_read_b128 v[56:59], v12 offset:10240
  s_add_u32 s52, s52, 1
  v_mfma_f32_16x16x32_bf16 v[72:75], v[36:39], a[236:239], v[72:75]
  ds_read_b128 v[36:39], v12 offset:9216
  s_cmp_lt_u32 s52, 64
  v_mfma_f32_16x16x32_bf16 v[76:79], v[60:63], a[236:239], v[76:79]
  ds_read_b128 v[60:63], v12 offset:11264
  s_cbranch_scc1 u_loop
  s_nop 2
  v_cvt_pk_bf16_f32 v84, v72, v73
  v_cvt_pk_bf16_f32 v85, v74, v75
  s_nop 0
  v_cvt_pk_bf16_f32 v86, v76, v77
  v_cvt_pk_bf16_f32 v87, v78, v79
  buffer_store_dwordx4 v[84:87], v5, s[8:11], s59 offen sc1
  v_mov_b32 v8, s52
  s_waitcnt vmcnt(0) lgkmcnt(0)
  buffer_store_dword v8, v7, s[8:11], 0 offen sc1
  s_branch u_done
u_slow:
  s_cmp_ge_u32 s56, s57
  s_cbranch_scc1 wf_done_10
  s_mov_b32 s50, 0
wf_loop_11:
  buffer_load_dword v13, v6, s[8:11], 0 offen sc1
  s_add_u32 s50, s50, 1
  s_cmp_gt_u32 s50, 131072
  s_cbranch_scc1 L_fail
  s_waitcnt vmcnt(0)
  v_readfirstlane_b32 s56, v13
  s_nop 0
  s_cmp_ge_u32 s56, s57
  s_cbranch_scc1 wf_done_10
  s_sleep 2
  s_branch wf_loop_11
wf_done_10:
  s_branch u_back
u_done:
L_parta:
  s_barrier
  s_lshl_b32 s65, s44, 2
  s_add_u32 s65, s65, s43
  s_sub_u32 s65, s65, 4
  s_cmp_ge_u32 s65, 120
  s_cbranch_scc1 pa_att
  s_mov_b32 s4, s18
  s_mov_b32 s5, s19
  s_mov_b32 s6, 2457600
  s_mov_b32 s7, 0x20000
  s_mov_b32 s12, s16
  s_mov_b32 s13, s17
  s_mov_b32 s14, 2621440
  s_mov_b32 s15, 0x20000
  s_mul_i32 s46, s65, 205
  s_lshr_b32 s46, s46, 11
  s_mul_i32 s47, s46, 10
  s_sub_u32 s47, s65, s47
  s_mul_i32 s60, s47, 384
  s_lshl_b32 s67, s47, 6
  s_mov_b32 s63, 176168960
  s_mul_i32 s61, s46, 6
  s_add_u32 s62, s61, 6
  s_mul_i32 s48, s46, 3
  s_add_u32 s49, s48, 31
  s_add_u32 s48, s48, 28
  s_min_u32 s61, s61, s48
  s_min_u32 s62, s62, s49
  s_add_u32 s67, s67, s61
  s_lshl_b32 s64, s65, 7
  s_add_u32 s64, s64, 1081344
  v_lshrrev_b32 v10, 3, v0
  v_lshrrev_b32 v11, 2, v10
  v_lshlrev_b32 v11, 3, v11
  v_and_b32 v1, 3, v10
  v_add_u32 v1, v1, v11
  s_and_b32 s46, s42, 1
  s_lshl_b32 s46, s46, 2
  s_lshr_b32 s47, s42, 1
  s_lshl_b32 s47, s47, 4
  s_add_u32 s46, s46, s47
  v_add_u32 v1, s46, v1
  v_mul_u32_u24 v1, 3840, v1
  v_lshrrev_b32 v10, 1, v10
  v_bfe_u32 v11, v0, 1, 2
  v_xor_b32 v10, v10, v11
  v_lshlrev_b32 v10, 5, v10
  v_and_b32 v11, 1, v0
  v_lshlrev_b32 v11, 4, v11
  v_add3_u32 v1, v1, v10, v11
  v_lshrrev_b32 v10, 5, v0
  v_lshlrev_b32 v2, 11, v10
  v_bfe_u32 v10, v0, 2, 3
  v_lshl_add_u32 v2, v10, 7, v2
  v_lshrrev_b32 v10, 1, v10
  v_xor_b32 v10, s42, v10
  v_lshl_add_u32 v2, v10, 5, v2
  v_and_b32 v10, 3, v0
  v_lshl_add_u32 v2, v10, 3, v2
  v_add_u32 v3, 0x10000, v2
  v_add_u32 v4, 0x20000, v2
  v_lshrrev_b32 v10, 3, v0
  s_lshl_b32 s46, s42, 3
  v_add_u32 v10, s46, v10
  v_mul_u32_u24 v5, 1280, v10
  v_bfe_u32 v10, v10, 1, 3
  v_and_b32 v11, 7, v0
  v_xor_b32 v10, v10, v11
  v_lshl_add_u32 v5, v10, 4, v5
  v_and_b32 v10, 15, v0
  v_lshlrev_b32 v6, 7, v10
  v_lshrrev_b32 v10, 1, v10
  v_lshrrev_b32 v11, 4, v0
  v_xor_b32 v10, v10, v11
  v_lshl_add_u32 v6, v10, 4, v6
  v_add_u32 v6, 122880, v6
  v_xor_b32 v7, 64, v6
  v_and_b32 v10, 15, v0
  v_lshlrev_b32 v8, 4, v10
  v_bfe_u32 v10, v0, 4, 1
  v_lshlrev_b32 v10, 11, v10
  v_lshrrev_b32 v11, 5, v0
  v_lshlrev_b32 v11, 8, v11
  v_add3_u32 v8, v8, v10, v11
  s_lshl_b32 s46, s42, 9
  v_add_u32 v8, s46, v8
  v_mov_b32 v9, s64
  v_mov_b32 v10, 2146435072
  s_cmp_eq_u32 s42, 0
  s_cselect_b64 vcc, 1, 0
  v_cndmask_b32 v9, v10, v9, vcc
  s_lshl_b32 s46, s43, 7
  s_add_u32 s46, s46, 1076736
  v_mov_b32 v14, s46
  s_mov_b32 s68, 0
  s_lshr_b32 s70, s44, 5
  s_add_u32 s70, s70, 60
  s_mov_b32 s52, s61
  s_mul_i32 s53, s52, 40960
  s_add_u32 s54, s51, 122880
  s_add_u32 m0, s54, 0
  s_nop 0
  buffer_load_dwordx4 v5, s[12:15], s53 offen offset:0 lds
  s_add_u32 m0, s54, 3968
  s_nop 0
  buffer_load_dwordx4 v5, s[12:15], s53 offen offset:128 lds
  s_add_u32 m0, s54, 7936
  s_nop 0
  buffer_load_dwordx4 v5, s[12:15], s53 offen offset:256 lds
  s_add_u32 m0, s54, 11904
  s_nop 0
  buffer_load_dwordx4 v5, s[12:15], s53 offen offset:384 lds
  s_add_u32 m0, s54, 15872
  s_nop 0
  buffer_load_dwordx4 v5, s[12:15], s53 offen offset:512 lds
  s_add_u32 m0, s54, 19840
  s_nop 0
  buffer_load_dwordx4 v5, s[12:15], s53 offen offset:640 lds
  s_add_u32 m0, s54, 23808
  s_nop 0
  buffer_load_dwordx4 v5, s[12:15], s53 offen offset:768 lds
  s_add_u32 m0, s54, 27776
  s_nop 0
  buffer_load_dwordx4 v5, s[12:15], s53 offen offset:896 lds
  s_add_u32 m0, s54, 31744
  s_nop 0
  buffer_load_dwordx4 v5, s[12:15], s53 offen offset:1024 lds
  s_add_u32 m0, s54, 35712
  s_nop 0
  buffer_load_dwordx4 v5, s[12:15], s53 offen offset:1152 lds
  s_add_u32 m0, s51, 0
  s_add_u32 s46, s60, 0
  buffer_load_dwordx4 v1, s[4:7], s46 offen  lds
  s_add_u32 m0, s51, 4096
  s_add_u32 s46, s60, 128
  buffer_load_dwordx4 v1, s[4:7], s46 offen  lds
  s_add_u32 m0, s51, 8192
  s_add_u32 s46, s60, 256
  buffer_load_dwordx4 v1, s[4:7], s46 offen  lds
  s_add_u32 m0, s51, 12288
  s_add_u32 s46, s60, 122880
  buffer_load_dwordx4 v1, s[4:7], s46 offen  lds
  s_add_u32 m0, s51, 16384
  s_add_u32 s46, s60, 123008
  buffer_load_dwordx4 v1, s[4:7], s46 offen  lds
  s_add_u32 m0, s51, 20480
  s_add_u32 s46, s60, 123136
  buffer_load_dwordx4 v1, s[4:7], s46 offen  lds
  s_add_u32 m0, s51, 24576
  s_add_u32 s46, s60, 245760
  buffer_load_dwordx4 v1, s[4:7], s46 offen  lds
  s_add_u32 m0, s51, 28672
  s_add_u32 s46, s60, 245888
  buffer_load_dwordx4 v1, s[4:7], s46 offen  lds
  s_add_u32 m0, s51, 32768
  s_add_u32 s46, s60, 246016
  buffer_load_dwordx4 v1, s[4:7], s46 offen  lds
  s_add_u32 m0, s51, 36864
  s_add_u32 s46, s60, 368640
  buffer_load_dwordx4 v1, s[4:7], s46 offen  lds
  s_add_u32 m0, s51, 40960
  s_add_u32 s46, s60, 368768
  buffer_load_dwordx4 v1, s[4:7], s46 offen  lds
  s_add_u32 m0, s51, 45056
  s_add_u32 s46, s60, 368896
  buffer_load_dwordx4 v1, s[4:7], s46 offen  lds
  s_add_u32 m0, s51, 49152
  s_add_u32 s46, s60, 491520
  buffer_load_dwordx4 v1, s[4:7], s46 offen  lds
  s_add_u32 m0, s51, 53248
  s_add_u32 s46, s60, 491648
  buffer_load_dwordx4 v1, s[4:7], s46 offen  lds
  s_add_u32 m0, s51, 57344
  s_add_u32 s46, s60, 491776
  buffer_load_dwordx4 v1, s[4:7], s46 offen  lds
  s_add_u32 m0, s51, 61440
  s_add_u32 s46, s60, 614400
  buffer_load_dwordx4 v1, s[4:7], s46 offen  lds
  s_add_u32 m0, s51, 65536
  s_add_u32 s46, s60, 614528
  buffer_load_dwordx4 v1, s[4:7], s46 offen  lds
  s_add_u32 m0, s51, 69632
  s_add_u32 s46, s60, 614656
  buffer_load_dwordx4 v1, s[4:7], s46 offen  lds
  s_add_u32 m0, s51, 73728
  s_add_u32 s46, s60, 737280
  buffer_load_dwordx4 v1, s[4:7], s46 offen  lds
  s_add_u32 m0, s51, 77824
  s_add_u32 s46, s60, 737408
  buffer_load_dwordx4 v1, s[4:7], s46 offen  lds
  s_add_u32 m0, s51, 81920
  s_add_u32 s46, s60, 737536
  buffer_load_dwordx4 v1, s[4:7], s46 offen  lds
  s_add_u32 m0, s51, 86016
  s_add_u32 s46, s60, 860160
  buffer_load_dwordx4 v1, s[4:7], s46 offen  lds
  s_add_u32 m0, s51, 90112
  s_add_u32 s46, s60, 860288
  buffer_load_dwordx4 v1, s[4:7], s46 offen  lds
  s_add_u32 m0, s51, 94208
  s_add_u32 s46, s60, 860416
  buffer_load_dwordx4 v1, s[4:7], s46 offen  lds
  s_waitcnt vmcnt(18)
  s_barrier
  s_add_u32 m0, s51, 98304
  s_add_u32 s46, s60, 983040
  buffer_load_dwordx4 v1, s[4:7], s46 offen  lds
  s_add_u32 m0, s51, 102400
  s_add_u32 s46, s60, 983168
  buffer_load_dwordx4 v1, s[4:7], s46 offen  lds
  s_add_u32 m0, s51, 106496
  s_add_u32 s46, s60, 983296
  buffer_load_dwordx4 v1, s[4:7], s46 offen  lds
  s_add_u32 m0, s51, 110592
  s_add_u32 s46, s60, 1105920
  buffer_load_dwordx4 v1, s[4:7], s46 offen  lds
  s_add_u32 m0, s51, 114688
  s_add_u32 s46, s60, 1106048
  buffer_load_dwordx4 v1, s[4:7], s46 offen  lds
  s_add_u32 m0, s51, 118784
  s_add_u32 s46, s60, 1106176
  buffer_load_dwordx4 v1, s[4:7], s46 offen  lds
  ds_read_b64_tr_b16 a[0:1], v2 offset:0
  ds_read_b64_tr_b16 a[2:3], v2 offset:1024
  ds_read_b64_tr_b16 a[4:5], v2 offset:4096
  ds_read_b64_tr_b16 a[6:7], v2 offset:5120
  ds_read_b64_tr_b16 a[8:9], v2 offset:8192
  ds_read_b64_tr_b16 a[10:11], v2 offset:9216
  ds_read_b64_tr_b16 a[12:13], v2 offset:12288
  ds_read_b64_tr_b16 a[14:15], v2 offset:13312
  ds_read_b64_tr_b16 a[16:17], v2 offset:16384
  ds_read_b64_tr_b16 a[18:19], v2 offset:17408
  ds_read_b64_tr_b16 a[20:21], v2 offset:20480
  ds_read_b64_tr_b16 a[22:23], v2 offset:21504
  s_waitcnt lgkmcnt(0)
  s_waitcnt vmcnt(18)
  s_barrier
  s_add_u32 m0, s51, 0
  s_add_u32 s46, s60, 1228800
  buffer_load_dwordx4 v1, s[4:7], s46 offen  lds
  s_add_u32 m0, s51, 4096
  s_add_u32 s46, s60, 1228928
  buffer_load_dwordx4 v1, s[4:7], s46 offen  lds
  s_add_u32 m0, s51, 8192
  s_add_u32 s46, s60, 1229056
  buffer_load_dwordx4 v1, s[4:7], s46 offen  lds
  s_add_u32 m0, s51, 12288
  s_add_u32 s46, s60, 1351680
  buffer_load_dwordx4 v1, s[4:7], s46 offen  lds
  s_add_u32 m0, s51, 16384
  s_add_u32 s46, s60, 1351808
  buffer_load_dwordx4 v1, s[4:7], s46 offen  lds
  s_add_u32 m0, s51, 20480
  s_add_u32 s46, s60, 1351936
  buffer_load_dwordx4 v1, s[4:7], s46 offen  lds
  ds_read_b64_tr_b16 a[24:25], v2 offset:24576
  ds_read_b64_tr_b16 a[26:27], v2 offset:25600
  ds_read_b64_tr_b16 a[28:29], v2 offset:28672
  ds_read_b64_tr_b16 a[30:31], v2 offset:29696
  ds_read_b64_tr_b16 a[32:33], v2 offset:32768
  ds_read_b64_tr_b16 a[34:35], v2 offset:33792
  ds_read_b64_tr_b16 a[36:37], v2 offset:36864
  ds_read_b64_tr_b16 a[38:39], v2 offset:37888
  ds_read_b64_tr_b16 a[40:41], v2 offset:40960
  ds_read_b64_tr_b16 a[42:43], v2 offset:41984
  ds_read_b64_tr_b16 a[44:45], v2 offset:45056
  ds_read_b64_tr_b16 a[46:47], v2 offset:46080
  s_waitcnt lgkmcnt(0)
  s_waitcnt vmcnt(18)
  s_barrier
  s_add_u32 m0, s51, 24576
  s_add_u32 s46, s60, 1474560
  buffer_load_dwordx4 v1, s[4:7], s46 offen  lds
  s_add_u32 m0, s51, 28672
  s_add_u32 s46, s60, 1474688
  buffer_load_dwordx4 v1, s[4:7], s46 offen  lds
  s_add_u32 m0, s51, 32768
  s_add_u32 s46, s60, 1474816
  buffer_load_dwordx4 v1, s[4:7], s46 offen  lds
  s_add_u32 m0, s51, 36864
  s_add_u32 s46, s60, 1597440
  buffer_load_dwordx4 v1, s[4:7], s46 offen  lds
  s_add_u32 m0, s51, 40960
  s_add_u32 s46, s60, 1597568
  buffer_load_dwordx4 v1, s[4:7], s46 offen  lds
  s_add_u32 m0, s51, 45056
  s_add_u32 s46, s60, 1597696
  buffer_load_dwordx4 v1, s[4:7], s46 offen  lds
  ds_read_b64_tr_b16 a[48:49], v2 offset:49152
  ds_read_b64_tr_b16 a[50:51], v2 offset:50176
  ds_read_b64_tr_b16 a[52:53], v2 offset:53248
  ds_read_b64_tr_b16 a[54:55], v2 offset:54272
  ds_read_b64_tr_b16 a[56:57], v2 offset:57344
  ds_read_b64_tr_b16 a[58:59], v2 offset:58368
  ds_read_b64_tr_b16 a[60:61], v2 offset:61440
  ds_read_b64_tr_b16 a[62:63], v2 offset:62464
  ds_read_b64_tr_b16 a[64:65], v3 offset:0
  ds_read_b64_tr_b16 a[66:67], v3 offset:1024
  ds_read_b64_tr_b16 a[68:69], v3 offset:4096
  ds_read_b64_tr_b16 a[70:71], v3 offset:5120
  s_waitcnt lgkmcnt(0)
  s_waitcnt vmcnt(18)
  s_barrier
  s_add_u32 m0, s51, 49152
  s_add_u32 s46, s60, 1720320
  buffer_load_dwordx4 v1, s[4:7], s46 offen  lds
  s_add_u32 m0, s51, 53248
  s_add_u32 s46, s60, 1720448
  buffer_load_dwordx4 v1, s[4:7], s46 offen  lds
  s_add_u32 m0, s51, 57344
  s_add_u32 s46, s60, 1720576
  buffer_load_dwordx4 v1, s[4:7], s46 offen  lds
  s_add_u32 m0, s51, 61440
  s_add_u32 s46, s60, 1843200
  buffer_load_dwordx4 v1, s[4:7], s46 offen  lds
  s_add_u32 m0, s51, 65536
  s_add_u32 s46, s60, 1843328
  buffer_load_dwordx4 v1, s[4:7], s46 offen  lds
  s_add_u32 m0, s51, 69632
  s_add_u32 s46, s60, 1843456
  buffer_load_dwordx4 v1, s[4:7], s46 offen  lds
  ds_read_b64_tr_b16 a[72:73], v3 offset:8192
  ds_read_b64_tr_b16 a[74:75], v3 offset:9216
  ds_read_b64_tr_b16 a[76:77], v3 offset:12288
  ds_read_b64_tr_b16 a[78:79], v3 offset:13312
  ds_read_b64_tr_b16 a[80:81], v3 offset:16384
  ds_read_b64_tr_b16 a[82:83], v3 offset:17408
  ds_read_b64_tr_b16 a[84:85], v3 offset:20480
  ds_read_b64_tr_b16 a[86:87], v3 offset:21504
  ds_read_b64_tr_b16 a[88:89], v3 offset:24576
  ds_read_b64_tr_b16 a[90:91], v3 offset:25600
  ds_read_b64_tr_b16 a[92:93], v3 offset:28672
  ds_read_b64_tr_b16 a[94:95], v3 offset:29696
  s_waitcnt lgkmcnt(0)
  s_waitcnt vmcnt(18)
  s_barrier
  s_add_u32 m0, s51, 73728
  s_add_u32 s46, s60, 1966080
  buffer_load_dwordx4 v1, s[4:7], s46 offen  lds
  s_add_u32 m0, s51, 77824
  s_add_u32 s46, s60, 1966208
  buffer_load_dwordx4 v1, s[4:7], s46 offen  lds
  s_add_u32 m0, s51, 81920
  s_add_u32 s46, s60, 1966336
  buffer_load_dwordx4 v1, s[4:7], s46 offen  lds
  s_add_u32 m0, s51, 86016
  s_add_u32 s46, s60, 2088960
  buffer_load_dwordx4 v1, s[4:7], s46 offen  lds
  s_add_u32 m0, s51, 90112
  s_add_u32 s46, s60, 2089088
  buffer_load_dwordx4 v1, s[4:7], s46 offen  lds
  s_add_u32 m0, s51, 94208
  s_add_u32 s46, s60, 2089216
  buffer_load_dwordx4 v1, s[4:7], s46 offen  lds
  ds_read_b64_tr_b16 a[96:97], v3 offset:32768
  ds_read_b64_tr_b16 a[98:99], v3 offset:33792
  ds_read_b64_tr_b16 a[100:101], v3 offset:36864
  ds_read_b64_tr_b16 a[102:103], v3 offset:37888
  ds_read_b64_tr_b16 a[104:105], v3 offset:40960
  ds_read_b64_tr_b16 a[106:107], v3 offset:41984
  ds_read_b64_tr_b16 a[108:109], v3 offset:45056
  ds_read_b64_tr_b16 a[110:111], v3 offset:46080
  ds_read_b64_tr_b16 a[112:113], v3 offset:49152
  ds_read_b64_tr_b16 a[114:115], v3 offset:50176
  ds_read_b64_tr_b16 a[116:117], v3 offset:53248
  ds_read_b64_tr_b16 a[118:119], v3 offset:54272
  s_waitcnt lgkmcnt(0)
  s_waitcnt vmcnt(18)
  s_barrier
  s_add_u32 m0, s51, 98304
  s_add_u32 s46, s60, 2211840
  buffer_load_dwordx4 v1, s[4:7], s46 offen  lds
  s_add_u32 m0, s51, 102400
  s_add_u32 s46, s60, 2211968
  buffer_load_dwordx4 v1, s[4:7], s46 offen  lds
  s_add_u32 m0, s51, 106496
  s_add_u32 s46, s60, 2212096
  buffer_load_dwordx4 v1, s[4:7], s46 offen  lds
  s_add_u32 m0, s51, 110592
  s_add_u32 s46, s60, 2334720
  buffer_load_dwordx4 v1, s[4:7], s46 offen  lds
  s_add_u32 m0, s51, 114688
  s_add_u32 s46, s60, 2334848
  buffer_load_dwordx4 v1, s[4:7], s46 offen  lds
  s_add_u32 m0, s51, 118784
  s_add_u32 s46, s60, 2334976
  buffer_load_dwordx4 v1, s[4:7], s46 offen  lds
  ds_read_b64_tr_b16 a[120:121], v2 offset:0
  ds_read_b64_tr_b16 a[122:123], v2 offset:1024
  ds_read_b64_tr_b16 a[124:125], v2 offset:4096
  ds_read_b64_tr_b16 a[126:127], v2 offset:5120
  ds_read_b64_tr_b16 a[128:129], v2 offset:8192
  ds_read_b64_tr_b16 a[130:131], v2 offset:9216
  ds_read_b64_tr_b16 a[132:133], v2 offset:12288
  ds_read_b64_tr_b16 a[134:135], v2 offset:13312
  ds_read_b64_tr_b16 a[136:137], v2 offset:16384
  ds_read_b64_tr_b16 a[138:139], v2 offset:17408
  ds_read_b64_tr_b16 a[140:141], v2 offset:20480
  ds_read_b64_tr_b16 a[142:143], v2 offset:21504
  s_waitcnt lgkmcnt(0)
  s_waitcnt vmcnt(18)
  s_barrier
  ds_read_b64_tr_b16 a[144:145], v2 offset:24576
  ds_read_b64_tr_b16 a[146:147], v2 offset:25600
  ds_read_b64_tr_b16 a[148:149], v2 offset:28672
  ds_read_b64_tr_b16 a[150:151], v2 offset:29696
  ds_read_b64_tr_b16 a[152:153], v2 offset:32768
  ds_read_b64_tr_b16 a[154:155], v2 offset:33792
  ds_read_b64_tr_b16 a[156:157], v2 offset:36864
  ds_read_b64_tr_b16 a[158:159], v2 offset:37888
  ds_read_b64_tr_b16 a[160:161], v2 offset:40960
  ds_read_b64_tr_b16 a[162:163], v2 offset:41984
  ds_read_b64_tr_b16 a[164:165], v2 offset:45056
  ds_read_b64_tr_b16 a[166:167], v2 offset:46080
  s_waitcnt lgkmcnt(0)
  s_waitcnt vmcnt(12)
  s_barrier
  ds_read_b64_tr_b16 a[168:169], v2 offset:49152
  ds_read_b64_tr_b16 a[170:171], v2 offset:50176
  ds_read_b64_tr_b16 a[172:173], v2 offset:53248
  ds_read_b64_tr_b16 a[174:175], v2 offset:54272
  ds_read_b64_tr_b16 a[176:177], v2 offset:57344
  ds_read_b64_tr_b16 a[178:179], v2 offset:58368
  ds_read_b64_tr_b16 a[180:181], v2 offset:61440
  ds_read_b64_tr_b16 a[182:183], v2 offset:62464
  ds_read_b64_tr_b16 a[184:185], v3 offset:0
  ds_read_b64_tr_b16 a[186:187], v3 offset:1024
  ds_read_b64_tr_b16 a[188:189], v3 offset:4096
  ds_read_b64_tr_b16 a[190:191], v3 offset:5120
  s_waitcnt lgkmcnt(0)
  s_waitcnt vmcnt(6)
  s_barrier
  ds_read_b64_tr_b16 a[192:193], v3 offset:8192
  ds_read_b64_tr_b16 a[194:195], v3 offset:9216
  ds_read_b64_tr_b16 a[196:197], v3 offset:12288
  ds_read_b64_tr_b16 a[198:199], v3 offset:13312
  ds_read_b64_tr_b16 a[200:201], v3 offset:16384
  ds_read_b64_tr_b16 a[202:203], v3 offset:17408
  ds_read_b64_tr_b16 a[204:205], v3 offset:20480
  ds_read_b64_tr_b16 a[206:207], v3 offset:21504
  ds_read_b64_tr_b16 a[208:209], v3 offset:24576
  ds_read_b64_tr_b16 a[210:211], v3 offset:25600
  ds_read_b64_tr_b16 a[212:213], v3 offset:28672
  ds_read_b64_tr_b16 a[214:215], v3 offset:29696
  s_waitcnt lgkmcnt(0)
  s_waitcnt vmcnt(0)
  s_barrier
  ds_read_b64_tr_b16 a[216:217], v3 offset:32768
  ds_read_b64_tr_b16 a[218:219], v3 offset:33792
  ds_read_b64_tr_b16 a[220:221], v3 offset:36864
  ds_read_b64_tr_b16 a[222:223], v3 offset:37888
  ds_read_b64_tr_b16 a[224:225], v3 offset:40960
  ds_read_b64_tr_b16 a[226:227], v3 offset:41984
  ds_read_b64_tr_b16 a[228:229], v3 offset:45056
  ds_read_b64_tr_b16 a[230:231], v3 offset:46080
  ds_read_b64_tr_b16 a[232:233], v3 offset:49152
  ds_read_b64_tr_b16 a[234:235], v3 offset:50176
  ds_read_b64_tr_b16 a[236:237], v3 offset:53248
  ds_read_b64_tr_b16 a[238:239], v3 offset:54272
  s_waitcnt lgkmcnt(0)
  s_barrier
  s_mov_b32 s54, s51
  s_add_u32 s53, s53, 40960
  s_add_u32 m0, s54, 0
  s_nop 0
  buffer_load_dwordx4 v5, s[12:15], s53 offen offset:0 lds
  s_add_u32 m0, s54, 3968
  s_nop 0
  buffer_load_dwordx4 v5, s[12:15], s53 offen offset:128 lds
  s_add_u32 m0, s54, 7936
  s_nop 0
  buffer_load_dwordx4 v5, s[12:15], s53 offen offset:256 lds
  s_add_u32 m0, s54, 11904
  s_nop 0
  buffer_load_dwordx4 v5, s[12:15], s53 offen offset:384 lds
  s_add_u32 m0, s54, 15872
  s_nop 0
  buffer_load_dwordx4 v5, s[12:15], s53 offen offset:512 lds
  s_add_u32 m0, s54, 19840
  s_nop 0
  buffer_load_dwordx4 v5, s[12:15], s53 offen offset:640 lds
  s_add_u32 m0, s54, 23808
  s_nop 0
  buffer_load_dwordx4 v5, s[12:15], s53 offen offset:768 lds
  s_add_u32 m0, s54, 27776
  s_nop 0
  buffer_load_dwordx4 v5, s[12:15], s53 offen offset:896 lds
  s_add_u32 m0, s54, 31744
  s_nop 0
  buffer_load_dwordx4 v5, s[12:15], s53 offen offset:1024 lds
  s_add_u32 m0, s54, 35712
  s_nop 0
  buffer_load_dwordx4 v5, s[12:15], s53 offen offset:1152 lds
  s_mov_b32 s55, 2146435072
  s_mov_b32 s56, 2146435072
  s_mov_b32 s57, 2146435072
  s_xor_b32 s63, s63, s3
  s_mov_b32 s58, 122880
  ds_read_b128 v[16:19], v6 offset:0
  ds_read_b128 v[20:23], v7 offset:0
  ds_read_b128 v[24:27], v6 offset:4096
  ds_read_b128 v[28:31], v7 offset:4096
  s_waitcnt lgkmcnt(3)
pa_loop_12:
  v_mfma_f32_16x16x32_bf16 v[40:43], a[0:3], v[16:19], 0
  ds_read_b128 v[32:35], v6 offset:8192
  v_mfma_f32_16x16x32_bf16 v[48:51], a[4:7], v[16:19], 0
  v_mfma_f32_16x16x32_bf16 v[56:59], a[8:11], v[16:19], 0
  s_waitcnt lgkmcnt(3)
  v_cvt_pk_bf16_f32 v66, v44, v45
  v_mfma_f32_16x16x32_bf16 v[40:43], a[12:15], v[20:23], v[40:43]
  ds_read_b128 v[16:19], v7 offset:8192
  v_cvt_pk_bf16_f32 v67, v46, v47
  v_mfma_f32_16x16x32_bf16 v[48:51], a[16:19], v[20:23], v[48:51]
  v_cvt_pk_bf16_f32 v70, v52, v53
  v_mfma_f32_16x16x32_bf16 v[56:59], a[20:23], v[20:23], v[56:59]
  s_waitcnt lgkmcnt(3)
  v_cvt_pk_bf16_f32 v71, v54, v55
  v_mfma_f32_16x16x32_bf16 v[40:43], a[24:27], v[24:27], v[40:43]
  ds_read_b128 v[20:23], v6 offset:12288
  v_cvt_pk_bf16_f32 v74, v60, v61
  v_mfma_f32_16x16x32_bf16 v[48:51], a[28:31], v[24:27], v[48:51]
  v_cvt_pk_bf16_f32 v75, v62, v63
  v_mfma_f32_16x16x32_bf16 v[56:59], a[32:35], v[24:27], v[56:59]
  s_waitcnt lgkmcnt(3)
  v_mfma_f32_16x16x32_bf16 v[40:43], a[36:39], v[28:31], v[40:43]
  ds_read_b128 v[24:27], v7 offset:12288
  v_permlane16_swap_b32 v64, v66
  v_mfma_f32_16x16x32_bf16 v[48:51], a[40:43], v[28:31], v[48:51]
  v_permlane16_swap_b32 v65, v67
  v_mfma_f32_16x16x32_bf16 v[56:59], a[44:47], v[28:31], v[56:59]
  buffer_store_dwordx4 v[64:67], v8, s[8:11], s55 offen sc1
  s_waitcnt lgkmcnt(3)
  v_mfma_f32_16x16x32_bf16 v[40:43], a[48:51], v[32:35], v[40:43]
  ds_read_b128 v[28:31], v6 offset:16384
  v_permlane16_swap_b32 v68, v70
  v_mfma_f32_16x16x32_bf16 v[48:51], a[52:55], v[32:35], v[48:51]
  v_permlane16_swap_b32 v69, v71
  v_mfma_f32_16x16x32_bf16 v[56:59], a[56:59], v[32:35], v[56:59]
  buffer_store_dwordx4 v[68:71], v8, s[8:11], s56 offen sc1
  s_waitcnt lgkmcnt(3)
  v_mfma_f32_16x16x32_bf16 v[40:43], a[60:63], v[16:19], v[40:43]
  ds_read_b128 v[32:35], v7 offset:16384
  v_permlane16_swap_b32 v72, v74
  v_mfma_f32_16x16x32_bf16 v[48:51], a[64:67], v[16:19], v[48:51]
  v_permlane16_swap_b32 v73, v75
  v_mfma_f32_16x16x32_bf16 v[56:59], a[68:71], v[16:19], v[56:59]
  buffer_store_dwordx4 v[72:75], v8, s[8:11], s57 offen sc1
  s_waitcnt lgkmcnt(3)
  v_mfma_f32_16x16x32_bf16 v[40:43], a[72:75], v[20:23], v[40:43]
  ds_read_b128 v[16:19], v6 offset:20480
  v_mfma_f32_16x16x32_bf16 v[48:51], a[76:79], v[20:23], v[48:51]
  v_mfma_f32_16x16x32_bf16 v[56:59], a[80:83], v[20:23], v[56:59]
  s_waitcnt lgkmcnt(3)
  v_mfma_f32_16x16x32_bf16 v[40:43], a[84:87], v[24:27], v[40:43]
  ds_read_b128 v[20:23], v7 offset:20480
  v_mfma_f32_16x16x32_bf16 v[48:51], a[88:91], v[24:27], v[48:51]
  v_mov_b32 v10, s52
  v_mfma_f32_16x16x32_bf16 v[56:59], a[92:95], v[24:27], v[56:59]
  s_waitcnt lgkmcnt(3)
  v_mfma_f32_16x16x32_bf16 v[40:43], a[96:99], v[28:31], v[40:43]
  ds_read_b128 v[24:27], v6 offset:24576
  v_mfma_f32_16x16x32_bf16 v[48:51], a[100:103], v[28:31], v[48:51]
  s_add_u32 s53, s53, 40960
  s_add_u32 s54, s54, 40960
  v_mfma_f32_16x16x32_bf16 v[56:59], a[104:107], v[28:31], v[56:59]
  s_waitcnt lgkmcnt(3)
  v_mfma_f32_16x16x32_bf16 v[40:43], a[108:111], v[32:35], v[40:43]
  ds_read_b128 v[28:31], v7 offset:24576
  v_mfma_f32_16x16x32_bf16 v[48:51], a[112:115], v[32:35], v[48:51]
  s_cmp_ge_u32 s54, 163840
  s_cselect_b32 s54, s51, s54
  v_mfma_f32_16x16x32_bf16 v[56:59], a[116:119], v[32:35], v[56:59]
  s_waitcnt lgkmcnt(3)
  v_mfma_f32_16x16x32_bf16 v[40:43], a[120:123], v[16:19], v[40:43]
  ds_read_b128 v[32:35], v6 offset:28672
  v_mfma_f32_16x16x32_bf16 v[48:51], a[124:127], v[16:19], v[48:51]
  s_cmp_eq_u32 s58, 122880
  s_cselect_b32 s59, 163840, 0
  v_mfma_f32_16x16x32_bf16 v[56:59], a[128:131], v[16:19], v[56:59]
  s_waitcnt lgkmcnt(3)
  v_mfma_f32_16x16x32_bf16 v[40:43], a[132:135], v[20:23], v[40:43]
  ds_read_b128 v[16:19], v7 offset:28672
  v_mfma_f32_16x16x32_bf16 v[48:51], a[136:139], v[20:23], v[48:51]
  s_sub_u32 s59, 40960, s59
  s_add_u32 s58, s58, s59
  v_mfma_f32_16x16x32_bf16 v[56:59], a[140:143], v[20:23], v[56:59]
  s_waitcnt lgkmcnt(3)
  v_mfma_f32_16x16x32_bf16 v[40:43], a[144:147], v[24:27], v[40:43]
  ds_read_b128 v[20:23], v6 offset:32768
  v_mfma_f32_16x16x32_bf16 v[48:51], a[148:151], v[24:27], v[48:51]
  s_lshr_b32 s55, s67, 1
  v_mfma_f32_16x16x32_bf16 v[56:59], a[152:155], v[24:27], v[56:59]
  s_lshl_b32 s55, s55, 14
  s_waitcnt lgkmcnt(3)
  v_mfma_f32_16x16x32_bf16 v[40:43], a[156:159], v[28:31], v[40:43]
  ds_read_b128 v[24:27], v7 offset:32768
  v_mfma_f32_16x16x32_bf16 v[48:51], a[160:163], v[28:31], v[48:51]
  s_and_b32 s56, s67, 1
  v_mfma_f32_16x16x32_bf16 v[56:59], a[164:167], v[28:31], v[56:59]
  s_lshl_b32 s56, s56, 12
  s_waitcnt lgkmcnt(3)
  v_mfma_f32_16x16x32_bf16 v[40:43], a[168:171], v[32:35], v[40:43]
  ds_read_b128 v[28:31], v6 offset:36864
  v_mfma_f32_16x16x32_bf16 v[48:51], a[172:175], v[32:35], v[48:51]
  s_add_u32 s55, s55, s56
  v_mfma_f32_16x16x32_bf16 v[56:59], a[176:179], v[32:35], v[56:59]
  s_add_u32 s55, s55, s63
  s_waitcnt lgkmcnt(3)
  v_mfma_f32_16x16x32_bf16 v[40:43], a[180:183], v[16:19], v[40:43]
  ds_read_b128 v[32:35], v7 offset:36864
  v_mfma_f32_16x16x32_bf16 v[48:51], a[184:187], v[16:19], v[48:51]
  s_lshr_b32 s56, s55, 8
  v_mfma_f32_16x16x32_bf16 v[56:59], a[188:191], v[16:19], v[56:59]
  s_and_b32 s56, s56, 0x2000
  s_waitcnt lgkmcnt(3)
  v_mfma_f32_16x16x32_bf16 v[40:43], a[192:195], v[20:23], v[40:43]
  ds_read_b128 v[16:19], v6 offset:2048
  v_mfma_f32_16x16x32_bf16 v[48:51], a[196:199], v[20:23], v[48:51]
  s_xor_b32 s55, s55, s56
  v_mfma_f32_16x16x32_bf16 v[56:59], a[200:203], v[20:23], v[56:59]
  s_add_u32 s67, s67, 1
  s_waitcnt lgkmcnt(3)
  v_mfma_f32_16x16x32_bf16 v[40:43], a[204:207], v[24:27], v[40:43]
  ds_read_b128 v[20:23], v7 offset:2048
  v_mfma_f32_16x16x32_bf16 v[48:51], a[208:211], v[24:27], v[48:51]
  s_add_u32 s56, s55, 16777216
  v_mfma_f32_16x16x32_bf16 v[56:59], a[212:215], v[24:27], v[56:59]
  s_add_u32 s57, s55, 33554432
  s_waitcnt lgkmcnt(3)
  v_mfma_f32_16x16x32_bf16 v[40:43], a[216:219], v[28:31], v[40:43]
  ds_read_b128 v[24:27], v6 offset:6144
  v_mfma_f32_16x16x32_bf16 v[48:51], a[220:223], v[28:31], v[48:51]
  v_mfma_f32_16x16x32_bf16 v[56:59], a[224:227], v[28:31], v[56:59]
  s_waitcnt lgkmcnt(3)
  v_mfma_f32_16x16x32_bf16 v[40:43], a[228:231], v[32:35], v[40:43]
  ds_read_b128 v[28:31], v7 offset:6144
  v_mfma_f32_16x16x32_bf16 v[48:51], a[232:235], v[32:35], v[48:51]
  v_mfma_f32_16x16x32_bf16 v[56:59], a[236:239], v[32:35], v[56:59]
  s_waitcnt lgkmcnt(3)
  v_mfma_f32_16x16x32_bf16 v[44:47], a[0:3], v[16:19], 0
  ds_read_b128 v[32:35], v6 offset:10240
  v_mfma_f32_16x16x32_bf16 v[52:55], a[4:7], v[16:19], 0
  v_mfma_f32_16x16x32_bf16 v[60:63], a[8:11], v[16:19], 0
  s_waitcnt lgkmcnt(3)
  v_cvt_pk_bf16_f32 v64, v40, v41
  v_mfma_f32_16x16x32_bf16 v[44:47], a[12:15], v[20:23], v[44:47]
  ds_read_b128 v[16:19], v7 offset:10240
  v_cvt_pk_bf16_f32 v65, v42, v43
  v_mfma_f32_16x16x32_bf16 v[52:55], a[16:19], v[20:23], v[52:55]
  v_cvt_pk_bf16_f32 v68, v48, v49
  v_mfma_f32_16x16x32_bf16 v[60:63], a[20:23], v[20:23], v[60:63]
  s_waitcnt lgkmcnt(3)
  v_cvt_pk_bf16_f32 v69, v50, v51
  v_mfma_f32_16x16x32_bf16 v[44:47], a[24:27], v[24:27], v[44:47]
  ds_read_b128 v[20:23], v6 offset:14336
  v_cvt_pk_bf16_f32 v72, v56, v57
  v_mfma_f32_16x16x32_bf16 v[52:55], a[28:31], v[24:27], v[52:55]
  v_cvt_pk_bf16_f32 v73, v58, v59
  v_mfma_f32_16x16x32_bf16 v[60:63], a[32:35], v[24:27], v[60:63]
  s_waitcnt lgkmcnt(3)
  v_mfma_f32_16x16x32_bf16 v[44:47], a[36:39], v[28:31], v[44:47]
  ds_read_b128 v[24:27], v7 offset:14336
  v_mfma_f32_16x16x32_bf16 v[52:55], a[40:43], v[28:31], v[52:55]
  s_waitcnt vmcnt(0)
  s_barrier
  v_mfma_f32_16x16x32_bf16 v[60:63], a[44:47], v[28:31], v[60:63]
  buffer_store_dword v10, v9, s[8:11], 0 offen sc1
  s_waitcnt lgkmcnt(3)
  v_mfma_f32_16x16x32_bf16 v[44:47], a[48:51], v[32:35], v[44:47]
  ds_read_b128 v[28:31], v6 offset:18432
  s_add_u32 m0, s54, 0
  v_mfma_f32_16x16x32_bf16 v[52:55], a[52:55], v[32:35], v[52:55]
  buffer_load_dwordx4 v5, s[12:15], s53 offen offset:0 lds
  v_mfma_f32_16x16x32_bf16 v[60:63], a[56:59], v[32:35], v[60:63]
  s_waitcnt lgkmcnt(3)
  v_mfma_f32_16x16x32_bf16 v[44:47], a[60:63], v[16:19], v[44:47]
  ds_read_b128 v[32:35], v7 offset:18432
  s_add_u32 m0, s54, 3968
  v_mfma_f32_16x16x32_bf16 v[52:55], a[64:67], v[16:19], v[52:55]
  buffer_load_dwordx4 v5, s[12:15], s53 offen offset:128 lds
  v_mfma_f32_16x16x32_bf16 v[60:63], a[68:71], v[16:19], v[60:63]
  s_waitcnt lgkmcnt(3)
  v_mfma_f32_16x16x32_bf16 v[44:47], a[72:75], v[20:23], v[44:47]
  ds_read_b128 v[16:19], v6 offset:22528
  s_add_u32 m0, s54, 7936
  v_mfma_f32_16x16x32_bf16 v[52:55], a[76:79], v[20:23], v[52:55]
  buffer_load_dwordx4 v5, s[12:15], s53 offen offset:256 lds
  v_mfma_f32_16x16x32_bf16 v[60:63], a[80:83], v[20:23], v[60:63]
  s_waitcnt lgkmcnt(3)
  v_mfma_f32_16x16x32_bf16 v[44:47], a[84:87], v[24:27], v[44:47]
  ds_read_b128 v[20:23], v7 offset:22528
  s_add_u32 m0, s54, 11904
  v_mfma_f32_16x16x32_bf16 v[52:55], a[88:91], v[24:27], v[52:55]
  buffer_load_dwordx4 v5, s[12:15], s53 offen offset:384 lds
  v_mfma_f32_16x16x32_bf16 v[60:63], a[92:95], v[24:27], v[60:63]
  s_waitcnt lgkmcnt(3)
  v_mfma_f32_16x16x32_bf16 v[44:47], a[96:99], v[28:31], v[44:47]
  ds_read_b128 v[24:27], v6 offset:26624
  s_add_u32 m0, s54, 15872
  v_mfma_f32_16x16x32_bf16 v[52:55], a[100:103], v[28:31], v[52:55]
  buffer_load_dwordx4 v5, s[12:15], s53 offen offset:512 lds
  v_mfma_f32_16x16x32_bf16 v[60:63], a[104:107], v[28:31], v[60:63]
  s_waitcnt lgkmcnt(3)
  v_mfma_f32_16x16x32_bf16 v[44:47], a[108:111], v[32:35], v[44:47]
  ds_read_b128 v[28:31], v7 offset:26624
  s_add_u32 m0, s54, 19840
  v_mfma_f32_16x16x32_bf16 v[52:55], a[112:115], v[32:35], v[52:55]
  buffer_load_dwordx4 v5, s[12:15], s53 offen offset:640 lds
  v_mfma_f32_16x16x32_bf16 v[60:63], a[116:119], v[32:35], v[60:63]
  s_waitcnt lgkmcnt(3)
  v_mfma_f32_16x16x32_bf16 v[44:47], a[120:123], v[16:19], v[44:47]
  ds_read_b128 v[32:35], v6 offset:30720
  s_add_u32 m0, s54, 23808
  v_mfma_f32_16x16x32_bf16 v[52:55], a[124:127], v[16:19], v[52:55]
  buffer_load_dwordx4 v5, s[12:15], s53 offen offset:768 lds
  v_mfma_f32_16x16x32_bf16 v[60:63], a[128:131], v[16:19], v[60:63]
  s_waitcnt lgkmcnt(3)
  v_mfma_f32_16x16x32_bf16 v[44:47], a[132:135], v[20:23], v[44:47]
  ds_read_b128 v[16:19], v7 offset:30720
  s_add_u32 m0, s54, 27776
  v_mfma_f32_16x16x32_bf16 v[52:55], a[136:139], v[20:23], v[52:55]
  buffer_load_dwordx4 v5, s[12:15], s53 offen offset:896 lds
  v_mfma_f32_16x16x32_bf16 v[60:63], a[140:143], v[20:23], v[60:63]
  s_waitcnt lgkmcnt(3)
  v_mfma_f32_16x16x32_bf16 v[44:47], a[144:147], v[24:27], v[44:47]
  ds_read_b128 v[20:23], v6 offset:34816
  s_add_u32 m0, s54, 31744
  v_mfma_f32_16x16x32_bf16 v[52:55], a[148:151], v[24:27], v[52:55]
  buffer_load_dwordx4 v5, s[12:15], s53 offen offset:1024 lds
  v_mfma_f32_16x16x32_bf16 v[60:63], a[152:155], v[24:27], v[60:63]
  s_waitcnt lgkmcnt(3)
  v_mfma_f32_16x16x32_bf16 v[44:47], a[156:159], v[28:31], v[44:47]
  ds_read_b128 v[24:27], v7 offset:34816
  s_add_u32 m0, s54, 35712
  v_mfma_f32_16x16x32_bf16 v[52:55], a[160:163], v[28:31], v[52:55]
  buffer_load_dwordx4 v5, s[12:15], s53 offen offset:1152 lds
  v_mfma_f32_16x16x32_bf16 v[60:63], a[164:167], v[28:31], v[60:63]
  s_waitcnt lgkmcnt(3)
  v_mfma_f32_16x16x32_bf16 v[44:47], a[168:171], v[32:35], v[44:47]
  ds_read_b128 v[28:31], v6 offset:38912
  v_mfma_f32_16x16x32_bf16 v[52:55], a[172:175], v[32:35], v[52:55]
  v_mfma_f32_16x16x32_bf16 v[60:63], a[176:179], v[32:35], v[60:63]
  s_waitcnt lgkmcnt(3)
  v_mfma_f32_16x16x32_bf16 v[44:47], a[180:183], v[16:19], v[44:47]
  ds_read_b128 v[32:35], v7 offset:38912
  v_mfma_f32_16x16x32_bf16 v[52:55], a[184:187], v[16:19], v[52:55]
  v_add_u32 v6, s59, v6
  v_add_u32 v7, s59, v7
  v_mfma_f32_16x16x32_bf16 v[60:63], a[188:191], v[16:19], v[60:63]
  s_waitcnt lgkmcnt(3)
  v_mfma_f32_16x16x32_bf16 v[44:47], a[192:195], v[20:23], v[44:47]
  ds_read_b128 v[16:19], v6 offset:0
  v_mfma_f32_16x16x32_bf16 v[52:55], a[196:199], v[20:23], v[52:55]
  v_mfma_f32_16x16x32_bf16 v[60:63], a[200:203], v[20:23], v[60:63]
  s_waitcnt lgkmcnt(3)
  v_mfma_f32_16x16x32_bf16 v[44:47], a[204:207], v[24:27], v[44:47]
  ds_read_b128 v[20:23], v7 offset:0
  v_mfma_f32_16x16x32_bf16 v[52:55], a[208:211], v[24:27], v[52:55]
  s_add_u32 s52, s52, 1
  v_mfma_f32_16x16x32_bf16 v[60:63], a[212:215], v[24:27], v[60:63]
  s_waitcnt lgkmcnt(3)
  v_mfma_f32_16x16x32_bf16 v[44:47], a[216:219], v[28:31], v[44:47]
  ds_read_b128 v[24:27], v6 offset:4096
  v_mfma_f32_16x16x32_bf16 v[52:55], a[220:223], v[28:31], v[52:55]
  v_mfma_f32_16x16x32_bf16 v[60:63], a[224:227], v[28:31], v[60:63]
  s_waitcnt lgkmcnt(3)
  v_mfma_f32_16x16x32_bf16 v[44:47], a[228:231], v[32:35], v[44:47]
  ds_read_b128 v[28:31], v7 offset:4096
  v_mfma_f32_16x16x32_bf16 v[52:55], a[232:235], v[32:35], v[52:55]
  s_cmp_lt_u32 s52, s62
  v_mfma_f32_16x16x32_bf16 v[60:63], a[236:239], v[32:35], v[60:63]
  s_waitcnt lgkmcnt(3)
  s_cbranch_scc1 pa_loop_12
  v_cvt_pk_bf16_f32 v66, v44, v45
  v_cvt_pk_bf16_f32 v67, v46, v47
  s_nop 1
  v_cvt_pk_bf16_f32 v70, v52, v53
  v_cvt_pk_bf16_f32 v71, v54, v55
  v_cvt_pk_bf16_f32 v74, v60, v61
  v_cvt_pk_bf16_f32 v75, v62, v63
  v_permlane16_swap_b32 v64, v66
  v_permlane16_swap_b32 v65, v67
  v_permlane16_swap_b32 v68, v70
  v_permlane16_swap_b32 v69, v71
  v_permlane16_swap_b32 v72, v74
  v_permlane16_swap_b32 v73, v75
  buffer_store_dwordx4 v[64:67], v8, s[8:11], s55 offen sc1
  buffer_store_dwordx4 v[68:71], v8, s[8:11], s56 offen sc1
  buffer_store_dwordx4 v[72:75], v8, s[8:11], s57 offen sc1
  v_mov_b32 v10, s52
  s_waitcnt vmcnt(0) lgkmcnt(0)
  s_barrier
  buffer_store_dword v10, v9, s[8:11], 0 offen sc1
pa_att:
  v_min_u32 v1, 19, v0
  v_cmp_lt_u32 vcc, 9, v1
  s_lshl_b32 s46, s65, 4
  s_max_u32 s47, s46, 14
  s_sub_u32 s47, s47, 14
  s_lshr_b32 s47, s47, 5
  s_lshr_b32 s48, s46, 5
  v_mov_b32 v2, s47
  v_mov_b32 v3, s48
  v_cndmask_b32 v2, v2, v3, vcc
  v_subrev_u32 v3, 10, v1
  v_cndmask_b32 v1, v1, v3, vcc
  v_mul_u32_u24 v3, 171, v2
  v_lshrrev_b32 v3, 10, v3
  v_max_u32 v4, 28, v2
  v_subrev_u32 v4, 28, v4
  v_mul_u32_u24 v4, 171, v4
  v_lshrrev_b32 v4, 9, v4
  v_max_u32 v3, v3, v4
  v_mul_u32_u24 v3, 10, v3
  v_add_u32 v1, v1, v3
  v_lshlrev_b32 v1, 7, v1
  v_add_u32 v1, 1081344, v1
  v_lshrrev_b32 v3, 4, v0
  s_lshl_b32 s47, s42, 2
  v_add_u32 v3, s47, v3
  v_mul_u32_u24 v3, 5, v3
  s_xor_b32 s47, s3, 176168960
  v_add_u32 v8, 0, v3
  v_mul_u32_u24 v4, 171, v8
  v_lshrrev_b32 v4, 12, v4
  v_mul_u32_u24 v5, 3, v4
  v_lshrrev_b32 v6, 3, v8
  v_sub_u32 v5, v6, v5
  v_and_b32 v8, 7, v8
  v_lshl_add_u32 v8, v8, 8, s47
  v_lshl_add_u32 v8, v4, 19, v8
  v_lshl_add_u32 v8, v5, 24, v8
  v_lshrrev_b32 v4, 8, v8
  v_and_b32 v4, 0x2000, v4
  v_xor_b32 v8, v8, v4
  v_add_u32 v9, 1, v3
  v_mul_u32_u24 v4, 171, v9
  v_lshrrev_b32 v4, 12, v4
  v_mul_u32_u24 v5, 3, v4
  v_lshrrev_b32 v6, 3, v9
  v_sub_u32 v5, v6, v5
  v_and_b32 v9, 7, v9
  v_lshl_add_u32 v9, v9, 8, s47
  v_lshl_add_u32 v9, v4, 19, v9
  v_lshl_add_u32 v9, v5, 24, v9
  v_lshrrev_b32 v4, 8, v9
  v_and_b32 v4, 0x2000, v4
  v_xor_b32 v9, v9, v4
  v_add_u32 v10, 2, v3
  v_mul_u32_u24 v4, 171, v10
  v_lshrrev_b32 v4, 12, v4
  v_mul_u32_u24 v5, 3, v4
  v_lshrrev_b32 v6, 3, v10
  v_sub_u32 v5, v6, v5
  v_and_b32 v10, 7, v10
  v_lshl_add_u32 v10, v10, 8, s47
  v_lshl_add_u32 v10, v4, 19, v10
  v_lshl_add_u32 v10, v5, 24, v10
  v_lshrrev_b32 v4, 8, v10
  v_and_b32 v4, 0x2000, v4
  v_xor_b32 v10, v10, v4
  v_add_u32 v11, 3, v3
  v_mul_u32_u24 v4, 171, v11
  v_lshrrev_b32 v4, 12, v4
  v_mul_u32_u24 v5, 3, v4
  v_lshrrev_b32 v6, 3, v11
  v_sub_u32 v5, v6, v5
  v_and_b32 v11, 7, v11
  v_lshl_add_u32 v11, v11, 8, s47
  v_lshl_add_u32 v11, v4, 19, v11
  v_lshl_add_u32 v11, v5, 24, v11
  v_lshrrev_b32 v4, 8, v11
  v_and_b32 v4, 0x2000, v4
  v_xor_b32 v11, v11, v4
  v_add_u32 v12, 4, v3
  v_mul_u32_u24 v4, 171, v12
  v_lshrrev_b32 v4, 12, v4
  v_mul_u32_u24 v5, 3, v4
  v_lshrrev_b32 v6, 3, v12
  v_sub_u32 v5, v6, v5
  v_and_b32 v12, 7, v12
  v_lshl_add_u32 v12, v12, 8, s47
  v_lshl_add_u32 v12, v4, 19, v12
  v_lshl_add_u32 v12, v5, 24, v12
  v_lshrrev_b32 v4, 8, v12
  v_and_b32 v4, 0x2000, v4
  v_xor_b32 v12, v12, v4
  v_add_u32 v13, 80, v3
  v_mul_u32_u24 v4, 171, v13
  v_lshrrev_b32 v4, 12, v4
  v_mul_u32_u24 v5, 3, v4
  v_lshrrev_b32 v6, 3, v13
  v_sub_u32 v5, v6, v5
  v_and_b32 v13, 7, v13
  v_lshl_add_u32 v13, v13, 8, s47
  v_lshl_add_u32 v13, v4, 19, v13
  v_lshl_add_u32 v13, v5, 24, v13
  v_lshrrev_b32 v4, 8, v13
  v_and_b32 v4, 0x2000, v4
  v_xor_b32 v13, v13, v4
  v_add_u32 v14, 81, v3
  v_mul_u32_u24 v4, 171, v14
  v_lshrrev_b32 v4, 12, v4
  v_mul_u32_u24 v5, 3, v4
  v_lshrrev_b32 v6, 3, v14
  v_sub_u32 v5, v6, v5
  v_and_b32 v14, 7, v14
  v_lshl_add_u32 v14, v14, 8, s47
  v_lshl_add_u32 v14, v4, 19, v14
  v_lshl_add_u32 v14, v5, 24, v14
  v_lshrrev_b32 v4, 8, v14
  v_and_b32 v4, 0x2000, v4
  v_xor_b32 v14, v14, v4
  v_add_u32 v15, 82, v3
  v_mul_u32_u24 v4, 171, v15
  v_lshrrev_b32 v4, 12, v4
  v_mul_u32_u24 v5, 3, v4
  v_lshrrev_b32 v6, 3, v15
  v_sub_u32 v5, v6, v5
  v_and_b32 v15, 7, v15
  v_lshl_add_u32 v15, v15, 8, s47
  v_lshl_add_u32 v15, v4, 19, v15
  v_lshl_add_u32 v15, v5, 24, v15
  v_lshrrev_b32 v4, 8, v15
  v_and_b32 v4, 0x2000, v4
  v_xor_b32 v15, v15, v4
  v_add_u32 v16, 83, v3
  v_mul_u32_u24 v4, 171, v16
  v_lshrrev_b32 v4, 12, v4
  v_mul_u32_u24 v5, 3, v4
  v_lshrrev_b32 v6, 3, v16
  v_sub_u32 v5, v6, v5
  v_and_b32 v16, 7, v16
  v_lshl_add_u32 v16, v16, 8, s47
  v_lshl_add_u32 v16, v4, 19, v16
  v_lshl_add_u32 v16, v5, 24, v16
  v_lshrrev_b32 v4, 8, v16
  v_and_b32 v4, 0x2000, v4
  v_xor_b32 v16, v16, v4
  v_add_u32 v17, 84, v3
  v_mul_u32_u24 v4, 171, v17
  v_lshrrev_b32 v4, 12, v4
  v_mul_u32_u24 v5, 3, v4
  v_lshrrev_b32 v6, 3, v17
  v_sub_u32 v5, v6, v5
  v_and_b32 v17, 7, v17
  v_lshl_add_u32 v17, v17, 8, s47
  v_lshl_add_u32 v17, v4, 19, v17
  v_lshl_add_u32 v17, v5, 24, v17
  v_lshrrev_b32 v4, 8, v17
  v_and_b32 v4, 0x2000, v4
  v_xor_b32 v17, v17, v4
  v_add_u32 v18, 160, v3
  v_mul_u32_u24 v4, 171, v18
  v_lshrrev_b32 v4, 12, v4
  v_mul_u32_u24 v5, 3, v4
  v_lshrrev_b32 v6, 3, v18
  v_sub_u32 v5, v6, v5
  v_and_b32 v18, 7, v18
  v_lshl_add_u32 v18, v18, 8, s47
  v_lshl_add_u32 v18, v4, 19, v18
  v_lshl_add_u32 v18, v5, 24, v18
  v_lshrrev_b32 v4, 8, v18
  v_and_b32 v4, 0x2000, v4
  v_xor_b32 v18, v18, v4
  v_add_u32 v19, 161, v3
  v_mul_u32_u24 v4, 171, v19
  v_lshrrev_b32 v4, 12, v4
  v_mul_u32_u24 v5, 3, v4
  v_lshrrev_b32 v6, 3, v19
  v_sub_u32 v5, v6, v5
  v_and_b32 v19, 7, v19
  v_lshl_add_u32 v19, v19, 8, s47
  v_lshl_add_u32 v19, v4, 19, v19
  v_lshl_add_u32 v19, v5, 24, v19
  v_lshrrev_b32 v4, 8, v19
  v_and_b32 v4, 0x2000, v4
  v_xor_b32 v19, v19, v4
  v_add_u32 v20, 162, v3
  v_mul_u32_u24 v4, 171, v20
  v_lshrrev_b32 v4, 12, v4
  v_mul_u32_u24 v5, 3, v4
  v_lshrrev_b32 v6, 3, v20
  v_sub_u32 v5, v6, v5
  v_and_b32 v20, 7, v20
  v_lshl_add_u32 v20, v20, 8, s47
  v_lshl_add_u32 v20, v4, 19, v20
  v_lshl_add_u32 v20, v5, 24, v20
  v_lshrrev_b32 v4, 8, v20
  v_and_b32 v4, 0x2000, v4
  v_xor_b32 v20, v20, v4
  v_add_u32 v21, 163, v3
  v_mul_u32_u24 v4, 171, v21
  v_lshrrev_b32 v4, 12, v4
  v_mul_u32_u24 v5, 3, v4
  v_lshrrev_b32 v6, 3, v21
  v_sub_u32 v5, v6, v5
  v_and_b32 v21, 7, v21
  v_lshl_add_u32 v21, v21, 8, s47
  v_lshl_add_u32 v21, v4, 19, v21
  v_lshl_add_u32 v21, v5, 24, v21
  v_lshrrev_b32 v4, 8, v21
  v_and_b32 v4, 0x2000, v4
  v_xor_b32 v21, v21, v4
  v_add_u32 v22, 164, v3
  v_mul_u32_u24 v4, 171, v22
  v_lshrrev_b32 v4, 12, v4
  v_mul_u32_u24 v5, 3, v4
  v_lshrrev_b32 v6, 3, v22
  v_sub_u32 v5, v6, v5
  v_and_b32 v22, 7, v22
  v_lshl_add_u32 v22, v22, 8, s47
  v_lshl_add_u32 v22, v4, 19, v22
  v_lshl_add_u32 v22, v5, 24, v22
  v_lshrrev_b32 v4, 8, v22
  v_and_b32 v4, 0x2000, v4
  v_xor_b32 v22, v22, v4
  v_and_b32 v5, 15, v0
  v_add_u32 v6, s46, v5
  v_subrev_u32 v4, 0, v6
  v_max_i32 v4, 0, v4
  v_and_b32 v23, 15, v4
  v_lshlrev_b32 v23, 4, v23
  v_bfe_u32 v7, v4, 4, 2
  v_lshl_add_u32 v23, v7, 11, v23
  v_lshrrev_b32 v4, 6, v4
  v_lshl_add_u32 v23, v4, 14, v23
  v_cmp_gt_u32 s[72:73], 0, v6
  v_subrev_u32 v4, 2, v6
  v_max_i32 v4, 0, v4
  v_and_b32 v24, 15, v4
  v_lshlrev_b32 v24, 4, v24
  v_bfe_u32 v7, v4, 4, 2
  v_lshl_add_u32 v24, v7, 11, v24
  v_lshrrev_b32 v4, 6, v4
  v_lshl_add_u32 v24, v4, 14, v24
  v_cmp_gt_u32 s[74:75], 2, v6
  v_subrev_u32 v4, 4, v6
  v_max_i32 v4, 0, v4
  v_and_b32 v25, 15, v4
  v_lshlrev_b32 v25, 4, v25
  v_bfe_u32 v7, v4, 4, 2
  v_lshl_add_u32 v25, v7, 11, v25
  v_lshrrev_b32 v4, 6, v4
  v_lshl_add_u32 v25, v4, 14, v25
  v_cmp_gt_u32 s[76:77], 4, v6
  v_subrev_u32 v4, 6, v6
  v_max_i32 v4, 0, v4
  v_and_b32 v26, 15, v4
  v_lshlrev_b32 v26, 4, v26
  v_bfe_u32 v7, v4, 4, 2
  v_lshl_add_u32 v26, v7, 11, v26
  v_lshrrev_b32 v4, 6, v4
  v_lshl_add_u32 v26, v4, 14, v26
  v_cmp_gt_u32 s[78:79], 6, v6
  v_subrev_u32 v4, 8, v6
  v_max_i32 v4, 0, v4
  v_and_b32 v27, 15, v4
  v_lshlrev_b32 v27, 4, v27
  v_bfe_u32 v7, v4, 4, 2
  v_lshl_add_u32 v27, v7, 11, v27
  v_lshrrev_b32 v4, 6, v4
  v_lshl_add_u32 v27, v4, 14, v27
  v_cmp_gt_u32 s[80:81], 8, v6
  v_subrev_u32 v4, 10, v6
  v_max_i32 v4, 0, v4
  v_and_b32 v28, 15, v4
  v_lshlrev_b32 v28, 4, v28
  v_bfe_u32 v7, v4, 4, 2
  v_lshl_add_u32 v28, v7, 11, v28
  v_lshrrev_b32 v4, 6, v4
  v_lshl_add_u32 v28, v4, 14, v28
  v_cmp_gt_u32 s[82:83], 10, v6
  v_subrev_u32 v4, 12, v6
  v_max_i32 v4, 0, v4
  v_and_b32 v29, 15, v4
  v_lshlrev_b32 v29, 4, v29
  v_bfe_u32 v7, v4, 4, 2
  v_lshl_add_u32 v29, v7, 11, v29
  v_lshrrev_b32 v4, 6, v4
  v_lshl_add_u32 v29, v4, 14, v29
  v_cmp_gt_u32 s[84:85], 12, v6
  v_subrev_u32 v4, 14, v6
  v_max_i32 v4, 0, v4
  v_and_b32 v30, 15, v4
  v_lshlrev_b32 v30, 4, v30
  v_bfe_u32 v7, v4, 4, 2
  v_lshl_add_u32 v30, v7, 11, v30
  v_lshrrev_b32 v4, 6, v4
  v_lshl_add_u32 v30, v4, 14, v30
  v_cmp_gt_u32 s[86:87], 14, v6
  s_mov_b32 s50, 0
  s_mov_b32 s66, 0
pa_wait:
  buffer_load_dword v4, v1, s[8:11], 0 offen sc1
  s_add_u32 s50, s50, 1
  s_cmp_gt_u32 s50, 131072
  s_cbranch_scc1 L_fail
  s_waitcnt vmcnt(0)
  v_cmp_le_u32 vcc, v4, v2
  s_cbranch_vccnz pa_wait
  v_add_u32 v232, v8, v23
  buffer_load_dwordx4 v[32:35], v232, s[8:11], s66 offen sc1
  v_add_u32 v233, v9, v23
  buffer_load_dwordx4 v[36:39], v233, s[8:11], s66 offen sc1
  v_add_u32 v234, v10, v23
  buffer_load_dwordx4 v[40:43], v234, s[8:11], s66 offen sc1
  v_add_u32 v235, v11, v23
  buffer_load_dwordx4 v[44:47], v235, s[8:11], s66 offen sc1
  v_add_u32 v236, v12, v23
  buffer_load_dwordx4 v[48:51], v236, s[8:11], s66 offen sc1
  v_add_u32 v232, v13, v23
  buffer_load_dwordx4 v[72:75], v232, s[8:11], s66 offen sc1
  v_add_u32 v233, v14, v23
  buffer_load_dwordx4 v[76:79], v233, s[8:11], s66 offen sc1
  v_add_u32 v234, v15, v23
  buffer_load_dwordx4 v[80:83], v234, s[8:11], s66 offen sc1
  v_add_u32 v235, v16, v23
  buffer_load_dwordx4 v[84:87], v235, s[8:11], s66 offen sc1
  v_add_u32 v236, v17, v23
  buffer_load_dwordx4 v[88:91], v236, s[8:11], s66 offen sc1
  v_add_u32 v232, v13, v24
  buffer_load_dwordx4 v[92:95], v232, s[8:11], s66 offen sc1
  v_add_u32 v233, v14, v24
  buffer_load_dwordx4 v[96:99], v233, s[8:11], s66 offen sc1
  v_add_u32 v234, v15, v24
  buffer_load_dwordx4 v[100:103], v234, s[8:11], s66 offen sc1
  v_add_u32 v235, v16, v24
  buffer_load_dwordx4 v[104:107], v235, s[8:11], s66 offen sc1
  v_add_u32 v236, v17, v24
  buffer_load_dwordx4 v[108:111], v236, s[8:11], s66 offen sc1
  v_add_u32 v232, v13, v25
  buffer_load_dwordx4 v[112:115], v232, s[8:11], s66 offen sc1
  v_add_u32 v233, v14, v25
  buffer_load_dwordx4 v[116:119], v233, s[8:11], s66 offen sc1
  v_add_u32 v234, v15, v25
  buffer_load_dwordx4 v[120:123], v234, s[8:11], s66 offen sc1
  v_add_u32 v235, v16, v25
  buffer_load_dwordx4 v[124:127], v235, s[8:11], s66 offen sc1
  v_add_u32 v236, v17, v25
  buffer_load_dwordx4 v[128:131], v236, s[8:11], s66 offen sc1
  v_add_u32 v232, v13, v26
  buffer_load_dwordx4 v[132:135], v232, s[8:11], s66 offen sc1
  v_add_u32 v233, v14, v26
  buffer_load_dwordx4 v[136:139], v233, s[8:11], s66 offen sc1
  v_add_u32 v234, v15, v26
  buffer_load_dwordx4 v[140:143], v234, s[8:11], s66 offen sc1
  v_add_u32 v235, v16, v26
  buffer_load_dwordx4 v[144:147], v235, s[8:11], s66 offen sc1
  v_add_u32 v236, v17, v26
  buffer_load_dwordx4 v[148:151], v236, s[8:11], s66 offen sc1
  v_add_u32 v232, v13, v27
  buffer_load_dwordx4 v[152:155], v232, s[8:11], s66 offen sc1
  v_add_u32 v233, v14, v27
  buffer_load_dwordx4 v[156:159], v233, s[8:11], s66 offen sc1
  v_add_u32 v234, v15, v27
  buffer_load_dwordx4 v[160:163], v234, s[8:11], s66 offen sc1
  v_add_u32 v235, v16, v27
  buffer_load_dwordx4 v[164:167], v235, s[8:11], s66 offen sc1
  v_add_u32 v236, v17, v27
  buffer_load_dwordx4 v[168:171], v236, s[8:11], s66 offen sc1
  v_add_u32 v232, v13, v28
  buffer_load_dwordx4 v[172:175], v232, s[8:11], s66 offen sc1
  v_add_u32 v233, v14, v28
  buffer_load_dwordx4 v[176:179], v233, s[8:11], s66 offen sc1
  v_add_u32 v234, v15, v28
  buffer_load_dwordx4 v[180:183], v234, s[8:11], s66 offen sc1
  v_add_u32 v235, v16, v28
  buffer_load_dwordx4 v[184:187], v235, s[8:11], s66 offen sc1
  v_add_u32 v236, v17, v28
  buffer_load_dwordx4 v[188:191], v236, s[8:11], s66 offen sc1
  v_add_u32 v232, v13, v29
  buffer_load_dwordx4 v[192:195], v232, s[8:11], s66 offen sc1
  v_add_u32 v233, v14, v29
  buffer_load_dwordx4 v[196:199], v233, s[8:11], s66 offen sc1
  v_add_u32 v234, v15, v29
  buffer_load_dwordx4 v[200:203], v234, s[8:11], s66 offen sc1
  v_add_u32 v235, v16, v29
  buffer_load_dwordx4 v[204:207], v235, s[8:11], s66 offen sc1
  v_add_u32 v236, v17, v29
  buffer_load_dwordx4 v[208:211], v236, s[8:11], s66 offen sc1
  v_add_u32 v232, v13, v30
  buffer_load_dwordx4 v[212:215], v232, s[8:11], s66 offen sc1
  v_add_u32 v233, v14, v30
  buffer_load_dwordx4 v[216:219], v233, s[8:11], s66 offen sc1
  v_add_u32 v234, v15, v30
  buffer_load_dwordx4 v[220:223], v234, s[8:11], s66 offen sc1
  v_add_u32 v235, v16, v30
  buffer_load_dwordx4 v[224:227], v235, s[8:11], s66 offen sc1
  v_add_u32 v236, v17, v30
  buffer_load_dwordx4 v[228:231], v236, s[8:11], s66 offen sc1
  s_waitcnt vmcnt(35)
  v_dot2_f32_bf16 v52, v32, v72, 0
  v_dot2_f32_bf16 v60, v42, v82, 0
  v_dot2_f32_bf16 v52, v33, v73, v52
  v_dot2_f32_bf16 v60, v43, v83, v60
  v_dot2_f32_bf16 v52, v34, v74, v52
  v_dot2_f32_bf16 v60, v44, v84, v60
  v_dot2_f32_bf16 v52, v35, v75, v52
  v_dot2_f32_bf16 v60, v45, v85, v60
  v_dot2_f32_bf16 v52, v36, v76, v52
  v_dot2_f32_bf16 v60, v46, v86, v60
  v_dot2_f32_bf16 v52, v37, v77, v52
  v_dot2_f32_bf16 v60, v47, v87, v60
  v_dot2_f32_bf16 v52, v38, v78, v52
  v_dot2_f32_bf16 v60, v48, v88, v60
  v_dot2_f32_bf16 v52, v39, v79, v52
  v_dot2_f32_bf16 v60, v49, v89, v60
  v_dot2_f32_bf16 v52, v40, v80, v52
  v_dot2_f32_bf16 v60, v50, v90, v60
  v_dot2_f32_bf16 v52, v41, v81, v52
  v_dot2_f32_bf16 v60, v51, v91, v60
  v_add_u32 v232, v18, v23
  buffer_load_dwordx4 v[72:75], v232, s[8:11], s66 offen sc1
  v_add_u32 v233, v19, v23
  buffer_load_dwordx4 v[76:79], v233, s[8:11], s66 offen sc1
  v_add_u32 v234, v20, v23
  buffer_load_dwordx4 v[80:83], v234, s[8:11], s66 offen sc1
  v_add_u32 v235, v21, v23
  buffer_load_dwordx4 v[84:87], v235, s[8:11], s66 offen sc1
  v_add_u32 v236, v22, v23
  buffer_load_dwordx4 v[88:91], v236, s[8:11], s66 offen sc1
  s_waitcnt vmcnt(35)
  v_dot2_f32_bf16 v53, v32, v92, 0
  v_dot2_f32_bf16 v61, v42, v102, 0
  v_dot2_f32_bf16 v53, v33, v93, v53
  v_dot2_f32_bf16 v61, v43, v103, v61
  v_dot2_f32_bf16 v53, v34, v94, v53
  v_dot2_f32_bf16 v61, v44, v104, v61
  v_dot2_f32_bf16 v53, v35, v95, v53
  v_dot2_f32_bf16 v61, v45, v105, v61
  v_dot2_f32_bf16 v53, v36, v96, v53
  v_dot2_f32_bf16 v61, v46, v106, v61
  v_dot2_f32_bf16 v53, v37, v97, v53
  v_dot2_f32_bf16 v61, v47, v107, v61
  v_dot2_f32_bf16 v53, v38, v98, v53
  v_dot2_f32_bf16 v61, v48, v108, v61
  v_dot2_f32_bf16 v53, v39, v99, v53
  v_dot2_f32_bf16 v61, v49, v109, v61
  v_dot2_f32_bf16 v53, v40, v100, v53
  v_dot2_f32_bf16 v61, v50, v110, v61
  v_dot2_f32_bf16 v53, v41, v101, v53
  v_dot2_f32_bf16 v61, v51, v111, v61
  v_add_u32 v232, v18, v24
  buffer_load_dwordx4 v[92:95], v232, s[8:11], s66 offen sc1
  v_add_u32 v233, v19, v24
  buffer_load_dwordx4 v[96:99], v233, s[8:11], s66 offen sc1
  v_add_u32 v234, v20, v24
  buffer_load_dwordx4 v[100:103], v234, s[8:11], s66 offen sc1
  v_add_u32 v235, v21, v24
  buffer_load_dwordx4 v[104:107], v235, s[8:11], s66 offen sc1
  v_add_u32 v236, v22, v24
  buffer_load_dwordx4 v[108:111], v236, s[8:11], s66 offen sc1
  s_waitcnt vmcnt(35)
  v_dot2_f32_bf16 v54, v32, v112, 0
  v_dot2_f32_bf16 v62, v42, v122, 0
  v_dot2_f32_bf16 v54, v33, v113, v54
  v_dot2_f32_bf16 v62, v43, v123, v62
  v_dot2_f32_bf16 v54, v34, v114, v54
  v_dot2_f32_bf16 v62, v44, v124, v62
  v_dot2_f32_bf16 v54, v35, v115, v54
  v_dot2_f32_bf16 v62, v45, v125, v62
  v_dot2_f32_bf16 v54, v36, v116, v54
  v_dot2_f32_bf16 v62, v46, v126, v62
  v_dot2_f32_bf16 v54, v37, v117, v54
  v_dot2_f32_bf16 v62, v47, v127, v62
  v_dot2_f32_bf16 v54, v38, v118, v54
  v_dot2_f32_bf16 v62, v48, v128, v62
  v_dot2_f32_bf16 v54, v39, v119, v54
  v_dot2_f32_bf16 v62, v49, v129, v62
  v_dot2_f32_bf16 v54, v40, v120, v54
  v_dot2_f32_bf16 v62, v50, v130, v62
  v_dot2_f32_bf16 v54, v41, v121, v54
  v_dot2_f32_bf16 v62, v51, v131, v62
  v_add_u32 v232, v18, v25
  buffer_load_dwordx4 v[112:115], v232, s[8:11], s66 offen sc1
  v_add_u32 v233, v19, v25
  buffer_load_dwordx4 v[116:119], v233, s[8:11], s66 offen sc1
  v_add_u32 v234, v20, v25
  buffer_load_dwordx4 v[120:123], v234, s[8:11], s66 offen sc1
  v_add_u32 v235, v21, v25
  buffer_load_dwordx4 v[124:127], v235, s[8:11], s66 offen sc1
  v_add_u32 v236, v22, v25
  buffer_load_dwordx4 v[128:131], v236, s[8:11], s66 offen sc1
  s_waitcnt vmcnt(35)
  v_dot2_f32_bf16 v55, v32, v132, 0
  v_dot2_f32_bf16 v63, v42, v142, 0
  v_dot2_f32_bf16 v55, v33, v133, v55
  v_dot2_f32_bf16 v63, v43, v143, v63
  v_dot2_f32_bf16 v55, v34, v134, v55
  v_dot2_f32_bf16 v63, v44, v144, v63
  v_dot2_f32_bf16 v55, v35, v135, v55
  v_dot2_f32_bf16 v63, v45, v145, v63
  v_dot2_f32_bf16 v55, v36, v136, v55
  v_dot2_f32_bf16 v63, v46, v146, v63
  v_dot2_f32_bf16 v55, v37, v137, v55
  v_dot2_f32_bf16 v63, v47, v147, v63
  v_dot2_f32_bf16 v55, v38, v138, v55
  v_dot2_f32_bf16 v63, v48, v148, v63
  v_dot2_f32_bf16 v55, v39, v139, v55
  v_dot2_f32_bf16 v63, v49, v149, v63
  v_dot2_f32_bf16 v55, v40, v140, v55
  v_dot2_f32_bf16 v63, v50, v150, v63
  v_dot2_f32_bf16 v55, v41, v141, v55
  v_dot2_f32_bf16 v63, v51, v151, v63
  v_add_u32 v232, v18, v26
  buffer_load_dwordx4 v[132:135], v232, s[8:11], s66 offen sc1
  v_add_u32 v233, v19, v26
  buffer_load_dwordx4 v[136:139], v233, s[8:11], s66 offen sc1
  v_add_u32 v234, v20, v26
  buffer_load_dwordx4 v[140:143], v234, s[8:11], s66 offen sc1
  v_add_u32 v235, v21, v26
  buffer_load_dwordx4 v[144:147], v235, s[8:11], s66 offen sc1
  v_add_u32 v236, v22, v26
  buffer_load_dwordx4 v[148:151], v236, s[8:11], s66 offen sc1
  s_waitcnt vmcnt(35)
  v_dot2_f32_bf16 v56, v32, v152, 0
  v_dot2_f32_bf16 v64, v42, v162, 0
  v_dot2_f32_bf16 v56, v33, v153, v56
  v_dot2_f32_bf16 v64, v43, v163, v64
  v_dot2_f32_bf16 v56, v34, v154, v56
  v_dot2_f32_bf16 v64, v44, v164, v64
  v_dot2_f32_bf16 v56, v35, v155, v56
  v_dot2_f32_bf16 v64, v45, v165, v64
  v_dot2_f32_bf16 v56, v36, v156, v56
  v_dot2_f32_bf16 v64, v46, v166, v64
  v_dot2_f32_bf16 v56, v37, v157, v56
  v_dot2_f32_bf16 v64, v47, v167, v64
  v_dot2_f32_bf16 v56, v38, v158, v56
  v_dot2_f32_bf16 v64, v48, v168, v64
  v_dot2_f32_bf16 v56, v39, v159, v56
  v_dot2_f32_bf16 v64, v49, v169, v64
  v_dot2_f32_bf16 v56, v40, v160, v56
  v_dot2_f32_bf16 v64, v50, v170, v64
  v_dot2_f32_bf16 v56, v41, v161, v56
  v_dot2_f32_bf16 v64, v51, v171, v64
  v_add_u32 v232, v18, v27
  buffer_load_dwordx4 v[152:155], v232, s[8:11], s66 offen sc1
  v_add_u32 v233, v19, v27
  buffer_load_dwordx4 v[156:159], v233, s[8:11], s66 offen sc1
  v_add_u32 v234, v20, v27
  buffer_load_dwordx4 v[160:163], v234, s[8:11], s66 offen sc1
  v_add_u32 v235, v21, v27
  buffer_load_dwordx4 v[164:167], v235, s[8:11], s66 offen sc1
  v_add_u32 v236, v22, v27
  buffer_load_dwordx4 v[168:171], v236, s[8:11], s66 offen sc1
  s_waitcnt vmcnt(35)
  v_dot2_f32_bf16 v57, v32, v172, 0
  v_dot2_f32_bf16 v65, v42, v182, 0
  v_dot2_f32_bf16 v57, v33, v173, v57
  v_dot2_f32_bf16 v65, v43, v183, v65
  v_dot2_f32_bf16 v57, v34, v174, v57
  v_dot2_f32_bf16 v65, v44, v184, v65
  v_dot2_f32_bf16 v57, v35, v175, v57
  v_dot2_f32_bf16 v65, v45, v185, v65
  v_dot2_f32_bf16 v57, v36, v176, v57
  v_dot2_f32_bf16 v65, v46, v186, v65
  v_dot2_f32_bf16 v57, v37, v177, v57
  v_dot2_f32_bf16 v65, v47, v187, v65
  v_dot2_f32_bf16 v57, v38, v178, v57
  v_dot2_f32_bf16 v65, v48, v188, v65
  v_dot2_f32_bf16 v57, v39, v179, v57
  v_dot2_f32_bf16 v65, v49, v189, v65
  v_dot2_f32_bf16 v57, v40, v180, v57
  v_dot2_f32_bf16 v65, v50, v190, v65
  v_dot2_f32_bf16 v57, v41, v181, v57
  v_dot2_f32_bf16 v65, v51, v191, v65
  v_add_u32 v232, v18, v28
  buffer_load_dwordx4 v[172:175], v232, s[8:11], s66 offen sc1
  v_add_u32 v233, v19, v28
  buffer_load_dwordx4 v[176:179], v233, s[8:11], s66 offen sc1
  v_add_u32 v234, v20, v28
  buffer_load_dwordx4 v[180:183], v234, s[8:11], s66 offen sc1
  v_add_u32 v235, v21, v28
  buffer_load_dwordx4 v[184:187], v235, s[8:11], s66 offen sc1
  v_add_u32 v236, v22, v28
  buffer_load_dwordx4 v[188:191], v236, s[8:11], s66 offen sc1
  s_waitcnt vmcnt(35)
  v_dot2_f32_bf16 v58, v32, v192, 0
  v_dot2_f32_bf16 v66, v42, v202, 0
  v_dot2_f32_bf16 v58, v33, v193, v58
  v_dot2_f32_bf16 v66, v43, v203, v66
  v_dot2_f32_bf16 v58, v34, v194, v58
  v_dot2_f32_bf16 v66, v44, v204, v66
  v_dot2_f32_bf16 v58, v35, v195, v58
  v_dot2_f32_bf16 v66, v45, v205, v66
  v_dot2_f32_bf16 v58, v36, v196, v58
  v_dot2_f32_bf16 v66, v46, v206, v66
  v_dot2_f32_bf16 v58, v37, v197, v58
  v_dot2_f32_bf16 v66, v47, v207, v66
  v_dot2_f32_bf16 v58, v38, v198, v58
  v_dot2_f32_bf16 v66, v48, v208, v66
  v_dot2_f32_bf16 v58, v39, v199, v58
  v_dot2_f32_bf16 v66, v49, v209, v66
  v_dot2_f32_bf16 v58, v40, v200, v58
  v_dot2_f32_bf16 v66, v50, v210, v66
  v_dot2_f32_bf16 v58, v41, v201, v58
  v_dot2_f32_bf16 v66, v51, v211, v66
  v_add_u32 v232, v18, v29
  buffer_load_dwordx4 v[192:195], v232, s[8:11], s66 offen sc1
  v_add_u32 v233, v19, v29
  buffer_load_dwordx4 v[196:199], v233, s[8:11], s66 offen sc1
  v_add_u32 v234, v20, v29
  buffer_load_dwordx4 v[200:203], v234, s[8:11], s66 offen sc1
  v_add_u32 v235, v21, v29
  buffer_load_dwordx4 v[204:207], v235, s[8:11], s66 offen sc1
  v_add_u32 v236, v22, v29
  buffer_load_dwordx4 v[208:211], v236, s[8:11], s66 offen sc1
  s_waitcnt vmcnt(35)
  v_dot2_f32_bf16 v59, v32, v212, 0
  v_dot2_f32_bf16 v67, v42, v222, 0
  v_dot2_f32_bf16 v59, v33, v213, v59
  v_dot2_f32_bf16 v67, v43, v223, v67
  v_dot2_f32_bf16 v59, v34, v214, v59
  v_dot2_f32_bf16 v67, v44, v224, v67
  v_dot2_f32_bf16 v59, v35, v215, v59
  v_dot2_f32_bf16 v67, v45, v225, v67
  v_dot2_f32_bf16 v59, v36, v216, v59
  v_dot2_f32_bf16 v67, v46, v226, v67
  v_dot2_f32_bf16 v59, v37, v217, v59
  v_dot2_f32_bf16 v67, v47, v227, v67
  v_dot2_f32_bf16 v59, v38, v218, v59
  v_dot2_f32_bf16 v67, v48, v228, v67
  v_dot2_f32_bf16 v59, v39, v219, v59
  v_dot2_f32_bf16 v67, v49, v229, v67
  v_dot2_f32_bf16 v59, v40, v220, v59
  v_dot2_f32_bf16 v67, v50, v230, v67
  v_dot2_f32_bf16 v59, v41, v221, v59
  v_dot2_f32_bf16 v67, v51, v231, v67
  v_add_u32 v232, v18, v30
  buffer_load_dwordx4 v[212:215], v232, s[8:11], s66 offen sc1
  v_add_u32 v233, v19, v30
  buffer_load_dwordx4 v[216:219], v233, s[8:11], s66 offen sc1
  v_add_u32 v234, v20, v30
  buffer_load_dwordx4 v[220:223], v234, s[8:11], s66 offen sc1
  v_add_u32 v235, v21, v30
  buffer_load_dwordx4 v[224:227], v235, s[8:11], s66 offen sc1
  v_add_u32 v236, v22, v30
  buffer_load_dwordx4 v[228:231], v236, s[8:11], s66 offen sc1
  s_mov_b32 s46, 1051011932
  v_mov_b32 v232, 3481618353
  v_cndmask_b32 v53, v53, v232, s[74:75]
  v_cndmask_b32 v54, v54, v232, s[76:77]
  v_cndmask_b32 v55, v55, v232, s[78:79]
  v_cndmask_b32 v56, v56, v232, s[80:81]
  v_cndmask_b32 v57, v57, v232, s[82:83]
  v_cndmask_b32 v58, v58, v232, s[84:85]
  v_cndmask_b32 v59, v59, v232, s[86:87]
  v_max_f32 v233, v52, v53
  v_max3_f32 v233, v233, v54, v55
  v_max3_f32 v233, v233, v56, v57
  v_max3_f32 v233, v233, v58, v59
  v_mul_f32 v233, s46, v233
  v_fma_f32 v52, v52, s46, -v233
  v_fma_f32 v53, v53, s46, -v233
  v_fma_f32 v54, v54, s46, -v233
  v_fma_f32 v55, v55, s46, -v233
  v_fma_f32 v56, v56, s46, -v233
  v_fma_f32 v57, v57, s46, -v233
  v_fma_f32 v58, v58, s46, -v233
  v_fma_f32 v59, v59, s46, -v233
  v_exp_f32 v52, v52
  v_exp_f32 v53, v53
  v_exp_f32 v54, v54
  v_exp_f32 v55, v55
  v_exp_f32 v56, v56
  v_exp_f32 v57, v57
  v_exp_f32 v58, v58
  v_exp_f32 v59, v59
  v_add_f32 v233, v52, v53
  v_add_f32 v233, v233, v54
  v_add_f32 v233, v233, v55
  v_add_f32 v233, v233, v56
  v_add_f32 v233, v233, v57
  v_add_f32 v233, v233, v58
  v_add_f32 v233, v233, v59
  v_rcp_f32 v233, v233
  s_nop 0
  v_mul_f32 v52, v52, v233
  v_mul_f32 v53, v53, v233
  v_mul_f32 v54, v54, v233
  v_mul_f32 v55, v55, v233
  v_mul_f32 v56, v56, v233
  v_mul_f32 v57, v57, v233
  v_mul_f32 v58, v58, v233
  v_mul_f32 v59, v59, v233
  v_cndmask_b32 v61, v61, v232, s[74:75]
  v_cndmask_b32 v62, v62, v232, s[76:77]
  v_cndmask_b32 v63, v63, v232, s[78:79]
  v_cndmask_b32 v64, v64, v232, s[80:81]
  v_cndmask_b32 v65, v65, v232, s[82:83]
  v_cndmask_b32 v66, v66, v232, s[84:85]
  v_cndmask_b32 v67, v67, v232, s[86:87]
  v_max_f32 v233, v60, v61
  v_max3_f32 v233, v233, v62, v63
  v_max3_f32 v233, v233, v64, v65
  v_max3_f32 v233, v233, v66, v67
  v_mul_f32 v233, s46, v233
  v_fma_f32 v60, v60, s46, -v233
  v_fma_f32 v61, v61, s46, -v233
  v_fma_f32 v62, v62, s46, -v233
  v_fma_f32 v63, v63, s46, -v233
  v_fma_f32 v64, v64, s46, -v233
  v_fma_f32 v65, v65, s46, -v233
  v_fma_f32 v66, v66, s46, -v233
  v_fma_f32 v67, v67, s46, -v233
  v_exp_f32 v60, v60
  v_exp_f32 v61, v61
  v_exp_f32 v62, v62
  v_exp_f32 v63, v63
  v_exp_f32 v64, v64
  v_exp_f32 v65, v65
  v_exp_f32 v66, v66
  v_exp_f32 v67, v67
  v_add_f32 v233, v60, v61
  v_add_f32 v233, v233, v62
  v_add_f32 v233, v233, v63
  v_add_f32 v233, v233, v64
  v_add_f32 v233, v233, v65
  v_add_f32 v233, v233, v66
  v_add_f32 v233, v233, v67
  v_rcp_f32 v233, v233
  s_nop 0
  v_mul_f32 v60, v60, v233
  v_mul_f32 v61, v61, v233
  v_mul_f32 v62, v62, v233
  v_mul_f32 v63, v63, v233
  v_mul_f32 v64, v64, v233
  v_mul_f32 v65, v65, v233
  v_mul_f32 v66, v66, v233
  v_mul_f32 v67, v67, v233
  v_cvt_pk_bf16_f32 v52, v52, 0
  v_lshlrev_b32 v236, 16, v52
  v_cvt_pk_bf16_f32 v53, v53, 0
  v_lshlrev_b32 v237, 16, v53
  v_cvt_pk_bf16_f32 v54, v54, 0
  v_lshlrev_b32 v238, 16, v54
  v_cvt_pk_bf16_f32 v55, v55, 0
  v_lshlrev_b32 v239, 16, v55
  v_cvt_pk_bf16_f32 v56, v56, 0
  v_lshlrev_b32 v240, 16, v56
  v_cvt_pk_bf16_f32 v57, v57, 0
  v_lshlrev_b32 v241, 16, v57
  v_cvt_pk_bf16_f32 v58, v58, 0
  v_lshlrev_b32 v242, 16, v58
  v_cvt_pk_bf16_f32 v59, v59, 0
  v_lshlrev_b32 v243, 16, v59
  v_cvt_pk_bf16_f32 v60, v60, 0
  v_lshlrev_b32 v244, 16, v60
  v_cvt_pk_bf16_f32 v61, v61, 0
  v_lshlrev_b32 v245, 16, v61
  v_cvt_pk_bf16_f32 v62, v62, 0
  v_lshlrev_b32 v246, 16, v62
  v_cvt_pk_bf16_f32 v63, v63, 0
  v_lshlrev_b32 v247, 16, v63
  v_cvt_pk_bf16_f32 v64, v64, 0
  v_lshlrev_b32 v248, 16, v64
  v_cvt_pk_bf16_f32 v65, v65, 0
  v_lshlrev_b32 v249, 16, v65
  v_cvt_pk_bf16_f32 v66, v66, 0
  v_lshlrev_b32 v250, 16, v66
  v_cvt_pk_bf16_f32 v67, v67, 0
  v_lshlrev_b32 v251, 16, v67
  s_waitcnt vmcnt(35)
  v_dot2_f32_bf16 v8, v72, v52, 0
  v_dot2_f32_bf16 v9, v72, v236, 0
  v_dot2_f32_bf16 v10, v73, v52, 0
  v_dot2_f32_bf16 v11, v73, v236, 0
  v_dot2_f32_bf16 v12, v74, v52, 0
  v_dot2_f32_bf16 v13, v74, v236, 0
  v_dot2_f32_bf16 v14, v75, v52, 0
  v_dot2_f32_bf16 v15, v75, v236, 0
  v_dot2_f32_bf16 v16, v76, v52, 0
  v_dot2_f32_bf16 v17, v76, v236, 0
  v_dot2_f32_bf16 v18, v77, v52, 0
  v_dot2_f32_bf16 v19, v77, v236, 0
  v_dot2_f32_bf16 v20, v78, v52, 0
  v_dot2_f32_bf16 v21, v78, v236, 0
  v_dot2_f32_bf16 v22, v79, v52, 0
  v_dot2_f32_bf16 v23, v79, v236, 0
  v_dot2_f32_bf16 v24, v80, v52, 0
  v_dot2_f32_bf16 v25, v80, v236, 0
  v_dot2_f32_bf16 v26, v81, v52, 0
  v_dot2_f32_bf16 v27, v81, v236, 0
  v_dot2_f32_bf16 v28, v82, v60, 0
  v_dot2_f32_bf16 v29, v82, v244, 0
  v_dot2_f32_bf16 v30, v83, v60, 0
  v_dot2_f32_bf16 v31, v83, v244, 0
  v_dot2_f32_bf16 v32, v84, v60, 0
  v_dot2_f32_bf16 v33, v84, v244, 0
  v_dot2_f32_bf16 v34, v85, v60, 0
  v_dot2_f32_bf16 v35, v85, v244, 0
  v_dot2_f32_bf16 v36, v86, v60, 0
  v_dot2_f32_bf16 v37, v86, v244, 0
  v_dot2_f32_bf16 v38, v87, v60, 0
  v_dot2_f32_bf16 v39, v87, v244, 0
  v_dot2_f32_bf16 v40, v88, v60, 0
  v_dot2_f32_bf16 v41, v88, v244, 0
  v_dot2_f32_bf16 v42, v89, v60, 0
  v_dot2_f32_bf16 v43, v89, v244, 0
  v_dot2_f32_bf16 v44, v90, v60, 0
  v_dot2_f32_bf16 v45, v90, v244, 0
  v_dot2_f32_bf16 v46, v91, v60, 0
  v_dot2_f32_bf16 v47, v91, v244, 0
  s_waitcnt vmcnt(30)
  v_dot2_f32_bf16 v8, v92, v53, v8
  v_dot2_f32_bf16 v9, v92, v237, v9
  v_dot2_f32_bf16 v10, v93, v53, v10
  v_dot2_f32_bf16 v11, v93, v237, v11
  v_dot2_f32_bf16 v12, v94, v53, v12
  v_dot2_f32_bf16 v13, v94, v237, v13
  v_dot2_f32_bf16 v14, v95, v53, v14
  v_dot2_f32_bf16 v15, v95, v237, v15
  v_dot2_f32_bf16 v16, v96, v53, v16
  v_dot2_f32_bf16 v17, v96, v237, v17
  v_dot2_f32_bf16 v18, v97, v53, v18
  v_dot2_f32_bf16 v19, v97, v237, v19
  v_dot2_f32_bf16 v20, v98, v53, v20
  v_dot2_f32_bf16 v21, v98, v237, v21
  v_dot2_f32_bf16 v22, v99, v53, v22
  v_dot2_f32_bf16 v23, v99, v237, v23
  v_dot2_f32_bf16 v24, v100, v53, v24
  v_dot2_f32_bf16 v25, v100, v237, v25
  v_dot2_f32_bf16 v26, v101, v53, v26
  v_dot2_f32_bf16 v27, v101, v237, v27
  v_dot2_f32_bf16 v28, v102, v61, v28
  v_dot2_f32_bf16 v29, v102, v245, v29
  v_dot2_f32_bf16 v30, v103, v61, v30
  v_dot2_f32_bf16 v31, v103, v245, v31
  v_dot2_f32_bf16 v32, v104, v61, v32
  v_dot2_f32_bf16 v33, v104, v245, v33
  v_dot2_f32_bf16 v34, v105, v61, v34
  v_dot2_f32_bf16 v35, v105, v245, v35
  v_dot2_f32_bf16 v36, v106, v61, v36
  v_dot2_f32_bf16 v37, v106, v245, v37
  v_dot2_f32_bf16 v38, v107, v61, v38
  v_dot2_f32_bf16 v39, v107, v245, v39
  v_dot2_f32_bf16 v40, v108, v61, v40
  v_dot2_f32_bf16 v41, v108, v245, v41
  v_dot2_f32_bf16 v42, v109, v61, v42
  v_dot2_f32_bf16 v43, v109, v245, v43
  v_dot2_f32_bf16 v44, v110, v61, v44
  v_dot2_f32_bf16 v45, v110, v245, v45
  v_dot2_f32_bf16 v46, v111, v61, v46
  v_dot2_f32_bf16 v47, v111, v245, v47
  s_waitcnt vmcnt(25)
  v_dot2_f32_bf16 v8, v112, v54, v8
  v_dot2_f32_bf16 v9, v112, v238, v9
  v_dot2_f32_bf16 v10, v113, v54, v10
  v_dot2_f32_bf16 v11, v113, v238, v11
  v_dot2_f32_bf16 v12, v114, v54, v12
  v_dot2_f32_bf16 v13, v114, v238, v13
  v_dot2_f32_bf16 v14, v115, v54, v14
  v_dot2_f32_bf16 v15, v115, v238, v15
  v_dot2_f32_bf16 v16, v116, v54, v16
  v_dot2_f32_bf16 v17, v116, v238, v17
  v_dot2_f32_bf16 v18, v117, v54, v18
  v_dot2_f32_bf16 v19, v117, v238, v19
  v_dot2_f32_bf16 v20, v118, v54, v20
  v_dot2_f32_bf16 v21, v118, v238, v21
  v_dot2_f32_bf16 v22, v119, v54, v22
  v_dot2_f32_bf16 v23, v119, v238, v23
  v_dot2_f32_bf16 v24, v120, v54, v24
  v_dot2_f32_bf16 v25, v120, v238, v25
  v_dot2_f32_bf16 v26, v121, v54, v26
  v_dot2_f32_bf16 v27, v121, v238, v27
  v_dot2_f32_bf16 v28, v122, v62, v28
  v_dot2_f32_bf16 v29, v122, v246, v29
  v_dot2_f32_bf16 v30, v123, v62, v30
  v_dot2_f32_bf16 v31, v123, v246, v31
  v_dot2_f32_bf16 v32, v124, v62, v32
  v_dot2_f32_bf16 v33, v124, v246, v33
  v_dot2_f32_bf16 v34, v125, v62, v34
  v_dot2_f32_bf16 v35, v125, v246, v35
  v_dot2_f32_bf16 v36, v126, v62, v36
  v_dot2_f32_bf16 v37, v126, v246, v37
  v_dot2_f32_bf16 v38, v127, v62, v38
  v_dot2_f32_bf16 v39, v127, v246, v39
  v_dot2_f32_bf16 v40, v128, v62, v40
  v_dot2_f32_bf16 v41, v128, v246, v41
  v_dot2_f32_bf16 v42, v129, v62, v42
  v_dot2_f32_bf16 v43, v129, v246, v43
  v_dot2_f32_bf16 v44, v130, v62, v44
  v_dot2_f32_bf16 v45, v130, v246, v45
  v_dot2_f32_bf16 v46, v131, v62, v46
  v_dot2_f32_bf16 v47, v131, v246, v47
  s_waitcnt vmcnt(20)
  v_dot2_f32_bf16 v8, v132, v55, v8
  v_dot2_f32_bf16 v9, v132, v239, v9
  v_dot2_f32_bf16 v10, v133, v55, v10
  v_dot2_f32_bf16 v11, v133, v239, v11
  v_dot2_f32_bf16 v12, v134, v55, v12
  v_dot2_f32_bf16 v13, v134, v239, v13
  v_dot2_f32_bf16 v14, v135, v55, v14
  v_dot2_f32_bf16 v15, v135, v239, v15
  v_dot2_f32_bf16 v16, v136, v55, v16
  v_dot2_f32_bf16 v17, v136, v239, v17
  v_dot2_f32_bf16 v18, v137, v55, v18
  v_dot2_f32_bf16 v19, v137, v239, v19
  v_dot2_f32_bf16 v20, v138, v55, v20
  v_dot2_f32_bf16 v21, v138, v239, v21
  v_dot2_f32_bf16 v22, v139, v55, v22
  v_dot2_f32_bf16 v23, v139, v239, v23
  v_dot2_f32_bf16 v24, v140, v55, v24
  v_dot2_f32_bf16 v25, v140, v239, v25
  v_dot2_f32_bf16 v26, v141, v55, v26
  v_dot2_f32_bf16 v27, v141, v239, v27
  v_dot2_f32_bf16 v28, v142, v63, v28
  v_dot2_f32_bf16 v29, v142, v247, v29
  v_dot2_f32_bf16 v30, v143, v63, v30
  v_dot2_f32_bf16 v31, v143, v247, v31
  v_dot2_f32_bf16 v32, v144, v63, v32
  v_dot2_f32_bf16 v33, v144, v247, v33
  v_dot2_f32_bf16 v34, v145, v63, v34
  v_dot2_f32_bf16 v35, v145, v247, v35
  v_dot2_f32_bf16 v36, v146, v63, v36
  v_dot2_f32_bf16 v37, v146, v247, v37
  v_dot2_f32_bf16 v38, v147, v63, v38
  v_dot2_f32_bf16 v39, v147, v247, v39
  v_dot2_f32_bf16 v40, v148, v63, v40
  v_dot2_f32_bf16 v41, v148, v247, v41
  v_dot2_f32_bf16 v42, v149, v63, v42
  v_dot2_f32_bf16 v43, v149, v247, v43
  v_dot2_f32_bf16 v44, v150, v63, v44
  v_dot2_f32_bf16 v45, v150, v247, v45
  v_dot2_f32_bf16 v46, v151, v63, v46
  v_dot2_f32_bf16 v47, v151, v247, v47
  s_waitcnt vmcnt(15)
  v_dot2_f32_bf16 v8, v152, v56, v8
  v_dot2_f32_bf16 v9, v152, v240, v9
  v_dot2_f32_bf16 v10, v153, v56, v10
  v_dot2_f32_bf16 v11, v153, v240, v11
  v_dot2_f32_bf16 v12, v154, v56, v12
  v_dot2_f32_bf16 v13, v154, v240, v13
  v_dot2_f32_bf16 v14, v155, v56, v14
  v_dot2_f32_bf16 v15, v155, v240, v15
  v_dot2_f32_bf16 v16, v156, v56, v16
  v_dot2_f32_bf16 v17, v156, v240, v17
  v_dot2_f32_bf16 v18, v157, v56, v18
  v_dot2_f32_bf16 v19, v157, v240, v19
  v_dot2_f32_bf16 v20, v158, v56, v20
  v_dot2_f32_bf16 v21, v158, v240, v21
  v_dot2_f32_bf16 v22, v159, v56, v22
  v_dot2_f32_bf16 v23, v159, v240, v23
  v_dot2_f32_bf16 v24, v160, v56, v24
  v_dot2_f32_bf16 v25, v160, v240, v25
  v_dot2_f32_bf16 v26, v161, v56, v26
  v_dot2_f32_bf16 v27, v161, v240, v27
  v_dot2_f32_bf16 v28, v162, v64, v28
  v_dot2_f32_bf16 v29, v162, v248, v29
  v_dot2_f32_bf16 v30, v163, v64, v30
  v_dot2_f32_bf16 v31, v163, v248, v31
  v_dot2_f32_bf16 v32, v164, v64, v32
  v_dot2_f32_bf16 v33, v164, v248, v33
  v_dot2_f32_bf16 v34, v165, v64, v34
  v_dot2_f32_bf16 v35, v165, v248, v35
  v_dot2_f32_bf16 v36, v166, v64, v36
  v_dot2_f32_bf16 v37, v166, v248, v37
  v_dot2_f32_bf16 v38, v167, v64, v38
  v_dot2_f32_bf16 v39, v167, v248, v39
  v_dot2_f32_bf16 v40, v168, v64, v40
  v_dot2_f32_bf16 v41, v168, v248, v41
  v_dot2_f32_bf16 v42, v169, v64, v42
  v_dot2_f32_bf16 v43, v169, v248, v43
  v_dot2_f32_bf16 v44, v170, v64, v44
  v_dot2_f32_bf16 v45, v170, v248, v45
  v_dot2_f32_bf16 v46, v171, v64, v46
  v_dot2_f32_bf16 v47, v171, v248, v47
  s_waitcnt vmcnt(10)
  v_dot2_f32_bf16 v8, v172, v57, v8
  v_dot2_f32_bf16 v9, v172, v241, v9
  v_dot2_f32_bf16 v10, v173, v57, v10
  v_dot2_f32_bf16 v11, v173, v241, v11
  v_dot2_f32_bf16 v12, v174, v57, v12
  v_dot2_f32_bf16 v13, v174, v241, v13
  v_dot2_f32_bf16 v14, v175, v57, v14
  v_dot2_f32_bf16 v15, v175, v241, v15
  v_dot2_f32_bf16 v16, v176, v57, v16
  v_dot2_f32_bf16 v17, v176, v241, v17
  v_dot2_f32_bf16 v18, v177, v57, v18
  v_dot2_f32_bf16 v19, v177, v241, v19
  v_dot2_f32_bf16 v20, v178, v57, v20
  v_dot2_f32_bf16 v21, v178, v241, v21
  v_dot2_f32_bf16 v22, v179, v57, v22
  v_dot2_f32_bf16 v23, v179, v241, v23
  v_dot2_f32_bf16 v24, v180, v57, v24
  v_dot2_f32_bf16 v25, v180, v241, v25
  v_dot2_f32_bf16 v26, v181, v57, v26
  v_dot2_f32_bf16 v27, v181, v241, v27
  v_dot2_f32_bf16 v28, v182, v65, v28
  v_dot2_f32_bf16 v29, v182, v249, v29
  v_dot2_f32_bf16 v30, v183, v65, v30
  v_dot2_f32_bf16 v31, v183, v249, v31
  v_dot2_f32_bf16 v32, v184, v65, v32
  v_dot2_f32_bf16 v33, v184, v249, v33
  v_dot2_f32_bf16 v34, v185, v65, v34
  v_dot2_f32_bf16 v35, v185, v249, v35
  v_dot2_f32_bf16 v36, v186, v65, v36
  v_dot2_f32_bf16 v37, v186, v249, v37
  v_dot2_f32_bf16 v38, v187, v65, v38
  v_dot2_f32_bf16 v39, v187, v249, v39
  v_dot2_f32_bf16 v40, v188, v65, v40
  v_dot2_f32_bf16 v41, v188, v249, v41
  v_dot2_f32_bf16 v42, v189, v65, v42
  v_dot2_f32_bf16 v43, v189, v249, v43
  v_dot2_f32_bf16 v44, v190, v65, v44
  v_dot2_f32_bf16 v45, v190, v249, v45
  v_dot2_f32_bf16 v46, v191, v65, v46
  v_dot2_f32_bf16 v47, v191, v249, v47
  s_waitcnt vmcnt(5)
  v_dot2_f32_bf16 v8, v192, v58, v8
  v_dot2_f32_bf16 v9, v192, v242, v9
  v_dot2_f32_bf16 v10, v193, v58, v10
  v_dot2_f32_bf16 v11, v193, v242, v11
  v_dot2_f32_bf16 v12, v194, v58, v12
  v_dot2_f32_bf16 v13, v194, v242, v13
  v_dot2_f32_bf16 v14, v195, v58, v14
  v_dot2_f32_bf16 v15, v195, v242, v15
  v_dot2_f32_bf16 v16, v196, v58, v16
  v_dot2_f32_bf16 v17, v196, v242, v17
  v_dot2_f32_bf16 v18, v197, v58, v18
  v_dot2_f32_bf16 v19, v197, v242, v19
  v_dot2_f32_bf16 v20, v198, v58, v20
  v_dot2_f32_bf16 v21, v198, v242, v21
  v_dot2_f32_bf16 v22, v199, v58, v22
  v_dot2_f32_bf16 v23, v199, v242, v23
  v_dot2_f32_bf16 v24, v200, v58, v24
  v_dot2_f32_bf16 v25, v200, v242, v25
  v_dot2_f32_bf16 v26, v201, v58, v26
  v_dot2_f32_bf16 v27, v201, v242, v27
  v_dot2_f32_bf16 v28, v202, v66, v28
  v_dot2_f32_bf16 v29, v202, v250, v29
  v_dot2_f32_bf16 v30, v203, v66, v30
  v_dot2_f32_bf16 v31, v203, v250, v31
  v_dot2_f32_bf16 v32, v204, v66, v32
  v_dot2_f32_bf16 v33, v204, v250, v33
  v_dot2_f32_bf16 v34, v205, v66, v34
  v_dot2_f32_bf16 v35, v205, v250, v35
  v_dot2_f32_bf16 v36, v206, v66, v36
  v_dot2_f32_bf16 v37, v206, v250, v37
  v_dot2_f32_bf16 v38, v207, v66, v38
  v_dot2_f32_bf16 v39, v207, v250, v39
  v_dot2_f32_bf16 v40, v208, v66, v40
  v_dot2_f32_bf16 v41, v208, v250, v41
  v_dot2_f32_bf16 v42, v209, v66, v42
  v_dot2_f32_bf16 v43, v209, v250, v43
  v_dot2_f32_bf16 v44, v210, v66, v44
  v_dot2_f32_bf16 v45, v210, v250, v45
  v_dot2_f32_bf16 v46, v211, v66, v46
  v_dot2_f32_bf16 v47, v211, v250, v47
  s_waitcnt vmcnt(0)
  v_dot2_f32_bf16 v8, v212, v59, v8
  v_dot2_f32_bf16 v9, v212, v243, v9
  v_dot2_f32_bf16 v10, v213, v59, v10
  v_dot2_f32_bf16 v11, v213, v243, v11
  v_dot2_f32_bf16 v12, v214, v59, v12
  v_dot2_f32_bf16 v13, v214, v243, v13
  v_dot2_f32_bf16 v14, v215, v59, v14
  v_dot2_f32_bf16 v15, v215, v243, v15
  v_dot2_f32_bf16 v16, v216, v59, v16
  v_dot2_f32_bf16 v17, v216, v243, v17
  v_dot2_f32_bf16 v18, v217, v59, v18
  v_dot2_f32_bf16 v19, v217, v243, v19
  v_dot2_f32_bf16 v20, v218, v59, v20
  v_dot2_f32_bf16 v21, v218, v243, v21
  v_dot2_f32_bf16 v22, v219, v59, v22
  v_dot2_f32_bf16 v23, v219, v243, v23
  v_dot2_f32_bf16 v24, v220, v59, v24
  v_dot2_f32_bf16 v25, v220, v243, v25
  v_dot2_f32_bf16 v26, v221, v59, v26
  v_dot2_f32_bf16 v27, v221, v243, v27
  v_dot2_f32_bf16 v28, v222, v67, v28
  v_dot2_f32_bf16 v29, v222, v251, v29
  v_dot2_f32_bf16 v30, v223, v67, v30
  v_dot2_f32_bf16 v31, v223, v251, v31
  v_dot2_f32_bf16 v32, v224, v67, v32
  v_dot2_f32_bf16 v33, v224, v251, v33
  v_dot2_f32_bf16 v34, v225, v67, v34
  v_dot2_f32_bf16 v35, v225, v251, v35
  v_dot2_f32_bf16 v36, v226, v67, v36
  v_dot2_f32_bf16 v37, v226, v251, v37
  v_dot2_f32_bf16 v38, v227, v67, v38
  v_dot2_f32_bf16 v39, v227, v251, v39
  v_dot2_f32_bf16 v40, v228, v67, v40
  v_dot2_f32_bf16 v41, v228, v251, v41
  v_dot2_f32_bf16 v42, v229, v67, v42
  v_dot2_f32_bf16 v43, v229, v251, v43
  v_dot2_f32_bf16 v44, v230, v67, v44
  v_dot2_f32_bf16 v45, v230, v251, v45
  v_dot2_f32_bf16 v46, v231, v67, v46
  v_dot2_f32_bf16 v47, v231, v251, v47
  v_cvt_pk_bf16_f32 v72, v8, v9
  v_cvt_pk_bf16_f32 v73, v10, v11
  v_cvt_pk_bf16_f32 v74, v12, v13
  v_cvt_pk_bf16_f32 v75, v14, v15
  v_cvt_pk_bf16_f32 v76, v16, v17
  v_cvt_pk_bf16_f32 v77, v18, v19
  v_cvt_pk_bf16_f32 v78, v20, v21
  v_cvt_pk_bf16_f32 v79, v22, v23
  v_cvt_pk_bf16_f32 v80, v24, v25
  v_cvt_pk_bf16_f32 v81, v26, v27
  v_cvt_pk_bf16_f32 v82, v28, v29
  v_cvt_pk_bf16_f32 v83, v30, v31
  v_cvt_pk_bf16_f32 v84, v32, v33
  v_cvt_pk_bf16_f32 v85, v34, v35
  v_cvt_pk_bf16_f32 v86, v36, v37
  v_cvt_pk_bf16_f32 v87, v38, v39
  v_cvt_pk_bf16_f32 v88, v40, v41
  v_cvt_pk_bf16_f32 v89, v42, v43
  v_cvt_pk_bf16_f32 v90, v44, v45
  v_cvt_pk_bf16_f32 v91, v46, v47
  v_lshlrev_b32 v3, 8, v3
  v_lshl_add_u32 v3, v5, 4, v3
  v_add_u32 v3, 122880, v3
  ds_write_b128 v3, v[72:75] offset:0
  ds_write_b128 v3, v[76:79] offset:256
  ds_write_b128 v3, v[80:83] offset:512
  ds_write_b128 v3, v[84:87] offset:768
  ds_write_b128 v3, v[88:91] offset:1024
  s_waitcnt lgkmcnt(0)
  s_barrier
  v_lshlrev_b32 v13, 4, v0
  v_add_u32 v13, 122880, v13
  ds_read_b128 v[20:23], v13 offset:0
  ds_read_b128 v[24:27], v13 offset:1024
  ds_read_b128 v[28:31], v13 offset:2048
  ds_read_b128 v[32:35], v13 offset:3072
  ds_read_b128 v[36:39], v13 offset:4096
  ds_read_b128 v[40:43], v13 offset:5120
  ds_read_b128 v[44:47], v13 offset:6144
  ds_read_b128 v[48:51], v13 offset:7168
  ds_read_b128 v[52:55], v13 offset:8192
  ds_read_b128 v[56:59], v13 offset:9216
  ds_read_b128 v[60:63], v13 offset:10240
  ds_read_b128 v[64:67], v13 offset:11264
  s_waitcnt lgkmcnt(4)
  ds_read_b128 v[68:71], v13 offset:12288
  ds_read_b128 v[72:75], v13 offset:13312
  ds_read_b128 v[76:79], v13 offset:14336
  ds_read_b128 v[80:83], v13 offset:15360
  ds_read_b128 v[84:87], v13 offset:16384
  ds_read_b128 v[88:91], v13 offset:17408
  ds_read_b128 v[92:95], v13 offset:18432
  ds_read_b128 v[96:99], v13 offset:19456
  s_mov_b32 s4, s20
  s_mov_b32 s5, s21
  s_mov_b32 s6, 819200
  s_mov_b32 s7, 0x20000
  s_mov_b32 s12, s36
  s_mov_b32 s13, s37
  s_mov_b32 s14, 5242880
  s_mov_b32 s15, 0x20000
  v_mul_u32_u24 v12, 2560, v6
  v_lshrrev_b32 v14, 4, v0
  v_lshl_add_u32 v12, v14, 3, v12
  s_lshl_b32 s46, s42, 5
  v_add_u32 v12, s46, v12
  s_mov_b32 s66, 0
  s_waitcnt lgkmcnt(0)
  v_lshrrev_b32 v13, 3, v0
  v_lshrrev_b32 v14, 2, v13
  v_lshlrev_b32 v14, 3, v14
  v_and_b32 v8, 3, v13
  v_add_u32 v8, v8, v14
  s_and_b32 s46, s42, 1
  s_lshl_b32 s46, s46, 2
  s_lshr_b32 s47, s42, 1
  s_lshl_b32 s47, s47, 4
  s_add_u32 s46, s46, s47
  v_add_u32 v8, s46, v8
  v_mul_u32_u24 v8, 1280, v8
  v_lshrrev_b32 v13, 1, v13
  v_bfe_u32 v14, v0, 1, 2
  v_xor_b32 v13, v13, v14
  v_lshlrev_b32 v13, 5, v13
  v_and_b32 v14, 1, v0
  v_lshlrev_b32 v14, 4, v14
  v_add3_u32 v8, v8, v13, v14
  v_lshrrev_b32 v13, 5, v0
  v_lshlrev_b32 v9, 11, v13
  v_bfe_u32 v13, v0, 2, 3
  v_lshl_add_u32 v9, v13, 7, v9
  v_lshrrev_b32 v13, 1, v13
  v_xor_b32 v13, s42, v13
  v_lshl_add_u32 v9, v13, 5, v9
  v_and_b32 v13, 3, v0
  v_lshl_add_u32 v9, v13, 3, v9
  v_add_u32 v10, 0x10000, v9
  v_add_u32 v11, 0x20000, v9
  s_add_u32 m0, s51, 0
  s_add_u32 s46, s66, 0
  buffer_load_dwordx4 v8, s[4:7], s46 offen  lds
  s_add_u32 m0, s51, 4096
  s_add_u32 s46, s66, 128
  buffer_load_dwordx4 v8, s[4:7], s46 offen  lds
  s_add_u32 m0, s51, 8192
  s_add_u32 s46, s66, 256
  buffer_load_dwordx4 v8, s[4:7], s46 offen  lds
  s_add_u32 m0, s51, 12288
  s_add_u32 s46, s66, 384
  buffer_load_dwordx4 v8, s[4:7], s46 offen  lds
  s_add_u32 m0, s51, 16384
  s_add_u32 s46, s66, 512
  buffer_load_dwordx4 v8, s[4:7], s46 offen  lds
  s_add_u32 m0, s51, 20480
  s_add_u32 s46, s66, 640
  buffer_load_dwordx4 v8, s[4:7], s46 offen  lds
  s_add_u32 m0, s51, 24576
  s_add_u32 s46, s66, 768
  buffer_load_dwordx4 v8, s[4:7], s46 offen  lds
  s_add_u32 m0, s51, 28672
  s_add_u32 s46, s66, 896
  buffer_load_dwordx4 v8, s[4:7], s46 offen  lds
  s_add_u32 m0, s51, 32768
  s_add_u32 s46, s66, 1024
  buffer_load_dwordx4 v8, s[4:7], s46 offen  lds
  s_add_u32 m0, s51, 36864
  s_add_u32 s46, s66, 1152
  buffer_load_dwordx4 v8, s[4:7], s46 offen  lds
  s_add_u32 m0, s51, 40960
  s_add_u32 s46, s66, 40960
  buffer_load_dwordx4 v8, s[4:7], s46 offen  lds
  s_add_u32 m0, s51, 45056
  s_add_u32 s46, s66, 41088
  buffer_load_dwordx4 v8, s[4:7], s46 offen  lds
  s_add_u32 m0, s51, 49152
  s_add_u32 s46, s66, 41216
  buffer_load_dwordx4 v8, s[4:7], s46 offen  lds
  s_add_u32 m0, s51, 53248
  s_add_u32 s46, s66, 41344
  buffer_load_dwordx4 v8, s[4:7], s46 offen  lds
  s_add_u32 m0, s51, 57344
  s_add_u32 s46, s66, 41472
  buffer_load_dwordx4 v8, s[4:7], s46 offen  lds
  s_add_u32 m0, s51, 61440
  s_add_u32 s46, s66, 41600
  buffer_load_dwordx4 v8, s[4:7], s46 offen  lds
  s_add_u32 m0, s51, 65536
  s_add_u32 s46, s66, 41728
  buffer_load_dwordx4 v8, s[4:7], s46 offen  lds
  s_add_u32 m0, s51, 69632
  s_add_u32 s46, s66, 41856
  buffer_load_dwordx4 v8, s[4:7], s46 offen  lds
  s_add_u32 m0, s51, 73728
  s_add_u32 s46, s66, 41984
  buffer_load_dwordx4 v8, s[4:7], s46 offen  lds
  s_add_u32 m0, s51, 77824
  s_add_u32 s46, s66, 42112
  buffer_load_dwordx4 v8, s[4:7], s46 offen  lds
  s_add_u32 m0, s51, 81920
  s_add_u32 s46, s66, 81920
  buffer_load_dwordx4 v8, s[4:7], s46 offen  lds
  s_add_u32 m0, s51, 86016
  s_add_u32 s46, s66, 82048
  buffer_load_dwordx4 v8, s[4:7], s46 offen  lds
  s_add_u32 m0, s51, 90112
  s_add_u32 s46, s66, 82176
  buffer_load_dwordx4 v8, s[4:7], s46 offen  lds
  s_add_u32 m0, s51, 94208
  s_add_u32 s46, s66, 82304
  buffer_load_dwordx4 v8, s[4:7], s46 offen  lds
  s_add_u32 m0, s51, 98304
  s_add_u32 s46, s66, 82432
  buffer_load_dwordx4 v8, s[4:7], s46 offen  lds
  s_waitcnt vmcnt(20)
  s_barrier
  s_add_u32 m0, s51, 102400
  s_add_u32 s46, s66, 82560
  buffer_load_dwordx4 v8, s[4:7], s46 offen  lds
  s_add_u32 m0, s51, 106496
  s_add_u32 s46, s66, 82688
  buffer_load_dwordx4 v8, s[4:7], s46 offen  lds
  s_add_u32 m0, s51, 110592
  s_add_u32 s46, s66, 82816
  buffer_load_dwordx4 v8, s[4:7], s46 offen  lds
  s_add_u32 m0, s51, 114688
  s_add_u32 s46, s66, 82944
  buffer_load_dwordx4 v8, s[4:7], s46 offen  lds
  s_add_u32 m0, s51, 118784
  s_add_u32 s46, s66, 83072
  buffer_load_dwordx4 v8, s[4:7], s46 offen  lds
  ds_read_b64_tr_b16 v[100:101], v9 offset:0
  ds_read_b64_tr_b16 v[102:103], v9 offset:1024
  ds_read_b64_tr_b16 v[104:105], v9 offset:4096
  ds_read_b64_tr_b16 v[106:107], v9 offset:5120
  ds_read_b64_tr_b16 v[108:109], v9 offset:8192
  ds_read_b64_tr_b16 v[110:111], v9 offset:9216
  ds_read_b64_tr_b16 v[112:113], v9 offset:12288
  ds_read_b64_tr_b16 v[114:115], v9 offset:13312
  ds_read_b64_tr_b16 v[116:117], v9 offset:16384
  ds_read_b64_tr_b16 v[118:119], v9 offset:17408
  s_waitcnt lgkmcnt(0)
  v_mfma_f32_16x16x32_bf16 v[140:143], v[100:103], v[20:23], 0
  v_mfma_f32_16x16x32_bf16 v[144:147], v[104:107], v[20:23], 0
  v_mfma_f32_16x16x32_bf16 v[148:151], v[108:111], v[20:23], 0
  v_mfma_f32_16x16x32_bf16 v[152:155], v[112:115], v[20:23], 0
  v_mfma_f32_16x16x32_bf16 v[156:159], v[116:119], v[20:23], 0
  s_waitcnt vmcnt(20)
  s_barrier
  s_add_u32 m0, s51, 0
  s_add_u32 s46, s66, 122880
  buffer_load_dwordx4 v8, s[4:7], s46 offen  lds
  s_add_u32 m0, s51, 4096
  s_add_u32 s46, s66, 123008
  buffer_load_dwordx4 v8, s[4:7], s46 offen  lds
  s_add_u32 m0, s51, 8192
  s_add_u32 s46, s66, 123136
  buffer_load_dwordx4 v8, s[4:7], s46 offen  lds
  s_add_u32 m0, s51, 12288
  s_add_u32 s46, s66, 123264
  buffer_load_dwordx4 v8, s[4:7], s46 offen  lds
  s_add_u32 m0, s51, 16384
  s_add_u32 s46, s66, 123392
  buffer_load_dwordx4 v8, s[4:7], s46 offen  lds
  ds_read_b64_tr_b16 v[120:121], v9 offset:20480
  ds_read_b64_tr_b16 v[122:123], v9 offset:21504
  ds_read_b64_tr_b16 v[124:125], v9 offset:24576
  ds_read_b64_tr_b16 v[126:127], v9 offset:25600
  ds_read_b64_tr_b16 v[128:129], v9 offset:28672
  ds_read_b64_tr_b16 v[130:131], v9 offset:29696
  ds_read_b64_tr_b16 v[132:133], v9 offset:32768
  ds_read_b64_tr_b16 v[134:135], v9 offset:33792
  ds_read_b64_tr_b16 v[136:137], v9 offset:36864
  ds_read_b64_tr_b16 v[138:139], v9 offset:37888
  s_waitcnt lgkmcnt(0)
  v_mfma_f32_16x16x32_bf16 v[160:163], v[120:123], v[20:23], 0
  v_mfma_f32_16x16x32_bf16 v[164:167], v[124:127], v[20:23], 0
  v_mfma_f32_16x16x32_bf16 v[168:171], v[128:131], v[20:23], 0
  v_mfma_f32_16x16x32_bf16 v[172:175], v[132:135], v[20:23], 0
  v_mfma_f32_16x16x32_bf16 v[176:179], v[136:139], v[20:23], 0
  s_waitcnt vmcnt(20)
  s_barrier
  s_add_u32 m0, s51, 20480
  s_add_u32 s46, s66, 123520
  buffer_load_dwordx4 v8, s[4:7], s46 offen  lds
  s_add_u32 m0, s51, 24576
  s_add_u32 s46, s66, 123648
  buffer_load_dwordx4 v8, s[4:7], s46 offen  lds
  s_add_u32 m0, s51, 28672
  s_add_u32 s46, s66, 123776
  buffer_load_dwordx4 v8, s[4:7], s46 offen  lds
  s_add_u32 m0, s51, 32768
  s_add_u32 s46, s66, 123904
  buffer_load_dwordx4 v8, s[4:7], s46 offen  lds
  s_add_u32 m0, s51, 36864
  s_add_u32 s46, s66, 124032
  buffer_load_dwordx4 v8, s[4:7], s46 offen  lds
  ds_read_b64_tr_b16 v[100:101], v9 offset:40960
  ds_read_b64_tr_b16 v[102:103], v9 offset:41984
  ds_read_b64_tr_b16 v[104:105], v9 offset:45056
  ds_read_b64_tr_b16 v[106:107], v9 offset:46080
  ds_read_b64_tr_b16 v[108:109], v9 offset:49152
  ds_read_b64_tr_b16 v[110:111], v9 offset:50176
  ds_read_b64_tr_b16 v[112:113], v9 offset:53248
  ds_read_b64_tr_b16 v[114:115], v9 offset:54272
  ds_read_b64_tr_b16 v[116:117], v9 offset:57344
  ds_read_b64_tr_b16 v[118:119], v9 offset:58368
  s_waitcnt lgkmcnt(0)
  v_mfma_f32_16x16x32_bf16 v[140:143], v[100:103], v[24:27], v[140:143]
  v_mfma_f32_16x16x32_bf16 v[144:147], v[104:107], v[24:27], v[144:147]
  v_mfma_f32_16x16x32_bf16 v[148:151], v[108:111], v[24:27], v[148:151]
  v_mfma_f32_16x16x32_bf16 v[152:155], v[112:115], v[24:27], v[152:155]
  v_mfma_f32_16x16x32_bf16 v[156:159], v[116:119], v[24:27], v[156:159]
  s_waitcnt vmcnt(20)
  s_barrier
  s_add_u32 m0, s51, 40960
  s_add_u32 s46, s66, 163840
  buffer_load_dwordx4 v8, s[4:7], s46 offen  lds
  s_add_u32 m0, s51, 45056
  s_add_u32 s46, s66, 163968
  buffer_load_dwordx4 v8, s[4:7], s46 offen  lds
  s_add_u32 m0, s51, 49152
  s_add_u32 s46, s66, 164096
  buffer_load_dwordx4 v8, s[4:7], s46 offen  lds
  s_add_u32 m0, s51, 53248
  s_add_u32 s46, s66, 164224
  buffer_load_dwordx4 v8, s[4:7], s46 offen  lds
  s_add_u32 m0, s51, 57344
  s_add_u32 s46, s66, 164352
  buffer_load_dwordx4 v8, s[4:7], s46 offen  lds
  ds_read_b64_tr_b16 v[120:121], v9 offset:61440
  ds_read_b64_tr_b16 v[122:123], v9 offset:62464
  ds_read_b64_tr_b16 v[124:125], v10 offset:0
  ds_read_b64_tr_b16 v[126:127], v10 offset:1024
  ds_read_b64_tr_b16 v[128:129], v10 offset:4096
  ds_read_b64_tr_b16 v[130:131], v10 offset:5120
  ds_read_b64_tr_b16 v[132:133], v10 offset:8192
  ds_read_b64_tr_b16 v[134:135], v10 offset:9216
  ds_read_b64_tr_b16 v[136:137], v10 offset:12288
  ds_read_b64_tr_b16 v[138:139], v10 offset:13312
  s_waitcnt lgkmcnt(0)
  v_mfma_f32_16x16x32_bf16 v[160:163], v[120:123], v[24:27], v[160:163]
  v_mfma_f32_16x16x32_bf16 v[164:167], v[124:127], v[24:27], v[164:167]
  v_mfma_f32_16x16x32_bf16 v[168:171], v[128:131], v[24:27], v[168:171]
  v_mfma_f32_16x16x32_bf16 v[172:175], v[132:135], v[24:27], v[172:175]
  v_mfma_f32_16x16x32_bf16 v[176:179], v[136:139], v[24:27], v[176:179]
  s_waitcnt vmcnt(20)
  s_barrier
  s_add_u32 m0, s51, 61440
  s_add_u32 s46, s66, 164480
  buffer_load_dwordx4 v8, s[4:7], s46 offen  lds
  s_add_u32 m0, s51, 65536
  s_add_u32 s46, s66, 164608
  buffer_load_dwordx4 v8, s[4:7], s46 offen  lds
  s_add_u32 m0, s51, 69632
  s_add_u32 s46, s66, 164736
  buffer_load_dwordx4 v8, s[4:7], s46 offen  lds
  s_add_u32 m0, s51, 73728
  s_add_u32 s46, s66, 164864
  buffer_load_dwordx4 v8, s[4:7], s46 offen  lds
  s_add_u32 m0, s51, 77824
  s_add_u32 s46, s66, 164992
  buffer_load_dwordx4 v8, s[4:7], s46 offen  lds
  ds_read_b64_tr_b16 v[100:101], v10 offset:16384
  ds_read_b64_tr_b16 v[102:103], v10 offset:17408
  ds_read_b64_tr_b16 v[104:105], v10 offset:20480
  ds_read_b64_tr_b16 v[106:107], v10 offset:21504
  ds_read_b64_tr_b16 v[108:109], v10 offset:24576
  ds_read_b64_tr_b16 v[110:111], v10 offset:25600
  ds_read_b64_tr_b16 v[112:113], v10 offset:28672
  ds_read_b64_tr_b16 v[114:115], v10 offset:29696
  ds_read_b64_tr_b16 v[116:117], v10 offset:32768
  ds_read_b64_tr_b16 v[118:119], v10 offset:33792
  s_waitcnt lgkmcnt(0)
  v_mfma_f32_16x16x32_bf16 v[140:143], v[100:103], v[28:31], v[140:143]
  v_mfma_f32_16x16x32_bf16 v[144:147], v[104:107], v[28:31], v[144:147]
  v_mfma_f32_16x16x32_bf16 v[148:151], v[108:111], v[28:31], v[148:151]
  v_mfma_f32_16x16x32_bf16 v[152:155], v[112:115], v[28:31], v[152:155]
  v_mfma_f32_16x16x32_bf16 v[156:159], v[116:119], v[28:31], v[156:159]
  s_waitcnt vmcnt(20)
  s_barrier
  s_add_u32 m0, s51, 81920
  s_add_u32 s46, s66, 204800
  buffer_load_dwordx4 v8, s[4:7], s46 offen  lds
  s_add_u32 m0, s51, 86016
  s_add_u32 s46, s66, 204928
  buffer_load_dwordx4 v8, s[4:7], s46 offen  lds
  s_add_u32 m0, s51, 90112
  s_add_u32 s46, s66, 205056
  buffer_load_dwordx4 v8, s[4:7], s46 offen  lds
  s_add_u32 m0, s51, 94208
  s_add_u32 s46, s66, 205184
  buffer_load_dwordx4 v8, s[4:7], s46 offen  lds
  s_add_u32 m0, s51, 98304
  s_add_u32 s46, s66, 205312
  buffer_load_dwordx4 v8, s[4:7], s46 offen  lds
  ds_read_b64_tr_b16 v[120:121], v10 offset:36864
  ds_read_b64_tr_b16 v[122:123], v10 offset:37888
  ds_read_b64_tr_b16 v[124:125], v10 offset:40960
  ds_read_b64_tr_b16 v[126:127], v10 offset:41984
  ds_read_b64_tr_b16 v[128:129], v10 offset:45056
  ds_read_b64_tr_b16 v[130:131], v10 offset:46080
  ds_read_b64_tr_b16 v[132:133], v10 offset:49152
  ds_read_b64_tr_b16 v[134:135], v10 offset:50176
  ds_read_b64_tr_b16 v[136:137], v10 offset:53248
  ds_read_b64_tr_b16 v[138:139], v10 offset:54272
  s_waitcnt lgkmcnt(0)
  v_mfma_f32_16x16x32_bf16 v[160:163], v[120:123], v[28:31], v[160:163]
  v_mfma_f32_16x16x32_bf16 v[164:167], v[124:127], v[28:31], v[164:167]
  v_mfma_f32_16x16x32_bf16 v[168:171], v[128:131], v[28:31], v[168:171]
  v_mfma_f32_16x16x32_bf16 v[172:175], v[132:135], v[28:31], v[172:175]
  v_mfma_f32_16x16x32_bf16 v[176:179], v[136:139], v[28:31], v[176:179]
  s_waitcnt vmcnt(20)
  s_barrier
  s_add_u32 m0, s51, 102400
  s_add_u32 s46, s66, 205440
  buffer_load_dwordx4 v8, s[4:7], s46 offen  lds
  s_add_u32 m0, s51, 106496
  s_add_u32 s46, s66, 205568
  buffer_load_dwordx4 v8, s[4:7], s46 offen  lds
  s_add_u32 m0, s51, 110592
  s_add_u32 s46, s66, 205696
  buffer_load_dwordx4 v8, s[4:7], s46 offen  lds
  s_add_u32 m0, s51, 114688
  s_add_u32 s46, s66, 205824
  buffer_load_dwordx4 v8, s[4:7], s46 offen  lds
  s_add_u32 m0, s51, 118784
  s_add_u32 s46, s66, 205952
  buffer_load_dwordx4 v8, s[4:7], s46 offen  lds
  ds_read_b64_tr_b16 v[100:101], v9 offset:0
  ds_read_b64_tr_b16 v[102:103], v9 offset:1024
  ds_read_b64_tr_b16 v[104:105], v9 offset:4096
  ds_read_b64_tr_b16 v[106:107], v9 offset:5120
  ds_read_b64_tr_b16 v[108:109], v9 offset:8192
  ds_read_b64_tr_b16 v[110:111], v9 offset:9216
  ds_read_b64_tr_b16 v[112:113], v9 offset:12288
  ds_read_b64_tr_b16 v[114:115], v9 offset:13312
  ds_read_b64_tr_b16 v[116:117], v9 offset:16384
  ds_read_b64_tr_b16 v[118:119], v9 offset:17408
  s_waitcnt lgkmcnt(0)
  v_mfma_f32_16x16x32_bf16 v[140:143], v[100:103], v[32:35], v[140:143]
  v_mfma_f32_16x16x32_bf16 v[144:147], v[104:107], v[32:35], v[144:147]
  v_mfma_f32_16x16x32_bf16 v[148:151], v[108:111], v[32:35], v[148:151]
  v_mfma_f32_16x16x32_bf16 v[152:155], v[112:115], v[32:35], v[152:155]
  v_mfma_f32_16x16x32_bf16 v[156:159], v[116:119], v[32:35], v[156:159]
  s_waitcnt vmcnt(20)
  s_barrier
  s_add_u32 m0, s51, 0
  s_add_u32 s46, s66, 245760
  buffer_load_dwordx4 v8, s[4:7], s46 offen  lds
  s_add_u32 m0, s51, 4096
  s_add_u32 s46, s66, 245888
  buffer_load_dwordx4 v8, s[4:7], s46 offen  lds
  s_add_u32 m0, s51, 8192
  s_add_u32 s46, s66, 246016
  buffer_load_dwordx4 v8, s[4:7], s46 offen  lds
  s_add_u32 m0, s51, 12288
  s_add_u32 s46, s66, 246144
  buffer_load_dwordx4 v8, s[4:7], s46 offen  lds
  s_add_u32 m0, s51, 16384
  s_add_u32 s46, s66, 246272
  buffer_load_dwordx4 v8, s[4:7], s46 offen  lds
  ds_read_b64_tr_b16 v[120:121], v9 offset:20480
  ds_read_b64_tr_b16 v[122:123], v9 offset:21504
  ds_read_b64_tr_b16 v[124:125], v9 offset:24576
  ds_read_b64_tr_b16 v[126:127], v9 offset:25600
  ds_read_b64_tr_b16 v[128:129], v9 offset:28672
  ds_read_b64_tr_b16 v[130:131], v9 offset:29696
  ds_read_b64_tr_b16 v[132:133], v9 offset:32768
  ds_read_b64_tr_b16 v[134:135], v9 offset:33792
  ds_read_b64_tr_b16 v[136:137], v9 offset:36864
  ds_read_b64_tr_b16 v[138:139], v9 offset:37888
  s_waitcnt lgkmcnt(0)
  v_mfma_f32_16x16x32_bf16 v[160:163], v[120:123], v[32:35], v[160:163]
  v_mfma_f32_16x16x32_bf16 v[164:167], v[124:127], v[32:35], v[164:167]
  v_mfma_f32_16x16x32_bf16 v[168:171], v[128:131], v[32:35], v[168:171]
  v_mfma_f32_16x16x32_bf16 v[172:175], v[132:135], v[32:35], v[172:175]
  v_mfma_f32_16x16x32_bf16 v[176:179], v[136:139], v[32:35], v[176:179]
  s_waitcnt vmcnt(20)
  s_barrier
  s_add_u32 m0, s51, 20480
  s_add_u32 s46, s66, 246400
  buffer_load_dwordx4 v8, s[4:7], s46 offen  lds
  s_add_u32 m0, s51, 24576
  s_add_u32 s46, s66, 246528
  buffer_load_dwordx4 v8, s[4:7], s46 offen  lds
  s_add_u32 m0, s51, 28672
  s_add_u32 s46, s66, 246656
  buffer_load_dwordx4 v8, s[4:7], s46 offen  lds
  s_add_u32 m0, s51, 32768
  s_add_u32 s46, s66, 246784
  buffer_load_dwordx4 v8, s[4:7], s46 offen  lds
  s_add_u32 m0, s51, 36864
  s_add_u32 s46, s66, 246912
  buffer_load_dwordx4 v8, s[4:7], s46 offen  lds
  ds_read_b64_tr_b16 v[100:101], v9 offset:40960
  ds_read_b64_tr_b16 v[102:103], v9 offset:41984
  ds_read_b64_tr_b16 v[104:105], v9 offset:45056
  ds_read_b64_tr_b16 v[106:107], v9 offset:46080
  ds_read_b64_tr_b16 v[108:109], v9 offset:49152
  ds_read_b64_tr_b16 v[110:111], v9 offset:50176
  ds_read_b64_tr_b16 v[112:113], v9 offset:53248
  ds_read_b64_tr_b16 v[114:115], v9 offset:54272
  ds_read_b64_tr_b16 v[116:117], v9 offset:57344
  ds_read_b64_tr_b16 v[118:119], v9 offset:58368
  s_waitcnt lgkmcnt(0)
  v_mfma_f32_16x16x32_bf16 v[140:143], v[100:103], v[36:39], v[140:143]
  v_mfma_f32_16x16x32_bf16 v[144:147], v[104:107], v[36:39], v[144:147]
  v_mfma_f32_16x16x32_bf16 v[148:151], v[108:111], v[36:39], v[148:151]
  v_mfma_f32_16x16x32_bf16 v[152:155], v[112:115], v[36:39], v[152:155]
  v_mfma_f32_16x16x32_bf16 v[156:159], v[116:119], v[36:39], v[156:159]
  s_waitcnt vmcnt(20)
  s_barrier
  s_add_u32 m0, s51, 40960
  s_add_u32 s46, s66, 286720
  buffer_load_dwordx4 v8, s[4:7], s46 offen  lds
  s_add_u32 m0, s51, 45056
  s_add_u32 s46, s66, 286848
  buffer_load_dwordx4 v8, s[4:7], s46 offen  lds
  s_add_u32 m0, s51, 49152
  s_add_u32 s46, s66, 286976
  buffer_load_dwordx4 v8, s[4:7], s46 offen  lds
  s_add_u32 m0, s51, 53248
  s_add_u32 s46, s66, 287104
  buffer_load_dwordx4 v8, s[4:7], s46 offen  lds
  s_add_u32 m0, s51, 57344
  s_add_u32 s46, s66, 287232
  buffer_load_dwordx4 v8, s[4:7], s46 offen  lds
  ds_read_b64_tr_b16 v[120:121], v9 offset:61440
  ds_read_b64_tr_b16 v[122:123], v9 offset:62464
  ds_read_b64_tr_b16 v[124:125], v10 offset:0
  ds_read_b64_tr_b16 v[126:127], v10 offset:1024
  ds_read_b64_tr_b16 v[128:129], v10 offset:4096
  ds_read_b64_tr_b16 v[130:131], v10 offset:5120
  ds_read_b64_tr_b16 v[132:133], v10 offset:8192
  ds_read_b64_tr_b16 v[134:135], v10 offset:9216
  ds_read_b64_tr_b16 v[136:137], v10 offset:12288
  ds_read_b64_tr_b16 v[138:139], v10 offset:13312
  s_waitcnt lgkmcnt(0)
  v_mfma_f32_16x16x32_bf16 v[160:163], v[120:123], v[36:39], v[160:163]
  v_mfma_f32_16x16x32_bf16 v[164:167], v[124:127], v[36:39], v[164:167]
  v_mfma_f32_16x16x32_bf16 v[168:171], v[128:131], v[36:39], v[168:171]
  v_mfma_f32_16x16x32_bf16 v[172:175], v[132:135], v[36:39], v[172:175]
  v_mfma_f32_16x16x32_bf16 v[176:179], v[136:139], v[36:39], v[176:179]
  s_waitcnt vmcnt(20)
  s_barrier
  s_add_u32 m0, s51, 61440
  s_add_u32 s46, s66, 287360
  buffer_load_dwordx4 v8, s[4:7], s46 offen  lds
  s_add_u32 m0, s51, 65536
  s_add_u32 s46, s66, 287488
  buffer_load_dwordx4 v8, s[4:7], s46 offen  lds
  s_add_u32 m0, s51, 69632
  s_add_u32 s46, s66, 287616
  buffer_load_dwordx4 v8, s[4:7], s46 offen  lds
  s_add_u32 m0, s51, 73728
  s_add_u32 s46, s66, 287744
  buffer_load_dwordx4 v8, s[4:7], s46 offen  lds
  s_add_u32 m0, s51, 77824
  s_add_u32 s46, s66, 287872
  buffer_load_dwordx4 v8, s[4:7], s46 offen  lds
  ds_read_b64_tr_b16 v[100:101], v10 offset:16384
  ds_read_b64_tr_b16 v[102:103], v10 offset:17408
  ds_read_b64_tr_b16 v[104:105], v10 offset:20480
  ds_read_b64_tr_b16 v[106:107], v10 offset:21504
  ds_read_b64_tr_b16 v[108:109], v10 offset:24576
  ds_read_b64_tr_b16 v[110:111], v10 offset:25600
  ds_read_b64_tr_b16 v[112:113], v10 offset:28672
  ds_read_b64_tr_b16 v[114:115], v10 offset:29696
  ds_read_b64_tr_b16 v[116:117], v10 offset:32768
  ds_read_b64_tr_b16 v[118:119], v10 offset:33792
  s_waitcnt lgkmcnt(0)
  v_mfma_f32_16x16x32_bf16 v[140:143], v[100:103], v[40:43], v[140:143]
  v_mfma_f32_16x16x32_bf16 v[144:147], v[104:107], v[40:43], v[144:147]
  v_mfma_f32_16x16x32_bf16 v[148:151], v[108:111], v[40:43], v[148:151]
  v_mfma_f32_16x16x32_bf16 v[152:155], v[112:115], v[40:43], v[152:155]
  v_mfma_f32_16x16x32_bf16 v[156:159], v[116:119], v[40:43], v[156:159]
  s_waitcnt vmcnt(20)
  s_barrier
  s_add_u32 m0, s51, 81920
  s_add_u32 s46, s66, 327680
  buffer_load_dwordx4 v8, s[4:7], s46 offen  lds
  s_add_u32 m0, s51, 86016
  s_add_u32 s46, s66, 327808
  buffer_load_dwordx4 v8, s[4:7], s46 offen  lds
  s_add_u32 m0, s51, 90112
  s_add_u32 s46, s66, 327936
  buffer_load_dwordx4 v8, s[4:7], s46 offen  lds
  s_add_u32 m0, s51, 94208
  s_add_u32 s46, s66, 328064
  buffer_load_dwordx4 v8, s[4:7], s46 offen  lds
  s_add_u32 m0, s51, 98304
  s_add_u32 s46, s66, 328192
  buffer_load_dwordx4 v8, s[4:7], s46 offen  lds
  ds_read_b64_tr_b16 v[120:121], v10 offset:36864
  ds_read_b64_tr_b16 v[122:123], v10 offset:37888
  ds_read_b64_tr_b16 v[124:125], v10 offset:40960
  ds_read_b64_tr_b16 v[126:127], v10 offset:41984
  ds_read_b64_tr_b16 v[128:129], v10 offset:45056
  ds_read_b64_tr_b16 v[130:131], v10 offset:46080
  ds_read_b64_tr_b16 v[132:133], v10 offset:49152
  ds_read_b64_tr_b16 v[134:135], v10 offset:50176
  ds_read_b64_tr_b16 v[136:137], v10 offset:53248
  ds_read_b64_tr_b16 v[138:139], v10 offset:54272
  s_waitcnt lgkmcnt(0)
  v_mfma_f32_16x16x32_bf16 v[160:163], v[120:123], v[40:43], v[160:163]
  v_mfma_f32_16x16x32_bf16 v[164:167], v[124:127], v[40:43], v[164:167]
  v_mfma_f32_16x16x32_bf16 v[168:171], v[128:131], v[40:43], v[168:171]
  v_mfma_f32_16x16x32_bf16 v[172:175], v[132:135], v[40:43], v[172:175]
  v_mfma_f32_16x16x32_bf16 v[176:179], v[136:139], v[40:43], v[176:179]
  s_waitcnt vmcnt(20)
  s_barrier
  s_add_u32 m0, s51, 102400
  s_add_u32 s46, s66, 328320
  buffer_load_dwordx4 v8, s[4:7], s46 offen  lds
  s_add_u32 m0, s51, 106496
  s_add_u32 s46, s66, 328448
  buffer_load_dwordx4 v8, s[4:7], s46 offen  lds
  s_add_u32 m0, s51, 110592
  s_add_u32 s46, s66, 328576
  buffer_load_dwordx4 v8, s[4:7], s46 offen  lds
  s_add_u32 m0, s51, 114688
  s_add_u32 s46, s66, 328704
  buffer_load_dwordx4 v8, s[4:7], s46 offen  lds
  s_add_u32 m0, s51, 118784
  s_add_u32 s46, s66, 328832
  buffer_load_dwordx4 v8, s[4:7], s46 offen  lds
  ds_read_b64_tr_b16 v[100:101], v9 offset:0
  ds_read_b64_tr_b16 v[102:103], v9 offset:1024
  ds_read_b64_tr_b16 v[104:105], v9 offset:4096
  ds_read_b64_tr_b16 v[106:107], v9 offset:5120
  ds_read_b64_tr_b16 v[108:109], v9 offset:8192
  ds_read_b64_tr_b16 v[110:111], v9 offset:9216
  ds_read_b64_tr_b16 v[112:113], v9 offset:12288
  ds_read_b64_tr_b16 v[114:115], v9 offset:13312
  ds_read_b64_tr_b16 v[116:117], v9 offset:16384
  ds_read_b64_tr_b16 v[118:119], v9 offset:17408
  s_waitcnt lgkmcnt(0)
  v_mfma_f32_16x16x32_bf16 v[140:143], v[100:103], v[44:47], v[140:143]
  v_mfma_f32_16x16x32_bf16 v[144:147], v[104:107], v[44:47], v[144:147]
  v_mfma_f32_16x16x32_bf16 v[148:151], v[108:111], v[44:47], v[148:151]
  v_mfma_f32_16x16x32_bf16 v[152:155], v[112:115], v[44:47], v[152:155]
  v_mfma_f32_16x16x32_bf16 v[156:159], v[116:119], v[44:47], v[156:159]
  s_waitcnt vmcnt(20)
  s_barrier
  s_add_u32 m0, s51, 0
  s_add_u32 s46, s66, 368640
  buffer_load_dwordx4 v8, s[4:7], s46 offen  lds
  s_add_u32 m0, s51, 4096
  s_add_u32 s46, s66, 368768
  buffer_load_dwordx4 v8, s[4:7], s46 offen  lds
  s_add_u32 m0, s51, 8192
  s_add_u32 s46, s66, 368896
  buffer_load_dwordx4 v8, s[4:7], s46 offen  lds
  s_add_u32 m0, s51, 12288
  s_add_u32 s46, s66, 369024
  buffer_load_dwordx4 v8, s[4:7], s46 offen  lds
  s_add_u32 m0, s51, 16384
  s_add_u32 s46, s66, 369152
  buffer_load_dwordx4 v8, s[4:7], s46 offen  lds
  ds_read_b64_tr_b16 v[120:121], v9 offset:20480
  ds_read_b64_tr_b16 v[122:123], v9 offset:21504
  ds_read_b64_tr_b16 v[124:125], v9 offset:24576
  ds_read_b64_tr_b16 v[126:127], v9 offset:25600
  ds_read_b64_tr_b16 v[128:129], v9 offset:28672
  ds_read_b64_tr_b16 v[130:131], v9 offset:29696
  ds_read_b64_tr_b16 v[132:133], v9 offset:32768
  ds_read_b64_tr_b16 v[134:135], v9 offset:33792
  ds_read_b64_tr_b16 v[136:137], v9 offset:36864
  ds_read_b64_tr_b16 v[138:139], v9 offset:37888
  s_waitcnt lgkmcnt(0)
  v_mfma_f32_16x16x32_bf16 v[160:163], v[120:123], v[44:47], v[160:163]
  v_mfma_f32_16x16x32_bf16 v[164:167], v[124:127], v[44:47], v[164:167]
  v_mfma_f32_16x16x32_bf16 v[168:171], v[128:131], v[44:47], v[168:171]
  v_mfma_f32_16x16x32_bf16 v[172:175], v[132:135], v[44:47], v[172:175]
  v_mfma_f32_16x16x32_bf16 v[176:179], v[136:139], v[44:47], v[176:179]
  s_waitcnt vmcnt(20)
  s_barrier
  s_add_u32 m0, s51, 20480
  s_add_u32 s46, s66, 369280
  buffer_load_dwordx4 v8, s[4:7], s46 offen  lds
  s_add_u32 m0, s51, 24576
  s_add_u32 s46, s66, 369408
  buffer_load_dwordx4 v8, s[4:7], s46 offen  lds
  s_add_u32 m0, s51, 28672
  s_add_u32 s46, s66, 369536
  buffer_load_dwordx4 v8, s[4:7], s46 offen  lds
  s_add_u32 m0, s51, 32768
  s_add_u32 s46, s66, 369664
  buffer_load_dwordx4 v8, s[4:7], s46 offen  lds
  s_add_u32 m0, s51, 36864
  s_add_u32 s46, s66, 369792
  buffer_load_dwordx4 v8, s[4:7], s46 offen  lds
  ds_read_b64_tr_b16 v[100:101], v9 offset:40960
  ds_read_b64_tr_b16 v[102:103], v9 offset:41984
  ds_read_b64_tr_b16 v[104:105], v9 offset:45056
  ds_read_b64_tr_b16 v[106:107], v9 offset:46080
  ds_read_b64_tr_b16 v[108:109], v9 offset:49152
  ds_read_b64_tr_b16 v[110:111], v9 offset:50176
  ds_read_b64_tr_b16 v[112:113], v9 offset:53248
  ds_read_b64_tr_b16 v[114:115], v9 offset:54272
  ds_read_b64_tr_b16 v[116:117], v9 offset:57344
  ds_read_b64_tr_b16 v[118:119], v9 offset:58368
  s_waitcnt lgkmcnt(0)
  v_mfma_f32_16x16x32_bf16 v[140:143], v[100:103], v[48:51], v[140:143]
  v_mfma_f32_16x16x32_bf16 v[144:147], v[104:107], v[48:51], v[144:147]
  v_mfma_f32_16x16x32_bf16 v[148:151], v[108:111], v[48:51], v[148:151]
  v_mfma_f32_16x16x32_bf16 v[152:155], v[112:115], v[48:51], v[152:155]
  v_mfma_f32_16x16x32_bf16 v[156:159], v[116:119], v[48:51], v[156:159]
  s_waitcnt vmcnt(20)
  s_barrier
  s_add_u32 m0, s51, 40960
  s_add_u32 s46, s66, 409600
  buffer_load_dwordx4 v8, s[4:7], s46 offen  lds
  s_add_u32 m0, s51, 45056
  s_add_u32 s46, s66, 409728
  buffer_load_dwordx4 v8, s[4:7], s46 offen  lds
  s_add_u32 m0, s51, 49152
  s_add_u32 s46, s66, 409856
  buffer_load_dwordx4 v8, s[4:7], s46 offen  lds
  s_add_u32 m0, s51, 53248
  s_add_u32 s46, s66, 409984
  buffer_load_dwordx4 v8, s[4:7], s46 offen  lds
  s_add_u32 m0, s51, 57344
  s_add_u32 s46, s66, 410112
  buffer_load_dwordx4 v8, s[4:7], s46 offen  lds
  ds_read_b64_tr_b16 v[120:121], v9 offset:61440
  ds_read_b64_tr_b16 v[122:123], v9 offset:62464
  ds_read_b64_tr_b16 v[124:125], v10 offset:0
  ds_read_b64_tr_b16 v[126:127], v10 offset:1024
  ds_read_b64_tr_b16 v[128:129], v10 offset:4096
  ds_read_b64_tr_b16 v[130:131], v10 offset:5120
  ds_read_b64_tr_b16 v[132:133], v10 offset:8192
  ds_read_b64_tr_b16 v[134:135], v10 offset:9216
  ds_read_b64_tr_b16 v[136:137], v10 offset:12288
  ds_read_b64_tr_b16 v[138:139], v10 offset:13312
  s_waitcnt lgkmcnt(0)
  v_mfma_f32_16x16x32_bf16 v[160:163], v[120:123], v[48:51], v[160:163]
  v_mfma_f32_16x16x32_bf16 v[164:167], v[124:127], v[48:51], v[164:167]
  v_mfma_f32_16x16x32_bf16 v[168:171], v[128:131], v[48:51], v[168:171]
  v_mfma_f32_16x16x32_bf16 v[172:175], v[132:135], v[48:51], v[172:175]
  v_mfma_f32_16x16x32_bf16 v[176:179], v[136:139], v[48:51], v[176:179]
  s_waitcnt vmcnt(20)
  s_barrier
  s_add_u32 m0, s51, 61440
  s_add_u32 s46, s66, 410240
  buffer_load_dwordx4 v8, s[4:7], s46 offen  lds
  s_add_u32 m0, s51, 65536
  s_add_u32 s46, s66, 410368
  buffer_load_dwordx4 v8, s[4:7], s46 offen  lds
  s_add_u32 m0, s51, 69632
  s_add_u32 s46, s66, 410496
  buffer_load_dwordx4 v8, s[4:7], s46 offen  lds
  s_add_u32 m0, s51, 73728
  s_add_u32 s46, s66, 410624
  buffer_load_dwordx4 v8, s[4:7], s46 offen  lds
  s_add_u32 m0, s51, 77824
  s_add_u32 s46, s66, 410752
  buffer_load_dwordx4 v8, s[4:7], s46 offen  lds
  ds_read_b64_tr_b16 v[100:101], v10 offset:16384
  ds_read_b64_tr_b16 v[102:103], v10 offset:17408
  ds_read_b64_tr_b16 v[104:105], v10 offset:20480
  ds_read_b64_tr_b16 v[106:107], v10 offset:21504
  ds_read_b64_tr_b16 v[108:109], v10 offset:24576
  ds_read_b64_tr_b16 v[110:111], v10 offset:25600
  ds_read_b64_tr_b16 v[112:113], v10 offset:28672
  ds_read_b64_tr_b16 v[114:115], v10 offset:29696
  ds_read_b64_tr_b16 v[116:117], v10 offset:32768
  ds_read_b64_tr_b16 v[118:119], v10 offset:33792
  s_waitcnt lgkmcnt(0)
  v_mfma_f32_16x16x32_bf16 v[140:143], v[100:103], v[52:55], v[140:143]
  v_mfma_f32_16x16x32_bf16 v[144:147], v[104:107], v[52:55], v[144:147]
  v_mfma_f32_16x16x32_bf16 v[148:151], v[108:111], v[52:55], v[148:151]
  v_mfma_f32_16x16x32_bf16 v[152:155], v[112:115], v[52:55], v[152:155]
  v_mfma_f32_16x16x32_bf16 v[156:159], v[116:119], v[52:55], v[156:159]
  s_waitcnt vmcnt(20)
  s_barrier
  s_add_u32 m0, s51, 81920
  s_add_u32 s46, s66, 450560
  buffer_load_dwordx4 v8, s[4:7], s46 offen  lds
  s_add_u32 m0, s51, 86016
  s_add_u32 s46, s66, 450688
  buffer_load_dwordx4 v8, s[4:7], s46 offen  lds
  s_add_u32 m0, s51, 90112
  s_add_u32 s46, s66, 450816
  buffer_load_dwordx4 v8, s[4:7], s46 offen  lds
  s_add_u32 m0, s51, 94208
  s_add_u32 s46, s66, 450944
  buffer_load_dwordx4 v8, s[4:7], s46 offen  lds
  s_add_u32 m0, s51, 98304
  s_add_u32 s46, s66, 451072
  buffer_load_dwordx4 v8, s[4:7], s46 offen  lds
  ds_read_b64_tr_b16 v[120:121], v10 offset:36864
  ds_read_b64_tr_b16 v[122:123], v10 offset:37888
  ds_read_b64_tr_b16 v[124:125], v10 offset:40960
  ds_read_b64_tr_b16 v[126:127], v10 offset:41984
  ds_read_b64_tr_b16 v[128:129], v10 offset:45056
  ds_read_b64_tr_b16 v[130:131], v10 offset:46080
  ds_read_b64_tr_b16 v[132:133], v10 offset:49152
  ds_read_b64_tr_b16 v[134:135], v10 offset:50176
  ds_read_b64_tr_b16 v[136:137], v10 offset:53248
  ds_read_b64_tr_b16 v[138:139], v10 offset:54272
  s_waitcnt lgkmcnt(0)
  v_mfma_f32_16x16x32_bf16 v[160:163], v[120:123], v[52:55], v[160:163]
  v_mfma_f32_16x16x32_bf16 v[164:167], v[124:127], v[52:55], v[164:167]
  v_mfma_f32_16x16x32_bf16 v[168:171], v[128:131], v[52:55], v[168:171]
  v_mfma_f32_16x16x32_bf16 v[172:175], v[132:135], v[52:55], v[172:175]
  v_mfma_f32_16x16x32_bf16 v[176:179], v[136:139], v[52:55], v[176:179]
  s_waitcnt vmcnt(20)
  s_barrier
  s_add_u32 m0, s51, 102400
  s_add_u32 s46, s66, 451200
  buffer_load_dwordx4 v8, s[4:7], s46 offen  lds
  s_add_u32 m0, s51, 106496
  s_add_u32 s46, s66, 451328
  buffer_load_dwordx4 v8, s[4:7], s46 offen  lds
  s_add_u32 m0, s51, 110592
  s_add_u32 s46, s66, 451456
  buffer_load_dwordx4 v8, s[4:7], s46 offen  lds
  s_add_u32 m0, s51, 114688
  s_add_u32 s46, s66, 451584
  buffer_load_dwordx4 v8, s[4:7], s46 offen  lds
  s_add_u32 m0, s51, 118784
  s_add_u32 s46, s66, 451712
  buffer_load_dwordx4 v8, s[4:7], s46 offen  lds
  ds_read_b64_tr_b16 v[100:101], v9 offset:0
  ds_read_b64_tr_b16 v[102:103], v9 offset:1024
  ds_read_b64_tr_b16 v[104:105], v9 offset:4096
  ds_read_b64_tr_b16 v[106:107], v9 offset:5120
  ds_read_b64_tr_b16 v[108:109], v9 offset:8192
  ds_read_b64_tr_b16 v[110:111], v9 offset:9216
  ds_read_b64_tr_b16 v[112:113], v9 offset:12288
  ds_read_b64_tr_b16 v[114:115], v9 offset:13312
  ds_read_b64_tr_b16 v[116:117], v9 offset:16384
  ds_read_b64_tr_b16 v[118:119], v9 offset:17408
  s_waitcnt lgkmcnt(0)
  v_mfma_f32_16x16x32_bf16 v[140:143], v[100:103], v[56:59], v[140:143]
  v_mfma_f32_16x16x32_bf16 v[144:147], v[104:107], v[56:59], v[144:147]
  v_mfma_f32_16x16x32_bf16 v[148:151], v[108:111], v[56:59], v[148:151]
  v_mfma_f32_16x16x32_bf16 v[152:155], v[112:115], v[56:59], v[152:155]
  v_mfma_f32_16x16x32_bf16 v[156:159], v[116:119], v[56:59], v[156:159]
  s_waitcnt vmcnt(20)
  s_barrier
  s_add_u32 m0, s51, 0
  s_add_u32 s46, s66, 491520
  buffer_load_dwordx4 v8, s[4:7], s46 offen  lds
  s_add_u32 m0, s51, 4096
  s_add_u32 s46, s66, 491648
  buffer_load_dwordx4 v8, s[4:7], s46 offen  lds
  s_add_u32 m0, s51, 8192
  s_add_u32 s46, s66, 491776
  buffer_load_dwordx4 v8, s[4:7], s46 offen  lds
  s_add_u32 m0, s51, 12288
  s_add_u32 s46, s66, 491904
  buffer_load_dwordx4 v8, s[4:7], s46 offen  lds
  s_add_u32 m0, s51, 16384
  s_add_u32 s46, s66, 492032
  buffer_load_dwordx4 v8, s[4:7], s46 offen  lds
  ds_read_b64_tr_b16 v[120:121], v9 offset:20480
  ds_read_b64_tr_b16 v[122:123], v9 offset:21504
  ds_read_b64_tr_b16 v[124:125], v9 offset:24576
  ds_read_b64_tr_b16 v[126:127], v9 offset:25600
  ds_read_b64_tr_b16 v[128:129], v9 offset:28672
  ds_read_b64_tr_b16 v[130:131], v9 offset:29696
  ds_read_b64_tr_b16 v[132:133], v9 offset:32768
  ds_read_b64_tr_b16 v[134:135], v9 offset:33792
  ds_read_b64_tr_b16 v[136:137], v9 offset:36864
  ds_read_b64_tr_b16 v[138:139], v9 offset:37888
  s_waitcnt lgkmcnt(0)
  v_mfma_f32_16x16x32_bf16 v[160:163], v[120:123], v[56:59], v[160:163]
  v_mfma_f32_16x16x32_bf16 v[164:167], v[124:127], v[56:59], v[164:167]
  v_mfma_f32_16x16x32_bf16 v[168:171], v[128:131], v[56:59], v[168:171]
  v_mfma_f32_16x16x32_bf16 v[172:175], v[132:135], v[56:59], v[172:175]
  v_mfma_f32_16x16x32_bf16 v[176:179], v[136:139], v[56:59], v[176:179]
  s_waitcnt vmcnt(20)
  s_barrier
  s_add_u32 m0, s51, 20480
  s_add_u32 s46, s66, 492160
  buffer_load_dwordx4 v8, s[4:7], s46 offen  lds
  s_add_u32 m0, s51, 24576
  s_add_u32 s46, s66, 492288
  buffer_load_dwordx4 v8, s[4:7], s46 offen  lds
  s_add_u32 m0, s51, 28672
  s_add_u32 s46, s66, 492416
  buffer_load_dwordx4 v8, s[4:7], s46 offen  lds
  s_add_u32 m0, s51, 32768
  s_add_u32 s46, s66, 492544
  buffer_load_dwordx4 v8, s[4:7], s46 offen  lds
  s_add_u32 m0, s51, 36864
  s_add_u32 s46, s66, 492672
  buffer_load_dwordx4 v8, s[4:7], s46 offen  lds
  ds_read_b64_tr_b16 v[100:101], v9 offset:40960
  ds_read_b64_tr_b16 v[102:103], v9 offset:41984
  ds_read_b64_tr_b16 v[104:105], v9 offset:45056
  ds_read_b64_tr_b16 v[106:107], v9 offset:46080
  ds_read_b64_tr_b16 v[108:109], v9 offset:49152
  ds_read_b64_tr_b16 v[110:111], v9 offset:50176
  ds_read_b64_tr_b16 v[112:113], v9 offset:53248
  ds_read_b64_tr_b16 v[114:115], v9 offset:54272
  ds_read_b64_tr_b16 v[116:117], v9 offset:57344
  ds_read_b64_tr_b16 v[118:119], v9 offset:58368
  s_waitcnt lgkmcnt(0)
  v_mfma_f32_16x16x32_bf16 v[140:143], v[100:103], v[60:63], v[140:143]
  v_mfma_f32_16x16x32_bf16 v[144:147], v[104:107], v[60:63], v[144:147]
  v_mfma_f32_16x16x32_bf16 v[148:151], v[108:111], v[60:63], v[148:151]
  v_mfma_f32_16x16x32_bf16 v[152:155], v[112:115], v[60:63], v[152:155]
  v_mfma_f32_16x16x32_bf16 v[156:159], v[116:119], v[60:63], v[156:159]
  s_waitcnt vmcnt(20)
  s_barrier
  s_add_u32 m0, s51, 40960
  s_add_u32 s46, s66, 532480
  buffer_load_dwordx4 v8, s[4:7], s46 offen  lds
  s_add_u32 m0, s51, 45056
  s_add_u32 s46, s66, 532608
  buffer_load_dwordx4 v8, s[4:7], s46 offen  lds
  s_add_u32 m0, s51, 49152
  s_add_u32 s46, s66, 532736
  buffer_load_dwordx4 v8, s[4:7], s46 offen  lds
  s_add_u32 m0, s51, 53248
  s_add_u32 s46, s66, 532864
  buffer_load_dwordx4 v8, s[4:7], s46 offen  lds
  s_add_u32 m0, s51, 57344
  s_add_u32 s46, s66, 532992
  buffer_load_dwordx4 v8, s[4:7], s46 offen  lds
  ds_read_b64_tr_b16 v[120:121], v9 offset:61440
  ds_read_b64_tr_b16 v[122:123], v9 offset:62464
  ds_read_b64_tr_b16 v[124:125], v10 offset:0
  ds_read_b64_tr_b16 v[126:127], v10 offset:1024
  ds_read_b64_tr_b16 v[128:129], v10 offset:4096
  ds_read_b64_tr_b16 v[130:131], v10 offset:5120
  ds_read_b64_tr_b16 v[132:133], v10 offset:8192
  ds_read_b64_tr_b16 v[134:135], v10 offset:9216
  ds_read_b64_tr_b16 v[136:137], v10 offset:12288
  ds_read_b64_tr_b16 v[138:139], v10 offset:13312
  s_waitcnt lgkmcnt(0)
  v_mfma_f32_16x16x32_bf16 v[160:163], v[120:123], v[60:63], v[160:163]
  v_mfma_f32_16x16x32_bf16 v[164:167], v[124:127], v[60:63], v[164:167]
  v_mfma_f32_16x16x32_bf16 v[168:171], v[128:131], v[60:63], v[168:171]
  v_mfma_f32_16x16x32_bf16 v[172:175], v[132:135], v[60:63], v[172:175]
  v_mfma_f32_16x16x32_bf16 v[176:179], v[136:139], v[60:63], v[176:179]
  s_waitcnt vmcnt(20)
  s_barrier
  s_add_u32 m0, s51, 61440
  s_add_u32 s46, s66, 533120
  buffer_load_dwordx4 v8, s[4:7], s46 offen  lds
  s_add_u32 m0, s51, 65536
  s_add_u32 s46, s66, 533248
  buffer_load_dwordx4 v8, s[4:7], s46 offen  lds
  s_add_u32 m0, s51, 69632
  s_add_u32 s46, s66, 533376
  buffer_load_dwordx4 v8, s[4:7], s46 offen  lds
  s_add_u32 m0, s51, 73728
  s_add_u32 s46, s66, 533504
  buffer_load_dwordx4 v8, s[4:7], s46 offen  lds
  s_add_u32 m0, s51, 77824
  s_add_u32 s46, s66, 533632
  buffer_load_dwordx4 v8, s[4:7], s46 offen  lds
  ds_read_b64_tr_b16 v[100:101], v10 offset:16384
  ds_read_b64_tr_b16 v[102:103], v10 offset:17408
  ds_read_b64_tr_b16 v[104:105], v10 offset:20480
  ds_read_b64_tr_b16 v[106:107], v10 offset:21504
  ds_read_b64_tr_b16 v[108:109], v10 offset:24576
  ds_read_b64_tr_b16 v[110:111], v10 offset:25600
  ds_read_b64_tr_b16 v[112:113], v10 offset:28672
  ds_read_b64_tr_b16 v[114:115], v10 offset:29696
  ds_read_b64_tr_b16 v[116:117], v10 offset:32768
  ds_read_b64_tr_b16 v[118:119], v10 offset:33792
  s_waitcnt lgkmcnt(0)
  v_mfma_f32_16x16x32_bf16 v[140:143], v[100:103], v[64:67], v[140:143]
  v_mfma_f32_16x16x32_bf16 v[144:147], v[104:107], v[64:67], v[144:147]
  v_mfma_f32_16x16x32_bf16 v[148:151], v[108:111], v[64:67], v[148:151]
  v_mfma_f32_16x16x32_bf16 v[152:155], v[112:115], v[64:67], v[152:155]
  v_mfma_f32_16x16x32_bf16 v[156:159], v[116:119], v[64:67], v[156:159]
  s_waitcnt vmcnt(20)
  s_barrier
  s_add_u32 m0, s51, 81920
  s_add_u32 s46, s66, 573440
  buffer_load_dwordx4 v8, s[4:7], s46 offen  lds
  s_add_u32 m0, s51, 86016
  s_add_u32 s46, s66, 573568
  buffer_load_dwordx4 v8, s[4:7], s46 offen  lds
  s_add_u32 m0, s51, 90112
  s_add_u32 s46, s66, 573696
  buffer_load_dwordx4 v8, s[4:7], s46 offen  lds
  s_add_u32 m0, s51, 94208
  s_add_u32 s46, s66, 573824
  buffer_load_dwordx4 v8, s[4:7], s46 offen  lds
  s_add_u32 m0, s51, 98304
  s_add_u32 s46, s66, 573952
  buffer_load_dwordx4 v8, s[4:7], s46 offen  lds
  ds_read_b64_tr_b16 v[120:121], v10 offset:36864
  ds_read_b64_tr_b16 v[122:123], v10 offset:37888
  ds_read_b64_tr_b16 v[124:125], v10 offset:40960
  ds_read_b64_tr_b16 v[126:127], v10 offset:41984
  ds_read_b64_tr_b16 v[128:129], v10 offset:45056
  ds_read_b64_tr_b16 v[130:131], v10 offset:46080
  ds_read_b64_tr_b16 v[132:133], v10 offset:49152
  ds_read_b64_tr_b16 v[134:135], v10 offset:50176
  ds_read_b64_tr_b16 v[136:137], v10 offset:53248
  ds_read_b64_tr_b16 v[138:139], v10 offset:54272
  s_waitcnt lgkmcnt(0)
  v_mfma_f32_16x16x32_bf16 v[160:163], v[120:123], v[64:67], v[160:163]
  v_mfma_f32_16x16x32_bf16 v[164:167], v[124:127], v[64:67], v[164:167]
  v_mfma_f32_16x16x32_bf16 v[168:171], v[128:131], v[64:67], v[168:171]
  v_mfma_f32_16x16x32_bf16 v[172:175], v[132:135], v[64:67], v[172:175]
  v_mfma_f32_16x16x32_bf16 v[176:179], v[136:139], v[64:67], v[176:179]
  s_waitcnt vmcnt(20)
  s_barrier
  s_add_u32 m0, s51, 102400
  s_add_u32 s46, s66, 574080
  buffer_load_dwordx4 v8, s[4:7], s46 offen  lds
  s_add_u32 m0, s51, 106496
  s_add_u32 s46, s66, 574208
  buffer_load_dwordx4 v8, s[4:7], s46 offen  lds
  s_add_u32 m0, s51, 110592
  s_add_u32 s46, s66, 574336
  buffer_load_dwordx4 v8, s[4:7], s46 offen  lds
  s_add_u32 m0, s51, 114688
  s_add_u32 s46, s66, 574464
  buffer_load_dwordx4 v8, s[4:7], s46 offen  lds
  s_add_u32 m0, s51, 118784
  s_add_u32 s46, s66, 574592
  buffer_load_dwordx4 v8, s[4:7], s46 offen  lds
  ds_read_b64_tr_b16 v[100:101], v9 offset:0
  ds_read_b64_tr_b16 v[102:103], v9 offset:1024
  ds_read_b64_tr_b16 v[104:105], v9 offset:4096
  ds_read_b64_tr_b16 v[106:107], v9 offset:5120
  ds_read_b64_tr_b16 v[108:109], v9 offset:8192
  ds_read_b64_tr_b16 v[110:111], v9 offset:9216
  ds_read_b64_tr_b16 v[112:113], v9 offset:12288
  ds_read_b64_tr_b16 v[114:115], v9 offset:13312
  ds_read_b64_tr_b16 v[116:117], v9 offset:16384
  ds_read_b64_tr_b16 v[118:119], v9 offset:17408
  s_waitcnt lgkmcnt(0)
  v_mfma_f32_16x16x32_bf16 v[140:143], v[100:103], v[68:71], v[140:143]
  v_mfma_f32_16x16x32_bf16 v[144:147], v[104:107], v[68:71], v[144:147]
  v_mfma_f32_16x16x32_bf16 v[148:151], v[108:111], v[68:71], v[148:151]
  v_mfma_f32_16x16x32_bf16 v[152:155], v[112:115], v[68:71], v[152:155]
  v_mfma_f32_16x16x32_bf16 v[156:159], v[116:119], v[68:71], v[156:159]
  s_waitcnt vmcnt(20)
  s_barrier
  s_add_u32 m0, s51, 0
  s_add_u32 s46, s66, 614400
  buffer_load_dwordx4 v8, s[4:7], s46 offen  lds
  s_add_u32 m0, s51, 4096
  s_add_u32 s46, s66, 614528
  buffer_load_dwordx4 v8, s[4:7], s46 offen  lds
  s_add_u32 m0, s51, 8192
  s_add_u32 s46, s66, 614656
  buffer_load_dwordx4 v8, s[4:7], s46 offen  lds
  s_add_u32 m0, s51, 12288
  s_add_u32 s46, s66, 614784
  buffer_load_dwordx4 v8, s[4:7], s46 offen  lds
  s_add_u32 m0, s51, 16384
  s_add_u32 s46, s66, 614912
  buffer_load_dwordx4 v8, s[4:7], s46 offen  lds
  ds_read_b64_tr_b16 v[120:121], v9 offset:20480
  ds_read_b64_tr_b16 v[122:123], v9 offset:21504
  ds_read_b64_tr_b16 v[124:125], v9 offset:24576
  ds_read_b64_tr_b16 v[126:127], v9 offset:25600
  ds_read_b64_tr_b16 v[128:129], v9 offset:28672
  ds_read_b64_tr_b16 v[130:131], v9 offset:29696
  ds_read_b64_tr_b16 v[132:133], v9 offset:32768
  ds_read_b64_tr_b16 v[134:135], v9 offset:33792
  ds_read_b64_tr_b16 v[136:137], v9 offset:36864
  ds_read_b64_tr_b16 v[138:139], v9 offset:37888
  s_waitcnt lgkmcnt(0)
  v_mfma_f32_16x16x32_bf16 v[160:163], v[120:123], v[68:71], v[160:163]
  v_mfma_f32_16x16x32_bf16 v[164:167], v[124:127], v[68:71], v[164:167]
  v_mfma_f32_16x16x32_bf16 v[168:171], v[128:131], v[68:71], v[168:171]
  v_mfma_f32_16x16x32_bf16 v[172:175], v[132:135], v[68:71], v[172:175]
  v_mfma_f32_16x16x32_bf16 v[176:179], v[136:139], v[68:71], v[176:179]
  s_waitcnt vmcnt(20)
  s_barrier
  s_add_u32 m0, s51, 20480
  s_add_u32 s46, s66, 615040
  buffer_load_dwordx4 v8, s[4:7], s46 offen  lds
  s_add_u32 m0, s51, 24576
  s_add_u32 s46, s66, 615168
  buffer_load_dwordx4 v8, s[4:7], s46 offen  lds
  s_add_u32 m0, s51, 28672
  s_add_u32 s46, s66, 615296
  buffer_load_dwordx4 v8, s[4:7], s46 offen  lds
  s_add_u32 m0, s51, 32768
  s_add_u32 s46, s66, 615424
  buffer_load_dwordx4 v8, s[4:7], s46 offen  lds
  s_add_u32 m0, s51, 36864
  s_add_u32 s46, s66, 615552
  buffer_load_dwordx4 v8, s[4:7], s46 offen  lds
  ds_read_b64_tr_b16 v[100:101], v9 offset:40960
  ds_read_b64_tr_b16 v[102:103], v9 offset:41984
  ds_read_b64_tr_b16 v[104:105], v9 offset:45056
  ds_read_b64_tr_b16 v[106:107], v9 offset:46080
  ds_read_b64_tr_b16 v[108:109], v9 offset:49152
  ds_read_b64_tr_b16 v[110:111], v9 offset:50176
  ds_read_b64_tr_b16 v[112:113], v9 offset:53248
  ds_read_b64_tr_b16 v[114:115], v9 offset:54272
  ds_read_b64_tr_b16 v[116:117], v9 offset:57344
  ds_read_b64_tr_b16 v[118:119], v9 offset:58368
  s_waitcnt lgkmcnt(0)
  v_mfma_f32_16x16x32_bf16 v[140:143], v[100:103], v[72:75], v[140:143]
  v_mfma_f32_16x16x32_bf16 v[144:147], v[104:107], v[72:75], v[144:147]
  v_mfma_f32_16x16x32_bf16 v[148:151], v[108:111], v[72:75], v[148:151]
  v_mfma_f32_16x16x32_bf16 v[152:155], v[112:115], v[72:75], v[152:155]
  v_mfma_f32_16x16x32_bf16 v[156:159], v[116:119], v[72:75], v[156:159]
  s_waitcnt vmcnt(20)
  s_barrier
  s_add_u32 m0, s51, 40960
  s_add_u32 s46, s66, 655360
  buffer_load_dwordx4 v8, s[4:7], s46 offen  lds
  s_add_u32 m0, s51, 45056
  s_add_u32 s46, s66, 655488
  buffer_load_dwordx4 v8, s[4:7], s46 offen  lds
  s_add_u32 m0, s51, 49152
  s_add_u32 s46, s66, 655616
  buffer_load_dwordx4 v8, s[4:7], s46 offen  lds
  s_add_u32 m0, s51, 53248
  s_add_u32 s46, s66, 655744
  buffer_load_dwordx4 v8, s[4:7], s46 offen  lds
  s_add_u32 m0, s51, 57344
  s_add_u32 s46, s66, 655872
  buffer_load_dwordx4 v8, s[4:7], s46 offen  lds
  ds_read_b64_tr_b16 v[120:121], v9 offset:61440
  ds_read_b64_tr_b16 v[122:123], v9 offset:62464
  ds_read_b64_tr_b16 v[124:125], v10 offset:0
  ds_read_b64_tr_b16 v[126:127], v10 offset:1024
  ds_read_b64_tr_b16 v[128:129], v10 offset:4096
  ds_read_b64_tr_b16 v[130:131], v10 offset:5120
  ds_read_b64_tr_b16 v[132:133], v10 offset:8192
  ds_read_b64_tr_b16 v[134:135], v10 offset:9216
  ds_read_b64_tr_b16 v[136:137], v10 offset:12288
  ds_read_b64_tr_b16 v[138:139], v10 offset:13312
  s_waitcnt lgkmcnt(0)
  v_mfma_f32_16x16x32_bf16 v[160:163], v[120:123], v[72:75], v[160:163]
  v_mfma_f32_16x16x32_bf16 v[164:167], v[124:127], v[72:75], v[164:167]
  v_mfma_f32_16x16x32_bf16 v[168:171], v[128:131], v[72:75], v[168:171]
  v_mfma_f32_16x16x32_bf16 v[172:175], v[132:135], v[72:75], v[172:175]
  v_mfma_f32_16x16x32_bf16 v[176:179], v[136:139], v[72:75], v[176:179]
  s_waitcnt vmcnt(20)
  s_barrier
  s_add_u32 m0, s51, 61440
  s_add_u32 s46, s66, 656000
  buffer_load_dwordx4 v8, s[4:7], s46 offen  lds
  s_add_u32 m0, s51, 65536
  s_add_u32 s46, s66, 656128
  buffer_load_dwordx4 v8, s[4:7], s46 offen  lds
  s_add_u32 m0, s51, 69632
  s_add_u32 s46, s66, 656256
  buffer_load_dwordx4 v8, s[4:7], s46 offen  lds
  s_add_u32 m0, s51, 73728
  s_add_u32 s46, s66, 656384
  buffer_load_dwordx4 v8, s[4:7], s46 offen  lds
  s_add_u32 m0, s51, 77824
  s_add_u32 s46, s66, 656512
  buffer_load_dwordx4 v8, s[4:7], s46 offen  lds
  ds_read_b64_tr_b16 v[100:101], v10 offset:16384
  ds_read_b64_tr_b16 v[102:103], v10 offset:17408
  ds_read_b64_tr_b16 v[104:105], v10 offset:20480
  ds_read_b64_tr_b16 v[106:107], v10 offset:21504
  ds_read_b64_tr_b16 v[108:109], v10 offset:24576
  ds_read_b64_tr_b16 v[110:111], v10 offset:25600
  ds_read_b64_tr_b16 v[112:113], v10 offset:28672
  ds_read_b64_tr_b16 v[114:115], v10 offset:29696
  ds_read_b64_tr_b16 v[116:117], v10 offset:32768
  ds_read_b64_tr_b16 v[118:119], v10 offset:33792
  s_waitcnt lgkmcnt(0)
  v_mfma_f32_16x16x32_bf16 v[140:143], v[100:103], v[76:79], v[140:143]
  v_mfma_f32_16x16x32_bf16 v[144:147], v[104:107], v[76:79], v[144:147]
  v_mfma_f32_16x16x32_bf16 v[148:151], v[108:111], v[76:79], v[148:151]
  v_mfma_f32_16x16x32_bf16 v[152:155], v[112:115], v[76:79], v[152:155]
  v_mfma_f32_16x16x32_bf16 v[156:159], v[116:119], v[76:79], v[156:159]
  s_waitcnt vmcnt(20)
  s_barrier
  s_add_u32 m0, s51, 81920
  s_add_u32 s46, s66, 696320
  buffer_load_dwordx4 v8, s[4:7], s46 offen  lds
  s_add_u32 m0, s51, 86016
  s_add_u32 s46, s66, 696448
  buffer_load_dwordx4 v8, s[4:7], s46 offen  lds
  s_add_u32 m0, s51, 90112
  s_add_u32 s46, s66, 696576
  buffer_load_dwordx4 v8, s[4:7], s46 offen  lds
  s_add_u32 m0, s51, 94208
  s_add_u32 s46, s66, 696704
  buffer_load_dwordx4 v8, s[4:7], s46 offen  lds
  s_add_u32 m0, s51, 98304
  s_add_u32 s46, s66, 696832
  buffer_load_dwordx4 v8, s[4:7], s46 offen  lds
  ds_read_b64_tr_b16 v[120:121], v10 offset:36864
  ds_read_b64_tr_b16 v[122:123], v10 offset:37888
  ds_read_b64_tr_b16 v[124:125], v10 offset:40960
  ds_read_b64_tr_b16 v[126:127], v10 offset:41984
  ds_read_b64_tr_b16 v[128:129], v10 offset:45056
  ds_read_b64_tr_b16 v[130:131], v10 offset:46080
  ds_read_b64_tr_b16 v[132:133], v10 offset:49152
  ds_read_b64_tr_b16 v[134:135], v10 offset:50176
  ds_read_b64_tr_b16 v[136:137], v10 offset:53248
  ds_read_b64_tr_b16 v[138:139], v10 offset:54272
  s_waitcnt lgkmcnt(0)
  v_mfma_f32_16x16x32_bf16 v[160:163], v[120:123], v[76:79], v[160:163]
  v_mfma_f32_16x16x32_bf16 v[164:167], v[124:127], v[76:79], v[164:167]
  v_mfma_f32_16x16x32_bf16 v[168:171], v[128:131], v[76:79], v[168:171]
  v_mfma_f32_16x16x32_bf16 v[172:175], v[132:135], v[76:79], v[172:175]
  v_mfma_f32_16x16x32_bf16 v[176:179], v[136:139], v[76:79], v[176:179]
  s_waitcnt vmcnt(20)
  s_barrier
  s_add_u32 m0, s51, 102400
  s_add_u32 s46, s66, 696960
  buffer_load_dwordx4 v8, s[4:7], s46 offen  lds
  s_add_u32 m0, s51, 106496
  s_add_u32 s46, s66, 697088
  buffer_load_dwordx4 v8, s[4:7], s46 offen  lds
  s_add_u32 m0, s51, 110592
  s_add_u32 s46, s66, 697216
  buffer_load_dwordx4 v8, s[4:7], s46 offen  lds
  s_add_u32 m0, s51, 114688
  s_add_u32 s46, s66, 697344
  buffer_load_dwordx4 v8, s[4:7], s46 offen  lds
  s_add_u32 m0, s51, 118784
  s_add_u32 s46, s66, 697472
  buffer_load_dwordx4 v8, s[4:7], s46 offen  lds
  ds_read_b64_tr_b16 v[100:101], v9 offset:0
  ds_read_b64_tr_b16 v[102:103], v9 offset:1024
  ds_read_b64_tr_b16 v[104:105], v9 offset:4096
  ds_read_b64_tr_b16 v[106:107], v9 offset:5120
  ds_read_b64_tr_b16 v[108:109], v9 offset:8192
  ds_read_b64_tr_b16 v[110:111], v9 offset:9216
  ds_read_b64_tr_b16 v[112:113], v9 offset:12288
  ds_read_b64_tr_b16 v[114:115], v9 offset:13312
  ds_read_b64_tr_b16 v[116:117], v9 offset:16384
  ds_read_b64_tr_b16 v[118:119], v9 offset:17408
  s_waitcnt lgkmcnt(0)
  v_mfma_f32_16x16x32_bf16 v[140:143], v[100:103], v[80:83], v[140:143]
  v_mfma_f32_16x16x32_bf16 v[144:147], v[104:107], v[80:83], v[144:147]
  v_mfma_f32_16x16x32_bf16 v[148:151], v[108:111], v[80:83], v[148:151]
  v_mfma_f32_16x16x32_bf16 v[152:155], v[112:115], v[80:83], v[152:155]
  v_mfma_f32_16x16x32_bf16 v[156:159], v[116:119], v[80:83], v[156:159]
  s_waitcnt vmcnt(20)
  s_barrier
  s_add_u32 m0, s51, 0
  s_add_u32 s46, s66, 737280
  buffer_load_dwordx4 v8, s[4:7], s46 offen  lds
  s_add_u32 m0, s51, 4096
  s_add_u32 s46, s66, 737408
  buffer_load_dwordx4 v8, s[4:7], s46 offen  lds
  s_add_u32 m0, s51, 8192
  s_add_u32 s46, s66, 737536
  buffer_load_dwordx4 v8, s[4:7], s46 offen  lds
  s_add_u32 m0, s51, 12288
  s_add_u32 s46, s66, 737664
  buffer_load_dwordx4 v8, s[4:7], s46 offen  lds
  s_add_u32 m0, s51, 16384
  s_add_u32 s46, s66, 737792
  buffer_load_dwordx4 v8, s[4:7], s46 offen  lds
  ds_read_b64_tr_b16 v[120:121], v9 offset:20480
  ds_read_b64_tr_b16 v[122:123], v9 offset:21504
  ds_read_b64_tr_b16 v[124:125], v9 offset:24576
  ds_read_b64_tr_b16 v[126:127], v9 offset:25600
  ds_read_b64_tr_b16 v[128:129], v9 offset:28672
  ds_read_b64_tr_b16 v[130:131], v9 offset:29696
  ds_read_b64_tr_b16 v[132:133], v9 offset:32768
  ds_read_b64_tr_b16 v[134:135], v9 offset:33792
  ds_read_b64_tr_b16 v[136:137], v9 offset:36864
  ds_read_b64_tr_b16 v[138:139], v9 offset:37888
  s_waitcnt lgkmcnt(0)
  v_mfma_f32_16x16x32_bf16 v[160:163], v[120:123], v[80:83], v[160:163]
  v_mfma_f32_16x16x32_bf16 v[164:167], v[124:127], v[80:83], v[164:167]
  v_mfma_f32_16x16x32_bf16 v[168:171], v[128:131], v[80:83], v[168:171]
  v_mfma_f32_16x16x32_bf16 v[172:175], v[132:135], v[80:83], v[172:175]
  v_mfma_f32_16x16x32_bf16 v[176:179], v[136:139], v[80:83], v[176:179]
  s_waitcnt vmcnt(20)
  s_barrier
  s_add_u32 m0, s51, 20480
  s_add_u32 s46, s66, 737920
  buffer_load_dwordx4 v8, s[4:7], s46 offen  lds
  s_add_u32 m0, s51, 24576
  s_add_u32 s46, s66, 738048
  buffer_load_dwordx4 v8, s[4:7], s46 offen  lds
  s_add_u32 m0, s51, 28672
  s_add_u32 s46, s66, 738176
  buffer_load_dwordx4 v8, s[4:7], s46 offen  lds
  s_add_u32 m0, s51, 32768
  s_add_u32 s46, s66, 738304
  buffer_load_dwordx4 v8, s[4:7], s46 offen  lds
  s_add_u32 m0, s51, 36864
  s_add_u32 s46, s66, 738432
  buffer_load_dwordx4 v8, s[4:7], s46 offen  lds
  ds_read_b64_tr_b16 v[100:101], v9 offset:40960
  ds_read_b64_tr_b16 v[102:103], v9 offset:41984
  ds_read_b64_tr_b16 v[104:105], v9 offset:45056
  ds_read_b64_tr_b16 v[106:107], v9 offset:46080
  ds_read_b64_tr_b16 v[108:109], v9 offset:49152
  ds_read_b64_tr_b16 v[110:111], v9 offset:50176
  ds_read_b64_tr_b16 v[112:113], v9 offset:53248
  ds_read_b64_tr_b16 v[114:115], v9 offset:54272
  ds_read_b64_tr_b16 v[116:117], v9 offset:57344
  ds_read_b64_tr_b16 v[118:119], v9 offset:58368
  s_waitcnt lgkmcnt(0)
  v_mfma_f32_16x16x32_bf16 v[140:143], v[100:103], v[84:87], v[140:143]
  v_mfma_f32_16x16x32_bf16 v[144:147], v[104:107], v[84:87], v[144:147]
  v_mfma_f32_16x16x32_bf16 v[148:151], v[108:111], v[84:87], v[148:151]
  v_mfma_f32_16x16x32_bf16 v[152:155], v[112:115], v[84:87], v[152:155]
  v_mfma_f32_16x16x32_bf16 v[156:159], v[116:119], v[84:87], v[156:159]
  s_waitcnt vmcnt(20)
  s_barrier
  s_add_u32 m0, s51, 40960
  s_add_u32 s46, s66, 778240
  buffer_load_dwordx4 v8, s[4:7], s46 offen  lds
  s_add_u32 m0, s51, 45056
  s_add_u32 s46, s66, 778368
  buffer_load_dwordx4 v8, s[4:7], s46 offen  lds
  s_add_u32 m0, s51, 49152
  s_add_u32 s46, s66, 778496
  buffer_load_dwordx4 v8, s[4:7], s46 offen  lds
  s_add_u32 m0, s51, 53248
  s_add_u32 s46, s66, 778624
  buffer_load_dwordx4 v8, s[4:7], s46 offen  lds
  s_add_u32 m0, s51, 57344
  s_add_u32 s46, s66, 778752
  buffer_load_dwordx4 v8, s[4:7], s46 offen  lds
  ds_read_b64_tr_b16 v[120:121], v9 offset:61440
  ds_read_b64_tr_b16 v[122:123], v9 offset:62464
  ds_read_b64_tr_b16 v[124:125], v10 offset:0
  ds_read_b64_tr_b16 v[126:127], v10 offset:1024
  ds_read_b64_tr_b16 v[128:129], v10 offset:4096
  ds_read_b64_tr_b16 v[130:131], v10 offset:5120
  ds_read_b64_tr_b16 v[132:133], v10 offset:8192
  ds_read_b64_tr_b16 v[134:135], v10 offset:9216
  ds_read_b64_tr_b16 v[136:137], v10 offset:12288
  ds_read_b64_tr_b16 v[138:139], v10 offset:13312
  s_waitcnt lgkmcnt(0)
  v_mfma_f32_16x16x32_bf16 v[160:163], v[120:123], v[84:87], v[160:163]
  v_mfma_f32_16x16x32_bf16 v[164:167], v[124:127], v[84:87], v[164:167]
  v_mfma_f32_16x16x32_bf16 v[168:171], v[128:131], v[84:87], v[168:171]
  v_mfma_f32_16x16x32_bf16 v[172:175], v[132:135], v[84:87], v[172:175]
  v_mfma_f32_16x16x32_bf16 v[176:179], v[136:139], v[84:87], v[176:179]
  s_waitcnt vmcnt(20)
  s_barrier
  s_add_u32 m0, s51, 61440
  s_add_u32 s46, s66, 778880
  buffer_load_dwordx4 v8, s[4:7], s46 offen  lds
  s_add_u32 m0, s51, 65536
  s_add_u32 s46, s66, 779008
  buffer_load_dwordx4 v8, s[4:7], s46 offen  lds
  s_add_u32 m0, s51, 69632
  s_add_u32 s46, s66, 779136
  buffer_load_dwordx4 v8, s[4:7], s46 offen  lds
  s_add_u32 m0, s51, 73728
  s_add_u32 s46, s66, 779264
  buffer_load_dwordx4 v8, s[4:7], s46 offen  lds
  s_add_u32 m0, s51, 77824
  s_add_u32 s46, s66, 779392
  buffer_load_dwordx4 v8, s[4:7], s46 offen  lds
  ds_read_b64_tr_b16 v[100:101], v10 offset:16384
  ds_read_b64_tr_b16 v[102:103], v10 offset:17408
  ds_read_b64_tr_b16 v[104:105], v10 offset:20480
  ds_read_b64_tr_b16 v[106:107], v10 offset:21504
  ds_read_b64_tr_b16 v[108:109], v10 offset:24576
  ds_read_b64_tr_b16 v[110:111], v10 offset:25600
  ds_read_b64_tr_b16 v[112:113], v10 offset:28672
  ds_read_b64_tr_b16 v[114:115], v10 offset:29696
  ds_read_b64_tr_b16 v[116:117], v10 offset:32768
  ds_read_b64_tr_b16 v[118:119], v10 offset:33792
  s_waitcnt lgkmcnt(0)
  v_mfma_f32_16x16x32_bf16 v[140:143], v[100:103], v[88:91], v[140:143]
  v_mfma_f32_16x16x32_bf16 v[144:147], v[104:107], v[88:91], v[144:147]
  v_mfma_f32_16x16x32_bf16 v[148:151], v[108:111], v[88:91], v[148:151]
  v_mfma_f32_16x16x32_bf16 v[152:155], v[112:115], v[88:91], v[152:155]
  v_mfma_f32_16x16x32_bf16 v[156:159], v[116:119], v[88:91], v[156:159]
  s_waitcnt vmcnt(20)
  s_barrier
  ds_read_b64_tr_b16 v[120:121], v10 offset:36864
  ds_read_b64_tr_b16 v[122:123], v10 offset:37888
  ds_read_b64_tr_b16 v[124:125], v10 offset:40960
  ds_read_b64_tr_b16 v[126:127], v10 offset:41984
  ds_read_b64_tr_b16 v[128:129], v10 offset:45056
  ds_read_b64_tr_b16 v[130:131], v10 offset:46080
  ds_read_b64_tr_b16 v[132:133], v10 offset:49152
  ds_read_b64_tr_b16 v[134:135], v10 offset:50176
  ds_read_b64_tr_b16 v[136:137], v10 offset:53248
  ds_read_b64_tr_b16 v[138:139], v10 offset:54272
  s_waitcnt lgkmcnt(0)
  v_mfma_f32_16x16x32_bf16 v[160:163], v[120:123], v[88:91], v[160:163]
  v_mfma_f32_16x16x32_bf16 v[164:167], v[124:127], v[88:91], v[164:167]
  v_mfma_f32_16x16x32_bf16 v[168:171], v[128:131], v[88:91], v[168:171]
  v_mfma_f32_16x16x32_bf16 v[172:175], v[132:135], v[88:91], v[172:175]
  v_mfma_f32_16x16x32_bf16 v[176:179], v[136:139], v[88:91], v[176:179]
  s_waitcnt vmcnt(15)
  s_barrier
  ds_read_b64_tr_b16 v[100:101], v9 offset:0
  ds_read_b64_tr_b16 v[102:103], v9 offset:1024
  ds_read_b64_tr_b16 v[104:105], v9 offset:4096
  ds_read_b64_tr_b16 v[106:107], v9 offset:5120
  ds_read_b64_tr_b16 v[108:109], v9 offset:8192
  ds_read_b64_tr_b16 v[110:111], v9 offset:9216
  ds_read_b64_tr_b16 v[112:113], v9 offset:12288
  ds_read_b64_tr_b16 v[114:115], v9 offset:13312
  ds_read_b64_tr_b16 v[116:117], v9 offset:16384
  ds_read_b64_tr_b16 v[118:119], v9 offset:17408
  s_waitcnt lgkmcnt(0)
  v_mfma_f32_16x16x32_bf16 v[140:143], v[100:103], v[92:95], v[140:143]
  v_mfma_f32_16x16x32_bf16 v[144:147], v[104:107], v[92:95], v[144:147]
  v_mfma_f32_16x16x32_bf16 v[148:151], v[108:111], v[92:95], v[148:151]
  v_mfma_f32_16x16x32_bf16 v[152:155], v[112:115], v[92:95], v[152:155]
  v_mfma_f32_16x16x32_bf16 v[156:159], v[116:119], v[92:95], v[156:159]
  s_waitcnt vmcnt(10)
  s_barrier
  ds_read_b64_tr_b16 v[120:121], v9 offset:20480
  ds_read_b64_tr_b16 v[122:123], v9 offset:21504
  ds_read_b64_tr_b16 v[124:125], v9 offset:24576
  ds_read_b64_tr_b16 v[126:127], v9 offset:25600
  ds_read_b64_tr_b16 v[128:129], v9 offset:28672
  ds_read_b64_tr_b16 v[130:131], v9 offset:29696
  ds_read_b64_tr_b16 v[132:133], v9 offset:32768
  ds_read_b64_tr_b16 v[134:135], v9 offset:33792
  ds_read_b64_tr_b16 v[136:137], v9 offset:36864
  ds_read_b64_tr_b16 v[138:139], v9 offset:37888
  s_waitcnt lgkmcnt(0)
  v_mfma_f32_16x16x32_bf16 v[160:163], v[120:123], v[92:95], v[160:163]
  v_mfma_f32_16x16x32_bf16 v[164:167], v[124:127], v[92:95], v[164:167]
  v_mfma_f32_16x16x32_bf16 v[168:171], v[128:131], v[92:95], v[168:171]
  v_mfma_f32_16x16x32_bf16 v[172:175], v[132:135], v[92:95], v[172:175]
  v_mfma_f32_16x16x32_bf16 v[176:179], v[136:139], v[92:95], v[176:179]
  s_waitcnt vmcnt(5)
  s_barrier
  ds_read_b64_tr_b16 v[100:101], v9 offset:40960
  ds_read_b64_tr_b16 v[102:103], v9 offset:41984
  ds_read_b64_tr_b16 v[104:105], v9 offset:45056
  ds_read_b64_tr_b16 v[106:107], v9 offset:46080
  ds_read_b64_tr_b16 v[108:109], v9 offset:49152
  ds_read_b64_tr_b16 v[110:111], v9 offset:50176
  ds_read_b64_tr_b16 v[112:113], v9 offset:53248
  ds_read_b64_tr_b16 v[114:115], v9 offset:54272
  ds_read_b64_tr_b16 v[116:117], v9 offset:57344
  ds_read_b64_tr_b16 v[118:119], v9 offset:58368
  s_waitcnt lgkmcnt(0)
  v_mfma_f32_16x16x32_bf16 v[140:143], v[100:103], v[96:99], v[140:143]
  v_mfma_f32_16x16x32_bf16 v[144:147], v[104:107], v[96:99], v[144:147]
  v_mfma_f32_16x16x32_bf16 v[148:151], v[108:111], v[96:99], v[148:151]
  v_mfma_f32_16x16x32_bf16 v[152:155], v[112:115], v[96:99], v[152:155]
  v_mfma_f32_16x16x32_bf16 v[156:159], v[116:119], v[96:99], v[156:159]
  s_waitcnt vmcnt(0)
  s_barrier
  ds_read_b64_tr_b16 v[120:121], v9 offset:61440
  ds_read_b64_tr_b16 v[122:123], v9 offset:62464
  ds_read_b64_tr_b16 v[124:125], v10 offset:0
  ds_read_b64_tr_b16 v[126:127], v10 offset:1024
  ds_read_b64_tr_b16 v[128:129], v10 offset:4096
  ds_read_b64_tr_b16 v[130:131], v10 offset:5120
  ds_read_b64_tr_b16 v[132:133], v10 offset:8192
  ds_read_b64_tr_b16 v[134:135], v10 offset:9216
  ds_read_b64_tr_b16 v[136:137], v10 offset:12288
  ds_read_b64_tr_b16 v[138:139], v10 offset:13312
  s_waitcnt lgkmcnt(0)
  v_mfma_f32_16x16x32_bf16 v[160:163], v[120:123], v[96:99], v[160:163]
  v_mfma_f32_16x16x32_bf16 v[164:167], v[124:127], v[96:99], v[164:167]
  v_mfma_f32_16x16x32_bf16 v[168:171], v[128:131], v[96:99], v[168:171]
  v_mfma_f32_16x16x32_bf16 v[172:175], v[132:135], v[96:99], v[172:175]
  v_mfma_f32_16x16x32_bf16 v[176:179], v[136:139], v[96:99], v[176:179]
  s_barrier
  v_cvt_pk_bf16_f32 v140, v140, v141
  v_cvt_pk_bf16_f32 v141, v142, v143
  buffer_store_dwordx2 v[140:141], v12, s[12:15], 0 offen offset:0
  v_cvt_pk_bf16_f32 v144, v144, v145
  v_cvt_pk_bf16_f32 v145, v146, v147
  buffer_store_dwordx2 v[144:145], v12, s[12:15], 0 offen offset:128
  v_cvt_pk_bf16_f32 v148, v148, v149
  v_cvt_pk_bf16_f32 v149, v150, v151
  buffer_store_dwordx2 v[148:149], v12, s[12:15], 0 offen offset:256
  v_cvt_pk_bf16_f32 v152, v152, v153
  v_cvt_pk_bf16_f32 v153, v154, v155
  buffer_store_dwordx2 v[152:153], v12, s[12:15], 0 offen offset:384
  v_cvt_pk_bf16_f32 v156, v156, v157
  v_cvt_pk_bf16_f32 v157, v158, v159
  buffer_store_dwordx2 v[156:157], v12, s[12:15], 0 offen offset:512
  v_cvt_pk_bf16_f32 v160, v160, v161
  v_cvt_pk_bf16_f32 v161, v162, v163
  buffer_store_dwordx2 v[160:161], v12, s[12:15], 0 offen offset:640
  v_cvt_pk_bf16_f32 v164, v164, v165
  v_cvt_pk_bf16_f32 v165, v166, v167
  buffer_store_dwordx2 v[164:165], v12, s[12:15], 0 offen offset:768
  v_cvt_pk_bf16_f32 v168, v168, v169
  v_cvt_pk_bf16_f32 v169, v170, v171
  buffer_store_dwordx2 v[168:169], v12, s[12:15], 0 offen offset:896
  v_cvt_pk_bf16_f32 v172, v172, v173
  v_cvt_pk_bf16_f32 v173, v174, v175
  buffer_store_dwordx2 v[172:173], v12, s[12:15], 0 offen offset:1024
  v_cvt_pk_bf16_f32 v176, v176, v177
  v_cvt_pk_bf16_f32 v177, v178, v179
  buffer_store_dwordx2 v[176:177], v12, s[12:15], 0 offen offset:1152
  s_endpgm
L_recur:
  s_cmp_lt_u32 s44, 8
  s_cbranch_scc1 L_score
  s_cmp_lt_u32 s44, 16
  s_cbranch_scc1 L_value
  s_cmp_lt_u32 s44, 28
  s_cbranch_scc1 rc_nowarm
  s_lshl_b32 s46, s44, 2
  s_add_u32 s46, s46, s43
  s_lshl_b32 s46, s46, 2
  s_add_u32 s46, s46, s42
  s_sub_u32 s46, s46, 448
  s_lshl_b32 s46, s46, 13
  v_lshlrev_b32 v1, 7, v0
  s_add_u32 s47, s46, 0
  buffer_load_dword v250, v1, s[12:15], s47 offen
  s_add_u32 s47, s46, 524288
  buffer_load_dword v250, v1, s[12:15], s47 offen
  s_add_u32 s47, s46, 1048576
  buffer_load_dword v250, v1, s[12:15], s47 offen
  s_add_u32 s47, s46, 1572864
  buffer_load_dword v250, v1, s[12:15], s47 offen
  s_add_u32 s47, s46, 2097152
  buffer_load_dword v250, v1, s[12:15], s47 offen
rc_nowarm:
  v_and_b32 v3, 3, v0
  v_lshlrev_b32 v3, 2, v3
  s_mov_b32 s50, 0
ss_13:
  global_load_dword v2, v3, s[38:39] sc1
  s_add_u32 s50, s50, 1
  s_cmp_gt_u32 s50, 131072
  s_cbranch_scc1 L_fail
  s_waitcnt vmcnt(0)
  v_readlane_b32 s46, v2, 0
  v_readlane_b32 s47, v2, 0
  v_readlane_b32 s48, v2, 0
  s_nop 0
  s_min_u32 s47, s47, s48
  s_cmp_lg_u32 s46, 0
  s_cselect_b32 s48, 7, 0
  s_add_u32 s46, s46, s2
  s_xor_b32 s49, s46, s43
  s_and_b32 s49, s49, s48
  s_cbranch_scc1 L_reroll
  s_cmp_lg_u32 s47, 0
  s_cbranch_scc1 ss_ok_14
  s_sleep 6
  s_branch ss_13
ss_ok_14:
  s_cmp_lt_u32 s44, 26
  s_cbranch_scc1 L_owner
  s_branch L_xowner
L_score:
  s_mov_b32 s4, s26
  s_mov_b32 s5, s27
  s_mov_b32 s6, 7864320
  s_mov_b32 s7, 0x20000
  s_mov_b32 s12, s28
  s_mov_b32 s13, s29
  s_mov_b32 s14, 7864320
  s_mov_b32 s15, 0x20000
  v_lshrrev_b32 v136, 3, v0
  v_lshrrev_b32 v137, 2, v136
  v_lshlrev_b32 v137, 3, v137
  v_and_b32 v64, 3, v136
  v_add_u32 v64, v64, v137
  s_and_b32 s46, s42, 1
  s_lshl_b32 s46, s46, 2
  s_lshr_b32 s47, s42, 1
  s_lshl_b32 s47, s47, 4
  s_add_u32 s46, s46, s47
  v_add_u32 v64, s46, v64
  v_mul_u32_u24 v64, 12288, v64
  v_lshrrev_b32 v136, 1, v136
  v_bfe_u32 v137, v0, 1, 2
  v_xor_b32 v136, v136, v137
  v_lshlrev_b32 v136, 5, v136
  v_and_b32 v137, 1, v0
  v_lshlrev_b32 v137, 4, v137
  v_add3_u32 v64, v64, v136, v137
  v_lshrrev_b32 v136, 5, v0
  v_lshlrev_b32 v65, 11, v136
  v_bfe_u32 v136, v0, 2, 3
  v_lshl_add_u32 v65, v136, 7, v65
  v_lshrrev_b32 v136, 1, v136
  v_xor_b32 v136, s42, v136
  v_lshl_add_u32 v65, v136, 5, v65
  v_and_b32 v136, 3, v0
  v_lshl_add_u32 v65, v136, 3, v65
  v_add_u32 v66, 0x10000, v65
  v_add_u32 v67, 0x20000, v65
  v_lshlrev_b32 v1, 4, v0
  v_add_u32 v2, s51, v1
  v_add_u32 v3, 0x10000, v2
  s_mul_i32 s62, s45, 384
  s_mov_b32 s24, 4096
  s_mov_b32 s25, 49152
  s_add_u32 m0, s51, 73728
  s_add_u32 s46, s62, 786432
  buffer_load_dwordx4 v64, s[12:15], s46 offen  lds
  s_add_u32 m0, s51, 77824
  s_add_u32 s46, s62, 1179648
  buffer_load_dwordx4 v64, s[12:15], s46 offen  lds
  s_add_u32 m0, s51, 81920
  s_add_u32 s46, s62, 786560
  buffer_load_dwordx4 v64, s[12:15], s46 offen  lds
  s_add_u32 m0, s51, 86016
  s_add_u32 s46, s62, 1179776
  buffer_load_dwordx4 v64, s[12:15], s46 offen  lds
  s_add_u32 m0, s51, 90112
  s_add_u32 s46, s62, 786688
  buffer_load_dwordx4 v64, s[12:15], s46 offen  lds
  s_add_u32 m0, s51, 94208
  s_add_u32 s46, s62, 1179904
  buffer_load_dwordx4 v64, s[12:15], s46 offen  lds
  s_add_u32 m0, s51, 98304
  s_add_u32 s46, s62, 1572864
  buffer_load_dwordx4 v64, s[12:15], s46 offen  lds
  s_add_u32 m0, s51, 102400
  s_add_u32 s46, s62, 1966080
  buffer_load_dwordx4 v64, s[12:15], s46 offen  lds
  s_add_u32 m0, s51, 106496
  s_add_u32 s46, s62, 1572992
  buffer_load_dwordx4 v64, s[12:15], s46 offen  lds
  s_add_u32 m0, s51, 110592
  s_add_u32 s46, s62, 1966208
  buffer_load_dwordx4 v64, s[12:15], s46 offen  lds
  s_add_u32 m0, s51, 114688
  s_add_u32 s46, s62, 1573120
  buffer_load_dwordx4 v64, s[12:15], s46 offen  lds
  s_add_u32 m0, s51, 118784
  s_add_u32 s46, s62, 1966336
  buffer_load_dwordx4 v64, s[12:15], s46 offen  lds
  s_add_u32 m0, s51, 122880
  s_add_u32 s46, s62, 2359296
  buffer_load_dwordx4 v64, s[12:15], s46 offen  lds
  s_add_u32 m0, s51, 126976
  s_add_u32 s46, s62, 2752512
  buffer_load_dwordx4 v64, s[12:15], s46 offen  lds
  s_add_u32 m0, s51, 131072
  s_add_u32 s46, s62, 2359424
  buffer_load_dwordx4 v64, s[12:15], s46 offen  lds
  s_add_u32 m0, s51, 135168
  s_add_u32 s46, s62, 2752640
  buffer_load_dwordx4 v64, s[12:15], s46 offen  lds
  s_add_u32 m0, s51, 139264
  s_add_u32 s46, s62, 2359552
  buffer_load_dwordx4 v64, s[12:15], s46 offen  lds
  s_add_u32 m0, s51, 143360
  s_add_u32 s46, s62, 2752768
  buffer_load_dwordx4 v64, s[12:15], s46 offen  lds
  s_add_u32 m0, s51, 0
  s_add_u32 s46, s62, 3145728
  buffer_load_dwordx4 v64, s[12:15], s46 offen  lds
  s_add_u32 m0, s51, 4096
  s_add_u32 s46, s62, 3538944
  buffer_load_dwordx4 v64, s[12:15], s46 offen  lds
  s_add_u32 m0, s51, 8192
  s_add_u32 s46, s62, 3145856
  buffer_load_dwordx4 v64, s[12:15], s46 offen  lds
  s_add_u32 m0, s51, 12288
  s_add_u32 s46, s62, 3539072
  buffer_load_dwordx4 v64, s[12:15], s46 offen  lds
  s_add_u32 m0, s51, 16384
  s_add_u32 s46, s62, 3145984
  buffer_load_dwordx4 v64, s[12:15], s46 offen  lds
  s_add_u32 m0, s51, 20480
  s_add_u32 s46, s62, 3539200
  buffer_load_dwordx4 v64, s[12:15], s46 offen  lds
  s_add_u32 m0, s51, 24576
  s_add_u32 s46, s62, 4718592
  buffer_load_dwordx4 v64, s[12:15], s46 offen  lds
  s_add_u32 m0, s51, 28672
  s_add_u32 s46, s62, 5111808
  buffer_load_dwordx4 v64, s[12:15], s46 offen  lds
  s_add_u32 m0, s51, 32768
  s_add_u32 s46, s62, 4718720
  buffer_load_dwordx4 v64, s[12:15], s46 offen  lds
  s_add_u32 m0, s51, 36864
  s_add_u32 s46, s62, 5111936
  buffer_load_dwordx4 v64, s[12:15], s46 offen  lds
  s_add_u32 m0, s51, 40960
  s_add_u32 s46, s62, 4718848
  buffer_load_dwordx4 v64, s[12:15], s46 offen  lds
  s_add_u32 m0, s51, 45056
  s_add_u32 s46, s62, 5112064
  buffer_load_dwordx4 v64, s[12:15], s46 offen  lds
  s_waitcnt vmcnt(24)
  s_barrier
  s_add_u32 m0, s51, 49152
  s_add_u32 s46, s62, 5505024
  buffer_load_dwordx4 v64, s[12:15], s46 offen  lds
  s_add_u32 m0, s51, 53248
  s_add_u32 s46, s62, 5898240
  buffer_load_dwordx4 v64, s[12:15], s46 offen  lds
  s_add_u32 m0, s51, 57344
  s_add_u32 s46, s62, 5505152
  buffer_load_dwordx4 v64, s[12:15], s46 offen  lds
  s_add_u32 m0, s51, 61440
  s_add_u32 s46, s62, 5898368
  buffer_load_dwordx4 v64, s[12:15], s46 offen  lds
  s_add_u32 m0, s51, 65536
  s_add_u32 s46, s62, 5505280
  buffer_load_dwordx4 v64, s[12:15], s46 offen  lds
  s_add_u32 m0, s51, 69632
  s_add_u32 s46, s62, 5898496
  buffer_load_dwordx4 v64, s[12:15], s46 offen  lds
  ds_read_b64_tr_b16 a[0:1], v66 offset:8192
  ds_read_b64_tr_b16 a[2:3], v66 offset:9216
  ds_read_b64_tr_b16 a[4:5], v66 offset:12288
  ds_read_b64_tr_b16 a[6:7], v66 offset:13312
  ds_read_b64_tr_b16 a[8:9], v66 offset:16384
  ds_read_b64_tr_b16 a[10:11], v66 offset:17408
  ds_read_b64_tr_b16 a[12:13], v66 offset:20480
  ds_read_b64_tr_b16 a[14:15], v66 offset:21504
  ds_read_b64_tr_b16 a[16:17], v66 offset:24576
  ds_read_b64_tr_b16 a[18:19], v66 offset:25600
  ds_read_b64_tr_b16 a[20:21], v66 offset:28672
  ds_read_b64_tr_b16 a[22:23], v66 offset:29696
  s_waitcnt lgkmcnt(0)
  s_waitcnt vmcnt(24)
  s_barrier
  s_add_u32 m0, s51, 73728
  s_add_u32 s46, s62, 6291456
  buffer_load_dwordx4 v64, s[12:15], s46 offen  lds
  s_add_u32 m0, s51, 77824
  s_add_u32 s46, s62, 6684672
  buffer_load_dwordx4 v64, s[12:15], s46 offen  lds
  s_add_u32 m0, s51, 81920
  s_add_u32 s46, s62, 6291584
  buffer_load_dwordx4 v64, s[12:15], s46 offen  lds
  s_add_u32 m0, s51, 86016
  s_add_u32 s46, s62, 6684800
  buffer_load_dwordx4 v64, s[12:15], s46 offen  lds
  s_add_u32 m0, s51, 90112
  s_add_u32 s46, s62, 6291712
  buffer_load_dwordx4 v64, s[12:15], s46 offen  lds
  s_add_u32 m0, s51, 94208
  s_add_u32 s46, s62, 6684928
  buffer_load_dwordx4 v64, s[12:15], s46 offen  lds
  ds_read_b64_tr_b16 a[24:25], v66 offset:32768
  ds_read_b64_tr_b16 a[26:27], v66 offset:33792
  ds_read_b64_tr_b16 a[28:29], v66 offset:36864
  ds_read_b64_tr_b16 a[30:31], v66 offset:37888
  ds_read_b64_tr_b16 a[32:33], v66 offset:40960
  ds_read_b64_tr_b16 a[34:35], v66 offset:41984
  ds_read_b64_tr_b16 a[36:37], v66 offset:45056
  ds_read_b64_tr_b16 a[38:39], v66 offset:46080
  ds_read_b64_tr_b16 a[40:41], v66 offset:49152
  ds_read_b64_tr_b16 a[42:43], v66 offset:50176
  ds_read_b64_tr_b16 a[44:45], v66 offset:53248
  ds_read_b64_tr_b16 a[46:47], v66 offset:54272
  s_waitcnt lgkmcnt(0)
  s_waitcnt vmcnt(24)
  s_barrier
  s_add_u32 m0, s51, 98304
  s_add_u32 s46, s62, 7077888
  buffer_load_dwordx4 v64, s[12:15], s46 offen  lds
  s_add_u32 m0, s51, 102400
  s_add_u32 s46, s62, 7471104
  buffer_load_dwordx4 v64, s[12:15], s46 offen  lds
  s_add_u32 m0, s51, 106496
  s_add_u32 s46, s62, 7078016
  buffer_load_dwordx4 v64, s[12:15], s46 offen  lds
  s_add_u32 m0, s51, 110592
  s_add_u32 s46, s62, 7471232
  buffer_load_dwordx4 v64, s[12:15], s46 offen  lds
  s_add_u32 m0, s51, 114688
  s_add_u32 s46, s62, 7078144
  buffer_load_dwordx4 v64, s[12:15], s46 offen  lds
  s_add_u32 m0, s51, 118784
  s_add_u32 s46, s62, 7471360
  buffer_load_dwordx4 v64, s[12:15], s46 offen  lds
  ds_read_b64_tr_b16 a[48:49], v66 offset:57344
  ds_read_b64_tr_b16 a[50:51], v66 offset:58368
  ds_read_b64_tr_b16 a[52:53], v66 offset:61440
  ds_read_b64_tr_b16 a[54:55], v66 offset:62464
  ds_read_b64_tr_b16 a[56:57], v67 offset:0
  ds_read_b64_tr_b16 a[58:59], v67 offset:1024
  ds_read_b64_tr_b16 a[60:61], v67 offset:4096
  ds_read_b64_tr_b16 a[62:63], v67 offset:5120
  ds_read_b64_tr_b16 a[64:65], v67 offset:8192
  ds_read_b64_tr_b16 a[66:67], v67 offset:9216
  ds_read_b64_tr_b16 a[68:69], v67 offset:12288
  ds_read_b64_tr_b16 a[70:71], v67 offset:13312
  s_waitcnt lgkmcnt(0)
  s_waitcnt vmcnt(24)
  s_barrier
  s_add_u32 m0, s51, 122880
  s_add_u32 s46, s62, 0
  buffer_load_dwordx4 v64, s[4:7], s46 offen  lds
  s_add_u32 m0, s51, 126976
  s_add_u32 s46, s62, 393216
  buffer_load_dwordx4 v64, s[4:7], s46 offen  lds
  s_add_u32 m0, s51, 131072
  s_add_u32 s46, s62, 128
  buffer_load_dwordx4 v64, s[4:7], s46 offen  lds
  s_add_u32 m0, s51, 135168
  s_add_u32 s46, s62, 393344
  buffer_load_dwordx4 v64, s[4:7], s46 offen  lds
  s_add_u32 m0, s51, 139264
  s_add_u32 s46, s62, 256
  buffer_load_dwordx4 v64, s[4:7], s46 offen  lds
  s_add_u32 m0, s51, 143360
  s_add_u32 s46, s62, 393472
  buffer_load_dwordx4 v64, s[4:7], s46 offen  lds
  ds_read_b64_tr_b16 a[72:73], v65 offset:0
  ds_read_b64_tr_b16 a[74:75], v65 offset:1024
  ds_read_b64_tr_b16 a[76:77], v65 offset:4096
  ds_read_b64_tr_b16 a[78:79], v65 offset:5120
  ds_read_b64_tr_b16 a[80:81], v65 offset:8192
  ds_read_b64_tr_b16 a[82:83], v65 offset:9216
  ds_read_b64_tr_b16 a[84:85], v65 offset:12288
  ds_read_b64_tr_b16 a[86:87], v65 offset:13312
  ds_read_b64_tr_b16 a[88:89], v65 offset:16384
  ds_read_b64_tr_b16 a[90:91], v65 offset:17408
  ds_read_b64_tr_b16 a[92:93], v65 offset:20480
  ds_read_b64_tr_b16 a[94:95], v65 offset:21504
  s_waitcnt lgkmcnt(0)
  s_waitcnt vmcnt(24)
  s_barrier
  s_add_u32 m0, s51, 0
  s_add_u32 s46, s62, 786432
  buffer_load_dwordx4 v64, s[4:7], s46 offen  lds
  s_add_u32 m0, s51, 4096
  s_add_u32 s46, s62, 1179648
  buffer_load_dwordx4 v64, s[4:7], s46 offen  lds
  s_add_u32 m0, s51, 8192
  s_add_u32 s46, s62, 786560
  buffer_load_dwordx4 v64, s[4:7], s46 offen  lds
  s_add_u32 m0, s51, 12288
  s_add_u32 s46, s62, 1179776
  buffer_load_dwordx4 v64, s[4:7], s46 offen  lds
  s_add_u32 m0, s51, 16384
  s_add_u32 s46, s62, 786688
  buffer_load_dwordx4 v64, s[4:7], s46 offen  lds
  s_add_u32 m0, s51, 20480
  s_add_u32 s46, s62, 1179904
  buffer_load_dwordx4 v64, s[4:7], s46 offen  lds
  ds_read_b64_tr_b16 a[96:97], v65 offset:24576
  ds_read_b64_tr_b16 a[98:99], v65 offset:25600
  ds_read_b64_tr_b16 a[100:101], v65 offset:28672
  ds_read_b64_tr_b16 a[102:103], v65 offset:29696
  ds_read_b64_tr_b16 a[104:105], v65 offset:32768
  ds_read_b64_tr_b16 a[106:107], v65 offset:33792
  ds_read_b64_tr_b16 a[108:109], v65 offset:36864
  ds_read_b64_tr_b16 a[110:111], v65 offset:37888
  ds_read_b64_tr_b16 a[112:113], v65 offset:40960
  ds_read_b64_tr_b16 a[114:115], v65 offset:41984
  ds_read_b64_tr_b16 a[116:117], v65 offset:45056
  ds_read_b64_tr_b16 a[118:119], v65 offset:46080
  s_waitcnt lgkmcnt(0)
  s_waitcnt vmcnt(24)
  s_barrier
  s_add_u32 m0, s51, 24576
  s_add_u32 s46, s62, 1572864
  buffer_load_dwordx4 v64, s[4:7], s46 offen  lds
  s_add_u32 m0, s51, 28672
  s_add_u32 s46, s62, 1966080
  buffer_load_dwordx4 v64, s[4:7], s46 offen  lds
  s_add_u32 m0, s51, 32768
  s_add_u32 s46, s62, 1572992
  buffer_load_dwordx4 v64, s[4:7], s46 offen  lds
  s_add_u32 m0, s51, 36864
  s_add_u32 s46, s62, 1966208
  buffer_load_dwordx4 v64, s[4:7], s46 offen  lds
  s_add_u32 m0, s51, 40960
  s_add_u32 s46, s62, 1573120
  buffer_load_dwordx4 v64, s[4:7], s46 offen  lds
  s_add_u32 m0, s51, 45056
  s_add_u32 s46, s62, 1966336
  buffer_load_dwordx4 v64, s[4:7], s46 offen  lds
  ds_read_b64_tr_b16 a[120:121], v65 offset:49152
  ds_read_b64_tr_b16 a[122:123], v65 offset:50176
  ds_read_b64_tr_b16 a[124:125], v65 offset:53248
  ds_read_b64_tr_b16 a[126:127], v65 offset:54272
  ds_read_b64_tr_b16 a[128:129], v65 offset:57344
  ds_read_b64_tr_b16 a[130:131], v65 offset:58368
  ds_read_b64_tr_b16 a[132:133], v65 offset:61440
  ds_read_b64_tr_b16 a[134:135], v65 offset:62464
  ds_read_b64_tr_b16 a[136:137], v66 offset:0
  ds_read_b64_tr_b16 a[138:139], v66 offset:1024
  ds_read_b64_tr_b16 a[140:141], v66 offset:4096
  ds_read_b64_tr_b16 a[142:143], v66 offset:5120
  s_waitcnt lgkmcnt(0)
  s_waitcnt vmcnt(24)
  s_barrier
  s_add_u32 m0, s51, 49152
  s_add_u32 s46, s62, 3145728
  buffer_load_dwordx4 v64, s[4:7], s46 offen  lds
  s_add_u32 m0, s51, 53248
  s_add_u32 s46, s62, 3538944
  buffer_load_dwordx4 v64, s[4:7], s46 offen  lds
  s_add_u32 m0, s51, 57344
  s_add_u32 s46, s62, 3145856
  buffer_load_dwordx4 v64, s[4:7], s46 offen  lds
  s_add_u32 m0, s51, 61440
  s_add_u32 s46, s62, 3539072
  buffer_load_dwordx4 v64, s[4:7], s46 offen  lds
  s_add_u32 m0, s51, 65536
  s_add_u32 s46, s62, 3145984
  buffer_load_dwordx4 v64, s[4:7], s46 offen  lds
  s_add_u32 m0, s51, 69632
  s_add_u32 s46, s62, 3539200
  buffer_load_dwordx4 v64, s[4:7], s46 offen  lds
  ds_read_b64_tr_b16 a[144:145], v66 offset:8192
  ds_read_b64_tr_b16 a[146:147], v66 offset:9216
  ds_read_b64_tr_b16 a[148:149], v66 offset:12288
  ds_read_b64_tr_b16 a[150:151], v66 offset:13312
  ds_read_b64_tr_b16 a[152:153], v66 offset:16384
  ds_read_b64_tr_b16 a[154:155], v66 offset:17408
  ds_read_b64_tr_b16 a[156:157], v66 offset:20480
  ds_read_b64_tr_b16 a[158:159], v66 offset:21504
  ds_read_b64_tr_b16 a[160:161], v66 offset:24576
  ds_read_b64_tr_b16 a[162:163], v66 offset:25600
  ds_read_b64_tr_b16 a[164:165], v66 offset:28672
  ds_read_b64_tr_b16 a[166:167], v66 offset:29696
  s_waitcnt lgkmcnt(0)
  s_waitcnt vmcnt(24)
  s_barrier
  s_add_u32 m0, s51, 73728
  s_add_u32 s46, s62, 3932160
  buffer_load_dwordx4 v64, s[4:7], s46 offen  lds
  s_add_u32 m0, s51, 77824
  s_add_u32 s46, s62, 4325376
  buffer_load_dwordx4 v64, s[4:7], s46 offen  lds
  s_add_u32 m0, s51, 81920
  s_add_u32 s46, s62, 3932288
  buffer_load_dwordx4 v64, s[4:7], s46 offen  lds
  s_add_u32 m0, s51, 86016
  s_add_u32 s46, s62, 4325504
  buffer_load_dwordx4 v64, s[4:7], s46 offen  lds
  s_add_u32 m0, s51, 90112
  s_add_u32 s46, s62, 3932416
  buffer_load_dwordx4 v64, s[4:7], s46 offen  lds
  s_add_u32 m0, s51, 94208
  s_add_u32 s46, s62, 4325632
  buffer_load_dwordx4 v64, s[4:7], s46 offen  lds
  ds_read_b64_tr_b16 a[168:169], v66 offset:32768
  ds_read_b64_tr_b16 a[170:171], v66 offset:33792
  ds_read_b64_tr_b16 a[172:173], v66 offset:36864
  ds_read_b64_tr_b16 a[174:175], v66 offset:37888
  ds_read_b64_tr_b16 a[176:177], v66 offset:40960
  ds_read_b64_tr_b16 a[178:179], v66 offset:41984
  ds_read_b64_tr_b16 a[180:181], v66 offset:45056
  ds_read_b64_tr_b16 a[182:183], v66 offset:46080
  ds_read_b64_tr_b16 a[184:185], v66 offset:49152
  ds_read_b64_tr_b16 a[186:187], v66 offset:50176
  ds_read_b64_tr_b16 a[188:189], v66 offset:53248
  ds_read_b64_tr_b16 a[190:191], v66 offset:54272
  s_waitcnt lgkmcnt(0)
  s_waitcnt vmcnt(24)
  s_barrier
  s_add_u32 m0, s51, 98304
  s_add_u32 s46, s62, 5505024
  buffer_load_dwordx4 v64, s[4:7], s46 offen  lds
  s_add_u32 m0, s51, 102400
  s_add_u32 s46, s62, 5898240
  buffer_load_dwordx4 v64, s[4:7], s46 offen  lds
  s_add_u32 m0, s51, 106496
  s_add_u32 s46, s62, 5505152
  buffer_load_dwordx4 v64, s[4:7], s46 offen  lds
  s_add_u32 m0, s51, 110592
  s_add_u32 s46, s62, 5898368
  buffer_load_dwordx4 v64, s[4:7], s46 offen  lds
  s_add_u32 m0, s51, 114688
  s_add_u32 s46, s62, 5505280
  buffer_load_dwordx4 v64, s[4:7], s46 offen  lds
  s_add_u32 m0, s51, 118784
  s_add_u32 s46, s62, 5898496
  buffer_load_dwordx4 v64, s[4:7], s46 offen  lds
  ds_read_b64_tr_b16 a[192:193], v66 offset:57344
  ds_read_b64_tr_b16 a[194:195], v66 offset:58368
  ds_read_b64_tr_b16 a[196:197], v66 offset:61440
  ds_read_b64_tr_b16 a[198:199], v66 offset:62464
  ds_read_b64_tr_b16 a[200:201], v67 offset:0
  ds_read_b64_tr_b16 a[202:203], v67 offset:1024
  ds_read_b64_tr_b16 a[204:205], v67 offset:4096
  ds_read_b64_tr_b16 a[206:207], v67 offset:5120
  ds_read_b64_tr_b16 a[208:209], v67 offset:8192
  ds_read_b64_tr_b16 a[210:211], v67 offset:9216
  ds_read_b64_tr_b16 a[212:213], v67 offset:12288
  ds_read_b64_tr_b16 a[214:215], v67 offset:13312
  s_waitcnt lgkmcnt(0)
  s_waitcnt vmcnt(24)
  s_barrier
  s_add_u32 m0, s51, 122880
  s_add_u32 s46, s62, 6291456
  buffer_load_dwordx4 v64, s[4:7], s46 offen  lds
  s_add_u32 m0, s51, 126976
  s_add_u32 s46, s62, 6684672
  buffer_load_dwordx4 v64, s[4:7], s46 offen  lds
  s_add_u32 m0, s51, 131072
  s_add_u32 s46, s62, 6291584
  buffer_load_dwordx4 v64, s[4:7], s46 offen  lds
  s_add_u32 m0, s51, 135168
  s_add_u32 s46, s62, 6684800
  buffer_load_dwordx4 v64, s[4:7], s46 offen  lds
  s_add_u32 m0, s51, 139264
  s_add_u32 s46, s62, 6291712
  buffer_load_dwordx4 v64, s[4:7], s46 offen  lds
  s_add_u32 m0, s51, 143360
  s_add_u32 s46, s62, 6684928
  buffer_load_dwordx4 v64, s[4:7], s46 offen  lds
  ds_read_b64_tr_b16 a[216:217], v65 offset:0
  ds_read_b64_tr_b16 a[218:219], v65 offset:1024
  ds_read_b64_tr_b16 a[220:221], v65 offset:4096
  ds_read_b64_tr_b16 a[222:223], v65 offset:5120
  ds_read_b64_tr_b16 a[224:225], v65 offset:8192
  ds_read_b64_tr_b16 a[226:227], v65 offset:9216
  ds_read_b64_tr_b16 a[228:229], v65 offset:12288
  ds_read_b64_tr_b16 a[230:231], v65 offset:13312
  ds_read_b64_tr_b16 a[232:233], v65 offset:16384
  ds_read_b64_tr_b16 a[234:235], v65 offset:17408
  ds_read_b64_tr_b16 a[236:237], v65 offset:20480
  ds_read_b64_tr_b16 a[238:239], v65 offset:21504
  s_waitcnt lgkmcnt(0)
  s_waitcnt vmcnt(24)
  s_barrier
  s_add_u32 m0, s51, 0
  s_add_u32 s46, s62, 0
  buffer_load_dwordx4 v64, s[12:15], s46 offen  lds
  s_add_u32 m0, s51, 4096
  s_add_u32 s46, s62, 393216
  buffer_load_dwordx4 v64, s[12:15], s46 offen  lds
  s_add_u32 m0, s51, 8192
  s_add_u32 s46, s62, 128
  buffer_load_dwordx4 v64, s[12:15], s46 offen  lds
  s_add_u32 m0, s51, 12288
  s_add_u32 s46, s62, 393344
  buffer_load_dwordx4 v64, s[12:15], s46 offen  lds
  s_add_u32 m0, s51, 16384
  s_add_u32 s46, s62, 256
  buffer_load_dwordx4 v64, s[12:15], s46 offen  lds
  s_add_u32 m0, s51, 20480
  s_add_u32 s46, s62, 393472
  buffer_load_dwordx4 v64, s[12:15], s46 offen  lds
  ds_read_b64_tr_b16 a[240:241], v65 offset:24576
  ds_read_b64_tr_b16 a[242:243], v65 offset:25600
  ds_read_b64_tr_b16 a[244:245], v65 offset:28672
  ds_read_b64_tr_b16 a[246:247], v65 offset:29696
  ds_read_b64_tr_b16 a[248:249], v65 offset:32768
  ds_read_b64_tr_b16 a[250:251], v65 offset:33792
  ds_read_b64_tr_b16 a[252:253], v65 offset:36864
  ds_read_b64_tr_b16 a[254:255], v65 offset:37888
  ds_read_b64_tr_b16 v[152:153], v65 offset:40960
  ds_read_b64_tr_b16 v[154:155], v65 offset:41984
  ds_read_b64_tr_b16 v[156:157], v65 offset:45056
  ds_read_b64_tr_b16 v[158:159], v65 offset:46080
  s_waitcnt lgkmcnt(0)
  s_waitcnt vmcnt(24)
  s_barrier
  s_add_u32 m0, s51, 24576
  s_add_u32 s46, s62, 3932160
  buffer_load_dwordx4 v64, s[12:15], s46 offen  lds
  s_add_u32 m0, s51, 28672
  s_add_u32 s46, s62, 4325376
  buffer_load_dwordx4 v64, s[12:15], s46 offen  lds
  s_add_u32 m0, s51, 32768
  s_add_u32 s46, s62, 3932288
  buffer_load_dwordx4 v64, s[12:15], s46 offen  lds
  s_add_u32 m0, s51, 36864
  s_add_u32 s46, s62, 4325504
  buffer_load_dwordx4 v64, s[12:15], s46 offen  lds
  s_add_u32 m0, s51, 40960
  s_add_u32 s46, s62, 3932416
  buffer_load_dwordx4 v64, s[12:15], s46 offen  lds
  s_add_u32 m0, s51, 45056
  s_add_u32 s46, s62, 4325632
  buffer_load_dwordx4 v64, s[12:15], s46 offen  lds
  ds_read_b64_tr_b16 v[160:161], v65 offset:49152
  ds_read_b64_tr_b16 v[162:163], v65 offset:50176
  ds_read_b64_tr_b16 v[164:165], v65 offset:53248
  ds_read_b64_tr_b16 v[166:167], v65 offset:54272
  ds_read_b64_tr_b16 v[168:169], v65 offset:57344
  ds_read_b64_tr_b16 v[170:171], v65 offset:58368
  ds_read_b64_tr_b16 v[172:173], v65 offset:61440
  ds_read_b64_tr_b16 v[174:175], v65 offset:62464
  ds_read_b64_tr_b16 v[176:177], v66 offset:0
  ds_read_b64_tr_b16 v[178:179], v66 offset:1024
  ds_read_b64_tr_b16 v[180:181], v66 offset:4096
  ds_read_b64_tr_b16 v[182:183], v66 offset:5120
  s_waitcnt lgkmcnt(0)
  s_waitcnt vmcnt(24)
  s_barrier
  s_add_u32 m0, s51, 49152
  s_add_u32 s46, s62, 2359296
  buffer_load_dwordx4 v64, s[4:7], s46 offen  lds
  s_add_u32 m0, s51, 53248
  s_add_u32 s46, s62, 2752512
  buffer_load_dwordx4 v64, s[4:7], s46 offen  lds
  s_add_u32 m0, s51, 57344
  s_add_u32 s46, s62, 2359424
  buffer_load_dwordx4 v64, s[4:7], s46 offen  lds
  s_add_u32 m0, s51, 61440
  s_add_u32 s46, s62, 2752640
  buffer_load_dwordx4 v64, s[4:7], s46 offen  lds
  s_add_u32 m0, s51, 65536
  s_add_u32 s46, s62, 2359552
  buffer_load_dwordx4 v64, s[4:7], s46 offen  lds
  s_add_u32 m0, s51, 69632
  s_add_u32 s46, s62, 2752768
  buffer_load_dwordx4 v64, s[4:7], s46 offen  lds
  ds_read_b64_tr_b16 v[184:185], v66 offset:8192
  ds_read_b64_tr_b16 v[186:187], v66 offset:9216
  ds_read_b64_tr_b16 v[188:189], v66 offset:12288
  ds_read_b64_tr_b16 v[190:191], v66 offset:13312
  ds_read_b64_tr_b16 v[192:193], v66 offset:16384
  ds_read_b64_tr_b16 v[194:195], v66 offset:17408
  ds_read_b64_tr_b16 v[196:197], v66 offset:20480
  ds_read_b64_tr_b16 v[198:199], v66 offset:21504
  ds_read_b64_tr_b16 v[200:201], v66 offset:24576
  ds_read_b64_tr_b16 v[202:203], v66 offset:25600
  ds_read_b64_tr_b16 v[204:205], v66 offset:28672
  ds_read_b64_tr_b16 v[206:207], v66 offset:29696
  s_waitcnt lgkmcnt(0)
  s_waitcnt vmcnt(24)
  s_barrier
  s_add_u32 m0, s51, 73728
  s_add_u32 s46, s62, 4718592
  buffer_load_dwordx4 v64, s[4:7], s46 offen  lds
  s_add_u32 m0, s51, 77824
  s_add_u32 s46, s62, 5111808
  buffer_load_dwordx4 v64, s[4:7], s46 offen  lds
  s_add_u32 m0, s51, 81920
  s_add_u32 s46, s62, 4718720
  buffer_load_dwordx4 v64, s[4:7], s46 offen  lds
  s_add_u32 m0, s51, 86016
  s_add_u32 s46, s62, 5111936
  buffer_load_dwordx4 v64, s[4:7], s46 offen  lds
  s_add_u32 m0, s51, 90112
  s_add_u32 s46, s62, 4718848
  buffer_load_dwordx4 v64, s[4:7], s46 offen  lds
  s_add_u32 m0, s51, 94208
  s_add_u32 s46, s62, 5112064
  buffer_load_dwordx4 v64, s[4:7], s46 offen  lds
  ds_read_b64_tr_b16 v[208:209], v66 offset:32768
  ds_read_b64_tr_b16 v[210:211], v66 offset:33792
  ds_read_b64_tr_b16 v[212:213], v66 offset:36864
  ds_read_b64_tr_b16 v[214:215], v66 offset:37888
  ds_read_b64_tr_b16 v[216:217], v66 offset:40960
  ds_read_b64_tr_b16 v[218:219], v66 offset:41984
  ds_read_b64_tr_b16 v[220:221], v66 offset:45056
  ds_read_b64_tr_b16 v[222:223], v66 offset:46080
  ds_read_b64_tr_b16 v[224:225], v66 offset:49152
  ds_read_b64_tr_b16 v[226:227], v66 offset:50176
  ds_read_b64_tr_b16 v[228:229], v66 offset:53248
  ds_read_b64_tr_b16 v[230:231], v66 offset:54272
  s_waitcnt lgkmcnt(0)
  s_waitcnt vmcnt(24)
  s_barrier
  s_add_u32 m0, s51, 98304
  s_add_u32 s46, s62, 7077888
  buffer_load_dwordx4 v64, s[4:7], s46 offen  lds
  s_add_u32 m0, s51, 102400
  s_add_u32 s46, s62, 7471104
  buffer_load_dwordx4 v64, s[4:7], s46 offen  lds
  s_add_u32 m0, s51, 106496
  s_add_u32 s46, s62, 7078016
  buffer_load_dwordx4 v64, s[4:7], s46 offen  lds
  s_add_u32 m0, s51, 110592
  s_add_u32 s46, s62, 7471232
  buffer_load_dwordx4 v64, s[4:7], s46 offen  lds
  s_add_u32 m0, s51, 114688
  s_add_u32 s46, s62, 7078144
  buffer_load_dwordx4 v64, s[4:7], s46 offen  lds
  s_add_u32 m0, s51, 118784
  s_add_u32 s46, s62, 7471360
  buffer_load_dwordx4 v64, s[4:7], s46 offen  lds
  ds_read_b64_tr_b16 v[232:233], v66 offset:57344
  ds_read_b64_tr_b16 v[234:235], v66 offset:58368
  ds_read_b64_tr_b16 v[236:237], v66 offset:61440
  ds_read_b64_tr_b16 v[238:239], v66 offset:62464
  ds_read_b64_tr_b16 v[240:241], v67 offset:0
  ds_read_b64_tr_b16 v[242:243], v67 offset:1024
  ds_read_b64_tr_b16 v[244:245], v67 offset:4096
  ds_read_b64_tr_b16 v[246:247], v67 offset:5120
  ds_read_b64_tr_b16 v[248:249], v67 offset:8192
  ds_read_b64_tr_b16 v[250:251], v67 offset:9216
  ds_read_b64_tr_b16 v[252:253], v67 offset:12288
  ds_read_b64_tr_b16 v[254:255], v67 offset:13312
  s_waitcnt lgkmcnt(0)
  s_waitcnt vmcnt(24)
  s_barrier
  ds_read_b64_tr_b16 v[40:41], v65 offset:0
  ds_read_b64_tr_b16 v[42:43], v65 offset:1024
  ds_read_b64_tr_b16 v[44:45], v65 offset:4096
  ds_read_b64_tr_b16 v[46:47], v65 offset:5120
  ds_read_b64_tr_b16 v[48:49], v65 offset:8192
  ds_read_b64_tr_b16 v[50:51], v65 offset:9216
  ds_read_b64_tr_b16 v[52:53], v65 offset:12288
  ds_read_b64_tr_b16 v[54:55], v65 offset:13312
  ds_read_b64_tr_b16 v[56:57], v65 offset:16384
  ds_read_b64_tr_b16 v[58:59], v65 offset:17408
  ds_read_b64_tr_b16 v[60:61], v65 offset:20480
  ds_read_b64_tr_b16 v[62:63], v65 offset:21504
  s_waitcnt lgkmcnt(0)
  s_waitcnt vmcnt(18)
  s_barrier
  ds_write_b128 v2, v[40:43] offset:0
  ds_write_b128 v2, v[44:47] offset:4096
  ds_write_b128 v2, v[48:51] offset:8192
  ds_write_b128 v2, v[52:55] offset:12288
  ds_write_b128 v2, v[56:59] offset:16384
  ds_write_b128 v2, v[60:63] offset:20480
  ds_read_b64_tr_b16 v[16:17], v65 offset:24576
  ds_read_b64_tr_b16 v[18:19], v65 offset:25600
  ds_read_b64_tr_b16 v[20:21], v65 offset:28672
  ds_read_b64_tr_b16 v[22:23], v65 offset:29696
  ds_read_b64_tr_b16 v[24:25], v65 offset:32768
  ds_read_b64_tr_b16 v[26:27], v65 offset:33792
  ds_read_b64_tr_b16 v[28:29], v65 offset:36864
  ds_read_b64_tr_b16 v[30:31], v65 offset:37888
  ds_read_b64_tr_b16 v[32:33], v65 offset:40960
  ds_read_b64_tr_b16 v[34:35], v65 offset:41984
  ds_read_b64_tr_b16 v[36:37], v65 offset:45056
  ds_read_b64_tr_b16 v[38:39], v65 offset:46080
  s_waitcnt lgkmcnt(0)
  s_waitcnt vmcnt(12)
  s_barrier
  ds_write_b128 v2, v[16:19] offset:24576
  ds_write_b128 v2, v[20:23] offset:28672
  ds_write_b128 v2, v[24:27] offset:32768
  ds_write_b128 v2, v[28:31] offset:36864
  ds_write_b128 v2, v[32:35] offset:40960
  ds_write_b128 v2, v[36:39] offset:45056
  ds_read_b64_tr_b16 v[40:41], v65 offset:49152
  ds_read_b64_tr_b16 v[42:43], v65 offset:50176
  ds_read_b64_tr_b16 v[44:45], v65 offset:53248
  ds_read_b64_tr_b16 v[46:47], v65 offset:54272
  ds_read_b64_tr_b16 v[48:49], v65 offset:57344
  ds_read_b64_tr_b16 v[50:51], v65 offset:58368
  ds_read_b64_tr_b16 v[52:53], v65 offset:61440
  ds_read_b64_tr_b16 v[54:55], v65 offset:62464
  ds_read_b64_tr_b16 v[56:57], v66 offset:0
  ds_read_b64_tr_b16 v[58:59], v66 offset:1024
  ds_read_b64_tr_b16 v[60:61], v66 offset:4096
  ds_read_b64_tr_b16 v[62:63], v66 offset:5120
  s_waitcnt lgkmcnt(0)
  s_waitcnt vmcnt(6)
  s_barrier
  ds_write_b128 v2, v[40:43] offset:49152
  ds_write_b128 v2, v[44:47] offset:53248
  ds_write_b128 v2, v[48:51] offset:57344
  ds_write_b128 v2, v[52:55] offset:61440
  ds_write_b128 v3, v[56:59] offset:0
  ds_write_b128 v3, v[60:63] offset:4096
  ds_read_b64_tr_b16 v[16:17], v66 offset:8192
  ds_read_b64_tr_b16 v[18:19], v66 offset:9216
  ds_read_b64_tr_b16 v[20:21], v66 offset:12288
  ds_read_b64_tr_b16 v[22:23], v66 offset:13312
  ds_read_b64_tr_b16 v[24:25], v66 offset:16384
  ds_read_b64_tr_b16 v[26:27], v66 offset:17408
  ds_read_b64_tr_b16 v[28:29], v66 offset:20480
  ds_read_b64_tr_b16 v[30:31], v66 offset:21504
  ds_read_b64_tr_b16 v[32:33], v66 offset:24576
  ds_read_b64_tr_b16 v[34:35], v66 offset:25600
  ds_read_b64_tr_b16 v[36:37], v66 offset:28672
  ds_read_b64_tr_b16 v[38:39], v66 offset:29696
  s_waitcnt lgkmcnt(0)
  s_waitcnt vmcnt(0)
  s_barrier
  ds_write_b128 v3, v[16:19] offset:8192
  ds_write_b128 v3, v[20:23] offset:12288
  ds_write_b128 v3, v[24:27] offset:16384
  ds_write_b128 v3, v[28:31] offset:20480
  ds_write_b128 v3, v[32:35] offset:24576
  ds_write_b128 v3, v[36:39] offset:28672
  ds_read_b64_tr_b16 v[40:41], v66 offset:32768
  ds_read_b64_tr_b16 v[42:43], v66 offset:33792
  ds_read_b64_tr_b16 v[44:45], v66 offset:36864
  ds_read_b64_tr_b16 v[46:47], v66 offset:37888
  ds_read_b64_tr_b16 v[48:49], v66 offset:40960
  ds_read_b64_tr_b16 v[50:51], v66 offset:41984
  ds_read_b64_tr_b16 v[52:53], v66 offset:45056
  ds_read_b64_tr_b16 v[54:55], v66 offset:46080
  ds_read_b64_tr_b16 v[56:57], v66 offset:49152
  ds_read_b64_tr_b16 v[58:59], v66 offset:50176
  ds_read_b64_tr_b16 v[60:61], v66 offset:53248
  ds_read_b64_tr_b16 v[62:63], v66 offset:54272
  s_waitcnt lgkmcnt(0)
  s_barrier
  ds_write_b128 v3, v[40:43] offset:32768
  ds_write_b128 v3, v[44:47] offset:36864
  ds_write_b128 v3, v[48:51] offset:40960
  ds_write_b128 v3, v[52:55] offset:45056
  ds_write_b128 v3, v[56:59] offset:49152
  ds_write_b128 v3, v[60:63] offset:53248
  s_waitcnt lgkmcnt(0)
  v_and_b32 v137, 3, v0
  v_lshlrev_b32 v137, 2, v137
  s_mov_b32 s50, 0
ss_15:
  global_load_dword v136, v137, s[38:39] sc1
  s_add_u32 s50, s50, 1
  s_cmp_gt_u32 s50, 131072
  s_cbranch_scc1 L_fail
  s_waitcnt vmcnt(0)
  v_readlane_b32 s46, v136, 0
  v_readlane_b32 s47, v136, 2
  v_readlane_b32 s48, v136, 1
  s_nop 0
  s_min_u32 s47, s47, s48
  s_cmp_lg_u32 s46, 0
  s_cselect_b32 s48, 7, 0
  s_add_u32 s46, s46, s2
  s_xor_b32 s49, s46, s43
  s_and_b32 s49, s49, s48
  s_cbranch_scc1 L_reroll
  s_cmp_lg_u32 s47, 0
  s_cbranch_scc1 ss_ok_16
  s_sleep 6
  s_branch ss_15
ss_ok_16:
  v_readlane_b32 s3, v136, 1
  s_nop 0
  s_and_b32 s3, s3, 0x2000
  v_and_b32 v136, 3, v0
  s_lshl_b32 s46, s43, 9
  s_add_u32 s46, s46, s3
  s_add_u32 s46, s46, 13369344
  v_lshl_add_u32 v10, v136, 7, s46
  s_lshl_b32 s46, s43, 7
  s_add_u32 s46, s46, s3
  s_add_u32 s46, s46, 13371392
  v_lshl_add_u32 v11, v136, 9, s46
  v_mov_b32 v7, 0x44444444
  v_mov_b32 v136, 0xeeeeeeee
  v_and_b32 v137, 2, v0
  v_cmp_ne_u32 vcc, 0, v137
  s_nop 1
  v_cndmask_b32 v7, v7, v136, vcc
  s_mov_b32 s69, 1037384597
  s_mov_b32 s70, 3494803967
  v_and_b32 v136, 15, v0
  v_lshrrev_b32 v138, 4, v0
  v_lshlrev_b32 v4, 4, v136
  v_lshl_add_u32 v4, v138, 2, v4
  s_lshl_b32 s46, s42, 8
  s_add_u32 s46, s46, 147456
  v_add_u32 v4, s46, v4
  v_lshlrev_b32 v5, 7, v138
  v_bfe_u32 v137, v0, 2, 2
  v_lshl_add_u32 v5, v137, 4, v5
  v_and_b32 v137, 1, v0
  v_lshl_add_u32 v5, v137, 3, v5
  v_add_u32 v5, 147456, v5
  v_add_u32 v13, 122880, v1
  v_add_u32 v149, 153600, v1
  v_bfe_u32 v140, v0, 1, 2
  v_lshl_add_u32 v140, v140, 2, v137
  v_bfe_u32 v137, v0, 3, 1
  v_lshl_add_u32 v140, v137, 1, v140
  v_cmp_eq_u32 s[18:19], 1, v137
  s_add_u32 s46, s3, 12582912
  s_lshr_b32 s47, s45, 4
  s_add_u32 s47, s47, 1
  s_lshl_b32 s47, s47, 14
  s_and_b32 s48, s45, 15
  s_lshl_b32 s48, s48, 9
  s_add_u32 s47, s47, s48
  s_add_u32 s47, s47, s46
  v_lshrrev_b32 v137, 1, v138
  v_and_b32 v139, 1, v138
  v_lshl_add_u32 v8, v137, 4, v140
  v_lshlrev_b32 v8, 4, v8
  v_lshl_add_u32 v8, v139, 3, v8
  v_add_u32 v8, s47, v8
  s_lshl_b32 s47, s45, 7
  s_add_u32 s47, s47, s46
  s_add_u32 s47, s47, 51200
  v_lshlrev_b32 v9, 3, v140
  v_lshl_add_u32 v9, v139, 2, v9
  v_add_u32 v9, s47, v9
  v_lshl_add_u32 v9, v137, 30, v9
  v_mov_b32 v140, 2146435072
  s_cmp_eq_u32 s44, 0
  s_cselect_b64 vcc, 15, 0
  v_cndmask_b32 v11, v140, v11, vcc
  v_lshlrev_b32 v14, 4, v136
  v_lshl_add_u32 v14, v139, 3, v14
  v_lshl_add_u32 v14, v137, 2, v14
  s_lshl_b32 s47, s45, 8
  s_add_u32 s47, s47, 65536
  v_add_u32 v14, s47, v14
  s_lshl_b32 s47, s42, 4
  v_add_u32 v136, s47, v136
  v_lshlrev_b32 v138, 2, v138
  v_sub_u32 v136, v136, v138
  v_cmp_gt_i32 s[72:73], 0, v136
  v_cmp_gt_i32 s[74:75], 1, v136
  v_cmp_gt_i32 s[76:77], 2, v136
  v_cmp_gt_i32 s[78:79], 3, v136
  v_cmp_gt_i32 s[80:81], 16, v136
  v_cmp_gt_i32 s[82:83], 17, v136
  v_cmp_gt_i32 s[84:85], 18, v136
  v_cmp_gt_i32 s[86:87], 19, v136
  s_lshl_b32 s46, s45, 7
  s_lshl_b32 s47, s42, 2
  s_add_u32 s47, s47, s46
  s_add_u32 s47, s47, 1069056
  v_mov_b32 v15, s47
  s_cmp_lg_u32 s42, 2
  s_cbranch_scc1 sc_fl
  v_and_b32 v15, 1, v0
  v_lshlrev_b32 v15, 12, v15
  s_add_u32 s46, s46, 1048576
  v_add_u32 v15, s46, v15
sc_fl:
  s_mov_b32 s23, s45
  s_lshl_b32 s20, s42, 24
  s_add_u32 s20, s20, s3
  s_add_u32 s20, s20, 31457280
  s_xor_b32 s20, s20, 0
  s_lshl_b32 s26, s42, 11
  s_lshl_b32 s46, s42, 24
  s_sub_u32 s26, s26, s46
  s_cmp_eq_u32 s42, 2
  s_cselect_b32 s26, 2012217344, s26
  s_lshl_b32 s21, s42, 12
  s_add_u32 s21, s21, 122880
  s_mov_b32 s22, 12288
  s_mul_i32 s64, s42, 81920
  s_add_u32 s64, s64, s3
  s_add_u32 s64, s64, 14680064
  s_lshr_b32 s27, s45, 3
  s_lshl_b32 s27, s27, 14
  s_and_b32 s46, s45, 7
  s_lshl_b32 s46, s46, 10
  s_add_u32 s27, s27, s46
  s_mov_b32 s61, 0
  s_mov_b32 s52, 0
  s_mov_b32 s58, 0
  s_mov_b32 s65, 524288
  s_mov_b32 s100, 0
  s_add_u32 s46, s42, 3
  s_lshl_b32 s31, s46, 10
  s_cmp_ge_u32 s46, 8
  s_cselect_b32 s47, 40960, 0
  s_add_u32 s31, s31, s47
  s_cmp_ge_u32 s46, 10
  s_cselect_b32 s31, 2146435072, s31
  s_add_u32 s46, s42, 7
  s_lshl_b32 s32, s46, 10
  s_cmp_ge_u32 s46, 8
  s_cselect_b32 s47, 40960, 0
  s_add_u32 s32, s32, s47
  s_cmp_ge_u32 s46, 10
  s_cselect_b32 s32, 2146435072, s32
  s_cmp_lg_u32 s42, 2
  s_cbranch_scc1 sc_k0
  s_mov_b32 s53, 1
  s_cmp_ge_u32 s61, s53
  s_cbranch_scc1 wf_done_17
  s_mov_b32 s50, 0
wf_loop_18:
  buffer_load_dword v136, v15, s[8:11], 0 offen sc1
  s_add_u32 s50, s50, 1
  s_cmp_gt_u32 s50, 131072
  s_cbranch_scc1 L_fail
  s_waitcnt vmcnt(0)
  v_lshrrev_b32 v137, 6, v136
  v_not_b32 v138, v0
  v_or_b32 v137, v137, v138
  v_and_b32 v137, 1, v137
  v_add_u32 v136, v136, v137
  s_nop 1
  v_min_u32_dpp v136, v136, v136 row_ror:8 row_mask:0xf bank_mask:0xf
  s_nop 1
  v_min_u32_dpp v136, v136, v136 row_ror:4 row_mask:0xf bank_mask:0xf
  s_nop 1
  v_min_u32_dpp v136, v136, v136 row_ror:2 row_mask:0xf bank_mask:0xf
  s_nop 1
  v_min_u32_dpp v136, v136, v136 row_ror:1 row_mask:0xf bank_mask:0xf
  v_mov_b32 v137, v136
  s_nop 1
  v_permlane16_swap_b32 v137, v136
  v_min_u32 v136, v136, v137
  v_mov_b32 v137, v136
  s_nop 1
  v_permlane32_swap_b32 v137, v136
  v_min_u32 v136, v136, v137
  s_nop 0
  v_readfirstlane_b32 s61, v136
  s_nop 0
  s_cmp_ge_u32 s61, s53
  s_cbranch_scc1 wf_done_17
  s_sleep 2
  s_branch wf_loop_18
wf_done_17:
sc_k0:
  s_barrier
  s_cmp_eq_u32 s42, 3
  s_cbranch_scc1 scs_loop
  s_mov_b32 m0, s21
  s_lshr_b32 s63, s23, 1
  s_lshl_b32 s63, s63, 14
  s_and_b32 s46, s23, 1
  s_lshl_b32 s46, s46, 12
  s_add_u32 s63, s63, s46
  s_add_u32 s63, s63, s20
  s_lshr_b32 s46, s63, 8
  s_and_b32 s46, s46, 0x2000
  s_xor_b32 s63, s63, s46
  buffer_load_dwordx4 v1, s[8:11], s63 offen offset:0 sc1 lds
  buffer_load_dwordx4 v1, s[8:11], s63 offen offset:1024 sc1 lds
  buffer_load_dwordx4 v1, s[8:11], s63 offen offset:2048 sc1 lds
  buffer_load_dwordx4 v1, s[8:11], s63 offen offset:3072 sc1 lds
  s_waitcnt vmcnt(0)
  s_branch sch_loop
scs_loop:
  s_add_u32 s53, s52, 1
  s_lshl_b32 s56, s58, 2
  s_add_u32 s56, s56, s43
  s_lshl_b32 s56, s56, 16
  s_add_u32 s56, s56, s3
  s_add_u32 s56, s56, 12582912
  v_add_u32 v12, s56, v1
  s_lshl_b32 s66, s58, 18
  s_mov_b64 s[16:17], -1
  s_mov_b32 s71, 0
  ds_read_b128 v[56:59], v2 offset:0
  ds_read_b128 v[60:63], v2 offset:4096
  ds_read_b128 v[64:67], v2 offset:8192
  ds_read_b128 v[68:71], v2 offset:12288
  ds_read_b128 v[72:75], v2 offset:16384
  ds_read_b128 v[76:79], v2 offset:20480
  ds_read_b128 v[80:83], v2 offset:49152
  ds_read_b128 v[84:87], v2 offset:53248
  v_mov_b32 v88, 0
  v_mov_b32 v89, 0
  v_mov_b32 v90, 0
  v_mov_b32 v91, 0
  v_mov_b32 v92, 0
  v_mov_b32 v93, 0
  v_mov_b32 v94, 0
  v_mov_b32 v95, 0
  v_mov_b32 v96, 0
  v_mov_b32 v97, 0
  v_mov_b32 v98, 0
  v_mov_b32 v99, 0
  v_mov_b32 v100, 0
  v_mov_b32 v101, 0
  v_mov_b32 v102, 0
  v_mov_b32 v103, 0
  v_mov_b32 v104, 0
  v_mov_b32 v105, 0
  v_mov_b32 v106, 0
  v_mov_b32 v107, 0
  v_mov_b32 v108, 0
  v_mov_b32 v109, 0
  v_mov_b32 v110, 0
  v_mov_b32 v111, 0
  v_mov_b32 v6, s53
  s_mov_b32 s50, 0
scs_top:
  s_waitcnt lgkmcnt(0)
  s_barrier
  buffer_load_dwordx4 v[16:19], v12, s[8:11], 0 offen offset:0 sc1
  s_add_u32 m0, s51, 153600
  s_barrier
  buffer_load_dwordx4 v[20:23], v12, s[8:11], 0 offen offset:1024 sc1
  s_barrier
  buffer_load_dwordx4 v[24:27], v12, s[8:11], 0 offen offset:2048 sc1
  s_barrier
  buffer_load_dwordx4 v12, s[8:11], s31 offen sc1 lds
  s_add_u32 m0, s51, 157696
  s_barrier
  buffer_load_dwordx4 v12, s[8:11], s32 offen sc1 lds
  s_waitcnt vmcnt(4)
scs_go:
  v_smfmac_f32_16x16x64_bf16 v[88:91], v[16:19], a[192:199], v7
  v_smfmac_f32_16x16x64_bf16 v[92:95], v[16:19], a[200:207], v7
  v_smfmac_f32_16x16x64_bf16 v[96:99], v[16:19], a[208:215], v7
  v_smfmac_f32_16x16x64_bf16 v[100:103], v[16:19], v[56:63], v7
  v_smfmac_f32_16x16x64_bf16 v[104:107], v[16:19], v[64:71], v7
  ds_read_b128 v[56:59], v2 offset:57344
  v_smfmac_f32_16x16x64_bf16 v[108:111], v[16:19], v[72:79], v7
  s_waitcnt vmcnt(3)
  ds_read_b128 v[60:63], v2 offset:61440
  v_smfmac_f32_16x16x64_bf16 v[88:91], v[20:23], a[216:223], v7
  ds_read_b128 v[64:67], v3 offset:0
  v_smfmac_f32_16x16x64_bf16 v[92:95], v[20:23], a[224:231], v7
  ds_read_b128 v[68:71], v3 offset:4096
  v_smfmac_f32_16x16x64_bf16 v[96:99], v[20:23], a[232:239], v7
  s_waitcnt vmcnt(2)
  v_max3_u32 v136, v16, v20, v24
  v_smfmac_f32_16x16x64_bf16 v[100:103], v[20:23], a[0:7], v7
  ds_read_b128 v[72:75], v3 offset:8192
  v_cmp_eq_u32 vcc, -1, v136
  v_smfmac_f32_16x16x64_bf16 v[104:107], v[20:23], a[8:15], v7
  ds_read_b128 v[76:79], v3 offset:12288
  v_smfmac_f32_16x16x64_bf16 v[108:111], v[20:23], a[16:23], v7
  s_cbranch_vccnz scs_ha
  v_smfmac_f32_16x16x64_bf16 v[88:91], v[24:27], a[240:247], v7
  s_waitcnt vmcnt(1)
  s_barrier
  ds_read_b128 v[28:31], v149 offset:0
  v_smfmac_f32_16x16x64_bf16 v[92:95], v[24:27], a[248:255], v7
  ds_read_b128 v[32:35], v149 offset:1024
  v_smfmac_f32_16x16x64_bf16 v[96:99], v[24:27], v[152:159], v7
  ds_read_b128 v[36:39], v149 offset:2048
  v_smfmac_f32_16x16x64_bf16 v[100:103], v[24:27], a[24:31], v7
  ds_read_b128 v[40:43], v149 offset:3072
  v_smfmac_f32_16x16x64_bf16 v[104:107], v[24:27], a[32:39], v7
  v_smfmac_f32_16x16x64_bf16 v[108:111], v[24:27], a[40:47], v7
  s_waitcnt vmcnt(0)
  s_barrier
  s_waitcnt lgkmcnt(3)
  v_smfmac_f32_16x16x64_bf16 v[88:91], v[28:31], v[80:87], v7
  ds_read_b128 v[44:47], v149 offset:4096
  v_smfmac_f32_16x16x64_bf16 v[92:95], v[28:31], v[56:63], v7
  ds_read_b128 v[48:51], v149 offset:5120
  v_smfmac_f32_16x16x64_bf16 v[96:99], v[28:31], v[64:71], v7
  ds_read_b128 v[52:55], v149 offset:6144
  s_waitcnt lgkmcnt(3)
  v_smfmac_f32_16x16x64_bf16 v[88:91], v[32:35], v[160:167], v7
  ds_read_b128 v[80:83], v3 offset:32768
  ds_read_b128 v[16:19], v13 offset:8192
  v_smfmac_f32_16x16x64_bf16 v[92:95], v[32:35], v[168:175], v7
  ds_read_b128 v[84:87], v3 offset:36864
  ds_read_b128 v[20:23], v13 offset:10240
  v_smfmac_f32_16x16x64_bf16 v[96:99], v[32:35], v[176:183], v7
  ds_read_b128 v[56:59], v3 offset:16384
  ds_read_b128 v[24:27], v13 offset:9216
  v_smfmac_f32_16x16x64_bf16 v[88:91], v[36:39], v[184:191], v7
  s_waitcnt lgkmcnt(6)
  v_max3_u32 v136, v28, v32, v36
  v_smfmac_f32_16x16x64_bf16 v[92:95], v[36:39], v[192:199], v7
  ds_read_b128 v[60:63], v3 offset:20480
  v_max3_u32 v136, v136, v40, v44
  v_smfmac_f32_16x16x64_bf16 v[96:99], v[36:39], v[200:207], v7
  ds_read_b128 v[64:67], v3 offset:40960
  v_max3_u32 v136, v136, v48, v52
  v_smfmac_f32_16x16x64_bf16 v[88:91], v[44:47], v[208:215], v7
  ds_read_b128 v[68:71], v3 offset:45056
  v_cmp_eq_u32 vcc, -1, v136
  v_smfmac_f32_16x16x64_bf16 v[88:91], v[48:51], v[232:239], v7
  v_smfmac_f32_16x16x64_bf16 v[88:91], v[40:43], v[72:79], v7
  s_cbranch_vccnz scs_hb
  s_waitcnt lgkmcnt(3)
  v_smfmac_f32_16x16x64_bf16 v[88:91], v[52:55], v[80:87], v7
  ds_read_b128 v[72:75], v3 offset:24576
scs_join:
  v_smfmac_f32_16x16x64_bf16 v[92:95], v[44:47], v[216:223], v7
  ds_read_b128 v[76:79], v3 offset:28672
  v_smfmac_f32_16x16x64_bf16 v[92:95], v[48:51], v[240:247], v7
  ds_read_b128 v[80:83], v3 offset:49152
  s_waitcnt lgkmcnt(3)
  v_add_f32 v88, v88, v90
  v_smfmac_f32_16x16x64_bf16 v[92:95], v[40:43], v[56:63], v7
  ds_read_b128 v[84:87], v3 offset:53248
  v_add_f32 v89, v89, v91
  v_smfmac_f32_16x16x64_bf16 v[92:95], v[52:55], v[64:71], v7
  ds_read_b128 v[56:59], v2 offset:24576
  v_cmp_u_f32 vcc, v88, v89
  v_smfmac_f32_16x16x64_bf16 v[96:99], v[44:47], v[224:231], v7
  ds_read_b128 v[60:63], v2 offset:28672
  v_cvt_pk_bf16_f32 v136, v88, v89
  v_smfmac_f32_16x16x64_bf16 v[96:99], v[48:51], v[248:255], v7
  s_and_b64 vcc, vcc, s[16:17]
  s_cbranch_scc1 scs_redo
  s_waitcnt lgkmcnt(4)
  v_add_f32 v92, v92, v94
  v_smfmac_f32_16x16x64_bf16 v[96:99], v[40:43], v[72:79], v7
  ds_read_b128 v[64:67], v2 offset:32768
  s_waitcnt lgkmcnt(3)
  v_add_f32 v93, v93, v95
  v_smfmac_f32_16x16x64_bf16 v[96:99], v[52:55], v[80:87], v7
  ds_read_b128 v[68:71], v2 offset:36864
  v_cvt_pk_bf16_f32 v137, v92, v93
  v_smfmac_f32_16x16x64_bf16 v[100:103], v[28:31], a[48:55], v7
  ds_write2st64_b32 v4, v136, v137 offset0:0 offset1:4
  v_smfmac_f32_16x16x64_bf16 v[100:103], v[32:35], a[72:79], v7
  ds_read_b128 v[72:75], v2 offset:40960
  v_add_f32 v96, v96, v98
  v_smfmac_f32_16x16x64_bf16 v[100:103], v[40:43], a[96:103], v7
  ds_read_b128 v[76:79], v2 offset:45056
  s_waitcnt lgkmcnt(5)
  v_add_f32 v97, v97, v99
  v_smfmac_f32_16x16x64_bf16 v[100:103], v[36:39], v[56:63], v7
  ds_read_b128 v[80:83], v13 offset:5120
  v_cvt_pk_bf16_f32 v138, v96, v97
  v_smfmac_f32_16x16x64_bf16 v[100:103], v[44:47], a[120:127], v7
  ds_write_b32 v4, v138 offset:2048
  v_smfmac_f32_16x16x64_bf16 v[100:103], v[48:51], a[144:151], v7
  ds_read_b128 v[84:87], v13 offset:7168
  ds_read_b128 v[56:59], v13 offset:0
  s_waitcnt lgkmcnt(6)
  v_smfmac_f32_16x16x64_bf16 v[104:107], v[36:39], v[64:71], v7
  ds_read_b128 v[60:63], v13 offset:2048
  s_waitcnt lgkmcnt(5)
  v_smfmac_f32_16x16x64_bf16 v[108:111], v[36:39], v[72:79], v7
  ds_read_b128 v[64:67], v13 offset:1024
  ds_read_b128 v[68:71], v13 offset:3072
  v_smfmac_f32_16x16x64_bf16 v[100:103], v[52:55], a[168:175], v7
  s_waitcnt lgkmcnt(5)
  s_barrier
  v_smfmac_f32_16x16x64_bf16 v[104:107], v[28:31], a[56:63], v7
  ds_read_b64_tr_b16 v[112:113], v5 offset:0
  ds_read_b64_tr_b16 v[114:115], v5 offset:64
  v_smfmac_f32_16x16x64_bf16 v[104:107], v[32:35], a[80:87], v7
  ds_read_b64_tr_b16 v[116:117], v5 offset:512
  ds_read_b64_tr_b16 v[118:119], v5 offset:576
  v_smfmac_f32_16x16x64_bf16 v[104:107], v[40:43], a[104:111], v7
  ds_read_b64_tr_b16 v[120:121], v5 offset:1024
  ds_read_b64_tr_b16 v[122:123], v5 offset:1088
  v_smfmac_f32_16x16x64_bf16 v[104:107], v[44:47], a[128:135], v7
  ds_read_b64_tr_b16 v[124:125], v5 offset:1536
  ds_read_b64_tr_b16 v[126:127], v5 offset:1600
  v_smfmac_f32_16x16x64_bf16 v[104:107], v[48:51], a[152:159], v7
  ds_read_b64_tr_b16 v[128:129], v5 offset:2048
  ds_read_b64_tr_b16 v[130:131], v5 offset:2112
  v_smfmac_f32_16x16x64_bf16 v[104:107], v[52:55], a[176:183], v7
  ds_read_b64_tr_b16 v[132:133], v5 offset:2560
  ds_read_b64_tr_b16 v[134:135], v5 offset:2624
  v_smfmac_f32_16x16x64_bf16 v[108:111], v[28:31], a[64:71], v7
  ds_read_b128 v[72:75], v13 offset:4096
  v_add_f32 v100, v100, v102
  v_smfmac_f32_16x16x64_bf16 v[108:111], v[32:35], a[88:95], v7
  ds_read_b128 v[76:79], v13 offset:6144
  v_add_f32 v101, v101, v103
  v_smfmac_f32_16x16x64_bf16 v[108:111], v[40:43], a[112:119], v7
  ds_read_b128 v[36:39], v13 offset:11264
  v_cvt_pk_bf16_f32 v139, v100, v101
  v_smfmac_f32_16x16x64_bf16 v[108:111], v[44:47], a[136:143], v7
  buffer_store_dword v6, v11, s[8:11], 0 offen sc1
  v_add_f32 v104, v104, v106
  v_smfmac_f32_16x16x64_bf16 v[108:111], v[48:51], a[160:167], v7
  v_add_f32 v105, v105, v107
  v_smfmac_f32_16x16x64_bf16 v[108:111], v[52:55], a[184:191], v7
  s_waitcnt lgkmcnt(2)
  v_cvt_pk_bf16_f32 v140, v104, v105
  v_mfma_f32_16x16x32_bf16 v[88:91], v[56:59], v[112:115], 0
  ds_write2st64_b32 v4, v139, v140 offset0:12 offset1:16
  v_mfma_f32_16x16x32_bf16 v[92:95], v[60:63], v[112:115], 0
  v_add_f32 v108, v108, v110
  v_add_f32 v109, v109, v111
  v_mfma_f32_16x16x32_bf16 v[88:91], v[64:67], v[116:119], v[88:91]
  v_cvt_pk_bf16_f32 v141, v108, v109
  v_mfma_f32_16x16x32_bf16 v[92:95], v[68:71], v[116:119], v[92:95]
  ds_write_b32 v4, v141 offset:5120
  v_mfma_f32_16x16x32_bf16 v[88:91], v[72:75], v[120:123], v[88:91]
  s_waitcnt lgkmcnt(1)
  s_barrier
  v_mfma_f32_16x16x32_bf16 v[92:95], v[76:79], v[120:123], v[92:95]
  ds_read_b64_tr_b16 v[28:29], v5 offset:3072
  ds_read_b64_tr_b16 v[30:31], v5 offset:3136
  v_mfma_f32_16x16x32_bf16 v[88:91], v[80:83], v[124:127], v[88:91]
  ds_read_b64_tr_b16 v[32:33], v5 offset:3584
  ds_read_b64_tr_b16 v[34:35], v5 offset:3648
  v_mfma_f32_16x16x32_bf16 v[92:95], v[84:87], v[124:127], v[92:95]
  s_waitcnt lgkmcnt(4)
  s_barrier
  v_mfma_f32_16x16x32_bf16 v[88:91], v[16:19], v[128:131], v[88:91]
  ds_read_b64_tr_b16 v[40:41], v5 offset:4096
  ds_read_b64_tr_b16 v[42:43], v5 offset:4160
  v_mfma_f32_16x16x32_bf16 v[92:95], v[20:23], v[128:131], v[92:95]
  ds_read_b64_tr_b16 v[44:45], v5 offset:4608
  ds_read_b64_tr_b16 v[46:47], v5 offset:4672
  v_mfma_f32_16x16x32_bf16 v[88:91], v[24:27], v[132:135], v[88:91]
  ds_read_b64_tr_b16 v[48:49], v5 offset:5120
  ds_read_b64_tr_b16 v[50:51], v5 offset:5184
  v_mfma_f32_16x16x32_bf16 v[92:95], v[36:39], v[132:135], v[92:95]
  ds_read_b64_tr_b16 v[52:53], v5 offset:5632
  s_waitcnt lgkmcnt(7)
  v_mfma_f32_16x16x32_bf16 v[96:99], v[28:31], v[112:115], 0
  ds_read_b64_tr_b16 v[54:55], v5 offset:5696
  v_mfma_f32_16x16x32_bf16 v[96:99], v[32:35], v[116:119], v[96:99]
  s_waitcnt lgkmcnt(6)
  v_cndmask_b32 v136, v88, v90, s[18:19]
  v_cndmask_b32 v137, v89, v91, s[18:19]
  v_mfma_f32_16x16x32_bf16 v[96:99], v[40:43], v[120:123], v[96:99]
  s_waitcnt lgkmcnt(4)
  v_cndmask_b32 v138, v92, v94, s[18:19]
  v_cndmask_b32 v139, v93, v95, s[18:19]
  v_mfma_f32_16x16x32_bf16 v[96:99], v[44:47], v[124:127], v[96:99]
  s_waitcnt lgkmcnt(2)
  v_max3_f32 v142, v136, v137, v138
  v_max_f32 v142, v142, v139
  v_mfma_f32_16x16x32_bf16 v[96:99], v[48:51], v[128:131], v[96:99]
  s_barrier
  s_waitcnt lgkmcnt(0)
  v_mov_b32 v143, v142
  v_mfma_f32_16x16x32_bf16 v[96:99], v[52:55], v[132:135], v[96:99]
  s_nop 0
  v_permlane32_swap_b32 v143, v142
  v_max_f32 v142, v142, v143
  s_nop 4
  v_cndmask_b32 v140, v96, v98, s[18:19]
  v_cndmask_b32 v141, v97, v99, s[18:19]
  v_max3_f32 v142, v142, v140, v141
  s_nop 1
  v_max_f32_dpp v142, v142, v142 row_ror:8 row_mask:0xf bank_mask:0xf
  v_mov_b32 v143, v142
  s_nop 1
  v_permlane16_swap_b32 v143, v142
  v_max_f32 v142, v142, v143
  v_mul_f32 v142, s69, v142
  v_fma_f32 v136, v136, s69, -v142
  v_fma_f32 v137, v137, s69, -v142
  v_fma_f32 v138, v138, s69, -v142
  v_fma_f32 v139, v139, s69, -v142
  v_fma_f32 v140, v140, s69, -v142
  v_fma_f32 v141, v141, s69, -v142
  v_exp_f32 v136, v136
  v_exp_f32 v137, v137
  v_exp_f32 v138, v138
  v_exp_f32 v139, v139
  v_add_f32 v142, v136, v137
  v_add_f32 v143, v138, v139
  v_add_f32 v142, v142, v143
  v_mov_b32 v143, v142
  v_exp_f32 v140, v140
  v_exp_f32 v141, v141
  v_permlane32_swap_b32 v143, v142
  v_add_f32 v144, v140, v141
  v_add_f32 v142, v142, v143
  v_add_f32 v142, v142, v144
  s_nop 1
  v_add_f32_dpp v142, v142, v142 row_ror:8 row_mask:0xf bank_mask:0xf
  v_mov_b32 v143, v142
  s_nop 1
  v_permlane16_swap_b32 v143, v142
  v_add_f32 v142, v142, v143
  v_rcp_f32 v142, v142
  s_nop 0
  v_mul_f32 v136, v136, v142
  v_mul_f32 v137, v137, v142
  v_mul_f32 v138, v138, v142
  v_mul_f32 v139, v139, v142
  v_cvt_pk_bf16_f32 v146, v136, v137
  v_cvt_pk_bf16_f32 v147, v138, v139
  buffer_store_dwordx2 v[146:147], v8, s[8:11], s66 offen sc1
  v_mul_f32 v140, v140, v142
  v_mul_f32 v141, v141, v142
  v_cvt_pk_bf16_f32 v148, v140, v141
  buffer_store_dword v148, v9, s[8:11], s66 offen sc1
  v_mov_b32 v150, -1
  v_mov_b32 v151, -1
  s_add_u32 s46, s65, 0
  buffer_store_dwordx2 v[150:151], v8, s[8:11], s46 offen sc1
  buffer_store_dword v150, v9, s[8:11], s46 offen sc1
  s_mov_b32 s65, s66
  v_add_u32 v13, s22, v13
  s_sub_u32 s22, 0, s22
  s_add_u32 s58, s58, 1
  s_cmp_eq_u32 s58, 3
  s_cselect_b32 s58, 0, s58
  s_mov_b32 s52, s53
  s_cmp_lt_u32 s52, 64
  s_cbranch_scc1 scs_loop
  s_endpgm
sch_loop:
  s_add_u32 s53, s52, 1
  s_lshl_b32 s56, s58, 2
  s_add_u32 s56, s56, s43
  s_lshl_b32 s56, s56, 16
  s_add_u32 s56, s56, s3
  s_add_u32 s56, s56, 12582912
  v_add_u32 v12, s56, v1
  s_lshl_b32 s66, s58, 18
  s_mov_b64 s[16:17], -1
  s_mov_b32 s71, 0
  ds_read_b128 v[56:59], v2 offset:0
  ds_read_b128 v[60:63], v2 offset:4096
  ds_read_b128 v[64:67], v2 offset:8192
  ds_read_b128 v[68:71], v2 offset:12288
  ds_read_b128 v[72:75], v2 offset:16384
  ds_read_b128 v[76:79], v2 offset:20480
  ds_read_b128 v[80:83], v2 offset:49152
  ds_read_b128 v[84:87], v2 offset:53248
  v_mov_b32 v88, 0
  v_mov_b32 v89, 0
  v_mov_b32 v90, 0
  v_mov_b32 v91, 0
  v_mov_b32 v92, 0
  v_mov_b32 v93, 0
  v_mov_b32 v94, 0
  v_mov_b32 v95, 0
  v_mov_b32 v96, 0
  v_mov_b32 v97, 0
  v_mov_b32 v98, 0
  v_mov_b32 v99, 0
  v_mov_b32 v100, 0
  v_mov_b32 v101, 0
  v_mov_b32 v102, 0
  v_mov_b32 v103, 0
  v_mov_b32 v104, 0
  v_mov_b32 v105, 0
  v_mov_b32 v106, 0
  v_mov_b32 v107, 0
  v_mov_b32 v108, 0
  v_mov_b32 v109, 0
  v_mov_b32 v110, 0
  v_mov_b32 v111, 0
  s_xor_b32 s28, s63, 0x2000
  s_add_u32 s28, s28, s26
  s_add_u32 s29, s28, 16777216
  s_add_u32 s30, s28, 33554432
  s_add_u32 s23, s23, 32
  s_cmp_ge_u32 s23, 1024
  s_cselect_b32 s46, 1024, 0
  s_sub_u32 s23, s23, s46
  s_lshr_b32 s63, s23, 1
  s_lshl_b32 s63, s63, 14
  s_and_b32 s46, s23, 1
  s_lshl_b32 s46, s46, 12
  s_add_u32 s63, s63, s46
  s_add_u32 s63, s63, s20
  s_lshr_b32 s46, s63, 8
  s_and_b32 s46, s46, 0x2000
  s_xor_b32 s63, s63, s46
  s_add_u32 s21, s21, s22
  s_cmp_lg_u32 s42, 2
  s_cbranch_scc1 sc_nobell
  s_add_u32 s49, s52, 2
  s_cmp_ge_u32 s61, s49
  s_cbranch_scc1 wf_done_19
  s_mov_b32 s50, 0
wf_loop_20:
  buffer_load_dword v136, v15, s[8:11], 0 offen sc1
  s_add_u32 s50, s50, 1
  s_cmp_gt_u32 s50, 131072
  s_cbranch_scc1 L_fail
  s_waitcnt vmcnt(0)
  v_lshrrev_b32 v137, 6, v136
  v_not_b32 v138, v0
  v_or_b32 v137, v137, v138
  v_and_b32 v137, 1, v137
  v_add_u32 v136, v136, v137
  s_nop 1
  v_min_u32_dpp v136, v136, v136 row_ror:8 row_mask:0xf bank_mask:0xf
  s_nop 1
  v_min_u32_dpp v136, v136, v136 row_ror:4 row_mask:0xf bank_mask:0xf
  s_nop 1
  v_min_u32_dpp v136, v136, v136 row_ror:2 row_mask:0xf bank_mask:0xf
  s_nop 1
  v_min_u32_dpp v136, v136, v136 row_ror:1 row_mask:0xf bank_mask:0xf
  v_mov_b32 v137, v136
  s_nop 1
  v_permlane16_swap_b32 v137, v136
  v_min_u32 v136, v136, v137
  v_mov_b32 v137, v136
  s_nop 1
  v_permlane32_swap_b32 v137, v136
  v_min_u32 v136, v136, v137
  s_nop 0
  v_readfirstlane_b32 s61, v136
  s_nop 0
  s_cmp_ge_u32 s61, s49
  s_cbranch_scc1 wf_done_19
  s_sleep 2
  s_branch wf_loop_20
wf_done_19:
  s_mov_b32 s50, 0
  s_mov_b64 exec, 15
  buffer_load_dword v112, v10, s[8:11], 0 offen sc1
  s_nop 11
  buffer_load_dword v113, v10, s[8:11], 0 offen sc1
  s_nop 11
  buffer_load_dword v114, v10, s[8:11], 0 offen sc1
  s_nop 11
  buffer_load_dword v115, v10, s[8:11], 0 offen sc1
  s_nop 11
  buffer_load_dword v116, v10, s[8:11], 0 offen sc1
  s_nop 11
  buffer_load_dword v117, v10, s[8:11], 0 offen sc1
  s_nop 11
  buffer_load_dword v118, v10, s[8:11], 0 offen sc1
  s_nop 11
  buffer_load_dword v119, v10, s[8:11], 0 offen sc1
  s_nop 11
  buffer_load_dword v120, v10, s[8:11], 0 offen sc1
  s_nop 11
bell_21:
  buffer_load_dword v121, v10, s[8:11], 0 offen sc1
  s_waitcnt vmcnt(9)
  v_cmp_gt_u32 vcc, s53, v112
  s_cbranch_vccz bell_x_22
  s_nop 7
  buffer_load_dword v112, v10, s[8:11], 0 offen sc1
  s_waitcnt vmcnt(9)
  v_cmp_gt_u32 vcc, s53, v113
  s_cbranch_vccz bell_x_22
  s_nop 7
  buffer_load_dword v113, v10, s[8:11], 0 offen sc1
  s_waitcnt vmcnt(9)
  v_cmp_gt_u32 vcc, s53, v114
  s_cbranch_vccz bell_x_22
  s_nop 7
  buffer_load_dword v114, v10, s[8:11], 0 offen sc1
  s_waitcnt vmcnt(9)
  v_cmp_gt_u32 vcc, s53, v115
  s_cbranch_vccz bell_x_22
  s_nop 7
  buffer_load_dword v115, v10, s[8:11], 0 offen sc1
  s_waitcnt vmcnt(9)
  v_cmp_gt_u32 vcc, s53, v116
  s_cbranch_vccz bell_x_22
  s_nop 7
  buffer_load_dword v116, v10, s[8:11], 0 offen sc1
  s_waitcnt vmcnt(9)
  v_cmp_gt_u32 vcc, s53, v117
  s_cbranch_vccz bell_x_22
  s_nop 7
  buffer_load_dword v117, v10, s[8:11], 0 offen sc1
  s_waitcnt vmcnt(9)
  v_cmp_gt_u32 vcc, s53, v118
  s_cbranch_vccz bell_x_22
  s_nop 7
  buffer_load_dword v118, v10, s[8:11], 0 offen sc1
  s_waitcnt vmcnt(9)
  v_cmp_gt_u32 vcc, s53, v119
  s_cbranch_vccz bell_x_22
  s_nop 7
  buffer_load_dword v119, v10, s[8:11], 0 offen sc1
  s_waitcnt vmcnt(9)
  v_cmp_gt_u32 vcc, s53, v120
  s_cbranch_vccz bell_x_22
  s_nop 7
  buffer_load_dword v120, v10, s[8:11], 0 offen sc1
  s_waitcnt vmcnt(9)
  v_cmp_gt_u32 vcc, s53, v121
  s_cbranch_vccz bell_x_22
  s_add_u32 s50, s50, 1
  s_cmp_gt_u32 s50, 131072
  s_cbranch_scc1 L_fail
  s_branch bell_21
bell_x_22:
  s_mov_b64 exec, -1
sc_nobell:
  s_mov_b32 s50, 0
sch_top:
  s_waitcnt lgkmcnt(0)
  s_barrier
  buffer_load_dwordx4 v[16:19], v12, s[8:11], 0 offen offset:0 sc1
  s_add_u32 m0, s51, 153600
  s_barrier
  buffer_load_dwordx4 v[20:23], v12, s[8:11], 0 offen offset:1024 sc1
  s_barrier
  buffer_load_dwordx4 v[24:27], v12, s[8:11], 0 offen offset:2048 sc1
  s_barrier
  buffer_load_dwordx4 v12, s[8:11], s31 offen sc1 lds
  s_add_u32 m0, s51, 157696
  s_barrier
  buffer_load_dwordx4 v12, s[8:11], s32 offen sc1 lds
  s_waitcnt vmcnt(4)
sch_go:
  v_smfmac_f32_16x16x64_bf16 v[88:91], v[16:19], a[192:199], v7
  v_smfmac_f32_16x16x64_bf16 v[92:95], v[16:19], a[200:207], v7
  v_smfmac_f32_16x16x64_bf16 v[96:99], v[16:19], a[208:215], v7
  v_smfmac_f32_16x16x64_bf16 v[100:103], v[16:19], v[56:63], v7
  v_smfmac_f32_16x16x64_bf16 v[104:107], v[16:19], v[64:71], v7
  ds_read_b128 v[56:59], v2 offset:57344
  v_smfmac_f32_16x16x64_bf16 v[108:111], v[16:19], v[72:79], v7
  s_waitcnt vmcnt(3)
  ds_read_b128 v[60:63], v2 offset:61440
  v_smfmac_f32_16x16x64_bf16 v[88:91], v[20:23], a[216:223], v7
  ds_read_b128 v[64:67], v3 offset:0
  v_smfmac_f32_16x16x64_bf16 v[92:95], v[20:23], a[224:231], v7
  ds_read_b128 v[68:71], v3 offset:4096
  v_smfmac_f32_16x16x64_bf16 v[96:99], v[20:23], a[232:239], v7
  s_waitcnt vmcnt(2)
  v_max3_u32 v136, v16, v20, v24
  v_smfmac_f32_16x16x64_bf16 v[100:103], v[20:23], a[0:7], v7
  ds_read_b128 v[72:75], v3 offset:8192
  v_cmp_eq_u32 vcc, -1, v136
  v_smfmac_f32_16x16x64_bf16 v[104:107], v[20:23], a[8:15], v7
  ds_read_b128 v[76:79], v3 offset:12288
  v_smfmac_f32_16x16x64_bf16 v[108:111], v[20:23], a[16:23], v7
  s_cbranch_vccnz sch_ha
  v_smfmac_f32_16x16x64_bf16 v[88:91], v[24:27], a[240:247], v7
  s_waitcnt vmcnt(1)
  s_barrier
  ds_read_b128 v[28:31], v149 offset:0
  v_smfmac_f32_16x16x64_bf16 v[92:95], v[24:27], a[248:255], v7
  ds_read_b128 v[32:35], v149 offset:1024
  v_smfmac_f32_16x16x64_bf16 v[96:99], v[24:27], v[152:159], v7
  ds_read_b128 v[36:39], v149 offset:2048
  v_smfmac_f32_16x16x64_bf16 v[100:103], v[24:27], a[24:31], v7
  ds_read_b128 v[40:43], v149 offset:3072
  v_smfmac_f32_16x16x64_bf16 v[104:107], v[24:27], a[32:39], v7
  v_smfmac_f32_16x16x64_bf16 v[108:111], v[24:27], a[40:47], v7
  s_waitcnt vmcnt(0)
  s_barrier
  s_waitcnt lgkmcnt(3)
  v_smfmac_f32_16x16x64_bf16 v[88:91], v[28:31], v[80:87], v7
  ds_read_b128 v[44:47], v149 offset:4096
  v_smfmac_f32_16x16x64_bf16 v[92:95], v[28:31], v[56:63], v7
  ds_read_b128 v[48:51], v149 offset:5120
  v_smfmac_f32_16x16x64_bf16 v[96:99], v[28:31], v[64:71], v7
  ds_read_b128 v[52:55], v149 offset:6144
  s_waitcnt lgkmcnt(3)
  v_smfmac_f32_16x16x64_bf16 v[88:91], v[32:35], v[160:167], v7
  ds_read_b128 v[80:83], v3 offset:32768
  v_smfmac_f32_16x16x64_bf16 v[92:95], v[32:35], v[168:175], v7
  ds_read_b128 v[84:87], v3 offset:36864
  v_smfmac_f32_16x16x64_bf16 v[96:99], v[32:35], v[176:183], v7
  ds_read_b128 v[56:59], v3 offset:16384
  v_smfmac_f32_16x16x64_bf16 v[88:91], v[36:39], v[184:191], v7
  s_waitcnt lgkmcnt(3)
  v_max3_u32 v136, v28, v32, v36
  v_smfmac_f32_16x16x64_bf16 v[92:95], v[36:39], v[192:199], v7
  ds_read_b128 v[60:63], v3 offset:20480
  v_max3_u32 v136, v136, v40, v44
  v_smfmac_f32_16x16x64_bf16 v[96:99], v[36:39], v[200:207], v7
  ds_read_b128 v[64:67], v3 offset:40960
  v_max3_u32 v136, v136, v48, v52
  v_smfmac_f32_16x16x64_bf16 v[88:91], v[44:47], v[208:215], v7
  ds_read_b128 v[68:71], v3 offset:45056
  v_cmp_eq_u32 vcc, -1, v136
  v_smfmac_f32_16x16x64_bf16 v[88:91], v[48:51], v[232:239], v7
  v_smfmac_f32_16x16x64_bf16 v[88:91], v[40:43], v[72:79], v7
  s_cbranch_vccnz sch_hb
  s_waitcnt lgkmcnt(3)
  v_smfmac_f32_16x16x64_bf16 v[88:91], v[52:55], v[80:87], v7
  ds_read_b128 v[72:75], v3 offset:24576
  s_mov_b32 m0, s21
sch_join:
  v_smfmac_f32_16x16x64_bf16 v[92:95], v[44:47], v[216:223], v7
  ds_read_b128 v[76:79], v3 offset:28672
  buffer_load_dwordx4 v[112:115], v1, s[8:11], s28 offen offset:0 sc1
  v_smfmac_f32_16x16x64_bf16 v[92:95], v[48:51], v[240:247], v7
  ds_read_b128 v[80:83], v3 offset:49152
  s_waitcnt lgkmcnt(3)
  v_add_f32 v88, v88, v90
  v_smfmac_f32_16x16x64_bf16 v[92:95], v[40:43], v[56:63], v7
  ds_read_b128 v[84:87], v3 offset:53248
  v_add_f32 v89, v89, v91
  v_smfmac_f32_16x16x64_bf16 v[92:95], v[52:55], v[64:71], v7
  ds_read_b128 v[56:59], v2 offset:24576
  buffer_load_dwordx4 v[116:119], v1, s[8:11], s28 offen offset:1024 sc1
  v_cmp_u_f32 vcc, v88, v89
  v_smfmac_f32_16x16x64_bf16 v[96:99], v[44:47], v[224:231], v7
  ds_read_b128 v[60:63], v2 offset:28672
  v_cvt_pk_bf16_f32 v136, v88, v89
  v_smfmac_f32_16x16x64_bf16 v[96:99], v[48:51], v[248:255], v7
  s_and_b64 vcc, vcc, s[16:17]
  s_cbranch_scc1 sch_redo
  s_waitcnt lgkmcnt(4)
  v_add_f32 v92, v92, v94
  v_smfmac_f32_16x16x64_bf16 v[96:99], v[40:43], v[72:79], v7
  ds_read_b128 v[64:67], v2 offset:32768
  buffer_load_dwordx4 v[120:123], v1, s[8:11], s29 offen offset:0 sc1
  s_waitcnt lgkmcnt(3)
  v_add_f32 v93, v93, v95
  v_smfmac_f32_16x16x64_bf16 v[96:99], v[52:55], v[80:87], v7
  ds_read_b128 v[68:71], v2 offset:36864
  v_cvt_pk_bf16_f32 v137, v92, v93
  v_smfmac_f32_16x16x64_bf16 v[100:103], v[28:31], a[48:55], v7
  ds_write2st64_b32 v4, v136, v137 offset0:0 offset1:4
  v_smfmac_f32_16x16x64_bf16 v[100:103], v[32:35], a[72:79], v7
  ds_read_b128 v[72:75], v2 offset:40960
  buffer_load_dwordx4 v[124:127], v1, s[8:11], s29 offen offset:1024 sc1
  v_add_f32 v96, v96, v98
  v_smfmac_f32_16x16x64_bf16 v[100:103], v[40:43], a[96:103], v7
  ds_read_b128 v[76:79], v2 offset:45056
  s_waitcnt lgkmcnt(5)
  v_add_f32 v97, v97, v99
  v_smfmac_f32_16x16x64_bf16 v[100:103], v[36:39], v[56:63], v7
  v_cvt_pk_bf16_f32 v138, v96, v97
  v_smfmac_f32_16x16x64_bf16 v[100:103], v[44:47], a[120:127], v7
  ds_write_b32 v4, v138 offset:2048
  buffer_load_dwordx4 v[128:131], v1, s[8:11], s30 offen offset:0 sc1
  v_smfmac_f32_16x16x64_bf16 v[100:103], v[48:51], a[144:151], v7
  s_waitcnt lgkmcnt(3)
  v_smfmac_f32_16x16x64_bf16 v[104:107], v[36:39], v[64:71], v7
  s_waitcnt lgkmcnt(1)
  v_smfmac_f32_16x16x64_bf16 v[108:111], v[36:39], v[72:79], v7
  buffer_load_dwordx4 v[132:135], v1, s[8:11], s30 offen offset:1024 sc1
  v_smfmac_f32_16x16x64_bf16 v[100:103], v[52:55], a[168:175], v7
  s_waitcnt lgkmcnt(0)
  s_barrier
  v_smfmac_f32_16x16x64_bf16 v[104:107], v[28:31], a[56:63], v7
  v_smfmac_f32_16x16x64_bf16 v[104:107], v[32:35], a[80:87], v7
  buffer_load_dwordx4 v1, s[8:11], s63 offen offset:0 sc1 lds
  v_smfmac_f32_16x16x64_bf16 v[104:107], v[40:43], a[104:111], v7
  v_smfmac_f32_16x16x64_bf16 v[104:107], v[44:47], a[128:135], v7
  v_smfmac_f32_16x16x64_bf16 v[104:107], v[48:51], a[152:159], v7
  buffer_load_dwordx4 v1, s[8:11], s63 offen offset:1024 sc1 lds
  v_smfmac_f32_16x16x64_bf16 v[104:107], v[52:55], a[176:183], v7
  v_smfmac_f32_16x16x64_bf16 v[108:111], v[28:31], a[64:71], v7
  v_add_f32 v100, v100, v102
  v_smfmac_f32_16x16x64_bf16 v[108:111], v[32:35], a[88:95], v7
  buffer_load_dwordx4 v1, s[8:11], s63 offen offset:2048 sc1 lds
  v_add_f32 v101, v101, v103
  v_smfmac_f32_16x16x64_bf16 v[108:111], v[40:43], a[112:119], v7
  v_cvt_pk_bf16_f32 v139, v100, v101
  v_smfmac_f32_16x16x64_bf16 v[108:111], v[44:47], a[136:143], v7
  v_add_f32 v104, v104, v106
  v_smfmac_f32_16x16x64_bf16 v[108:111], v[48:51], a[160:167], v7
  buffer_load_dwordx4 v1, s[8:11], s63 offen offset:3072 sc1 lds
  v_add_f32 v105, v105, v107
  v_smfmac_f32_16x16x64_bf16 v[108:111], v[52:55], a[184:191], v7
  v_cvt_pk_bf16_f32 v140, v104, v105
  ds_write2st64_b32 v4, v139, v140 offset0:12 offset1:16
  s_nop 5
  v_add_f32 v108, v108, v110
  v_add_f32 v109, v109, v111
  v_cvt_pk_bf16_f32 v141, v108, v109
  ds_write_b32 v4, v141 offset:5120
  s_waitcnt lgkmcnt(0)
  s_barrier
  s_barrier
  s_barrier
  s_cmp_ge_u32 s42, 2
  s_cbranch_scc1 sc_nox
  ds_read_b128 v[56:59], v13 offset:0
  ds_read_b128 v[60:63], v13 offset:2048
  ds_read_b128 v[64:67], v13 offset:1024
  ds_read_b128 v[68:71], v13 offset:3072
  ds_read_b128 v[72:75], v13 offset:4096
  ds_read_b128 v[76:79], v13 offset:6144
  ds_read_b128 v[80:83], v13 offset:5120
  ds_read_b128 v[84:87], v13 offset:7168
  ds_read_b128 v[16:19], v13 offset:8192
  ds_read_b128 v[20:23], v13 offset:10240
  ds_read_b128 v[24:27], v13 offset:9216
  ds_read_b128 v[36:39], v13 offset:11264
  s_waitcnt vmcnt(4)
  s_waitcnt lgkmcnt(11)
  v_mfma_f32_16x16x32_bf16 v[88:91], v[56:59], v[112:115], 0
  ds_read_b64_tr_b16 v[28:29], v5 offset:3072
  s_waitcnt lgkmcnt(11)
  v_mfma_f32_16x16x32_bf16 v[92:95], v[60:63], v[112:115], 0
  ds_read_b64_tr_b16 v[30:31], v5 offset:3136
  s_waitcnt lgkmcnt(11)
  v_mfma_f32_16x16x32_bf16 v[88:91], v[64:67], v[116:119], v[88:91]
  ds_read_b64_tr_b16 v[32:33], v5 offset:3584
  s_waitcnt lgkmcnt(11)
  v_mfma_f32_16x16x32_bf16 v[92:95], v[68:71], v[116:119], v[92:95]
  ds_read_b64_tr_b16 v[34:35], v5 offset:3648
  s_waitcnt lgkmcnt(11)
  v_mfma_f32_16x16x32_bf16 v[88:91], v[72:75], v[120:123], v[88:91]
  ds_read_b64_tr_b16 v[40:41], v5 offset:4096
  s_waitcnt lgkmcnt(5)
  v_mfma_f32_16x16x32_bf16 v[92:95], v[76:79], v[120:123], v[92:95]
  ds_read_b64_tr_b16 v[42:43], v5 offset:4160
  v_mfma_f32_16x16x32_bf16 v[88:91], v[80:83], v[124:127], v[88:91]
  ds_read_b64_tr_b16 v[44:45], v5 offset:4608
  v_mfma_f32_16x16x32_bf16 v[92:95], v[84:87], v[124:127], v[92:95]
  ds_read_b64_tr_b16 v[46:47], v5 offset:4672
  v_mfma_f32_16x16x32_bf16 v[88:91], v[16:19], v[128:131], v[88:91]
  ds_read_b64_tr_b16 v[48:49], v5 offset:5120
  v_mfma_f32_16x16x32_bf16 v[92:95], v[20:23], v[128:131], v[92:95]
  ds_read_b64_tr_b16 v[50:51], v5 offset:5184
  v_mfma_f32_16x16x32_bf16 v[88:91], v[24:27], v[132:135], v[88:91]
  ds_read_b64_tr_b16 v[52:53], v5 offset:5632
  v_mfma_f32_16x16x32_bf16 v[92:95], v[36:39], v[132:135], v[92:95]
  ds_read_b64_tr_b16 v[54:55], v5 offset:5696
  s_waitcnt lgkmcnt(5)
  v_mfma_f32_16x16x32_bf16 v[96:99], v[28:31], v[112:115], 0
  v_mfma_f32_16x16x32_bf16 v[96:99], v[32:35], v[116:119], v[96:99]
  v_mfma_f32_16x16x32_bf16 v[96:99], v[40:43], v[120:123], v[96:99]
  s_waitcnt lgkmcnt(2)
  v_mfma_f32_16x16x32_bf16 v[96:99], v[44:47], v[124:127], v[96:99]
  v_mfma_f32_16x16x32_bf16 v[96:99], v[48:51], v[128:131], v[96:99]
  s_waitcnt lgkmcnt(0)
  v_mfma_f32_16x16x32_bf16 v[96:99], v[52:55], v[132:135], v[96:99]
  s_waitcnt vmcnt(0)
  v_mov_b32 v143, s70
  v_cndmask_b32 v88, v88, v143, s[72:73]
  v_cndmask_b32 v89, v89, v143, s[74:75]
  v_cndmask_b32 v90, v90, v143, s[76:77]
  v_cndmask_b32 v91, v91, v143, s[78:79]
  v_cndmask_b32 v92, v92, v143, s[80:81]
  v_cndmask_b32 v93, v93, v143, s[82:83]
  v_cndmask_b32 v94, v94, v143, s[84:85]
  v_cndmask_b32 v95, v95, v143, s[86:87]
  s_mov_b32 vcc_lo, 0
  s_mov_b32 vcc_hi, -1
  v_cndmask_b32 v96, v96, v98, vcc
  v_cndmask_b32 v97, v97, v99, vcc
  v_max_f32 v142, v88, v89
  v_max3_f32 v142, v142, v90, v91
  v_max3_f32 v142, v142, v92, v93
  v_max3_f32 v142, v142, v94, v95
  v_max3_f32 v142, v142, v96, v97
  v_mov_b32 v143, v142
  s_nop 1
  v_permlane16_swap_b32 v143, v142
  v_max_f32 v142, v142, v143
  v_mov_b32 v143, v142
  s_nop 1
  v_permlane32_swap_b32 v143, v142
  v_max_f32 v142, v142, v143
  v_mul_f32 v142, s69, v142
  v_fma_f32 v88, v88, s69, -v142
  v_fma_f32 v89, v89, s69, -v142
  v_fma_f32 v90, v90, s69, -v142
  v_fma_f32 v91, v91, s69, -v142
  v_fma_f32 v92, v92, s69, -v142
  v_fma_f32 v93, v93, s69, -v142
  v_fma_f32 v94, v94, s69, -v142
  v_fma_f32 v95, v95, s69, -v142
  v_fma_f32 v96, v96, s69, -v142
  v_fma_f32 v97, v97, s69, -v142
  v_exp_f32 v88, v88
  v_exp_f32 v89, v89
  v_exp_f32 v90, v90
  v_exp_f32 v91, v91
  v_exp_f32 v92, v92
  v_exp_f32 v93, v93
  v_exp_f32 v94, v94
  v_exp_f32 v95, v95
  v_exp_f32 v96, v96
  v_exp_f32 v97, v97
  v_add_f32 v142, v88, v89
  v_add_f32 v142, v142, v90
  v_add_f32 v142, v142, v91
  v_add_f32 v142, v142, v92
  v_add_f32 v142, v142, v93
  v_add_f32 v142, v142, v94
  v_add_f32 v142, v142, v95
  v_add_f32 v142, v142, v96
  v_add_f32 v142, v142, v97
  v_mov_b32 v143, v142
  s_nop 1
  v_permlane16_swap_b32 v143, v142
  v_add_f32 v142, v142, v143
  v_mov_b32 v143, v142
  s_nop 1
  v_permlane32_swap_b32 v143, v142
  v_add_f32 v142, v142, v143
  v_rcp_f32 v142, v142
  s_nop 0
  v_mul_f32 v88, v88, v142
  v_mul_f32 v89, v89, v142
  v_mul_f32 v90, v90, v142
  v_mul_f32 v91, v91, v142
  v_mul_f32 v92, v92, v142
  v_mul_f32 v93, v93, v142
  v_mul_f32 v94, v94, v142
  v_mul_f32 v95, v95, v142
  v_mul_f32 v96, v96, v142
  v_mul_f32 v97, v97, v142
  v_cvt_pk_bf16_f32 v144, v88, v89
  v_cvt_pk_bf16_f32 v145, v90, v91
  v_cvt_pk_bf16_f32 v146, v92, v93
  v_cvt_pk_bf16_f32 v147, v94, v95
  v_cvt_pk_bf16_f32 v148, v96, v97
  s_mov_b32 s47, s64
  s_lshr_b32 s46, s47, 8
  s_and_b32 s46, s46, 0x2000
  s_xor_b32 s47, s47, s46
  s_add_u32 s46, s47, s27
  buffer_store_dwordx4 v[144:147], v1, s[8:11], s46 offen sc1
  buffer_store_dword v148, v14, s[8:11], s47 offen sc1
  s_add_u32 s64, s64, 262144
  s_cmp_ge_u32 s64, 16777216
  s_cselect_b32 s46, 2097152, 0
  s_sub_u32 s64, s64, s46
  s_branch sc_join
sc_nox:
  s_waitcnt vmcnt(0)
sc_join:
  v_add_u32 v13, s22, v13
  s_sub_u32 s22, 0, s22
  s_add_u32 s58, s58, 1
  s_cmp_eq_u32 s58, 3
  s_cselect_b32 s58, 0, s58
  s_mov_b32 s52, s53
  s_cmp_lt_u32 s52, 64
  s_cbranch_scc1 sch_loop
  s_waitcnt vmcnt(0)
  s_cmp_ge_u32 s42, 2
  s_cbranch_scc1 L_end
  v_mov_b32 v136, s52
  s_mov_b64 exec, 1
  buffer_store_dword v136, v15, s[8:11], 0 offen sc1
  s_mov_b64 exec, -1
  s_endpgm
scs_ha:
  s_waitcnt lgkmcnt(0)
  ds_read_b128 v[56:59], v2 offset:0
  ds_read_b128 v[60:63], v2 offset:4096
  ds_read_b128 v[64:67], v2 offset:8192
  ds_read_b128 v[68:71], v2 offset:12288
  ds_read_b128 v[72:75], v2 offset:16384
  ds_read_b128 v[76:79], v2 offset:20480
  ds_read_b128 v[80:83], v2 offset:49152
  ds_read_b128 v[84:87], v2 offset:53248
  v_mov_b32 v88, 0
  v_mov_b32 v89, 0
  v_mov_b32 v90, 0
  v_mov_b32 v91, 0
  v_mov_b32 v92, 0
  v_mov_b32 v93, 0
  v_mov_b32 v94, 0
  v_mov_b32 v95, 0
  v_mov_b32 v96, 0
  v_mov_b32 v97, 0
  v_mov_b32 v98, 0
  v_mov_b32 v99, 0
  v_mov_b32 v100, 0
  v_mov_b32 v101, 0
  v_mov_b32 v102, 0
  v_mov_b32 v103, 0
  v_mov_b32 v104, 0
  v_mov_b32 v105, 0
  v_mov_b32 v106, 0
  v_mov_b32 v107, 0
  v_mov_b32 v108, 0
  v_mov_b32 v109, 0
  v_mov_b32 v110, 0
  v_mov_b32 v111, 0
scs_ra:
  buffer_load_dwordx4 v[16:19], v12, s[8:11], 0 offen offset:0 sc1
  buffer_load_dwordx4 v[20:23], v12, s[8:11], 0 offen offset:1024 sc1
  buffer_load_dwordx4 v[24:27], v12, s[8:11], 0 offen offset:2048 sc1
  s_add_u32 s50, s50, 1
  s_cmp_gt_u32 s50, 131072
  s_cbranch_scc1 L_fail
  s_waitcnt vmcnt(0) lgkmcnt(0)
  v_max3_u32 v136, v16, v20, v24
  v_cmp_eq_u32 vcc, -1, v136
  s_cbranch_vccnz scs_ra
  s_branch scs_go
scs_hb:
  s_waitcnt lgkmcnt(0)
  s_add_u32 s50, s50, 1
  s_cmp_gt_u32 s50, 131072
  s_cbranch_scc1 L_fail
  ds_read_b128 v[56:59], v2 offset:0
  ds_read_b128 v[60:63], v2 offset:4096
  ds_read_b128 v[64:67], v2 offset:8192
  ds_read_b128 v[68:71], v2 offset:12288
  ds_read_b128 v[72:75], v2 offset:16384
  ds_read_b128 v[76:79], v2 offset:20480
  ds_read_b128 v[80:83], v2 offset:49152
  ds_read_b128 v[84:87], v2 offset:53248
  v_mov_b32 v88, 0
  v_mov_b32 v89, 0
  v_mov_b32 v90, 0
  v_mov_b32 v91, 0
  v_mov_b32 v92, 0
  v_mov_b32 v93, 0
  v_mov_b32 v94, 0
  v_mov_b32 v95, 0
  v_mov_b32 v96, 0
  v_mov_b32 v97, 0
  v_mov_b32 v98, 0
  v_mov_b32 v99, 0
  v_mov_b32 v100, 0
  v_mov_b32 v101, 0
  v_mov_b32 v102, 0
  v_mov_b32 v103, 0
  v_mov_b32 v104, 0
  v_mov_b32 v105, 0
  v_mov_b32 v106, 0
  v_mov_b32 v107, 0
  v_mov_b32 v108, 0
  v_mov_b32 v109, 0
  v_mov_b32 v110, 0
  v_mov_b32 v111, 0
  s_branch scs_top
scs_redo:
  s_waitcnt lgkmcnt(0)
  s_mov_b32 s50, 0
scs_poll:
  buffer_load_dwordx4 v[16:19], v12, s[8:11], 0 offen offset:0 sc1
  buffer_load_dwordx4 v[20:23], v12, s[8:11], 0 offen offset:1024 sc1
  buffer_load_dwordx4 v[24:27], v12, s[8:11], 0 offen offset:2048 sc1
  buffer_load_dwordx4 v[28:31], v12, s[8:11], 0 offen offset:3072 sc1
  buffer_load_dwordx4 v[32:35], v12, s[8:11], s24 offen offset:0 sc1
  buffer_load_dwordx4 v[36:39], v12, s[8:11], s24 offen offset:1024 sc1
  buffer_load_dwordx4 v[40:43], v12, s[8:11], s24 offen offset:2048 sc1
  buffer_load_dwordx4 v[44:47], v12, s[8:11], s24 offen offset:3072 sc1
  buffer_load_dwordx4 v[48:51], v12, s[8:11], s25 offen offset:0 sc1
  buffer_load_dwordx4 v[52:55], v12, s[8:11], s25 offen offset:1024 sc1
  s_add_u32 s50, s50, 1
  s_cmp_gt_u32 s50, 131072
  s_cbranch_scc1 L_fail
  s_waitcnt vmcnt(0) lgkmcnt(0)
  v_max_u32 v136, v16, v17
  v_max3_u32 v136, v18, v19, v136
  v_max3_u32 v136, v20, v21, v136
  v_max3_u32 v136, v22, v23, v136
  v_max3_u32 v136, v24, v25, v136
  v_max3_u32 v136, v26, v27, v136
  v_max3_u32 v136, v28, v29, v136
  v_max3_u32 v136, v30, v31, v136
  v_max3_u32 v136, v32, v33, v136
  v_max3_u32 v136, v34, v35, v136
  v_max3_u32 v136, v36, v37, v136
  v_max3_u32 v136, v38, v39, v136
  v_max3_u32 v136, v40, v41, v136
  v_max3_u32 v136, v42, v43, v136
  v_max3_u32 v136, v44, v45, v136
  v_max3_u32 v136, v46, v47, v136
  v_max3_u32 v136, v48, v49, v136
  v_max3_u32 v136, v50, v51, v136
  v_max3_u32 v136, v52, v53, v136
  v_max3_u32 v136, v54, v55, v136
  v_cmp_eq_u32 vcc, -1, v136
  s_cbranch_vccnz scs_poll
  s_mov_b64 s[16:17], 0
  ds_read_b128 v[56:59], v2 offset:0
  ds_read_b128 v[60:63], v2 offset:4096
  ds_read_b128 v[64:67], v2 offset:8192
  ds_read_b128 v[68:71], v2 offset:12288
  ds_read_b128 v[72:75], v2 offset:16384
  ds_read_b128 v[76:79], v2 offset:20480
  ds_read_b128 v[80:83], v2 offset:49152
  ds_read_b128 v[84:87], v2 offset:53248
  v_mov_b32 v88, 0
  v_mov_b32 v89, 0
  v_mov_b32 v90, 0
  v_mov_b32 v91, 0
  v_mov_b32 v92, 0
  v_mov_b32 v93, 0
  v_mov_b32 v94, 0
  v_mov_b32 v95, 0
  v_mov_b32 v96, 0
  v_mov_b32 v97, 0
  v_mov_b32 v98, 0
  v_mov_b32 v99, 0
  v_mov_b32 v100, 0
  v_mov_b32 v101, 0
  v_mov_b32 v102, 0
  v_mov_b32 v103, 0
  v_mov_b32 v104, 0
  v_mov_b32 v105, 0
  v_mov_b32 v106, 0
  v_mov_b32 v107, 0
  v_mov_b32 v108, 0
  v_mov_b32 v109, 0
  v_mov_b32 v110, 0
  v_mov_b32 v111, 0
  s_waitcnt lgkmcnt(0)
  v_smfmac_f32_16x16x64_bf16 v[88:91], v[16:19], a[192:199], v7
  v_smfmac_f32_16x16x64_bf16 v[92:95], v[16:19], a[200:207], v7
  v_smfmac_f32_16x16x64_bf16 v[96:99], v[16:19], a[208:215], v7
  v_smfmac_f32_16x16x64_bf16 v[100:103], v[16:19], v[56:63], v7
  v_smfmac_f32_16x16x64_bf16 v[104:107], v[16:19], v[64:71], v7
  ds_read_b128 v[56:59], v2 offset:57344
  v_smfmac_f32_16x16x64_bf16 v[108:111], v[16:19], v[72:79], v7
  ds_read_b128 v[60:63], v2 offset:61440
  v_smfmac_f32_16x16x64_bf16 v[88:91], v[20:23], a[216:223], v7
  ds_read_b128 v[64:67], v3 offset:0
  v_smfmac_f32_16x16x64_bf16 v[92:95], v[20:23], a[224:231], v7
  ds_read_b128 v[68:71], v3 offset:4096
  v_smfmac_f32_16x16x64_bf16 v[96:99], v[20:23], a[232:239], v7
  v_smfmac_f32_16x16x64_bf16 v[100:103], v[20:23], a[0:7], v7
  ds_read_b128 v[72:75], v3 offset:8192
  v_smfmac_f32_16x16x64_bf16 v[104:107], v[20:23], a[8:15], v7
  ds_read_b128 v[76:79], v3 offset:12288
  v_smfmac_f32_16x16x64_bf16 v[108:111], v[20:23], a[16:23], v7
  v_smfmac_f32_16x16x64_bf16 v[88:91], v[24:27], a[240:247], v7
  v_smfmac_f32_16x16x64_bf16 v[92:95], v[24:27], a[248:255], v7
  v_smfmac_f32_16x16x64_bf16 v[96:99], v[24:27], v[152:159], v7
  v_smfmac_f32_16x16x64_bf16 v[100:103], v[24:27], a[24:31], v7
  v_smfmac_f32_16x16x64_bf16 v[104:107], v[24:27], a[32:39], v7
  v_smfmac_f32_16x16x64_bf16 v[108:111], v[24:27], a[40:47], v7
  v_smfmac_f32_16x16x64_bf16 v[88:91], v[28:31], v[80:87], v7
  s_waitcnt lgkmcnt(0)
  v_smfmac_f32_16x16x64_bf16 v[92:95], v[28:31], v[56:63], v7
  v_smfmac_f32_16x16x64_bf16 v[96:99], v[28:31], v[64:71], v7
  v_smfmac_f32_16x16x64_bf16 v[88:91], v[32:35], v[160:167], v7
  ds_read_b128 v[80:83], v3 offset:32768
  ds_read_b128 v[16:19], v13 offset:8192
  v_smfmac_f32_16x16x64_bf16 v[92:95], v[32:35], v[168:175], v7
  ds_read_b128 v[84:87], v3 offset:36864
  ds_read_b128 v[20:23], v13 offset:10240
  v_smfmac_f32_16x16x64_bf16 v[96:99], v[32:35], v[176:183], v7
  ds_read_b128 v[56:59], v3 offset:16384
  ds_read_b128 v[24:27], v13 offset:9216
  v_smfmac_f32_16x16x64_bf16 v[88:91], v[36:39], v[184:191], v7
  v_smfmac_f32_16x16x64_bf16 v[92:95], v[36:39], v[192:199], v7
  ds_read_b128 v[60:63], v3 offset:20480
  v_smfmac_f32_16x16x64_bf16 v[96:99], v[36:39], v[200:207], v7
  ds_read_b128 v[64:67], v3 offset:40960
  v_smfmac_f32_16x16x64_bf16 v[88:91], v[44:47], v[208:215], v7
  ds_read_b128 v[68:71], v3 offset:45056
  v_smfmac_f32_16x16x64_bf16 v[88:91], v[48:51], v[232:239], v7
  v_smfmac_f32_16x16x64_bf16 v[88:91], v[40:43], v[72:79], v7
  s_waitcnt lgkmcnt(3)
  v_smfmac_f32_16x16x64_bf16 v[88:91], v[52:55], v[80:87], v7
  ds_read_b128 v[72:75], v3 offset:24576
  s_waitcnt lgkmcnt(0)
  s_branch scs_join
sch_ha:
  s_waitcnt lgkmcnt(0)
  ds_read_b128 v[56:59], v2 offset:0
  ds_read_b128 v[60:63], v2 offset:4096
  ds_read_b128 v[64:67], v2 offset:8192
  ds_read_b128 v[68:71], v2 offset:12288
  ds_read_b128 v[72:75], v2 offset:16384
  ds_read_b128 v[76:79], v2 offset:20480
  ds_read_b128 v[80:83], v2 offset:49152
  ds_read_b128 v[84:87], v2 offset:53248
  v_mov_b32 v88, 0
  v_mov_b32 v89, 0
  v_mov_b32 v90, 0
  v_mov_b32 v91, 0
  v_mov_b32 v92, 0
  v_mov_b32 v93, 0
  v_mov_b32 v94, 0
  v_mov_b32 v95, 0
  v_mov_b32 v96, 0
  v_mov_b32 v97, 0
  v_mov_b32 v98, 0
  v_mov_b32 v99, 0
  v_mov_b32 v100, 0
  v_mov_b32 v101, 0
  v_mov_b32 v102, 0
  v_mov_b32 v103, 0
  v_mov_b32 v104, 0
  v_mov_b32 v105, 0
  v_mov_b32 v106, 0
  v_mov_b32 v107, 0
  v_mov_b32 v108, 0
  v_mov_b32 v109, 0
  v_mov_b32 v110, 0
  v_mov_b32 v111, 0
sch_ra:
  buffer_load_dwordx4 v[16:19], v12, s[8:11], 0 offen offset:0 sc1
  buffer_load_dwordx4 v[20:23], v12, s[8:11], 0 offen offset:1024 sc1
  buffer_load_dwordx4 v[24:27], v12, s[8:11], 0 offen offset:2048 sc1
  s_add_u32 s50, s50, 1
  s_cmp_gt_u32 s50, 131072
  s_cbranch_scc1 L_fail
  s_waitcnt vmcnt(0) lgkmcnt(0)
  v_max3_u32 v136, v16, v20, v24
  v_cmp_eq_u32 vcc, -1, v136
  s_cbranch_vccnz sch_ra
  s_branch sch_go
sch_hb:
  s_waitcnt lgkmcnt(0)
  s_add_u32 s50, s50, 1
  s_cmp_gt_u32 s50, 131072
  s_cbranch_scc1 L_fail
  ds_read_b128 v[56:59], v2 offset:0
  ds_read_b128 v[60:63], v2 offset:4096
  ds_read_b128 v[64:67], v2 offset:8192
  ds_read_b128 v[68:71], v2 offset:12288
  ds_read_b128 v[72:75], v2 offset:16384
  ds_read_b128 v[76:79], v2 offset:20480
  ds_read_b128 v[80:83], v2 offset:49152
  ds_read_b128 v[84:87], v2 offset:53248
  v_mov_b32 v88, 0
  v_mov_b32 v89, 0
  v_mov_b32 v90, 0
  v_mov_b32 v91, 0
  v_mov_b32 v92, 0
  v_mov_b32 v93, 0
  v_mov_b32 v94, 0
  v_mov_b32 v95, 0
  v_mov_b32 v96, 0
  v_mov_b32 v97, 0
  v_mov_b32 v98, 0
  v_mov_b32 v99, 0
  v_mov_b32 v100, 0
  v_mov_b32 v101, 0
  v_mov_b32 v102, 0
  v_mov_b32 v103, 0
  v_mov_b32 v104, 0
  v_mov_b32 v105, 0
  v_mov_b32 v106, 0
  v_mov_b32 v107, 0
  v_mov_b32 v108, 0
  v_mov_b32 v109, 0
  v_mov_b32 v110, 0
  v_mov_b32 v111, 0
  s_branch sch_top
sch_redo:
  s_waitcnt lgkmcnt(0)
  s_mov_b32 s50, 0
sch_poll:
  buffer_load_dwordx4 v[16:19], v12, s[8:11], 0 offen offset:0 sc1
  buffer_load_dwordx4 v[20:23], v12, s[8:11], 0 offen offset:1024 sc1
  buffer_load_dwordx4 v[24:27], v12, s[8:11], 0 offen offset:2048 sc1
  buffer_load_dwordx4 v[28:31], v12, s[8:11], 0 offen offset:3072 sc1
  buffer_load_dwordx4 v[32:35], v12, s[8:11], s24 offen offset:0 sc1
  buffer_load_dwordx4 v[36:39], v12, s[8:11], s24 offen offset:1024 sc1
  buffer_load_dwordx4 v[40:43], v12, s[8:11], s24 offen offset:2048 sc1
  buffer_load_dwordx4 v[44:47], v12, s[8:11], s24 offen offset:3072 sc1
  buffer_load_dwordx4 v[48:51], v12, s[8:11], s25 offen offset:0 sc1
  buffer_load_dwordx4 v[52:55], v12, s[8:11], s25 offen offset:1024 sc1
  s_add_u32 s50, s50, 1
  s_cmp_gt_u32 s50, 131072
  s_cbranch_scc1 L_fail
  s_waitcnt vmcnt(0) lgkmcnt(0)
  v_max_u32 v136, v16, v17
  v_max3_u32 v136, v18, v19, v136
  v_max3_u32 v136, v20, v21, v136
  v_max3_u32 v136, v22, v23, v136
  v_max3_u32 v136, v24, v25, v136
  v_max3_u32 v136, v26, v27, v136
  v_max3_u32 v136, v28, v29, v136
  v_max3_u32 v136, v30, v31, v136
  v_max3_u32 v136, v32, v33, v136
  v_max3_u32 v136, v34, v35, v136
  v_max3_u32 v136, v36, v37, v136
  v_max3_u32 v136, v38, v39, v136
  v_max3_u32 v136, v40, v41, v136
  v_max3_u32 v136, v42, v43, v136
  v_max3_u32 v136, v44, v45, v136
  v_max3_u32 v136, v46, v47, v136
  v_max3_u32 v136, v48, v49, v136
  v_max3_u32 v136, v50, v51, v136
  v_max3_u32 v136, v52, v53, v136
  v_max3_u32 v136, v54, v55, v136
  v_cmp_eq_u32 vcc, -1, v136
  s_cbranch_vccnz sch_poll
  s_mov_b64 s[16:17], 0
  ds_read_b128 v[56:59], v2 offset:0
  ds_read_b128 v[60:63], v2 offset:4096
  ds_read_b128 v[64:67], v2 offset:8192
  ds_read_b128 v[68:71], v2 offset:12288
  ds_read_b128 v[72:75], v2 offset:16384
  ds_read_b128 v[76:79], v2 offset:20480
  ds_read_b128 v[80:83], v2 offset:49152
  ds_read_b128 v[84:87], v2 offset:53248
  v_mov_b32 v88, 0
  v_mov_b32 v89, 0
  v_mov_b32 v90, 0
  v_mov_b32 v91, 0
  v_mov_b32 v92, 0
  v_mov_b32 v93, 0
  v_mov_b32 v94, 0
  v_mov_b32 v95, 0
  v_mov_b32 v96, 0
  v_mov_b32 v97, 0
  v_mov_b32 v98, 0
  v_mov_b32 v99, 0
  v_mov_b32 v100, 0
  v_mov_b32 v101, 0
  v_mov_b32 v102, 0
  v_mov_b32 v103, 0
  v_mov_b32 v104, 0
  v_mov_b32 v105, 0
  v_mov_b32 v106, 0
  v_mov_b32 v107, 0
  v_mov_b32 v108, 0
  v_mov_b32 v109, 0
  v_mov_b32 v110, 0
  v_mov_b32 v111, 0
  s_waitcnt lgkmcnt(0)
  v_smfmac_f32_16x16x64_bf16 v[88:91], v[16:19], a[192:199], v7
  v_smfmac_f32_16x16x64_bf16 v[92:95], v[16:19], a[200:207], v7
  v_smfmac_f32_16x16x64_bf16 v[96:99], v[16:19], a[208:215], v7
  v_smfmac_f32_16x16x64_bf16 v[100:103], v[16:19], v[56:63], v7
  v_smfmac_f32_16x16x64_bf16 v[104:107], v[16:19], v[64:71], v7
  ds_read_b128 v[56:59], v2 offset:57344
  v_smfmac_f32_16x16x64_bf16 v[108:111], v[16:19], v[72:79], v7
  ds_read_b128 v[60:63], v2 offset:61440
  v_smfmac_f32_16x16x64_bf16 v[88:91], v[20:23], a[216:223], v7
  ds_read_b128 v[64:67], v3 offset:0
  v_smfmac_f32_16x16x64_bf16 v[92:95], v[20:23], a[224:231], v7
  ds_read_b128 v[68:71], v3 offset:4096
  v_smfmac_f32_16x16x64_bf16 v[96:99], v[20:23], a[232:239], v7
  v_smfmac_f32_16x16x64_bf16 v[100:103], v[20:23], a[0:7], v7
  ds_read_b128 v[72:75], v3 offset:8192
  v_smfmac_f32_16x16x64_bf16 v[104:107], v[20:23], a[8:15], v7
  ds_read_b128 v[76:79], v3 offset:12288
  v_smfmac_f32_16x16x64_bf16 v[108:111], v[20:23], a[16:23], v7
  v_smfmac_f32_16x16x64_bf16 v[88:91], v[24:27], a[240:247], v7
  v_smfmac_f32_16x16x64_bf16 v[92:95], v[24:27], a[248:255], v7
  v_smfmac_f32_16x16x64_bf16 v[96:99], v[24:27], v[152:159], v7
  v_smfmac_f32_16x16x64_bf16 v[100:103], v[24:27], a[24:31], v7
  v_smfmac_f32_16x16x64_bf16 v[104:107], v[24:27], a[32:39], v7
  v_smfmac_f32_16x16x64_bf16 v[108:111], v[24:27], a[40:47], v7
  v_smfmac_f32_16x16x64_bf16 v[88:91], v[28:31], v[80:87], v7
  s_waitcnt lgkmcnt(0)
  v_smfmac_f32_16x16x64_bf16 v[92:95], v[28:31], v[56:63], v7
  v_smfmac_f32_16x16x64_bf16 v[96:99], v[28:31], v[64:71], v7
  v_smfmac_f32_16x16x64_bf16 v[88:91], v[32:35], v[160:167], v7
  ds_read_b128 v[80:83], v3 offset:32768
  v_smfmac_f32_16x16x64_bf16 v[92:95], v[32:35], v[168:175], v7
  ds_read_b128 v[84:87], v3 offset:36864
  v_smfmac_f32_16x16x64_bf16 v[96:99], v[32:35], v[176:183], v7
  ds_read_b128 v[56:59], v3 offset:16384
  v_smfmac_f32_16x16x64_bf16 v[88:91], v[36:39], v[184:191], v7
  v_smfmac_f32_16x16x64_bf16 v[92:95], v[36:39], v[192:199], v7
  ds_read_b128 v[60:63], v3 offset:20480
  v_smfmac_f32_16x16x64_bf16 v[96:99], v[36:39], v[200:207], v7
  ds_read_b128 v[64:67], v3 offset:40960
  v_smfmac_f32_16x16x64_bf16 v[88:91], v[44:47], v[208:215], v7
  ds_read_b128 v[68:71], v3 offset:45056
  v_smfmac_f32_16x16x64_bf16 v[88:91], v[48:51], v[232:239], v7
  v_smfmac_f32_16x16x64_bf16 v[88:91], v[40:43], v[72:79], v7
  s_waitcnt lgkmcnt(3)
  v_smfmac_f32_16x16x64_bf16 v[88:91], v[52:55], v[80:87], v7
  ds_read_b128 v[72:75], v3 offset:24576
  s_mov_b32 m0, s21
  s_waitcnt lgkmcnt(0)
  s_branch sch_join
L_value:
  s_mov_b32 s4, s30
  s_mov_b32 s5, s31
  s_mov_b32 s6, 7864320
  s_mov_b32 s7, 0x20000
  s_mov_b32 s12, s32
  s_mov_b32 s13, s33
  s_mov_b32 s14, 7864320
  s_mov_b32 s15, 0x20000
  v_lshrrev_b32 v148, 3, v0
  v_lshrrev_b32 v149, 2, v148
  v_lshlrev_b32 v149, 3, v149
  v_and_b32 v64, 3, v148
  v_add_u32 v64, v64, v149
  s_and_b32 s46, s42, 1
  s_lshl_b32 s46, s46, 2
  s_lshr_b32 s47, s42, 1
  s_lshl_b32 s47, s47, 4
  s_add_u32 s46, s46, s47
  v_add_u32 v64, s46, v64
  v_mul_u32_u24 v64, 12288, v64
  v_lshrrev_b32 v148, 1, v148
  v_bfe_u32 v149, v0, 1, 2
  v_xor_b32 v148, v148, v149
  v_lshlrev_b32 v148, 5, v148
  v_and_b32 v149, 1, v0
  v_lshlrev_b32 v149, 4, v149
  v_add3_u32 v64, v64, v148, v149
  v_lshrrev_b32 v148, 3, v0
  v_lshrrev_b32 v149, 2, v148
  v_lshlrev_b32 v149, 3, v149
  v_and_b32 v65, 3, v148
  v_add_u32 v65, v65, v149
  s_and_b32 s46, s42, 1
  s_lshl_b32 s46, s46, 2
  s_lshr_b32 s47, s42, 1
  s_lshl_b32 s47, s47, 4
  s_add_u32 s46, s46, s47
  v_add_u32 v65, s46, v65
  v_mul_u32_u24 v65, 1280, v65
  v_lshrrev_b32 v148, 1, v148
  v_bfe_u32 v149, v0, 1, 2
  v_xor_b32 v148, v148, v149
  v_lshlrev_b32 v148, 5, v148
  v_and_b32 v149, 1, v0
  v_lshlrev_b32 v149, 4, v149
  v_add3_u32 v65, v65, v148, v149
  v_lshrrev_b32 v148, 5, v0
  v_lshlrev_b32 v66, 11, v148
  v_bfe_u32 v148, v0, 2, 3
  v_lshl_add_u32 v66, v148, 7, v66
  v_lshrrev_b32 v148, 1, v148
  v_xor_b32 v148, s42, v148
  v_lshl_add_u32 v66, v148, 5, v66
  v_and_b32 v148, 3, v0
  v_lshl_add_u32 v66, v148, 3, v66
  v_add_u32 v67, 0x10000, v66
  v_add_u32 v68, 0x20000, v66
  v_lshlrev_b32 v1, 4, v0
  v_add_u32 v2, s51, v1
  v_add_u32 v3, 0x10000, v2
  s_mul_i32 s62, s45, 384
  s_mul_i32 s63, s45, 245760
  s_mov_b32 s24, 4096
  s_mov_b32 s25, 49152
  s_add_u32 m0, s51, 73728
  s_add_u32 s46, s62, 0
  buffer_load_dwordx4 v64, s[4:7], s46 offen  lds
  s_add_u32 m0, s51, 77824
  s_add_u32 s46, s62, 393216
  buffer_load_dwordx4 v64, s[4:7], s46 offen  lds
  s_add_u32 m0, s51, 81920
  s_add_u32 s46, s62, 128
  buffer_load_dwordx4 v64, s[4:7], s46 offen  lds
  s_add_u32 m0, s51, 86016
  s_add_u32 s46, s62, 393344
  buffer_load_dwordx4 v64, s[4:7], s46 offen  lds
  s_add_u32 m0, s51, 90112
  s_add_u32 s46, s62, 256
  buffer_load_dwordx4 v64, s[4:7], s46 offen  lds
  s_add_u32 m0, s51, 94208
  s_add_u32 s46, s62, 393472
  buffer_load_dwordx4 v64, s[4:7], s46 offen  lds
  s_add_u32 m0, s51, 98304
  s_add_u32 s46, s62, 786432
  buffer_load_dwordx4 v64, s[4:7], s46 offen  lds
  s_add_u32 m0, s51, 102400
  s_add_u32 s46, s62, 1179648
  buffer_load_dwordx4 v64, s[4:7], s46 offen  lds
  s_add_u32 m0, s51, 106496
  s_add_u32 s46, s62, 786560
  buffer_load_dwordx4 v64, s[4:7], s46 offen  lds
  s_add_u32 m0, s51, 110592
  s_add_u32 s46, s62, 1179776
  buffer_load_dwordx4 v64, s[4:7], s46 offen  lds
  s_add_u32 m0, s51, 114688
  s_add_u32 s46, s62, 786688
  buffer_load_dwordx4 v64, s[4:7], s46 offen  lds
  s_add_u32 m0, s51, 118784
  s_add_u32 s46, s62, 1179904
  buffer_load_dwordx4 v64, s[4:7], s46 offen  lds
  s_add_u32 m0, s51, 122880
  s_add_u32 s46, s62, 2359296
  buffer_load_dwordx4 v64, s[4:7], s46 offen  lds
  s_add_u32 m0, s51, 126976
  s_add_u32 s46, s62, 2752512
  buffer_load_dwordx4 v64, s[4:7], s46 offen  lds
  s_add_u32 m0, s51, 131072
  s_add_u32 s46, s62, 2359424
  buffer_load_dwordx4 v64, s[4:7], s46 offen  lds
  s_add_u32 m0, s51, 135168
  s_add_u32 s46, s62, 2752640
  buffer_load_dwordx4 v64, s[4:7], s46 offen  lds
  s_add_u32 m0, s51, 139264
  s_add_u32 s46, s62, 2359552
  buffer_load_dwordx4 v64, s[4:7], s46 offen  lds
  s_add_u32 m0, s51, 143360
  s_add_u32 s46, s62, 2752768
  buffer_load_dwordx4 v64, s[4:7], s46 offen  lds
  s_add_u32 m0, s51, 0
  s_add_u32 s46, s62, 3145728
  buffer_load_dwordx4 v64, s[4:7], s46 offen  lds
  s_add_u32 m0, s51, 4096
  s_add_u32 s46, s62, 3538944
  buffer_load_dwordx4 v64, s[4:7], s46 offen  lds
  s_add_u32 m0, s51, 8192
  s_add_u32 s46, s62, 3145856
  buffer_load_dwordx4 v64, s[4:7], s46 offen  lds
  s_add_u32 m0, s51, 12288
  s_add_u32 s46, s62, 3539072
  buffer_load_dwordx4 v64, s[4:7], s46 offen  lds
  s_add_u32 m0, s51, 16384
  s_add_u32 s46, s62, 3145984
  buffer_load_dwordx4 v64, s[4:7], s46 offen  lds
  s_add_u32 m0, s51, 20480
  s_add_u32 s46, s62, 3539200
  buffer_load_dwordx4 v64, s[4:7], s46 offen  lds
  s_add_u32 m0, s51, 24576
  s_add_u32 s46, s62, 4718592
  buffer_load_dwordx4 v64, s[4:7], s46 offen  lds
  s_add_u32 m0, s51, 28672
  s_add_u32 s46, s62, 5111808
  buffer_load_dwordx4 v64, s[4:7], s46 offen  lds
  s_add_u32 m0, s51, 32768
  s_add_u32 s46, s62, 4718720
  buffer_load_dwordx4 v64, s[4:7], s46 offen  lds
  s_add_u32 m0, s51, 36864
  s_add_u32 s46, s62, 5111936
  buffer_load_dwordx4 v64, s[4:7], s46 offen  lds
  s_add_u32 m0, s51, 40960
  s_add_u32 s46, s62, 4718848
  buffer_load_dwordx4 v64, s[4:7], s46 offen  lds
  s_add_u32 m0, s51, 45056
  s_add_u32 s46, s62, 5112064
  buffer_load_dwordx4 v64, s[4:7], s46 offen  lds
  s_waitcnt vmcnt(24)
  s_barrier
  s_add_u32 m0, s51, 49152
  s_add_u32 s46, s62, 5505024
  buffer_load_dwordx4 v64, s[4:7], s46 offen  lds
  s_add_u32 m0, s51, 53248
  s_add_u32 s46, s62, 5898240
  buffer_load_dwordx4 v64, s[4:7], s46 offen  lds
  s_add_u32 m0, s51, 57344
  s_add_u32 s46, s62, 5505152
  buffer_load_dwordx4 v64, s[4:7], s46 offen  lds
  s_add_u32 m0, s51, 61440
  s_add_u32 s46, s62, 5898368
  buffer_load_dwordx4 v64, s[4:7], s46 offen  lds
  s_add_u32 m0, s51, 65536
  s_add_u32 s46, s62, 5505280
  buffer_load_dwordx4 v64, s[4:7], s46 offen  lds
  s_add_u32 m0, s51, 69632
  s_add_u32 s46, s62, 5898496
  buffer_load_dwordx4 v64, s[4:7], s46 offen  lds
  ds_read_b64_tr_b16 a[0:1], v67 offset:8192
  ds_read_b64_tr_b16 a[2:3], v67 offset:9216
  ds_read_b64_tr_b16 a[4:5], v67 offset:12288
  ds_read_b64_tr_b16 a[6:7], v67 offset:13312
  ds_read_b64_tr_b16 a[8:9], v67 offset:16384
  ds_read_b64_tr_b16 a[10:11], v67 offset:17408
  ds_read_b64_tr_b16 a[12:13], v67 offset:20480
  ds_read_b64_tr_b16 a[14:15], v67 offset:21504
  ds_read_b64_tr_b16 a[16:17], v67 offset:24576
  ds_read_b64_tr_b16 a[18:19], v67 offset:25600
  ds_read_b64_tr_b16 a[20:21], v67 offset:28672
  ds_read_b64_tr_b16 a[22:23], v67 offset:29696
  s_waitcnt lgkmcnt(0)
  s_waitcnt vmcnt(24)
  s_barrier
  s_add_u32 m0, s51, 73728
  s_add_u32 s46, s62, 7077888
  buffer_load_dwordx4 v64, s[4:7], s46 offen  lds
  s_add_u32 m0, s51, 77824
  s_add_u32 s46, s62, 7471104
  buffer_load_dwordx4 v64, s[4:7], s46 offen  lds
  s_add_u32 m0, s51, 81920
  s_add_u32 s46, s62, 7078016
  buffer_load_dwordx4 v64, s[4:7], s46 offen  lds
  s_add_u32 m0, s51, 86016
  s_add_u32 s46, s62, 7471232
  buffer_load_dwordx4 v64, s[4:7], s46 offen  lds
  s_add_u32 m0, s51, 90112
  s_add_u32 s46, s62, 7078144
  buffer_load_dwordx4 v64, s[4:7], s46 offen  lds
  s_add_u32 m0, s51, 94208
  s_add_u32 s46, s62, 7471360
  buffer_load_dwordx4 v64, s[4:7], s46 offen  lds
  ds_read_b64_tr_b16 a[24:25], v67 offset:32768
  ds_read_b64_tr_b16 a[26:27], v67 offset:33792
  ds_read_b64_tr_b16 a[28:29], v67 offset:36864
  ds_read_b64_tr_b16 a[30:31], v67 offset:37888
  ds_read_b64_tr_b16 a[32:33], v67 offset:40960
  ds_read_b64_tr_b16 a[34:35], v67 offset:41984
  ds_read_b64_tr_b16 a[36:37], v67 offset:45056
  ds_read_b64_tr_b16 a[38:39], v67 offset:46080
  ds_read_b64_tr_b16 a[40:41], v67 offset:49152
  ds_read_b64_tr_b16 a[42:43], v67 offset:50176
  ds_read_b64_tr_b16 a[44:45], v67 offset:53248
  ds_read_b64_tr_b16 a[46:47], v67 offset:54272
  s_waitcnt lgkmcnt(0)
  s_waitcnt vmcnt(24)
  s_barrier
  s_add_u32 m0, s51, 98304
  s_add_u32 s46, s63, 0
  buffer_load_dwordx4 v65, s[12:15], s46 offen  lds
  s_add_u32 m0, s51, 102400
  s_add_u32 s46, s63, 40960
  buffer_load_dwordx4 v65, s[12:15], s46 offen  lds
  s_add_u32 m0, s51, 106496
  s_add_u32 s46, s63, 81920
  buffer_load_dwordx4 v65, s[12:15], s46 offen  lds
  s_add_u32 m0, s51, 110592
  s_add_u32 s46, s63, 122880
  buffer_load_dwordx4 v65, s[12:15], s46 offen  lds
  s_add_u32 m0, s51, 114688
  s_add_u32 s46, s63, 163840
  buffer_load_dwordx4 v65, s[12:15], s46 offen  lds
  s_add_u32 m0, s51, 118784
  s_add_u32 s46, s63, 204800
  buffer_load_dwordx4 v65, s[12:15], s46 offen  lds
  ds_read_b64_tr_b16 a[48:49], v67 offset:57344
  ds_read_b64_tr_b16 a[50:51], v67 offset:58368
  ds_read_b64_tr_b16 a[52:53], v67 offset:61440
  ds_read_b64_tr_b16 a[54:55], v67 offset:62464
  ds_read_b64_tr_b16 a[56:57], v68 offset:0
  ds_read_b64_tr_b16 a[58:59], v68 offset:1024
  ds_read_b64_tr_b16 a[60:61], v68 offset:4096
  ds_read_b64_tr_b16 a[62:63], v68 offset:5120
  ds_read_b64_tr_b16 a[64:65], v68 offset:8192
  ds_read_b64_tr_b16 a[66:67], v68 offset:9216
  ds_read_b64_tr_b16 a[68:69], v68 offset:12288
  ds_read_b64_tr_b16 a[70:71], v68 offset:13312
  s_waitcnt lgkmcnt(0)
  s_waitcnt vmcnt(24)
  s_barrier
  s_add_u32 m0, s51, 122880
  s_add_u32 s46, s63, 128
  buffer_load_dwordx4 v65, s[12:15], s46 offen  lds
  s_add_u32 m0, s51, 126976
  s_add_u32 s46, s63, 41088
  buffer_load_dwordx4 v65, s[12:15], s46 offen  lds
  s_add_u32 m0, s51, 131072
  s_add_u32 s46, s63, 82048
  buffer_load_dwordx4 v65, s[12:15], s46 offen  lds
  s_add_u32 m0, s51, 135168
  s_add_u32 s46, s63, 123008
  buffer_load_dwordx4 v65, s[12:15], s46 offen  lds
  s_add_u32 m0, s51, 139264
  s_add_u32 s46, s63, 163968
  buffer_load_dwordx4 v65, s[12:15], s46 offen  lds
  s_add_u32 m0, s51, 143360
  s_add_u32 s46, s63, 204928
  buffer_load_dwordx4 v65, s[12:15], s46 offen  lds
  ds_read_b64_tr_b16 a[72:73], v66 offset:0
  ds_read_b64_tr_b16 a[74:75], v66 offset:1024
  ds_read_b64_tr_b16 a[76:77], v66 offset:4096
  ds_read_b64_tr_b16 a[78:79], v66 offset:5120
  ds_read_b64_tr_b16 a[80:81], v66 offset:8192
  ds_read_b64_tr_b16 a[82:83], v66 offset:9216
  ds_read_b64_tr_b16 a[84:85], v66 offset:12288
  ds_read_b64_tr_b16 a[86:87], v66 offset:13312
  ds_read_b64_tr_b16 a[88:89], v66 offset:16384
  ds_read_b64_tr_b16 a[90:91], v66 offset:17408
  ds_read_b64_tr_b16 a[92:93], v66 offset:20480
  ds_read_b64_tr_b16 a[94:95], v66 offset:21504
  s_waitcnt lgkmcnt(0)
  s_waitcnt vmcnt(24)
  s_barrier
  s_add_u32 m0, s51, 0
  s_add_u32 s46, s63, 256
  buffer_load_dwordx4 v65, s[12:15], s46 offen  lds
  s_add_u32 m0, s51, 4096
  s_add_u32 s46, s63, 41216
  buffer_load_dwordx4 v65, s[12:15], s46 offen  lds
  s_add_u32 m0, s51, 8192
  s_add_u32 s46, s63, 82176
  buffer_load_dwordx4 v65, s[12:15], s46 offen  lds
  s_add_u32 m0, s51, 12288
  s_add_u32 s46, s63, 123136
  buffer_load_dwordx4 v65, s[12:15], s46 offen  lds
  s_add_u32 m0, s51, 16384
  s_add_u32 s46, s63, 164096
  buffer_load_dwordx4 v65, s[12:15], s46 offen  lds
  s_add_u32 m0, s51, 20480
  s_add_u32 s46, s63, 205056
  buffer_load_dwordx4 v65, s[12:15], s46 offen  lds
  ds_read_b64_tr_b16 a[96:97], v66 offset:24576
  ds_read_b64_tr_b16 a[98:99], v66 offset:25600
  ds_read_b64_tr_b16 a[100:101], v66 offset:28672
  ds_read_b64_tr_b16 a[102:103], v66 offset:29696
  ds_read_b64_tr_b16 a[104:105], v66 offset:32768
  ds_read_b64_tr_b16 a[106:107], v66 offset:33792
  ds_read_b64_tr_b16 a[108:109], v66 offset:36864
  ds_read_b64_tr_b16 a[110:111], v66 offset:37888
  ds_read_b64_tr_b16 a[112:113], v66 offset:40960
  ds_read_b64_tr_b16 a[114:115], v66 offset:41984
  ds_read_b64_tr_b16 a[116:117], v66 offset:45056
  ds_read_b64_tr_b16 a[118:119], v66 offset:46080
  s_waitcnt lgkmcnt(0)
  s_waitcnt vmcnt(24)
  s_barrier
  s_add_u32 m0, s51, 24576
  s_add_u32 s46, s63, 384
  buffer_load_dwordx4 v65, s[12:15], s46 offen  lds
  s_add_u32 m0, s51, 28672
  s_add_u32 s46, s63, 41344
  buffer_load_dwordx4 v65, s[12:15], s46 offen  lds
  s_add_u32 m0, s51, 32768
  s_add_u32 s46, s63, 82304
  buffer_load_dwordx4 v65, s[12:15], s46 offen  lds
  s_add_u32 m0, s51, 36864
  s_add_u32 s46, s63, 123264
  buffer_load_dwordx4 v65, s[12:15], s46 offen  lds
  s_add_u32 m0, s51, 40960
  s_add_u32 s46, s63, 164224
  buffer_load_dwordx4 v65, s[12:15], s46 offen  lds
  s_add_u32 m0, s51, 45056
  s_add_u32 s46, s63, 205184
  buffer_load_dwordx4 v65, s[12:15], s46 offen  lds
  ds_read_b64_tr_b16 a[120:121], v66 offset:49152
  ds_read_b64_tr_b16 a[122:123], v66 offset:50176
  ds_read_b64_tr_b16 a[124:125], v66 offset:53248
  ds_read_b64_tr_b16 a[126:127], v66 offset:54272
  ds_read_b64_tr_b16 a[128:129], v66 offset:57344
  ds_read_b64_tr_b16 a[130:131], v66 offset:58368
  ds_read_b64_tr_b16 a[132:133], v66 offset:61440
  ds_read_b64_tr_b16 a[134:135], v66 offset:62464
  ds_read_b64_tr_b16 a[136:137], v67 offset:0
  ds_read_b64_tr_b16 a[138:139], v67 offset:1024
  ds_read_b64_tr_b16 a[140:141], v67 offset:4096
  ds_read_b64_tr_b16 a[142:143], v67 offset:5120
  s_waitcnt lgkmcnt(0)
  s_waitcnt vmcnt(24)
  s_barrier
  s_add_u32 m0, s51, 49152
  s_add_u32 s46, s63, 640
  buffer_load_dwordx4 v65, s[12:15], s46 offen  lds
  s_add_u32 m0, s51, 53248
  s_add_u32 s46, s63, 41600
  buffer_load_dwordx4 v65, s[12:15], s46 offen  lds
  s_add_u32 m0, s51, 57344
  s_add_u32 s46, s63, 82560
  buffer_load_dwordx4 v65, s[12:15], s46 offen  lds
  s_add_u32 m0, s51, 61440
  s_add_u32 s46, s63, 123520
  buffer_load_dwordx4 v65, s[12:15], s46 offen  lds
  s_add_u32 m0, s51, 65536
  s_add_u32 s46, s63, 164480
  buffer_load_dwordx4 v65, s[12:15], s46 offen  lds
  s_add_u32 m0, s51, 69632
  s_add_u32 s46, s63, 205440
  buffer_load_dwordx4 v65, s[12:15], s46 offen  lds
  ds_read_b64_tr_b16 a[144:145], v67 offset:8192
  ds_read_b64_tr_b16 a[146:147], v67 offset:9216
  ds_read_b64_tr_b16 a[148:149], v67 offset:12288
  ds_read_b64_tr_b16 a[150:151], v67 offset:13312
  ds_read_b64_tr_b16 a[152:153], v67 offset:16384
  ds_read_b64_tr_b16 a[154:155], v67 offset:17408
  ds_read_b64_tr_b16 a[156:157], v67 offset:20480
  ds_read_b64_tr_b16 a[158:159], v67 offset:21504
  ds_read_b64_tr_b16 a[160:161], v67 offset:24576
  ds_read_b64_tr_b16 a[162:163], v67 offset:25600
  ds_read_b64_tr_b16 a[164:165], v67 offset:28672
  ds_read_b64_tr_b16 a[166:167], v67 offset:29696
  s_waitcnt lgkmcnt(0)
  s_waitcnt vmcnt(24)
  s_barrier
  s_add_u32 m0, s51, 73728
  s_add_u32 s46, s63, 768
  buffer_load_dwordx4 v65, s[12:15], s46 offen  lds
  s_add_u32 m0, s51, 77824
  s_add_u32 s46, s63, 41728
  buffer_load_dwordx4 v65, s[12:15], s46 offen  lds
  s_add_u32 m0, s51, 81920
  s_add_u32 s46, s63, 82688
  buffer_load_dwordx4 v65, s[12:15], s46 offen  lds
  s_add_u32 m0, s51, 86016
  s_add_u32 s46, s63, 123648
  buffer_load_dwordx4 v65, s[12:15], s46 offen  lds
  s_add_u32 m0, s51, 90112
  s_add_u32 s46, s63, 164608
  buffer_load_dwordx4 v65, s[12:15], s46 offen  lds
  s_add_u32 m0, s51, 94208
  s_add_u32 s46, s63, 205568
  buffer_load_dwordx4 v65, s[12:15], s46 offen  lds
  ds_read_b64_tr_b16 a[168:169], v67 offset:32768
  ds_read_b64_tr_b16 a[170:171], v67 offset:33792
  ds_read_b64_tr_b16 a[172:173], v67 offset:36864
  ds_read_b64_tr_b16 a[174:175], v67 offset:37888
  ds_read_b64_tr_b16 a[176:177], v67 offset:40960
  ds_read_b64_tr_b16 a[178:179], v67 offset:41984
  ds_read_b64_tr_b16 a[180:181], v67 offset:45056
  ds_read_b64_tr_b16 a[182:183], v67 offset:46080
  ds_read_b64_tr_b16 a[184:185], v67 offset:49152
  ds_read_b64_tr_b16 a[186:187], v67 offset:50176
  ds_read_b64_tr_b16 a[188:189], v67 offset:53248
  ds_read_b64_tr_b16 a[190:191], v67 offset:54272
  s_waitcnt lgkmcnt(0)
  s_waitcnt vmcnt(24)
  s_barrier
  s_add_u32 m0, s51, 98304
  s_add_u32 s46, s63, 896
  buffer_load_dwordx4 v65, s[12:15], s46 offen  lds
  s_add_u32 m0, s51, 102400
  s_add_u32 s46, s63, 41856
  buffer_load_dwordx4 v65, s[12:15], s46 offen  lds
  s_add_u32 m0, s51, 106496
  s_add_u32 s46, s63, 82816
  buffer_load_dwordx4 v65, s[12:15], s46 offen  lds
  s_add_u32 m0, s51, 110592
  s_add_u32 s46, s63, 123776
  buffer_load_dwordx4 v65, s[12:15], s46 offen  lds
  s_add_u32 m0, s51, 114688
  s_add_u32 s46, s63, 164736
  buffer_load_dwordx4 v65, s[12:15], s46 offen  lds
  s_add_u32 m0, s51, 118784
  s_add_u32 s46, s63, 205696
  buffer_load_dwordx4 v65, s[12:15], s46 offen  lds
  ds_read_b64_tr_b16 a[192:193], v67 offset:57344
  ds_read_b64_tr_b16 a[194:195], v67 offset:58368
  ds_read_b64_tr_b16 a[196:197], v67 offset:61440
  ds_read_b64_tr_b16 a[198:199], v67 offset:62464
  ds_read_b64_tr_b16 a[200:201], v68 offset:0
  ds_read_b64_tr_b16 a[202:203], v68 offset:1024
  ds_read_b64_tr_b16 a[204:205], v68 offset:4096
  ds_read_b64_tr_b16 a[206:207], v68 offset:5120
  ds_read_b64_tr_b16 a[208:209], v68 offset:8192
  ds_read_b64_tr_b16 a[210:211], v68 offset:9216
  ds_read_b64_tr_b16 a[212:213], v68 offset:12288
  ds_read_b64_tr_b16 a[214:215], v68 offset:13312
  s_waitcnt lgkmcnt(0)
  s_waitcnt vmcnt(24)
  s_barrier
  s_add_u32 m0, s51, 122880
  s_add_u32 s46, s63, 1152
  buffer_load_dwordx4 v65, s[12:15], s46 offen  lds
  s_add_u32 m0, s51, 126976
  s_add_u32 s46, s63, 42112
  buffer_load_dwordx4 v65, s[12:15], s46 offen  lds
  s_add_u32 m0, s51, 131072
  s_add_u32 s46, s63, 83072
  buffer_load_dwordx4 v65, s[12:15], s46 offen  lds
  s_add_u32 m0, s51, 135168
  s_add_u32 s46, s63, 124032
  buffer_load_dwordx4 v65, s[12:15], s46 offen  lds
  s_add_u32 m0, s51, 139264
  s_add_u32 s46, s63, 164992
  buffer_load_dwordx4 v65, s[12:15], s46 offen  lds
  s_add_u32 m0, s51, 143360
  s_add_u32 s46, s63, 205952
  buffer_load_dwordx4 v65, s[12:15], s46 offen  lds
  ds_read_b64_tr_b16 a[216:217], v66 offset:0
  ds_read_b64_tr_b16 a[218:219], v66 offset:1024
  ds_read_b64_tr_b16 a[220:221], v66 offset:4096
  ds_read_b64_tr_b16 a[222:223], v66 offset:5120
  ds_read_b64_tr_b16 a[224:225], v66 offset:8192
  ds_read_b64_tr_b16 a[226:227], v66 offset:9216
  ds_read_b64_tr_b16 a[228:229], v66 offset:12288
  ds_read_b64_tr_b16 a[230:231], v66 offset:13312
  ds_read_b64_tr_b16 a[232:233], v66 offset:16384
  ds_read_b64_tr_b16 a[234:235], v66 offset:17408
  ds_read_b64_tr_b16 a[236:237], v66 offset:20480
  ds_read_b64_tr_b16 a[238:239], v66 offset:21504
  s_waitcnt lgkmcnt(0)
  s_waitcnt vmcnt(24)
  s_barrier
  s_add_u32 m0, s51, 0
  s_add_u32 s46, s62, 1572864
  buffer_load_dwordx4 v64, s[4:7], s46 offen  lds
  s_add_u32 m0, s51, 4096
  s_add_u32 s46, s62, 1966080
  buffer_load_dwordx4 v64, s[4:7], s46 offen  lds
  s_add_u32 m0, s51, 8192
  s_add_u32 s46, s62, 1572992
  buffer_load_dwordx4 v64, s[4:7], s46 offen  lds
  s_add_u32 m0, s51, 12288
  s_add_u32 s46, s62, 1966208
  buffer_load_dwordx4 v64, s[4:7], s46 offen  lds
  s_add_u32 m0, s51, 16384
  s_add_u32 s46, s62, 1573120
  buffer_load_dwordx4 v64, s[4:7], s46 offen  lds
  s_add_u32 m0, s51, 20480
  s_add_u32 s46, s62, 1966336
  buffer_load_dwordx4 v64, s[4:7], s46 offen  lds
  ds_read_b64_tr_b16 a[240:241], v66 offset:24576
  ds_read_b64_tr_b16 a[242:243], v66 offset:25600
  ds_read_b64_tr_b16 a[244:245], v66 offset:28672
  ds_read_b64_tr_b16 a[246:247], v66 offset:29696
  ds_read_b64_tr_b16 a[248:249], v66 offset:32768
  ds_read_b64_tr_b16 a[250:251], v66 offset:33792
  ds_read_b64_tr_b16 a[252:253], v66 offset:36864
  ds_read_b64_tr_b16 a[254:255], v66 offset:37888
  ds_read_b64_tr_b16 v[152:153], v66 offset:40960
  ds_read_b64_tr_b16 v[154:155], v66 offset:41984
  ds_read_b64_tr_b16 v[156:157], v66 offset:45056
  ds_read_b64_tr_b16 v[158:159], v66 offset:46080
  s_waitcnt lgkmcnt(0)
  s_waitcnt vmcnt(24)
  s_barrier
  s_add_u32 m0, s51, 24576
  s_add_u32 s46, s62, 3932160
  buffer_load_dwordx4 v64, s[4:7], s46 offen  lds
  s_add_u32 m0, s51, 28672
  s_add_u32 s46, s62, 4325376
  buffer_load_dwordx4 v64, s[4:7], s46 offen  lds
  s_add_u32 m0, s51, 32768
  s_add_u32 s46, s62, 3932288
  buffer_load_dwordx4 v64, s[4:7], s46 offen  lds
  s_add_u32 m0, s51, 36864
  s_add_u32 s46, s62, 4325504
  buffer_load_dwordx4 v64, s[4:7], s46 offen  lds
  s_add_u32 m0, s51, 40960
  s_add_u32 s46, s62, 3932416
  buffer_load_dwordx4 v64, s[4:7], s46 offen  lds
  s_add_u32 m0, s51, 45056
  s_add_u32 s46, s62, 4325632
  buffer_load_dwordx4 v64, s[4:7], s46 offen  lds
  ds_read_b64_tr_b16 v[160:161], v66 offset:49152
  ds_read_b64_tr_b16 v[162:163], v66 offset:50176
  ds_read_b64_tr_b16 v[164:165], v66 offset:53248
  ds_read_b64_tr_b16 v[166:167], v66 offset:54272
  ds_read_b64_tr_b16 v[168:169], v66 offset:57344
  ds_read_b64_tr_b16 v[170:171], v66 offset:58368
  ds_read_b64_tr_b16 v[172:173], v66 offset:61440
  ds_read_b64_tr_b16 v[174:175], v66 offset:62464
  ds_read_b64_tr_b16 v[176:177], v67 offset:0
  ds_read_b64_tr_b16 v[178:179], v67 offset:1024
  ds_read_b64_tr_b16 v[180:181], v67 offset:4096
  ds_read_b64_tr_b16 v[182:183], v67 offset:5120
  s_waitcnt lgkmcnt(0)
  s_waitcnt vmcnt(24)
  s_barrier
  s_add_u32 m0, s51, 49152
  s_add_u32 s46, s62, 6291456
  buffer_load_dwordx4 v64, s[4:7], s46 offen  lds
  s_add_u32 m0, s51, 53248
  s_add_u32 s46, s62, 6684672
  buffer_load_dwordx4 v64, s[4:7], s46 offen  lds
  s_add_u32 m0, s51, 57344
  s_add_u32 s46, s62, 6291584
  buffer_load_dwordx4 v64, s[4:7], s46 offen  lds
  s_add_u32 m0, s51, 61440
  s_add_u32 s46, s62, 6684800
  buffer_load_dwordx4 v64, s[4:7], s46 offen  lds
  s_add_u32 m0, s51, 65536
  s_add_u32 s46, s62, 6291712
  buffer_load_dwordx4 v64, s[4:7], s46 offen  lds
  s_add_u32 m0, s51, 69632
  s_add_u32 s46, s62, 6684928
  buffer_load_dwordx4 v64, s[4:7], s46 offen  lds
  ds_read_b64_tr_b16 v[184:185], v67 offset:8192
  ds_read_b64_tr_b16 v[186:187], v67 offset:9216
  ds_read_b64_tr_b16 v[188:189], v67 offset:12288
  ds_read_b64_tr_b16 v[190:191], v67 offset:13312
  ds_read_b64_tr_b16 v[192:193], v67 offset:16384
  ds_read_b64_tr_b16 v[194:195], v67 offset:17408
  ds_read_b64_tr_b16 v[196:197], v67 offset:20480
  ds_read_b64_tr_b16 v[198:199], v67 offset:21504
  ds_read_b64_tr_b16 v[200:201], v67 offset:24576
  ds_read_b64_tr_b16 v[202:203], v67 offset:25600
  ds_read_b64_tr_b16 v[204:205], v67 offset:28672
  ds_read_b64_tr_b16 v[206:207], v67 offset:29696
  s_waitcnt lgkmcnt(0)
  s_waitcnt vmcnt(24)
  s_barrier
  s_add_u32 m0, s51, 73728
  s_add_u32 s46, s63, 512
  buffer_load_dwordx4 v65, s[12:15], s46 offen  lds
  s_add_u32 m0, s51, 77824
  s_add_u32 s46, s63, 41472
  buffer_load_dwordx4 v65, s[12:15], s46 offen  lds
  s_add_u32 m0, s51, 81920
  s_add_u32 s46, s63, 82432
  buffer_load_dwordx4 v65, s[12:15], s46 offen  lds
  s_add_u32 m0, s51, 86016
  s_add_u32 s46, s63, 123392
  buffer_load_dwordx4 v65, s[12:15], s46 offen  lds
  s_add_u32 m0, s51, 90112
  s_add_u32 s46, s63, 164352
  buffer_load_dwordx4 v65, s[12:15], s46 offen  lds
  s_add_u32 m0, s51, 94208
  s_add_u32 s46, s63, 205312
  buffer_load_dwordx4 v65, s[12:15], s46 offen  lds
  ds_read_b64_tr_b16 v[208:209], v67 offset:32768
  ds_read_b64_tr_b16 v[210:211], v67 offset:33792
  ds_read_b64_tr_b16 v[212:213], v67 offset:36864
  ds_read_b64_tr_b16 v[214:215], v67 offset:37888
  ds_read_b64_tr_b16 v[216:217], v67 offset:40960
  ds_read_b64_tr_b16 v[218:219], v67 offset:41984
  ds_read_b64_tr_b16 v[220:221], v67 offset:45056
  ds_read_b64_tr_b16 v[222:223], v67 offset:46080
  ds_read_b64_tr_b16 v[224:225], v67 offset:49152
  ds_read_b64_tr_b16 v[226:227], v67 offset:50176
  ds_read_b64_tr_b16 v[228:229], v67 offset:53248
  ds_read_b64_tr_b16 v[230:231], v67 offset:54272
  s_waitcnt lgkmcnt(0)
  s_waitcnt vmcnt(24)
  s_barrier
  s_add_u32 m0, s51, 98304
  s_add_u32 s46, s63, 1024
  buffer_load_dwordx4 v65, s[12:15], s46 offen  lds
  s_add_u32 m0, s51, 102400
  s_add_u32 s46, s63, 41984
  buffer_load_dwordx4 v65, s[12:15], s46 offen  lds
  s_add_u32 m0, s51, 106496
  s_add_u32 s46, s63, 82944
  buffer_load_dwordx4 v65, s[12:15], s46 offen  lds
  s_add_u32 m0, s51, 110592
  s_add_u32 s46, s63, 123904
  buffer_load_dwordx4 v65, s[12:15], s46 offen  lds
  s_add_u32 m0, s51, 114688
  s_add_u32 s46, s63, 164864
  buffer_load_dwordx4 v65, s[12:15], s46 offen  lds
  s_add_u32 m0, s51, 118784
  s_add_u32 s46, s63, 205824
  buffer_load_dwordx4 v65, s[12:15], s46 offen  lds
  ds_read_b64_tr_b16 v[232:233], v67 offset:57344
  ds_read_b64_tr_b16 v[234:235], v67 offset:58368
  ds_read_b64_tr_b16 v[236:237], v67 offset:61440
  ds_read_b64_tr_b16 v[238:239], v67 offset:62464
  ds_read_b64_tr_b16 v[240:241], v68 offset:0
  ds_read_b64_tr_b16 v[242:243], v68 offset:1024
  ds_read_b64_tr_b16 v[244:245], v68 offset:4096
  ds_read_b64_tr_b16 v[246:247], v68 offset:5120
  ds_read_b64_tr_b16 v[248:249], v68 offset:8192
  ds_read_b64_tr_b16 v[250:251], v68 offset:9216
  ds_read_b64_tr_b16 v[252:253], v68 offset:12288
  ds_read_b64_tr_b16 v[254:255], v68 offset:13312
  s_waitcnt lgkmcnt(0)
  s_waitcnt vmcnt(24)
  s_barrier
  ds_read_b64_tr_b16 v[40:41], v66 offset:0
  ds_read_b64_tr_b16 v[42:43], v66 offset:1024
  ds_read_b64_tr_b16 v[44:45], v66 offset:4096
  ds_read_b64_tr_b16 v[46:47], v66 offset:5120
  ds_read_b64_tr_b16 v[48:49], v66 offset:8192
  ds_read_b64_tr_b16 v[50:51], v66 offset:9216
  ds_read_b64_tr_b16 v[52:53], v66 offset:12288
  ds_read_b64_tr_b16 v[54:55], v66 offset:13312
  ds_read_b64_tr_b16 v[56:57], v66 offset:16384
  ds_read_b64_tr_b16 v[58:59], v66 offset:17408
  ds_read_b64_tr_b16 v[60:61], v66 offset:20480
  ds_read_b64_tr_b16 v[62:63], v66 offset:21504
  s_waitcnt lgkmcnt(0)
  s_waitcnt vmcnt(18)
  s_barrier
  ds_write_b128 v2, v[40:43] offset:0
  ds_write_b128 v2, v[44:47] offset:4096
  ds_write_b128 v2, v[48:51] offset:8192
  ds_write_b128 v2, v[52:55] offset:12288
  ds_write_b128 v2, v[56:59] offset:16384
  ds_write_b128 v2, v[60:63] offset:20480
  ds_read_b64_tr_b16 v[16:17], v66 offset:24576
  ds_read_b64_tr_b16 v[18:19], v66 offset:25600
  ds_read_b64_tr_b16 v[20:21], v66 offset:28672
  ds_read_b64_tr_b16 v[22:23], v66 offset:29696
  ds_read_b64_tr_b16 v[24:25], v66 offset:32768
  ds_read_b64_tr_b16 v[26:27], v66 offset:33792
  ds_read_b64_tr_b16 v[28:29], v66 offset:36864
  ds_read_b64_tr_b16 v[30:31], v66 offset:37888
  ds_read_b64_tr_b16 v[32:33], v66 offset:40960
  ds_read_b64_tr_b16 v[34:35], v66 offset:41984
  ds_read_b64_tr_b16 v[36:37], v66 offset:45056
  ds_read_b64_tr_b16 v[38:39], v66 offset:46080
  s_waitcnt lgkmcnt(0)
  s_waitcnt vmcnt(12)
  s_barrier
  ds_write_b128 v2, v[16:19] offset:24576
  ds_write_b128 v2, v[20:23] offset:28672
  ds_write_b128 v2, v[24:27] offset:32768
  ds_write_b128 v2, v[28:31] offset:36864
  ds_write_b128 v2, v[32:35] offset:40960
  ds_write_b128 v2, v[36:39] offset:45056
  ds_read_b64_tr_b16 v[40:41], v66 offset:49152
  ds_read_b64_tr_b16 v[42:43], v66 offset:50176
  ds_read_b64_tr_b16 v[44:45], v66 offset:53248
  ds_read_b64_tr_b16 v[46:47], v66 offset:54272
  ds_read_b64_tr_b16 v[48:49], v66 offset:57344
  ds_read_b64_tr_b16 v[50:51], v66 offset:58368
  ds_read_b64_tr_b16 v[52:53], v66 offset:61440
  ds_read_b64_tr_b16 v[54:55], v66 offset:62464
  ds_read_b64_tr_b16 v[56:57], v67 offset:0
  ds_read_b64_tr_b16 v[58:59], v67 offset:1024
  ds_read_b64_tr_b16 v[60:61], v67 offset:4096
  ds_read_b64_tr_b16 v[62:63], v67 offset:5120
  s_waitcnt lgkmcnt(0)
  s_waitcnt vmcnt(6)
  s_barrier
  ds_write_b128 v2, v[40:43] offset:49152
  ds_write_b128 v2, v[44:47] offset:53248
  ds_write_b128 v2, v[48:51] offset:57344
  ds_write_b128 v2, v[52:55] offset:61440
  ds_write_b128 v3, v[56:59] offset:0
  ds_write_b128 v3, v[60:63] offset:4096
  ds_read_b64_tr_b16 v[16:17], v67 offset:8192
  ds_read_b64_tr_b16 v[18:19], v67 offset:9216
  ds_read_b64_tr_b16 v[20:21], v67 offset:12288
  ds_read_b64_tr_b16 v[22:23], v67 offset:13312
  ds_read_b64_tr_b16 v[24:25], v67 offset:16384
  ds_read_b64_tr_b16 v[26:27], v67 offset:17408
  ds_read_b64_tr_b16 v[28:29], v67 offset:20480
  ds_read_b64_tr_b16 v[30:31], v67 offset:21504
  ds_read_b64_tr_b16 v[32:33], v67 offset:24576
  ds_read_b64_tr_b16 v[34:35], v67 offset:25600
  ds_read_b64_tr_b16 v[36:37], v67 offset:28672
  ds_read_b64_tr_b16 v[38:39], v67 offset:29696
  s_waitcnt lgkmcnt(0)
  s_waitcnt vmcnt(0)
  s_barrier
  ds_write_b128 v3, v[16:19] offset:8192
  ds_write_b128 v3, v[20:23] offset:12288
  ds_write_b128 v3, v[24:27] offset:16384
  ds_write_b128 v3, v[28:31] offset:20480
  ds_write_b128 v3, v[32:35] offset:24576
  ds_write_b128 v3, v[36:39] offset:28672
  ds_read_b64_tr_b16 v[40:41], v67 offset:32768
  ds_read_b64_tr_b16 v[42:43], v67 offset:33792
  ds_read_b64_tr_b16 v[44:45], v67 offset:36864
  ds_read_b64_tr_b16 v[46:47], v67 offset:37888
  ds_read_b64_tr_b16 v[48:49], v67 offset:40960
  ds_read_b64_tr_b16 v[50:51], v67 offset:41984
  ds_read_b64_tr_b16 v[52:53], v67 offset:45056
  ds_read_b64_tr_b16 v[54:55], v67 offset:46080
  ds_read_b64_tr_b16 v[56:57], v67 offset:49152
  ds_read_b64_tr_b16 v[58:59], v67 offset:50176
  ds_read_b64_tr_b16 v[60:61], v67 offset:53248
  ds_read_b64_tr_b16 v[62:63], v67 offset:54272
  s_waitcnt lgkmcnt(0)
  s_barrier
  ds_write_b128 v3, v[40:43] offset:32768
  ds_write_b128 v3, v[44:47] offset:36864
  ds_write_b128 v3, v[48:51] offset:40960
  ds_write_b128 v3, v[52:55] offset:45056
  ds_write_b128 v3, v[56:59] offset:49152
  ds_write_b128 v3, v[60:63] offset:53248
  s_waitcnt lgkmcnt(0)
  s_add_u32 s46, s42, 1
  s_lshl_b32 s31, s46, 10
  s_cmp_ge_u32 s46, 8
  s_cselect_b32 s47, 40960, 0
  s_add_u32 s31, s31, s47
  s_cmp_ge_u32 s46, 10
  s_cselect_b32 s31, 2146435072, s31
  s_add_u32 s46, s42, 5
  s_lshl_b32 s32, s46, 10
  s_cmp_ge_u32 s46, 8
  s_cselect_b32 s47, 40960, 0
  s_add_u32 s32, s32, s47
  s_cmp_ge_u32 s46, 10
  s_cselect_b32 s32, 2146435072, s32
  s_add_u32 s46, s42, 9
  s_lshl_b32 s33, s46, 10
  s_cmp_ge_u32 s46, 8
  s_cselect_b32 s47, 40960, 0
  s_add_u32 s33, s33, s47
  s_cmp_ge_u32 s46, 10
  s_cselect_b32 s33, 2146435072, s33
  v_add_u32 v9, 126976, v1
  v_and_b32 v149, 3, v0
  v_lshlrev_b32 v149, 2, v149
  s_mov_b32 s50, 0
ss_23:
  global_load_dword v148, v149, s[38:39] sc1
  s_add_u32 s50, s50, 1
  s_cmp_gt_u32 s50, 131072
  s_cbranch_scc1 L_fail
  s_waitcnt vmcnt(0)
  v_readlane_b32 s46, v148, 0
  v_readlane_b32 s47, v148, 2
  v_readlane_b32 s48, v148, 1
  s_nop 0
  s_min_u32 s47, s47, s48
  s_cmp_lg_u32 s46, 0
  s_cselect_b32 s48, 7, 0
  s_add_u32 s46, s46, s2
  s_xor_b32 s49, s46, s43
  s_and_b32 s49, s49, s48
  s_cbranch_scc1 L_reroll
  s_cmp_lg_u32 s47, 0
  s_cbranch_scc1 ss_ok_24
  s_sleep 6
  s_branch ss_23
ss_ok_24:
  v_readlane_b32 s3, v148, 1
  s_nop 0
  s_and_b32 s3, s3, 0x2000
  v_and_b32 v148, 3, v0
  s_lshl_b32 s46, s43, 9
  s_add_u32 s46, s46, s3
  s_add_u32 s46, s46, 13369344
  v_lshl_add_u32 v10, v148, 7, s46
  v_mov_b32 v7, 0x44444444
  v_mov_b32 v148, 0xeeeeeeee
  v_and_b32 v149, 2, v0
  v_cmp_ne_u32 vcc, 0, v149
  s_nop 1
  v_cndmask_b32 v7, v7, v148, vcc
  v_and_b32 v148, 15, v0
  v_lshrrev_b32 v149, 4, v0
  v_lshlrev_b32 v8, 4, v148
  v_lshrrev_b32 v150, 1, v149
  v_lshl_add_u32 v8, v150, 3, v8
  v_and_b32 v151, 1, v149
  v_lshrrev_b32 v150, 2, v148
  v_lshlrev_b32 v4, 6, v150
  v_and_b32 v150, 1, v148
  v_lshl_add_u32 v4, v150, 5, v4
  v_lshl_add_u32 v4, v149, 3, v4
  v_bfe_u32 v150, v148, 1, 1
  v_lshl_add_u32 v4, v150, 2, v4
  s_and_b32 s46, s42, 1
  s_lshl_b32 s46, s46, 7
  v_xor_b32 v4, s46, v4
  s_lshl_b32 s46, s42, 8
  s_add_u32 s46, s46, 122880
  v_add_u32 v4, s46, v4
  s_lshl_b32 s46, s45, 8
  s_lshl_b32 s47, s42, 14
  s_add_u32 s47, s47, s46
  v_lshl_add_u32 v8, v151, 16, v8
  v_add_u32 v8, s47, v8
  v_lshlrev_b32 v5, 8, v149
  v_and_b32 v150, 1, v149
  v_lshl_add_u32 v5, v150, 7, v5
  v_lshl_add_u32 v5, v148, 3, v5
  v_xor_b32 v6, 0x80, v5
  v_add_u32 v5, 122880, v5
  v_add_u32 v6, 122880, v6
  s_lshl_b32 s46, s45, 7
  s_lshl_b32 s47, s42, 2
  s_add_u32 s47, s47, s46
  s_add_u32 s47, s47, 1064960
  v_mov_b32 v15, s47
  s_mov_b32 s52, 0
  s_mov_b32 s58, 0
  s_mov_b32 s54, 0
  s_mov_b32 s100, 0
va_loop:
  s_add_u32 s53, s52, 1
  s_lshl_b32 s56, s58, 2
  s_add_u32 s56, s56, s43
  s_lshl_b32 s56, s56, 16
  s_add_u32 s56, s56, s3
  s_add_u32 s56, s56, 12582912
  s_lshl_b32 s66, s54, 21
  s_mul_i32 s46, s58, 655360
  s_add_u32 s66, s66, s46
  s_add_u32 s66, s66, s3
  s_add_u32 s66, s66, 4194304
  s_lshr_b32 s46, s66, 8
  s_and_b32 s46, s46, 0x2000
  s_xor_b32 s66, s66, s46
  v_add_u32 v11, s56, v1
  s_mov_b64 s[16:17], -1
  s_mov_b32 s71, 0
  ds_read_b128 v[56:59], v2 offset:0
  ds_read_b128 v[60:63], v2 offset:4096
  ds_read_b128 v[64:67], v2 offset:8192
  ds_read_b128 v[68:71], v2 offset:12288
  ds_read_b128 v[72:75], v2 offset:16384
  ds_read_b128 v[76:79], v2 offset:20480
  ds_read_b128 v[80:83], v2 offset:24576
  ds_read_b128 v[84:87], v2 offset:28672
  ds_read_b128 v[88:91], v2 offset:32768
  ds_read_b128 v[92:95], v2 offset:36864
  ds_read_b128 v[96:99], v2 offset:40960
  ds_read_b128 v[100:103], v2 offset:45056
  v_mov_b32 v104, 0
  v_mov_b32 v105, 0
  v_mov_b32 v106, 0
  v_mov_b32 v107, 0
  v_mov_b32 v108, 0
  v_mov_b32 v109, 0
  v_mov_b32 v110, 0
  v_mov_b32 v111, 0
  v_mov_b32 v112, 0
  v_mov_b32 v113, 0
  v_mov_b32 v114, 0
  v_mov_b32 v115, 0
  v_mov_b32 v128, 0
  v_mov_b32 v129, 0
  v_mov_b32 v130, 0
  v_mov_b32 v131, 0
  v_mov_b32 v132, 0
  v_mov_b32 v133, 0
  v_mov_b32 v134, 0
  v_mov_b32 v135, 0
  v_mov_b32 v136, 0
  v_mov_b32 v137, 0
  v_mov_b32 v138, 0
  v_mov_b32 v139, 0
  v_mov_b32 v140, 0
  v_mov_b32 v141, 0
  v_mov_b32 v142, 0
  v_mov_b32 v143, 0
  v_mov_b32 v144, 0
  v_mov_b32 v145, 0
  v_mov_b32 v146, 0
  v_mov_b32 v147, 0
  s_cmp_lg_u32 s42, 3
  s_cbranch_scc1 va_nobell
  s_mov_b32 s50, 0
  s_mov_b64 exec, 15
  buffer_load_dword v116, v10, s[8:11], 0 offen sc1
  s_nop 11
  buffer_load_dword v117, v10, s[8:11], 0 offen sc1
  s_nop 11
  buffer_load_dword v118, v10, s[8:11], 0 offen sc1
  s_nop 11
  buffer_load_dword v119, v10, s[8:11], 0 offen sc1
  s_nop 11
  buffer_load_dword v120, v10, s[8:11], 0 offen sc1
  s_nop 11
  buffer_load_dword v121, v10, s[8:11], 0 offen sc1
  s_nop 11
  buffer_load_dword v122, v10, s[8:11], 0 offen sc1
  s_nop 11
  buffer_load_dword v123, v10, s[8:11], 0 offen sc1
  s_nop 11
  buffer_load_dword v124, v10, s[8:11], 0 offen sc1
  s_nop 11
bell_25:
  buffer_load_dword v125, v10, s[8:11], 0 offen sc1
  s_waitcnt vmcnt(9)
  v_cmp_gt_u32 vcc, s53, v116
  s_cbranch_vccz bell_x_26
  s_nop 7
  buffer_load_dword v116, v10, s[8:11], 0 offen sc1
  s_waitcnt vmcnt(9)
  v_cmp_gt_u32 vcc, s53, v117
  s_cbranch_vccz bell_x_26
  s_nop 7
  buffer_load_dword v117, v10, s[8:11], 0 offen sc1
  s_waitcnt vmcnt(9)
  v_cmp_gt_u32 vcc, s53, v118
  s_cbranch_vccz bell_x_26
  s_nop 7
  buffer_load_dword v118, v10, s[8:11], 0 offen sc1
  s_waitcnt vmcnt(9)
  v_cmp_gt_u32 vcc, s53, v119
  s_cbranch_vccz bell_x_26
  s_nop 7
  buffer_load_dword v119, v10, s[8:11], 0 offen sc1
  s_waitcnt vmcnt(9)
  v_cmp_gt_u32 vcc, s53, v120
  s_cbranch_vccz bell_x_26
  s_nop 7
  buffer_load_dword v120, v10, s[8:11], 0 offen sc1
  s_waitcnt vmcnt(9)
  v_cmp_gt_u32 vcc, s53, v121
  s_cbranch_vccz bell_x_26
  s_nop 7
  buffer_load_dword v121, v10, s[8:11], 0 offen sc1
  s_waitcnt vmcnt(9)
  v_cmp_gt_u32 vcc, s53, v122
  s_cbranch_vccz bell_x_26
  s_nop 7
  buffer_load_dword v122, v10, s[8:11], 0 offen sc1
  s_waitcnt vmcnt(9)
  v_cmp_gt_u32 vcc, s53, v123
  s_cbranch_vccz bell_x_26
  s_nop 7
  buffer_load_dword v123, v10, s[8:11], 0 offen sc1
  s_waitcnt vmcnt(9)
  v_cmp_gt_u32 vcc, s53, v124
  s_cbranch_vccz bell_x_26
  s_nop 7
  buffer_load_dword v124, v10, s[8:11], 0 offen sc1
  s_waitcnt vmcnt(9)
  v_cmp_gt_u32 vcc, s53, v125
  s_cbranch_vccz bell_x_26
  s_add_u32 s50, s50, 1
  s_cmp_gt_u32 s50, 131072
  s_cbranch_scc1 L_fail
  s_branch bell_25
bell_x_26:
  s_mov_b64 exec, -1
va_nobell:
  s_mov_b32 s50, 0
va_top:
  s_add_u32 m0, s51, 126976
  s_waitcnt lgkmcnt(0)
  s_barrier
  buffer_load_dwordx4 v11, s[8:11], s31 offen sc1 lds
  s_add_u32 m0, s51, 131072
  s_barrier
  buffer_load_dwordx4 v[16:19], v11, s[8:11], 0 offen offset:0 sc1
  s_barrier
  buffer_load_dwordx4 v11, s[8:11], s32 offen sc1 lds
  s_add_u32 m0, s51, 135168
  s_nop 0
  buffer_load_dwordx4 v11, s[8:11], s33 offen sc1 lds
  s_waitcnt vmcnt(3)
  s_barrier
  ds_read_b128 v[20:23], v9 offset:0
  ds_read_b128 v[24:27], v9 offset:1024
  ds_read_b128 v[28:31], v9 offset:2048
  ds_read_b128 v[32:35], v9 offset:3072
  s_waitcnt vmcnt(2)
va_go:
  v_smfmac_f32_16x16x64_bf16 v[104:107], v[16:19], a[0:7], v7
  v_cmp_eq_u32 vcc, -1, v16
  v_smfmac_f32_16x16x64_bf16 v[108:111], v[16:19], a[8:15], v7
  v_smfmac_f32_16x16x64_bf16 v[112:115], v[16:19], a[16:23], v7
  s_cbranch_vccnz va_ha
  s_waitcnt lgkmcnt(3)
  v_smfmac_f32_16x16x64_bf16 v[104:107], v[20:23], a[24:31], v7
  v_smfmac_f32_16x16x64_bf16 v[108:111], v[20:23], a[32:39], v7
  s_waitcnt vmcnt(0)
  s_barrier
  ds_read_b128 v[36:39], v9 offset:4096
  v_smfmac_f32_16x16x64_bf16 v[112:115], v[20:23], a[40:47], v7
  ds_read_b128 v[40:43], v9 offset:5120
  s_waitcnt lgkmcnt(2)
  v_smfmac_f32_16x16x64_bf16 v[104:107], v[24:27], v[56:63], v7
  ds_read_b128 v[44:47], v9 offset:6144
  v_smfmac_f32_16x16x64_bf16 v[108:111], v[24:27], v[64:71], v7
  ds_read_b128 v[48:51], v9 offset:7168
  v_smfmac_f32_16x16x64_bf16 v[112:115], v[24:27], v[72:79], v7
  ds_read_b128 v[52:55], v9 offset:8192
  v_smfmac_f32_16x16x64_bf16 v[104:107], v[28:31], a[48:55], v7
  ds_read_b128 v[56:59], v2 offset:49152
  v_smfmac_f32_16x16x64_bf16 v[108:111], v[28:31], a[56:63], v7
  ds_read_b128 v[60:63], v2 offset:53248
  v_max3_u32 v12, v20, v24, v28
  v_smfmac_f32_16x16x64_bf16 v[112:115], v[28:31], a[64:71], v7
  s_waitcnt lgkmcnt(4)
  v_max3_u32 v12, v12, v32, v36
  v_smfmac_f32_16x16x64_bf16 v[104:107], v[32:35], a[72:79], v7
  ds_read_b128 v[64:67], v2 offset:57344
  v_max3_u32 v12, v12, v40, v44
  v_smfmac_f32_16x16x64_bf16 v[108:111], v[32:35], a[80:87], v7
  s_waitcnt lgkmcnt(3)
  v_max3_u32 v12, v12, v48, v52
  v_smfmac_f32_16x16x64_bf16 v[112:115], v[32:35], a[88:95], v7
  ds_read_b128 v[68:71], v2 offset:61440
  v_cmp_eq_u32 vcc, -1, v12
  v_smfmac_f32_16x16x64_bf16 v[104:107], v[36:39], v[80:87], v7
  ds_read_b128 v[72:75], v3 offset:0
  v_mov_b32 v16, 0
  v_smfmac_f32_16x16x64_bf16 v[108:111], v[36:39], v[88:95], v7
  s_cbranch_vccnz va_hb
  v_smfmac_f32_16x16x64_bf16 v[112:115], v[36:39], v[96:103], v7
  ds_read_b128 v[76:79], v3 offset:4096
  v_mov_b32 v17, 0
  v_smfmac_f32_16x16x64_bf16 v[104:107], v[40:43], a[96:103], v7
  ds_read_b128 v[80:83], v3 offset:8192
  v_mov_b32 v18, 0
  v_smfmac_f32_16x16x64_bf16 v[108:111], v[40:43], a[104:111], v7
  ds_read_b128 v[84:87], v3 offset:12288
  v_mov_b32 v19, 0
  v_smfmac_f32_16x16x64_bf16 v[112:115], v[40:43], a[112:119], v7
  ds_read_b128 v[88:91], v3 offset:16384
  v_mov_b32 v20, 0
  v_smfmac_f32_16x16x64_bf16 v[104:107], v[44:47], a[120:127], v7
  ds_read_b128 v[92:95], v3 offset:20480
  v_mov_b32 v21, 0
  v_smfmac_f32_16x16x64_bf16 v[108:111], v[44:47], a[128:135], v7
  ds_read_b128 v[96:99], v3 offset:24576
  v_mov_b32 v22, 0
  v_smfmac_f32_16x16x64_bf16 v[112:115], v[44:47], a[136:143], v7
  ds_read_b128 v[100:103], v3 offset:28672
  s_waitcnt lgkmcnt(5)
  v_mov_b32 v23, 0
  v_smfmac_f32_16x16x64_bf16 v[104:107], v[48:51], v[56:63], v7
  v_mov_b32 v24, 0
  v_smfmac_f32_16x16x64_bf16 v[108:111], v[48:51], v[64:71], v7
  v_mov_b32 v25, 0
  v_smfmac_f32_16x16x64_bf16 v[112:115], v[48:51], v[72:79], v7
  v_mov_b32 v26, 0
  v_smfmac_f32_16x16x64_bf16 v[104:107], v[52:55], a[144:151], v7
  v_mov_b32 v27, 0
  v_smfmac_f32_16x16x64_bf16 v[108:111], v[52:55], a[152:159], v7
  v_mov_b32 v28, 0
  v_smfmac_f32_16x16x64_bf16 v[112:115], v[52:55], a[160:167], v7
  v_mov_b32 v29, 0
va_join:
  v_add_f32 v104, v104, v106
  v_add_f32 v105, v105, v107
  v_cmp_u_f32 vcc, v104, v105
  v_cvt_pk_bf16_f32 v106, v104, v105
  s_nop 0
  v_add_f32 v108, v108, v110
  v_add_f32 v109, v109, v111
  v_cvt_pk_bf16_f32 v110, v108, v109
  v_add_f32 v112, v112, v114
  v_add_f32 v113, v113, v115
  v_cvt_pk_bf16_f32 v114, v112, v113
  s_and_b64 vcc, vcc, s[16:17]
  s_cbranch_scc1 va_redo
  ds_write_b32 v4, v106 offset:0
  ds_write_b32 v4, v110 offset:1024
  ds_write_b32 v4, v114 offset:2048
  v_mov_b32 v30, 0
  v_mov_b32 v31, 0
  s_waitcnt lgkmcnt(0)
  s_barrier
  ds_read_b64_tr_b16 v[116:117], v5 offset:0
  ds_read_b64_tr_b16 v[118:119], v6 offset:0
  ds_read_b64_tr_b16 v[120:121], v5 offset:1024
  ds_read_b64_tr_b16 v[122:123], v6 offset:1024
  ds_read_b64_tr_b16 v[124:125], v5 offset:2048
  ds_read_b64_tr_b16 v[126:127], v6 offset:2048
  s_waitcnt lgkmcnt(4)
  v_smfmac_f32_16x16x64_bf16 v[128:131], v[116:119], a[168:175], v7
  s_waitcnt lgkmcnt(2)
  v_mov_b32 v32, 0
  v_smfmac_f32_16x16x64_bf16 v[128:131], v[120:123], a[176:183], v7
  s_waitcnt lgkmcnt(0)
  v_mov_b32 v33, 0
  v_smfmac_f32_16x16x64_bf16 v[128:131], v[124:127], a[184:191], v7
  ds_read_b128 v[56:59], v3 offset:32768
  v_mov_b32 v34, 0
  v_smfmac_f32_16x16x64_bf16 v[132:135], v[116:119], a[192:199], v7
  ds_read_b128 v[60:63], v3 offset:36864
  v_mov_b32 v35, 0
  v_smfmac_f32_16x16x64_bf16 v[132:135], v[120:123], a[200:207], v7
  ds_read_b128 v[64:67], v3 offset:40960
  v_add_f32 v128, v128, v130
  v_smfmac_f32_16x16x64_bf16 v[132:135], v[124:127], a[208:215], v7
  ds_read_b128 v[68:71], v3 offset:45056
  v_add_f32 v129, v129, v131
  v_smfmac_f32_16x16x64_bf16 v[136:139], v[116:119], a[216:223], v7
  ds_read_b128 v[72:75], v3 offset:49152
  v_cvt_pk_bf16_f32 v130, v128, v129
  v_smfmac_f32_16x16x64_bf16 v[136:139], v[120:123], a[224:231], v7
  ds_read_b128 v[76:79], v3 offset:53248
  v_add_f32 v132, v132, v134
  v_smfmac_f32_16x16x64_bf16 v[136:139], v[124:127], a[232:239], v7
  s_add_u32 s46, s66, 0
  v_add_f32 v133, v133, v135
  v_smfmac_f32_16x16x64_bf16 v[140:143], v[116:119], a[240:247], v7
  v_cvt_pk_bf16_f32 v131, v132, v133
  v_smfmac_f32_16x16x64_bf16 v[140:143], v[120:123], a[248:255], v7
  v_add_f32 v136, v136, v138
  v_smfmac_f32_16x16x64_bf16 v[140:143], v[124:127], v[152:159], v7
  v_permlane16_swap_b32 v130, v131
  v_add_f32 v137, v137, v139
  v_smfmac_f32_16x16x64_bf16 v[144:147], v[116:119], v[80:87], v7
  buffer_store_dwordx2 v[130:131], v8, s[8:11], s46 offen sc1
  v_cvt_pk_bf16_f32 v138, v136, v137
  v_smfmac_f32_16x16x64_bf16 v[144:147], v[120:123], v[88:95], v7
  v_add_f32 v140, v140, v142
  v_smfmac_f32_16x16x64_bf16 v[144:147], v[124:127], v[96:103], v7
  s_add_u32 s46, s66, 131072
  v_add_f32 v141, v141, v143
  v_smfmac_f32_16x16x64_bf16 v[16:19], v[116:119], v[160:167], v7
  v_cvt_pk_bf16_f32 v139, v140, v141
  v_smfmac_f32_16x16x64_bf16 v[16:19], v[120:123], v[168:175], v7
  v_add_f32 v144, v144, v146
  v_smfmac_f32_16x16x64_bf16 v[16:19], v[124:127], v[176:183], v7
  v_permlane16_swap_b32 v138, v139
  v_add_f32 v145, v145, v147
  v_smfmac_f32_16x16x64_bf16 v[20:23], v[116:119], v[184:191], v7
  buffer_store_dwordx2 v[138:139], v8, s[8:11], s46 offen sc1
  v_cvt_pk_bf16_f32 v146, v144, v145
  v_smfmac_f32_16x16x64_bf16 v[20:23], v[120:123], v[192:199], v7
  v_add_f32 v16, v16, v18
  v_smfmac_f32_16x16x64_bf16 v[20:23], v[124:127], v[200:207], v7
  s_add_u32 s46, s66, 262144
  v_add_f32 v17, v17, v19
  v_smfmac_f32_16x16x64_bf16 v[24:27], v[116:119], v[208:215], v7
  v_cvt_pk_bf16_f32 v147, v16, v17
  v_smfmac_f32_16x16x64_bf16 v[24:27], v[120:123], v[216:223], v7
  v_add_f32 v20, v20, v22
  v_smfmac_f32_16x16x64_bf16 v[24:27], v[124:127], v[224:231], v7
  s_waitcnt lgkmcnt(0)
  v_permlane16_swap_b32 v146, v147
  v_add_f32 v21, v21, v23
  v_smfmac_f32_16x16x64_bf16 v[28:31], v[116:119], v[56:63], v7
  buffer_store_dwordx2 v[146:147], v8, s[8:11], s46 offen sc1
  v_cvt_pk_bf16_f32 v22, v20, v21
  v_smfmac_f32_16x16x64_bf16 v[28:31], v[120:123], v[64:71], v7
  v_add_f32 v24, v24, v26
  v_smfmac_f32_16x16x64_bf16 v[28:31], v[124:127], v[72:79], v7
  s_add_u32 s46, s66, 393216
  v_add_f32 v25, v25, v27
  v_smfmac_f32_16x16x64_bf16 v[32:35], v[116:119], v[232:239], v7
  v_cvt_pk_bf16_f32 v23, v24, v25
  v_smfmac_f32_16x16x64_bf16 v[32:35], v[120:123], v[240:247], v7
  v_add_f32 v28, v28, v30
  v_smfmac_f32_16x16x64_bf16 v[32:35], v[124:127], v[248:255], v7
  v_permlane16_swap_b32 v22, v23
  buffer_store_dwordx2 v[22:23], v8, s[8:11], s46 offen sc1
  v_add_f32 v29, v29, v31
  v_cvt_pk_bf16_f32 v30, v28, v29
  s_nop 3
  v_add_f32 v32, v32, v34
  v_add_f32 v33, v33, v35
  s_add_u32 s46, s66, 524288
  v_cvt_pk_bf16_f32 v31, v32, v33
  s_nop 1
  v_permlane16_swap_b32 v30, v31
  buffer_store_dwordx2 v[30:31], v8, s[8:11], s46 offen sc1
  s_add_u32 s58, s58, 1
  s_cmp_eq_u32 s58, 3
  s_cselect_b32 s58, 0, s58
  s_cmp_eq_u32 s58, 0
  s_addc_u32 s54, s54, 0
  s_cmp_eq_u32 s54, 3
  s_cselect_b32 s54, 0, s54
  s_mov_b32 s52, s53
  s_cmp_lt_u32 s52, 64
  s_cbranch_scc1 va_loop
  s_waitcnt vmcnt(0)
  v_mov_b32 v148, s52
  s_mov_b64 exec, 1
  buffer_store_dword v148, v15, s[8:11], 0 offen sc1
  s_mov_b64 exec, -1
  s_endpgm
va_ha:
  s_waitcnt lgkmcnt(0)
  ds_read_b128 v[56:59], v2 offset:0
  ds_read_b128 v[60:63], v2 offset:4096
  ds_read_b128 v[64:67], v2 offset:8192
  ds_read_b128 v[68:71], v2 offset:12288
  ds_read_b128 v[72:75], v2 offset:16384
  ds_read_b128 v[76:79], v2 offset:20480
  ds_read_b128 v[80:83], v2 offset:24576
  ds_read_b128 v[84:87], v2 offset:28672
  ds_read_b128 v[88:91], v2 offset:32768
  ds_read_b128 v[92:95], v2 offset:36864
  ds_read_b128 v[96:99], v2 offset:40960
  ds_read_b128 v[100:103], v2 offset:45056
  v_mov_b32 v104, 0
  v_mov_b32 v105, 0
  v_mov_b32 v106, 0
  v_mov_b32 v107, 0
  v_mov_b32 v108, 0
  v_mov_b32 v109, 0
  v_mov_b32 v110, 0
  v_mov_b32 v111, 0
  v_mov_b32 v112, 0
  v_mov_b32 v113, 0
  v_mov_b32 v114, 0
  v_mov_b32 v115, 0
  v_mov_b32 v128, 0
  v_mov_b32 v129, 0
  v_mov_b32 v130, 0
  v_mov_b32 v131, 0
  v_mov_b32 v132, 0
  v_mov_b32 v133, 0
  v_mov_b32 v134, 0
  v_mov_b32 v135, 0
  v_mov_b32 v136, 0
  v_mov_b32 v137, 0
  v_mov_b32 v138, 0
  v_mov_b32 v139, 0
  v_mov_b32 v140, 0
  v_mov_b32 v141, 0
  v_mov_b32 v142, 0
  v_mov_b32 v143, 0
  v_mov_b32 v144, 0
  v_mov_b32 v145, 0
  v_mov_b32 v146, 0
  v_mov_b32 v147, 0
va_ra:
  buffer_load_dwordx4 v[16:19], v11, s[8:11], 0 offen offset:0 sc1
  s_add_u32 s50, s50, 1
  s_cmp_gt_u32 s50, 131072
  s_cbranch_scc1 L_fail
  s_waitcnt vmcnt(0) lgkmcnt(0)
  v_cmp_eq_u32 vcc, -1, v16
  s_cbranch_vccnz va_ra
  s_branch va_go
va_hb:
  s_waitcnt lgkmcnt(0)
  s_add_u32 s50, s50, 1
  s_cmp_gt_u32 s50, 131072
  s_cbranch_scc1 L_fail
  ds_read_b128 v[56:59], v2 offset:0
  ds_read_b128 v[60:63], v2 offset:4096
  ds_read_b128 v[64:67], v2 offset:8192
  ds_read_b128 v[68:71], v2 offset:12288
  ds_read_b128 v[72:75], v2 offset:16384
  ds_read_b128 v[76:79], v2 offset:20480
  ds_read_b128 v[80:83], v2 offset:24576
  ds_read_b128 v[84:87], v2 offset:28672
  ds_read_b128 v[88:91], v2 offset:32768
  ds_read_b128 v[92:95], v2 offset:36864
  ds_read_b128 v[96:99], v2 offset:40960
  ds_read_b128 v[100:103], v2 offset:45056
  v_mov_b32 v104, 0
  v_mov_b32 v105, 0
  v_mov_b32 v106, 0
  v_mov_b32 v107, 0
  v_mov_b32 v108, 0
  v_mov_b32 v109, 0
  v_mov_b32 v110, 0
  v_mov_b32 v111, 0
  v_mov_b32 v112, 0
  v_mov_b32 v113, 0
  v_mov_b32 v114, 0
  v_mov_b32 v115, 0
  v_mov_b32 v128, 0
  v_mov_b32 v129, 0
  v_mov_b32 v130, 0
  v_mov_b32 v131, 0
  v_mov_b32 v132, 0
  v_mov_b32 v133, 0
  v_mov_b32 v134, 0
  v_mov_b32 v135, 0
  v_mov_b32 v136, 0
  v_mov_b32 v137, 0
  v_mov_b32 v138, 0
  v_mov_b32 v139, 0
  v_mov_b32 v140, 0
  v_mov_b32 v141, 0
  v_mov_b32 v142, 0
  v_mov_b32 v143, 0
  v_mov_b32 v144, 0
  v_mov_b32 v145, 0
  v_mov_b32 v146, 0
  v_mov_b32 v147, 0
  s_branch va_top
va_redo:
  s_waitcnt lgkmcnt(0)
  s_mov_b32 s50, 0
va_poll:
  buffer_load_dwordx4 v[16:19], v11, s[8:11], 0 offen offset:0 sc1
  buffer_load_dwordx4 v[20:23], v11, s[8:11], 0 offen offset:1024 sc1
  buffer_load_dwordx4 v[24:27], v11, s[8:11], 0 offen offset:2048 sc1
  buffer_load_dwordx4 v[28:31], v11, s[8:11], 0 offen offset:3072 sc1
  buffer_load_dwordx4 v[32:35], v11, s[8:11], s24 offen offset:0 sc1
  buffer_load_dwordx4 v[36:39], v11, s[8:11], s24 offen offset:1024 sc1
  buffer_load_dwordx4 v[40:43], v11, s[8:11], s24 offen offset:2048 sc1
  buffer_load_dwordx4 v[44:47], v11, s[8:11], s24 offen offset:3072 sc1
  buffer_load_dwordx4 v[48:51], v11, s[8:11], s25 offen offset:0 sc1
  buffer_load_dwordx4 v[52:55], v11, s[8:11], s25 offen offset:1024 sc1
  s_add_u32 s50, s50, 1
  s_cmp_gt_u32 s50, 131072
  s_cbranch_scc1 L_fail
  s_waitcnt vmcnt(0) lgkmcnt(0)
  v_max_u32 v12, v16, v17
  v_max3_u32 v12, v18, v19, v12
  v_max3_u32 v12, v20, v21, v12
  v_max3_u32 v12, v22, v23, v12
  v_max3_u32 v12, v24, v25, v12
  v_max3_u32 v12, v26, v27, v12
  v_max3_u32 v12, v28, v29, v12
  v_max3_u32 v12, v30, v31, v12
  v_max3_u32 v12, v32, v33, v12
  v_max3_u32 v12, v34, v35, v12
  v_max3_u32 v12, v36, v37, v12
  v_max3_u32 v12, v38, v39, v12
  v_max3_u32 v12, v40, v41, v12
  v_max3_u32 v12, v42, v43, v12
  v_max3_u32 v12, v44, v45, v12
  v_max3_u32 v12, v46, v47, v12
  v_max3_u32 v12, v48, v49, v12
  v_max3_u32 v12, v50, v51, v12
  v_max3_u32 v12, v52, v53, v12
  v_max3_u32 v12, v54, v55, v12
  v_cmp_eq_u32 vcc, -1, v12
  s_cbranch_vccnz va_poll
  s_mov_b64 s[16:17], 0
  ds_read_b128 v[56:59], v2 offset:0
  ds_read_b128 v[60:63], v2 offset:4096
  ds_read_b128 v[64:67], v2 offset:8192
  ds_read_b128 v[68:71], v2 offset:12288
  ds_read_b128 v[72:75], v2 offset:16384
  ds_read_b128 v[76:79], v2 offset:20480
  ds_read_b128 v[80:83], v2 offset:24576
  ds_read_b128 v[84:87], v2 offset:28672
  ds_read_b128 v[88:91], v2 offset:32768
  ds_read_b128 v[92:95], v2 offset:36864
  ds_read_b128 v[96:99], v2 offset:40960
  ds_read_b128 v[100:103], v2 offset:45056
  v_mov_b32 v104, 0
  v_mov_b32 v105, 0
  v_mov_b32 v106, 0
  v_mov_b32 v107, 0
  v_mov_b32 v108, 0
  v_mov_b32 v109, 0
  v_mov_b32 v110, 0
  v_mov_b32 v111, 0
  v_mov_b32 v112, 0
  v_mov_b32 v113, 0
  v_mov_b32 v114, 0
  v_mov_b32 v115, 0
  v_mov_b32 v128, 0
  v_mov_b32 v129, 0
  v_mov_b32 v130, 0
  v_mov_b32 v131, 0
  v_mov_b32 v132, 0
  v_mov_b32 v133, 0
  v_mov_b32 v134, 0
  v_mov_b32 v135, 0
  v_mov_b32 v136, 0
  v_mov_b32 v137, 0
  v_mov_b32 v138, 0
  v_mov_b32 v139, 0
  v_mov_b32 v140, 0
  v_mov_b32 v141, 0
  v_mov_b32 v142, 0
  v_mov_b32 v143, 0
  v_mov_b32 v144, 0
  v_mov_b32 v145, 0
  v_mov_b32 v146, 0
  v_mov_b32 v147, 0
  s_waitcnt lgkmcnt(0)
  v_smfmac_f32_16x16x64_bf16 v[104:107], v[16:19], a[0:7], v7
  v_smfmac_f32_16x16x64_bf16 v[108:111], v[16:19], a[8:15], v7
  v_smfmac_f32_16x16x64_bf16 v[112:115], v[16:19], a[16:23], v7
  v_smfmac_f32_16x16x64_bf16 v[104:107], v[20:23], a[24:31], v7
  v_smfmac_f32_16x16x64_bf16 v[108:111], v[20:23], a[32:39], v7
  v_smfmac_f32_16x16x64_bf16 v[112:115], v[20:23], a[40:47], v7
  v_smfmac_f32_16x16x64_bf16 v[104:107], v[24:27], v[56:63], v7
  v_smfmac_f32_16x16x64_bf16 v[108:111], v[24:27], v[64:71], v7
  v_smfmac_f32_16x16x64_bf16 v[112:115], v[24:27], v[72:79], v7
  v_smfmac_f32_16x16x64_bf16 v[104:107], v[28:31], a[48:55], v7
  ds_read_b128 v[56:59], v2 offset:49152
  v_smfmac_f32_16x16x64_bf16 v[108:111], v[28:31], a[56:63], v7
  ds_read_b128 v[60:63], v2 offset:53248
  v_smfmac_f32_16x16x64_bf16 v[112:115], v[28:31], a[64:71], v7
  v_smfmac_f32_16x16x64_bf16 v[104:107], v[32:35], a[72:79], v7
  ds_read_b128 v[64:67], v2 offset:57344
  v_smfmac_f32_16x16x64_bf16 v[108:111], v[32:35], a[80:87], v7
  v_smfmac_f32_16x16x64_bf16 v[112:115], v[32:35], a[88:95], v7
  ds_read_b128 v[68:71], v2 offset:61440
  v_smfmac_f32_16x16x64_bf16 v[104:107], v[36:39], v[80:87], v7
  ds_read_b128 v[72:75], v3 offset:0
  v_mov_b32 v16, 0
  v_smfmac_f32_16x16x64_bf16 v[108:111], v[36:39], v[88:95], v7
  v_smfmac_f32_16x16x64_bf16 v[112:115], v[36:39], v[96:103], v7
  ds_read_b128 v[76:79], v3 offset:4096
  v_mov_b32 v17, 0
  v_smfmac_f32_16x16x64_bf16 v[104:107], v[40:43], a[96:103], v7
  ds_read_b128 v[80:83], v3 offset:8192
  v_mov_b32 v18, 0
  v_smfmac_f32_16x16x64_bf16 v[108:111], v[40:43], a[104:111], v7
  ds_read_b128 v[84:87], v3 offset:12288
  v_mov_b32 v19, 0
  v_smfmac_f32_16x16x64_bf16 v[112:115], v[40:43], a[112:119], v7
  ds_read_b128 v[88:91], v3 offset:16384
  v_mov_b32 v20, 0
  v_smfmac_f32_16x16x64_bf16 v[104:107], v[44:47], a[120:127], v7
  ds_read_b128 v[92:95], v3 offset:20480
  v_mov_b32 v21, 0
  v_smfmac_f32_16x16x64_bf16 v[108:111], v[44:47], a[128:135], v7
  ds_read_b128 v[96:99], v3 offset:24576
  v_mov_b32 v22, 0
  v_smfmac_f32_16x16x64_bf16 v[112:115], v[44:47], a[136:143], v7
  ds_read_b128 v[100:103], v3 offset:28672
  s_waitcnt lgkmcnt(5)
  v_mov_b32 v23, 0
  v_smfmac_f32_16x16x64_bf16 v[104:107], v[48:51], v[56:63], v7
  v_mov_b32 v24, 0
  v_smfmac_f32_16x16x64_bf16 v[108:111], v[48:51], v[64:71], v7
  v_mov_b32 v25, 0
  v_smfmac_f32_16x16x64_bf16 v[112:115], v[48:51], v[72:79], v7
  v_mov_b32 v26, 0
  v_smfmac_f32_16x16x64_bf16 v[104:107], v[52:55], a[144:151], v7
  v_mov_b32 v27, 0
  v_smfmac_f32_16x16x64_bf16 v[108:111], v[52:55], a[152:159], v7
  v_mov_b32 v28, 0
  v_smfmac_f32_16x16x64_bf16 v[112:115], v[52:55], a[160:167], v7
  v_mov_b32 v29, 0
  s_waitcnt lgkmcnt(0)
  s_branch va_join
L_owner:
  s_cmp_ge_u32 s42, 2
  s_cbranch_scc1 L_end
  s_mul_i32 s62, s43, 10
  s_add_u32 s62, s62, s44
  s_sub_u32 s62, s62, 16
  s_mov_b32 s12, s24
  s_mov_b32 s13, s25
  s_mov_b32 s14, 10240
  s_mov_b32 s15, 0x20000
  v_mov_b32 v20, -1
  v_mov_b32 v24, 0
  v_mov_b32 v21, -1
  v_mov_b32 v25, 0
  v_mov_b32 v22, -1
  v_mov_b32 v26, 0
  v_mov_b32 v23, -1
  v_mov_b32 v27, 0
  s_lshl_b32 s48, s42, 13
  s_lshl_b32 s46, s62, 8
  s_cmp_ge_u32 s62, 32
  s_cselect_b32 s47, 40960, 0
  s_add_u32 s46, s46, s47
  s_add_u32 s46, s46, s48
  s_add_u32 s46, s46, 12582912
  v_and_b32 v13, 15, v0
  v_lshlrev_b32 v13, 4, v13
  v_lshrrev_b32 v12, 4, v0
  v_lshl_add_u32 v13, v12, 16, v13
  buffer_store_dwordx4 v[20:23], v13, s[8:11], s46 offen sc1
  s_add_u32 s46, s46, 262144
  buffer_store_dwordx4 v[20:23], v13, s[8:11], s46 offen sc1
  s_add_u32 s46, s46, 262144
  buffer_store_dwordx4 v[20:23], v13, s[8:11], s46 offen sc1
  s_add_u32 s46, s46, 262144
  s_lshl_b32 s46, s62, 9
  s_cmp_ge_u32 s62, 16
  s_cselect_b32 s47, 8192, 0
  s_add_u32 s46, s46, s47
  s_cmp_ge_u32 s62, 32
  s_cselect_b32 s47, 10240, 0
  s_add_u32 s46, s46, s47
  s_add_u32 s46, s46, s48
  s_add_u32 s46, s46, 12599296
  v_lshlrev_b32 v13, 3, v0
  buffer_store_dwordx2 v[20:21], v13, s[8:11], s46 offen sc1
  s_add_u32 s46, s46, 262144
  buffer_store_dwordx2 v[20:21], v13, s[8:11], s46 offen sc1
  s_add_u32 s46, s46, 262144
  buffer_store_dwordx2 v[20:21], v13, s[8:11], s46 offen sc1
  s_add_u32 s46, s46, 262144
  v_min_u32 v13, 4, v0
  v_lshlrev_b32 v13, 7, v13
  s_lshl_b32 s46, s62, 1
  s_add_u32 s46, s46, s42
  s_mul_i32 s46, s46, 640
  s_add_u32 s46, s46, 1048576
  buffer_store_dwordx4 v[24:27], v13, s[8:11], s46 offen sc1
  s_lshl_b32 s46, s62, 7
  s_add_u32 s46, s46, s48
  s_add_u32 s46, s46, 13369344
  buffer_store_dword v24, v24, s[8:11], s46 offen sc1
  v_mov_b32 v13, 192
  v_mov_b32 v14, 1
  s_waitcnt vmcnt(0)
  s_barrier
  s_cmp_lg_u32 s42, 0
  s_cbranch_scc1 ow_notlast
  s_mov_b64 exec, 1
  global_atomic_add v12, v13, v14, s[38:39] sc0 sc1
  s_waitcnt vmcnt(0)
  v_readfirstlane_b32 s46, v12
  s_nop 0
  s_cmp_lg_u32 s46, 39
  s_cbranch_scc1 ow_notlast
  v_mov_b32 v13, 8
  global_store_dword v13, v14, s[38:39] sc1
ow_notlast:
  s_mov_b64 exec, -1
  v_and_b32 v11, 3, v0
  v_lshlrev_b32 v11, 2, v11
  s_mov_b32 s50, 0
ss_27:
  global_load_dword v10, v11, s[38:39] sc1
  s_add_u32 s50, s50, 1
  s_cmp_gt_u32 s50, 131072
  s_cbranch_scc1 L_fail
  s_waitcnt vmcnt(0)
  v_readlane_b32 s46, v10, 0
  v_readlane_b32 s47, v10, 2
  v_readlane_b32 s48, v10, 1
  s_nop 0
  s_min_u32 s47, s47, s48
  s_cmp_lg_u32 s46, 0
  s_cselect_b32 s48, 7, 0
  s_add_u32 s46, s46, s2
  s_xor_b32 s49, s46, s43
  s_and_b32 s49, s49, s48
  s_cbranch_scc1 L_reroll
  s_cmp_lg_u32 s47, 0
  s_cbranch_scc1 ss_ok_28
  s_sleep 6
  s_branch ss_27
ss_ok_28:
  v_readlane_b32 s3, v10, 1
  s_nop 0
  s_and_b32 s3, s3, 0x2000
  v_and_b32 v10, 3, v0
  s_lshl_b32 s46, s43, 9
  s_add_u32 s46, s46, s3
  s_add_u32 s46, s46, 13371392
  v_lshl_add_u32 v6, v10, 7, s46
  s_lshl_b32 s46, s43, 7
  s_add_u32 s46, s46, s3
  s_add_u32 s46, s46, 13369344
  v_lshl_add_u32 v7, v10, 9, s46
  v_mov_b32 v17, 0
  v_mov_b32 v14, 2146435072
  s_cmp_eq_u32 s44, 16
  s_cselect_b64 vcc, 15, 0
  v_cndmask_b32 v7, v14, v7, vcc
  v_lshlrev_b32 v9, 7, v0
  s_and_b32 s46, s62, 3
  s_lshl_b32 s46, s46, 2
  s_add_u32 s46, s46, 1060864
  v_add_u32 v9, s46, v9
  v_and_b32 v18, 3, v0
  v_min_u32 v18, 2, v18
  v_lshlrev_b32 v18, 8, v18
  s_mul_i32 s46, s43, 768
  s_cmp_ge_u32 s44, 21
  s_cselect_b32 s47, 128, 0
  s_add_u32 s46, s46, s47
  s_add_u32 s46, s46, 1073152
  v_add_u32 v18, s46, v18
  v_cmp_lt_u32 vcc, 31, v0
  s_nop 1
  v_cndmask_b32 v9, v9, v18, vcc
  s_cmp_eq_u32 s42, 0
  s_cbranch_scc1 ow_main
  v_mov_b32 v14, 2146435072
  s_lshl_b32 s46, s43, 7
  s_add_u32 s46, s46, s3
  s_add_u32 s46, s46, 13373440
  v_mov_b32 v19, s46
  s_lshl_b32 s46, s43, 7
  s_add_u32 s46, s46, 1077248
  v_writelane_b32 v19, s46, 1
  s_cmp_eq_u32 s44, 17
  s_cselect_b64 vcc, 3, 0
  v_cndmask_b32 v19, v14, v19, vcc
  s_barrier
  s_mov_b32 s53, 1
  v_mov_b32 v15, 0
ow_listen:
  s_add_u32 s46, s53, 2
  s_min_u32 s46, s46, 64
  v_cmp_gt_u32 vcc, s46, v15
  s_nop 0
  s_and_saveexec_b64 s[64:65], vcc
  s_cbranch_execz ow_fresh
  buffer_load_dword v15, v9, s[8:11], 0 offen sc1
ow_fresh:
  s_mov_b64 exec, -1
  s_waitcnt vmcnt(0)
  v_mov_b32 v12, v15
  s_nop 1
  v_min_u32_dpp v12, v12, v12 row_ror:8 row_mask:0xf bank_mask:0xf
  s_nop 1
  v_min_u32_dpp v12, v12, v12 row_ror:4 row_mask:0xf bank_mask:0xf
  s_nop 1
  v_min_u32_dpp v12, v12, v12 row_ror:2 row_mask:0xf bank_mask:0xf
  s_nop 1
  v_min_u32_dpp v12, v12, v12 row_ror:1 row_mask:0xf bank_mask:0xf
  v_mov_b32 v13, v12
  s_nop 1
  v_permlane16_swap_b32 v13, v12
  v_min_u32 v12, v12, v13
  v_mov_b32 v13, v12
  s_nop 1
  v_permlane32_swap_b32 v13, v12
  v_min_u32 v12, v12, v13
  ds_write_b32 v17, v12
  s_waitcnt lgkmcnt(0)
  s_add_u32 s46, s53, 1
  v_mov_b32 v16, s46
  s_mov_b32 s50, 0
  s_mov_b64 exec, 15
  buffer_load_dword v136, v6, s[8:11], 0 offen sc1
  s_nop 11
  buffer_load_dword v137, v6, s[8:11], 0 offen sc1
  s_nop 11
  buffer_load_dword v138, v6, s[8:11], 0 offen sc1
  s_nop 11
  buffer_load_dword v139, v6, s[8:11], 0 offen sc1
  s_nop 11
  buffer_load_dword v140, v6, s[8:11], 0 offen sc1
  s_nop 11
  buffer_load_dword v141, v6, s[8:11], 0 offen sc1
  s_nop 11
  buffer_load_dword v142, v6, s[8:11], 0 offen sc1
  s_nop 11
  buffer_load_dword v143, v6, s[8:11], 0 offen sc1
  s_nop 11
  buffer_load_dword v144, v6, s[8:11], 0 offen sc1
  s_nop 11
bell_29:
  buffer_load_dword v145, v6, s[8:11], 0 offen sc1
  s_waitcnt vmcnt(9)
  v_cmp_gt_u32 vcc, s53, v136
  s_cbranch_vccz bell_x_30
  s_nop 7
  buffer_load_dword v136, v6, s[8:11], 0 offen sc1
  s_waitcnt vmcnt(9)
  v_cmp_gt_u32 vcc, s53, v137
  s_cbranch_vccz bell_x_30
  s_nop 7
  buffer_load_dword v137, v6, s[8:11], 0 offen sc1
  s_waitcnt vmcnt(9)
  v_cmp_gt_u32 vcc, s53, v138
  s_cbranch_vccz bell_x_30
  s_nop 7
  buffer_load_dword v138, v6, s[8:11], 0 offen sc1
  s_waitcnt vmcnt(9)
  v_cmp_gt_u32 vcc, s53, v139
  s_cbranch_vccz bell_x_30
  s_nop 7
  buffer_load_dword v139, v6, s[8:11], 0 offen sc1
  s_waitcnt vmcnt(9)
  v_cmp_gt_u32 vcc, s53, v140
  s_cbranch_vccz bell_x_30
  s_nop 7
  buffer_load_dword v140, v6, s[8:11], 0 offen sc1
  s_waitcnt vmcnt(9)
  v_cmp_gt_u32 vcc, s53, v141
  s_cbranch_vccz bell_x_30
  s_nop 7
  buffer_load_dword v141, v6, s[8:11], 0 offen sc1
  s_waitcnt vmcnt(9)
  v_cmp_gt_u32 vcc, s53, v142
  s_cbranch_vccz bell_x_30
  s_nop 7
  buffer_load_dword v142, v6, s[8:11], 0 offen sc1
  s_waitcnt vmcnt(9)
  v_cmp_gt_u32 vcc, s53, v143
  s_cbranch_vccz bell_x_30
  s_nop 7
  buffer_load_dword v143, v6, s[8:11], 0 offen sc1
  s_waitcnt vmcnt(9)
  v_cmp_gt_u32 vcc, s53, v144
  s_cbranch_vccz bell_x_30
  s_nop 7
  buffer_load_dword v144, v6, s[8:11], 0 offen sc1
  s_waitcnt vmcnt(9)
  v_cmp_gt_u32 vcc, s53, v145
  s_cbranch_vccz bell_x_30
  s_add_u32 s50, s50, 1
  s_cmp_gt_u32 s50, 131072
  s_cbranch_scc1 L_fail
  s_branch bell_29
bell_x_30:
  s_mov_b64 exec, -1
  s_barrier
  s_sub_u32 s46, s53, 1
  v_mov_b32 v12, s46
  s_barrier
  s_sleep 0
  buffer_store_dword v12, v19, s[8:11], 0 offen sc1
  s_sleep 8
  s_add_u32 s53, s53, 1
  s_cmp_lt_u32 s53, 64
  s_cbranch_scc1 ow_listen
  s_endpgm
ow_main:
  v_mov_b32 v5, 0x44444444
  v_mov_b32 v10, 0xeeeeeeee
  v_and_b32 v11, 2, v0
  v_cmp_ne_u32 vcc, 0, v11
  s_nop 1
  v_cndmask_b32 v5, v5, v10, vcc
  v_lshlrev_b32 v1, 4, v0
  v_and_b32 v10, 15, v0
  v_lshrrev_b32 v11, 4, v0
  v_lshlrev_b32 v2, 3, v10
  v_lshl_add_u32 v2, v11, 8, v2
  v_and_b32 v13, 1, v10
  v_lshl_add_u32 v12, v11, 1, v13
  v_mov_b32 v4, 0x05040100
  v_mov_b32 v14, 0x03020706
  v_cmp_eq_u32 vcc, 1, v13
  s_nop 1
  v_cndmask_b32 v4, v4, v14, vcc
  v_and_b32 v13, 3, v10
  v_lshl_add_u32 v3, v11, 2, v13
  v_lshlrev_b32 v3, 4, v3
  v_lshrrev_b32 v13, 2, v10
  v_lshl_add_u32 v3, v13, 2, v3
  s_lshl_b32 s46, s62, 8
  s_cmp_ge_u32 s62, 32
  s_cselect_b32 s47, 40960, 0
  s_add_u32 s46, s46, s47
  s_add_u32 s46, s46, s3
  s_add_u32 s46, s46, 12582912
  v_add_u32 v3, s46, v3
  v_mul_u32_u24 v12, 1280, v12
  v_and_b32 v13, 14, v10
  v_lshl_add_u32 v12, v13, 1, v12
  s_lshl_b32 s46, s62, 5
  buffer_load_dword v15, v12, s[12:15], s46 offen
  s_lshl_b32 s63, s62, 16
  s_add_u32 s63, s63, s3
  s_add_u32 s63, s63, 81788928
  s_mov_b32 s61, 0
  s_mov_b32 s52, 0
  s_mov_b32 s58, 0
  s_mov_b32 s54, 0
  s_mov_b32 s100, 0
  s_barrier
  s_mov_b32 s49, 1
  s_cmp_ge_u32 s61, s49
  s_cbranch_scc1 wf_done_31
  s_mov_b32 s50, 0
wf_loop_32:
  buffer_load_dword v12, v18, s[8:11], 0 offen sc1
  s_add_u32 s50, s50, 1
  s_cmp_gt_u32 s50, 131072
  s_cbranch_scc1 L_fail
  s_waitcnt vmcnt(0)
  v_min_u32_dpp v12, v12, v12 row_ror:8 row_mask:0xf bank_mask:0xf
  s_nop 1
  v_min_u32_dpp v12, v12, v12 row_ror:4 row_mask:0xf bank_mask:0xf
  s_nop 1
  v_min_u32_dpp v12, v12, v12 row_ror:2 row_mask:0xf bank_mask:0xf
  s_nop 1
  v_min_u32_dpp v12, v12, v12 row_ror:1 row_mask:0xf bank_mask:0xf
  v_mov_b32 v13, v12
  s_nop 1
  v_permlane16_swap_b32 v13, v12
  v_min_u32 v12, v12, v13
  v_mov_b32 v13, v12
  s_nop 1
  v_permlane32_swap_b32 v13, v12
  v_min_u32 v12, v12, v13
  s_nop 0
  v_readfirstlane_b32 s61, v12
  s_nop 0
  s_cmp_ge_u32 s61, s49
  s_cbranch_scc1 wf_done_31
  s_sleep 2
  s_branch wf_loop_32
wf_done_31:
  s_mov_b32 s61, 0
  v_min_u32 v15, -2, v15
  s_mov_b32 s46, 0
  buffer_store_dword v15, v3, s[8:11], s46 offen sc1
  s_mov_b32 s46, 65536
  buffer_store_dword v15, v3, s[8:11], s46 offen sc1
  s_mov_b32 s46, 131072
  buffer_store_dword v15, v3, s[8:11], s46 offen sc1
  s_mov_b32 s46, 196608
  buffer_store_dword v15, v3, s[8:11], s46 offen sc1
  v_mov_b32 v16, 1
  buffer_store_dword v16, v7, s[8:11], 0 offen sc1
  s_mov_b32 s49, 1
  s_cmp_ge_u32 s61, s49
  s_cbranch_scc1 wf_done_33
  s_mov_b32 s50, 0
wf_loop_34:
  buffer_load_dword v12, v9, s[8:11], 0 offen sc1
  s_add_u32 s50, s50, 1
  s_cmp_gt_u32 s50, 131072
  s_cbranch_scc1 L_fail
  s_waitcnt vmcnt(0)
  v_min_u32_dpp v12, v12, v12 row_ror:8 row_mask:0xf bank_mask:0xf
  s_nop 1
  v_min_u32_dpp v12, v12, v12 row_ror:4 row_mask:0xf bank_mask:0xf
  s_nop 1
  v_min_u32_dpp v12, v12, v12 row_ror:2 row_mask:0xf bank_mask:0xf
  s_nop 1
  v_min_u32_dpp v12, v12, v12 row_ror:1 row_mask:0xf bank_mask:0xf
  v_mov_b32 v13, v12
  s_nop 1
  v_permlane16_swap_b32 v13, v12
  v_min_u32 v12, v12, v13
  v_mov_b32 v13, v12
  s_nop 1
  v_permlane32_swap_b32 v13, v12
  v_min_u32 v12, v12, v13
  s_nop 0
  v_readfirstlane_b32 s61, v12
  s_nop 0
  s_cmp_ge_u32 s61, s49
  s_cbranch_scc1 wf_done_33
  s_sleep 2
  s_branch wf_loop_34
wf_done_33:
  s_mov_b32 s65, s63
  s_lshr_b32 s46, s65, 8
  s_and_b32 s46, s46, 0x2000
  s_xor_b32 s65, s65, s46
  s_add_u32 s63, s63, 2621440
  s_cmp_ge_u32 s63, 165675008
  s_cselect_b32 s46, 83886080, 0
  s_sub_u32 s63, s63, s46
  s_add_u32 s46, s65, 0
  s_xor_b32 s46, s46, 0x2000
  buffer_load_dwordx4 a[0:3], v1, s[8:11], s46 offen offset:0 sc1
  buffer_load_dwordx4 a[4:7], v1, s[8:11], s46 offen offset:1024 sc1
  buffer_load_dwordx4 a[8:11], v1, s[8:11], s46 offen offset:2048 sc1
  buffer_load_dwordx4 a[12:15], v1, s[8:11], s46 offen offset:3072 sc1
  s_add_u32 s46, s65, 4096
  s_xor_b32 s46, s46, 0x2000
  buffer_load_dwordx4 a[16:19], v1, s[8:11], s46 offen offset:0 sc1
  buffer_load_dwordx4 a[20:23], v1, s[8:11], s46 offen offset:1024 sc1
  buffer_load_dwordx4 a[24:27], v1, s[8:11], s46 offen offset:2048 sc1
  buffer_load_dwordx4 a[28:31], v1, s[8:11], s46 offen offset:3072 sc1
  s_add_u32 s46, s65, 16384
  buffer_load_dwordx4 a[32:35], v1, s[8:11], s46 offen offset:0 sc1
  buffer_load_dwordx4 a[36:39], v1, s[8:11], s46 offen offset:1024 sc1
  buffer_load_dwordx4 a[40:43], v1, s[8:11], s46 offen offset:2048 sc1
  buffer_load_dwordx4 a[44:47], v1, s[8:11], s46 offen offset:3072 sc1
  s_add_u32 s46, s65, 20480
  buffer_load_dwordx4 a[48:51], v1, s[8:11], s46 offen offset:0 sc1
  buffer_load_dwordx4 a[52:55], v1, s[8:11], s46 offen offset:1024 sc1
  buffer_load_dwordx4 a[56:59], v1, s[8:11], s46 offen offset:2048 sc1
  buffer_load_dwordx4 a[60:63], v1, s[8:11], s46 offen offset:3072 sc1
  s_add_u32 s46, s65, 32768
  buffer_load_dwordx4 a[64:67], v1, s[8:11], s46 offen offset:0 sc1
  buffer_load_dwordx4 a[68:71], v1, s[8:11], s46 offen offset:1024 sc1
  buffer_load_dwordx4 a[72:75], v1, s[8:11], s46 offen offset:2048 sc1
  buffer_load_dwordx4 a[76:79], v1, s[8:11], s46 offen offset:3072 sc1
  s_add_u32 s46, s65, 36864
  buffer_load_dwordx4 a[80:83], v1, s[8:11], s46 offen offset:0 sc1
  buffer_load_dwordx4 a[84:87], v1, s[8:11], s46 offen offset:1024 sc1
  buffer_load_dwordx4 a[88:91], v1, s[8:11], s46 offen offset:2048 sc1
  buffer_load_dwordx4 a[92:95], v1, s[8:11], s46 offen offset:3072 sc1
  s_add_u32 s46, s65, 49152
  buffer_load_dwordx4 a[96:99], v1, s[8:11], s46 offen offset:0 sc1
  buffer_load_dwordx4 a[100:103], v1, s[8:11], s46 offen offset:1024 sc1
  buffer_load_dwordx4 a[104:107], v1, s[8:11], s46 offen offset:2048 sc1
  buffer_load_dwordx4 a[108:111], v1, s[8:11], s46 offen offset:3072 sc1
  s_add_u32 s46, s65, 53248
  buffer_load_dwordx4 a[112:115], v1, s[8:11], s46 offen offset:0 sc1
  buffer_load_dwordx4 a[116:119], v1, s[8:11], s46 offen offset:1024 sc1
  buffer_load_dwordx4 a[120:123], v1, s[8:11], s46 offen offset:2048 sc1
  buffer_load_dwordx4 a[124:127], v1, s[8:11], s46 offen offset:3072 sc1
ow_loop:
  s_add_u32 s53, s52, 1
  s_lshl_b32 s56, s58, 2
  s_add_u32 s56, s56, s43
  s_lshl_b32 s56, s56, 16
  s_add_u32 s56, s56, s3
  s_add_u32 s56, s56, 12582912
  s_add_u32 s66, s58, 1
  s_cmp_eq_u32 s66, 3
  s_cselect_b32 s66, 0, s66
  s_lshl_b32 s72, s54, 21
  s_mul_i32 s46, s58, 655360
  s_add_u32 s72, s72, s46
  s_add_u32 s72, s72, s3
  s_add_u32 s72, s72, 4194304
  s_lshr_b32 s46, s72, 8
  s_and_b32 s46, s46, 0x2000
  s_xor_b32 s72, s72, s46
  s_lshl_b32 s46, s62, 14
  s_add_u32 s72, s72, s46
  s_add_u32 s73, s72, 4096
  s_and_b32 s46, s43, 3
  s_lshl_b32 s46, s46, 16
  s_sub_u32 s56, s56, s46
  s_add_u32 s74, s56, 16384
  s_add_u32 s75, s56, 20480
  s_add_u32 s76, s56, 32768
  s_add_u32 s77, s56, 36864
  s_add_u32 s78, s56, 51200
  s_lshl_b32 s80, s66, 18
  s_add_u32 s81, s80, 65536
  s_add_u32 s82, s80, 131072
  s_add_u32 s83, s80, 196608
  s_add_u32 s64, s52, 2
  v_mov_b32 v16, s64
  s_mov_b64 s[16:17], -1
  s_mov_b32 s71, 0
  v_mov_b32 v20, 0
  v_mov_b32 v21, 0
  v_mov_b32 v22, 0
  v_mov_b32 v23, 0
  s_waitcnt vmcnt(0)
  s_barrier
  buffer_load_dwordx4 v[24:27], v1, s[8:11], s72 offen offset:0 sc1
  buffer_load_dwordx4 v[28:31], v1, s[8:11], s72 offen offset:1024 sc1
  buffer_load_dwordx4 v[32:35], v1, s[8:11], s72 offen offset:2048 sc1
  buffer_load_dwordx4 v[36:39], v1, s[8:11], s72 offen offset:3072 sc1
  buffer_load_dwordx4 v[40:43], v1, s[8:11], s73 offen offset:0 sc1
  buffer_load_dwordx4 v[44:47], v1, s[8:11], s73 offen offset:1024 sc1
  buffer_load_dwordx4 v[48:51], v1, s[8:11], s73 offen offset:2048 sc1
  buffer_load_dwordx4 v[52:55], v1, s[8:11], s73 offen offset:3072 sc1
  buffer_load_dwordx2 v[56:57], v2, s[8:11], s78 offen offset:0 sc1
  buffer_load_dwordx2 v[58:59], v2, s[8:11], s78 offen offset:128 sc1
  buffer_load_dwordx2 v[60:61], v2, s[8:11], s78 offen offset:1024 sc1
  buffer_load_dwordx2 v[62:63], v2, s[8:11], s78 offen offset:1152 sc1
  buffer_load_dwordx2 v[64:65], v2, s[8:11], s78 offen offset:2048 sc1
  buffer_load_dwordx2 v[66:67], v2, s[8:11], s78 offen offset:2176 sc1
  buffer_load_dwordx2 v[68:69], v2, s[8:11], s78 offen offset:3072 sc1
  buffer_load_dwordx2 v[70:71], v2, s[8:11], s78 offen offset:3200 sc1
  buffer_load_dwordx4 v[72:75], v1, s[8:11], s74 offen offset:0 sc1
  buffer_load_dwordx4 v[76:79], v1, s[8:11], s74 offen offset:1024 sc1
  buffer_load_dwordx4 v[80:83], v1, s[8:11], s74 offen offset:2048 sc1
  buffer_load_dwordx4 v[84:87], v1, s[8:11], s74 offen offset:3072 sc1
  buffer_load_dwordx4 v[88:91], v1, s[8:11], s75 offen offset:0 sc1
  buffer_load_dwordx4 v[92:95], v1, s[8:11], s75 offen offset:1024 sc1
  buffer_load_dwordx4 v[96:99], v1, s[8:11], s75 offen offset:2048 sc1
  buffer_load_dwordx4 v[100:103], v1, s[8:11], s75 offen offset:3072 sc1
  buffer_load_dwordx4 v[104:107], v1, s[8:11], s76 offen offset:0 sc1
  buffer_load_dwordx4 v[108:111], v1, s[8:11], s76 offen offset:1024 sc1
  buffer_load_dwordx4 v[112:115], v1, s[8:11], s76 offen offset:2048 sc1
  buffer_load_dwordx4 v[116:119], v1, s[8:11], s76 offen offset:3072 sc1
  buffer_load_dwordx4 v[120:123], v1, s[8:11], s77 offen offset:0 sc1
  buffer_load_dwordx4 v[124:127], v1, s[8:11], s77 offen offset:1024 sc1
  buffer_load_dwordx4 v[128:131], v1, s[8:11], s77 offen offset:2048 sc1
  buffer_load_dwordx4 v[132:135], v1, s[8:11], s77 offen offset:3072 sc1
ow_go:
  s_waitcnt vmcnt(22)
  v_smfmac_f32_16x16x64_bf16 v[20:23], v[56:59], v[24:31], v5
  s_waitcnt vmcnt(20)
  v_smfmac_f32_16x16x64_bf16 v[20:23], v[60:63], v[32:39], v5
  buffer_store_dword v16, v7, s[8:11], 0 offen sc1
  s_waitcnt vmcnt(19)
  v_smfmac_f32_16x16x64_bf16 v[20:23], v[64:67], v[40:47], v5
  s_waitcnt vmcnt(17)
  v_smfmac_f32_16x16x64_bf16 v[20:23], v[68:71], v[48:55], v5
  s_waitcnt vmcnt(16)
  v_smfmac_f32_16x16x64_bf16 v[20:23], v[72:75], a[0:7], v5
  s_waitcnt vmcnt(15)
  v_smfmac_f32_16x16x64_bf16 v[20:23], v[76:79], a[8:15], v5
  s_waitcnt vmcnt(14)
  v_smfmac_f32_16x16x64_bf16 v[20:23], v[80:83], a[16:23], v5
  s_waitcnt vmcnt(13)
  v_smfmac_f32_16x16x64_bf16 v[20:23], v[84:87], a[24:31], v5
  s_waitcnt vmcnt(12)
  v_smfmac_f32_16x16x64_bf16 v[20:23], v[88:91], a[32:39], v5
  s_waitcnt vmcnt(11)
  v_smfmac_f32_16x16x64_bf16 v[20:23], v[92:95], a[40:47], v5
  s_waitcnt vmcnt(10)
  v_smfmac_f32_16x16x64_bf16 v[20:23], v[96:99], a[48:55], v5
  s_waitcnt vmcnt(9)
  v_smfmac_f32_16x16x64_bf16 v[20:23], v[100:103], a[56:63], v5
  s_waitcnt vmcnt(8)
  v_smfmac_f32_16x16x64_bf16 v[20:23], v[104:107], a[64:71], v5
  s_waitcnt vmcnt(7)
  v_smfmac_f32_16x16x64_bf16 v[20:23], v[108:111], a[72:79], v5
  s_waitcnt vmcnt(6)
  v_smfmac_f32_16x16x64_bf16 v[20:23], v[112:115], a[80:87], v5
  s_waitcnt vmcnt(5)
  v_smfmac_f32_16x16x64_bf16 v[20:23], v[116:119], a[88:95], v5
  s_waitcnt vmcnt(4)
  v_smfmac_f32_16x16x64_bf16 v[20:23], v[120:123], a[96:103], v5
  s_waitcnt vmcnt(3)
  v_smfmac_f32_16x16x64_bf16 v[20:23], v[124:127], a[104:111], v5
  s_waitcnt vmcnt(2)
  v_smfmac_f32_16x16x64_bf16 v[20:23], v[128:131], a[112:119], v5
  s_waitcnt vmcnt(1)
  v_smfmac_f32_16x16x64_bf16 v[20:23], v[132:135], a[120:127], v5
  s_nop 7
  v_add_f32 v20, v20, v22
  v_add_f32 v21, v21, v23
  v_cvt_pk_bf16_f32 v10, v20, v21
  v_cmp_u_f32 vcc, v20, v21
  s_nop 0
  v_mov_b32_dpp v11, v10 quad_perm:[1,0,3,2] row_mask:0xf bank_mask:0xf
  v_perm_b32 v10, v11, v10, v4
  s_and_b64 vcc, vcc, s[16:17]
  s_cbranch_scc1 ow_redo
  buffer_store_dword v10, v3, s[8:11], s80 offen sc1
  buffer_store_dword v10, v3, s[8:11], s81 offen sc1
  buffer_store_dword v10, v3, s[8:11], s82 offen sc1
  buffer_store_dword v10, v3, s[8:11], s83 offen sc1
  s_barrier
  s_add_u32 s49, s52, 2
  v_mov_b32 v11, -1
  s_lshl_b32 s47, s58, 18
  s_add_u32 s46, s47, 0
  buffer_store_dword v11, v3, s[8:11], s46 offen sc1
  s_add_u32 s46, s47, 65536
  buffer_store_dword v11, v3, s[8:11], s46 offen sc1
  s_add_u32 s46, s47, 131072
  buffer_store_dword v11, v3, s[8:11], s46 offen sc1
  s_add_u32 s46, s47, 196608
  buffer_store_dword v11, v3, s[8:11], s46 offen sc1
  s_waitcnt vmcnt(0)
  ds_read_b32 v12, v17
  s_waitcnt lgkmcnt(0)
  v_readfirstlane_b32 s46, v12
  s_nop 0
  s_max_u32 s61, s61, s46
  s_cmp_ge_u32 s61, s49
  s_cbranch_scc1 wf_done_35
  s_mov_b32 s50, 0
wf_loop_36:
  buffer_load_dword v12, v9, s[8:11], 0 offen sc1
  s_add_u32 s50, s50, 1
  s_cmp_gt_u32 s50, 131072
  s_cbranch_scc1 L_fail
  s_waitcnt vmcnt(0)
  v_min_u32_dpp v12, v12, v12 row_ror:8 row_mask:0xf bank_mask:0xf
  s_nop 1
  v_min_u32_dpp v12, v12, v12 row_ror:4 row_mask:0xf bank_mask:0xf
  s_nop 1
  v_min_u32_dpp v12, v12, v12 row_ror:2 row_mask:0xf bank_mask:0xf
  s_nop 1
  v_min_u32_dpp v12, v12, v12 row_ror:1 row_mask:0xf bank_mask:0xf
  v_mov_b32 v13, v12
  s_nop 1
  v_permlane16_swap_b32 v13, v12
  v_min_u32 v12, v12, v13
  v_mov_b32 v13, v12
  s_nop 1
  v_permlane32_swap_b32 v13, v12
  v_min_u32 v12, v12, v13
  s_nop 0
  v_readfirstlane_b32 s61, v12
  s_nop 0
  s_cmp_ge_u32 s61, s49
  s_cbranch_scc1 wf_done_35
  s_sleep 2
  s_branch wf_loop_36
wf_done_35:
  s_mov_b32 s65, s63
  s_lshr_b32 s46, s65, 8
  s_and_b32 s46, s46, 0x2000
  s_xor_b32 s65, s65, s46
  s_add_u32 s63, s63, 2621440
  s_cmp_ge_u32 s63, 165675008
  s_cselect_b32 s46, 83886080, 0
  s_sub_u32 s63, s63, s46
  s_add_u32 s46, s65, 0
  s_xor_b32 s46, s46, 0x2000
  buffer_load_dwordx4 a[0:3], v1, s[8:11], s46 offen offset:0 sc1
  buffer_load_dwordx4 a[4:7], v1, s[8:11], s46 offen offset:1024 sc1
  buffer_load_dwordx4 a[8:11], v1, s[8:11], s46 offen offset:2048 sc1
  buffer_load_dwordx4 a[12:15], v1, s[8:11], s46 offen offset:3072 sc1
  s_add_u32 s46, s65, 4096
  s_xor_b32 s46, s46, 0x2000
  buffer_load_dwordx4 a[16:19], v1, s[8:11], s46 offen offset:0 sc1
  buffer_load_dwordx4 a[20:23], v1, s[8:11], s46 offen offset:1024 sc1
  buffer_load_dwordx4 a[24:27], v1, s[8:11], s46 offen offset:2048 sc1
  buffer_load_dwordx4 a[28:31], v1, s[8:11], s46 offen offset:3072 sc1
  s_add_u32 s46, s65, 16384
  buffer_load_dwordx4 a[32:35], v1, s[8:11], s46 offen offset:0 sc1
  buffer_load_dwordx4 a[36:39], v1, s[8:11], s46 offen offset:1024 sc1
  buffer_load_dwordx4 a[40:43], v1, s[8:11], s46 offen offset:2048 sc1
  buffer_load_dwordx4 a[44:47], v1, s[8:11], s46 offen offset:3072 sc1
  s_add_u32 s46, s65, 20480
  buffer_load_dwordx4 a[48:51], v1, s[8:11], s46 offen offset:0 sc1
  buffer_load_dwordx4 a[52:55], v1, s[8:11], s46 offen offset:1024 sc1
  buffer_load_dwordx4 a[56:59], v1, s[8:11], s46 offen offset:2048 sc1
  buffer_load_dwordx4 a[60:63], v1, s[8:11], s46 offen offset:3072 sc1
  s_add_u32 s46, s65, 32768
  buffer_load_dwordx4 a[64:67], v1, s[8:11], s46 offen offset:0 sc1
  buffer_load_dwordx4 a[68:71], v1, s[8:11], s46 offen offset:1024 sc1
  buffer_load_dwordx4 a[72:75], v1, s[8:11], s46 offen offset:2048 sc1
  buffer_load_dwordx4 a[76:79], v1, s[8:11], s46 offen offset:3072 sc1
  s_add_u32 s46, s65, 36864
  buffer_load_dwordx4 a[80:83], v1, s[8:11], s46 offen offset:0 sc1
  buffer_load_dwordx4 a[84:87], v1, s[8:11], s46 offen offset:1024 sc1
  buffer_load_dwordx4 a[88:91], v1, s[8:11], s46 offen offset:2048 sc1
  buffer_load_dwordx4 a[92:95], v1, s[8:11], s46 offen offset:3072 sc1
  s_add_u32 s46, s65, 49152
  buffer_load_dwordx4 a[96:99], v1, s[8:11], s46 offen offset:0 sc1
  buffer_load_dwordx4 a[100:103], v1, s[8:11], s46 offen offset:1024 sc1
  buffer_load_dwordx4 a[104:107], v1, s[8:11], s46 offen offset:2048 sc1
  buffer_load_dwordx4 a[108:111], v1, s[8:11], s46 offen offset:3072 sc1
  s_add_u32 s46, s65, 53248
  buffer_load_dwordx4 a[112:115], v1, s[8:11], s46 offen offset:0 sc1
  buffer_load_dwordx4 a[116:119], v1, s[8:11], s46 offen offset:1024 sc1
  buffer_load_dwordx4 a[120:123], v1, s[8:11], s46 offen offset:2048 sc1
  buffer_load_dwordx4 a[124:127], v1, s[8:11], s46 offen offset:3072 sc1
  s_mov_b32 s58, s66
  s_cmp_eq_u32 s58, 0
  s_addc_u32 s54, s54, 0
  s_cmp_eq_u32 s54, 3
  s_cselect_b32 s54, 0, s54
  s_mov_b32 s52, s53
  s_cmp_lt_u32 s52, 63
  s_cbranch_scc1 ow_loop
  s_endpgm
ow_redo:
  s_mov_b32 s50, 0
ow_poll:
  buffer_load_dwordx4 v[24:27], v1, s[8:11], s72 offen offset:0 sc1
  buffer_load_dwordx4 v[28:31], v1, s[8:11], s72 offen offset:1024 sc1
  buffer_load_dwordx4 v[32:35], v1, s[8:11], s72 offen offset:2048 sc1
  buffer_load_dwordx4 v[36:39], v1, s[8:11], s72 offen offset:3072 sc1
  buffer_load_dwordx4 v[40:43], v1, s[8:11], s73 offen offset:0 sc1
  buffer_load_dwordx4 v[44:47], v1, s[8:11], s73 offen offset:1024 sc1
  buffer_load_dwordx4 v[48:51], v1, s[8:11], s73 offen offset:2048 sc1
  buffer_load_dwordx4 v[52:55], v1, s[8:11], s73 offen offset:3072 sc1
  buffer_load_dwordx2 v[56:57], v2, s[8:11], s78 offen offset:0 sc1
  buffer_load_dwordx2 v[58:59], v2, s[8:11], s78 offen offset:128 sc1
  buffer_load_dwordx2 v[60:61], v2, s[8:11], s78 offen offset:1024 sc1
  buffer_load_dwordx2 v[62:63], v2, s[8:11], s78 offen offset:1152 sc1
  buffer_load_dwordx2 v[64:65], v2, s[8:11], s78 offen offset:2048 sc1
  buffer_load_dwordx2 v[66:67], v2, s[8:11], s78 offen offset:2176 sc1
  buffer_load_dwordx2 v[68:69], v2, s[8:11], s78 offen offset:3072 sc1
  buffer_load_dwordx2 v[70:71], v2, s[8:11], s78 offen offset:3200 sc1
  buffer_load_dwordx4 v[72:75], v1, s[8:11], s74 offen offset:0 sc1
  buffer_load_dwordx4 v[76:79], v1, s[8:11], s74 offen offset:1024 sc1
  buffer_load_dwordx4 v[80:83], v1, s[8:11], s74 offen offset:2048 sc1
  buffer_load_dwordx4 v[84:87], v1, s[8:11], s74 offen offset:3072 sc1
  buffer_load_dwordx4 v[88:91], v1, s[8:11], s75 offen offset:0 sc1
  buffer_load_dwordx4 v[92:95], v1, s[8:11], s75 offen offset:1024 sc1
  buffer_load_dwordx4 v[96:99], v1, s[8:11], s75 offen offset:2048 sc1
  buffer_load_dwordx4 v[100:103], v1, s[8:11], s75 offen offset:3072 sc1
  buffer_load_dwordx4 v[104:107], v1, s[8:11], s76 offen offset:0 sc1
  buffer_load_dwordx4 v[108:111], v1, s[8:11], s76 offen offset:1024 sc1
  buffer_load_dwordx4 v[112:115], v1, s[8:11], s76 offen offset:2048 sc1
  buffer_load_dwordx4 v[116:119], v1, s[8:11], s76 offen offset:3072 sc1
  buffer_load_dwordx4 v[120:123], v1, s[8:11], s77 offen offset:0 sc1
  buffer_load_dwordx4 v[124:127], v1, s[8:11], s77 offen offset:1024 sc1
  buffer_load_dwordx4 v[128:131], v1, s[8:11], s77 offen offset:2048 sc1
  buffer_load_dwordx4 v[132:135], v1, s[8:11], s77 offen offset:3072 sc1
  s_add_u32 s71, s71, 1
  s_cmp_le_u32 s71, 2
  s_cbranch_scc1 ow_again
  s_add_u32 s50, s50, 1
  s_cmp_gt_u32 s50, 131072
  s_cbranch_scc1 L_fail
  s_waitcnt vmcnt(0)
  v_max_u32 v8, v24, v25
  v_max3_u32 v8, v26, v27, v8
  v_max3_u32 v8, v28, v29, v8
  v_max3_u32 v8, v30, v31, v8
  v_max3_u32 v8, v32, v33, v8
  v_max3_u32 v8, v34, v35, v8
  v_max3_u32 v8, v36, v37, v8
  v_max3_u32 v8, v38, v39, v8
  v_max3_u32 v8, v40, v41, v8
  v_max3_u32 v8, v42, v43, v8
  v_max3_u32 v8, v44, v45, v8
  v_max3_u32 v8, v46, v47, v8
  v_max3_u32 v8, v48, v49, v8
  v_max3_u32 v8, v50, v51, v8
  v_max3_u32 v8, v52, v53, v8
  v_max3_u32 v8, v54, v55, v8
  v_max3_u32 v8, v56, v57, v8
  v_max3_u32 v8, v58, v59, v8
  v_max3_u32 v8, v60, v61, v8
  v_max3_u32 v8, v62, v63, v8
  v_max3_u32 v8, v64, v65, v8
  v_max3_u32 v8, v66, v67, v8
  v_max3_u32 v8, v68, v69, v8
  v_max3_u32 v8, v70, v71, v8
  v_max3_u32 v8, v72, v73, v8
  v_max3_u32 v8, v74, v75, v8
  v_max3_u32 v8, v76, v77, v8
  v_max3_u32 v8, v78, v79, v8
  v_max3_u32 v8, v80, v81, v8
  v_max3_u32 v8, v82, v83, v8
  v_max3_u32 v8, v84, v85, v8
  v_max3_u32 v8, v86, v87, v8
  v_max3_u32 v8, v88, v89, v8
  v_max3_u32 v8, v90, v91, v8
  v_max3_u32 v8, v92, v93, v8
  v_max3_u32 v8, v94, v95, v8
  v_max3_u32 v8, v96, v97, v8
  v_max3_u32 v8, v98, v99, v8
  v_max3_u32 v8, v100, v101, v8
  v_max3_u32 v8, v102, v103, v8
  v_max3_u32 v8, v104, v105, v8
  v_max3_u32 v8, v106, v107, v8
  v_max3_u32 v8, v108, v109, v8
  v_max3_u32 v8, v110, v111, v8
  v_max3_u32 v8, v112, v113, v8
  v_max3_u32 v8, v114, v115, v8
  v_max3_u32 v8, v116, v117, v8
  v_max3_u32 v8, v118, v119, v8
  v_max3_u32 v8, v120, v121, v8
  v_max3_u32 v8, v122, v123, v8
  v_max3_u32 v8, v124, v125, v8
  v_max3_u32 v8, v126, v127, v8
  v_max3_u32 v8, v128, v129, v8
  v_max3_u32 v8, v130, v131, v8
  v_max3_u32 v8, v132, v133, v8
  v_max3_u32 v8, v134, v135, v8
  v_cmp_eq_u32 vcc, -1, v8
  s_cbranch_vccnz ow_poll
  s_mov_b64 s[16:17], 0
ow_again:
  v_mov_b32 v20, 0
  v_mov_b32 v21, 0
  v_mov_b32 v22, 0
  v_mov_b32 v23, 0
  s_branch ow_go
L_xowner:
  s_mov_b32 s4, s16
  s_mov_b32 s5, s17
  s_mov_b32 s6, 2621440
  s_mov_b32 s7, 0x20000
  s_mov_b32 s12, s36
  s_mov_b32 s13, s37
  s_mov_b32 s14, 5242880
  s_mov_b32 s15, 0x20000
  v_and_b32 v11, 3, v0
  v_lshlrev_b32 v11, 2, v11
  s_mov_b32 s50, 0
ss_37:
  global_load_dword v10, v11, s[38:39] sc1
  s_add_u32 s50, s50, 1
  s_cmp_gt_u32 s50, 131072
  s_cbranch_scc1 L_fail
  s_waitcnt vmcnt(0)
  v_readlane_b32 s46, v10, 0
  v_readlane_b32 s47, v10, 1
  v_readlane_b32 s48, v10, 0
  s_nop 0
  s_min_u32 s47, s47, s48
  s_cmp_lg_u32 s46, 0
  s_cselect_b32 s48, 7, 0
  s_add_u32 s46, s46, s2
  s_xor_b32 s49, s46, s43
  s_and_b32 s49, s49, s48
  s_cbranch_scc1 L_reroll
  s_cmp_lg_u32 s47, 0
  s_cbranch_scc1 ss_ok_38
  s_sleep 6
  s_branch ss_37
ss_ok_38:
  v_readlane_b32 s3, v10, 1
  s_nop 0
  s_and_b32 s3, s3, 0x2000
  s_lshl_b32 s46, s43, 7
  s_add_u32 s46, s46, s3
  s_add_u32 s46, s46, 13373440
  v_mov_b32 v14, s46
  s_sub_u32 s48, s44, 26
  s_and_b32 s46, s48, 1
  s_mul_i32 s46, s46, 5
  s_mul_i32 s62, s43, 10
  s_add_u32 s62, s62, s46
  s_lshr_b32 s52, s48, 1
  v_lshlrev_b32 v1, 4, v0
  v_and_b32 v10, 7, v0
  v_lshlrev_b32 v10, 7, v10
  v_add_u32 v10, s51, v10
  v_bfe_u32 v11, v0, 3, 2
  v_lshl_add_u32 v2, v11, 2, v10
  v_add_u32 v3, 1064960, v2
  v_add_u32 v2, 1060864, v2
  v_bfe_u32 v11, v0, 3, 1
  v_lshl_add_u32 v4, v11, 2, v10
  v_add_u32 v4, 1069056, v4
  v_cmp_lt_u32 vcc, 31, v0
  s_nop 1
  v_cndmask_b32 v3, v3, v4, vcc
  s_mul_i32 s46, s43, 6
  s_add_u32 s46, s46, s48
  s_lshl_b32 s46, s46, 7
  s_add_u32 s46, s46, 1073152
  v_mov_b32 v15, s46
  v_mov_b32 v11, 2146435072
  s_cmp_eq_u32 s42, 0
  s_cselect_b64 vcc, 1, 0
  v_cndmask_b32 v15, v11, v15, vcc
  s_mul_i32 s46, s42, 10240
  v_add_u32 v5, s46, v1
  v_add_u32 v6, s51, v1
  s_mul_i32 s63, s52, 40
  s_add_u32 s63, s63, s62
  s_lshl_b32 s63, s63, 16
  s_lshl_b32 s46, s42, 14
  s_add_u32 s63, s63, s46
  s_add_u32 s63, s63, s3
  s_add_u32 s63, s63, 81788928
  s_lshr_b32 s46, 1, s42
  s_and_b32 s46, s46, 1
  s_lshl_b32 s46, s46, 13
  s_xor_b32 s63, s63, s46
  s_lshl_b32 s65, s52, 18
  s_add_u32 s65, s65, s3
  s_add_u32 s65, s65, 14680064
  s_lshl_b32 s67, s62, 14
  s_lshl_b32 s46, s42, 11
  s_add_u32 s67, s67, s46
  s_mov_b32 s58, s52
  s_mul_i32 s66, s52, 81920
  v_and_b32 v10, 15, v0
  v_mul_u32_u24 v10, 2560, v10
  v_lshrrev_b32 v11, 4, v0
  v_lshl_add_u32 v10, v11, 3, v10
  s_add_u32 s46, s42, 0
  s_cmp_ge_u32 s46, 5
  s_cselect_b32 s47, 40800, 0
  s_add_u32 s48, s46, s62
  s_lshl_b32 s48, s48, 5
  s_add_u32 s47, s47, s48
  s_add_u32 s47, s47, 1280
  s_cmp_ge_u32 s46, 10
  s_cselect_b32 s47, 2146435072, s47
  v_add_u32 v7, s47, v10
  s_add_u32 s46, s42, 4
  s_cmp_ge_u32 s46, 5
  s_cselect_b32 s47, 40800, 0
  s_add_u32 s48, s46, s62
  s_lshl_b32 s48, s48, 5
  s_add_u32 s47, s47, s48
  s_add_u32 s47, s47, 1280
  s_cmp_ge_u32 s46, 10
  s_cselect_b32 s47, 2146435072, s47
  v_add_u32 v8, s47, v10
  s_add_u32 s46, s42, 8
  s_cmp_ge_u32 s46, 5
  s_cselect_b32 s47, 40800, 0
  s_add_u32 s48, s46, s62
  s_lshl_b32 s48, s48, 5
  s_add_u32 s47, s47, s48
  s_add_u32 s47, s47, 1280
  s_cmp_ge_u32 s46, 10
  s_cselect_b32 s47, 2146435072, s47
  v_add_u32 v9, s47, v10
  v_mov_b32 v224, -1
  v_mov_b32 v225, -1
  v_mov_b32 v226, -1
  v_mov_b32 v227, -1
  s_mov_b32 s54, 0
  s_lshl_b32 s64, s54, 21
  s_mul_i32 s46, s58, 655360
  s_add_u32 s64, s64, s46
  s_add_u32 s64, s64, s3
  s_add_u32 s64, s64, 4194304
  s_lshr_b32 s46, s64, 8
  s_and_b32 s46, s46, 0x2000
  s_xor_b32 s64, s64, s46
  s_add_u32 s64, s64, s67
  s_add_u32 s46, s64, 0
  buffer_store_dwordx4 v[224:227], v1, s[8:11], s46 offen offset:0 sc1
  buffer_store_dwordx4 v[224:227], v1, s[8:11], s46 offen offset:1024 sc1
  s_add_u32 s46, s64, 16384
  buffer_store_dwordx4 v[224:227], v1, s[8:11], s46 offen offset:0 sc1
  buffer_store_dwordx4 v[224:227], v1, s[8:11], s46 offen offset:1024 sc1
  s_add_u32 s46, s64, 32768
  buffer_store_dwordx4 v[224:227], v1, s[8:11], s46 offen offset:0 sc1
  buffer_store_dwordx4 v[224:227], v1, s[8:11], s46 offen offset:1024 sc1
  s_add_u32 s46, s64, 49152
  buffer_store_dwordx4 v[224:227], v1, s[8:11], s46 offen offset:0 sc1
  buffer_store_dwordx4 v[224:227], v1, s[8:11], s46 offen offset:1024 sc1
  s_add_u32 s46, s64, 65536
  buffer_store_dwordx4 v[224:227], v1, s[8:11], s46 offen offset:0 sc1
  buffer_store_dwordx4 v[224:227], v1, s[8:11], s46 offen offset:1024 sc1
  s_mov_b32 s54, 1
  s_lshl_b32 s64, s54, 21
  s_mul_i32 s46, s58, 655360
  s_add_u32 s64, s64, s46
  s_add_u32 s64, s64, s3
  s_add_u32 s64, s64, 4194304
  s_lshr_b32 s46, s64, 8
  s_and_b32 s46, s46, 0x2000
  s_xor_b32 s64, s64, s46
  s_add_u32 s64, s64, s67
  s_add_u32 s46, s64, 0
  buffer_store_dwordx4 v[224:227], v1, s[8:11], s46 offen offset:0 sc1
  buffer_store_dwordx4 v[224:227], v1, s[8:11], s46 offen offset:1024 sc1
  s_add_u32 s46, s64, 16384
  buffer_store_dwordx4 v[224:227], v1, s[8:11], s46 offen offset:0 sc1
  buffer_store_dwordx4 v[224:227], v1, s[8:11], s46 offen offset:1024 sc1
  s_add_u32 s46, s64, 32768
  buffer_store_dwordx4 v[224:227], v1, s[8:11], s46 offen offset:0 sc1
  buffer_store_dwordx4 v[224:227], v1, s[8:11], s46 offen offset:1024 sc1
  s_add_u32 s46, s64, 49152
  buffer_store_dwordx4 v[224:227], v1, s[8:11], s46 offen offset:0 sc1
  buffer_store_dwordx4 v[224:227], v1, s[8:11], s46 offen offset:1024 sc1
  s_add_u32 s46, s64, 65536
  buffer_store_dwordx4 v[224:227], v1, s[8:11], s46 offen offset:0 sc1
  buffer_store_dwordx4 v[224:227], v1, s[8:11], s46 offen offset:1024 sc1
  s_mov_b32 s54, 2
  s_lshl_b32 s64, s54, 21
  s_mul_i32 s46, s58, 655360
  s_add_u32 s64, s64, s46
  s_add_u32 s64, s64, s3
  s_add_u32 s64, s64, 4194304
  s_lshr_b32 s46, s64, 8
  s_and_b32 s46, s46, 0x2000
  s_xor_b32 s64, s64, s46
  s_add_u32 s64, s64, s67
  s_add_u32 s46, s64, 0
  buffer_store_dwordx4 v[224:227], v1, s[8:11], s46 offen offset:0 sc1
  buffer_store_dwordx4 v[224:227], v1, s[8:11], s46 offen offset:1024 sc1
  s_add_u32 s46, s64, 16384
  buffer_store_dwordx4 v[224:227], v1, s[8:11], s46 offen offset:0 sc1
  buffer_store_dwordx4 v[224:227], v1, s[8:11], s46 offen offset:1024 sc1
  s_add_u32 s46, s64, 32768
  buffer_store_dwordx4 v[224:227], v1, s[8:11], s46 offen offset:0 sc1
  buffer_store_dwordx4 v[224:227], v1, s[8:11], s46 offen offset:1024 sc1
  s_add_u32 s46, s64, 49152
  buffer_store_dwordx4 v[224:227], v1, s[8:11], s46 offen offset:0 sc1
  buffer_store_dwordx4 v[224:227], v1, s[8:11], s46 offen offset:1024 sc1
  s_add_u32 s46, s64, 65536
  buffer_store_dwordx4 v[224:227], v1, s[8:11], s46 offen offset:0 sc1
  buffer_store_dwordx4 v[224:227], v1, s[8:11], s46 offen offset:1024 sc1
  v_and_b32 v11, 3, v0
  v_lshlrev_b32 v11, 2, v11
  s_mov_b32 s50, 0
ss_39:
  global_load_dword v10, v11, s[38:39] sc1
  s_add_u32 s50, s50, 1
  s_cmp_gt_u32 s50, 131072
  s_cbranch_scc1 L_fail
  s_waitcnt vmcnt(0)
  v_readlane_b32 s46, v10, 0
  v_readlane_b32 s47, v10, 2
  v_readlane_b32 s48, v10, 1
  s_nop 0
  s_min_u32 s47, s47, s48
  s_cmp_lg_u32 s46, 0
  s_cselect_b32 s48, 7, 0
  s_add_u32 s46, s46, s2
  s_xor_b32 s49, s46, s43
  s_and_b32 s49, s49, s48
  s_cbranch_scc1 L_reroll
  s_cmp_lg_u32 s47, 0
  s_cbranch_scc1 ss_ok_40
  s_sleep 6
  s_branch ss_39
ss_ok_40:
  v_readlane_b32 s3, v10, 1
  s_nop 0
  s_and_b32 s3, s3, 0x2000
  s_add_u32 s46, s52, 6
  v_mov_b32 v10, s46
  s_waitcnt vmcnt(0)
  s_barrier
  buffer_store_dword v10, v15, s[8:11], 0 offen sc1
  s_mov_b32 s60, 0
  s_mov_b32 s61, 0
  s_mov_b32 s54, 0
  v_lshlrev_b32 v228, 7, v0
  s_mul_i32 s76, s43, 6
  s_add_u32 s76, s76, s44
  s_sub_u32 s76, s76, 26
  s_lshl_b32 s76, s76, 2
  s_add_u32 s76, s76, s42
  s_lshl_b32 s76, s76, 13
  s_mov_b32 s77, 2457600
  s_mov_b32 s78, 819200
xo_loop:
  s_add_u32 s53, s52, 1
  s_cmp_ge_u32 s60, s53
  s_cbranch_scc1 wf_done_41
  s_mov_b32 s50, 0
wf_loop_42:
  buffer_load_dword v10, v2, s[8:11], 0 offen sc1
  s_add_u32 s50, s50, 1
  s_cmp_gt_u32 s50, 131072
  s_cbranch_scc1 L_fail
  s_waitcnt vmcnt(0)
  v_min_u32_dpp v10, v10, v10 row_ror:8 row_mask:0xf bank_mask:0xf
  s_nop 1
  v_min_u32_dpp v10, v10, v10 row_ror:4 row_mask:0xf bank_mask:0xf
  s_nop 1
  v_min_u32_dpp v10, v10, v10 row_ror:2 row_mask:0xf bank_mask:0xf
  s_nop 1
  v_min_u32_dpp v10, v10, v10 row_ror:1 row_mask:0xf bank_mask:0xf
  v_mov_b32 v11, v10
  s_nop 1
  v_permlane16_swap_b32 v11, v10
  v_min_u32 v10, v10, v11
  v_mov_b32 v11, v10
  s_nop 1
  v_permlane32_swap_b32 v11, v10
  v_min_u32 v10, v10, v11
  s_nop 0
  v_readfirstlane_b32 s60, v10
  s_nop 0
  s_cmp_ge_u32 s60, s53
  s_cbranch_scc1 wf_done_41
  s_sleep 2
  s_branch wf_loop_42
wf_done_41:
  s_add_u32 s46, s63, 0
  s_lshr_b32 s47, s46, 8
  s_and_b32 s47, s47, 0x2000
  s_xor_b32 s46, s46, s47
  buffer_load_dwordx4 a[0:3], v1, s[8:11], s46 offen offset:0 sc1
  buffer_load_dwordx4 a[4:7], v1, s[8:11], s46 offen offset:1024 sc1
  buffer_load_dwordx4 a[8:11], v1, s[8:11], s46 offen offset:2048 sc1
  buffer_load_dwordx4 a[12:15], v1, s[8:11], s46 offen offset:3072 sc1
  s_add_u32 s46, s46, 4096
  buffer_load_dwordx4 a[16:19], v1, s[8:11], s46 offen offset:0 sc1
  buffer_load_dwordx4 a[20:23], v1, s[8:11], s46 offen offset:1024 sc1
  buffer_load_dwordx4 a[24:27], v1, s[8:11], s46 offen offset:2048 sc1
  buffer_load_dwordx4 a[28:31], v1, s[8:11], s46 offen offset:3072 sc1
  s_add_u32 s46, s63, 65536
  s_lshr_b32 s47, s46, 8
  s_and_b32 s47, s47, 0x2000
  s_xor_b32 s46, s46, s47
  buffer_load_dwordx4 a[32:35], v1, s[8:11], s46 offen offset:0 sc1
  buffer_load_dwordx4 a[36:39], v1, s[8:11], s46 offen offset:1024 sc1
  buffer_load_dwordx4 a[40:43], v1, s[8:11], s46 offen offset:2048 sc1
  buffer_load_dwordx4 a[44:47], v1, s[8:11], s46 offen offset:3072 sc1
  s_add_u32 s46, s46, 4096
  buffer_load_dwordx4 a[48:51], v1, s[8:11], s46 offen offset:0 sc1
  buffer_load_dwordx4 a[52:55], v1, s[8:11], s46 offen offset:1024 sc1
  buffer_load_dwordx4 a[56:59], v1, s[8:11], s46 offen offset:2048 sc1
  buffer_load_dwordx4 a[60:63], v1, s[8:11], s46 offen offset:3072 sc1
  s_add_u32 s46, s63, 131072
  s_lshr_b32 s47, s46, 8
  s_and_b32 s47, s47, 0x2000
  s_xor_b32 s46, s46, s47
  buffer_load_dwordx4 a[64:67], v1, s[8:11], s46 offen offset:0 sc1
  buffer_load_dwordx4 a[68:71], v1, s[8:11], s46 offen offset:1024 sc1
  buffer_load_dwordx4 a[72:75], v1, s[8:11], s46 offen offset:2048 sc1
  buffer_load_dwordx4 a[76:79], v1, s[8:11], s46 offen offset:3072 sc1
  s_add_u32 s46, s46, 4096
  buffer_load_dwordx4 a[80:83], v1, s[8:11], s46 offen offset:0 sc1
  buffer_load_dwordx4 a[84:87], v1, s[8:11], s46 offen offset:1024 sc1
  buffer_load_dwordx4 a[88:91], v1, s[8:11], s46 offen offset:2048 sc1
  buffer_load_dwordx4 a[92:95], v1, s[8:11], s46 offen offset:3072 sc1
  s_add_u32 s46, s63, 196608
  s_lshr_b32 s47, s46, 8
  s_and_b32 s47, s47, 0x2000
  s_xor_b32 s46, s46, s47
  buffer_load_dwordx4 a[96:99], v1, s[8:11], s46 offen offset:0 sc1
  buffer_load_dwordx4 a[100:103], v1, s[8:11], s46 offen offset:1024 sc1
  buffer_load_dwordx4 a[104:107], v1, s[8:11], s46 offen offset:2048 sc1
  buffer_load_dwordx4 a[108:111], v1, s[8:11], s46 offen offset:3072 sc1
  s_add_u32 s46, s46, 4096
  buffer_load_dwordx4 a[112:115], v1, s[8:11], s46 offen offset:0 sc1
  buffer_load_dwordx4 a[116:119], v1, s[8:11], s46 offen offset:1024 sc1
  buffer_load_dwordx4 a[120:123], v1, s[8:11], s46 offen offset:2048 sc1
  buffer_load_dwordx4 a[124:127], v1, s[8:11], s46 offen offset:3072 sc1
  s_add_u32 s46, s63, 262144
  s_lshr_b32 s47, s46, 8
  s_and_b32 s47, s47, 0x2000
  s_xor_b32 s46, s46, s47
  buffer_load_dwordx4 a[128:131], v1, s[8:11], s46 offen offset:0 sc1
  buffer_load_dwordx4 a[132:135], v1, s[8:11], s46 offen offset:1024 sc1
  buffer_load_dwordx4 a[136:139], v1, s[8:11], s46 offen offset:2048 sc1
  buffer_load_dwordx4 a[140:143], v1, s[8:11], s46 offen offset:3072 sc1
  s_add_u32 s46, s46, 4096
  buffer_load_dwordx4 a[144:147], v1, s[8:11], s46 offen offset:0 sc1
  buffer_load_dwordx4 a[148:151], v1, s[8:11], s46 offen offset:1024 sc1
  buffer_load_dwordx4 a[152:155], v1, s[8:11], s46 offen offset:2048 sc1
  buffer_load_dwordx4 a[156:159], v1, s[8:11], s46 offen offset:3072 sc1
  s_waitcnt vmcnt(24)
  s_cmp_ge_u32 s52, 62
  s_cbranch_scc1 xo_last
  s_cmp_lg_u32 s42, 0
  s_cbranch_scc1 xo_go
  s_cmp_ge_u32 s61, s53
  s_cbranch_scc1 wf_done_43
  s_mov_b32 s50, 0
wf_loop_44:
  buffer_load_dword v10, v14, s[8:11], 0 offen sc1
  s_add_u32 s50, s50, 1
  s_cmp_gt_u32 s50, 131072
  s_cbranch_scc1 L_fail
  s_waitcnt vmcnt(0)
  v_readfirstlane_b32 s61, v10
  s_nop 0
  s_cmp_ge_u32 s61, s53
  s_cbranch_scc1 wf_done_43
  s_sleep 2
  s_branch wf_loop_44
wf_done_43:
  s_branch xo_go
xo_last:
  s_mov_b32 s53, 64
  s_mov_b32 s61, 0
  s_cmp_ge_u32 s61, s53
  s_cbranch_scc1 wf_done_45
  s_mov_b32 s50, 0
wf_loop_46:
  buffer_load_dword v10, v3, s[8:11], 0 offen sc1
  s_add_u32 s50, s50, 1
  s_cmp_gt_u32 s50, 131072
  s_cbranch_scc1 L_fail
  s_waitcnt vmcnt(0)
  v_min_u32_dpp v10, v10, v10 row_ror:8 row_mask:0xf bank_mask:0xf
  s_nop 1
  v_min_u32_dpp v10, v10, v10 row_ror:4 row_mask:0xf bank_mask:0xf
  s_nop 1
  v_min_u32_dpp v10, v10, v10 row_ror:2 row_mask:0xf bank_mask:0xf
  s_nop 1
  v_min_u32_dpp v10, v10, v10 row_ror:1 row_mask:0xf bank_mask:0xf
  v_mov_b32 v11, v10
  s_nop 1
  v_permlane16_swap_b32 v11, v10
  v_min_u32 v10, v10, v11
  v_mov_b32 v11, v10
  s_nop 1
  v_permlane32_swap_b32 v11, v10
  v_min_u32 v10, v10, v11
  s_nop 0
  v_readfirstlane_b32 s61, v10
  s_nop 0
  s_cmp_ge_u32 s61, s53
  s_cbranch_scc1 wf_done_45
  s_sleep 2
  s_branch wf_loop_46
wf_done_45:
xo_go:
  s_barrier
  s_lshl_b32 s64, s54, 21
  s_mul_i32 s46, s58, 655360
  s_add_u32 s64, s64, s46
  s_add_u32 s64, s64, s3
  s_add_u32 s64, s64, 4194304
  s_lshr_b32 s46, s64, 8
  s_and_b32 s46, s46, 0x2000
  s_xor_b32 s64, s64, s46
  s_add_u32 s64, s64, s67
  s_mov_b32 s49, s65
  s_lshr_b32 s46, s49, 8
  s_and_b32 s46, s46, 0x2000
  s_xor_b32 s49, s49, s46
  s_lshl_b32 s47, s42, 14
  s_add_u32 s47, s47, s49
  s_lshl_b32 s48, s42, 11
  s_add_u32 s48, s48, s49
  s_add_u32 s46, s47, 0
  buffer_load_dwordx4 v[56:59], v1, s[8:11], s46 offen sc1
  s_add_u32 s46, s47, 81920
  buffer_load_dwordx4 v[60:63], v1, s[8:11], s46 offen sc1
  s_add_u32 s46, s47, 1024
  buffer_load_dwordx4 v[64:67], v1, s[8:11], s46 offen sc1
  s_add_u32 s46, s47, 82944
  buffer_load_dwordx4 v[68:71], v1, s[8:11], s46 offen sc1
  s_add_u32 s46, s47, 2048
  buffer_load_dwordx4 v[72:75], v1, s[8:11], s46 offen sc1
  s_add_u32 s46, s47, 83968
  buffer_load_dwordx4 v[76:79], v1, s[8:11], s46 offen sc1
  s_add_u32 s46, s47, 3072
  buffer_load_dwordx4 v[80:83], v1, s[8:11], s46 offen sc1
  s_add_u32 s46, s47, 84992
  buffer_load_dwordx4 v[84:87], v1, s[8:11], s46 offen sc1
  s_add_u32 s46, s47, 4096
  buffer_load_dwordx4 v[88:91], v1, s[8:11], s46 offen sc1
  s_add_u32 s46, s47, 86016
  buffer_load_dwordx4 v[92:95], v1, s[8:11], s46 offen sc1
  s_add_u32 s46, s47, 5120
  buffer_load_dwordx4 v[96:99], v1, s[8:11], s46 offen sc1
  s_add_u32 s46, s47, 87040
  buffer_load_dwordx4 v[100:103], v1, s[8:11], s46 offen sc1
  s_add_u32 s46, s47, 6144
  buffer_load_dwordx4 v[104:107], v1, s[8:11], s46 offen sc1
  s_add_u32 s46, s47, 88064
  buffer_load_dwordx4 v[108:111], v1, s[8:11], s46 offen sc1
  s_add_u32 s46, s47, 7168
  buffer_load_dwordx4 v[112:115], v1, s[8:11], s46 offen sc1
  s_add_u32 s46, s47, 89088
  buffer_load_dwordx4 v[116:119], v1, s[8:11], s46 offen sc1
  s_add_u32 s46, s48, 65536
  buffer_load_dwordx4 v[120:123], v1, s[8:11], s46 offen sc1
  s_add_u32 s46, s48, 147456
  buffer_load_dwordx4 v[124:127], v1, s[8:11], s46 offen sc1
  s_add_u32 s46, s48, 66560
  buffer_load_dwordx4 v[128:131], v1, s[8:11], s46 offen sc1
  s_add_u32 s46, s48, 148480
  buffer_load_dwordx4 v[132:135], v1, s[8:11], s46 offen sc1
  s_add_u32 s46, s64, 0
  buffer_load_dwordx4 v[16:19], v1, s[8:11], s46 offen offset:0 sc1
  buffer_load_dwordx4 v[20:23], v1, s[8:11], s46 offen offset:1024 sc1
  s_add_u32 s46, s64, 16384
  buffer_load_dwordx4 v[24:27], v1, s[8:11], s46 offen offset:0 sc1
  buffer_load_dwordx4 v[28:31], v1, s[8:11], s46 offen offset:1024 sc1
  s_add_u32 s46, s64, 32768
  buffer_load_dwordx4 v[32:35], v1, s[8:11], s46 offen offset:0 sc1
  buffer_load_dwordx4 v[36:39], v1, s[8:11], s46 offen offset:1024 sc1
  s_add_u32 s46, s64, 49152
  buffer_load_dwordx4 v[40:43], v1, s[8:11], s46 offen offset:0 sc1
  buffer_load_dwordx4 v[44:47], v1, s[8:11], s46 offen offset:1024 sc1
  s_add_u32 s46, s64, 65536
  buffer_load_dwordx4 v[48:51], v1, s[8:11], s46 offen offset:0 sc1
  buffer_load_dwordx4 v[52:55], v1, s[8:11], s46 offen offset:1024 sc1
  s_waitcnt vmcnt(29)
  v_mfma_f32_16x16x32_bf16 v[136:139], a[0:3], v[56:59], 0
  v_mfma_f32_16x16x32_bf16 v[140:143], a[32:35], v[56:59], 0
  v_mfma_f32_16x16x32_bf16 v[144:147], a[64:67], v[56:59], 0
  v_mfma_f32_16x16x32_bf16 v[148:151], a[96:99], v[56:59], 0
  v_mfma_f32_16x16x32_bf16 v[152:155], a[128:131], v[56:59], 0
  s_waitcnt vmcnt(28)
  v_mfma_f32_16x16x32_bf16 v[156:159], a[0:3], v[60:63], 0
  v_mfma_f32_16x16x32_bf16 v[160:163], a[32:35], v[60:63], 0
  v_mfma_f32_16x16x32_bf16 v[164:167], a[64:67], v[60:63], 0
  v_mfma_f32_16x16x32_bf16 v[168:171], a[96:99], v[60:63], 0
  v_mfma_f32_16x16x32_bf16 v[172:175], a[128:131], v[60:63], 0
  s_waitcnt vmcnt(27)
  v_mfma_f32_16x16x32_bf16 v[136:139], a[4:7], v[64:67], v[136:139]
  v_mfma_f32_16x16x32_bf16 v[140:143], a[36:39], v[64:67], v[140:143]
  v_mfma_f32_16x16x32_bf16 v[144:147], a[68:71], v[64:67], v[144:147]
  v_mfma_f32_16x16x32_bf16 v[148:151], a[100:103], v[64:67], v[148:151]
  v_mfma_f32_16x16x32_bf16 v[152:155], a[132:135], v[64:67], v[152:155]
  s_waitcnt vmcnt(26)
  v_mfma_f32_16x16x32_bf16 v[156:159], a[4:7], v[68:71], v[156:159]
  v_mfma_f32_16x16x32_bf16 v[160:163], a[36:39], v[68:71], v[160:163]
  v_mfma_f32_16x16x32_bf16 v[164:167], a[68:71], v[68:71], v[164:167]
  v_mfma_f32_16x16x32_bf16 v[168:171], a[100:103], v[68:71], v[168:171]
  v_mfma_f32_16x16x32_bf16 v[172:175], a[132:135], v[68:71], v[172:175]
  s_waitcnt vmcnt(25)
  v_mfma_f32_16x16x32_bf16 v[136:139], a[8:11], v[72:75], v[136:139]
  v_mfma_f32_16x16x32_bf16 v[140:143], a[40:43], v[72:75], v[140:143]
  v_mfma_f32_16x16x32_bf16 v[144:147], a[72:75], v[72:75], v[144:147]
  v_mfma_f32_16x16x32_bf16 v[148:151], a[104:107], v[72:75], v[148:151]
  v_mfma_f32_16x16x32_bf16 v[152:155], a[136:139], v[72:75], v[152:155]
  s_waitcnt vmcnt(24)
  v_mfma_f32_16x16x32_bf16 v[156:159], a[8:11], v[76:79], v[156:159]
  v_mfma_f32_16x16x32_bf16 v[160:163], a[40:43], v[76:79], v[160:163]
  v_mfma_f32_16x16x32_bf16 v[164:167], a[72:75], v[76:79], v[164:167]
  v_mfma_f32_16x16x32_bf16 v[168:171], a[104:107], v[76:79], v[168:171]
  v_mfma_f32_16x16x32_bf16 v[172:175], a[136:139], v[76:79], v[172:175]
  s_waitcnt vmcnt(23)
  v_mfma_f32_16x16x32_bf16 v[136:139], a[12:15], v[80:83], v[136:139]
  v_mfma_f32_16x16x32_bf16 v[140:143], a[44:47], v[80:83], v[140:143]
  v_mfma_f32_16x16x32_bf16 v[144:147], a[76:79], v[80:83], v[144:147]
  v_mfma_f32_16x16x32_bf16 v[148:151], a[108:111], v[80:83], v[148:151]
  v_mfma_f32_16x16x32_bf16 v[152:155], a[140:143], v[80:83], v[152:155]
  s_waitcnt vmcnt(22)
  v_mfma_f32_16x16x32_bf16 v[156:159], a[12:15], v[84:87], v[156:159]
  v_mfma_f32_16x16x32_bf16 v[160:163], a[44:47], v[84:87], v[160:163]
  v_mfma_f32_16x16x32_bf16 v[164:167], a[76:79], v[84:87], v[164:167]
  v_mfma_f32_16x16x32_bf16 v[168:171], a[108:111], v[84:87], v[168:171]
  v_mfma_f32_16x16x32_bf16 v[172:175], a[140:143], v[84:87], v[172:175]
  s_waitcnt vmcnt(21)
  v_mfma_f32_16x16x32_bf16 v[136:139], a[16:19], v[88:91], v[136:139]
  v_mfma_f32_16x16x32_bf16 v[140:143], a[48:51], v[88:91], v[140:143]
  v_mfma_f32_16x16x32_bf16 v[144:147], a[80:83], v[88:91], v[144:147]
  v_mfma_f32_16x16x32_bf16 v[148:151], a[112:115], v[88:91], v[148:151]
  v_mfma_f32_16x16x32_bf16 v[152:155], a[144:147], v[88:91], v[152:155]
  s_waitcnt vmcnt(20)
  v_mfma_f32_16x16x32_bf16 v[156:159], a[16:19], v[92:95], v[156:159]
  v_mfma_f32_16x16x32_bf16 v[160:163], a[48:51], v[92:95], v[160:163]
  v_mfma_f32_16x16x32_bf16 v[164:167], a[80:83], v[92:95], v[164:167]
  v_mfma_f32_16x16x32_bf16 v[168:171], a[112:115], v[92:95], v[168:171]
  v_mfma_f32_16x16x32_bf16 v[172:175], a[144:147], v[92:95], v[172:175]
  s_waitcnt vmcnt(19)
  v_mfma_f32_16x16x32_bf16 v[136:139], a[20:23], v[96:99], v[136:139]
  v_mfma_f32_16x16x32_bf16 v[140:143], a[52:55], v[96:99], v[140:143]
  v_mfma_f32_16x16x32_bf16 v[144:147], a[84:87], v[96:99], v[144:147]
  v_mfma_f32_16x16x32_bf16 v[148:151], a[116:119], v[96:99], v[148:151]
  v_mfma_f32_16x16x32_bf16 v[152:155], a[148:151], v[96:99], v[152:155]
  s_waitcnt vmcnt(18)
  v_mfma_f32_16x16x32_bf16 v[156:159], a[20:23], v[100:103], v[156:159]
  v_mfma_f32_16x16x32_bf16 v[160:163], a[52:55], v[100:103], v[160:163]
  v_mfma_f32_16x16x32_bf16 v[164:167], a[84:87], v[100:103], v[164:167]
  v_mfma_f32_16x16x32_bf16 v[168:171], a[116:119], v[100:103], v[168:171]
  v_mfma_f32_16x16x32_bf16 v[172:175], a[148:151], v[100:103], v[172:175]
  s_waitcnt vmcnt(17)
  v_mfma_f32_16x16x32_bf16 v[136:139], a[24:27], v[104:107], v[136:139]
  v_mfma_f32_16x16x32_bf16 v[140:143], a[56:59], v[104:107], v[140:143]
  v_mfma_f32_16x16x32_bf16 v[144:147], a[88:91], v[104:107], v[144:147]
  v_mfma_f32_16x16x32_bf16 v[148:151], a[120:123], v[104:107], v[148:151]
  v_mfma_f32_16x16x32_bf16 v[152:155], a[152:155], v[104:107], v[152:155]
  s_waitcnt vmcnt(16)
  v_mfma_f32_16x16x32_bf16 v[156:159], a[24:27], v[108:111], v[156:159]
  v_mfma_f32_16x16x32_bf16 v[160:163], a[56:59], v[108:111], v[160:163]
  v_mfma_f32_16x16x32_bf16 v[164:167], a[88:91], v[108:111], v[164:167]
  v_mfma_f32_16x16x32_bf16 v[168:171], a[120:123], v[108:111], v[168:171]
  v_mfma_f32_16x16x32_bf16 v[172:175], a[152:155], v[108:111], v[172:175]
  s_waitcnt vmcnt(15)
  v_mfma_f32_16x16x32_bf16 v[136:139], a[28:31], v[112:115], v[136:139]
  v_mfma_f32_16x16x32_bf16 v[140:143], a[60:63], v[112:115], v[140:143]
  v_mfma_f32_16x16x32_bf16 v[144:147], a[92:95], v[112:115], v[144:147]
  v_mfma_f32_16x16x32_bf16 v[148:151], a[124:127], v[112:115], v[148:151]
  v_mfma_f32_16x16x32_bf16 v[152:155], a[156:159], v[112:115], v[152:155]
  s_waitcnt vmcnt(14)
  v_mfma_f32_16x16x32_bf16 v[156:159], a[28:31], v[116:119], v[156:159]
  v_mfma_f32_16x16x32_bf16 v[160:163], a[60:63], v[116:119], v[160:163]
  v_mfma_f32_16x16x32_bf16 v[164:167], a[92:95], v[116:119], v[164:167]
  v_mfma_f32_16x16x32_bf16 v[168:171], a[124:127], v[116:119], v[168:171]
  v_mfma_f32_16x16x32_bf16 v[172:175], a[156:159], v[116:119], v[172:175]
  s_waitcnt vmcnt(8)
  v_mfma_f32_16x16x32_bf16 v[136:139], v[16:19], v[120:123], v[136:139]
  v_mfma_f32_16x16x32_bf16 v[156:159], v[16:19], v[124:127], v[156:159]
  v_mfma_f32_16x16x32_bf16 v[136:139], v[20:23], v[128:131], v[136:139]
  v_mfma_f32_16x16x32_bf16 v[156:159], v[20:23], v[132:135], v[156:159]
  s_waitcnt vmcnt(6)
  v_mfma_f32_16x16x32_bf16 v[140:143], v[24:27], v[120:123], v[140:143]
  v_mfma_f32_16x16x32_bf16 v[160:163], v[24:27], v[124:127], v[160:163]
  v_mfma_f32_16x16x32_bf16 v[140:143], v[28:31], v[128:131], v[140:143]
  v_mfma_f32_16x16x32_bf16 v[160:163], v[28:31], v[132:135], v[160:163]
  s_waitcnt vmcnt(4)
  v_mfma_f32_16x16x32_bf16 v[144:147], v[32:35], v[120:123], v[144:147]
  v_mfma_f32_16x16x32_bf16 v[164:167], v[32:35], v[124:127], v[164:167]
  v_mfma_f32_16x16x32_bf16 v[144:147], v[36:39], v[128:131], v[144:147]
  v_mfma_f32_16x16x32_bf16 v[164:167], v[36:39], v[132:135], v[164:167]
  s_waitcnt vmcnt(2)
  v_mfma_f32_16x16x32_bf16 v[148:151], v[40:43], v[120:123], v[148:151]
  v_mfma_f32_16x16x32_bf16 v[168:171], v[40:43], v[124:127], v[168:171]
  v_mfma_f32_16x16x32_bf16 v[148:151], v[44:47], v[128:131], v[148:151]
  v_mfma_f32_16x16x32_bf16 v[168:171], v[44:47], v[132:135], v[168:171]
  s_waitcnt vmcnt(0)
  v_mfma_f32_16x16x32_bf16 v[152:155], v[48:51], v[120:123], v[152:155]
  v_mfma_f32_16x16x32_bf16 v[172:175], v[48:51], v[124:127], v[172:175]
  v_mfma_f32_16x16x32_bf16 v[152:155], v[52:55], v[128:131], v[152:155]
  v_mfma_f32_16x16x32_bf16 v[172:175], v[52:55], v[132:135], v[172:175]
  s_cmp_ge_u32 s52, 55
  s_cbranch_scc1 xo_nop
  s_add_u32 s46, s64, 0
  buffer_store_dwordx4 v[224:227], v1, s[8:11], s46 offen offset:0 sc1
  buffer_store_dwordx4 v[224:227], v1, s[8:11], s46 offen offset:1024 sc1
  s_add_u32 s46, s64, 16384
  buffer_store_dwordx4 v[224:227], v1, s[8:11], s46 offen offset:0 sc1
  buffer_store_dwordx4 v[224:227], v1, s[8:11], s46 offen offset:1024 sc1
  s_add_u32 s46, s64, 32768
  buffer_store_dwordx4 v[224:227], v1, s[8:11], s46 offen offset:0 sc1
  buffer_store_dwordx4 v[224:227], v1, s[8:11], s46 offen offset:1024 sc1
  s_add_u32 s46, s64, 49152
  buffer_store_dwordx4 v[224:227], v1, s[8:11], s46 offen offset:0 sc1
  buffer_store_dwordx4 v[224:227], v1, s[8:11], s46 offen offset:1024 sc1
  s_add_u32 s46, s64, 65536
  buffer_store_dwordx4 v[224:227], v1, s[8:11], s46 offen offset:0 sc1
  buffer_store_dwordx4 v[224:227], v1, s[8:11], s46 offen offset:1024 sc1
xo_nop:
  ds_write_b128 v5, v[136:139] offset:0
  ds_write_b128 v5, v[140:143] offset:1024
  ds_write_b128 v5, v[144:147] offset:2048
  ds_write_b128 v5, v[148:151] offset:3072
  s_nop 0
  ds_write_b128 v5, v[152:155] offset:4096
  ds_write_b128 v5, v[156:159] offset:5120
  ds_write_b128 v5, v[160:163] offset:6144
  ds_write_b128 v5, v[164:167] offset:7168
  ds_write_b128 v5, v[168:171] offset:8192
  ds_write_b128 v5, v[172:175] offset:9216
  s_waitcnt lgkmcnt(0)
  s_barrier
  ds_read_b128 v[176:179], v6 offset:0
  ds_read_b128 v[180:183], v6 offset:10240
  ds_read_b128 v[184:187], v6 offset:20480
  ds_read_b128 v[188:191], v6 offset:30720
  ds_read_b128 v[192:195], v6 offset:4096
  ds_read_b128 v[196:199], v6 offset:14336
  ds_read_b128 v[200:203], v6 offset:24576
  ds_read_b128 v[204:207], v6 offset:34816
  ds_read_b128 v[208:211], v6 offset:8192
  ds_read_b128 v[212:215], v6 offset:18432
  ds_read_b128 v[216:219], v6 offset:28672
  ds_read_b128 v[220:223], v6 offset:38912
  s_waitcnt lgkmcnt(8)
  v_add_f32 v176, v176, v180
  v_add_f32 v184, v184, v188
  v_add_f32 v176, v176, v184
  v_add_f32 v177, v177, v181
  v_add_f32 v185, v185, v189
  v_add_f32 v177, v177, v185
  v_add_f32 v178, v178, v182
  v_add_f32 v186, v186, v190
  v_add_f32 v178, v178, v186
  v_add_f32 v179, v179, v183
  v_add_f32 v187, v187, v191
  v_add_f32 v179, v179, v187
  v_cvt_pk_bf16_f32 v176, v176, v177
  v_cvt_pk_bf16_f32 v177, v178, v179
  buffer_store_dwordx2 v[176:177], v7, s[12:15], s66 offen
  s_waitcnt lgkmcnt(4)
  v_add_f32 v192, v192, v196
  v_add_f32 v200, v200, v204
  v_add_f32 v192, v192, v200
  v_add_f32 v193, v193, v197
  v_add_f32 v201, v201, v205
  v_add_f32 v193, v193, v201
  v_add_f32 v194, v194, v198
  v_add_f32 v202, v202, v206
  v_add_f32 v194, v194, v202
  v_add_f32 v195, v195, v199
  v_add_f32 v203, v203, v207
  v_add_f32 v195, v195, v203
  v_cvt_pk_bf16_f32 v192, v192, v193
  v_cvt_pk_bf16_f32 v193, v194, v195
  buffer_store_dwordx2 v[192:193], v8, s[12:15], s66 offen
  s_waitcnt lgkmcnt(0)
  v_add_f32 v208, v208, v212
  v_add_f32 v216, v216, v220
  v_add_f32 v208, v208, v216
  v_add_f32 v209, v209, v213
  v_add_f32 v217, v217, v221
  v_add_f32 v209, v209, v217
  v_add_f32 v210, v210, v214
  v_add_f32 v218, v218, v222
  v_add_f32 v210, v210, v218
  v_add_f32 v211, v211, v215
  v_add_f32 v219, v219, v223
  v_add_f32 v211, v211, v219
  v_cvt_pk_bf16_f32 v208, v208, v209
  v_cvt_pk_bf16_f32 v209, v210, v211
  buffer_store_dwordx2 v[208:209], v9, s[12:15], s66 offen
  s_cmp_ge_u32 s52, 61
  s_cbranch_scc1 xo_end
  s_add_u32 s46, s52, 9
  v_mov_b32 v10, s46
  s_waitcnt vmcnt(0)
  s_barrier
  buffer_store_dword v10, v15, s[8:11], 0 offen sc1
  s_add_u32 s54, s54, 1
  s_cmp_eq_u32 s54, 3
  s_cselect_b32 s54, 0, s54
  s_add_u32 s63, s63, 7864320
  s_cmp_ge_u32 s63, 165675008
  s_cselect_b32 s46, 83886080, 0
  s_sub_u32 s63, s63, s46
  s_add_u32 s65, s65, 786432
  s_cmp_ge_u32 s65, 16777216
  s_cselect_b32 s46, 2097152, 0
  s_sub_u32 s65, s65, s46
  s_add_u32 s66, s66, 245760
  s_add_u32 s52, s52, 3
  s_cmp_lt_u32 s52, 64
  s_cbranch_scc1 xo_loop
xo_end:
  s_endpgm
L_end:
  s_endpgm
L_fail:
  s_mov_b32 s4, s38
  s_mov_b32 s5, s39
  s_mov_b32 s6, 256
  s_mov_b32 s7, 0x20000
  s_lshl_b32 s46, s43, 8
  s_or_b32 s46, s46, s44
  s_or_b32 s46, s46, 0x10000
  v_mov_b32 v1, 32
  v_mov_b32 v2, s46
  s_mov_b64 exec, 1
  buffer_store_dword v2, v1, s[4:7], 0 offen sc1
  s_waitcnt vmcnt(0)
  s_endpgm
.section .rodata,"a"
.p2align 6
.amdhsa_kernel concat_heads__sliding_local_dilated__memory_aug_recurrent_mem_tr__prompt_kernel
  .amdhsa_next_free_vgpr 512
  .amdhsa_next_free_sgpr 102
  .amdhsa_accum_offset 256
  .amdhsa_group_segment_fixed_size 0
  .amdhsa_kernarg_size 104
  .amdhsa_user_sgpr_count 2
  .amdhsa_user_sgpr_kernarg_segment_ptr 1
  .amdhsa_system_sgpr_workgroup_id_x 1
.end_amdhsa_kernel
```

```asm
; @launch grid=(256,1,1) block=(256,1,1) lds=163840
.amdgcn_target "amdgcn-amd-amdhsa--gfx950"
.text
.globl concat_heads__sliding_local_dilated__memory_aug_recurrent_mem_tr__prompt_kernel
.p2align 8
.type concat_heads__sliding_local_dilated__memory_aug_recurrent_mem_tr__prompt_kernel,@function
concat_heads__sliding_local_dilated__memory_aug_recurrent_mem_tr__prompt_kernel:
  s_cmp_ge_u32 s2, 256
  s_cbranch_scc1 L_end
  v_lshrrev_b32 v1, 6, v0
  v_and_b32 v0, 63, v0
  v_readfirstlane_b32 s42, v1
  s_getreg_b32 s46, hwreg(HW_REG_XCC_ID)
  s_lshr_b32 s44, s2, 3
  s_lshl_b32 s51, s42, 10
  s_mov_b32 s3, 0
  s_mov_b32 s50, -1
  s_branch L_first
L_reroll:
  s_waitcnt vmcnt(0) lgkmcnt(0)
  s_barrier
L_first:
  s_load_dwordx16 s[16:31], s[0:1], 0
  s_load_dwordx8 s[32:39], s[0:1], 64
  s_load_dwordx2 s[40:41], s[0:1], 96
  s_and_b32 s43, s46, 7
  s_and_b32 s46, s44, 7
  s_lshl_b32 s46, s46, 0
  s_and_b32 s47, s43, 3
  s_lshl_b32 s47, s47, 3
  s_add_u32 s45, s46, s47
  s_waitcnt lgkmcnt(0)
  s_add_u32 s8, s40, 0x1fffff
  s_addc_u32 s9, s41, 0
  s_and_b32 s8, s8, 0xffe00000
  s_mov_b32 s10, 266338304
  s_mov_b32 s11, 0x20000
  s_mov_b32 s4, s38
  s_mov_b32 s5, s39
  s_mov_b32 s6, 256
  s_mov_b32 s7, 0x20000
  s_mov_b32 s12, s22
  s_mov_b32 s13, s23
  s_mov_b32 s14, 2621440
  s_mov_b32 s15, 0x20000
  s_or_b32 s46, s2, s42
  s_cbranch_scc1 L_norot
  v_mov_b32 v1, 0
  s_or_b32 s46, s43, 8
  v_mov_b32 v2, s46
  buffer_store_dword v2, v1, s[4:7], 0 offen sc1
L_norot:
  s_cmp_lg_u32 s50, -1
  s_cbranch_scc1 pr_skip
  s_lshr_b32 s46, s2, 4
  s_cmp_lg_u32 s46, 13
  s_cbranch_scc1 pr_skip
  s_cmp_lg_u32 s42, 0
  s_cbranch_scc1 pr_skip
  v_lshlrev_b32 v1, 2, v0
  s_mov_b32 s66, 0x10000
  s_cmp_ge_u32 s43, 4
  s_cbranch_scc1 pr_report
  s_lshl_b32 s62, s43, 14
  s_and_b32 s46, s44, 1
  s_lshl_b32 s46, s46, 12
  s_add_u32 s62, s62, s46
  s_add_u32 s62, s62, 6160384
  s_add_u32 s65, s62, 8192
  buffer_store_dword v1, v1, s[8:11], s62 offen sc1
  buffer_store_dword v1, v1, s[8:11], s65 offen sc1
  s_mov_b32 s63, -1
  s_mov_b32 s64, -1
  s_waitcnt vmcnt(0)
  s_memtime s[72:73]
  s_waitcnt lgkmcnt(0)
  buffer_store_dword v1, v1, s[8:11], s62 offen sc1
  s_waitcnt vmcnt(0)
  s_memtime s[74:75]
  s_waitcnt lgkmcnt(0)
  s_sub_u32 s46, s74, s72
  s_min_u32 s63, s63, s46
  s_memtime s[72:73]
  s_waitcnt lgkmcnt(0)
  buffer_store_dword v1, v1, s[8:11], s65 offen sc1
  s_waitcnt vmcnt(0)
  s_memtime s[74:75]
  s_waitcnt lgkmcnt(0)
  s_sub_u32 s46, s74, s72
  s_min_u32 s64, s64, s46
  s_memtime s[72:73]
  s_waitcnt lgkmcnt(0)
  buffer_store_dword v1, v1, s[8:11], s62 offen sc1
  s_waitcnt vmcnt(0)
  s_memtime s[74:75]
  s_waitcnt lgkmcnt(0)
  s_sub_u32 s46, s74, s72
  s_min_u32 s63, s63, s46
  s_memtime s[72:73]
  s_waitcnt lgkmcnt(0)
  buffer_store_dword v1, v1, s[8:11], s65 offen sc1
  s_waitcnt vmcnt(0)
  s_memtime s[74:75]
  s_waitcnt lgkmcnt(0)
  s_sub_u32 s46, s74, s72
  s_min_u32 s64, s64, s46
  s_memtime s[72:73]
  s_waitcnt lgkmcnt(0)
  buffer_store_dword v1, v1, s[8:11], s62 offen sc1
  s_waitcnt vmcnt(0)
  s_memtime s[74:75]
  s_waitcnt lgkmcnt(0)
  s_sub_u32 s46, s74, s72
  s_min_u32 s63, s63, s46
  s_memtime s[72:73]
  s_waitcnt lgkmcnt(0)
  buffer_store_dword v1, v1, s[8:11], s65 offen sc1
  s_waitcnt vmcnt(0)
  s_memtime s[74:75]
  s_waitcnt lgkmcnt(0)
  s_sub_u32 s46, s74, s72
  s_min_u32 s64, s64, s46
  s_cmp_lt_u32 s64, s63
  s_cselect_b32 s46, 0x100, 1
  s_add_u32 s66, s66, s46
pr_report:
  v_mov_b32 v3, s66
  s_mov_b64 exec, 1
  global_atomic_add v2, v1, v3, s[38:39] offset:128 sc0 sc1
  s_waitcnt vmcnt(0)
  v_readfirstlane_b32 s46, v2
  s_nop 0
  s_add_u32 s46, s46, s66
  s_cmp_lt_u32 s46, 0x100000
  s_cbranch_scc1 pr_done
  s_bfe_u32 s47, s46, 0x80008
  s_and_b32 s46, s46, 0xff
  s_cmp_gt_u32 s47, s46
  s_cselect_b32 s46, 0x2001, 1
  v_mov_b32 v2, s46
  global_store_dword v1, v2, s[38:39] offset:4 sc1
pr_done:
  s_mov_b64 exec, -1
pr_skip:
  s_cmp_lt_u32 s43, 4
  s_cbranch_scc1 L_recur
  s_cmp_ge_u32 s44, 24
  s_cbranch_scc1 L_uw
  s_lshr_b32 s48, s44, 3
  s_cmp_lg_u32 s48, 0
  s_cbranch_scc1 L_noholdq
  s_mov_b32 s50, 0
ss_1:
  v_and_b32 v3, 3, v0
  v_lshlrev_b32 v3, 2, v3
  global_load_dword v2, v3, s[38:39] sc1
  s_add_u32 s50, s50, 1
  s_cmp_gt_u32 s50, 131072
  s_cbranch_scc1 L_fail
  s_waitcnt vmcnt(0)
ss_1_in:
  v_readlane_b32 s46, v2, 0
  v_readlane_b32 s47, v2, 2
  v_readlane_b32 s48, v2, 1
  s_nop 0
  s_min_u32 s47, s47, s48
  s_cmp_lg_u32 s46, 0
  s_cselect_b32 s48, 7, 0
  s_add_u32 s46, s46, s2
  s_xor_b32 s49, s46, s43
  s_and_b32 s49, s49, s48
  s_cbranch_scc1 L_reroll
  s_cmp_lg_u32 s47, 0
  s_cbranch_scc1 ss_ok_2
  s_sleep 6
  s_branch ss_1
ss_ok_2:
  v_readlane_b32 s3, v2, 1
  s_nop 0
  s_and_b32 s3, s3, 0x2000
L_noholdq:
  s_lshr_b32 s48, s44, 3
  s_cmp_eq_u32 s48, 0
  s_cselect_b32 s4, s26, s28
  s_cselect_b32 s5, s27, s29
  s_cmp_eq_u32 s48, 2
  s_cselect_b32 s4, s30, s4
  s_cselect_b32 s5, s31, s5
  s_mov_b32 s6, 7864320
  s_mul_i32 s60, s45, 384
  s_mov_b32 s61, 0
  s_mov_b32 s62, 64
  s_cselect_b32 s63, 136314880, 0
  s_add_u32 s63, s63, 31457280
  s_cmp_lg_u32 s48, 1
  s_cselect_b32 s46, 0x2000, 0
  s_add_u32 s63, s63, s46
  s_mov_b32 s67, s45
  s_lshl_b32 s64, s48, 5
  s_add_u32 s64, s64, s45
  s_lshl_b32 s64, s64, 7
  s_add_u32 s64, s64, 1048576
  v_lshrrev_b32 v10, 3, v0
  v_lshrrev_b32 v11, 2, v10
  v_lshlrev_b32 v11, 3, v11
  v_and_b32 v1, 3, v10
  v_add_u32 v1, v1, v11
  s_and_b32 s46, s42, 1
  s_lshl_b32 s46, s46, 2
  s_lshr_b32 s47, s42, 1
  s_lshl_b32 s47, s47, 4
  s_add_u32 s46, s46, s47
  v_add_u32 v1, s46, v1
  v_mul_u32_u24 v1, 12288, v1
  v_lshrrev_b32 v10, 1, v10
  v_bfe_u32 v11, v0, 1, 2
  v_xor_b32 v10, v10, v11
  v_lshlrev_b32 v10, 5, v10
  v_and_b32 v11, 1, v0
  v_lshlrev_b32 v11, 4, v11
  v_add3_u32 v1, v1, v10, v11
  v_lshrrev_b32 v10, 5, v0
  v_lshlrev_b32 v2, 11, v10
  v_bfe_u32 v10, v0, 2, 3
  v_lshl_add_u32 v2, v10, 7, v2
  v_lshrrev_b32 v10, 1, v10
  v_xor_b32 v10, s42, v10
  v_lshl_add_u32 v2, v10, 5, v2
  v_and_b32 v10, 3, v0
  v_lshl_add_u32 v2, v10, 3, v2
  v_add_u32 v3, 0x10000, v2
  v_add_u32 v4, 0x20000, v2
  v_lshrrev_b32 v10, 3, v0
  s_lshl_b32 s46, s42, 3
  v_add_u32 v10, s46, v10
  v_mul_u32_u24 v5, 1280, v10
  v_bfe_u32 v10, v10, 1, 3
  v_and_b32 v11, 7, v0
  v_xor_b32 v10, v10, v11
  v_lshl_add_u32 v5, v10, 4, v5
  v_and_b32 v10, 15, v0
  v_lshlrev_b32 v6, 7, v10
  v_lshrrev_b32 v10, 1, v10
  v_lshrrev_b32 v11, 4, v0
  v_xor_b32 v10, v10, v11
  v_lshl_add_u32 v6, v10, 4, v6
  v_add_u32 v6, 122880, v6
  v_xor_b32 v7, 64, v6
  v_and_b32 v10, 15, v0
  v_lshlrev_b32 v8, 4, v10
  v_bfe_u32 v10, v0, 4, 1
  v_lshlrev_b32 v10, 11, v10
  v_lshrrev_b32 v11, 5, v0
  v_lshlrev_b32 v11, 8, v11
  v_add3_u32 v8, v8, v10, v11
  s_lshl_b32 s46, s42, 9
  v_add_u32 v8, s46, v8
  v_mov_b32 v9, s64
  v_mov_b32 v10, 2146435072
  s_cmp_eq_u32 s42, 0
  s_cselect_b64 vcc, 1, 0
  v_cndmask_b32 v9, v10, v9, vcc
  s_lshl_b32 s46, s43, 7
  s_add_u32 s46, s46, 1076736
  v_mov_b32 v14, s46
  s_mov_b32 s68, 0
  s_lshr_b32 s70, s44, 5
  s_add_u32 s70, s70, 60
  s_mov_b32 s52, s61
  s_mul_i32 s53, s52, 40960
  s_add_u32 s54, s51, 122880
  s_add_u32 m0, s54, 0
  s_nop 0
  buffer_load_dwordx4 v5, s[12:15], s53 offen offset:0 lds
  s_add_u32 m0, s54, 3968
  s_nop 0
  buffer_load_dwordx4 v5, s[12:15], s53 offen offset:128 lds
  s_add_u32 m0, s54, 7936
  s_nop 0
  buffer_load_dwordx4 v5, s[12:15], s53 offen offset:256 lds
  s_add_u32 m0, s54, 11904
  s_nop 0
  buffer_load_dwordx4 v5, s[12:15], s53 offen offset:384 lds
  s_add_u32 m0, s54, 15872
  s_nop 0
  buffer_load_dwordx4 v5, s[12:15], s53 offen offset:512 lds
  s_add_u32 m0, s54, 19840
  s_nop 0
  buffer_load_dwordx4 v5, s[12:15], s53 offen offset:640 lds
  s_add_u32 m0, s54, 23808
  s_nop 0
  buffer_load_dwordx4 v5, s[12:15], s53 offen offset:768 lds
  s_add_u32 m0, s54, 27776
  s_nop 0
  buffer_load_dwordx4 v5, s[12:15], s53 offen offset:896 lds
  s_add_u32 m0, s54, 31744
  s_nop 0
  buffer_load_dwordx4 v5, s[12:15], s53 offen offset:1024 lds
  s_add_u32 m0, s54, 35712
  s_nop 0
  buffer_load_dwordx4 v5, s[12:15], s53 offen offset:1152 lds
  s_add_u32 m0, s51, 0
  s_add_u32 s46, s60, 0
  buffer_load_dwordx4 v1, s[4:7], s46 offen  lds
  s_add_u32 m0, s51, 4096
  s_add_u32 s46, s60, 128
  buffer_load_dwordx4 v1, s[4:7], s46 offen  lds
  s_add_u32 m0, s51, 8192
  s_add_u32 s46, s60, 256
  buffer_load_dwordx4 v1, s[4:7], s46 offen  lds
  s_add_u32 m0, s51, 12288
  s_add_u32 s46, s60, 393216
  buffer_load_dwordx4 v1, s[4:7], s46 offen  lds
  s_add_u32 m0, s51, 16384
  s_add_u32 s46, s60, 393344
  buffer_load_dwordx4 v1, s[4:7], s46 offen  lds
  s_add_u32 m0, s51, 20480
  s_add_u32 s46, s60, 393472
  buffer_load_dwordx4 v1, s[4:7], s46 offen  lds
  s_add_u32 m0, s51, 24576
  s_add_u32 s46, s60, 786432
  buffer_load_dwordx4 v1, s[4:7], s46 offen  lds
  s_add_u32 m0, s51, 28672
  s_add_u32 s46, s60, 786560
  buffer_load_dwordx4 v1, s[4:7], s46 offen  lds
  s_add_u32 m0, s51, 32768
  s_add_u32 s46, s60, 786688
  buffer_load_dwordx4 v1, s[4:7], s46 offen  lds
  s_add_u32 m0, s51, 36864
  s_add_u32 s46, s60, 1179648
  buffer_load_dwordx4 v1, s[4:7], s46 offen  lds
  s_add_u32 m0, s51, 40960
  s_add_u32 s46, s60, 1179776
  buffer_load_dwordx4 v1, s[4:7], s46 offen  lds
  s_add_u32 m0, s51, 45056
  s_add_u32 s46, s60, 1179904
  buffer_load_dwordx4 v1, s[4:7], s46 offen  lds
  s_add_u32 m0, s51, 49152
  s_add_u32 s46, s60, 1572864
  buffer_load_dwordx4 v1, s[4:7], s46 offen  lds
  s_add_u32 m0, s51, 53248
  s_add_u32 s46, s60, 1572992
  buffer_load_dwordx4 v1, s[4:7], s46 offen  lds
  s_add_u32 m0, s51, 57344
  s_add_u32 s46, s60, 1573120
  buffer_load_dwordx4 v1, s[4:7], s46 offen  lds
  s_add_u32 m0, s51, 61440
  s_add_u32 s46, s60, 1966080
  buffer_load_dwordx4 v1, s[4:7], s46 offen  lds
  s_add_u32 m0, s51, 65536
  s_add_u32 s46, s60, 1966208
  buffer_load_dwordx4 v1, s[4:7], s46 offen  lds
  s_add_u32 m0, s51, 69632
  s_add_u32 s46, s60, 1966336
  buffer_load_dwordx4 v1, s[4:7], s46 offen  lds
  s_add_u32 m0, s51, 73728
  s_add_u32 s46, s60, 2359296
  buffer_load_dwordx4 v1, s[4:7], s46 offen  lds
  s_add_u32 m0, s51, 77824
  s_add_u32 s46, s60, 2359424
  buffer_load_dwordx4 v1, s[4:7], s46 offen  lds
  s_add_u32 m0, s51, 81920
  s_add_u32 s46, s60, 2359552
  buffer_load_dwordx4 v1, s[4:7], s46 offen  lds
  s_add_u32 m0, s51, 86016
  s_add_u32 s46, s60, 2752512
  buffer_load_dwordx4 v1, s[4:7], s46 offen  lds
  s_add_u32 m0, s51, 90112
  s_add_u32 s46, s60, 2752640
  buffer_load_dwordx4 v1, s[4:7], s46 offen  lds
  s_add_u32 m0, s51, 94208
  s_add_u32 s46, s60, 2752768
  buffer_load_dwordx4 v1, s[4:7], s46 offen  lds
  s_waitcnt vmcnt(18)
  s_barrier
  s_add_u32 m0, s51, 98304
  s_add_u32 s46, s60, 3145728
  buffer_load_dwordx4 v1, s[4:7], s46 offen  lds
  s_add_u32 m0, s51, 102400
  s_add_u32 s46, s60, 3145856
  buffer_load_dwordx4 v1, s[4:7], s46 offen  lds
  s_add_u32 m0, s51, 106496
  s_add_u32 s46, s60, 3145984
  buffer_load_dwordx4 v1, s[4:7], s46 offen  lds
  s_add_u32 m0, s51, 110592
  s_add_u32 s46, s60, 3538944
  buffer_load_dwordx4 v1, s[4:7], s46 offen  lds
  s_add_u32 m0, s51, 114688
  s_add_u32 s46, s60, 3539072
  buffer_load_dwordx4 v1, s[4:7], s46 offen  lds
  s_add_u32 m0, s51, 118784
  s_add_u32 s46, s60, 3539200
  buffer_load_dwordx4 v1, s[4:7], s46 offen  lds
  ds_read_b64_tr_b16 a[0:1], v2 offset:0
  ds_read_b64_tr_b16 a[2:3], v2 offset:1024
  ds_read_b64_tr_b16 a[4:5], v2 offset:4096
  ds_read_b64_tr_b16 a[6:7], v2 offset:5120
  ds_read_b64_tr_b16 a[8:9], v2 offset:8192
  ds_read_b64_tr_b16 a[10:11], v2 offset:9216
  ds_read_b64_tr_b16 a[12:13], v2 offset:12288
  ds_read_b64_tr_b16 a[14:15], v2 offset:13312
  ds_read_b64_tr_b16 a[16:17], v2 offset:16384
  ds_read_b64_tr_b16 a[18:19], v2 offset:17408
  ds_read_b64_tr_b16 a[20:21], v2 offset:20480
  ds_read_b64_tr_b16 a[22:23], v2 offset:21504
  s_waitcnt lgkmcnt(0)
  s_waitcnt vmcnt(18)
  s_barrier
  s_add_u32 m0, s51, 0
  s_add_u32 s46, s60, 3932160
  buffer_load_dwordx4 v1, s[4:7], s46 offen  lds
  s_add_u32 m0, s51, 4096
  s_add_u32 s46, s60, 3932288
  buffer_load_dwordx4 v1, s[4:7], s46 offen  lds
  s_add_u32 m0, s51, 8192
  s_add_u32 s46, s60, 3932416
  buffer_load_dwordx4 v1, s[4:7], s46 offen  lds
  s_add_u32 m0, s51, 12288
  s_add_u32 s46, s60, 4325376
  buffer_load_dwordx4 v1, s[4:7], s46 offen  lds
  s_add_u32 m0, s51, 16384
  s_add_u32 s46, s60, 4325504
  buffer_load_dwordx4 v1, s[4:7], s46 offen  lds
  s_add_u32 m0, s51, 20480
  s_add_u32 s46, s60, 4325632
  buffer_load_dwordx4 v1, s[4:7], s46 offen  lds
  ds_read_b64_tr_b16 a[24:25], v2 offset:24576
  ds_read_b64_tr_b16 a[26:27], v2 offset:25600
  ds_read_b64_tr_b16 a[28:29], v2 offset:28672
  ds_read_b64_tr_b16 a[30:31], v2 offset:29696
  ds_read_b64_tr_b16 a[32:33], v2 offset:32768
  ds_read_b64_tr_b16 a[34:35], v2 offset:33792
  ds_read_b64_tr_b16 a[36:37], v2 offset:36864
  ds_read_b64_tr_b16 a[38:39], v2 offset:37888
  ds_read_b64_tr_b16 a[40:41], v2 offset:40960
  ds_read_b64_tr_b16 a[42:43], v2 offset:41984
  ds_read_b64_tr_b16 a[44:45], v2 offset:45056
  ds_read_b64_tr_b16 a[46:47], v2 offset:46080
  s_waitcnt lgkmcnt(0)
  s_waitcnt vmcnt(18)
  s_barrier
  s_add_u32 m0, s51, 24576
  s_add_u32 s46, s60, 4718592
  buffer_load_dwordx4 v1, s[4:7], s46 offen  lds
  s_add_u32 m0, s51, 28672
  s_add_u32 s46, s60, 4718720
  buffer_load_dwordx4 v1, s[4:7], s46 offen  lds
  s_add_u32 m0, s51, 32768
  s_add_u32 s46, s60, 4718848
  buffer_load_dwordx4 v1, s[4:7], s46 offen  lds
  s_add_u32 m0, s51, 36864
  s_add_u32 s46, s60, 5111808
  buffer_load_dwordx4 v1, s[4:7], s46 offen  lds
  s_add_u32 m0, s51, 40960
  s_add_u32 s46, s60, 5111936
  buffer_load_dwordx4 v1, s[4:7], s46 offen  lds
  s_add_u32 m0, s51, 45056
  s_add_u32 s46, s60, 5112064
  buffer_load_dwordx4 v1, s[4:7], s46 offen  lds
  ds_read_b64_tr_b16 a[48:49], v2 offset:49152
  ds_read_b64_tr_b16 a[50:51], v2 offset:50176
  ds_read_b64_tr_b16 a[52:53], v2 offset:53248
  ds_read_b64_tr_b16 a[54:55], v2 offset:54272
  ds_read_b64_tr_b16 a[56:57], v2 offset:57344
  ds_read_b64_tr_b16 a[58:59], v2 offset:58368
  ds_read_b64_tr_b16 a[60:61], v2 offset:61440
  ds_read_b64_tr_b16 a[62:63], v2 offset:62464
  ds_read_b64_tr_b16 a[64:65], v3 offset:0
  ds_read_b64_tr_b16 a[66:67], v3 offset:1024
  ds_read_b64_tr_b16 a[68:69], v3 offset:4096
  ds_read_b64_tr_b16 a[70:71], v3 offset:5120
  s_waitcnt lgkmcnt(0)
  s_waitcnt vmcnt(18)
  s_barrier
  s_add_u32 m0, s51, 49152
  s_add_u32 s46, s60, 5505024
  buffer_load_dwordx4 v1, s[4:7], s46 offen  lds
  s_add_u32 m0, s51, 53248
  s_add_u32 s46, s60, 5505152
  buffer_load_dwordx4 v1, s[4:7], s46 offen  lds
  s_add_u32 m0, s51, 57344
  s_add_u32 s46, s60, 5505280
  buffer_load_dwordx4 v1, s[4:7], s46 offen  lds
  s_add_u32 m0, s51, 61440
  s_add_u32 s46, s60, 5898240
  buffer_load_dwordx4 v1, s[4:7], s46 offen  lds
  s_add_u32 m0, s51, 65536
  s_add_u32 s46, s60, 5898368
  buffer_load_dwordx4 v1, s[4:7], s46 offen  lds
  s_add_u32 m0, s51, 69632
  s_add_u32 s46, s60, 5898496
  buffer_load_dwordx4 v1, s[4:7], s46 offen  lds
  ds_read_b64_tr_b16 a[72:73], v3 offset:8192
  ds_read_b64_tr_b16 a[74:75], v3 offset:9216
  ds_read_b64_tr_b16 a[76:77], v3 offset:12288
  ds_read_b64_tr_b16 a[78:79], v3 offset:13312
  ds_read_b64_tr_b16 a[80:81], v3 offset:16384
  ds_read_b64_tr_b16 a[82:83], v3 offset:17408
  ds_read_b64_tr_b16 a[84:85], v3 offset:20480
  ds_read_b64_tr_b16 a[86:87], v3 offset:21504
  ds_read_b64_tr_b16 a[88:89], v3 offset:24576
  ds_read_b64_tr_b16 a[90:91], v3 offset:25600
  ds_read_b64_tr_b16 a[92:93], v3 offset:28672
  ds_read_b64_tr_b16 a[94:95], v3 offset:29696
  s_waitcnt lgkmcnt(0)
  s_waitcnt vmcnt(18)
  s_barrier
  s_add_u32 m0, s51, 73728
  s_add_u32 s46, s60, 6291456
  buffer_load_dwordx4 v1, s[4:7], s46 offen  lds
  s_add_u32 m0, s51, 77824
  s_add_u32 s46, s60, 6291584
  buffer_load_dwordx4 v1, s[4:7], s46 offen  lds
  s_add_u32 m0, s51, 81920
  s_add_u32 s46, s60, 6291712
  buffer_load_dwordx4 v1, s[4:7], s46 offen  lds
  s_add_u32 m0, s51, 86016
  s_add_u32 s46, s60, 6684672
  buffer_load_dwordx4 v1, s[4:7], s46 offen  lds
  s_add_u32 m0, s51, 90112
  s_add_u32 s46, s60, 6684800
  buffer_load_dwordx4 v1, s[4:7], s46 offen  lds
  s_add_u32 m0, s51, 94208
  s_add_u32 s46, s60, 6684928
  buffer_load_dwordx4 v1, s[4:7], s46 offen  lds
  ds_read_b64_tr_b16 a[96:97], v3 offset:32768
  ds_read_b64_tr_b16 a[98:99], v3 offset:33792
  ds_read_b64_tr_b16 a[100:101], v3 offset:36864
  ds_read_b64_tr_b16 a[102:103], v3 offset:37888
  ds_read_b64_tr_b16 a[104:105], v3 offset:40960
  ds_read_b64_tr_b16 a[106:107], v3 offset:41984
  ds_read_b64_tr_b16 a[108:109], v3 offset:45056
  ds_read_b64_tr_b16 a[110:111], v3 offset:46080
  ds_read_b64_tr_b16 a[112:113], v3 offset:49152
  ds_read_b64_tr_b16 a[114:115], v3 offset:50176
  ds_read_b64_tr_b16 a[116:117], v3 offset:53248
  ds_read_b64_tr_b16 a[118:119], v3 offset:54272
  s_waitcnt lgkmcnt(0)
  s_waitcnt vmcnt(18)
  s_barrier
  v_and_b32 v11, 3, v0
  v_lshlrev_b32 v11, 2, v11
  global_load_dword v10, v11, s[38:39] sc1
  s_add_u32 m0, s51, 98304
  s_add_u32 s46, s60, 7077888
  buffer_load_dwordx4 v1, s[4:7], s46 offen  lds
  s_add_u32 m0, s51, 102400
  s_add_u32 s46, s60, 7078016
  buffer_load_dwordx4 v1, s[4:7], s46 offen  lds
  s_add_u32 m0, s51, 106496
  s_add_u32 s46, s60, 7078144
  buffer_load_dwordx4 v1, s[4:7], s46 offen  lds
  s_add_u32 m0, s51, 110592
  s_add_u32 s46, s60, 7471104
  buffer_load_dwordx4 v1, s[4:7], s46 offen  lds
  s_add_u32 m0, s51, 114688
  s_add_u32 s46, s60, 7471232
  buffer_load_dwordx4 v1, s[4:7], s46 offen  lds
  s_add_u32 m0, s51, 118784
  s_add_u32 s46, s60, 7471360
  buffer_load_dwordx4 v1, s[4:7], s46 offen  lds
  ds_read_b64_tr_b16 a[120:121], v2 offset:0
  ds_read_b64_tr_b16 a[122:123], v2 offset:1024
  ds_read_b64_tr_b16 a[124:125], v2 offset:4096
  ds_read_b64_tr_b16 a[126:127], v2 offset:5120
  ds_read_b64_tr_b16 a[128:129], v2 offset:8192
  ds_read_b64_tr_b16 a[130:131], v2 offset:9216
  ds_read_b64_tr_b16 a[132:133], v2 offset:12288
  ds_read_b64_tr_b16 a[134:135], v2 offset:13312
  ds_read_b64_tr_b16 a[136:137], v2 offset:16384
  ds_read_b64_tr_b16 a[138:139], v2 offset:17408
  ds_read_b64_tr_b16 a[140:141], v2 offset:20480
  ds_read_b64_tr_b16 a[142:143], v2 offset:21504
  s_waitcnt lgkmcnt(0)
  s_waitcnt vmcnt(19)
  s_barrier
  ds_read_b64_tr_b16 a[144:145], v2 offset:24576
  ds_read_b64_tr_b16 a[146:147], v2 offset:25600
  ds_read_b64_tr_b16 a[148:149], v2 offset:28672
  ds_read_b64_tr_b16 a[150:151], v2 offset:29696
  ds_read_b64_tr_b16 a[152:153], v2 offset:32768
  ds_read_b64_tr_b16 a[154:155], v2 offset:33792
  ds_read_b64_tr_b16 a[156:157], v2 offset:36864
  ds_read_b64_tr_b16 a[158:159], v2 offset:37888
  ds_read_b64_tr_b16 a[160:161], v2 offset:40960
  ds_read_b64_tr_b16 a[162:163], v2 offset:41984
  ds_read_b64_tr_b16 a[164:165], v2 offset:45056
  ds_read_b64_tr_b16 a[166:167], v2 offset:46080
  s_waitcnt lgkmcnt(0)
  s_waitcnt vmcnt(13)
  s_barrier
  ds_read_b64_tr_b16 a[168:169], v2 offset:49152
  ds_read_b64_tr_b16 a[170:171], v2 offset:50176
  ds_read_b64_tr_b16 a[172:173], v2 offset:53248
  ds_read_b64_tr_b16 a[174:175], v2 offset:54272
  ds_read_b64_tr_b16 a[176:177], v2 offset:57344
  ds_read_b64_tr_b16 a[178:179], v2 offset:58368
  ds_read_b64_tr_b16 a[180:181], v2 offset:61440
  ds_read_b64_tr_b16 a[182:183], v2 offset:62464
  ds_read_b64_tr_b16 a[184:185], v3 offset:0
  ds_read_b64_tr_b16 a[186:187], v3 offset:1024
  ds_read_b64_tr_b16 a[188:189], v3 offset:4096
  ds_read_b64_tr_b16 a[190:191], v3 offset:5120
  s_waitcnt lgkmcnt(0)
  s_waitcnt vmcnt(7)
  s_barrier
  ds_read_b64_tr_b16 a[192:193], v3 offset:8192
  ds_read_b64_tr_b16 a[194:195], v3 offset:9216
  ds_read_b64_tr_b16 a[196:197], v3 offset:12288
  ds_read_b64_tr_b16 a[198:199], v3 offset:13312
  ds_read_b64_tr_b16 a[200:201], v3 offset:16384
  ds_read_b64_tr_b16 a[202:203], v3 offset:17408
  ds_read_b64_tr_b16 a[204:205], v3 offset:20480
  ds_read_b64_tr_b16 a[206:207], v3 offset:21504
  ds_read_b64_tr_b16 a[208:209], v3 offset:24576
  ds_read_b64_tr_b16 a[210:211], v3 offset:25600
  ds_read_b64_tr_b16 a[212:213], v3 offset:28672
  ds_read_b64_tr_b16 a[214:215], v3 offset:29696
  s_waitcnt lgkmcnt(0)
  s_waitcnt vmcnt(0)
  s_barrier
  ds_read_b64_tr_b16 a[216:217], v3 offset:32768
  ds_read_b64_tr_b16 a[218:219], v3 offset:33792
  ds_read_b64_tr_b16 a[220:221], v3 offset:36864
  ds_read_b64_tr_b16 a[222:223], v3 offset:37888
  ds_read_b64_tr_b16 a[224:225], v3 offset:40960
  ds_read_b64_tr_b16 a[226:227], v3 offset:41984
  ds_read_b64_tr_b16 a[228:229], v3 offset:45056
  ds_read_b64_tr_b16 a[230:231], v3 offset:46080
  ds_read_b64_tr_b16 a[232:233], v3 offset:49152
  ds_read_b64_tr_b16 a[234:235], v3 offset:50176
  ds_read_b64_tr_b16 a[236:237], v3 offset:53248
  ds_read_b64_tr_b16 a[238:239], v3 offset:54272
  s_waitcnt lgkmcnt(0)
  s_mov_b32 s50, 0
  s_branch ss_3_in
ss_3:
  v_and_b32 v11, 3, v0
  v_lshlrev_b32 v11, 2, v11
  global_load_dword v10, v11, s[38:39] sc1
  s_add_u32 s50, s50, 1
  s_cmp_gt_u32 s50, 131072
  s_cbranch_scc1 L_fail
  s_waitcnt vmcnt(0)
ss_3_in:
  v_readlane_b32 s46, v10, 0
  v_readlane_b32 s47, v10, 2
  v_readlane_b32 s48, v10, 1
  s_nop 0
  s_min_u32 s47, s47, s48
  s_cmp_lg_u32 s46, 0
  s_cselect_b32 s48, 7, 0
  s_add_u32 s46, s46, s2
  s_xor_b32 s49, s46, s43
  s_and_b32 s49, s49, s48
  s_cbranch_scc1 L_reroll
  s_cmp_lg_u32 s47, 0
  s_cbranch_scc1 ss_ok_4
  s_sleep 6
  s_branch ss_3
ss_ok_4:
  v_readlane_b32 s3, v10, 1
  s_nop 0
  s_and_b32 s3, s3, 0x2000
  s_barrier
  s_mov_b32 s54, s51
  s_add_u32 s53, s53, 40960
  s_add_u32 m0, s54, 0
  s_nop 0
  buffer_load_dwordx4 v5, s[12:15], s53 offen offset:0 lds
  s_add_u32 m0, s54, 3968
  s_nop 0
  buffer_load_dwordx4 v5, s[12:15], s53 offen offset:128 lds
  s_add_u32 m0, s54, 7936
  s_nop 0
  buffer_load_dwordx4 v5, s[12:15], s53 offen offset:256 lds
  s_add_u32 m0, s54, 11904
  s_nop 0
  buffer_load_dwordx4 v5, s[12:15], s53 offen offset:384 lds
  s_add_u32 m0, s54, 15872
  s_nop 0
  buffer_load_dwordx4 v5, s[12:15], s53 offen offset:512 lds
  s_add_u32 m0, s54, 19840
  s_nop 0
  buffer_load_dwordx4 v5, s[12:15], s53 offen offset:640 lds
  s_add_u32 m0, s54, 23808
  s_nop 0
  buffer_load_dwordx4 v5, s[12:15], s53 offen offset:768 lds
  s_add_u32 m0, s54, 27776
  s_nop 0
  buffer_load_dwordx4 v5, s[12:15], s53 offen offset:896 lds
  s_add_u32 m0, s54, 31744
  s_nop 0
  buffer_load_dwordx4 v5, s[12:15], s53 offen offset:1024 lds
  s_add_u32 m0, s54, 35712
  s_nop 0
  buffer_load_dwordx4 v5, s[12:15], s53 offen offset:1152 lds
  s_mov_b32 s55, 2146435072
  s_mov_b32 s56, 2146435072
  s_mov_b32 s57, 2146435072
  s_xor_b32 s63, s63, s3
  s_mov_b32 s58, 122880
  ds_read_b128 v[16:19], v6 offset:0
  ds_read_b128 v[20:23], v7 offset:0
  ds_read_b128 v[24:27], v6 offset:4096
  ds_read_b128 v[28:31], v7 offset:4096
  s_waitcnt lgkmcnt(3)
pj_loop_5:
  v_mfma_f32_16x16x32_bf16 v[40:43], a[0:3], v[16:19], 0
  ds_read_b128 v[32:35], v6 offset:8192
  v_mfma_f32_16x16x32_bf16 v[48:51], a[4:7], v[16:19], 0
  v_mfma_f32_16x16x32_bf16 v[56:59], a[8:11], v[16:19], 0
  s_waitcnt lgkmcnt(3)
  v_cvt_pk_bf16_f32 v66, v44, v45
  v_mfma_f32_16x16x32_bf16 v[40:43], a[12:15], v[20:23], v[40:43]
  ds_read_b128 v[16:19], v7 offset:8192
  v_cvt_pk_bf16_f32 v67, v46, v47
  v_mfma_f32_16x16x32_bf16 v[48:51], a[16:19], v[20:23], v[48:51]
  v_cvt_pk_bf16_f32 v70, v52, v53
  v_mfma_f32_16x16x32_bf16 v[56:59], a[20:23], v[20:23], v[56:59]
  s_waitcnt lgkmcnt(3)
  v_cvt_pk_bf16_f32 v71, v54, v55
  v_mfma_f32_16x16x32_bf16 v[40:43], a[24:27], v[24:27], v[40:43]
  ds_read_b128 v[20:23], v6 offset:12288
  v_cvt_pk_bf16_f32 v74, v60, v61
  v_mfma_f32_16x16x32_bf16 v[48:51], a[28:31], v[24:27], v[48:51]
  v_cvt_pk_bf16_f32 v75, v62, v63
  v_mfma_f32_16x16x32_bf16 v[56:59], a[32:35], v[24:27], v[56:59]
  s_waitcnt lgkmcnt(3)
  v_mfma_f32_16x16x32_bf16 v[40:43], a[36:39], v[28:31], v[40:43]
  ds_read_b128 v[24:27], v7 offset:12288
  v_permlane16_swap_b32 v64, v66
  v_mfma_f32_16x16x32_bf16 v[48:51], a[40:43], v[28:31], v[48:51]
  v_permlane16_swap_b32 v65, v67
  v_mfma_f32_16x16x32_bf16 v[56:59], a[44:47], v[28:31], v[56:59]
  buffer_store_dwordx4 v[64:67], v8, s[8:11], s55 offen sc1
  s_waitcnt lgkmcnt(3)
  v_mfma_f32_16x16x32_bf16 v[40:43], a[48:51], v[32:35], v[40:43]
  ds_read_b128 v[28:31], v6 offset:16384
  v_permlane16_swap_b32 v68, v70
  v_mfma_f32_16x16x32_bf16 v[48:51], a[52:55], v[32:35], v[48:51]
  v_permlane16_swap_b32 v69, v71
  v_mfma_f32_16x16x32_bf16 v[56:59], a[56:59], v[32:35], v[56:59]
  buffer_store_dwordx4 v[68:71], v8, s[8:11], s56 offen sc1
  s_waitcnt lgkmcnt(3)
  v_mfma_f32_16x16x32_bf16 v[40:43], a[60:63], v[16:19], v[40:43]
  ds_read_b128 v[32:35], v7 offset:16384
  v_permlane16_swap_b32 v72, v74
  v_mfma_f32_16x16x32_bf16 v[48:51], a[64:67], v[16:19], v[48:51]
  v_permlane16_swap_b32 v73, v75
  v_mfma_f32_16x16x32_bf16 v[56:59], a[68:71], v[16:19], v[56:59]
  buffer_store_dwordx4 v[72:75], v8, s[8:11], s57 offen sc1
  s_waitcnt lgkmcnt(3)
  v_mfma_f32_16x16x32_bf16 v[40:43], a[72:75], v[20:23], v[40:43]
  ds_read_b128 v[16:19], v6 offset:20480
  v_mfma_f32_16x16x32_bf16 v[48:51], a[76:79], v[20:23], v[48:51]
  v_mfma_f32_16x16x32_bf16 v[56:59], a[80:83], v[20:23], v[56:59]
  s_waitcnt lgkmcnt(3)
  v_mfma_f32_16x16x32_bf16 v[40:43], a[84:87], v[24:27], v[40:43]
  ds_read_b128 v[20:23], v7 offset:20480
  v_mfma_f32_16x16x32_bf16 v[48:51], a[88:91], v[24:27], v[48:51]
  v_mov_b32 v10, s52
  v_mfma_f32_16x16x32_bf16 v[56:59], a[92:95], v[24:27], v[56:59]
  s_waitcnt lgkmcnt(3)
  v_mfma_f32_16x16x32_bf16 v[40:43], a[96:99], v[28:31], v[40:43]
  ds_read_b128 v[24:27], v6 offset:24576
  v_mfma_f32_16x16x32_bf16 v[48:51], a[100:103], v[28:31], v[48:51]
  s_add_u32 s53, s53, 40960
  s_add_u32 s54, s54, 40960
  v_mfma_f32_16x16x32_bf16 v[56:59], a[104:107], v[28:31], v[56:59]
  s_waitcnt lgkmcnt(3)
  v_mfma_f32_16x16x32_bf16 v[40:43], a[108:111], v[32:35], v[40:43]
  ds_read_b128 v[28:31], v7 offset:24576
  v_mfma_f32_16x16x32_bf16 v[48:51], a[112:115], v[32:35], v[48:51]
  s_cmp_ge_u32 s54, 163840
  s_cselect_b32 s54, s51, s54
  v_mfma_f32_16x16x32_bf16 v[56:59], a[116:119], v[32:35], v[56:59]
  s_waitcnt lgkmcnt(3)
  v_mfma_f32_16x16x32_bf16 v[40:43], a[120:123], v[16:19], v[40:43]
  ds_read_b128 v[32:35], v6 offset:28672
  v_mfma_f32_16x16x32_bf16 v[48:51], a[124:127], v[16:19], v[48:51]
  s_cmp_eq_u32 s58, 122880
  s_cselect_b32 s59, 163840, 0
  v_mfma_f32_16x16x32_bf16 v[56:59], a[128:131], v[16:19], v[56:59]
  s_waitcnt lgkmcnt(3)
  v_mfma_f32_16x16x32_bf16 v[40:43], a[132:135], v[20:23], v[40:43]
  ds_read_b128 v[16:19], v7 offset:28672
  v_mfma_f32_16x16x32_bf16 v[48:51], a[136:139], v[20:23], v[48:51]
  s_sub_u32 s59, 40960, s59
  s_add_u32 s58, s58, s59
  v_mfma_f32_16x16x32_bf16 v[56:59], a[140:143], v[20:23], v[56:59]
  s_cmp_eq_u32 s52, 1
  s_cbranch_scc1 pj_eager
pj_eback:
  s_waitcnt lgkmcnt(3)
  v_mfma_f32_16x16x32_bf16 v[40:43], a[144:147], v[24:27], v[40:43]
  ds_read_b128 v[20:23], v6 offset:32768
  v_mfma_f32_16x16x32_bf16 v[48:51], a[148:151], v[24:27], v[48:51]
  s_lshr_b32 s55, s67, 1
  v_mfma_f32_16x16x32_bf16 v[56:59], a[152:155], v[24:27], v[56:59]
  s_lshl_b32 s55, s55, 14
  s_waitcnt lgkmcnt(3)
  v_mfma_f32_16x16x32_bf16 v[40:43], a[156:159], v[28:31], v[40:43]
  ds_read_b128 v[24:27], v7 offset:32768
  v_mfma_f32_16x16x32_bf16 v[48:51], a[160:163], v[28:31], v[48:51]
  s_and_b32 s56, s67, 1
  v_mfma_f32_16x16x32_bf16 v[56:59], a[164:167], v[28:31], v[56:59]
  s_lshl_b32 s56, s56, 12
  s_waitcnt lgkmcnt(3)
  v_mfma_f32_16x16x32_bf16 v[40:43], a[168:171], v[32:35], v[40:43]
  ds_read_b128 v[28:31], v6 offset:36864
  v_mfma_f32_16x16x32_bf16 v[48:51], a[172:175], v[32:35], v[48:51]
  s_add_u32 s55, s55, s56
  v_mfma_f32_16x16x32_bf16 v[56:59], a[176:179], v[32:35], v[56:59]
  s_add_u32 s55, s55, s63
  s_waitcnt lgkmcnt(3)
  v_mfma_f32_16x16x32_bf16 v[40:43], a[180:183], v[16:19], v[40:43]
  ds_read_b128 v[32:35], v7 offset:36864
  v_mfma_f32_16x16x32_bf16 v[48:51], a[184:187], v[16:19], v[48:51]
  s_lshr_b32 s56, s55, 8
  v_mfma_f32_16x16x32_bf16 v[56:59], a[188:191], v[16:19], v[56:59]
  s_and_b32 s56, s56, 0x2000
  s_waitcnt lgkmcnt(3)
  v_mfma_f32_16x16x32_bf16 v[40:43], a[192:195], v[20:23], v[40:43]
  ds_read_b128 v[16:19], v6 offset:2048
  v_mfma_f32_16x16x32_bf16 v[48:51], a[196:199], v[20:23], v[48:51]
  s_xor_b32 s55, s55, s56
  v_mfma_f32_16x16x32_bf16 v[56:59], a[200:203], v[20:23], v[56:59]
  s_add_u32 s67, s67, 32
  s_waitcnt lgkmcnt(3)
  v_mfma_f32_16x16x32_bf16 v[40:43], a[204:207], v[24:27], v[40:43]
  ds_read_b128 v[20:23], v7 offset:2048
  v_mfma_f32_16x16x32_bf16 v[48:51], a[208:211], v[24:27], v[48:51]
  s_cmp_ge_u32 s67, 1024
  s_cselect_b32 s56, 1024, 0
  v_mfma_f32_16x16x32_bf16 v[56:59], a[212:215], v[24:27], v[56:59]
  s_sub_u32 s67, s67, s56
  s_waitcnt lgkmcnt(3)
  v_mfma_f32_16x16x32_bf16 v[40:43], a[216:219], v[28:31], v[40:43]
  ds_read_b128 v[24:27], v6 offset:6144
  v_mfma_f32_16x16x32_bf16 v[48:51], a[220:223], v[28:31], v[48:51]
  s_add_u32 s56, s55, 16777216
  v_mfma_f32_16x16x32_bf16 v[56:59], a[224:227], v[28:31], v[56:59]
  s_add_u32 s57, s55, 33554432
  s_waitcnt lgkmcnt(3)
  v_mfma_f32_16x16x32_bf16 v[40:43], a[228:231], v[32:35], v[40:43]
  ds_read_b128 v[28:31], v7 offset:6144
  v_mfma_f32_16x16x32_bf16 v[48:51], a[232:235], v[32:35], v[48:51]
  v_mfma_f32_16x16x32_bf16 v[56:59], a[236:239], v[32:35], v[56:59]
  s_waitcnt lgkmcnt(3)
  v_mfma_f32_16x16x32_bf16 v[44:47], a[0:3], v[16:19], 0
  ds_read_b128 v[32:35], v6 offset:10240
  v_mfma_f32_16x16x32_bf16 v[52:55], a[4:7], v[16:19], 0
  v_mfma_f32_16x16x32_bf16 v[60:63], a[8:11], v[16:19], 0
  s_waitcnt lgkmcnt(3)
  v_cvt_pk_bf16_f32 v64, v40, v41
  v_mfma_f32_16x16x32_bf16 v[44:47], a[12:15], v[20:23], v[44:47]
  ds_read_b128 v[16:19], v7 offset:10240
  v_cvt_pk_bf16_f32 v65, v42, v43
  v_mfma_f32_16x16x32_bf16 v[52:55], a[16:19], v[20:23], v[52:55]
  v_cvt_pk_bf16_f32 v68, v48, v49
  v_mfma_f32_16x16x32_bf16 v[60:63], a[20:23], v[20:23], v[60:63]
  s_waitcnt lgkmcnt(3)
  v_cvt_pk_bf16_f32 v69, v50, v51
  v_mfma_f32_16x16x32_bf16 v[44:47], a[24:27], v[24:27], v[44:47]
  ds_read_b128 v[20:23], v6 offset:14336
  v_cvt_pk_bf16_f32 v72, v56, v57
  v_mfma_f32_16x16x32_bf16 v[52:55], a[28:31], v[24:27], v[52:55]
  v_cvt_pk_bf16_f32 v73, v58, v59
  v_mfma_f32_16x16x32_bf16 v[60:63], a[32:35], v[24:27], v[60:63]
  s_waitcnt lgkmcnt(3)
  v_mfma_f32_16x16x32_bf16 v[44:47], a[36:39], v[28:31], v[44:47]
  ds_read_b128 v[24:27], v7 offset:14336
  v_mfma_f32_16x16x32_bf16 v[52:55], a[40:43], v[28:31], v[52:55]
  s_waitcnt vmcnt(0)
  s_barrier
  v_mfma_f32_16x16x32_bf16 v[60:63], a[44:47], v[28:31], v[60:63]
  buffer_store_dword v10, v9, s[8:11], 0 offen sc1
  s_waitcnt lgkmcnt(3)
  v_mfma_f32_16x16x32_bf16 v[44:47], a[48:51], v[32:35], v[44:47]
  ds_read_b128 v[28:31], v6 offset:18432
  s_add_u32 m0, s54, 0
  v_mfma_f32_16x16x32_bf16 v[52:55], a[52:55], v[32:35], v[52:55]
  buffer_load_dwordx4 v5, s[12:15], s53 offen offset:0 lds
  v_mfma_f32_16x16x32_bf16 v[60:63], a[56:59], v[32:35], v[60:63]
  s_waitcnt lgkmcnt(3)
  v_mfma_f32_16x16x32_bf16 v[44:47], a[60:63], v[16:19], v[44:47]
  ds_read_b128 v[32:35], v7 offset:18432
  s_add_u32 m0, s54, 3968
  v_mfma_f32_16x16x32_bf16 v[52:55], a[64:67], v[16:19], v[52:55]
  buffer_load_dwordx4 v5, s[12:15], s53 offen offset:128 lds
  v_mfma_f32_16x16x32_bf16 v[60:63], a[68:71], v[16:19], v[60:63]
  s_waitcnt lgkmcnt(3)
  v_mfma_f32_16x16x32_bf16 v[44:47], a[72:75], v[20:23], v[44:47]
  ds_read_b128 v[16:19], v6 offset:22528
  s_add_u32 m0, s54, 7936
  v_mfma_f32_16x16x32_bf16 v[52:55], a[76:79], v[20:23], v[52:55]
  buffer_load_dwordx4 v5, s[12:15], s53 offen offset:256 lds
  v_mfma_f32_16x16x32_bf16 v[60:63], a[80:83], v[20:23], v[60:63]
  s_waitcnt lgkmcnt(3)
  v_mfma_f32_16x16x32_bf16 v[44:47], a[84:87], v[24:27], v[44:47]
  ds_read_b128 v[20:23], v7 offset:22528
  s_add_u32 m0, s54, 11904
  v_mfma_f32_16x16x32_bf16 v[52:55], a[88:91], v[24:27], v[52:55]
  buffer_load_dwordx4 v5, s[12:15], s53 offen offset:384 lds
  v_mfma_f32_16x16x32_bf16 v[60:63], a[92:95], v[24:27], v[60:63]
  s_waitcnt lgkmcnt(3)
  v_mfma_f32_16x16x32_bf16 v[44:47], a[96:99], v[28:31], v[44:47]
  ds_read_b128 v[24:27], v6 offset:26624
  s_add_u32 m0, s54, 15872
  v_mfma_f32_16x16x32_bf16 v[52:55], a[100:103], v[28:31], v[52:55]
  buffer_load_dwordx4 v5, s[12:15], s53 offen offset:512 lds
  v_mfma_f32_16x16x32_bf16 v[60:63], a[104:107], v[28:31], v[60:63]
  s_waitcnt lgkmcnt(3)
  v_mfma_f32_16x16x32_bf16 v[44:47], a[108:111], v[32:35], v[44:47]
  ds_read_b128 v[28:31], v7 offset:26624
  s_add_u32 m0, s54, 19840
  v_mfma_f32_16x16x32_bf16 v[52:55], a[112:115], v[32:35], v[52:55]
  buffer_load_dwordx4 v5, s[12:15], s53 offen offset:640 lds
  v_mfma_f32_16x16x32_bf16 v[60:63], a[116:119], v[32:35], v[60:63]
  s_waitcnt lgkmcnt(3)
  v_mfma_f32_16x16x32_bf16 v[44:47], a[120:123], v[16:19], v[44:47]
  ds_read_b128 v[32:35], v6 offset:30720
  s_add_u32 m0, s54, 23808
  v_mfma_f32_16x16x32_bf16 v[52:55], a[124:127], v[16:19], v[52:55]
  buffer_load_dwordx4 v5, s[12:15], s53 offen offset:768 lds
  v_mfma_f32_16x16x32_bf16 v[60:63], a[128:131], v[16:19], v[60:63]
  s_waitcnt lgkmcnt(3)
  v_mfma_f32_16x16x32_bf16 v[44:47], a[132:135], v[20:23], v[44:47]
  ds_read_b128 v[16:19], v7 offset:30720
  s_add_u32 m0, s54, 27776
  v_mfma_f32_16x16x32_bf16 v[52:55], a[136:139], v[20:23], v[52:55]
  buffer_load_dwordx4 v5, s[12:15], s53 offen offset:896 lds
  v_mfma_f32_16x16x32_bf16 v[60:63], a[140:143], v[20:23], v[60:63]
  s_waitcnt lgkmcnt(3)
  v_mfma_f32_16x16x32_bf16 v[44:47], a[144:147], v[24:27], v[44:47]
  ds_read_b128 v[20:23], v6 offset:34816
  s_add_u32 m0, s54, 31744
  v_mfma_f32_16x16x32_bf16 v[52:55], a[148:151], v[24:27], v[52:55]
  buffer_load_dwordx4 v5, s[12:15], s53 offen offset:1024 lds
  v_mfma_f32_16x16x32_bf16 v[60:63], a[152:155], v[24:27], v[60:63]
  s_waitcnt lgkmcnt(3)
  v_mfma_f32_16x16x32_bf16 v[44:47], a[156:159], v[28:31], v[44:47]
  ds_read_b128 v[24:27], v7 offset:34816
  s_add_u32 m0, s54, 35712
  v_mfma_f32_16x16x32_bf16 v[52:55], a[160:163], v[28:31], v[52:55]
  buffer_load_dwordx4 v5, s[12:15], s53 offen offset:1152 lds
  v_mfma_f32_16x16x32_bf16 v[60:63], a[164:167], v[28:31], v[60:63]
  s_waitcnt lgkmcnt(3)
  v_mfma_f32_16x16x32_bf16 v[44:47], a[168:171], v[32:35], v[44:47]
  ds_read_b128 v[28:31], v6 offset:38912
  v_mfma_f32_16x16x32_bf16 v[52:55], a[172:175], v[32:35], v[52:55]
  s_max_u32 s69, s52, 25
  s_sub_u32 s69, s69, 25
  v_mfma_f32_16x16x32_bf16 v[60:63], a[176:179], v[32:35], v[60:63]
  s_cmp_eq_u32 s52, s70
  s_cbranch_scc1 pj_warm
pj_wback:
  s_waitcnt lgkmcnt(3)
  v_mfma_f32_16x16x32_bf16 v[44:47], a[180:183], v[16:19], v[44:47]
  ds_read_b128 v[32:35], v7 offset:38912
  v_mfma_f32_16x16x32_bf16 v[52:55], a[184:187], v[16:19], v[52:55]
  v_add_u32 v6, s59, v6
  v_add_u32 v7, s59, v7
  v_mfma_f32_16x16x32_bf16 v[60:63], a[188:191], v[16:19], v[60:63]
  s_waitcnt lgkmcnt(3)
  v_mfma_f32_16x16x32_bf16 v[44:47], a[192:195], v[20:23], v[44:47]
  ds_read_b128 v[16:19], v6 offset:0
  v_mfma_f32_16x16x32_bf16 v[52:55], a[196:199], v[20:23], v[52:55]
  s_cmp_lt_u32 s68, s69
  s_cbranch_scc1 pj_slow
pj_back:
  v_mfma_f32_16x16x32_bf16 v[60:63], a[200:203], v[20:23], v[60:63]
  s_waitcnt lgkmcnt(3)
  v_mfma_f32_16x16x32_bf16 v[44:47], a[204:207], v[24:27], v[44:47]
  ds_read_b128 v[20:23], v7 offset:0
  v_mfma_f32_16x16x32_bf16 v[52:55], a[208:211], v[24:27], v[52:55]
  s_add_u32 s52, s52, 1
  v_mfma_f32_16x16x32_bf16 v[60:63], a[212:215], v[24:27], v[60:63]
  s_waitcnt lgkmcnt(3)
  v_mfma_f32_16x16x32_bf16 v[44:47], a[216:219], v[28:31], v[44:47]
  ds_read_b128 v[24:27], v6 offset:4096
  v_mfma_f32_16x16x32_bf16 v[52:55], a[220:223], v[28:31], v[52:55]
  v_mfma_f32_16x16x32_bf16 v[60:63], a[224:227], v[28:31], v[60:63]
  s_waitcnt lgkmcnt(3)
  v_mfma_f32_16x16x32_bf16 v[44:47], a[228:231], v[32:35], v[44:47]
  ds_read_b128 v[28:31], v7 offset:4096
  v_mfma_f32_16x16x32_bf16 v[52:55], a[232:235], v[32:35], v[52:55]
  s_cmp_lt_u32 s52, s62
  v_mfma_f32_16x16x32_bf16 v[60:63], a[236:239], v[32:35], v[60:63]
  s_waitcnt lgkmcnt(3)
  s_cbranch_scc1 pj_loop_5
  v_cvt_pk_bf16_f32 v66, v44, v45
  v_cvt_pk_bf16_f32 v67, v46, v47
  s_nop 1
  v_cvt_pk_bf16_f32 v70, v52, v53
  v_cvt_pk_bf16_f32 v71, v54, v55
  v_cvt_pk_bf16_f32 v74, v60, v61
  v_cvt_pk_bf16_f32 v75, v62, v63
  v_permlane16_swap_b32 v64, v66
  v_permlane16_swap_b32 v65, v67
  v_permlane16_swap_b32 v68, v70
  v_permlane16_swap_b32 v69, v71
  v_permlane16_swap_b32 v72, v74
  v_permlane16_swap_b32 v73, v75
  buffer_store_dwordx4 v[64:67], v8, s[8:11], s55 offen sc1
  buffer_store_dwordx4 v[68:71], v8, s[8:11], s56 offen sc1
  buffer_store_dwordx4 v[72:75], v8, s[8:11], s57 offen sc1
  v_mov_b32 v10, s52
  s_waitcnt vmcnt(0) lgkmcnt(0)
  s_barrier
  buffer_store_dword v10, v9, s[8:11], 0 offen sc1
  s_branch pj_done
pj_slow:
  s_cmp_ge_u32 s68, s69
  s_cbranch_scc1 wf_done_6
  s_mov_b32 s50, 0
wf_loop_7:
  buffer_load_dword v11, v14, s[8:11], 0 offen sc1
  s_add_u32 s50, s50, 1
  s_cmp_gt_u32 s50, 131072
  s_cbranch_scc1 L_fail
  s_waitcnt vmcnt(0)
  v_readfirstlane_b32 s68, v11
  s_nop 0
  s_cmp_ge_u32 s68, s69
  s_cbranch_scc1 wf_done_6
  s_sleep 2
  s_branch wf_loop_7
wf_done_6:
  s_branch pj_back
pj_eager:
  s_waitcnt vmcnt(0)
  s_barrier
  buffer_store_dword v10, v9, s[8:11], 0 offen sc1
  s_branch pj_eback
pj_warm:
  s_lshl_b32 s46, s44, 2
  s_add_u32 s46, s46, s43
  s_sub_u32 s46, s46, 4
  s_lshl_b32 s46, s46, 2
  s_add_u32 s46, s46, s42
  s_lshl_b32 s46, s46, 13
  v_lshlrev_b32 v11, 7, v0
  s_mov_b32 s4, s16
  s_mov_b32 s5, s17
  s_mov_b32 s6, 2621440
  s_mov_b32 s7, 0x20000
  buffer_load_dword v12, v11, s[4:7], s46 offen
  s_mov_b32 s4, s18
  s_mov_b32 s5, s19
  s_mov_b32 s6, 2457600
  s_mov_b32 s7, 0x20000
  buffer_load_dword v12, v11, s[4:7], s46 offen
  s_mov_b32 s4, s20
  s_mov_b32 s5, s21
  s_mov_b32 s6, 819200
  s_mov_b32 s7, 0x20000
  buffer_load_dword v12, v11, s[4:7], s46 offen
  s_branch pj_wback
pj_done:
  s_branch L_parta
L_uw:
  s_mov_b32 s4, s32
  s_mov_b32 s5, s33
  s_mov_b32 s6, 7864320
  s_mov_b32 s7, 0x20000
  v_lshrrev_b32 v8, 3, v0
  v_lshrrev_b32 v9, 2, v8
  v_lshlrev_b32 v9, 3, v9
  v_and_b32 v1, 3, v8
  v_add_u32 v1, v1, v9
  s_and_b32 s46, s42, 1
  s_lshl_b32 s46, s46, 2
  s_lshr_b32 s47, s42, 1
  s_lshl_b32 s47, s47, 4
  s_add_u32 s46, s46, s47
  v_add_u32 v1, s46, v1
  v_mul_u32_u24 v1, 1280, v1
  v_lshrrev_b32 v8, 1, v8
  v_bfe_u32 v9, v0, 1, 2
  v_xor_b32 v8, v8, v9
  v_lshlrev_b32 v8, 5, v8
  v_and_b32 v9, 1, v0
  v_lshlrev_b32 v9, 4, v9
  v_add3_u32 v1, v1, v8, v9
  v_lshrrev_b32 v8, 5, v0
  v_lshlrev_b32 v2, 11, v8
  v_bfe_u32 v8, v0, 2, 3
  v_lshl_add_u32 v2, v8, 7, v2
  v_lshrrev_b32 v8, 1, v8
  v_xor_b32 v8, s42, v8
  v_lshl_add_u32 v2, v8, 5, v2
  v_and_b32 v8, 3, v0
  v_lshl_add_u32 v2, v8, 3, v2
  v_add_u32 v3, 0x10000, v2
  v_add_u32 v4, 0x20000, v2
  s_mul_i32 s53, s45, 245760
  v_lshlrev_b32 v5, 4, v0
  s_lshl_b32 s46, s45, 7
  s_add_u32 s47, s46, 1056768
  v_mov_b32 v6, s47
  s_lshl_b32 s47, s42, 2
  s_add_u32 s46, s46, s47
  s_add_u32 s46, s46, 1060864
  v_mov_b32 v7, s46
  v_mov_b32 v8, 2146435072
  v_cmp_eq_u32 vcc, 0, v0
  s_nop 1
  v_cndmask_b32 v7, v8, v7, vcc
  v_cndmask_b32 v6, v8, v6, vcc
  s_mov_b32 s60, s51
  s_add_u32 s61, s51, 167780352
  s_mov_b32 s62, s45
  v_mov_b32 v12, v5
  s_lshr_b32 s55, s45, 3
  s_lshl_b32 s55, s55, 14
  s_and_b32 s46, s45, 7
  s_lshl_b32 s46, s46, 10
  s_add_u32 s55, s55, s46
  s_lshl_b32 s46, s42, 16
  s_add_u32 s55, s55, s46
  s_add_u32 s55, s55, 81788928
  s_mov_b32 s52, 0
  s_mov_b32 s56, 0
  s_add_u32 m0, s51, 0
  s_add_u32 s46, s53, 0
  buffer_load_dwordx4 v1, s[4:7], s46 offen  lds
  s_add_u32 m0, s51, 4096
  s_add_u32 s46, s53, 128
  buffer_load_dwordx4 v1, s[4:7], s46 offen  lds
  s_add_u32 m0, s51, 8192
  s_add_u32 s46, s53, 256
  buffer_load_dwordx4 v1, s[4:7], s46 offen  lds
  s_add_u32 m0, s51, 12288
  s_add_u32 s46, s53, 384
  buffer_load_dwordx4 v1, s[4:7], s46 offen  lds
  s_add_u32 m0, s51, 16384
  s_add_u32 s46, s53, 512
  buffer_load_dwordx4 v1, s[4:7], s46 offen  lds
  s_add_u32 m0, s51, 20480
  s_add_u32 s46, s53, 640
  buffer_load_dwordx4 v1, s[4:7], s46 offen  lds
  s_add_u32 m0, s51, 24576
  s_add_u32 s46, s53, 768
  buffer_load_dwordx4 v1, s[4:7], s46 offen  lds
  s_add_u32 m0, s51, 28672
  s_add_u32 s46, s53, 896
  buffer_load_dwordx4 v1, s[4:7], s46 offen  lds
  s_add_u32 m0, s51, 32768
  s_add_u32 s46, s53, 1024
  buffer_load_dwordx4 v1, s[4:7], s46 offen  lds
  s_add_u32 m0, s51, 36864
  s_add_u32 s46, s53, 1152
  buffer_load_dwordx4 v1, s[4:7], s46 offen  lds
  s_add_u32 m0, s51, 40960
  s_add_u32 s46, s53, 40960
  buffer_load_dwordx4 v1, s[4:7], s46 offen  lds
  s_add_u32 m0, s51, 45056
  s_add_u32 s46, s53, 41088
  buffer_load_dwordx4 v1, s[4:7], s46 offen  lds
  s_add_u32 m0, s51, 49152
  s_add_u32 s46, s53, 41216
  buffer_load_dwordx4 v1, s[4:7], s46 offen  lds
  s_add_u32 m0, s51, 53248
  s_add_u32 s46, s53, 41344
  buffer_load_dwordx4 v1, s[4:7], s46 offen  lds
  s_add_u32 m0, s51, 57344
  s_add_u32 s46, s53, 41472
  buffer_load_dwordx4 v1, s[4:7], s46 offen  lds
  s_add_u32 m0, s51, 61440
  s_add_u32 s46, s53, 41600
  buffer_load_dwordx4 v1, s[4:7], s46 offen  lds
  s_add_u32 m0, s51, 65536
  s_add_u32 s46, s53, 41728
  buffer_load_dwordx4 v1, s[4:7], s46 offen  lds
  s_add_u32 m0, s51, 69632
  s_add_u32 s46, s53, 41856
  buffer_load_dwordx4 v1, s[4:7], s46 offen  lds
  s_add_u32 m0, s51, 73728
  s_add_u32 s46, s53, 41984
  buffer_load_dwordx4 v1, s[4:7], s46 offen  lds
  s_add_u32 m0, s51, 77824
  s_add_u32 s46, s53, 42112
  buffer_load_dwordx4 v1, s[4:7], s46 offen  lds
  s_add_u32 m0, s51, 81920
  s_add_u32 s46, s53, 81920
  buffer_load_dwordx4 v1, s[4:7], s46 offen  lds
  s_add_u32 m0, s51, 86016
  s_add_u32 s46, s53, 82048
  buffer_load_dwordx4 v1, s[4:7], s46 offen  lds
  s_add_u32 m0, s51, 90112
  s_add_u32 s46, s53, 82176
  buffer_load_dwordx4 v1, s[4:7], s46 offen  lds
  s_add_u32 m0, s51, 94208
  s_add_u32 s46, s53, 82304
  buffer_load_dwordx4 v1, s[4:7], s46 offen  lds
  s_add_u32 m0, s51, 98304
  s_add_u32 s46, s53, 82432
  buffer_load_dwordx4 v1, s[4:7], s46 offen  lds
  s_add_u32 m0, s51, 102400
  s_add_u32 s46, s53, 82560
  buffer_load_dwordx4 v1, s[4:7], s46 offen  lds
  s_add_u32 m0, s51, 106496
  s_add_u32 s46, s53, 82688
  buffer_load_dwordx4 v1, s[4:7], s46 offen  lds
  s_add_u32 m0, s51, 110592
  s_add_u32 s46, s53, 82816
  buffer_load_dwordx4 v1, s[4:7], s46 offen  lds
  s_add_u32 m0, s51, 114688
  s_add_u32 s46, s53, 82944
  buffer_load_dwordx4 v1, s[4:7], s46 offen  lds
  s_add_u32 m0, s51, 118784
  s_add_u32 s46, s53, 83072
  buffer_load_dwordx4 v1, s[4:7], s46 offen  lds
  s_waitcnt vmcnt(24)
  s_barrier
  s_add_u32 m0, s51, 122880
  s_add_u32 s46, s53, 122880
  buffer_load_dwordx4 v1, s[4:7], s46 offen  lds
  s_add_u32 m0, s51, 126976
  s_add_u32 s46, s53, 123008
  buffer_load_dwordx4 v1, s[4:7], s46 offen  lds
  s_add_u32 m0, s51, 131072
  s_add_u32 s46, s53, 123136
  buffer_load_dwordx4 v1, s[4:7], s46 offen  lds
  s_add_u32 m0, s51, 135168
  s_add_u32 s46, s53, 123264
  buffer_load_dwordx4 v1, s[4:7], s46 offen  lds
  s_add_u32 m0, s51, 139264
  s_add_u32 s46, s53, 123392
  buffer_load_dwordx4 v1, s[4:7], s46 offen  lds
  s_add_u32 m0, s51, 143360
  s_add_u32 s46, s53, 123520
  buffer_load_dwordx4 v1, s[4:7], s46 offen  lds
  ds_read_b64_tr_b16 a[0:1], v2 offset:0
  ds_read_b64_tr_b16 a[2:3], v2 offset:1024
  ds_read_b64_tr_b16 a[24:25], v2 offset:4096
  ds_read_b64_tr_b16 a[26:27], v2 offset:5120
  ds_read_b64_tr_b16 a[48:49], v2 offset:8192
  ds_read_b64_tr_b16 a[50:51], v2 offset:9216
  ds_read_b64_tr_b16 a[72:73], v2 offset:12288
  ds_read_b64_tr_b16 a[74:75], v2 offset:13312
  ds_read_b64_tr_b16 a[96:97], v2 offset:16384
  ds_read_b64_tr_b16 a[98:99], v2 offset:17408
  ds_read_b64_tr_b16 a[120:121], v2 offset:20480
  ds_read_b64_tr_b16 a[122:123], v2 offset:21504
  s_waitcnt lgkmcnt(0)
  s_waitcnt vmcnt(24)
  s_barrier
  s_add_u32 m0, s51, 0
  s_add_u32 s46, s53, 123648
  buffer_load_dwordx4 v1, s[4:7], s46 offen  lds
  s_add_u32 m0, s51, 4096
  s_add_u32 s46, s53, 123776
  buffer_load_dwordx4 v1, s[4:7], s46 offen  lds
  s_add_u32 m0, s51, 8192
  s_add_u32 s46, s53, 123904
  buffer_load_dwordx4 v1, s[4:7], s46 offen  lds
  s_add_u32 m0, s51, 12288
  s_add_u32 s46, s53, 124032
  buffer_load_dwordx4 v1, s[4:7], s46 offen  lds
  s_add_u32 m0, s51, 16384
  s_add_u32 s46, s53, 163840
  buffer_load_dwordx4 v1, s[4:7], s46 offen  lds
  s_add_u32 m0, s51, 20480
  s_add_u32 s46, s53, 163968
  buffer_load_dwordx4 v1, s[4:7], s46 offen  lds
  ds_read_b64_tr_b16 a[144:145], v2 offset:24576
  ds_read_b64_tr_b16 a[146:147], v2 offset:25600
  ds_read_b64_tr_b16 a[168:169], v2 offset:28672
  ds_read_b64_tr_b16 a[170:171], v2 offset:29696
  ds_read_b64_tr_b16 a[192:193], v2 offset:32768
  ds_read_b64_tr_b16 a[194:195], v2 offset:33792
  ds_read_b64_tr_b16 a[216:217], v2 offset:36864
  ds_read_b64_tr_b16 a[218:219], v2 offset:37888
  ds_read_b64_tr_b16 a[4:5], v2 offset:40960
  ds_read_b64_tr_b16 a[6:7], v2 offset:41984
  ds_read_b64_tr_b16 a[28:29], v2 offset:45056
  ds_read_b64_tr_b16 a[30:31], v2 offset:46080
  s_waitcnt lgkmcnt(0)
  s_waitcnt vmcnt(24)
  s_barrier
  s_add_u32 m0, s51, 24576
  s_add_u32 s46, s53, 164096
  buffer_load_dwordx4 v1, s[4:7], s46 offen  lds
  s_add_u32 m0, s51, 28672
  s_add_u32 s46, s53, 164224
  buffer_load_dwordx4 v1, s[4:7], s46 offen  lds
  s_add_u32 m0, s51, 32768
  s_add_u32 s46, s53, 164352
  buffer_load_dwordx4 v1, s[4:7], s46 offen  lds
  s_add_u32 m0, s51, 36864
  s_add_u32 s46, s53, 164480
  buffer_load_dwordx4 v1, s[4:7], s46 offen  lds
  s_add_u32 m0, s51, 40960
  s_add_u32 s46, s53, 164608
  buffer_load_dwordx4 v1, s[4:7], s46 offen  lds
  s_add_u32 m0, s51, 45056
  s_add_u32 s46, s53, 164736
  buffer_load_dwordx4 v1, s[4:7], s46 offen  lds
  ds_read_b64_tr_b16 a[52:53], v2 offset:49152
  ds_read_b64_tr_b16 a[54:55], v2 offset:50176
  ds_read_b64_tr_b16 a[76:77], v2 offset:53248
  ds_read_b64_tr_b16 a[78:79], v2 offset:54272
  ds_read_b64_tr_b16 a[100:101], v2 offset:57344
  ds_read_b64_tr_b16 a[102:103], v2 offset:58368
  ds_read_b64_tr_b16 a[124:125], v2 offset:61440
  ds_read_b64_tr_b16 a[126:127], v2 offset:62464
  ds_read_b64_tr_b16 a[148:149], v3 offset:0
  ds_read_b64_tr_b16 a[150:151], v3 offset:1024
  ds_read_b64_tr_b16 a[172:173], v3 offset:4096
  ds_read_b64_tr_b16 a[174:175], v3 offset:5120
  s_waitcnt lgkmcnt(0)
  s_waitcnt vmcnt(24)
  s_barrier
  s_add_u32 m0, s51, 49152
  s_add_u32 s46, s53, 164864
  buffer_load_dwordx4 v1, s[4:7], s46 offen  lds
  s_add_u32 m0, s51, 53248
  s_add_u32 s46, s53, 164992
  buffer_load_dwordx4 v1, s[4:7], s46 offen  lds
  s_add_u32 m0, s51, 57344
  s_add_u32 s46, s53, 204800
  buffer_load_dwordx4 v1, s[4:7], s46 offen  lds
  s_add_u32 m0, s51, 61440
  s_add_u32 s46, s53, 204928
  buffer_load_dwordx4 v1, s[4:7], s46 offen  lds
  s_add_u32 m0, s51, 65536
  s_add_u32 s46, s53, 205056
  buffer_load_dwordx4 v1, s[4:7], s46 offen  lds
  s_add_u32 m0, s51, 69632
  s_add_u32 s46, s53, 205184
  buffer_load_dwordx4 v1, s[4:7], s46 offen  lds
  ds_read_b64_tr_b16 a[196:197], v3 offset:8192
  ds_read_b64_tr_b16 a[198:199], v3 offset:9216
  ds_read_b64_tr_b16 a[220:221], v3 offset:12288
  ds_read_b64_tr_b16 a[222:223], v3 offset:13312
  ds_read_b64_tr_b16 a[8:9], v3 offset:16384
  ds_read_b64_tr_b16 a[10:11], v3 offset:17408
  ds_read_b64_tr_b16 a[32:33], v3 offset:20480
  ds_read_b64_tr_b16 a[34:35], v3 offset:21504
  ds_read_b64_tr_b16 a[56:57], v3 offset:24576
  ds_read_b64_tr_b16 a[58:59], v3 offset:25600
  ds_read_b64_tr_b16 a[80:81], v3 offset:28672
  ds_read_b64_tr_b16 a[82:83], v3 offset:29696
  s_waitcnt lgkmcnt(0)
  s_waitcnt vmcnt(24)
  s_barrier
  v_and_b32 v9, 3, v0
  v_lshlrev_b32 v9, 2, v9
  global_load_dword v8, v9, s[38:39] sc1
  s_add_u32 m0, s51, 73728
  s_add_u32 s46, s53, 205312
  buffer_load_dwordx4 v1, s[4:7], s46 offen  lds
  s_add_u32 m0, s51, 77824
  s_add_u32 s46, s53, 205440
  buffer_load_dwordx4 v1, s[4:7], s46 offen  lds
  s_add_u32 m0, s51, 81920
  s_add_u32 s46, s53, 205568
  buffer_load_dwordx4 v1, s[4:7], s46 offen  lds
  s_add_u32 m0, s51, 86016
  s_add_u32 s46, s53, 205696
  buffer_load_dwordx4 v1, s[4:7], s46 offen  lds
  s_add_u32 m0, s51, 90112
  s_add_u32 s46, s53, 205824
  buffer_load_dwordx4 v1, s[4:7], s46 offen  lds
  s_add_u32 m0, s51, 94208
  s_add_u32 s46, s53, 205952
  buffer_load_dwordx4 v1, s[4:7], s46 offen  lds
  ds_read_b64_tr_b16 a[104:105], v3 offset:32768
  ds_read_b64_tr_b16 a[106:107], v3 offset:33792
  ds_read_b64_tr_b16 a[128:129], v3 offset:36864
  ds_read_b64_tr_b16 a[130:131], v3 offset:37888
  ds_read_b64_tr_b16 a[152:153], v3 offset:40960
  ds_read_b64_tr_b16 a[154:155], v3 offset:41984
  ds_read_b64_tr_b16 a[176:177], v3 offset:45056
  ds_read_b64_tr_b16 a[178:179], v3 offset:46080
  ds_read_b64_tr_b16 a[200:201], v3 offset:49152
  ds_read_b64_tr_b16 a[202:203], v3 offset:50176
  ds_read_b64_tr_b16 a[224:225], v3 offset:53248
  ds_read_b64_tr_b16 a[226:227], v3 offset:54272
  s_waitcnt lgkmcnt(0)
  s_waitcnt vmcnt(25)
  s_barrier
  ds_read_b64_tr_b16 a[12:13], v3 offset:57344
  ds_read_b64_tr_b16 a[14:15], v3 offset:58368
  ds_read_b64_tr_b16 a[36:37], v3 offset:61440
  ds_read_b64_tr_b16 a[38:39], v3 offset:62464
  ds_read_b64_tr_b16 a[60:61], v4 offset:0
  ds_read_b64_tr_b16 a[62:63], v4 offset:1024
  ds_read_b64_tr_b16 a[84:85], v4 offset:4096
  ds_read_b64_tr_b16 a[86:87], v4 offset:5120
  ds_read_b64_tr_b16 a[108:109], v4 offset:8192
  ds_read_b64_tr_b16 a[110:111], v4 offset:9216
  ds_read_b64_tr_b16 a[132:133], v4 offset:12288
  ds_read_b64_tr_b16 a[134:135], v4 offset:13312
  s_waitcnt lgkmcnt(0)
  s_waitcnt vmcnt(19)
  s_barrier
  ds_read_b64_tr_b16 a[156:157], v2 offset:0
  ds_read_b64_tr_b16 a[158:159], v2 offset:1024
  ds_read_b64_tr_b16 a[180:181], v2 offset:4096
  ds_read_b64_tr_b16 a[182:183], v2 offset:5120
  ds_read_b64_tr_b16 a[204:205], v2 offset:8192
  ds_read_b64_tr_b16 a[206:207], v2 offset:9216
  ds_read_b64_tr_b16 a[228:229], v2 offset:12288
  ds_read_b64_tr_b16 a[230:231], v2 offset:13312
  ds_read_b64_tr_b16 a[16:17], v2 offset:16384
  ds_read_b64_tr_b16 a[18:19], v2 offset:17408
  ds_read_b64_tr_b16 a[40:41], v2 offset:20480
  ds_read_b64_tr_b16 a[42:43], v2 offset:21504
  s_waitcnt lgkmcnt(0)
  s_waitcnt vmcnt(13)
  s_barrier
  ds_read_b64_tr_b16 a[64:65], v2 offset:24576
  ds_read_b64_tr_b16 a[66:67], v2 offset:25600
  ds_read_b64_tr_b16 a[88:89], v2 offset:28672
  ds_read_b64_tr_b16 a[90:91], v2 offset:29696
  ds_read_b64_tr_b16 a[112:113], v2 offset:32768
  ds_read_b64_tr_b16 a[114:115], v2 offset:33792
  ds_read_b64_tr_b16 a[136:137], v2 offset:36864
  ds_read_b64_tr_b16 a[138:139], v2 offset:37888
  ds_read_b64_tr_b16 a[160:161], v2 offset:40960
  ds_read_b64_tr_b16 a[162:163], v2 offset:41984
  ds_read_b64_tr_b16 a[184:185], v2 offset:45056
  ds_read_b64_tr_b16 a[186:187], v2 offset:46080
  s_waitcnt lgkmcnt(0)
  s_waitcnt vmcnt(7)
  s_barrier
  ds_read_b64_tr_b16 a[208:209], v2 offset:49152
  ds_read_b64_tr_b16 a[210:211], v2 offset:50176
  ds_read_b64_tr_b16 a[232:233], v2 offset:53248
  ds_read_b64_tr_b16 a[234:235], v2 offset:54272
  ds_read_b64_tr_b16 a[20:21], v2 offset:57344
  ds_read_b64_tr_b16 a[22:23], v2 offset:58368
  ds_read_b64_tr_b16 a[44:45], v2 offset:61440
  ds_read_b64_tr_b16 a[46:47], v2 offset:62464
  ds_read_b64_tr_b16 a[68:69], v3 offset:0
  ds_read_b64_tr_b16 a[70:71], v3 offset:1024
  ds_read_b64_tr_b16 a[92:93], v3 offset:4096
  ds_read_b64_tr_b16 a[94:95], v3 offset:5120
  s_waitcnt lgkmcnt(0)
  s_waitcnt vmcnt(0)
  s_barrier
  ds_read_b64_tr_b16 a[116:117], v3 offset:8192
  ds_read_b64_tr_b16 a[118:119], v3 offset:9216
  ds_read_b64_tr_b16 a[140:141], v3 offset:12288
  ds_read_b64_tr_b16 a[142:143], v3 offset:13312
  ds_read_b64_tr_b16 a[164:165], v3 offset:16384
  ds_read_b64_tr_b16 a[166:167], v3 offset:17408
  ds_read_b64_tr_b16 a[188:189], v3 offset:20480
  ds_read_b64_tr_b16 a[190:191], v3 offset:21504
  ds_read_b64_tr_b16 a[212:213], v3 offset:24576
  ds_read_b64_tr_b16 a[214:215], v3 offset:25600
  ds_read_b64_tr_b16 a[236:237], v3 offset:28672
  ds_read_b64_tr_b16 a[238:239], v3 offset:29696
  s_waitcnt lgkmcnt(0)
  s_mov_b32 s50, 0
  s_branch ss_8_in
ss_8:
  v_and_b32 v9, 3, v0
  v_lshlrev_b32 v9, 2, v9
  global_load_dword v8, v9, s[38:39] sc1
  s_add_u32 s50, s50, 1
  s_cmp_gt_u32 s50, 131072
  s_cbranch_scc1 L_fail
  s_waitcnt vmcnt(0)
ss_8_in:
  v_readlane_b32 s46, v8, 0
  v_readlane_b32 s47, v8, 2
  v_readlane_b32 s48, v8, 1
  s_nop 0
  s_min_u32 s47, s47, s48
  s_cmp_lg_u32 s46, 0
  s_cselect_b32 s48, 7, 0
  s_add_u32 s46, s46, s2
  s_xor_b32 s49, s46, s43
  s_and_b32 s49, s49, s48
  s_cbranch_scc1 L_reroll
  s_cmp_lg_u32 s47, 0
  s_cbranch_scc1 ss_ok_9
  s_sleep 6
  s_branch ss_8
ss_ok_9:
  v_readlane_b32 s3, v8, 1
  s_nop 0
  s_and_b32 s3, s3, 0x2000
  s_barrier
  s_xor_b32 s61, s61, s3
  s_xor_b32 s55, s55, s3
  s_lshr_b32 s46, s45, 3
  s_lshr_b32 s46, 1, s46
  s_and_b32 s46, s46, 1
  s_lshl_b32 s46, s46, 13
  s_xor_b32 s55, s55, s46
  s_mov_b32 s57, 1
  s_cmp_ge_u32 s56, s57
  s_cbranch_scc1 wf_done_10
  s_mov_b32 s50, 0
wf_loop_11:
  buffer_load_dword v13, v6, s[8:11], 0 offen sc1
  s_add_u32 s50, s50, 1
  s_cmp_gt_u32 s50, 131072
  s_cbranch_scc1 L_fail
  s_waitcnt vmcnt(0)
  v_readfirstlane_b32 s56, v13
  s_nop 0
  s_cmp_ge_u32 s56, s57
  s_cbranch_scc1 wf_done_10
  s_sleep 2
  s_branch wf_loop_11
wf_done_10:
  s_lshr_b32 s54, s62, 1
  s_lshl_b32 s54, s54, 14
  s_and_b32 s47, s62, 1
  s_lshl_b32 s47, s47, 12
  s_add_u32 s54, s54, s47
  s_add_u32 s54, s54, s61
  s_lshr_b32 s47, s54, 8
  s_and_b32 s47, s47, 0x2000
  s_xor_b32 s54, s54, s47
  s_add_u32 m0, s60, 0
  s_add_u32 s47, s54, 0
  buffer_load_dwordx4 v5, s[8:11], s47 offen sc1 lds
  s_add_u32 m0, s60, 4096
  s_add_u32 s47, s54, 16777216
  buffer_load_dwordx4 v5, s[8:11], s47 offen sc1 lds
  s_add_u32 m0, s60, 8192
  s_add_u32 s47, s54, 33554432
  buffer_load_dwordx4 v5, s[8:11], s47 offen sc1 lds
  s_mov_b32 s59, 2146435072
  s_waitcnt vmcnt(0)
  s_barrier
  ds_read_b128 v[16:19], v12 offset:0
  ds_read_b128 v[40:43], v12 offset:2048
  ds_read_b128 v[20:23], v12 offset:1024
  ds_read_b128 v[44:47], v12 offset:3072
  ds_read_b128 v[24:27], v12 offset:4096
  ds_read_b128 v[48:51], v12 offset:6144
  ds_read_b128 v[28:31], v12 offset:5120
  ds_read_b128 v[52:55], v12 offset:7168
  ds_read_b128 v[32:35], v12 offset:8192
  ds_read_b128 v[56:59], v12 offset:10240
  ds_read_b128 v[36:39], v12 offset:9216
  ds_read_b128 v[60:63], v12 offset:11264
u_loop:
  s_waitcnt lgkmcnt(8)
  v_mfma_f32_16x16x32_bf16 v[64:67], v[16:19], a[0:3], 0
  buffer_load_dword v13, v6, s[8:11], 0 offen sc1
  v_mfma_f32_16x16x32_bf16 v[68:71], v[40:43], a[0:3], 0
  v_mfma_f32_16x16x32_bf16 v[64:67], v[20:23], a[4:7], v[64:67]
  v_cvt_pk_bf16_f32 v84, v72, v73
  v_mfma_f32_16x16x32_bf16 v[68:71], v[44:47], a[4:7], v[68:71]
  s_waitcnt lgkmcnt(4)
  v_cvt_pk_bf16_f32 v85, v74, v75
  v_mfma_f32_16x16x32_bf16 v[64:67], v[24:27], a[8:11], v[64:67]
  v_cvt_pk_bf16_f32 v86, v76, v77
  v_mfma_f32_16x16x32_bf16 v[68:71], v[48:51], a[8:11], v[68:71]
  v_cvt_pk_bf16_f32 v87, v78, v79
  v_mfma_f32_16x16x32_bf16 v[64:67], v[28:31], a[12:15], v[64:67]
  buffer_store_dwordx4 v[84:87], v5, s[8:11], s59 offen sc1
  v_mfma_f32_16x16x32_bf16 v[68:71], v[52:55], a[12:15], v[68:71]
  s_add_u32 s58, s55, 0
  s_waitcnt lgkmcnt(0)
  v_mfma_f32_16x16x32_bf16 v[64:67], v[32:35], a[16:19], v[64:67]
  s_lshr_b32 s46, s58, 8
  v_mfma_f32_16x16x32_bf16 v[68:71], v[56:59], a[16:19], v[68:71]
  s_and_b32 s46, s46, 0x2000
  v_mfma_f32_16x16x32_bf16 v[64:67], v[36:39], a[20:23], v[64:67]
  s_xor_b32 s58, s58, s46
  v_mfma_f32_16x16x32_bf16 v[68:71], v[60:63], a[20:23], v[68:71]
  v_mfma_f32_16x16x32_bf16 v[72:75], v[16:19], a[24:27], 0
  s_add_u32 s59, s55, 2359296
  v_mfma_f32_16x16x32_bf16 v[76:79], v[40:43], a[24:27], 0
  s_lshr_b32 s46, s59, 8
  v_mfma_f32_16x16x32_bf16 v[72:75], v[20:23], a[28:31], v[72:75]
  s_and_b32 s46, s46, 0x2000
  v_cvt_pk_bf16_f32 v80, v64, v65
  v_mfma_f32_16x16x32_bf16 v[76:79], v[44:47], a[28:31], v[76:79]
  s_xor_b32 s59, s59, s46
  v_cvt_pk_bf16_f32 v81, v66, v67
  v_mfma_f32_16x16x32_bf16 v[72:75], v[24:27], a[32:35], v[72:75]
  v_cvt_pk_bf16_f32 v82, v68, v69
  v_mfma_f32_16x16x32_bf16 v[76:79], v[48:51], a[32:35], v[76:79]
  s_add_u32 s57, s52, 2
  s_min_u32 s57, s57, 64
  v_cvt_pk_bf16_f32 v83, v70, v71
  v_mfma_f32_16x16x32_bf16 v[72:75], v[28:31], a[36:39], v[72:75]
  buffer_store_dwordx4 v[80:83], v5, s[8:11], s58 offen sc1
  v_mfma_f32_16x16x32_bf16 v[76:79], v[52:55], a[36:39], v[76:79]
  s_add_u32 s58, s55, 262144
  v_mfma_f32_16x16x32_bf16 v[72:75], v[32:35], a[40:43], v[72:75]
  s_lshr_b32 s46, s58, 8
  v_mfma_f32_16x16x32_bf16 v[76:79], v[56:59], a[40:43], v[76:79]
  s_and_b32 s46, s46, 0x2000
  v_mfma_f32_16x16x32_bf16 v[72:75], v[36:39], a[44:47], v[72:75]
  s_xor_b32 s58, s58, s46
  v_mfma_f32_16x16x32_bf16 v[76:79], v[60:63], a[44:47], v[76:79]
  s_xor_b32 s60, s60, 0x4000
  v_mov_b32 v8, s52
  v_mfma_f32_16x16x32_bf16 v[64:67], v[16:19], a[48:51], 0
  s_add_u32 s62, s62, 32
  v_xor_b32 v12, 0x4000, v12
  v_mfma_f32_16x16x32_bf16 v[68:71], v[40:43], a[48:51], 0
  s_cmp_ge_u32 s62, 1024
  s_cselect_b32 s47, 1024, 0
  v_mfma_f32_16x16x32_bf16 v[64:67], v[20:23], a[52:55], v[64:67]
  s_sub_u32 s62, s62, s47
  v_cvt_pk_bf16_f32 v84, v72, v73
  v_mfma_f32_16x16x32_bf16 v[68:71], v[44:47], a[52:55], v[68:71]
  s_lshr_b32 s54, s62, 1
  v_cvt_pk_bf16_f32 v85, v74, v75
  v_mfma_f32_16x16x32_bf16 v[64:67], v[24:27], a[56:59], v[64:67]
  s_lshl_b32 s54, s54, 14
  v_cvt_pk_bf16_f32 v86, v76, v77
  v_mfma_f32_16x16x32_bf16 v[68:71], v[48:51], a[56:59], v[68:71]
  s_and_b32 s47, s62, 1
  v_cvt_pk_bf16_f32 v87, v78, v79
  v_mfma_f32_16x16x32_bf16 v[64:67], v[28:31], a[60:63], v[64:67]
  buffer_store_dwordx4 v[84:87], v5, s[8:11], s58 offen sc1
  s_lshl_b32 s47, s47, 12
  v_mfma_f32_16x16x32_bf16 v[68:71], v[52:55], a[60:63], v[68:71]
  s_add_u32 s58, s55, 524288
  s_add_u32 s54, s54, s47
  v_mfma_f32_16x16x32_bf16 v[64:67], v[32:35], a[64:67], v[64:67]
  s_lshr_b32 s46, s58, 8
  s_add_u32 s54, s54, s61
  v_mfma_f32_16x16x32_bf16 v[68:71], v[56:59], a[64:67], v[68:71]
  s_and_b32 s46, s46, 0x2000
  s_lshr_b32 s47, s54, 8
  v_mfma_f32_16x16x32_bf16 v[64:67], v[36:39], a[68:71], v[64:67]
  s_xor_b32 s58, s58, s46
  s_and_b32 s47, s47, 0x2000
  v_mfma_f32_16x16x32_bf16 v[68:71], v[60:63], a[68:71], v[68:71]
  s_xor_b32 s54, s54, s47
  v_mfma_f32_16x16x32_bf16 v[72:75], v[16:19], a[72:75], 0
  v_mfma_f32_16x16x32_bf16 v[76:79], v[40:43], a[72:75], 0
  v_mfma_f32_16x16x32_bf16 v[72:75], v[20:23], a[76:79], v[72:75]
  v_cvt_pk_bf16_f32 v80, v64, v65
  v_mfma_f32_16x16x32_bf16 v[76:79], v[44:47], a[76:79], v[76:79]
  v_cvt_pk_bf16_f32 v81, v66, v67
  v_mfma_f32_16x16x32_bf16 v[72:75], v[24:27], a[80:83], v[72:75]
  v_cvt_pk_bf16_f32 v82, v68, v69
  v_mfma_f32_16x16x32_bf16 v[76:79], v[48:51], a[80:83], v[76:79]
  v_cvt_pk_bf16_f32 v83, v70, v71
  v_mfma_f32_16x16x32_bf16 v[72:75], v[28:31], a[84:87], v[72:75]
  buffer_store_dwordx4 v[80:83], v5, s[8:11], s58 offen sc1
  v_mfma_f32_16x16x32_bf16 v[76:79], v[52:55], a[84:87], v[76:79]
  s_add_u32 s58, s55, 786432
  v_mfma_f32_16x16x32_bf16 v[72:75], v[32:35], a[88:91], v[72:75]
  s_lshr_b32 s46, s58, 8
  v_mfma_f32_16x16x32_bf16 v[76:79], v[56:59], a[88:91], v[76:79]
  s_and_b32 s46, s46, 0x2000
  v_mfma_f32_16x16x32_bf16 v[72:75], v[36:39], a[92:95], v[72:75]
  s_xor_b32 s58, s58, s46
  s_waitcnt vmcnt(3)
  v_readfirstlane_b32 s56, v13
  v_mfma_f32_16x16x32_bf16 v[76:79], v[60:63], a[92:95], v[76:79]
  buffer_store_dword v8, v7, s[8:11], 0 offen sc1
  v_mfma_f32_16x16x32_bf16 v[64:67], v[16:19], a[96:99], 0
  s_cmp_lt_u32 s56, s57
  s_cbranch_scc1 u_slow
u_back:
  v_mfma_f32_16x16x32_bf16 v[68:71], v[40:43], a[96:99], 0
  s_add_u32 m0, s60, 0
  s_add_u32 s47, s54, 0
  buffer_load_dwordx4 v5, s[8:11], s47 offen sc1 lds
  v_mfma_f32_16x16x32_bf16 v[64:67], v[20:23], a[100:103], v[64:67]
  s_add_u32 m0, s60, 4096
  s_add_u32 s47, s54, 16777216
  buffer_load_dwordx4 v5, s[8:11], s47 offen sc1 lds
  v_cvt_pk_bf16_f32 v84, v72, v73
  v_mfma_f32_16x16x32_bf16 v[68:71], v[44:47], a[100:103], v[68:71]
  s_add_u32 m0, s60, 8192
  s_add_u32 s47, s54, 33554432
  buffer_load_dwordx4 v5, s[8:11], s47 offen sc1 lds
  v_cvt_pk_bf16_f32 v85, v74, v75
  v_mfma_f32_16x16x32_bf16 v[64:67], v[24:27], a[104:107], v[64:67]
  v_cvt_pk_bf16_f32 v86, v76, v77
  v_mfma_f32_16x16x32_bf16 v[68:71], v[48:51], a[104:107], v[68:71]
  v_cvt_pk_bf16_f32 v87, v78, v79
  v_mfma_f32_16x16x32_bf16 v[64:67], v[28:31], a[108:111], v[64:67]
  buffer_store_dwordx4 v[84:87], v5, s[8:11], s58 offen sc1
  v_mfma_f32_16x16x32_bf16 v[68:71], v[52:55], a[108:111], v[68:71]
  s_add_u32 s58, s55, 1048576
  v_mfma_f32_16x16x32_bf16 v[64:67], v[32:35], a[112:115], v[64:67]
  s_lshr_b32 s46, s58, 8
  v_mfma_f32_16x16x32_bf16 v[68:71], v[56:59], a[112:115], v[68:71]
  s_and_b32 s46, s46, 0x2000
  v_mfma_f32_16x16x32_bf16 v[64:67], v[36:39], a[116:119], v[64:67]
  s_xor_b32 s58, s58, s46
  v_mfma_f32_16x16x32_bf16 v[68:71], v[60:63], a[116:119], v[68:71]
  v_mfma_f32_16x16x32_bf16 v[72:75], v[16:19], a[120:123], 0
  v_mfma_f32_16x16x32_bf16 v[76:79], v[40:43], a[120:123], 0
  v_mfma_f32_16x16x32_bf16 v[72:75], v[20:23], a[124:127], v[72:75]
  v_cvt_pk_bf16_f32 v80, v64, v65
  v_mfma_f32_16x16x32_bf16 v[76:79], v[44:47], a[124:127], v[76:79]
  v_cvt_pk_bf16_f32 v81, v66, v67
  v_mfma_f32_16x16x32_bf16 v[72:75], v[24:27], a[128:131], v[72:75]
  v_cvt_pk_bf16_f32 v82, v68, v69
  v_mfma_f32_16x16x32_bf16 v[76:79], v[48:51], a[128:131], v[76:79]
  v_cvt_pk_bf16_f32 v83, v70, v71
  v_mfma_f32_16x16x32_bf16 v[72:75], v[28:31], a[132:135], v[72:75]
  buffer_store_dwordx4 v[80:83], v5, s[8:11], s58 offen sc1
  v_mfma_f32_16x16x32_bf16 v[76:79], v[52:55], a[132:135], v[76:79]
  s_add_u32 s58, s55, 1310720
  v_mfma_f32_16x16x32_bf16 v[72:75], v[32:35], a[136:139], v[72:75]
  s_lshr_b32 s46, s58, 8
  v_mfma_f32_16x16x32_bf16 v[76:79], v[56:59], a[136:139], v[76:79]
  s_and_b32 s46, s46, 0x2000
  v_mfma_f32_16x16x32_bf16 v[72:75], v[36:39], a[140:143], v[72:75]
  s_xor_b32 s58, s58, s46
  v_mfma_f32_16x16x32_bf16 v[76:79], v[60:63], a[140:143], v[76:79]
  v_mfma_f32_16x16x32_bf16 v[64:67], v[16:19], a[144:147], 0
  v_mfma_f32_16x16x32_bf16 v[68:71], v[40:43], a[144:147], 0
  v_mfma_f32_16x16x32_bf16 v[64:67], v[20:23], a[148:151], v[64:67]
  v_cvt_pk_bf16_f32 v84, v72, v73
  v_mfma_f32_16x16x32_bf16 v[68:71], v[44:47], a[148:151], v[68:71]
  v_cvt_pk_bf16_f32 v85, v74, v75
  v_mfma_f32_16x16x32_bf16 v[64:67], v[24:27], a[152:155], v[64:67]
  v_cvt_pk_bf16_f32 v86, v76, v77
  v_mfma_f32_16x16x32_bf16 v[68:71], v[48:51], a[152:155], v[68:71]
  v_cvt_pk_bf16_f32 v87, v78, v79
  v_mfma_f32_16x16x32_bf16 v[64:67], v[28:31], a[156:159], v[64:67]
  buffer_store_dwordx4 v[84:87], v5, s[8:11], s58 offen sc1
  v_mfma_f32_16x16x32_bf16 v[68:71], v[52:55], a[156:159], v[68:71]
  s_add_u32 s58, s55, 1572864
  v_mfma_f32_16x16x32_bf16 v[64:67], v[32:35], a[160:163], v[64:67]
  s_lshr_b32 s46, s58, 8
  v_mfma_f32_16x16x32_bf16 v[68:71], v[56:59], a[160:163], v[68:71]
  s_and_b32 s46, s46, 0x2000
  v_mfma_f32_16x16x32_bf16 v[64:67], v[36:39], a[164:167], v[64:67]
  s_xor_b32 s58, s58, s46
  v_mfma_f32_16x16x32_bf16 v[68:71], v[60:63], a[164:167], v[68:71]
  v_mfma_f32_16x16x32_bf16 v[72:75], v[16:19], a[168:171], 0
  v_mfma_f32_16x16x32_bf16 v[76:79], v[40:43], a[168:171], 0
  v_mfma_f32_16x16x32_bf16 v[72:75], v[20:23], a[172:175], v[72:75]
  v_cvt_pk_bf16_f32 v80, v64, v65
  v_mfma_f32_16x16x32_bf16 v[76:79], v[44:47], a[172:175], v[76:79]
  v_cvt_pk_bf16_f32 v81, v66, v67
  v_mfma_f32_16x16x32_bf16 v[72:75], v[24:27], a[176:179], v[72:75]
  v_cvt_pk_bf16_f32 v82, v68, v69
  v_mfma_f32_16x16x32_bf16 v[76:79], v[48:51], a[176:179], v[76:79]
  v_cvt_pk_bf16_f32 v83, v70, v71
  v_mfma_f32_16x16x32_bf16 v[72:75], v[28:31], a[180:183], v[72:75]
  buffer_store_dwordx4 v[80:83], v5, s[8:11], s58 offen sc1
  v_mfma_f32_16x16x32_bf16 v[76:79], v[52:55], a[180:183], v[76:79]
  s_add_u32 s58, s55, 1835008
  v_mfma_f32_16x16x32_bf16 v[72:75], v[32:35], a[184:187], v[72:75]
  s_lshr_b32 s46, s58, 8
  v_mfma_f32_16x16x32_bf16 v[76:79], v[56:59], a[184:187], v[76:79]
  s_and_b32 s46, s46, 0x2000
  v_mfma_f32_16x16x32_bf16 v[72:75], v[36:39], a[188:191], v[72:75]
  s_xor_b32 s58, s58, s46
  v_mfma_f32_16x16x32_bf16 v[76:79], v[60:63], a[188:191], v[76:79]
  v_mfma_f32_16x16x32_bf16 v[64:67], v[16:19], a[192:195], 0
  v_mfma_f32_16x16x32_bf16 v[68:71], v[40:43], a[192:195], 0
  v_mfma_f32_16x16x32_bf16 v[64:67], v[20:23], a[196:199], v[64:67]
  v_cvt_pk_bf16_f32 v84, v72, v73
  v_mfma_f32_16x16x32_bf16 v[68:71], v[44:47], a[196:199], v[68:71]
  v_cvt_pk_bf16_f32 v85, v74, v75
  v_mfma_f32_16x16x32_bf16 v[64:67], v[24:27], a[200:203], v[64:67]
  v_cvt_pk_bf16_f32 v86, v76, v77
  v_mfma_f32_16x16x32_bf16 v[68:71], v[48:51], a[200:203], v[68:71]
  v_cvt_pk_bf16_f32 v87, v78, v79
  v_mfma_f32_16x16x32_bf16 v[64:67], v[28:31], a[204:207], v[64:67]
  buffer_store_dwordx4 v[84:87], v5, s[8:11], s58 offen sc1
  v_mfma_f32_16x16x32_bf16 v[68:71], v[52:55], a[204:207], v[68:71]
  s_add_u32 s58, s55, 2097152
  v_mfma_f32_16x16x32_bf16 v[64:67], v[32:35], a[208:211], v[64:67]
  s_lshr_b32 s46, s58, 8
  v_mfma_f32_16x16x32_bf16 v[68:71], v[56:59], a[208:211], v[68:71]
  s_and_b32 s46, s46, 0x2000
  v_mfma_f32_16x16x32_bf16 v[64:67], v[36:39], a[212:215], v[64:67]
  s_xor_b32 s58, s58, s46
  s_waitcnt vmcnt(5)
  s_barrier
  v_mfma_f32_16x16x32_bf16 v[68:71], v[60:63], a[212:215], v[68:71]
  s_add_u32 s55, s55, 2621440
  v_mfma_f32_16x16x32_bf16 v[72:75], v[16:19], a[216:219], 0
  ds_read_b128 v[16:19], v12 offset:0
  v_mfma_f32_16x16x32_bf16 v[76:79], v[40:43], a[216:219], 0
  ds_read_b128 v[40:43], v12 offset:2048
  v_mfma_f32_16x16x32_bf16 v[72:75], v[20:23], a[220:223], v[72:75]
  ds_read_b128 v[20:23], v12 offset:1024
  v_cvt_pk_bf16_f32 v80, v64, v65
  v_mfma_f32_16x16x32_bf16 v[76:79], v[44:47], a[220:223], v[76:79]
  ds_read_b128 v[44:47], v12 offset:3072
  v_cvt_pk_bf16_f32 v81, v66, v67
  v_mfma_f32_16x16x32_bf16 v[72:75], v[24:27], a[224:227], v[72:75]
  ds_read_b128 v[24:27], v12 offset:4096
  v_cvt_pk_bf16_f32 v82, v68, v69
  v_mfma_f32_16x16x32_bf16 v[76:79], v[48:51], a[224:227], v[76:79]
  ds_read_b128 v[48:51], v12 offset:6144
  v_cvt_pk_bf16_f32 v83, v70, v71
  v_mfma_f32_16x16x32_bf16 v[72:75], v[28:31], a[228:231], v[72:75]
  buffer_store_dwordx4 v[80:83], v5, s[8:11], s58 offen sc1
  ds_read_b128 v[28:31], v12 offset:5120
  v_mfma_f32_16x16x32_bf16 v[76:79], v[52:55], a[228:231], v[76:79]
  ds_read_b128 v[52:55], v12 offset:7168
  s_cmp_ge_u32 s55, 165675008
  s_cselect_b32 s46, 83886080, 0
  v_mfma_f32_16x16x32_bf16 v[72:75], v[32:35], a[232:235], v[72:75]
  ds_read_b128 v[32:35], v12 offset:8192
  s_sub_u32 s55, s55, s46
  v_mfma_f32_16x16x32_bf16 v[76:79], v[56:59], a[232:235], v[76:79]
  ds_read_b128 v[56:59], v12 offset:10240
  s_add_u32 s52, s52, 1
  v_mfma_f32_16x16x32_bf16 v[72:75], v[36:39], a[236:239], v[72:75]
  ds_read_b128 v[36:39], v12 offset:9216
  s_cmp_lt_u32 s52, 64
  v_mfma_f32_16x16x32_bf16 v[76:79], v[60:63], a[236:239], v[76:79]
  ds_read_b128 v[60:63], v12 offset:11264
  s_cbranch_scc1 u_loop
  s_nop 2
  v_cvt_pk_bf16_f32 v84, v72, v73
  v_cvt_pk_bf16_f32 v85, v74, v75
  s_nop 0
  v_cvt_pk_bf16_f32 v86, v76, v77
  v_cvt_pk_bf16_f32 v87, v78, v79
  buffer_store_dwordx4 v[84:87], v5, s[8:11], s59 offen sc1
  v_mov_b32 v8, s52
  s_waitcnt vmcnt(0) lgkmcnt(0)
  buffer_store_dword v8, v7, s[8:11], 0 offen sc1
  s_branch u_done
u_slow:
  s_cmp_ge_u32 s56, s57
  s_cbranch_scc1 wf_done_12
  s_mov_b32 s50, 0
wf_loop_13:
  buffer_load_dword v13, v6, s[8:11], 0 offen sc1
  s_add_u32 s50, s50, 1
  s_cmp_gt_u32 s50, 131072
  s_cbranch_scc1 L_fail
  s_waitcnt vmcnt(0)
  v_readfirstlane_b32 s56, v13
  s_nop 0
  s_cmp_ge_u32 s56, s57
  s_cbranch_scc1 wf_done_12
  s_sleep 2
  s_branch wf_loop_13
wf_done_12:
  s_branch u_back
u_done:
L_parta:
  s_barrier
  s_lshl_b32 s65, s44, 2
  s_add_u32 s65, s65, s43
  s_sub_u32 s65, s65, 4
  s_cmp_ge_u32 s65, 120
  s_cbranch_scc1 pa_att
  s_mov_b32 s4, s18
  s_mov_b32 s5, s19
  s_mov_b32 s6, 2457600
  s_mov_b32 s7, 0x20000
  s_mov_b32 s12, s16
  s_mov_b32 s13, s17
  s_mov_b32 s14, 2621440
  s_mov_b32 s15, 0x20000
  s_mul_i32 s46, s65, 205
  s_lshr_b32 s46, s46, 11
  s_mul_i32 s47, s46, 10
  s_sub_u32 s47, s65, s47
  s_mul_i32 s60, s47, 384
  s_lshl_b32 s67, s47, 6
  s_mov_b32 s63, 176168960
  s_mul_i32 s61, s46, 6
  s_add_u32 s62, s61, 6
  s_mul_i32 s48, s46, 3
  s_add_u32 s49, s48, 31
  s_add_u32 s48, s48, 28
  s_min_u32 s61, s61, s48
  s_min_u32 s62, s62, s49
  s_add_u32 s67, s67, s61
  s_lshl_b32 s64, s65, 7
  s_add_u32 s64, s64, 1081344
  v_lshrrev_b32 v10, 3, v0
  v_lshrrev_b32 v11, 2, v10
  v_lshlrev_b32 v11, 3, v11
  v_and_b32 v1, 3, v10
  v_add_u32 v1, v1, v11
  s_and_b32 s46, s42, 1
  s_lshl_b32 s46, s46, 2
  s_lshr_b32 s47, s42, 1
  s_lshl_b32 s47, s47, 4
  s_add_u32 s46, s46, s47
  v_add_u32 v1, s46, v1
  v_mul_u32_u24 v1, 3840, v1
  v_lshrrev_b32 v10, 1, v10
  v_bfe_u32 v11, v0, 1, 2
  v_xor_b32 v10, v10, v11
  v_lshlrev_b32 v10, 5, v10
  v_and_b32 v11, 1, v0
  v_lshlrev_b32 v11, 4, v11
  v_add3_u32 v1, v1, v10, v11
  v_lshrrev_b32 v10, 5, v0
  v_lshlrev_b32 v2, 11, v10
  v_bfe_u32 v10, v0, 2, 3
  v_lshl_add_u32 v2, v10, 7, v2
  v_lshrrev_b32 v10, 1, v10
  v_xor_b32 v10, s42, v10
  v_lshl_add_u32 v2, v10, 5, v2
  v_and_b32 v10, 3, v0
  v_lshl_add_u32 v2, v10, 3, v2
  v_add_u32 v3, 0x10000, v2
  v_add_u32 v4, 0x20000, v2
  v_lshrrev_b32 v10, 3, v0
  s_lshl_b32 s46, s42, 3
  v_add_u32 v10, s46, v10
  v_mul_u32_u24 v5, 1280, v10
  v_bfe_u32 v10, v10, 1, 3
  v_and_b32 v11, 7, v0
  v_xor_b32 v10, v10, v11
  v_lshl_add_u32 v5, v10, 4, v5
  v_and_b32 v10, 15, v0
  v_lshlrev_b32 v6, 7, v10
  v_lshrrev_b32 v10, 1, v10
  v_lshrrev_b32 v11, 4, v0
  v_xor_b32 v10, v10, v11
  v_lshl_add_u32 v6, v10, 4, v6
  v_add_u32 v6, 122880, v6
  v_xor_b32 v7, 64, v6
  v_and_b32 v10, 15, v0
  v_lshlrev_b32 v8, 4, v10
  v_bfe_u32 v10, v0, 4, 1
  v_lshlrev_b32 v10, 11, v10
  v_lshrrev_b32 v11, 5, v0
  v_lshlrev_b32 v11, 8, v11
  v_add3_u32 v8, v8, v10, v11
  s_lshl_b32 s46, s42, 9
  v_add_u32 v8, s46, v8
  v_mov_b32 v9, s64
  v_mov_b32 v10, 2146435072
  s_cmp_eq_u32 s42, 0
  s_cselect_b64 vcc, 1, 0
  v_cndmask_b32 v9, v10, v9, vcc
  s_lshl_b32 s46, s43, 7
  s_add_u32 s46, s46, 1076736
  v_mov_b32 v14, s46
  s_mov_b32 s68, 0
  s_lshr_b32 s70, s44, 5
  s_add_u32 s70, s70, 60
  s_mov_b32 s52, s61
  s_mul_i32 s53, s52, 40960
  s_add_u32 s54, s51, 122880
  s_add_u32 m0, s54, 0
  s_nop 0
  buffer_load_dwordx4 v5, s[12:15], s53 offen offset:0 lds
  s_add_u32 m0, s54, 3968
  s_nop 0
  buffer_load_dwordx4 v5, s[12:15], s53 offen offset:128 lds
  s_add_u32 m0, s54, 7936
  s_nop 0
  buffer_load_dwordx4 v5, s[12:15], s53 offen offset:256 lds
  s_add_u32 m0, s54, 11904
  s_nop 0
  buffer_load_dwordx4 v5, s[12:15], s53 offen offset:384 lds
  s_add_u32 m0, s54, 15872
  s_nop 0
  buffer_load_dwordx4 v5, s[12:15], s53 offen offset:512 lds
  s_add_u32 m0, s54, 19840
  s_nop 0
  buffer_load_dwordx4 v5, s[12:15], s53 offen offset:640 lds
  s_add_u32 m0, s54, 23808
  s_nop 0
  buffer_load_dwordx4 v5, s[12:15], s53 offen offset:768 lds
  s_add_u32 m0, s54, 27776
  s_nop 0
  buffer_load_dwordx4 v5, s[12:15], s53 offen offset:896 lds
  s_add_u32 m0, s54, 31744
  s_nop 0
  buffer_load_dwordx4 v5, s[12:15], s53 offen offset:1024 lds
  s_add_u32 m0, s54, 35712
  s_nop 0
  buffer_load_dwordx4 v5, s[12:15], s53 offen offset:1152 lds
  s_add_u32 m0, s51, 0
  s_add_u32 s46, s60, 0
  buffer_load_dwordx4 v1, s[4:7], s46 offen  lds
  s_add_u32 m0, s51, 4096
  s_add_u32 s46, s60, 128
  buffer_load_dwordx4 v1, s[4:7], s46 offen  lds
  s_add_u32 m0, s51, 8192
  s_add_u32 s46, s60, 256
  buffer_load_dwordx4 v1, s[4:7], s46 offen  lds
  s_add_u32 m0, s51, 12288
  s_add_u32 s46, s60, 122880
  buffer_load_dwordx4 v1, s[4:7], s46 offen  lds
  s_add_u32 m0, s51, 16384
  s_add_u32 s46, s60, 123008
  buffer_load_dwordx4 v1, s[4:7], s46 offen  lds
  s_add_u32 m0, s51, 20480
  s_add_u32 s46, s60, 123136
  buffer_load_dwordx4 v1, s[4:7], s46 offen  lds
  s_add_u32 m0, s51, 24576
  s_add_u32 s46, s60, 245760
  buffer_load_dwordx4 v1, s[4:7], s46 offen  lds
  s_add_u32 m0, s51, 28672
  s_add_u32 s46, s60, 245888
  buffer_load_dwordx4 v1, s[4:7], s46 offen  lds
  s_add_u32 m0, s51, 32768
  s_add_u32 s46, s60, 246016
  buffer_load_dwordx4 v1, s[4:7], s46 offen  lds
  s_add_u32 m0, s51, 36864
  s_add_u32 s46, s60, 368640
  buffer_load_dwordx4 v1, s[4:7], s46 offen  lds
  s_add_u32 m0, s51, 40960
  s_add_u32 s46, s60, 368768
  buffer_load_dwordx4 v1, s[4:7], s46 offen  lds
  s_add_u32 m0, s51, 45056
  s_add_u32 s46, s60, 368896
  buffer_load_dwordx4 v1, s[4:7], s46 offen  lds
  s_add_u32 m0, s51, 49152
  s_add_u32 s46, s60, 491520
  buffer_load_dwordx4 v1, s[4:7], s46 offen  lds
  s_add_u32 m0, s51, 53248
  s_add_u32 s46, s60, 491648
  buffer_load_dwordx4 v1, s[4:7], s46 offen  lds
  s_add_u32 m0, s51, 57344
  s_add_u32 s46, s60, 491776
  buffer_load_dwordx4 v1, s[4:7], s46 offen  lds
  s_add_u32 m0, s51, 61440
  s_add_u32 s46, s60, 614400
  buffer_load_dwordx4 v1, s[4:7], s46 offen  lds
  s_add_u32 m0, s51, 65536
  s_add_u32 s46, s60, 614528
  buffer_load_dwordx4 v1, s[4:7], s46 offen  lds
  s_add_u32 m0, s51, 69632
  s_add_u32 s46, s60, 614656
  buffer_load_dwordx4 v1, s[4:7], s46 offen  lds
  s_add_u32 m0, s51, 73728
  s_add_u32 s46, s60, 737280
  buffer_load_dwordx4 v1, s[4:7], s46 offen  lds
  s_add_u32 m0, s51, 77824
  s_add_u32 s46, s60, 737408
  buffer_load_dwordx4 v1, s[4:7], s46 offen  lds
  s_add_u32 m0, s51, 81920
  s_add_u32 s46, s60, 737536
  buffer_load_dwordx4 v1, s[4:7], s46 offen  lds
  s_add_u32 m0, s51, 86016
  s_add_u32 s46, s60, 860160
  buffer_load_dwordx4 v1, s[4:7], s46 offen  lds
  s_add_u32 m0, s51, 90112
  s_add_u32 s46, s60, 860288
  buffer_load_dwordx4 v1, s[4:7], s46 offen  lds
  s_add_u32 m0, s51, 94208
  s_add_u32 s46, s60, 860416
  buffer_load_dwordx4 v1, s[4:7], s46 offen  lds
  s_waitcnt vmcnt(18)
  s_barrier
  s_add_u32 m0, s51, 98304
  s_add_u32 s46, s60, 983040
  buffer_load_dwordx4 v1, s[4:7], s46 offen  lds
  s_add_u32 m0, s51, 102400
  s_add_u32 s46, s60, 983168
  buffer_load_dwordx4 v1, s[4:7], s46 offen  lds
  s_add_u32 m0, s51, 106496
  s_add_u32 s46, s60, 983296
  buffer_load_dwordx4 v1, s[4:7], s46 offen  lds
  s_add_u32 m0, s51, 110592
  s_add_u32 s46, s60, 1105920
  buffer_load_dwordx4 v1, s[4:7], s46 offen  lds
  s_add_u32 m0, s51, 114688
  s_add_u32 s46, s60, 1106048
  buffer_load_dwordx4 v1, s[4:7], s46 offen  lds
  s_add_u32 m0, s51, 118784
  s_add_u32 s46, s60, 1106176
  buffer_load_dwordx4 v1, s[4:7], s46 offen  lds
  ds_read_b64_tr_b16 a[0:1], v2 offset:0
  ds_read_b64_tr_b16 a[2:3], v2 offset:1024
  ds_read_b64_tr_b16 a[4:5], v2 offset:4096
  ds_read_b64_tr_b16 a[6:7], v2 offset:5120
  ds_read_b64_tr_b16 a[8:9], v2 offset:8192
  ds_read_b64_tr_b16 a[10:11], v2 offset:9216
  ds_read_b64_tr_b16 a[12:13], v2 offset:12288
  ds_read_b64_tr_b16 a[14:15], v2 offset:13312
  ds_read_b64_tr_b16 a[16:17], v2 offset:16384
  ds_read_b64_tr_b16 a[18:19], v2 offset:17408
  ds_read_b64_tr_b16 a[20:21], v2 offset:20480
  ds_read_b64_tr_b16 a[22:23], v2 offset:21504
  s_waitcnt lgkmcnt(0)
  s_waitcnt vmcnt(18)
  s_barrier
  s_add_u32 m0, s51, 0
  s_add_u32 s46, s60, 1228800
  buffer_load_dwordx4 v1, s[4:7], s46 offen  lds
  s_add_u32 m0, s51, 4096
  s_add_u32 s46, s60, 1228928
  buffer_load_dwordx4 v1, s[4:7], s46 offen  lds
  s_add_u32 m0, s51, 8192
  s_add_u32 s46, s60, 1229056
  buffer_load_dwordx4 v1, s[4:7], s46 offen  lds
  s_add_u32 m0, s51, 12288
  s_add_u32 s46, s60, 1351680
  buffer_load_dwordx4 v1, s[4:7], s46 offen  lds
  s_add_u32 m0, s51, 16384
  s_add_u32 s46, s60, 1351808
  buffer_load_dwordx4 v1, s[4:7], s46 offen  lds
  s_add_u32 m0, s51, 20480
  s_add_u32 s46, s60, 1351936
  buffer_load_dwordx4 v1, s[4:7], s46 offen  lds
  ds_read_b64_tr_b16 a[24:25], v2 offset:24576
  ds_read_b64_tr_b16 a[26:27], v2 offset:25600
  ds_read_b64_tr_b16 a[28:29], v2 offset:28672
  ds_read_b64_tr_b16 a[30:31], v2 offset:29696
  ds_read_b64_tr_b16 a[32:33], v2 offset:32768
  ds_read_b64_tr_b16 a[34:35], v2 offset:33792
  ds_read_b64_tr_b16 a[36:37], v2 offset:36864
  ds_read_b64_tr_b16 a[38:39], v2 offset:37888
  ds_read_b64_tr_b16 a[40:41], v2 offset:40960
  ds_read_b64_tr_b16 a[42:43], v2 offset:41984
  ds_read_b64_tr_b16 a[44:45], v2 offset:45056
  ds_read_b64_tr_b16 a[46:47], v2 offset:46080
  s_waitcnt lgkmcnt(0)
  s_waitcnt vmcnt(18)
  s_barrier
  s_add_u32 m0, s51, 24576
  s_add_u32 s46, s60, 1474560
  buffer_load_dwordx4 v1, s[4:7], s46 offen  lds
  s_add_u32 m0, s51, 28672
  s_add_u32 s46, s60, 1474688
  buffer_load_dwordx4 v1, s[4:7], s46 offen  lds
  s_add_u32 m0, s51, 32768
  s_add_u32 s46, s60, 1474816
  buffer_load_dwordx4 v1, s[4:7], s46 offen  lds
  s_add_u32 m0, s51, 36864
  s_add_u32 s46, s60, 1597440
  buffer_load_dwordx4 v1, s[4:7], s46 offen  lds
  s_add_u32 m0, s51, 40960
  s_add_u32 s46, s60, 1597568
  buffer_load_dwordx4 v1, s[4:7], s46 offen  lds
  s_add_u32 m0, s51, 45056
  s_add_u32 s46, s60, 1597696
  buffer_load_dwordx4 v1, s[4:7], s46 offen  lds
  ds_read_b64_tr_b16 a[48:49], v2 offset:49152
  ds_read_b64_tr_b16 a[50:51], v2 offset:50176
  ds_read_b64_tr_b16 a[52:53], v2 offset:53248
  ds_read_b64_tr_b16 a[54:55], v2 offset:54272
  ds_read_b64_tr_b16 a[56:57], v2 offset:57344
  ds_read_b64_tr_b16 a[58:59], v2 offset:58368
  ds_read_b64_tr_b16 a[60:61], v2 offset:61440
  ds_read_b64_tr_b16 a[62:63], v2 offset:62464
  ds_read_b64_tr_b16 a[64:65], v3 offset:0
  ds_read_b64_tr_b16 a[66:67], v3 offset:1024
  ds_read_b64_tr_b16 a[68:69], v3 offset:4096
  ds_read_b64_tr_b16 a[70:71], v3 offset:5120
  s_waitcnt lgkmcnt(0)
  s_waitcnt vmcnt(18)
  s_barrier
  s_add_u32 m0, s51, 49152
  s_add_u32 s46, s60, 1720320
  buffer_load_dwordx4 v1, s[4:7], s46 offen  lds
  s_add_u32 m0, s51, 53248
  s_add_u32 s46, s60, 1720448
  buffer_load_dwordx4 v1, s[4:7], s46 offen  lds
  s_add_u32 m0, s51, 57344
  s_add_u32 s46, s60, 1720576
  buffer_load_dwordx4 v1, s[4:7], s46 offen  lds
  s_add_u32 m0, s51, 61440
  s_add_u32 s46, s60, 1843200
  buffer_load_dwordx4 v1, s[4:7], s46 offen  lds
  s_add_u32 m0, s51, 65536
  s_add_u32 s46, s60, 1843328
  buffer_load_dwordx4 v1, s[4:7], s46 offen  lds
  s_add_u32 m0, s51, 69632
  s_add_u32 s46, s60, 1843456
  buffer_load_dwordx4 v1, s[4:7], s46 offen  lds
  ds_read_b64_tr_b16 a[72:73], v3 offset:8192
  ds_read_b64_tr_b16 a[74:75], v3 offset:9216
  ds_read_b64_tr_b16 a[76:77], v3 offset:12288
  ds_read_b64_tr_b16 a[78:79], v3 offset:13312
  ds_read_b64_tr_b16 a[80:81], v3 offset:16384
  ds_read_b64_tr_b16 a[82:83], v3 offset:17408
  ds_read_b64_tr_b16 a[84:85], v3 offset:20480
  ds_read_b64_tr_b16 a[86:87], v3 offset:21504
  ds_read_b64_tr_b16 a[88:89], v3 offset:24576
  ds_read_b64_tr_b16 a[90:91], v3 offset:25600
  ds_read_b64_tr_b16 a[92:93], v3 offset:28672
  ds_read_b64_tr_b16 a[94:95], v3 offset:29696
  s_waitcnt lgkmcnt(0)
  s_waitcnt vmcnt(18)
  s_barrier
  s_add_u32 m0, s51, 73728
  s_add_u32 s46, s60, 1966080
  buffer_load_dwordx4 v1, s[4:7], s46 offen  lds
  s_add_u32 m0, s51, 77824
  s_add_u32 s46, s60, 1966208
  buffer_load_dwordx4 v1, s[4:7], s46 offen  lds
  s_add_u32 m0, s51, 81920
  s_add_u32 s46, s60, 1966336
  buffer_load_dwordx4 v1, s[4:7], s46 offen  lds
  s_add_u32 m0, s51, 86016
  s_add_u32 s46, s60, 2088960
  buffer_load_dwordx4 v1, s[4:7], s46 offen  lds
  s_add_u32 m0, s51, 90112
  s_add_u32 s46, s60, 2089088
  buffer_load_dwordx4 v1, s[4:7], s46 offen  lds
  s_add_u32 m0, s51, 94208
  s_add_u32 s46, s60, 2089216
  buffer_load_dwordx4 v1, s[4:7], s46 offen  lds
  ds_read_b64_tr_b16 a[96:97], v3 offset:32768
  ds_read_b64_tr_b16 a[98:99], v3 offset:33792
  ds_read_b64_tr_b16 a[100:101], v3 offset:36864
  ds_read_b64_tr_b16 a[102:103], v3 offset:37888
  ds_read_b64_tr_b16 a[104:105], v3 offset:40960
  ds_read_b64_tr_b16 a[106:107], v3 offset:41984
  ds_read_b64_tr_b16 a[108:109], v3 offset:45056
  ds_read_b64_tr_b16 a[110:111], v3 offset:46080
  ds_read_b64_tr_b16 a[112:113], v3 offset:49152
  ds_read_b64_tr_b16 a[114:115], v3 offset:50176
  ds_read_b64_tr_b16 a[116:117], v3 offset:53248
  ds_read_b64_tr_b16 a[118:119], v3 offset:54272
  s_waitcnt lgkmcnt(0)
  s_waitcnt vmcnt(18)
  s_barrier
  s_add_u32 m0, s51, 98304
  s_add_u32 s46, s60, 2211840
  buffer_load_dwordx4 v1, s[4:7], s46 offen  lds
  s_add_u32 m0, s51, 102400
  s_add_u32 s46, s60, 2211968
  buffer_load_dwordx4 v1, s[4:7], s46 offen  lds
  s_add_u32 m0, s51, 106496
  s_add_u32 s46, s60, 2212096
  buffer_load_dwordx4 v1, s[4:7], s46 offen  lds
  s_add_u32 m0, s51, 110592
  s_add_u32 s46, s60, 2334720
  buffer_load_dwordx4 v1, s[4:7], s46 offen  lds
  s_add_u32 m0, s51, 114688
  s_add_u32 s46, s60, 2334848
  buffer_load_dwordx4 v1, s[4:7], s46 offen  lds
  s_add_u32 m0, s51, 118784
  s_add_u32 s46, s60, 2334976
  buffer_load_dwordx4 v1, s[4:7], s46 offen  lds
  ds_read_b64_tr_b16 a[120:121], v2 offset:0
  ds_read_b64_tr_b16 a[122:123], v2 offset:1024
  ds_read_b64_tr_b16 a[124:125], v2 offset:4096
  ds_read_b64_tr_b16 a[126:127], v2 offset:5120
  ds_read_b64_tr_b16 a[128:129], v2 offset:8192
  ds_read_b64_tr_b16 a[130:131], v2 offset:9216
  ds_read_b64_tr_b16 a[132:133], v2 offset:12288
  ds_read_b64_tr_b16 a[134:135], v2 offset:13312
  ds_read_b64_tr_b16 a[136:137], v2 offset:16384
  ds_read_b64_tr_b16 a[138:139], v2 offset:17408
  ds_read_b64_tr_b16 a[140:141], v2 offset:20480
  ds_read_b64_tr_b16 a[142:143], v2 offset:21504
  s_waitcnt lgkmcnt(0)
  s_waitcnt vmcnt(18)
  s_barrier
  ds_read_b64_tr_b16 a[144:145], v2 offset:24576
  ds_read_b64_tr_b16 a[146:147], v2 offset:25600
  ds_read_b64_tr_b16 a[148:149], v2 offset:28672
  ds_read_b64_tr_b16 a[150:151], v2 offset:29696
  ds_read_b64_tr_b16 a[152:153], v2 offset:32768
  ds_read_b64_tr_b16 a[154:155], v2 offset:33792
  ds_read_b64_tr_b16 a[156:157], v2 offset:36864
  ds_read_b64_tr_b16 a[158:159], v2 offset:37888
  ds_read_b64_tr_b16 a[160:161], v2 offset:40960
  ds_read_b64_tr_b16 a[162:163], v2 offset:41984
  ds_read_b64_tr_b16 a[164:165], v2 offset:45056
  ds_read_b64_tr_b16 a[166:167], v2 offset:46080
  s_waitcnt lgkmcnt(0)
  s_waitcnt vmcnt(12)
  s_barrier
  ds_read_b64_tr_b16 a[168:169], v2 offset:49152
  ds_read_b64_tr_b16 a[170:171], v2 offset:50176
  ds_read_b64_tr_b16 a[172:173], v2 offset:53248
  ds_read_b64_tr_b16 a[174:175], v2 offset:54272
  ds_read_b64_tr_b16 a[176:177], v2 offset:57344
  ds_read_b64_tr_b16 a[178:179], v2 offset:58368
  ds_read_b64_tr_b16 a[180:181], v2 offset:61440
  ds_read_b64_tr_b16 a[182:183], v2 offset:62464
  ds_read_b64_tr_b16 a[184:185], v3 offset:0
  ds_read_b64_tr_b16 a[186:187], v3 offset:1024
  ds_read_b64_tr_b16 a[188:189], v3 offset:4096
  ds_read_b64_tr_b16 a[190:191], v3 offset:5120
  s_waitcnt lgkmcnt(0)
  s_waitcnt vmcnt(6)
  s_barrier
  ds_read_b64_tr_b16 a[192:193], v3 offset:8192
  ds_read_b64_tr_b16 a[194:195], v3 offset:9216
  ds_read_b64_tr_b16 a[196:197], v3 offset:12288
  ds_read_b64_tr_b16 a[198:199], v3 offset:13312
  ds_read_b64_tr_b16 a[200:201], v3 offset:16384
  ds_read_b64_tr_b16 a[202:203], v3 offset:17408
  ds_read_b64_tr_b16 a[204:205], v3 offset:20480
  ds_read_b64_tr_b16 a[206:207], v3 offset:21504
  ds_read_b64_tr_b16 a[208:209], v3 offset:24576
  ds_read_b64_tr_b16 a[210:211], v3 offset:25600
  ds_read_b64_tr_b16 a[212:213], v3 offset:28672
  ds_read_b64_tr_b16 a[214:215], v3 offset:29696
  s_waitcnt lgkmcnt(0)
  s_waitcnt vmcnt(0)
  s_barrier
  ds_read_b64_tr_b16 a[216:217], v3 offset:32768
  ds_read_b64_tr_b16 a[218:219], v3 offset:33792
  ds_read_b64_tr_b16 a[220:221], v3 offset:36864
  ds_read_b64_tr_b16 a[222:223], v3 offset:37888
  ds_read_b64_tr_b16 a[224:225], v3 offset:40960
  ds_read_b64_tr_b16 a[226:227], v3 offset:41984
  ds_read_b64_tr_b16 a[228:229], v3 offset:45056
  ds_read_b64_tr_b16 a[230:231], v3 offset:46080
  ds_read_b64_tr_b16 a[232:233], v3 offset:49152
  ds_read_b64_tr_b16 a[234:235], v3 offset:50176
  ds_read_b64_tr_b16 a[236:237], v3 offset:53248
  ds_read_b64_tr_b16 a[238:239], v3 offset:54272
  s_waitcnt lgkmcnt(0)
  s_barrier
  s_mov_b32 s54, s51
  s_add_u32 s53, s53, 40960
  s_add_u32 m0, s54, 0
  s_nop 0
  buffer_load_dwordx4 v5, s[12:15], s53 offen offset:0 lds
  s_add_u32 m0, s54, 3968
  s_nop 0
  buffer_load_dwordx4 v5, s[12:15], s53 offen offset:128 lds
  s_add_u32 m0, s54, 7936
  s_nop 0
  buffer_load_dwordx4 v5, s[12:15], s53 offen offset:256 lds
  s_add_u32 m0, s54, 11904
  s_nop 0
  buffer_load_dwordx4 v5, s[12:15], s53 offen offset:384 lds
  s_add_u32 m0, s54, 15872
  s_nop 0
  buffer_load_dwordx4 v5, s[12:15], s53 offen offset:512 lds
  s_add_u32 m0, s54, 19840
  s_nop 0
  buffer_load_dwordx4 v5, s[12:15], s53 offen offset:640 lds
  s_add_u32 m0, s54, 23808
  s_nop 0
  buffer_load_dwordx4 v5, s[12:15], s53 offen offset:768 lds
  s_add_u32 m0, s54, 27776
  s_nop 0
  buffer_load_dwordx4 v5, s[12:15], s53 offen offset:896 lds
  s_add_u32 m0, s54, 31744
  s_nop 0
  buffer_load_dwordx4 v5, s[12:15], s53 offen offset:1024 lds
  s_add_u32 m0, s54, 35712
  s_nop 0
  buffer_load_dwordx4 v5, s[12:15], s53 offen offset:1152 lds
  s_mov_b32 s55, 2146435072
  s_mov_b32 s56, 2146435072
  s_mov_b32 s57, 2146435072
  s_xor_b32 s63, s63, s3
  s_mov_b32 s58, 122880
  ds_read_b128 v[16:19], v6 offset:0
  ds_read_b128 v[20:23], v7 offset:0
  ds_read_b128 v[24:27], v6 offset:4096
  ds_read_b128 v[28:31], v7 offset:4096
  s_waitcnt lgkmcnt(3)
pa_loop_14:
  v_mfma_f32_16x16x32_bf16 v[40:43], a[0:3], v[16:19], 0
  ds_read_b128 v[32:35], v6 offset:8192
  v_mfma_f32_16x16x32_bf16 v[48:51], a[4:7], v[16:19], 0
  v_mfma_f32_16x16x32_bf16 v[56:59], a[8:11], v[16:19], 0
  s_waitcnt lgkmcnt(3)
  v_cvt_pk_bf16_f32 v66, v44, v45
  v_mfma_f32_16x16x32_bf16 v[40:43], a[12:15], v[20:23], v[40:43]
  ds_read_b128 v[16:19], v7 offset:8192
  v_cvt_pk_bf16_f32 v67, v46, v47
  v_mfma_f32_16x16x32_bf16 v[48:51], a[16:19], v[20:23], v[48:51]
  v_cvt_pk_bf16_f32 v70, v52, v53
  v_mfma_f32_16x16x32_bf16 v[56:59], a[20:23], v[20:23], v[56:59]
  s_waitcnt lgkmcnt(3)
  v_cvt_pk_bf16_f32 v71, v54, v55
  v_mfma_f32_16x16x32_bf16 v[40:43], a[24:27], v[24:27], v[40:43]
  ds_read_b128 v[20:23], v6 offset:12288
  v_cvt_pk_bf16_f32 v74, v60, v61
  v_mfma_f32_16x16x32_bf16 v[48:51], a[28:31], v[24:27], v[48:51]
  v_cvt_pk_bf16_f32 v75, v62, v63
  v_mfma_f32_16x16x32_bf16 v[56:59], a[32:35], v[24:27], v[56:59]
  s_waitcnt lgkmcnt(3)
  v_mfma_f32_16x16x32_bf16 v[40:43], a[36:39], v[28:31], v[40:43]
  ds_read_b128 v[24:27], v7 offset:12288
  v_permlane16_swap_b32 v64, v66
  v_mfma_f32_16x16x32_bf16 v[48:51], a[40:43], v[28:31], v[48:51]
  v_permlane16_swap_b32 v65, v67
  v_mfma_f32_16x16x32_bf16 v[56:59], a[44:47], v[28:31], v[56:59]
  buffer_store_dwordx4 v[64:67], v8, s[8:11], s55 offen sc1
  s_waitcnt lgkmcnt(3)
  v_mfma_f32_16x16x32_bf16 v[40:43], a[48:51], v[32:35], v[40:43]
  ds_read_b128 v[28:31], v6 offset:16384
  v_permlane16_swap_b32 v68, v70
  v_mfma_f32_16x16x32_bf16 v[48:51], a[52:55], v[32:35], v[48:51]
  v_permlane16_swap_b32 v69, v71
  v_mfma_f32_16x16x32_bf16 v[56:59], a[56:59], v[32:35], v[56:59]
  buffer_store_dwordx4 v[68:71], v8, s[8:11], s56 offen sc1
  s_waitcnt lgkmcnt(3)
  v_mfma_f32_16x16x32_bf16 v[40:43], a[60:63], v[16:19], v[40:43]
  ds_read_b128 v[32:35], v7 offset:16384
  v_permlane16_swap_b32 v72, v74
  v_mfma_f32_16x16x32_bf16 v[48:51], a[64:67], v[16:19], v[48:51]
  v_permlane16_swap_b32 v73, v75
  v_mfma_f32_16x16x32_bf16 v[56:59], a[68:71], v[16:19], v[56:59]
  buffer_store_dwordx4 v[72:75], v8, s[8:11], s57 offen sc1
  s_waitcnt lgkmcnt(3)
  v_mfma_f32_16x16x32_bf16 v[40:43], a[72:75], v[20:23], v[40:43]
  ds_read_b128 v[16:19], v6 offset:20480
  v_mfma_f32_16x16x32_bf16 v[48:51], a[76:79], v[20:23], v[48:51]
  v_mfma_f32_16x16x32_bf16 v[56:59], a[80:83], v[20:23], v[56:59]
  s_waitcnt lgkmcnt(3)
  v_mfma_f32_16x16x32_bf16 v[40:43], a[84:87], v[24:27], v[40:43]
  ds_read_b128 v[20:23], v7 offset:20480
  v_mfma_f32_16x16x32_bf16 v[48:51], a[88:91], v[24:27], v[48:51]
  v_mov_b32 v10, s52
  v_mfma_f32_16x16x32_bf16 v[56:59], a[92:95], v[24:27], v[56:59]
  s_waitcnt lgkmcnt(3)
  v_mfma_f32_16x16x32_bf16 v[40:43], a[96:99], v[28:31], v[40:43]
  ds_read_b128 v[24:27], v6 offset:24576
  v_mfma_f32_16x16x32_bf16 v[48:51], a[100:103], v[28:31], v[48:51]
  s_add_u32 s53, s53, 40960
  s_add_u32 s54, s54, 40960
  v_mfma_f32_16x16x32_bf16 v[56:59], a[104:107], v[28:31], v[56:59]
  s_waitcnt lgkmcnt(3)
  v_mfma_f32_16x16x32_bf16 v[40:43], a[108:111], v[32:35], v[40:43]
  ds_read_b128 v[28:31], v7 offset:24576
  v_mfma_f32_16x16x32_bf16 v[48:51], a[112:115], v[32:35], v[48:51]
  s_cmp_ge_u32 s54, 163840
  s_cselect_b32 s54, s51, s54
  v_mfma_f32_16x16x32_bf16 v[56:59], a[116:119], v[32:35], v[56:59]
  s_waitcnt lgkmcnt(3)
  v_mfma_f32_16x16x32_bf16 v[40:43], a[120:123], v[16:19], v[40:43]
  ds_read_b128 v[32:35], v6 offset:28672
  v_mfma_f32_16x16x32_bf16 v[48:51], a[124:127], v[16:19], v[48:51]
  s_cmp_eq_u32 s58, 122880
  s_cselect_b32 s59, 163840, 0
  v_mfma_f32_16x16x32_bf16 v[56:59], a[128:131], v[16:19], v[56:59]
  s_waitcnt lgkmcnt(3)
  v_mfma_f32_16x16x32_bf16 v[40:43], a[132:135], v[20:23], v[40:43]
  ds_read_b128 v[16:19], v7 offset:28672
  v_mfma_f32_16x16x32_bf16 v[48:51], a[136:139], v[20:23], v[48:51]
  s_sub_u32 s59, 40960, s59
  s_add_u32 s58, s58, s59
  v_mfma_f32_16x16x32_bf16 v[56:59], a[140:143], v[20:23], v[56:59]
  s_waitcnt lgkmcnt(3)
  v_mfma_f32_16x16x32_bf16 v[40:43], a[144:147], v[24:27], v[40:43]
  ds_read_b128 v[20:23], v6 offset:32768
  v_mfma_f32_16x16x32_bf16 v[48:51], a[148:151], v[24:27], v[48:51]
  s_lshr_b32 s55, s67, 1
  v_mfma_f32_16x16x32_bf16 v[56:59], a[152:155], v[24:27], v[56:59]
  s_lshl_b32 s55, s55, 14
  s_waitcnt lgkmcnt(3)
  v_mfma_f32_16x16x32_bf16 v[40:43], a[156:159], v[28:31], v[40:43]
  ds_read_b128 v[24:27], v7 offset:32768
  v_mfma_f32_16x16x32_bf16 v[48:51], a[160:163], v[28:31], v[48:51]
  s_and_b32 s56, s67, 1
  v_mfma_f32_16x16x32_bf16 v[56:59], a[164:167], v[28:31], v[56:59]
  s_lshl_b32 s56, s56, 12
  s_waitcnt lgkmcnt(3)
  v_mfma_f32_16x16x32_bf16 v[40:43], a[168:171], v[32:35], v[40:43]
  ds_read_b128 v[28:31], v6 offset:36864
  v_mfma_f32_16x16x32_bf16 v[48:51], a[172:175], v[32:35], v[48:51]
  s_add_u32 s55, s55, s56
  v_mfma_f32_16x16x32_bf16 v[56:59], a[176:179], v[32:35], v[56:59]
  s_add_u32 s55, s55, s63
  s_waitcnt lgkmcnt(3)
  v_mfma_f32_16x16x32_bf16 v[40:43], a[180:183], v[16:19], v[40:43]
  ds_read_b128 v[32:35], v7 offset:36864
  v_mfma_f32_16x16x32_bf16 v[48:51], a[184:187], v[16:19], v[48:51]
  s_lshr_b32 s56, s55, 8
  v_mfma_f32_16x16x32_bf16 v[56:59], a[188:191], v[16:19], v[56:59]
  s_and_b32 s56, s56, 0x2000
  s_waitcnt lgkmcnt(3)
  v_mfma_f32_16x16x32_bf16 v[40:43], a[192:195], v[20:23], v[40:43]
  ds_read_b128 v[16:19], v6 offset:2048
  v_mfma_f32_16x16x32_bf16 v[48:51], a[196:199], v[20:23], v[48:51]
  s_xor_b32 s55, s55, s56
  v_mfma_f32_16x16x32_bf16 v[56:59], a[200:203], v[20:23], v[56:59]
  s_add_u32 s67, s67, 1
  s_waitcnt lgkmcnt(3)
  v_mfma_f32_16x16x32_bf16 v[40:43], a[204:207], v[24:27], v[40:43]
  ds_read_b128 v[20:23], v7 offset:2048
  v_mfma_f32_16x16x32_bf16 v[48:51], a[208:211], v[24:27], v[48:51]
  s_add_u32 s56, s55, 16777216
  v_mfma_f32_16x16x32_bf16 v[56:59], a[212:215], v[24:27], v[56:59]
  s_add_u32 s57, s55, 33554432
  s_waitcnt lgkmcnt(3)
  v_mfma_f32_16x16x32_bf16 v[40:43], a[216:219], v[28:31], v[40:43]
  ds_read_b128 v[24:27], v6 offset:6144
  v_mfma_f32_16x16x32_bf16 v[48:51], a[220:223], v[28:31], v[48:51]
  v_mfma_f32_16x16x32_bf16 v[56:59], a[224:227], v[28:31], v[56:59]
  s_waitcnt lgkmcnt(3)
  v_mfma_f32_16x16x32_bf16 v[40:43], a[228:231], v[32:35], v[40:43]
  ds_read_b128 v[28:31], v7 offset:6144
  v_mfma_f32_16x16x32_bf16 v[48:51], a[232:235], v[32:35], v[48:51]
  v_mfma_f32_16x16x32_bf16 v[56:59], a[236:239], v[32:35], v[56:59]
  s_waitcnt lgkmcnt(3)
  v_mfma_f32_16x16x32_bf16 v[44:47], a[0:3], v[16:19], 0
  ds_read_b128 v[32:35], v6 offset:10240
  v_mfma_f32_16x16x32_bf16 v[52:55], a[4:7], v[16:19], 0
  v_mfma_f32_16x16x32_bf16 v[60:63], a[8:11], v[16:19], 0
  s_waitcnt lgkmcnt(3)
  v_cvt_pk_bf16_f32 v64, v40, v41
  v_mfma_f32_16x16x32_bf16 v[44:47], a[12:15], v[20:23], v[44:47]
  ds_read_b128 v[16:19], v7 offset:10240
  v_cvt_pk_bf16_f32 v65, v42, v43
  v_mfma_f32_16x16x32_bf16 v[52:55], a[16:19], v[20:23], v[52:55]
  v_cvt_pk_bf16_f32 v68, v48, v49
  v_mfma_f32_16x16x32_bf16 v[60:63], a[20:23], v[20:23], v[60:63]
  s_waitcnt lgkmcnt(3)
  v_cvt_pk_bf16_f32 v69, v50, v51
  v_mfma_f32_16x16x32_bf16 v[44:47], a[24:27], v[24:27], v[44:47]
  ds_read_b128 v[20:23], v6 offset:14336
  v_cvt_pk_bf16_f32 v72, v56, v57
  v_mfma_f32_16x16x32_bf16 v[52:55], a[28:31], v[24:27], v[52:55]
  v_cvt_pk_bf16_f32 v73, v58, v59
  v_mfma_f32_16x16x32_bf16 v[60:63], a[32:35], v[24:27], v[60:63]
  s_waitcnt lgkmcnt(3)
  v_mfma_f32_16x16x32_bf16 v[44:47], a[36:39], v[28:31], v[44:47]
  ds_read_b128 v[24:27], v7 offset:14336
  v_mfma_f32_16x16x32_bf16 v[52:55], a[40:43], v[28:31], v[52:55]
  s_waitcnt vmcnt(0)
  s_barrier
  v_mfma_f32_16x16x32_bf16 v[60:63], a[44:47], v[28:31], v[60:63]
  buffer_store_dword v10, v9, s[8:11], 0 offen sc1
  s_waitcnt lgkmcnt(3)
  v_mfma_f32_16x16x32_bf16 v[44:47], a[48:51], v[32:35], v[44:47]
  ds_read_b128 v[28:31], v6 offset:18432
  s_add_u32 m0, s54, 0
  v_mfma_f32_16x16x32_bf16 v[52:55], a[52:55], v[32:35], v[52:55]
  buffer_load_dwordx4 v5, s[12:15], s53 offen offset:0 lds
  v_mfma_f32_16x16x32_bf16 v[60:63], a[56:59], v[32:35], v[60:63]
  s_waitcnt lgkmcnt(3)
  v_mfma_f32_16x16x32_bf16 v[44:47], a[60:63], v[16:19], v[44:47]
  ds_read_b128 v[32:35], v7 offset:18432
  s_add_u32 m0, s54, 3968
  v_mfma_f32_16x16x32_bf16 v[52:55], a[64:67], v[16:19], v[52:55]
  buffer_load_dwordx4 v5, s[12:15], s53 offen offset:128 lds
  v_mfma_f32_16x16x32_bf16 v[60:63], a[68:71], v[16:19], v[60:63]
  s_waitcnt lgkmcnt(3)
  v_mfma_f32_16x16x32_bf16 v[44:47], a[72:75], v[20:23], v[44:47]
  ds_read_b128 v[16:19], v6 offset:22528
  s_add_u32 m0, s54, 7936
  v_mfma_f32_16x16x32_bf16 v[52:55], a[76:79], v[20:23], v[52:55]
  buffer_load_dwordx4 v5, s[12:15], s53 offen offset:256 lds
  v_mfma_f32_16x16x32_bf16 v[60:63], a[80:83], v[20:23], v[60:63]
  s_waitcnt lgkmcnt(3)
  v_mfma_f32_16x16x32_bf16 v[44:47], a[84:87], v[24:27], v[44:47]
  ds_read_b128 v[20:23], v7 offset:22528
  s_add_u32 m0, s54, 11904
  v_mfma_f32_16x16x32_bf16 v[52:55], a[88:91], v[24:27], v[52:55]
  buffer_load_dwordx4 v5, s[12:15], s53 offen offset:384 lds
  v_mfma_f32_16x16x32_bf16 v[60:63], a[92:95], v[24:27], v[60:63]
  s_waitcnt lgkmcnt(3)
  v_mfma_f32_16x16x32_bf16 v[44:47], a[96:99], v[28:31], v[44:47]
  ds_read_b128 v[24:27], v6 offset:26624
  s_add_u32 m0, s54, 15872
  v_mfma_f32_16x16x32_bf16 v[52:55], a[100:103], v[28:31], v[52:55]
  buffer_load_dwordx4 v5, s[12:15], s53 offen offset:512 lds
  v_mfma_f32_16x16x32_bf16 v[60:63], a[104:107], v[28:31], v[60:63]
  s_waitcnt lgkmcnt(3)
  v_mfma_f32_16x16x32_bf16 v[44:47], a[108:111], v[32:35], v[44:47]
  ds_read_b128 v[28:31], v7 offset:26624
  s_add_u32 m0, s54, 19840
  v_mfma_f32_16x16x32_bf16 v[52:55], a[112:115], v[32:35], v[52:55]
  buffer_load_dwordx4 v5, s[12:15], s53 offen offset:640 lds
  v_mfma_f32_16x16x32_bf16 v[60:63], a[116:119], v[32:35], v[60:63]
  s_waitcnt lgkmcnt(3)
  v_mfma_f32_16x16x32_bf16 v[44:47], a[120:123], v[16:19], v[44:47]
  ds_read_b128 v[32:35], v6 offset:30720
  s_add_u32 m0, s54, 23808
  v_mfma_f32_16x16x32_bf16 v[52:55], a[124:127], v[16:19], v[52:55]
  buffer_load_dwordx4 v5, s[12:15], s53 offen offset:768 lds
  v_mfma_f32_16x16x32_bf16 v[60:63], a[128:131], v[16:19], v[60:63]
  s_waitcnt lgkmcnt(3)
  v_mfma_f32_16x16x32_bf16 v[44:47], a[132:135], v[20:23], v[44:47]
  ds_read_b128 v[16:19], v7 offset:30720
  s_add_u32 m0, s54, 27776
  v_mfma_f32_16x16x32_bf16 v[52:55], a[136:139], v[20:23], v[52:55]
  buffer_load_dwordx4 v5, s[12:15], s53 offen offset:896 lds
  v_mfma_f32_16x16x32_bf16 v[60:63], a[140:143], v[20:23], v[60:63]
  s_waitcnt lgkmcnt(3)
  v_mfma_f32_16x16x32_bf16 v[44:47], a[144:147], v[24:27], v[44:47]
  ds_read_b128 v[20:23], v6 offset:34816
  s_add_u32 m0, s54, 31744
  v_mfma_f32_16x16x32_bf16 v[52:55], a[148:151], v[24:27], v[52:55]
  buffer_load_dwordx4 v5, s[12:15], s53 offen offset:1024 lds
  v_mfma_f32_16x16x32_bf16 v[60:63], a[152:155], v[24:27], v[60:63]
  s_waitcnt lgkmcnt(3)
  v_mfma_f32_16x16x32_bf16 v[44:47], a[156:159], v[28:31], v[44:47]
  ds_read_b128 v[24:27], v7 offset:34816
  s_add_u32 m0, s54, 35712
  v_mfma_f32_16x16x32_bf16 v[52:55], a[160:163], v[28:31], v[52:55]
  buffer_load_dwordx4 v5, s[12:15], s53 offen offset:1152 lds
  v_mfma_f32_16x16x32_bf16 v[60:63], a[164:167], v[28:31], v[60:63]
  s_waitcnt lgkmcnt(3)
  v_mfma_f32_16x16x32_bf16 v[44:47], a[168:171], v[32:35], v[44:47]
  ds_read_b128 v[28:31], v6 offset:38912
  v_mfma_f32_16x16x32_bf16 v[52:55], a[172:175], v[32:35], v[52:55]
  v_mfma_f32_16x16x32_bf16 v[60:63], a[176:179], v[32:35], v[60:63]
  s_waitcnt lgkmcnt(3)
  v_mfma_f32_16x16x32_bf16 v[44:47], a[180:183], v[16:19], v[44:47]
  ds_read_b128 v[32:35], v7 offset:38912
  v_mfma_f32_16x16x32_bf16 v[52:55], a[184:187], v[16:19], v[52:55]
  v_add_u32 v6, s59, v6
  v_add_u32 v7, s59, v7
  v_mfma_f32_16x16x32_bf16 v[60:63], a[188:191], v[16:19], v[60:63]
  s_waitcnt lgkmcnt(3)
  v_mfma_f32_16x16x32_bf16 v[44:47], a[192:195], v[20:23], v[44:47]
  ds_read_b128 v[16:19], v6 offset:0
  v_mfma_f32_16x16x32_bf16 v[52:55], a[196:199], v[20:23], v[52:55]
  v_mfma_f32_16x16x32_bf16 v[60:63], a[200:203], v[20:23], v[60:63]
  s_waitcnt lgkmcnt(3)
  v_mfma_f32_16x16x32_bf16 v[44:47], a[204:207], v[24:27], v[44:47]
  ds_read_b128 v[20:23], v7 offset:0
  v_mfma_f32_16x16x32_bf16 v[52:55], a[208:211], v[24:27], v[52:55]
  s_add_u32 s52, s52, 1
  v_mfma_f32_16x16x32_bf16 v[60:63], a[212:215], v[24:27], v[60:63]
  s_waitcnt lgkmcnt(3)
  v_mfma_f32_16x16x32_bf16 v[44:47], a[216:219], v[28:31], v[44:47]
  ds_read_b128 v[24:27], v6 offset:4096
  v_mfma_f32_16x16x32_bf16 v[52:55], a[220:223], v[28:31], v[52:55]
  v_mfma_f32_16x16x32_bf16 v[60:63], a[224:227], v[28:31], v[60:63]
  s_waitcnt lgkmcnt(3)
  v_mfma_f32_16x16x32_bf16 v[44:47], a[228:231], v[32:35], v[44:47]
  ds_read_b128 v[28:31], v7 offset:4096
  v_mfma_f32_16x16x32_bf16 v[52:55], a[232:235], v[32:35], v[52:55]
  s_cmp_lt_u32 s52, s62
  v_mfma_f32_16x16x32_bf16 v[60:63], a[236:239], v[32:35], v[60:63]
  s_waitcnt lgkmcnt(3)
  s_cbranch_scc1 pa_loop_14
  v_cvt_pk_bf16_f32 v66, v44, v45
  v_cvt_pk_bf16_f32 v67, v46, v47
  s_nop 1
  v_cvt_pk_bf16_f32 v70, v52, v53
  v_cvt_pk_bf16_f32 v71, v54, v55
  v_cvt_pk_bf16_f32 v74, v60, v61
  v_cvt_pk_bf16_f32 v75, v62, v63
  v_permlane16_swap_b32 v64, v66
  v_permlane16_swap_b32 v65, v67
  v_permlane16_swap_b32 v68, v70
  v_permlane16_swap_b32 v69, v71
  v_permlane16_swap_b32 v72, v74
  v_permlane16_swap_b32 v73, v75
  buffer_store_dwordx4 v[64:67], v8, s[8:11], s55 offen sc1
  buffer_store_dwordx4 v[68:71], v8, s[8:11], s56 offen sc1
  buffer_store_dwordx4 v[72:75], v8, s[8:11], s57 offen sc1
  v_mov_b32 v10, s52
  s_waitcnt vmcnt(0) lgkmcnt(0)
  s_barrier
  buffer_store_dword v10, v9, s[8:11], 0 offen sc1
pa_att:
  v_min_u32 v1, 19, v0
  v_cmp_lt_u32 vcc, 9, v1
  s_lshl_b32 s46, s65, 4
  s_max_u32 s47, s46, 14
  s_sub_u32 s47, s47, 14
  s_lshr_b32 s47, s47, 5
  s_lshr_b32 s48, s46, 5
  v_mov_b32 v2, s47
  v_mov_b32 v3, s48
  v_cndmask_b32 v2, v2, v3, vcc
  v_subrev_u32 v3, 10, v1
  v_cndmask_b32 v1, v1, v3, vcc
  v_mul_u32_u24 v3, 171, v2
  v_lshrrev_b32 v3, 10, v3
  v_max_u32 v4, 28, v2
  v_subrev_u32 v4, 28, v4
  v_mul_u32_u24 v4, 171, v4
  v_lshrrev_b32 v4, 9, v4
  v_max_u32 v3, v3, v4
  v_mul_u32_u24 v3, 10, v3
  v_add_u32 v1, v1, v3
  v_lshlrev_b32 v1, 7, v1
  v_add_u32 v1, 1081344, v1
  v_lshrrev_b32 v3, 4, v0
  s_lshl_b32 s47, s42, 2
  v_add_u32 v3, s47, v3
  v_mul_u32_u24 v3, 5, v3
  s_xor_b32 s47, s3, 176168960
  v_add_u32 v8, 0, v3
  v_mul_u32_u24 v4, 171, v8
  v_lshrrev_b32 v4, 12, v4
  v_mul_u32_u24 v5, 3, v4
  v_lshrrev_b32 v6, 3, v8
  v_sub_u32 v5, v6, v5
  v_and_b32 v8, 7, v8
  v_lshl_add_u32 v8, v8, 8, s47
  v_lshl_add_u32 v8, v4, 19, v8
  v_lshl_add_u32 v8, v5, 24, v8
  v_lshrrev_b32 v4, 8, v8
  v_and_b32 v4, 0x2000, v4
  v_xor_b32 v8, v8, v4
  v_add_u32 v9, 1, v3
  v_mul_u32_u24 v4, 171, v9
  v_lshrrev_b32 v4, 12, v4
  v_mul_u32_u24 v5, 3, v4
  v_lshrrev_b32 v6, 3, v9
  v_sub_u32 v5, v6, v5
  v_and_b32 v9, 7, v9
  v_lshl_add_u32 v9, v9, 8, s47
  v_lshl_add_u32 v9, v4, 19, v9
  v_lshl_add_u32 v9, v5, 24, v9
  v_lshrrev_b32 v4, 8, v9
  v_and_b32 v4, 0x2000, v4
  v_xor_b32 v9, v9, v4
  v_add_u32 v10, 2, v3
  v_mul_u32_u24 v4, 171, v10
  v_lshrrev_b32 v4, 12, v4
  v_mul_u32_u24 v5, 3, v4
  v_lshrrev_b32 v6, 3, v10
  v_sub_u32 v5, v6, v5
  v_and_b32 v10, 7, v10
  v_lshl_add_u32 v10, v10, 8, s47
  v_lshl_add_u32 v10, v4, 19, v10
  v_lshl_add_u32 v10, v5, 24, v10
  v_lshrrev_b32 v4, 8, v10
  v_and_b32 v4, 0x2000, v4
  v_xor_b32 v10, v10, v4
  v_add_u32 v11, 3, v3
  v_mul_u32_u24 v4, 171, v11
  v_lshrrev_b32 v4, 12, v4
  v_mul_u32_u24 v5, 3, v4
  v_lshrrev_b32 v6, 3, v11
  v_sub_u32 v5, v6, v5
  v_and_b32 v11, 7, v11
  v_lshl_add_u32 v11, v11, 8, s47
  v_lshl_add_u32 v11, v4, 19, v11
  v_lshl_add_u32 v11, v5, 24, v11
  v_lshrrev_b32 v4, 8, v11
  v_and_b32 v4, 0x2000, v4
  v_xor_b32 v11, v11, v4
  v_add_u32 v12, 4, v3
  v_mul_u32_u24 v4, 171, v12
  v_lshrrev_b32 v4, 12, v4
  v_mul_u32_u24 v5, 3, v4
  v_lshrrev_b32 v6, 3, v12
  v_sub_u32 v5, v6, v5
  v_and_b32 v12, 7, v12
  v_lshl_add_u32 v12, v12, 8, s47
  v_lshl_add_u32 v12, v4, 19, v12
  v_lshl_add_u32 v12, v5, 24, v12
  v_lshrrev_b32 v4, 8, v12
  v_and_b32 v4, 0x2000, v4
  v_xor_b32 v12, v12, v4
  v_add_u32 v13, 80, v3
  v_mul_u32_u24 v4, 171, v13
  v_lshrrev_b32 v4, 12, v4
  v_mul_u32_u24 v5, 3, v4
  v_lshrrev_b32 v6, 3, v13
  v_sub_u32 v5, v6, v5
  v_and_b32 v13, 7, v13
  v_lshl_add_u32 v13, v13, 8, s47
  v_lshl_add_u32 v13, v4, 19, v13
  v_lshl_add_u32 v13, v5, 24, v13
  v_lshrrev_b32 v4, 8, v13
  v_and_b32 v4, 0x2000, v4
  v_xor_b32 v13, v13, v4
  v_add_u32 v14, 81, v3
  v_mul_u32_u24 v4, 171, v14
  v_lshrrev_b32 v4, 12, v4
  v_mul_u32_u24 v5, 3, v4
  v_lshrrev_b32 v6, 3, v14
  v_sub_u32 v5, v6, v5
  v_and_b32 v14, 7, v14
  v_lshl_add_u32 v14, v14, 8, s47
  v_lshl_add_u32 v14, v4, 19, v14
  v_lshl_add_u32 v14, v5, 24, v14
  v_lshrrev_b32 v4, 8, v14
  v_and_b32 v4, 0x2000, v4
  v_xor_b32 v14, v14, v4
  v_add_u32 v15, 82, v3
  v_mul_u32_u24 v4, 171, v15
  v_lshrrev_b32 v4, 12, v4
  v_mul_u32_u24 v5, 3, v4
  v_lshrrev_b32 v6, 3, v15
  v_sub_u32 v5, v6, v5
  v_and_b32 v15, 7, v15
  v_lshl_add_u32 v15, v15, 8, s47
  v_lshl_add_u32 v15, v4, 19, v15
  v_lshl_add_u32 v15, v5, 24, v15
  v_lshrrev_b32 v4, 8, v15
  v_and_b32 v4, 0x2000, v4
  v_xor_b32 v15, v15, v4
  v_add_u32 v16, 83, v3
  v_mul_u32_u24 v4, 171, v16
  v_lshrrev_b32 v4, 12, v4
  v_mul_u32_u24 v5, 3, v4
  v_lshrrev_b32 v6, 3, v16
  v_sub_u32 v5, v6, v5
  v_and_b32 v16, 7, v16
  v_lshl_add_u32 v16, v16, 8, s47
  v_lshl_add_u32 v16, v4, 19, v16
  v_lshl_add_u32 v16, v5, 24, v16
  v_lshrrev_b32 v4, 8, v16
  v_and_b32 v4, 0x2000, v4
  v_xor_b32 v16, v16, v4
  v_add_u32 v17, 84, v3
  v_mul_u32_u24 v4, 171, v17
  v_lshrrev_b32 v4, 12, v4
  v_mul_u32_u24 v5, 3, v4
  v_lshrrev_b32 v6, 3, v17
  v_sub_u32 v5, v6, v5
  v_and_b32 v17, 7, v17
  v_lshl_add_u32 v17, v17, 8, s47
  v_lshl_add_u32 v17, v4, 19, v17
  v_lshl_add_u32 v17, v5, 24, v17
  v_lshrrev_b32 v4, 8, v17
  v_and_b32 v4, 0x2000, v4
  v_xor_b32 v17, v17, v4
  v_add_u32 v18, 160, v3
  v_mul_u32_u24 v4, 171, v18
  v_lshrrev_b32 v4, 12, v4
  v_mul_u32_u24 v5, 3, v4
  v_lshrrev_b32 v6, 3, v18
  v_sub_u32 v5, v6, v5
  v_and_b32 v18, 7, v18
  v_lshl_add_u32 v18, v18, 8, s47
  v_lshl_add_u32 v18, v4, 19, v18
  v_lshl_add_u32 v18, v5, 24, v18
  v_lshrrev_b32 v4, 8, v18
  v_and_b32 v4, 0x2000, v4
  v_xor_b32 v18, v18, v4
  v_add_u32 v19, 161, v3
  v_mul_u32_u24 v4, 171, v19
  v_lshrrev_b32 v4, 12, v4
  v_mul_u32_u24 v5, 3, v4
  v_lshrrev_b32 v6, 3, v19
  v_sub_u32 v5, v6, v5
  v_and_b32 v19, 7, v19
  v_lshl_add_u32 v19, v19, 8, s47
  v_lshl_add_u32 v19, v4, 19, v19
  v_lshl_add_u32 v19, v5, 24, v19
  v_lshrrev_b32 v4, 8, v19
  v_and_b32 v4, 0x2000, v4
  v_xor_b32 v19, v19, v4
  v_add_u32 v20, 162, v3
  v_mul_u32_u24 v4, 171, v20
  v_lshrrev_b32 v4, 12, v4
  v_mul_u32_u24 v5, 3, v4
  v_lshrrev_b32 v6, 3, v20
  v_sub_u32 v5, v6, v5
  v_and_b32 v20, 7, v20
  v_lshl_add_u32 v20, v20, 8, s47
  v_lshl_add_u32 v20, v4, 19, v20
  v_lshl_add_u32 v20, v5, 24, v20
  v_lshrrev_b32 v4, 8, v20
  v_and_b32 v4, 0x2000, v4
  v_xor_b32 v20, v20, v4
  v_add_u32 v21, 163, v3
  v_mul_u32_u24 v4, 171, v21
  v_lshrrev_b32 v4, 12, v4
  v_mul_u32_u24 v5, 3, v4
  v_lshrrev_b32 v6, 3, v21
  v_sub_u32 v5, v6, v5
  v_and_b32 v21, 7, v21
  v_lshl_add_u32 v21, v21, 8, s47
  v_lshl_add_u32 v21, v4, 19, v21
  v_lshl_add_u32 v21, v5, 24, v21
  v_lshrrev_b32 v4, 8, v21
  v_and_b32 v4, 0x2000, v4
  v_xor_b32 v21, v21, v4
  v_add_u32 v22, 164, v3
  v_mul_u32_u24 v4, 171, v22
  v_lshrrev_b32 v4, 12, v4
  v_mul_u32_u24 v5, 3, v4
  v_lshrrev_b32 v6, 3, v22
  v_sub_u32 v5, v6, v5
  v_and_b32 v22, 7, v22
  v_lshl_add_u32 v22, v22, 8, s47
  v_lshl_add_u32 v22, v4, 19, v22
  v_lshl_add_u32 v22, v5, 24, v22
  v_lshrrev_b32 v4, 8, v22
  v_and_b32 v4, 0x2000, v4
  v_xor_b32 v22, v22, v4
  v_and_b32 v5, 15, v0
  v_add_u32 v6, s46, v5
  v_subrev_u32 v4, 0, v6
  v_max_i32 v4, 0, v4
  v_and_b32 v23, 15, v4
  v_lshlrev_b32 v23, 4, v23
  v_bfe_u32 v7, v4, 4, 2
  v_lshl_add_u32 v23, v7, 11, v23
  v_lshrrev_b32 v4, 6, v4
  v_lshl_add_u32 v23, v4, 14, v23
  v_cmp_gt_u32 s[72:73], 0, v6
  v_subrev_u32 v4, 2, v6
  v_max_i32 v4, 0, v4
  v_and_b32 v24, 15, v4
  v_lshlrev_b32 v24, 4, v24
  v_bfe_u32 v7, v4, 4, 2
  v_lshl_add_u32 v24, v7, 11, v24
  v_lshrrev_b32 v4, 6, v4
  v_lshl_add_u32 v24, v4, 14, v24
  v_cmp_gt_u32 s[74:75], 2, v6
  v_subrev_u32 v4, 4, v6
  v_max_i32 v4, 0, v4
  v_and_b32 v25, 15, v4
  v_lshlrev_b32 v25, 4, v25
  v_bfe_u32 v7, v4, 4, 2
  v_lshl_add_u32 v25, v7, 11, v25
  v_lshrrev_b32 v4, 6, v4
  v_lshl_add_u32 v25, v4, 14, v25
  v_cmp_gt_u32 s[76:77], 4, v6
  v_subrev_u32 v4, 6, v6
  v_max_i32 v4, 0, v4
  v_and_b32 v26, 15, v4
  v_lshlrev_b32 v26, 4, v26
  v_bfe_u32 v7, v4, 4, 2
  v_lshl_add_u32 v26, v7, 11, v26
  v_lshrrev_b32 v4, 6, v4
  v_lshl_add_u32 v26, v4, 14, v26
  v_cmp_gt_u32 s[78:79], 6, v6
  v_subrev_u32 v4, 8, v6
  v_max_i32 v4, 0, v4
  v_and_b32 v27, 15, v4
  v_lshlrev_b32 v27, 4, v27
  v_bfe_u32 v7, v4, 4, 2
  v_lshl_add_u32 v27, v7, 11, v27
  v_lshrrev_b32 v4, 6, v4
  v_lshl_add_u32 v27, v4, 14, v27
  v_cmp_gt_u32 s[80:81], 8, v6
  v_subrev_u32 v4, 10, v6
  v_max_i32 v4, 0, v4
  v_and_b32 v28, 15, v4
  v_lshlrev_b32 v28, 4, v28
  v_bfe_u32 v7, v4, 4, 2
  v_lshl_add_u32 v28, v7, 11, v28
  v_lshrrev_b32 v4, 6, v4
  v_lshl_add_u32 v28, v4, 14, v28
  v_cmp_gt_u32 s[82:83], 10, v6
  v_subrev_u32 v4, 12, v6
  v_max_i32 v4, 0, v4
  v_and_b32 v29, 15, v4
  v_lshlrev_b32 v29, 4, v29
  v_bfe_u32 v7, v4, 4, 2
  v_lshl_add_u32 v29, v7, 11, v29
  v_lshrrev_b32 v4, 6, v4
  v_lshl_add_u32 v29, v4, 14, v29
  v_cmp_gt_u32 s[84:85], 12, v6
  v_subrev_u32 v4, 14, v6
  v_max_i32 v4, 0, v4
  v_and_b32 v30, 15, v4
  v_lshlrev_b32 v30, 4, v30
  v_bfe_u32 v7, v4, 4, 2
  v_lshl_add_u32 v30, v7, 11, v30
  v_lshrrev_b32 v4, 6, v4
  v_lshl_add_u32 v30, v4, 14, v30
  v_cmp_gt_u32 s[86:87], 14, v6
  s_mov_b32 s50, 0
  s_mov_b32 s66, 0
pa_wait:
  buffer_load_dword v4, v1, s[8:11], 0 offen sc1
  s_add_u32 s50, s50, 1
  s_cmp_gt_u32 s50, 131072
  s_cbranch_scc1 L_fail
  s_waitcnt vmcnt(0)
  v_cmp_le_u32 vcc, v4, v2
  s_cbranch_vccnz pa_wait
  v_add_u32 v232, v8, v23
  buffer_load_dwordx4 v[32:35], v232, s[8:11], s66 offen sc1
  v_add_u32 v233, v9, v23
  buffer_load_dwordx4 v[36:39], v233, s[8:11], s66 offen sc1
  v_add_u32 v234, v10, v23
  buffer_load_dwordx4 v[40:43], v234, s[8:11], s66 offen sc1
  v_add_u32 v235, v11, v23
  buffer_load_dwordx4 v[44:47], v235, s[8:11], s66 offen sc1
  v_add_u32 v236, v12, v23
  buffer_load_dwordx4 v[48:51], v236, s[8:11], s66 offen sc1
  v_add_u32 v232, v13, v23
  buffer_load_dwordx4 v[72:75], v232, s[8:11], s66 offen sc1
  v_add_u32 v233, v14, v23
  buffer_load_dwordx4 v[76:79], v233, s[8:11], s66 offen sc1
  v_add_u32 v234, v15, v23
  buffer_load_dwordx4 v[80:83], v234, s[8:11], s66 offen sc1
  v_add_u32 v235, v16, v23
  buffer_load_dwordx4 v[84:87], v235, s[8:11], s66 offen sc1
  v_add_u32 v236, v17, v23
  buffer_load_dwordx4 v[88:91], v236, s[8:11], s66 offen sc1
  v_add_u32 v232, v13, v24
  buffer_load_dwordx4 v[92:95], v232, s[8:11], s66 offen sc1
  v_add_u32 v233, v14, v24
  buffer_load_dwordx4 v[96:99], v233, s[8:11], s66 offen sc1
  v_add_u32 v234, v15, v24
  buffer_load_dwordx4 v[100:103], v234, s[8:11], s66 offen sc1
  v_add_u32 v235, v16, v24
  buffer_load_dwordx4 v[104:107], v235, s[8:11], s66 offen sc1
  v_add_u32 v236, v17, v24
  buffer_load_dwordx4 v[108:111], v236, s[8:11], s66 offen sc1
  v_add_u32 v232, v13, v25
  buffer_load_dwordx4 v[112:115], v232, s[8:11], s66 offen sc1
  v_add_u32 v233, v14, v25
  buffer_load_dwordx4 v[116:119], v233, s[8:11], s66 offen sc1
  v_add_u32 v234, v15, v25
  buffer_load_dwordx4 v[120:123], v234, s[8:11], s66 offen sc1
  v_add_u32 v235, v16, v25
  buffer_load_dwordx4 v[124:127], v235, s[8:11], s66 offen sc1
  v_add_u32 v236, v17, v25
  buffer_load_dwordx4 v[128:131], v236, s[8:11], s66 offen sc1
  v_add_u32 v232, v13, v26
  buffer_load_dwordx4 v[132:135], v232, s[8:11], s66 offen sc1
  v_add_u32 v233, v14, v26
  buffer_load_dwordx4 v[136:139], v233, s[8:11], s66 offen sc1
  v_add_u32 v234, v15, v26
  buffer_load_dwordx4 v[140:143], v234, s[8:11], s66 offen sc1
  v_add_u32 v235, v16, v26
  buffer_load_dwordx4 v[144:147], v235, s[8:11], s66 offen sc1
  v_add_u32 v236, v17, v26
  buffer_load_dwordx4 v[148:151], v236, s[8:11], s66 offen sc1
  v_add_u32 v232, v13, v27
  buffer_load_dwordx4 v[152:155], v232, s[8:11], s66 offen sc1
  v_add_u32 v233, v14, v27
  buffer_load_dwordx4 v[156:159], v233, s[8:11], s66 offen sc1
  v_add_u32 v234, v15, v27
  buffer_load_dwordx4 v[160:163], v234, s[8:11], s66 offen sc1
  v_add_u32 v235, v16, v27
  buffer_load_dwordx4 v[164:167], v235, s[8:11], s66 offen sc1
  v_add_u32 v236, v17, v27
  buffer_load_dwordx4 v[168:171], v236, s[8:11], s66 offen sc1
  v_add_u32 v232, v13, v28
  buffer_load_dwordx4 v[172:175], v232, s[8:11], s66 offen sc1
  v_add_u32 v233, v14, v28
  buffer_load_dwordx4 v[176:179], v233, s[8:11], s66 offen sc1
  v_add_u32 v234, v15, v28
  buffer_load_dwordx4 v[180:183], v234, s[8:11], s66 offen sc1
  v_add_u32 v235, v16, v28
  buffer_load_dwordx4 v[184:187], v235, s[8:11], s66 offen sc1
  v_add_u32 v236, v17, v28
  buffer_load_dwordx4 v[188:191], v236, s[8:11], s66 offen sc1
  v_add_u32 v232, v13, v29
  buffer_load_dwordx4 v[192:195], v232, s[8:11], s66 offen sc1
  v_add_u32 v233, v14, v29
  buffer_load_dwordx4 v[196:199], v233, s[8:11], s66 offen sc1
  v_add_u32 v234, v15, v29
  buffer_load_dwordx4 v[200:203], v234, s[8:11], s66 offen sc1
  v_add_u32 v235, v16, v29
  buffer_load_dwordx4 v[204:207], v235, s[8:11], s66 offen sc1
  v_add_u32 v236, v17, v29
  buffer_load_dwordx4 v[208:211], v236, s[8:11], s66 offen sc1
  v_add_u32 v232, v13, v30
  buffer_load_dwordx4 v[212:215], v232, s[8:11], s66 offen sc1
  v_add_u32 v233, v14, v30
  buffer_load_dwordx4 v[216:219], v233, s[8:11], s66 offen sc1
  v_add_u32 v234, v15, v30
  buffer_load_dwordx4 v[220:223], v234, s[8:11], s66 offen sc1
  v_add_u32 v235, v16, v30
  buffer_load_dwordx4 v[224:227], v235, s[8:11], s66 offen sc1
  v_add_u32 v236, v17, v30
  buffer_load_dwordx4 v[228:231], v236, s[8:11], s66 offen sc1
  s_waitcnt vmcnt(35)
  v_dot2_f32_bf16 v52, v32, v72, 0
  v_dot2_f32_bf16 v60, v42, v82, 0
  v_dot2_f32_bf16 v52, v33, v73, v52
  v_dot2_f32_bf16 v60, v43, v83, v60
  v_dot2_f32_bf16 v52, v34, v74, v52
  v_dot2_f32_bf16 v60, v44, v84, v60
  v_dot2_f32_bf16 v52, v35, v75, v52
  v_dot2_f32_bf16 v60, v45, v85, v60
  v_dot2_f32_bf16 v52, v36, v76, v52
  v_dot2_f32_bf16 v60, v46, v86, v60
  v_dot2_f32_bf16 v52, v37, v77, v52
  v_dot2_f32_bf16 v60, v47, v87, v60
  v_dot2_f32_bf16 v52, v38, v78, v52
  v_dot2_f32_bf16 v60, v48, v88, v60
  v_dot2_f32_bf16 v52, v39, v79, v52
  v_dot2_f32_bf16 v60, v49, v89, v60
  v_dot2_f32_bf16 v52, v40, v80, v52
  v_dot2_f32_bf16 v60, v50, v90, v60
  v_dot2_f32_bf16 v52, v41, v81, v52
  v_dot2_f32_bf16 v60, v51, v91, v60
  v_add_u32 v232, v18, v23
  buffer_load_dwordx4 v[72:75], v232, s[8:11], s66 offen sc1
  v_add_u32 v233, v19, v23
  buffer_load_dwordx4 v[76:79], v233, s[8:11], s66 offen sc1
  v_add_u32 v234, v20, v23
  buffer_load_dwordx4 v[80:83], v234, s[8:11], s66 offen sc1
  v_add_u32 v235, v21, v23
  buffer_load_dwordx4 v[84:87], v235, s[8:11], s66 offen sc1
  v_add_u32 v236, v22, v23
  buffer_load_dwordx4 v[88:91], v236, s[8:11], s66 offen sc1
  s_waitcnt vmcnt(35)
  v_dot2_f32_bf16 v53, v32, v92, 0
  v_dot2_f32_bf16 v61, v42, v102, 0
  v_dot2_f32_bf16 v53, v33, v93, v53
  v_dot2_f32_bf16 v61, v43, v103, v61
  v_dot2_f32_bf16 v53, v34, v94, v53
  v_dot2_f32_bf16 v61, v44, v104, v61
  v_dot2_f32_bf16 v53, v35, v95, v53
  v_dot2_f32_bf16 v61, v45, v105, v61
  v_dot2_f32_bf16 v53, v36, v96, v53
  v_dot2_f32_bf16 v61, v46, v106, v61
  v_dot2_f32_bf16 v53, v37, v97, v53
  v_dot2_f32_bf16 v61, v47, v107, v61
  v_dot2_f32_bf16 v53, v38, v98, v53
  v_dot2_f32_bf16 v61, v48, v108, v61
  v_dot2_f32_bf16 v53, v39, v99, v53
  v_dot2_f32_bf16 v61, v49, v109, v61
  v_dot2_f32_bf16 v53, v40, v100, v53
  v_dot2_f32_bf16 v61, v50, v110, v61
  v_dot2_f32_bf16 v53, v41, v101, v53
  v_dot2_f32_bf16 v61, v51, v111, v61
  v_add_u32 v232, v18, v24
  buffer_load_dwordx4 v[92:95], v232, s[8:11], s66 offen sc1
  v_add_u32 v233, v19, v24
  buffer_load_dwordx4 v[96:99], v233, s[8:11], s66 offen sc1
  v_add_u32 v234, v20, v24
  buffer_load_dwordx4 v[100:103], v234, s[8:11], s66 offen sc1
  v_add_u32 v235, v21, v24
  buffer_load_dwordx4 v[104:107], v235, s[8:11], s66 offen sc1
  v_add_u32 v236, v22, v24
  buffer_load_dwordx4 v[108:111], v236, s[8:11], s66 offen sc1
  s_waitcnt vmcnt(35)
  v_dot2_f32_bf16 v54, v32, v112, 0
  v_dot2_f32_bf16 v62, v42, v122, 0
  v_dot2_f32_bf16 v54, v33, v113, v54
  v_dot2_f32_bf16 v62, v43, v123, v62
  v_dot2_f32_bf16 v54, v34, v114, v54
  v_dot2_f32_bf16 v62, v44, v124, v62
  v_dot2_f32_bf16 v54, v35, v115, v54
  v_dot2_f32_bf16 v62, v45, v125, v62
  v_dot2_f32_bf16 v54, v36, v116, v54
  v_dot2_f32_bf16 v62, v46, v126, v62
  v_dot2_f32_bf16 v54, v37, v117, v54
  v_dot2_f32_bf16 v62, v47, v127, v62
  v_dot2_f32_bf16 v54, v38, v118, v54
  v_dot2_f32_bf16 v62, v48, v128, v62
  v_dot2_f32_bf16 v54, v39, v119, v54
  v_dot2_f32_bf16 v62, v49, v129, v62
  v_dot2_f32_bf16 v54, v40, v120, v54
  v_dot2_f32_bf16 v62, v50, v130, v62
  v_dot2_f32_bf16 v54, v41, v121, v54
  v_dot2_f32_bf16 v62, v51, v131, v62
  v_add_u32 v232, v18, v25
  buffer_load_dwordx4 v[112:115], v232, s[8:11], s66 offen sc1
  v_add_u32 v233, v19, v25
  buffer_load_dwordx4 v[116:119], v233, s[8:11], s66 offen sc1
  v_add_u32 v234, v20, v25
  buffer_load_dwordx4 v[120:123], v234, s[8:11], s66 offen sc1
  v_add_u32 v235, v21, v25
  buffer_load_dwordx4 v[124:127], v235, s[8:11], s66 offen sc1
  v_add_u32 v236, v22, v25
  buffer_load_dwordx4 v[128:131], v236, s[8:11], s66 offen sc1
  s_waitcnt vmcnt(35)
  v_dot2_f32_bf16 v55, v32, v132, 0
  v_dot2_f32_bf16 v63, v42, v142, 0
  v_dot2_f32_bf16 v55, v33, v133, v55
  v_dot2_f32_bf16 v63, v43, v143, v63
  v_dot2_f32_bf16 v55, v34, v134, v55
  v_dot2_f32_bf16 v63, v44, v144, v63
  v_dot2_f32_bf16 v55, v35, v135, v55
  v_dot2_f32_bf16 v63, v45, v145, v63
  v_dot2_f32_bf16 v55, v36, v136, v55
  v_dot2_f32_bf16 v63, v46, v146, v63
  v_dot2_f32_bf16 v55, v37, v137, v55
  v_dot2_f32_bf16 v63, v47, v147, v63
  v_dot2_f32_bf16 v55, v38, v138, v55
  v_dot2_f32_bf16 v63, v48, v148, v63
  v_dot2_f32_bf16 v55, v39, v139, v55
  v_dot2_f32_bf16 v63, v49, v149, v63
  v_dot2_f32_bf16 v55, v40, v140, v55
  v_dot2_f32_bf16 v63, v50, v150, v63
  v_dot2_f32_bf16 v55, v41, v141, v55
  v_dot2_f32_bf16 v63, v51, v151, v63
  v_add_u32 v232, v18, v26
  buffer_load_dwordx4 v[132:135], v232, s[8:11], s66 offen sc1
  v_add_u32 v233, v19, v26
  buffer_load_dwordx4 v[136:139], v233, s[8:11], s66 offen sc1
  v_add_u32 v234, v20, v26
  buffer_load_dwordx4 v[140:143], v234, s[8:11], s66 offen sc1
  v_add_u32 v235, v21, v26
  buffer_load_dwordx4 v[144:147], v235, s[8:11], s66 offen sc1
  v_add_u32 v236, v22, v26
  buffer_load_dwordx4 v[148:151], v236, s[8:11], s66 offen sc1
  s_waitcnt vmcnt(35)
  v_dot2_f32_bf16 v56, v32, v152, 0
  v_dot2_f32_bf16 v64, v42, v162, 0
  v_dot2_f32_bf16 v56, v33, v153, v56
  v_dot2_f32_bf16 v64, v43, v163, v64
  v_dot2_f32_bf16 v56, v34, v154, v56
  v_dot2_f32_bf16 v64, v44, v164, v64
  v_dot2_f32_bf16 v56, v35, v155, v56
  v_dot2_f32_bf16 v64, v45, v165, v64
  v_dot2_f32_bf16 v56, v36, v156, v56
  v_dot2_f32_bf16 v64, v46, v166, v64
  v_dot2_f32_bf16 v56, v37, v157, v56
  v_dot2_f32_bf16 v64, v47, v167, v64
  v_dot2_f32_bf16 v56, v38, v158, v56
  v_dot2_f32_bf16 v64, v48, v168, v64
  v_dot2_f32_bf16 v56, v39, v159, v56
  v_dot2_f32_bf16 v64, v49, v169, v64
  v_dot2_f32_bf16 v56, v40, v160, v56
  v_dot2_f32_bf16 v64, v50, v170, v64
  v_dot2_f32_bf16 v56, v41, v161, v56
  v_dot2_f32_bf16 v64, v51, v171, v64
  v_add_u32 v232, v18, v27
  buffer_load_dwordx4 v[152:155], v232, s[8:11], s66 offen sc1
  v_add_u32 v233, v19, v27
  buffer_load_dwordx4 v[156:159], v233, s[8:11], s66 offen sc1
  v_add_u32 v234, v20, v27
  buffer_load_dwordx4 v[160:163], v234, s[8:11], s66 offen sc1
  v_add_u32 v235, v21, v27
  buffer_load_dwordx4 v[164:167], v235, s[8:11], s66 offen sc1
  v_add_u32 v236, v22, v27
  buffer_load_dwordx4 v[168:171], v236, s[8:11], s66 offen sc1
  s_waitcnt vmcnt(35)
  v_dot2_f32_bf16 v57, v32, v172, 0
  v_dot2_f32_bf16 v65, v42, v182, 0
  v_dot2_f32_bf16 v57, v33, v173, v57
  v_dot2_f32_bf16 v65, v43, v183, v65
  v_dot2_f32_bf16 v57, v34, v174, v57
  v_dot2_f32_bf16 v65, v44, v184, v65
  v_dot2_f32_bf16 v57, v35, v175, v57
  v_dot2_f32_bf16 v65, v45, v185, v65
  v_dot2_f32_bf16 v57, v36, v176, v57
  v_dot2_f32_bf16 v65, v46, v186, v65
  v_dot2_f32_bf16 v57, v37, v177, v57
  v_dot2_f32_bf16 v65, v47, v187, v65
  v_dot2_f32_bf16 v57, v38, v178, v57
  v_dot2_f32_bf16 v65, v48, v188, v65
  v_dot2_f32_bf16 v57, v39, v179, v57
  v_dot2_f32_bf16 v65, v49, v189, v65
  v_dot2_f32_bf16 v57, v40, v180, v57
  v_dot2_f32_bf16 v65, v50, v190, v65
  v_dot2_f32_bf16 v57, v41, v181, v57
  v_dot2_f32_bf16 v65, v51, v191, v65
  v_add_u32 v232, v18, v28
  buffer_load_dwordx4 v[172:175], v232, s[8:11], s66 offen sc1
  v_add_u32 v233, v19, v28
  buffer_load_dwordx4 v[176:179], v233, s[8:11], s66 offen sc1
  v_add_u32 v234, v20, v28
  buffer_load_dwordx4 v[180:183], v234, s[8:11], s66 offen sc1
  v_add_u32 v235, v21, v28
  buffer_load_dwordx4 v[184:187], v235, s[8:11], s66 offen sc1
  v_add_u32 v236, v22, v28
  buffer_load_dwordx4 v[188:191], v236, s[8:11], s66 offen sc1
  s_waitcnt vmcnt(35)
  v_dot2_f32_bf16 v58, v32, v192, 0
  v_dot2_f32_bf16 v66, v42, v202, 0
  v_dot2_f32_bf16 v58, v33, v193, v58
  v_dot2_f32_bf16 v66, v43, v203, v66
  v_dot2_f32_bf16 v58, v34, v194, v58
  v_dot2_f32_bf16 v66, v44, v204, v66
  v_dot2_f32_bf16 v58, v35, v195, v58
  v_dot2_f32_bf16 v66, v45, v205, v66
  v_dot2_f32_bf16 v58, v36, v196, v58
  v_dot2_f32_bf16 v66, v46, v206, v66
  v_dot2_f32_bf16 v58, v37, v197, v58
  v_dot2_f32_bf16 v66, v47, v207, v66
  v_dot2_f32_bf16 v58, v38, v198, v58
  v_dot2_f32_bf16 v66, v48, v208, v66
  v_dot2_f32_bf16 v58, v39, v199, v58
  v_dot2_f32_bf16 v66, v49, v209, v66
  v_dot2_f32_bf16 v58, v40, v200, v58
  v_dot2_f32_bf16 v66, v50, v210, v66
  v_dot2_f32_bf16 v58, v41, v201, v58
  v_dot2_f32_bf16 v66, v51, v211, v66
  v_add_u32 v232, v18, v29
  buffer_load_dwordx4 v[192:195], v232, s[8:11], s66 offen sc1
  v_add_u32 v233, v19, v29
  buffer_load_dwordx4 v[196:199], v233, s[8:11], s66 offen sc1
  v_add_u32 v234, v20, v29
  buffer_load_dwordx4 v[200:203], v234, s[8:11], s66 offen sc1
  v_add_u32 v235, v21, v29
  buffer_load_dwordx4 v[204:207], v235, s[8:11], s66 offen sc1
  v_add_u32 v236, v22, v29
  buffer_load_dwordx4 v[208:211], v236, s[8:11], s66 offen sc1
  s_waitcnt vmcnt(35)
  v_dot2_f32_bf16 v59, v32, v212, 0
  v_dot2_f32_bf16 v67, v42, v222, 0
  v_dot2_f32_bf16 v59, v33, v213, v59
  v_dot2_f32_bf16 v67, v43, v223, v67
  v_dot2_f32_bf16 v59, v34, v214, v59
  v_dot2_f32_bf16 v67, v44, v224, v67
  v_dot2_f32_bf16 v59, v35, v215, v59
  v_dot2_f32_bf16 v67, v45, v225, v67
  v_dot2_f32_bf16 v59, v36, v216, v59
  v_dot2_f32_bf16 v67, v46, v226, v67
  v_dot2_f32_bf16 v59, v37, v217, v59
  v_dot2_f32_bf16 v67, v47, v227, v67
  v_dot2_f32_bf16 v59, v38, v218, v59
  v_dot2_f32_bf16 v67, v48, v228, v67
  v_dot2_f32_bf16 v59, v39, v219, v59
  v_dot2_f32_bf16 v67, v49, v229, v67
  v_dot2_f32_bf16 v59, v40, v220, v59
  v_dot2_f32_bf16 v67, v50, v230, v67
  v_dot2_f32_bf16 v59, v41, v221, v59
  v_dot2_f32_bf16 v67, v51, v231, v67
  v_add_u32 v232, v18, v30
  buffer_load_dwordx4 v[212:215], v232, s[8:11], s66 offen sc1
  v_add_u32 v233, v19, v30
  buffer_load_dwordx4 v[216:219], v233, s[8:11], s66 offen sc1
  v_add_u32 v234, v20, v30
  buffer_load_dwordx4 v[220:223], v234, s[8:11], s66 offen sc1
  v_add_u32 v235, v21, v30
  buffer_load_dwordx4 v[224:227], v235, s[8:11], s66 offen sc1
  v_add_u32 v236, v22, v30
  buffer_load_dwordx4 v[228:231], v236, s[8:11], s66 offen sc1
  s_mov_b32 s46, 1051011932
  v_mov_b32 v232, 3481618353
  v_cndmask_b32 v53, v53, v232, s[74:75]
  v_cndmask_b32 v54, v54, v232, s[76:77]
  v_cndmask_b32 v55, v55, v232, s[78:79]
  v_cndmask_b32 v56, v56, v232, s[80:81]
  v_cndmask_b32 v57, v57, v232, s[82:83]
  v_cndmask_b32 v58, v58, v232, s[84:85]
  v_cndmask_b32 v59, v59, v232, s[86:87]
  v_max_f32 v233, v52, v53
  v_max3_f32 v233, v233, v54, v55
  v_max3_f32 v233, v233, v56, v57
  v_max3_f32 v233, v233, v58, v59
  v_mul_f32 v233, s46, v233
  v_fma_f32 v52, v52, s46, -v233
  v_fma_f32 v53, v53, s46, -v233
  v_fma_f32 v54, v54, s46, -v233
  v_fma_f32 v55, v55, s46, -v233
  v_fma_f32 v56, v56, s46, -v233
  v_fma_f32 v57, v57, s46, -v233
  v_fma_f32 v58, v58, s46, -v233
  v_fma_f32 v59, v59, s46, -v233
  v_exp_f32 v52, v52
  v_exp_f32 v53, v53
  v_exp_f32 v54, v54
  v_exp_f32 v55, v55
  v_exp_f32 v56, v56
  v_exp_f32 v57, v57
  v_exp_f32 v58, v58
  v_exp_f32 v59, v59
  v_add_f32 v233, v52, v53
  v_add_f32 v233, v233, v54
  v_add_f32 v233, v233, v55
  v_add_f32 v233, v233, v56
  v_add_f32 v233, v233, v57
  v_add_f32 v233, v233, v58
  v_add_f32 v233, v233, v59
  v_rcp_f32 v233, v233
  s_nop 0
  v_mul_f32 v52, v52, v233
  v_mul_f32 v53, v53, v233
  v_mul_f32 v54, v54, v233
  v_mul_f32 v55, v55, v233
  v_mul_f32 v56, v56, v233
  v_mul_f32 v57, v57, v233
  v_mul_f32 v58, v58, v233
  v_mul_f32 v59, v59, v233
  v_cndmask_b32 v61, v61, v232, s[74:75]
  v_cndmask_b32 v62, v62, v232, s[76:77]
  v_cndmask_b32 v63, v63, v232, s[78:79]
  v_cndmask_b32 v64, v64, v232, s[80:81]
  v_cndmask_b32 v65, v65, v232, s[82:83]
  v_cndmask_b32 v66, v66, v232, s[84:85]
  v_cndmask_b32 v67, v67, v232, s[86:87]
  v_max_f32 v233, v60, v61
  v_max3_f32 v233, v233, v62, v63
  v_max3_f32 v233, v233, v64, v65
  v_max3_f32 v233, v233, v66, v67
  v_mul_f32 v233, s46, v233
  v_fma_f32 v60, v60, s46, -v233
  v_fma_f32 v61, v61, s46, -v233
  v_fma_f32 v62, v62, s46, -v233
  v_fma_f32 v63, v63, s46, -v233
  v_fma_f32 v64, v64, s46, -v233
  v_fma_f32 v65, v65, s46, -v233
  v_fma_f32 v66, v66, s46, -v233
  v_fma_f32 v67, v67, s46, -v233
  v_exp_f32 v60, v60
  v_exp_f32 v61, v61
  v_exp_f32 v62, v62
  v_exp_f32 v63, v63
  v_exp_f32 v64, v64
  v_exp_f32 v65, v65
  v_exp_f32 v66, v66
  v_exp_f32 v67, v67
  v_add_f32 v233, v60, v61
  v_add_f32 v233, v233, v62
  v_add_f32 v233, v233, v63
  v_add_f32 v233, v233, v64
  v_add_f32 v233, v233, v65
  v_add_f32 v233, v233, v66
  v_add_f32 v233, v233, v67
  v_rcp_f32 v233, v233
  s_nop 0
  v_mul_f32 v60, v60, v233
  v_mul_f32 v61, v61, v233
  v_mul_f32 v62, v62, v233
  v_mul_f32 v63, v63, v233
  v_mul_f32 v64, v64, v233
  v_mul_f32 v65, v65, v233
  v_mul_f32 v66, v66, v233
  v_mul_f32 v67, v67, v233
  v_cvt_pk_bf16_f32 v52, v52, 0
  v_lshlrev_b32 v236, 16, v52
  v_cvt_pk_bf16_f32 v53, v53, 0
  v_lshlrev_b32 v237, 16, v53
  v_cvt_pk_bf16_f32 v54, v54, 0
  v_lshlrev_b32 v238, 16, v54
  v_cvt_pk_bf16_f32 v55, v55, 0
  v_lshlrev_b32 v239, 16, v55
  v_cvt_pk_bf16_f32 v56, v56, 0
  v_lshlrev_b32 v240, 16, v56
  v_cvt_pk_bf16_f32 v57, v57, 0
  v_lshlrev_b32 v241, 16, v57
  v_cvt_pk_bf16_f32 v58, v58, 0
  v_lshlrev_b32 v242, 16, v58
  v_cvt_pk_bf16_f32 v59, v59, 0
  v_lshlrev_b32 v243, 16, v59
  v_cvt_pk_bf16_f32 v60, v60, 0
  v_lshlrev_b32 v244, 16, v60
  v_cvt_pk_bf16_f32 v61, v61, 0
  v_lshlrev_b32 v245, 16, v61
  v_cvt_pk_bf16_f32 v62, v62, 0
  v_lshlrev_b32 v246, 16, v62
  v_cvt_pk_bf16_f32 v63, v63, 0
  v_lshlrev_b32 v247, 16, v63
  v_cvt_pk_bf16_f32 v64, v64, 0
  v_lshlrev_b32 v248, 16, v64
  v_cvt_pk_bf16_f32 v65, v65, 0
  v_lshlrev_b32 v249, 16, v65
  v_cvt_pk_bf16_f32 v66, v66, 0
  v_lshlrev_b32 v250, 16, v66
  v_cvt_pk_bf16_f32 v67, v67, 0
  v_lshlrev_b32 v251, 16, v67
  s_waitcnt vmcnt(35)
  v_dot2_f32_bf16 v8, v72, v52, 0
  v_dot2_f32_bf16 v9, v72, v236, 0
  v_dot2_f32_bf16 v10, v73, v52, 0
  v_dot2_f32_bf16 v11, v73, v236, 0
  v_dot2_f32_bf16 v12, v74, v52, 0
  v_dot2_f32_bf16 v13, v74, v236, 0
  v_dot2_f32_bf16 v14, v75, v52, 0
  v_dot2_f32_bf16 v15, v75, v236, 0
  v_dot2_f32_bf16 v16, v76, v52, 0
  v_dot2_f32_bf16 v17, v76, v236, 0
  v_dot2_f32_bf16 v18, v77, v52, 0
  v_dot2_f32_bf16 v19, v77, v236, 0
  v_dot2_f32_bf16 v20, v78, v52, 0
  v_dot2_f32_bf16 v21, v78, v236, 0
  v_dot2_f32_bf16 v22, v79, v52, 0
  v_dot2_f32_bf16 v23, v79, v236, 0
  v_dot2_f32_bf16 v24, v80, v52, 0
  v_dot2_f32_bf16 v25, v80, v236, 0
  v_dot2_f32_bf16 v26, v81, v52, 0
  v_dot2_f32_bf16 v27, v81, v236, 0
  v_dot2_f32_bf16 v28, v82, v60, 0
  v_dot2_f32_bf16 v29, v82, v244, 0
  v_dot2_f32_bf16 v30, v83, v60, 0
  v_dot2_f32_bf16 v31, v83, v244, 0
  v_dot2_f32_bf16 v32, v84, v60, 0
  v_dot2_f32_bf16 v33, v84, v244, 0
  v_dot2_f32_bf16 v34, v85, v60, 0
  v_dot2_f32_bf16 v35, v85, v244, 0
  v_dot2_f32_bf16 v36, v86, v60, 0
  v_dot2_f32_bf16 v37, v86, v244, 0
  v_dot2_f32_bf16 v38, v87, v60, 0
  v_dot2_f32_bf16 v39, v87, v244, 0
  v_dot2_f32_bf16 v40, v88, v60, 0
  v_dot2_f32_bf16 v41, v88, v244, 0
  v_dot2_f32_bf16 v42, v89, v60, 0
  v_dot2_f32_bf16 v43, v89, v244, 0
  v_dot2_f32_bf16 v44, v90, v60, 0
  v_dot2_f32_bf16 v45, v90, v244, 0
  v_dot2_f32_bf16 v46, v91, v60, 0
  v_dot2_f32_bf16 v47, v91, v244, 0
  s_waitcnt vmcnt(30)
  v_dot2_f32_bf16 v8, v92, v53, v8
  v_dot2_f32_bf16 v9, v92, v237, v9
  v_dot2_f32_bf16 v10, v93, v53, v10
  v_dot2_f32_bf16 v11, v93, v237, v11
  v_dot2_f32_bf16 v12, v94, v53, v12
  v_dot2_f32_bf16 v13, v94, v237, v13
  v_dot2_f32_bf16 v14, v95, v53, v14
  v_dot2_f32_bf16 v15, v95, v237, v15
  v_dot2_f32_bf16 v16, v96, v53, v16
  v_dot2_f32_bf16 v17, v96, v237, v17
  v_dot2_f32_bf16 v18, v97, v53, v18
  v_dot2_f32_bf16 v19, v97, v237, v19
  v_dot2_f32_bf16 v20, v98, v53, v20
  v_dot2_f32_bf16 v21, v98, v237, v21
  v_dot2_f32_bf16 v22, v99, v53, v22
  v_dot2_f32_bf16 v23, v99, v237, v23
  v_dot2_f32_bf16 v24, v100, v53, v24
  v_dot2_f32_bf16 v25, v100, v237, v25
  v_dot2_f32_bf16 v26, v101, v53, v26
  v_dot2_f32_bf16 v27, v101, v237, v27
  v_dot2_f32_bf16 v28, v102, v61, v28
  v_dot2_f32_bf16 v29, v102, v245, v29
  v_dot2_f32_bf16 v30, v103, v61, v30
  v_dot2_f32_bf16 v31, v103, v245, v31
  v_dot2_f32_bf16 v32, v104, v61, v32
  v_dot2_f32_bf16 v33, v104, v245, v33
  v_dot2_f32_bf16 v34, v105, v61, v34
  v_dot2_f32_bf16 v35, v105, v245, v35
  v_dot2_f32_bf16 v36, v106, v61, v36
  v_dot2_f32_bf16 v37, v106, v245, v37
  v_dot2_f32_bf16 v38, v107, v61, v38
  v_dot2_f32_bf16 v39, v107, v245, v39
  v_dot2_f32_bf16 v40, v108, v61, v40
  v_dot2_f32_bf16 v41, v108, v245, v41
  v_dot2_f32_bf16 v42, v109, v61, v42
  v_dot2_f32_bf16 v43, v109, v245, v43
  v_dot2_f32_bf16 v44, v110, v61, v44
  v_dot2_f32_bf16 v45, v110, v245, v45
  v_dot2_f32_bf16 v46, v111, v61, v46
  v_dot2_f32_bf16 v47, v111, v245, v47
  s_waitcnt vmcnt(25)
  v_dot2_f32_bf16 v8, v112, v54, v8
  v_dot2_f32_bf16 v9, v112, v238, v9
  v_dot2_f32_bf16 v10, v113, v54, v10
  v_dot2_f32_bf16 v11, v113, v238, v11
  v_dot2_f32_bf16 v12, v114, v54, v12
  v_dot2_f32_bf16 v13, v114, v238, v13
  v_dot2_f32_bf16 v14, v115, v54, v14
  v_dot2_f32_bf16 v15, v115, v238, v15
  v_dot2_f32_bf16 v16, v116, v54, v16
  v_dot2_f32_bf16 v17, v116, v238, v17
  v_dot2_f32_bf16 v18, v117, v54, v18
  v_dot2_f32_bf16 v19, v117, v238, v19
  v_dot2_f32_bf16 v20, v118, v54, v20
  v_dot2_f32_bf16 v21, v118, v238, v21
  v_dot2_f32_bf16 v22, v119, v54, v22
  v_dot2_f32_bf16 v23, v119, v238, v23
  v_dot2_f32_bf16 v24, v120, v54, v24
  v_dot2_f32_bf16 v25, v120, v238, v25
  v_dot2_f32_bf16 v26, v121, v54, v26
  v_dot2_f32_bf16 v27, v121, v238, v27
  v_dot2_f32_bf16 v28, v122, v62, v28
  v_dot2_f32_bf16 v29, v122, v246, v29
  v_dot2_f32_bf16 v30, v123, v62, v30
  v_dot2_f32_bf16 v31, v123, v246, v31
  v_dot2_f32_bf16 v32, v124, v62, v32
  v_dot2_f32_bf16 v33, v124, v246, v33
  v_dot2_f32_bf16 v34, v125, v62, v34
  v_dot2_f32_bf16 v35, v125, v246, v35
  v_dot2_f32_bf16 v36, v126, v62, v36
  v_dot2_f32_bf16 v37, v126, v246, v37
  v_dot2_f32_bf16 v38, v127, v62, v38
  v_dot2_f32_bf16 v39, v127, v246, v39
  v_dot2_f32_bf16 v40, v128, v62, v40
  v_dot2_f32_bf16 v41, v128, v246, v41
  v_dot2_f32_bf16 v42, v129, v62, v42
  v_dot2_f32_bf16 v43, v129, v246, v43
  v_dot2_f32_bf16 v44, v130, v62, v44
  v_dot2_f32_bf16 v45, v130, v246, v45
  v_dot2_f32_bf16 v46, v131, v62, v46
  v_dot2_f32_bf16 v47, v131, v246, v47
  s_waitcnt vmcnt(20)
  v_dot2_f32_bf16 v8, v132, v55, v8
  v_dot2_f32_bf16 v9, v132, v239, v9
  v_dot2_f32_bf16 v10, v133, v55, v10
  v_dot2_f32_bf16 v11, v133, v239, v11
  v_dot2_f32_bf16 v12, v134, v55, v12
  v_dot2_f32_bf16 v13, v134, v239, v13
  v_dot2_f32_bf16 v14, v135, v55, v14
  v_dot2_f32_bf16 v15, v135, v239, v15
  v_dot2_f32_bf16 v16, v136, v55, v16
  v_dot2_f32_bf16 v17, v136, v239, v17
  v_dot2_f32_bf16 v18, v137, v55, v18
  v_dot2_f32_bf16 v19, v137, v239, v19
  v_dot2_f32_bf16 v20, v138, v55, v20
  v_dot2_f32_bf16 v21, v138, v239, v21
  v_dot2_f32_bf16 v22, v139, v55, v22
  v_dot2_f32_bf16 v23, v139, v239, v23
  v_dot2_f32_bf16 v24, v140, v55, v24
  v_dot2_f32_bf16 v25, v140, v239, v25
  v_dot2_f32_bf16 v26, v141, v55, v26
  v_dot2_f32_bf16 v27, v141, v239, v27
  v_dot2_f32_bf16 v28, v142, v63, v28
  v_dot2_f32_bf16 v29, v142, v247, v29
  v_dot2_f32_bf16 v30, v143, v63, v30
  v_dot2_f32_bf16 v31, v143, v247, v31
  v_dot2_f32_bf16 v32, v144, v63, v32
  v_dot2_f32_bf16 v33, v144, v247, v33
  v_dot2_f32_bf16 v34, v145, v63, v34
  v_dot2_f32_bf16 v35, v145, v247, v35
  v_dot2_f32_bf16 v36, v146, v63, v36
  v_dot2_f32_bf16 v37, v146, v247, v37
  v_dot2_f32_bf16 v38, v147, v63, v38
  v_dot2_f32_bf16 v39, v147, v247, v39
  v_dot2_f32_bf16 v40, v148, v63, v40
  v_dot2_f32_bf16 v41, v148, v247, v41
  v_dot2_f32_bf16 v42, v149, v63, v42
  v_dot2_f32_bf16 v43, v149, v247, v43
  v_dot2_f32_bf16 v44, v150, v63, v44
  v_dot2_f32_bf16 v45, v150, v247, v45
  v_dot2_f32_bf16 v46, v151, v63, v46
  v_dot2_f32_bf16 v47, v151, v247, v47
  s_waitcnt vmcnt(15)
  v_dot2_f32_bf16 v8, v152, v56, v8
  v_dot2_f32_bf16 v9, v152, v240, v9
  v_dot2_f32_bf16 v10, v153, v56, v10
  v_dot2_f32_bf16 v11, v153, v240, v11
  v_dot2_f32_bf16 v12, v154, v56, v12
  v_dot2_f32_bf16 v13, v154, v240, v13
  v_dot2_f32_bf16 v14, v155, v56, v14
  v_dot2_f32_bf16 v15, v155, v240, v15
  v_dot2_f32_bf16 v16, v156, v56, v16
  v_dot2_f32_bf16 v17, v156, v240, v17
  v_dot2_f32_bf16 v18, v157, v56, v18
  v_dot2_f32_bf16 v19, v157, v240, v19
  v_dot2_f32_bf16 v20, v158, v56, v20
  v_dot2_f32_bf16 v21, v158, v240, v21
  v_dot2_f32_bf16 v22, v159, v56, v22
  v_dot2_f32_bf16 v23, v159, v240, v23
  v_dot2_f32_bf16 v24, v160, v56, v24
  v_dot2_f32_bf16 v25, v160, v240, v25
  v_dot2_f32_bf16 v26, v161, v56, v26
  v_dot2_f32_bf16 v27, v161, v240, v27
  v_dot2_f32_bf16 v28, v162, v64, v28
  v_dot2_f32_bf16 v29, v162, v248, v29
  v_dot2_f32_bf16 v30, v163, v64, v30
  v_dot2_f32_bf16 v31, v163, v248, v31
  v_dot2_f32_bf16 v32, v164, v64, v32
  v_dot2_f32_bf16 v33, v164, v248, v33
  v_dot2_f32_bf16 v34, v165, v64, v34
  v_dot2_f32_bf16 v35, v165, v248, v35
  v_dot2_f32_bf16 v36, v166, v64, v36
  v_dot2_f32_bf16 v37, v166, v248, v37
  v_dot2_f32_bf16 v38, v167, v64, v38
  v_dot2_f32_bf16 v39, v167, v248, v39
  v_dot2_f32_bf16 v40, v168, v64, v40
  v_dot2_f32_bf16 v41, v168, v248, v41
  v_dot2_f32_bf16 v42, v169, v64, v42
  v_dot2_f32_bf16 v43, v169, v248, v43
  v_dot2_f32_bf16 v44, v170, v64, v44
  v_dot2_f32_bf16 v45, v170, v248, v45
  v_dot2_f32_bf16 v46, v171, v64, v46
  v_dot2_f32_bf16 v47, v171, v248, v47
  s_waitcnt vmcnt(10)
  v_dot2_f32_bf16 v8, v172, v57, v8
  v_dot2_f32_bf16 v9, v172, v241, v9
  v_dot2_f32_bf16 v10, v173, v57, v10
  v_dot2_f32_bf16 v11, v173, v241, v11
  v_dot2_f32_bf16 v12, v174, v57, v12
  v_dot2_f32_bf16 v13, v174, v241, v13
  v_dot2_f32_bf16 v14, v175, v57, v14
  v_dot2_f32_bf16 v15, v175, v241, v15
  v_dot2_f32_bf16 v16, v176, v57, v16
  v_dot2_f32_bf16 v17, v176, v241, v17
  v_dot2_f32_bf16 v18, v177, v57, v18
  v_dot2_f32_bf16 v19, v177, v241, v19
  v_dot2_f32_bf16 v20, v178, v57, v20
  v_dot2_f32_bf16 v21, v178, v241, v21
  v_dot2_f32_bf16 v22, v179, v57, v22
  v_dot2_f32_bf16 v23, v179, v241, v23
  v_dot2_f32_bf16 v24, v180, v57, v24
  v_dot2_f32_bf16 v25, v180, v241, v25
  v_dot2_f32_bf16 v26, v181, v57, v26
  v_dot2_f32_bf16 v27, v181, v241, v27
  v_dot2_f32_bf16 v28, v182, v65, v28
  v_dot2_f32_bf16 v29, v182, v249, v29
  v_dot2_f32_bf16 v30, v183, v65, v30
  v_dot2_f32_bf16 v31, v183, v249, v31
  v_dot2_f32_bf16 v32, v184, v65, v32
  v_dot2_f32_bf16 v33, v184, v249, v33
  v_dot2_f32_bf16 v34, v185, v65, v34
  v_dot2_f32_bf16 v35, v185, v249, v35
  v_dot2_f32_bf16 v36, v186, v65, v36
  v_dot2_f32_bf16 v37, v186, v249, v37
  v_dot2_f32_bf16 v38, v187, v65, v38
  v_dot2_f32_bf16 v39, v187, v249, v39
  v_dot2_f32_bf16 v40, v188, v65, v40
  v_dot2_f32_bf16 v41, v188, v249, v41
  v_dot2_f32_bf16 v42, v189, v65, v42
  v_dot2_f32_bf16 v43, v189, v249, v43
  v_dot2_f32_bf16 v44, v190, v65, v44
  v_dot2_f32_bf16 v45, v190, v249, v45
  v_dot2_f32_bf16 v46, v191, v65, v46
  v_dot2_f32_bf16 v47, v191, v249, v47
  s_waitcnt vmcnt(5)
  v_dot2_f32_bf16 v8, v192, v58, v8
  v_dot2_f32_bf16 v9, v192, v242, v9
  v_dot2_f32_bf16 v10, v193, v58, v10
  v_dot2_f32_bf16 v11, v193, v242, v11
  v_dot2_f32_bf16 v12, v194, v58, v12
  v_dot2_f32_bf16 v13, v194, v242, v13
  v_dot2_f32_bf16 v14, v195, v58, v14
  v_dot2_f32_bf16 v15, v195, v242, v15
  v_dot2_f32_bf16 v16, v196, v58, v16
  v_dot2_f32_bf16 v17, v196, v242, v17
  v_dot2_f32_bf16 v18, v197, v58, v18
  v_dot2_f32_bf16 v19, v197, v242, v19
  v_dot2_f32_bf16 v20, v198, v58, v20
  v_dot2_f32_bf16 v21, v198, v242, v21
  v_dot2_f32_bf16 v22, v199, v58, v22
  v_dot2_f32_bf16 v23, v199, v242, v23
  v_dot2_f32_bf16 v24, v200, v58, v24
  v_dot2_f32_bf16 v25, v200, v242, v25
  v_dot2_f32_bf16 v26, v201, v58, v26
  v_dot2_f32_bf16 v27, v201, v242, v27
  v_dot2_f32_bf16 v28, v202, v66, v28
  v_dot2_f32_bf16 v29, v202, v250, v29
  v_dot2_f32_bf16 v30, v203, v66, v30
  v_dot2_f32_bf16 v31, v203, v250, v31
  v_dot2_f32_bf16 v32, v204, v66, v32
  v_dot2_f32_bf16 v33, v204, v250, v33
  v_dot2_f32_bf16 v34, v205, v66, v34
  v_dot2_f32_bf16 v35, v205, v250, v35
  v_dot2_f32_bf16 v36, v206, v66, v36
  v_dot2_f32_bf16 v37, v206, v250, v37
  v_dot2_f32_bf16 v38, v207, v66, v38
  v_dot2_f32_bf16 v39, v207, v250, v39
  v_dot2_f32_bf16 v40, v208, v66, v40
  v_dot2_f32_bf16 v41, v208, v250, v41
  v_dot2_f32_bf16 v42, v209, v66, v42
  v_dot2_f32_bf16 v43, v209, v250, v43
  v_dot2_f32_bf16 v44, v210, v66, v44
  v_dot2_f32_bf16 v45, v210, v250, v45
  v_dot2_f32_bf16 v46, v211, v66, v46
  v_dot2_f32_bf16 v47, v211, v250, v47
  s_waitcnt vmcnt(0)
  v_dot2_f32_bf16 v8, v212, v59, v8
  v_dot2_f32_bf16 v9, v212, v243, v9
  v_dot2_f32_bf16 v10, v213, v59, v10
  v_dot2_f32_bf16 v11, v213, v243, v11
  v_dot2_f32_bf16 v12, v214, v59, v12
  v_dot2_f32_bf16 v13, v214, v243, v13
  v_dot2_f32_bf16 v14, v215, v59, v14
  v_dot2_f32_bf16 v15, v215, v243, v15
  v_dot2_f32_bf16 v16, v216, v59, v16
  v_dot2_f32_bf16 v17, v216, v243, v17
  v_dot2_f32_bf16 v18, v217, v59, v18
  v_dot2_f32_bf16 v19, v217, v243, v19
  v_dot2_f32_bf16 v20, v218, v59, v20
  v_dot2_f32_bf16 v21, v218, v243, v21
  v_dot2_f32_bf16 v22, v219, v59, v22
  v_dot2_f32_bf16 v23, v219, v243, v23
  v_dot2_f32_bf16 v24, v220, v59, v24
  v_dot2_f32_bf16 v25, v220, v243, v25
  v_dot2_f32_bf16 v26, v221, v59, v26
  v_dot2_f32_bf16 v27, v221, v243, v27
  v_dot2_f32_bf16 v28, v222, v67, v28
  v_dot2_f32_bf16 v29, v222, v251, v29
  v_dot2_f32_bf16 v30, v223, v67, v30
  v_dot2_f32_bf16 v31, v223, v251, v31
  v_dot2_f32_bf16 v32, v224, v67, v32
  v_dot2_f32_bf16 v33, v224, v251, v33
  v_dot2_f32_bf16 v34, v225, v67, v34
  v_dot2_f32_bf16 v35, v225, v251, v35
  v_dot2_f32_bf16 v36, v226, v67, v36
  v_dot2_f32_bf16 v37, v226, v251, v37
  v_dot2_f32_bf16 v38, v227, v67, v38
  v_dot2_f32_bf16 v39, v227, v251, v39
  v_dot2_f32_bf16 v40, v228, v67, v40
  v_dot2_f32_bf16 v41, v228, v251, v41
  v_dot2_f32_bf16 v42, v229, v67, v42
  v_dot2_f32_bf16 v43, v229, v251, v43
  v_dot2_f32_bf16 v44, v230, v67, v44
  v_dot2_f32_bf16 v45, v230, v251, v45
  v_dot2_f32_bf16 v46, v231, v67, v46
  v_dot2_f32_bf16 v47, v231, v251, v47
  v_cvt_pk_bf16_f32 v72, v8, v9
  v_cvt_pk_bf16_f32 v73, v10, v11
  v_cvt_pk_bf16_f32 v74, v12, v13
  v_cvt_pk_bf16_f32 v75, v14, v15
  v_cvt_pk_bf16_f32 v76, v16, v17
  v_cvt_pk_bf16_f32 v77, v18, v19
  v_cvt_pk_bf16_f32 v78, v20, v21
  v_cvt_pk_bf16_f32 v79, v22, v23
  v_cvt_pk_bf16_f32 v80, v24, v25
  v_cvt_pk_bf16_f32 v81, v26, v27
  v_cvt_pk_bf16_f32 v82, v28, v29
  v_cvt_pk_bf16_f32 v83, v30, v31
  v_cvt_pk_bf16_f32 v84, v32, v33
  v_cvt_pk_bf16_f32 v85, v34, v35
  v_cvt_pk_bf16_f32 v86, v36, v37
  v_cvt_pk_bf16_f32 v87, v38, v39
  v_cvt_pk_bf16_f32 v88, v40, v41
  v_cvt_pk_bf16_f32 v89, v42, v43
  v_cvt_pk_bf16_f32 v90, v44, v45
  v_cvt_pk_bf16_f32 v91, v46, v47
  v_lshlrev_b32 v3, 8, v3
  v_lshl_add_u32 v3, v5, 4, v3
  v_add_u32 v3, 122880, v3
  ds_write_b128 v3, v[72:75] offset:0
  ds_write_b128 v3, v[76:79] offset:256
  ds_write_b128 v3, v[80:83] offset:512
  ds_write_b128 v3, v[84:87] offset:768
  ds_write_b128 v3, v[88:91] offset:1024
  s_waitcnt lgkmcnt(0)
  s_barrier
  v_lshlrev_b32 v13, 4, v0
  v_add_u32 v13, 122880, v13
  ds_read_b128 v[20:23], v13 offset:0
  ds_read_b128 v[24:27], v13 offset:1024
  ds_read_b128 v[28:31], v13 offset:2048
  ds_read_b128 v[32:35], v13 offset:3072
  ds_read_b128 v[36:39], v13 offset:4096
  ds_read_b128 v[40:43], v13 offset:5120
  ds_read_b128 v[44:47], v13 offset:6144
  ds_read_b128 v[48:51], v13 offset:7168
  ds_read_b128 v[52:55], v13 offset:8192
  ds_read_b128 v[56:59], v13 offset:9216
  ds_read_b128 v[60:63], v13 offset:10240
  ds_read_b128 v[64:67], v13 offset:11264
  s_waitcnt lgkmcnt(4)
  ds_read_b128 v[68:71], v13 offset:12288
  ds_read_b128 v[72:75], v13 offset:13312
  ds_read_b128 v[76:79], v13 offset:14336
  ds_read_b128 v[80:83], v13 offset:15360
  ds_read_b128 v[84:87], v13 offset:16384
  ds_read_b128 v[88:91], v13 offset:17408
  ds_read_b128 v[92:95], v13 offset:18432
  ds_read_b128 v[96:99], v13 offset:19456
  s_mov_b32 s4, s20
  s_mov_b32 s5, s21
  s_mov_b32 s6, 819200
  s_mov_b32 s7, 0x20000
  s_mov_b32 s12, s36
  s_mov_b32 s13, s37
  s_mov_b32 s14, 5242880
  s_mov_b32 s15, 0x20000
  v_mul_u32_u24 v12, 2560, v6
  v_lshrrev_b32 v14, 4, v0
  v_lshl_add_u32 v12, v14, 3, v12
  s_lshl_b32 s46, s42, 5
  v_add_u32 v12, s46, v12
  s_mov_b32 s66, 0
  s_waitcnt lgkmcnt(0)
  v_lshrrev_b32 v13, 3, v0
  v_lshrrev_b32 v14, 2, v13
  v_lshlrev_b32 v14, 3, v14
  v_and_b32 v8, 3, v13
  v_add_u32 v8, v8, v14
  s_and_b32 s46, s42, 1
  s_lshl_b32 s46, s46, 2
  s_lshr_b32 s47, s42, 1
  s_lshl_b32 s47, s47, 4
  s_add_u32 s46, s46, s47
  v_add_u32 v8, s46, v8
  v_mul_u32_u24 v8, 1280, v8
  v_lshrrev_b32 v13, 1, v13
  v_bfe_u32 v14, v0, 1, 2
  v_xor_b32 v13, v13, v14
  v_lshlrev_b32 v13, 5, v13
  v_and_b32 v14, 1, v0
  v_lshlrev_b32 v14, 4, v14
  v_add3_u32 v8, v8, v13, v14
  v_lshrrev_b32 v13, 5, v0
  v_lshlrev_b32 v9, 11, v13
  v_bfe_u32 v13, v0, 2, 3
  v_lshl_add_u32 v9, v13, 7, v9
  v_lshrrev_b32 v13, 1, v13
  v_xor_b32 v13, s42, v13
  v_lshl_add_u32 v9, v13, 5, v9
  v_and_b32 v13, 3, v0
  v_lshl_add_u32 v9, v13, 3, v9
  v_add_u32 v10, 0x10000, v9
  v_add_u32 v11, 0x20000, v9
  s_add_u32 m0, s51, 0
  s_add_u32 s46, s66, 0
  buffer_load_dwordx4 v8, s[4:7], s46 offen  lds
  s_add_u32 m0, s51, 4096
  s_add_u32 s46, s66, 128
  buffer_load_dwordx4 v8, s[4:7], s46 offen  lds
  s_add_u32 m0, s51, 8192
  s_add_u32 s46, s66, 256
  buffer_load_dwordx4 v8, s[4:7], s46 offen  lds
  s_add_u32 m0, s51, 12288
  s_add_u32 s46, s66, 384
  buffer_load_dwordx4 v8, s[4:7], s46 offen  lds
  s_add_u32 m0, s51, 16384
  s_add_u32 s46, s66, 512
  buffer_load_dwordx4 v8, s[4:7], s46 offen  lds
  s_add_u32 m0, s51, 20480
  s_add_u32 s46, s66, 640
  buffer_load_dwordx4 v8, s[4:7], s46 offen  lds
  s_add_u32 m0, s51, 24576
  s_add_u32 s46, s66, 768
  buffer_load_dwordx4 v8, s[4:7], s46 offen  lds
  s_add_u32 m0, s51, 28672
  s_add_u32 s46, s66, 896
  buffer_load_dwordx4 v8, s[4:7], s46 offen  lds
  s_add_u32 m0, s51, 32768
  s_add_u32 s46, s66, 1024
  buffer_load_dwordx4 v8, s[4:7], s46 offen  lds
  s_add_u32 m0, s51, 36864
  s_add_u32 s46, s66, 1152
  buffer_load_dwordx4 v8, s[4:7], s46 offen  lds
  s_add_u32 m0, s51, 40960
  s_add_u32 s46, s66, 40960
  buffer_load_dwordx4 v8, s[4:7], s46 offen  lds
  s_add_u32 m0, s51, 45056
  s_add_u32 s46, s66, 41088
  buffer_load_dwordx4 v8, s[4:7], s46 offen  lds
  s_add_u32 m0, s51, 49152
  s_add_u32 s46, s66, 41216
  buffer_load_dwordx4 v8, s[4:7], s46 offen  lds
  s_add_u32 m0, s51, 53248
  s_add_u32 s46, s66, 41344
  buffer_load_dwordx4 v8, s[4:7], s46 offen  lds
  s_add_u32 m0, s51, 57344
  s_add_u32 s46, s66, 41472
  buffer_load_dwordx4 v8, s[4:7], s46 offen  lds
  s_add_u32 m0, s51, 61440
  s_add_u32 s46, s66, 41600
  buffer_load_dwordx4 v8, s[4:7], s46 offen  lds
  s_add_u32 m0, s51, 65536
  s_add_u32 s46, s66, 41728
  buffer_load_dwordx4 v8, s[4:7], s46 offen  lds
  s_add_u32 m0, s51, 69632
  s_add_u32 s46, s66, 41856
  buffer_load_dwordx4 v8, s[4:7], s46 offen  lds
  s_add_u32 m0, s51, 73728
  s_add_u32 s46, s66, 41984
  buffer_load_dwordx4 v8, s[4:7], s46 offen  lds
  s_add_u32 m0, s51, 77824
  s_add_u32 s46, s66, 42112
  buffer_load_dwordx4 v8, s[4:7], s46 offen  lds
  s_add_u32 m0, s51, 81920
  s_add_u32 s46, s66, 81920
  buffer_load_dwordx4 v8, s[4:7], s46 offen  lds
  s_add_u32 m0, s51, 86016
  s_add_u32 s46, s66, 82048
  buffer_load_dwordx4 v8, s[4:7], s46 offen  lds
  s_add_u32 m0, s51, 90112
  s_add_u32 s46, s66, 82176
  buffer_load_dwordx4 v8, s[4:7], s46 offen  lds
  s_add_u32 m0, s51, 94208
  s_add_u32 s46, s66, 82304
  buffer_load_dwordx4 v8, s[4:7], s46 offen  lds
  s_add_u32 m0, s51, 98304
  s_add_u32 s46, s66, 82432
  buffer_load_dwordx4 v8, s[4:7], s46 offen  lds
  s_waitcnt vmcnt(20)
  s_barrier
  s_add_u32 m0, s51, 102400
  s_add_u32 s46, s66, 82560
  buffer_load_dwordx4 v8, s[4:7], s46 offen  lds
  s_add_u32 m0, s51, 106496
  s_add_u32 s46, s66, 82688
  buffer_load_dwordx4 v8, s[4:7], s46 offen  lds
  s_add_u32 m0, s51, 110592
  s_add_u32 s46, s66, 82816
  buffer_load_dwordx4 v8, s[4:7], s46 offen  lds
  s_add_u32 m0, s51, 114688
  s_add_u32 s46, s66, 82944
  buffer_load_dwordx4 v8, s[4:7], s46 offen  lds
  s_add_u32 m0, s51, 118784
  s_add_u32 s46, s66, 83072
  buffer_load_dwordx4 v8, s[4:7], s46 offen  lds
  ds_read_b64_tr_b16 v[100:101], v9 offset:0
  ds_read_b64_tr_b16 v[102:103], v9 offset:1024
  ds_read_b64_tr_b16 v[104:105], v9 offset:4096
  ds_read_b64_tr_b16 v[106:107], v9 offset:5120
  ds_read_b64_tr_b16 v[108:109], v9 offset:8192
  ds_read_b64_tr_b16 v[110:111], v9 offset:9216
  ds_read_b64_tr_b16 v[112:113], v9 offset:12288
  ds_read_b64_tr_b16 v[114:115], v9 offset:13312
  ds_read_b64_tr_b16 v[116:117], v9 offset:16384
  ds_read_b64_tr_b16 v[118:119], v9 offset:17408
  s_waitcnt lgkmcnt(0)
  v_mfma_f32_16x16x32_bf16 v[140:143], v[100:103], v[20:23], 0
  v_mfma_f32_16x16x32_bf16 v[144:147], v[104:107], v[20:23], 0
  v_mfma_f32_16x16x32_bf16 v[148:151], v[108:111], v[20:23], 0
  v_mfma_f32_16x16x32_bf16 v[152:155], v[112:115], v[20:23], 0
  v_mfma_f32_16x16x32_bf16 v[156:159], v[116:119], v[20:23], 0
  s_waitcnt vmcnt(20)
  s_barrier
  s_add_u32 m0, s51, 0
  s_add_u32 s46, s66, 122880
  buffer_load_dwordx4 v8, s[4:7], s46 offen  lds
  s_add_u32 m0, s51, 4096
  s_add_u32 s46, s66, 123008
  buffer_load_dwordx4 v8, s[4:7], s46 offen  lds
  s_add_u32 m0, s51, 8192
  s_add_u32 s46, s66, 123136
  buffer_load_dwordx4 v8, s[4:7], s46 offen  lds
  s_add_u32 m0, s51, 12288
  s_add_u32 s46, s66, 123264
  buffer_load_dwordx4 v8, s[4:7], s46 offen  lds
  s_add_u32 m0, s51, 16384
  s_add_u32 s46, s66, 123392
  buffer_load_dwordx4 v8, s[4:7], s46 offen  lds
  ds_read_b64_tr_b16 v[120:121], v9 offset:20480
  ds_read_b64_tr_b16 v[122:123], v9 offset:21504
  ds_read_b64_tr_b16 v[124:125], v9 offset:24576
  ds_read_b64_tr_b16 v[126:127], v9 offset:25600
  ds_read_b64_tr_b16 v[128:129], v9 offset:28672
  ds_read_b64_tr_b16 v[130:131], v9 offset:29696
  ds_read_b64_tr_b16 v[132:133], v9 offset:32768
  ds_read_b64_tr_b16 v[134:135], v9 offset:33792
  ds_read_b64_tr_b16 v[136:137], v9 offset:36864
  ds_read_b64_tr_b16 v[138:139], v9 offset:37888
  s_waitcnt lgkmcnt(0)
  v_mfma_f32_16x16x32_bf16 v[160:163], v[120:123], v[20:23], 0
  v_mfma_f32_16x16x32_bf16 v[164:167], v[124:127], v[20:23], 0
  v_mfma_f32_16x16x32_bf16 v[168:171], v[128:131], v[20:23], 0
  v_mfma_f32_16x16x32_bf16 v[172:175], v[132:135], v[20:23], 0
  v_mfma_f32_16x16x32_bf16 v[176:179], v[136:139], v[20:23], 0
  s_waitcnt vmcnt(20)
  s_barrier
  s_add_u32 m0, s51, 20480
  s_add_u32 s46, s66, 123520
  buffer_load_dwordx4 v8, s[4:7], s46 offen  lds
  s_add_u32 m0, s51, 24576
  s_add_u32 s46, s66, 123648
  buffer_load_dwordx4 v8, s[4:7], s46 offen  lds
  s_add_u32 m0, s51, 28672
  s_add_u32 s46, s66, 123776
  buffer_load_dwordx4 v8, s[4:7], s46 offen  lds
  s_add_u32 m0, s51, 32768
  s_add_u32 s46, s66, 123904
  buffer_load_dwordx4 v8, s[4:7], s46 offen  lds
  s_add_u32 m0, s51, 36864
  s_add_u32 s46, s66, 124032
  buffer_load_dwordx4 v8, s[4:7], s46 offen  lds
  ds_read_b64_tr_b16 v[100:101], v9 offset:40960
  ds_read_b64_tr_b16 v[102:103], v9 offset:41984
  ds_read_b64_tr_b16 v[104:105], v9 offset:45056
  ds_read_b64_tr_b16 v[106:107], v9 offset:46080
  ds_read_b64_tr_b16 v[108:109], v9 offset:49152
  ds_read_b64_tr_b16 v[110:111], v9 offset:50176
  ds_read_b64_tr_b16 v[112:113], v9 offset:53248
  ds_read_b64_tr_b16 v[114:115], v9 offset:54272
  ds_read_b64_tr_b16 v[116:117], v9 offset:57344
  ds_read_b64_tr_b16 v[118:119], v9 offset:58368
  s_waitcnt lgkmcnt(0)
  v_mfma_f32_16x16x32_bf16 v[140:143], v[100:103], v[24:27], v[140:143]
  v_mfma_f32_16x16x32_bf16 v[144:147], v[104:107], v[24:27], v[144:147]
  v_mfma_f32_16x16x32_bf16 v[148:151], v[108:111], v[24:27], v[148:151]
  v_mfma_f32_16x16x32_bf16 v[152:155], v[112:115], v[24:27], v[152:155]
  v_mfma_f32_16x16x32_bf16 v[156:159], v[116:119], v[24:27], v[156:159]
  s_waitcnt vmcnt(20)
  s_barrier
  s_add_u32 m0, s51, 40960
  s_add_u32 s46, s66, 163840
  buffer_load_dwordx4 v8, s[4:7], s46 offen  lds
  s_add_u32 m0, s51, 45056
  s_add_u32 s46, s66, 163968
  buffer_load_dwordx4 v8, s[4:7], s46 offen  lds
  s_add_u32 m0, s51, 49152
  s_add_u32 s46, s66, 164096
  buffer_load_dwordx4 v8, s[4:7], s46 offen  lds
  s_add_u32 m0, s51, 53248
  s_add_u32 s46, s66, 164224
  buffer_load_dwordx4 v8, s[4:7], s46 offen  lds
  s_add_u32 m0, s51, 57344
  s_add_u32 s46, s66, 164352
  buffer_load_dwordx4 v8, s[4:7], s46 offen  lds
  ds_read_b64_tr_b16 v[120:121], v9 offset:61440
  ds_read_b64_tr_b16 v[122:123], v9 offset:62464
  ds_read_b64_tr_b16 v[124:125], v10 offset:0
  ds_read_b64_tr_b16 v[126:127], v10 offset:1024
  ds_read_b64_tr_b16 v[128:129], v10 offset:4096
  ds_read_b64_tr_b16 v[130:131], v10 offset:5120
  ds_read_b64_tr_b16 v[132:133], v10 offset:8192
  ds_read_b64_tr_b16 v[134:135], v10 offset:9216
  ds_read_b64_tr_b16 v[136:137], v10 offset:12288
  ds_read_b64_tr_b16 v[138:139], v10 offset:13312
  s_waitcnt lgkmcnt(0)
  v_mfma_f32_16x16x32_bf16 v[160:163], v[120:123], v[24:27], v[160:163]
  v_mfma_f32_16x16x32_bf16 v[164:167], v[124:127], v[24:27], v[164:167]
  v_mfma_f32_16x16x32_bf16 v[168:171], v[128:131], v[24:27], v[168:171]
  v_mfma_f32_16x16x32_bf16 v[172:175], v[132:135], v[24:27], v[172:175]
  v_mfma_f32_16x16x32_bf16 v[176:179], v[136:139], v[24:27], v[176:179]
  s_waitcnt vmcnt(20)
  s_barrier
  s_add_u32 m0, s51, 61440
  s_add_u32 s46, s66, 164480
  buffer_load_dwordx4 v8, s[4:7], s46 offen  lds
  s_add_u32 m0, s51, 65536
  s_add_u32 s46, s66, 164608
  buffer_load_dwordx4 v8, s[4:7], s46 offen  lds
  s_add_u32 m0, s51, 69632
  s_add_u32 s46, s66, 164736
  buffer_load_dwordx4 v8, s[4:7], s46 offen  lds
  s_add_u32 m0, s51, 73728
  s_add_u32 s46, s66, 164864
  buffer_load_dwordx4 v8, s[4:7], s46 offen  lds
  s_add_u32 m0, s51, 77824
  s_add_u32 s46, s66, 164992
  buffer_load_dwordx4 v8, s[4:7], s46 offen  lds
  ds_read_b64_tr_b16 v[100:101], v10 offset:16384
  ds_read_b64_tr_b16 v[102:103], v10 offset:17408
  ds_read_b64_tr_b16 v[104:105], v10 offset:20480
  ds_read_b64_tr_b16 v[106:107], v10 offset:21504
  ds_read_b64_tr_b16 v[108:109], v10 offset:24576
  ds_read_b64_tr_b16 v[110:111], v10 offset:25600
  ds_read_b64_tr_b16 v[112:113], v10 offset:28672
  ds_read_b64_tr_b16 v[114:115], v10 offset:29696
  ds_read_b64_tr_b16 v[116:117], v10 offset:32768
  ds_read_b64_tr_b16 v[118:119], v10 offset:33792
  s_waitcnt lgkmcnt(0)
  v_mfma_f32_16x16x32_bf16 v[140:143], v[100:103], v[28:31], v[140:143]
  v_mfma_f32_16x16x32_bf16 v[144:147], v[104:107], v[28:31], v[144:147]
  v_mfma_f32_16x16x32_bf16 v[148:151], v[108:111], v[28:31], v[148:151]
  v_mfma_f32_16x16x32_bf16 v[152:155], v[112:115], v[28:31], v[152:155]
  v_mfma_f32_16x16x32_bf16 v[156:159], v[116:119], v[28:31], v[156:159]
  s_waitcnt vmcnt(20)
  s_barrier
  s_add_u32 m0, s51, 81920
  s_add_u32 s46, s66, 204800
  buffer_load_dwordx4 v8, s[4:7], s46 offen  lds
  s_add_u32 m0, s51, 86016
  s_add_u32 s46, s66, 204928
  buffer_load_dwordx4 v8, s[4:7], s46 offen  lds
  s_add_u32 m0, s51, 90112
  s_add_u32 s46, s66, 205056
  buffer_load_dwordx4 v8, s[4:7], s46 offen  lds
  s_add_u32 m0, s51, 94208
  s_add_u32 s46, s66, 205184
  buffer_load_dwordx4 v8, s[4:7], s46 offen  lds
  s_add_u32 m0, s51, 98304
  s_add_u32 s46, s66, 205312
  buffer_load_dwordx4 v8, s[4:7], s46 offen  lds
  ds_read_b64_tr_b16 v[120:121], v10 offset:36864
  ds_read_b64_tr_b16 v[122:123], v10 offset:37888
  ds_read_b64_tr_b16 v[124:125], v10 offset:40960
  ds_read_b64_tr_b16 v[126:127], v10 offset:41984
  ds_read_b64_tr_b16 v[128:129], v10 offset:45056
  ds_read_b64_tr_b16 v[130:131], v10 offset:46080
  ds_read_b64_tr_b16 v[132:133], v10 offset:49152
  ds_read_b64_tr_b16 v[134:135], v10 offset:50176
  ds_read_b64_tr_b16 v[136:137], v10 offset:53248
  ds_read_b64_tr_b16 v[138:139], v10 offset:54272
  s_waitcnt lgkmcnt(0)
  v_mfma_f32_16x16x32_bf16 v[160:163], v[120:123], v[28:31], v[160:163]
  v_mfma_f32_16x16x32_bf16 v[164:167], v[124:127], v[28:31], v[164:167]
  v_mfma_f32_16x16x32_bf16 v[168:171], v[128:131], v[28:31], v[168:171]
  v_mfma_f32_16x16x32_bf16 v[172:175], v[132:135], v[28:31], v[172:175]
  v_mfma_f32_16x16x32_bf16 v[176:179], v[136:139], v[28:31], v[176:179]
  s_waitcnt vmcnt(20)
  s_barrier
  s_add_u32 m0, s51, 102400
  s_add_u32 s46, s66, 205440
  buffer_load_dwordx4 v8, s[4:7], s46 offen  lds
  s_add_u32 m0, s51, 106496
  s_add_u32 s46, s66, 205568
  buffer_load_dwordx4 v8, s[4:7], s46 offen  lds
  s_add_u32 m0, s51, 110592
  s_add_u32 s46, s66, 205696
  buffer_load_dwordx4 v8, s[4:7], s46 offen  lds
  s_add_u32 m0, s51, 114688
  s_add_u32 s46, s66, 205824
  buffer_load_dwordx4 v8, s[4:7], s46 offen  lds
  s_add_u32 m0, s51, 118784
  s_add_u32 s46, s66, 205952
  buffer_load_dwordx4 v8, s[4:7], s46 offen  lds
  ds_read_b64_tr_b16 v[100:101], v9 offset:0
  ds_read_b64_tr_b16 v[102:103], v9 offset:1024
  ds_read_b64_tr_b16 v[104:105], v9 offset:4096
  ds_read_b64_tr_b16 v[106:107], v9 offset:5120
  ds_read_b64_tr_b16 v[108:109], v9 offset:8192
  ds_read_b64_tr_b16 v[110:111], v9 offset:9216
  ds_read_b64_tr_b16 v[112:113], v9 offset:12288
  ds_read_b64_tr_b16 v[114:115], v9 offset:13312
  ds_read_b64_tr_b16 v[116:117], v9 offset:16384
  ds_read_b64_tr_b16 v[118:119], v9 offset:17408
  s_waitcnt lgkmcnt(0)
  v_mfma_f32_16x16x32_bf16 v[140:143], v[100:103], v[32:35], v[140:143]
  v_mfma_f32_16x16x32_bf16 v[144:147], v[104:107], v[32:35], v[144:147]
  v_mfma_f32_16x16x32_bf16 v[148:151], v[108:111], v[32:35], v[148:151]
  v_mfma_f32_16x16x32_bf16 v[152:155], v[112:115], v[32:35], v[152:155]
  v_mfma_f32_16x16x32_bf16 v[156:159], v[116:119], v[32:35], v[156:159]
  s_waitcnt vmcnt(20)
  s_barrier
  s_add_u32 m0, s51, 0
  s_add_u32 s46, s66, 245760
  buffer_load_dwordx4 v8, s[4:7], s46 offen  lds
  s_add_u32 m0, s51, 4096
  s_add_u32 s46, s66, 245888
  buffer_load_dwordx4 v8, s[4:7], s46 offen  lds
  s_add_u32 m0, s51, 8192
  s_add_u32 s46, s66, 246016
  buffer_load_dwordx4 v8, s[4:7], s46 offen  lds
  s_add_u32 m0, s51, 12288
  s_add_u32 s46, s66, 246144
  buffer_load_dwordx4 v8, s[4:7], s46 offen  lds
  s_add_u32 m0, s51, 16384
  s_add_u32 s46, s66, 246272
  buffer_load_dwordx4 v8, s[4:7], s46 offen  lds
  ds_read_b64_tr_b16 v[120:121], v9 offset:20480
  ds_read_b64_tr_b16 v[122:123], v9 offset:21504
  ds_read_b64_tr_b16 v[124:125], v9 offset:24576
  ds_read_b64_tr_b16 v[126:127], v9 offset:25600
  ds_read_b64_tr_b16 v[128:129], v9 offset:28672
  ds_read_b64_tr_b16 v[130:131], v9 offset:29696
  ds_read_b64_tr_b16 v[132:133], v9 offset:32768
  ds_read_b64_tr_b16 v[134:135], v9 offset:33792
  ds_read_b64_tr_b16 v[136:137], v9 offset:36864
  ds_read_b64_tr_b16 v[138:139], v9 offset:37888
  s_waitcnt lgkmcnt(0)
  v_mfma_f32_16x16x32_bf16 v[160:163], v[120:123], v[32:35], v[160:163]
  v_mfma_f32_16x16x32_bf16 v[164:167], v[124:127], v[32:35], v[164:167]
  v_mfma_f32_16x16x32_bf16 v[168:171], v[128:131], v[32:35], v[168:171]
  v_mfma_f32_16x16x32_bf16 v[172:175], v[132:135], v[32:35], v[172:175]
  v_mfma_f32_16x16x32_bf16 v[176:179], v[136:139], v[32:35], v[176:179]
  s_waitcnt vmcnt(20)
  s_barrier
  s_add_u32 m0, s51, 20480
  s_add_u32 s46, s66, 246400
  buffer_load_dwordx4 v8, s[4:7], s46 offen  lds
  s_add_u32 m0, s51, 24576
  s_add_u32 s46, s66, 246528
  buffer_load_dwordx4 v8, s[4:7], s46 offen  lds
  s_add_u32 m0, s51, 28672
  s_add_u32 s46, s66, 246656
  buffer_load_dwordx4 v8, s[4:7], s46 offen  lds
  s_add_u32 m0, s51, 32768
  s_add_u32 s46, s66, 246784
  buffer_load_dwordx4 v8, s[4:7], s46 offen  lds
  s_add_u32 m0, s51, 36864
  s_add_u32 s46, s66, 246912
  buffer_load_dwordx4 v8, s[4:7], s46 offen  lds
  ds_read_b64_tr_b16 v[100:101], v9 offset:40960
  ds_read_b64_tr_b16 v[102:103], v9 offset:41984
  ds_read_b64_tr_b16 v[104:105], v9 offset:45056
  ds_read_b64_tr_b16 v[106:107], v9 offset:46080
  ds_read_b64_tr_b16 v[108:109], v9 offset:49152
  ds_read_b64_tr_b16 v[110:111], v9 offset:50176
  ds_read_b64_tr_b16 v[112:113], v9 offset:53248
  ds_read_b64_tr_b16 v[114:115], v9 offset:54272
  ds_read_b64_tr_b16 v[116:117], v9 offset:57344
  ds_read_b64_tr_b16 v[118:119], v9 offset:58368
  s_waitcnt lgkmcnt(0)
  v_mfma_f32_16x16x32_bf16 v[140:143], v[100:103], v[36:39], v[140:143]
  v_mfma_f32_16x16x32_bf16 v[144:147], v[104:107], v[36:39], v[144:147]
  v_mfma_f32_16x16x32_bf16 v[148:151], v[108:111], v[36:39], v[148:151]
  v_mfma_f32_16x16x32_bf16 v[152:155], v[112:115], v[36:39], v[152:155]
  v_mfma_f32_16x16x32_bf16 v[156:159], v[116:119], v[36:39], v[156:159]
  s_waitcnt vmcnt(20)
  s_barrier
  s_add_u32 m0, s51, 40960
  s_add_u32 s46, s66, 286720
  buffer_load_dwordx4 v8, s[4:7], s46 offen  lds
  s_add_u32 m0, s51, 45056
  s_add_u32 s46, s66, 286848
  buffer_load_dwordx4 v8, s[4:7], s46 offen  lds
  s_add_u32 m0, s51, 49152
  s_add_u32 s46, s66, 286976
  buffer_load_dwordx4 v8, s[4:7], s46 offen  lds
  s_add_u32 m0, s51, 53248
  s_add_u32 s46, s66, 287104
  buffer_load_dwordx4 v8, s[4:7], s46 offen  lds
  s_add_u32 m0, s51, 57344
  s_add_u32 s46, s66, 287232
  buffer_load_dwordx4 v8, s[4:7], s46 offen  lds
  ds_read_b64_tr_b16 v[120:121], v9 offset:61440
  ds_read_b64_tr_b16 v[122:123], v9 offset:62464
  ds_read_b64_tr_b16 v[124:125], v10 offset:0
  ds_read_b64_tr_b16 v[126:127], v10 offset:1024
  ds_read_b64_tr_b16 v[128:129], v10 offset:4096
  ds_read_b64_tr_b16 v[130:131], v10 offset:5120
  ds_read_b64_tr_b16 v[132:133], v10 offset:8192
  ds_read_b64_tr_b16 v[134:135], v10 offset:9216
  ds_read_b64_tr_b16 v[136:137], v10 offset:12288
  ds_read_b64_tr_b16 v[138:139], v10 offset:13312
  s_waitcnt lgkmcnt(0)
  v_mfma_f32_16x16x32_bf16 v[160:163], v[120:123], v[36:39], v[160:163]
  v_mfma_f32_16x16x32_bf16 v[164:167], v[124:127], v[36:39], v[164:167]
  v_mfma_f32_16x16x32_bf16 v[168:171], v[128:131], v[36:39], v[168:171]
  v_mfma_f32_16x16x32_bf16 v[172:175], v[132:135], v[36:39], v[172:175]
  v_mfma_f32_16x16x32_bf16 v[176:179], v[136:139], v[36:39], v[176:179]
  s_waitcnt vmcnt(20)
  s_barrier
  s_add_u32 m0, s51, 61440
  s_add_u32 s46, s66, 287360
  buffer_load_dwordx4 v8, s[4:7], s46 offen  lds
  s_add_u32 m0, s51, 65536
  s_add_u32 s46, s66, 287488
  buffer_load_dwordx4 v8, s[4:7], s46 offen  lds
  s_add_u32 m0, s51, 69632
  s_add_u32 s46, s66, 287616
  buffer_load_dwordx4 v8, s[4:7], s46 offen  lds
  s_add_u32 m0, s51, 73728
  s_add_u32 s46, s66, 287744
  buffer_load_dwordx4 v8, s[4:7], s46 offen  lds
  s_add_u32 m0, s51, 77824
  s_add_u32 s46, s66, 287872
  buffer_load_dwordx4 v8, s[4:7], s46 offen  lds
  ds_read_b64_tr_b16 v[100:101], v10 offset:16384
  ds_read_b64_tr_b16 v[102:103], v10 offset:17408
  ds_read_b64_tr_b16 v[104:105], v10 offset:20480
  ds_read_b64_tr_b16 v[106:107], v10 offset:21504
  ds_read_b64_tr_b16 v[108:109], v10 offset:24576
  ds_read_b64_tr_b16 v[110:111], v10 offset:25600
  ds_read_b64_tr_b16 v[112:113], v10 offset:28672
  ds_read_b64_tr_b16 v[114:115], v10 offset:29696
  ds_read_b64_tr_b16 v[116:117], v10 offset:32768
  ds_read_b64_tr_b16 v[118:119], v10 offset:33792
  s_waitcnt lgkmcnt(0)
  v_mfma_f32_16x16x32_bf16 v[140:143], v[100:103], v[40:43], v[140:143]
  v_mfma_f32_16x16x32_bf16 v[144:147], v[104:107], v[40:43], v[144:147]
  v_mfma_f32_16x16x32_bf16 v[148:151], v[108:111], v[40:43], v[148:151]
  v_mfma_f32_16x16x32_bf16 v[152:155], v[112:115], v[40:43], v[152:155]
  v_mfma_f32_16x16x32_bf16 v[156:159], v[116:119], v[40:43], v[156:159]
  s_waitcnt vmcnt(20)
  s_barrier
  s_add_u32 m0, s51, 81920
  s_add_u32 s46, s66, 327680
  buffer_load_dwordx4 v8, s[4:7], s46 offen  lds
  s_add_u32 m0, s51, 86016
  s_add_u32 s46, s66, 327808
  buffer_load_dwordx4 v8, s[4:7], s46 offen  lds
  s_add_u32 m0, s51, 90112
  s_add_u32 s46, s66, 327936
  buffer_load_dwordx4 v8, s[4:7], s46 offen  lds
  s_add_u32 m0, s51, 94208
  s_add_u32 s46, s66, 328064
  buffer_load_dwordx4 v8, s[4:7], s46 offen  lds
  s_add_u32 m0, s51, 98304
  s_add_u32 s46, s66, 328192
  buffer_load_dwordx4 v8, s[4:7], s46 offen  lds
  ds_read_b64_tr_b16 v[120:121], v10 offset:36864
  ds_read_b64_tr_b16 v[122:123], v10 offset:37888
  ds_read_b64_tr_b16 v[124:125], v10 offset:40960
  ds_read_b64_tr_b16 v[126:127], v10 offset:41984
  ds_read_b64_tr_b16 v[128:129], v10 offset:45056
  ds_read_b64_tr_b16 v[130:131], v10 offset:46080
  ds_read_b64_tr_b16 v[132:133], v10 offset:49152
  ds_read_b64_tr_b16 v[134:135], v10 offset:50176
  ds_read_b64_tr_b16 v[136:137], v10 offset:53248
  ds_read_b64_tr_b16 v[138:139], v10 offset:54272
  s_waitcnt lgkmcnt(0)
  v_mfma_f32_16x16x32_bf16 v[160:163], v[120:123], v[40:43], v[160:163]
  v_mfma_f32_16x16x32_bf16 v[164:167], v[124:127], v[40:43], v[164:167]
  v_mfma_f32_16x16x32_bf16 v[168:171], v[128:131], v[40:43], v[168:171]
  v_mfma_f32_16x16x32_bf16 v[172:175], v[132:135], v[40:43], v[172:175]
  v_mfma_f32_16x16x32_bf16 v[176:179], v[136:139], v[40:43], v[176:179]
  s_waitcnt vmcnt(20)
  s_barrier
  s_add_u32 m0, s51, 102400
  s_add_u32 s46, s66, 328320
  buffer_load_dwordx4 v8, s[4:7], s46 offen  lds
  s_add_u32 m0, s51, 106496
  s_add_u32 s46, s66, 328448
  buffer_load_dwordx4 v8, s[4:7], s46 offen  lds
  s_add_u32 m0, s51, 110592
  s_add_u32 s46, s66, 328576
  buffer_load_dwordx4 v8, s[4:7], s46 offen  lds
  s_add_u32 m0, s51, 114688
  s_add_u32 s46, s66, 328704
  buffer_load_dwordx4 v8, s[4:7], s46 offen  lds
  s_add_u32 m0, s51, 118784
  s_add_u32 s46, s66, 328832
  buffer_load_dwordx4 v8, s[4:7], s46 offen  lds
  ds_read_b64_tr_b16 v[100:101], v9 offset:0
  ds_read_b64_tr_b16 v[102:103], v9 offset:1024
  ds_read_b64_tr_b16 v[104:105], v9 offset:4096
  ds_read_b64_tr_b16 v[106:107], v9 offset:5120
  ds_read_b64_tr_b16 v[108:109], v9 offset:8192
  ds_read_b64_tr_b16 v[110:111], v9 offset:9216
  ds_read_b64_tr_b16 v[112:113], v9 offset:12288
  ds_read_b64_tr_b16 v[114:115], v9 offset:13312
  ds_read_b64_tr_b16 v[116:117], v9 offset:16384
  ds_read_b64_tr_b16 v[118:119], v9 offset:17408
  s_waitcnt lgkmcnt(0)
  v_mfma_f32_16x16x32_bf16 v[140:143], v[100:103], v[44:47], v[140:143]
  v_mfma_f32_16x16x32_bf16 v[144:147], v[104:107], v[44:47], v[144:147]
  v_mfma_f32_16x16x32_bf16 v[148:151], v[108:111], v[44:47], v[148:151]
  v_mfma_f32_16x16x32_bf16 v[152:155], v[112:115], v[44:47], v[152:155]
  v_mfma_f32_16x16x32_bf16 v[156:159], v[116:119], v[44:47], v[156:159]
  s_waitcnt vmcnt(20)
  s_barrier
  s_add_u32 m0, s51, 0
  s_add_u32 s46, s66, 368640
  buffer_load_dwordx4 v8, s[4:7], s46 offen  lds
  s_add_u32 m0, s51, 4096
  s_add_u32 s46, s66, 368768
  buffer_load_dwordx4 v8, s[4:7], s46 offen  lds
  s_add_u32 m0, s51, 8192
  s_add_u32 s46, s66, 368896
  buffer_load_dwordx4 v8, s[4:7], s46 offen  lds
  s_add_u32 m0, s51, 12288
  s_add_u32 s46, s66, 369024
  buffer_load_dwordx4 v8, s[4:7], s46 offen  lds
  s_add_u32 m0, s51, 16384
  s_add_u32 s46, s66, 369152
  buffer_load_dwordx4 v8, s[4:7], s46 offen  lds
  ds_read_b64_tr_b16 v[120:121], v9 offset:20480
  ds_read_b64_tr_b16 v[122:123], v9 offset:21504
  ds_read_b64_tr_b16 v[124:125], v9 offset:24576
  ds_read_b64_tr_b16 v[126:127], v9 offset:25600
  ds_read_b64_tr_b16 v[128:129], v9 offset:28672
  ds_read_b64_tr_b16 v[130:131], v9 offset:29696
  ds_read_b64_tr_b16 v[132:133], v9 offset:32768
  ds_read_b64_tr_b16 v[134:135], v9 offset:33792
  ds_read_b64_tr_b16 v[136:137], v9 offset:36864
  ds_read_b64_tr_b16 v[138:139], v9 offset:37888
  s_waitcnt lgkmcnt(0)
  v_mfma_f32_16x16x32_bf16 v[160:163], v[120:123], v[44:47], v[160:163]
  v_mfma_f32_16x16x32_bf16 v[164:167], v[124:127], v[44:47], v[164:167]
  v_mfma_f32_16x16x32_bf16 v[168:171], v[128:131], v[44:47], v[168:171]
  v_mfma_f32_16x16x32_bf16 v[172:175], v[132:135], v[44:47], v[172:175]
  v_mfma_f32_16x16x32_bf16 v[176:179], v[136:139], v[44:47], v[176:179]
  s_waitcnt vmcnt(20)
  s_barrier
  s_add_u32 m0, s51, 20480
  s_add_u32 s46, s66, 369280
  buffer_load_dwordx4 v8, s[4:7], s46 offen  lds
  s_add_u32 m0, s51, 24576
  s_add_u32 s46, s66, 369408
  buffer_load_dwordx4 v8, s[4:7], s46 offen  lds
  s_add_u32 m0, s51, 28672
  s_add_u32 s46, s66, 369536
  buffer_load_dwordx4 v8, s[4:7], s46 offen  lds
  s_add_u32 m0, s51, 32768
  s_add_u32 s46, s66, 369664
  buffer_load_dwordx4 v8, s[4:7], s46 offen  lds
  s_add_u32 m0, s51, 36864
  s_add_u32 s46, s66, 369792
  buffer_load_dwordx4 v8, s[4:7], s46 offen  lds
  ds_read_b64_tr_b16 v[100:101], v9 offset:40960
  ds_read_b64_tr_b16 v[102:103], v9 offset:41984
  ds_read_b64_tr_b16 v[104:105], v9 offset:45056
  ds_read_b64_tr_b16 v[106:107], v9 offset:46080
  ds_read_b64_tr_b16 v[108:109], v9 offset:49152
  ds_read_b64_tr_b16 v[110:111], v9 offset:50176
  ds_read_b64_tr_b16 v[112:113], v9 offset:53248
  ds_read_b64_tr_b16 v[114:115], v9 offset:54272
  ds_read_b64_tr_b16 v[116:117], v9 offset:57344
  ds_read_b64_tr_b16 v[118:119], v9 offset:58368
  s_waitcnt lgkmcnt(0)
  v_mfma_f32_16x16x32_bf16 v[140:143], v[100:103], v[48:51], v[140:143]
  v_mfma_f32_16x16x32_bf16 v[144:147], v[104:107], v[48:51], v[144:147]
  v_mfma_f32_16x16x32_bf16 v[148:151], v[108:111], v[48:51], v[148:151]
  v_mfma_f32_16x16x32_bf16 v[152:155], v[112:115], v[48:51], v[152:155]
  v_mfma_f32_16x16x32_bf16 v[156:159], v[116:119], v[48:51], v[156:159]
  s_waitcnt vmcnt(20)
  s_barrier
  s_add_u32 m0, s51, 40960
  s_add_u32 s46, s66, 409600
  buffer_load_dwordx4 v8, s[4:7], s46 offen  lds
  s_add_u32 m0, s51, 45056
  s_add_u32 s46, s66, 409728
  buffer_load_dwordx4 v8, s[4:7], s46 offen  lds
  s_add_u32 m0, s51, 49152
  s_add_u32 s46, s66, 409856
  buffer_load_dwordx4 v8, s[4:7], s46 offen  lds
  s_add_u32 m0, s51, 53248
  s_add_u32 s46, s66, 409984
  buffer_load_dwordx4 v8, s[4:7], s46 offen  lds
  s_add_u32 m0, s51, 57344
  s_add_u32 s46, s66, 410112
  buffer_load_dwordx4 v8, s[4:7], s46 offen  lds
  ds_read_b64_tr_b16 v[120:121], v9 offset:61440
  ds_read_b64_tr_b16 v[122:123], v9 offset:62464
  ds_read_b64_tr_b16 v[124:125], v10 offset:0
  ds_read_b64_tr_b16 v[126:127], v10 offset:1024
  ds_read_b64_tr_b16 v[128:129], v10 offset:4096
  ds_read_b64_tr_b16 v[130:131], v10 offset:5120
  ds_read_b64_tr_b16 v[132:133], v10 offset:8192
  ds_read_b64_tr_b16 v[134:135], v10 offset:9216
  ds_read_b64_tr_b16 v[136:137], v10 offset:12288
  ds_read_b64_tr_b16 v[138:139], v10 offset:13312
  s_waitcnt lgkmcnt(0)
  v_mfma_f32_16x16x32_bf16 v[160:163], v[120:123], v[48:51], v[160:163]
  v_mfma_f32_16x16x32_bf16 v[164:167], v[124:127], v[48:51], v[164:167]
  v_mfma_f32_16x16x32_bf16 v[168:171], v[128:131], v[48:51], v[168:171]
  v_mfma_f32_16x16x32_bf16 v[172:175], v[132:135], v[48:51], v[172:175]
  v_mfma_f32_16x16x32_bf16 v[176:179], v[136:139], v[48:51], v[176:179]
  s_waitcnt vmcnt(20)
  s_barrier
  s_add_u32 m0, s51, 61440
  s_add_u32 s46, s66, 410240
  buffer_load_dwordx4 v8, s[4:7], s46 offen  lds
  s_add_u32 m0, s51, 65536
  s_add_u32 s46, s66, 410368
  buffer_load_dwordx4 v8, s[4:7], s46 offen  lds
  s_add_u32 m0, s51, 69632
  s_add_u32 s46, s66, 410496
  buffer_load_dwordx4 v8, s[4:7], s46 offen  lds
  s_add_u32 m0, s51, 73728
  s_add_u32 s46, s66, 410624
  buffer_load_dwordx4 v8, s[4:7], s46 offen  lds
  s_add_u32 m0, s51, 77824
  s_add_u32 s46, s66, 410752
  buffer_load_dwordx4 v8, s[4:7], s46 offen  lds
  ds_read_b64_tr_b16 v[100:101], v10 offset:16384
  ds_read_b64_tr_b16 v[102:103], v10 offset:17408
  ds_read_b64_tr_b16 v[104:105], v10 offset:20480
  ds_read_b64_tr_b16 v[106:107], v10 offset:21504
  ds_read_b64_tr_b16 v[108:109], v10 offset:24576
  ds_read_b64_tr_b16 v[110:111], v10 offset:25600
  ds_read_b64_tr_b16 v[112:113], v10 offset:28672
  ds_read_b64_tr_b16 v[114:115], v10 offset:29696
  ds_read_b64_tr_b16 v[116:117], v10 offset:32768
  ds_read_b64_tr_b16 v[118:119], v10 offset:33792
  s_waitcnt lgkmcnt(0)
  v_mfma_f32_16x16x32_bf16 v[140:143], v[100:103], v[52:55], v[140:143]
  v_mfma_f32_16x16x32_bf16 v[144:147], v[104:107], v[52:55], v[144:147]
  v_mfma_f32_16x16x32_bf16 v[148:151], v[108:111], v[52:55], v[148:151]
  v_mfma_f32_16x16x32_bf16 v[152:155], v[112:115], v[52:55], v[152:155]
  v_mfma_f32_16x16x32_bf16 v[156:159], v[116:119], v[52:55], v[156:159]
  s_waitcnt vmcnt(20)
  s_barrier
  s_add_u32 m0, s51, 81920
  s_add_u32 s46, s66, 450560
  buffer_load_dwordx4 v8, s[4:7], s46 offen  lds
  s_add_u32 m0, s51, 86016
  s_add_u32 s46, s66, 450688
  buffer_load_dwordx4 v8, s[4:7], s46 offen  lds
  s_add_u32 m0, s51, 90112
  s_add_u32 s46, s66, 450816
  buffer_load_dwordx4 v8, s[4:7], s46 offen  lds
  s_add_u32 m0, s51, 94208
  s_add_u32 s46, s66, 450944
  buffer_load_dwordx4 v8, s[4:7], s46 offen  lds
  s_add_u32 m0, s51, 98304
  s_add_u32 s46, s66, 451072
  buffer_load_dwordx4 v8, s[4:7], s46 offen  lds
  ds_read_b64_tr_b16 v[120:121], v10 offset:36864
  ds_read_b64_tr_b16 v[122:123], v10 offset:37888
  ds_read_b64_tr_b16 v[124:125], v10 offset:40960
  ds_read_b64_tr_b16 v[126:127], v10 offset:41984
  ds_read_b64_tr_b16 v[128:129], v10 offset:45056
  ds_read_b64_tr_b16 v[130:131], v10 offset:46080
  ds_read_b64_tr_b16 v[132:133], v10 offset:49152
  ds_read_b64_tr_b16 v[134:135], v10 offset:50176
  ds_read_b64_tr_b16 v[136:137], v10 offset:53248
  ds_read_b64_tr_b16 v[138:139], v10 offset:54272
  s_waitcnt lgkmcnt(0)
  v_mfma_f32_16x16x32_bf16 v[160:163], v[120:123], v[52:55], v[160:163]
  v_mfma_f32_16x16x32_bf16 v[164:167], v[124:127], v[52:55], v[164:167]
  v_mfma_f32_16x16x32_bf16 v[168:171], v[128:131], v[52:55], v[168:171]
  v_mfma_f32_16x16x32_bf16 v[172:175], v[132:135], v[52:55], v[172:175]
  v_mfma_f32_16x16x32_bf16 v[176:179], v[136:139], v[52:55], v[176:179]
  s_waitcnt vmcnt(20)
  s_barrier
  s_add_u32 m0, s51, 102400
  s_add_u32 s46, s66, 451200
  buffer_load_dwordx4 v8, s[4:7], s46 offen  lds
  s_add_u32 m0, s51, 106496
  s_add_u32 s46, s66, 451328
  buffer_load_dwordx4 v8, s[4:7], s46 offen  lds
  s_add_u32 m0, s51, 110592
  s_add_u32 s46, s66, 451456
  buffer_load_dwordx4 v8, s[4:7], s46 offen  lds
  s_add_u32 m0, s51, 114688
  s_add_u32 s46, s66, 451584
  buffer_load_dwordx4 v8, s[4:7], s46 offen  lds
  s_add_u32 m0, s51, 118784
  s_add_u32 s46, s66, 451712
  buffer_load_dwordx4 v8, s[4:7], s46 offen  lds
  ds_read_b64_tr_b16 v[100:101], v9 offset:0
  ds_read_b64_tr_b16 v[102:103], v9 offset:1024
  ds_read_b64_tr_b16 v[104:105], v9 offset:4096
  ds_read_b64_tr_b16 v[106:107], v9 offset:5120
  ds_read_b64_tr_b16 v[108:109], v9 offset:8192
  ds_read_b64_tr_b16 v[110:111], v9 offset:9216
  ds_read_b64_tr_b16 v[112:113], v9 offset:12288
  ds_read_b64_tr_b16 v[114:115], v9 offset:13312
  ds_read_b64_tr_b16 v[116:117], v9 offset:16384
  ds_read_b64_tr_b16 v[118:119], v9 offset:17408
  s_waitcnt lgkmcnt(0)
  v_mfma_f32_16x16x32_bf16 v[140:143], v[100:103], v[56:59], v[140:143]
  v_mfma_f32_16x16x32_bf16 v[144:147], v[104:107], v[56:59], v[144:147]
  v_mfma_f32_16x16x32_bf16 v[148:151], v[108:111], v[56:59], v[148:151]
  v_mfma_f32_16x16x32_bf16 v[152:155], v[112:115], v[56:59], v[152:155]
  v_mfma_f32_16x16x32_bf16 v[156:159], v[116:119], v[56:59], v[156:159]
  s_waitcnt vmcnt(20)
  s_barrier
  s_add_u32 m0, s51, 0
  s_add_u32 s46, s66, 491520
  buffer_load_dwordx4 v8, s[4:7], s46 offen  lds
  s_add_u32 m0, s51, 4096
  s_add_u32 s46, s66, 491648
  buffer_load_dwordx4 v8, s[4:7], s46 offen  lds
  s_add_u32 m0, s51, 8192
  s_add_u32 s46, s66, 491776
  buffer_load_dwordx4 v8, s[4:7], s46 offen  lds
  s_add_u32 m0, s51, 12288
  s_add_u32 s46, s66, 491904
  buffer_load_dwordx4 v8, s[4:7], s46 offen  lds
  s_add_u32 m0, s51, 16384
  s_add_u32 s46, s66, 492032
  buffer_load_dwordx4 v8, s[4:7], s46 offen  lds
  ds_read_b64_tr_b16 v[120:121], v9 offset:20480
  ds_read_b64_tr_b16 v[122:123], v9 offset:21504
  ds_read_b64_tr_b16 v[124:125], v9 offset:24576
  ds_read_b64_tr_b16 v[126:127], v9 offset:25600
  ds_read_b64_tr_b16 v[128:129], v9 offset:28672
  ds_read_b64_tr_b16 v[130:131], v9 offset:29696
  ds_read_b64_tr_b16 v[132:133], v9 offset:32768
  ds_read_b64_tr_b16 v[134:135], v9 offset:33792
  ds_read_b64_tr_b16 v[136:137], v9 offset:36864
  ds_read_b64_tr_b16 v[138:139], v9 offset:37888
  s_waitcnt lgkmcnt(0)
  v_mfma_f32_16x16x32_bf16 v[160:163], v[120:123], v[56:59], v[160:163]
  v_mfma_f32_16x16x32_bf16 v[164:167], v[124:127], v[56:59], v[164:167]
  v_mfma_f32_16x16x32_bf16 v[168:171], v[128:131], v[56:59], v[168:171]
  v_mfma_f32_16x16x32_bf16 v[172:175], v[132:135], v[56:59], v[172:175]
  v_mfma_f32_16x16x32_bf16 v[176:179], v[136:139], v[56:59], v[176:179]
  s_waitcnt vmcnt(20)
  s_barrier
  s_add_u32 m0, s51, 20480
  s_add_u32 s46, s66, 492160
  buffer_load_dwordx4 v8, s[4:7], s46 offen  lds
  s_add_u32 m0, s51, 24576
  s_add_u32 s46, s66, 492288
  buffer_load_dwordx4 v8, s[4:7], s46 offen  lds
  s_add_u32 m0, s51, 28672
  s_add_u32 s46, s66, 492416
  buffer_load_dwordx4 v8, s[4:7], s46 offen  lds
  s_add_u32 m0, s51, 32768
  s_add_u32 s46, s66, 492544
  buffer_load_dwordx4 v8, s[4:7], s46 offen  lds
  s_add_u32 m0, s51, 36864
  s_add_u32 s46, s66, 492672
  buffer_load_dwordx4 v8, s[4:7], s46 offen  lds
  ds_read_b64_tr_b16 v[100:101], v9 offset:40960
  ds_read_b64_tr_b16 v[102:103], v9 offset:41984
  ds_read_b64_tr_b16 v[104:105], v9 offset:45056
  ds_read_b64_tr_b16 v[106:107], v9 offset:46080
  ds_read_b64_tr_b16 v[108:109], v9 offset:49152
  ds_read_b64_tr_b16 v[110:111], v9 offset:50176
  ds_read_b64_tr_b16 v[112:113], v9 offset:53248
  ds_read_b64_tr_b16 v[114:115], v9 offset:54272
  ds_read_b64_tr_b16 v[116:117], v9 offset:57344
  ds_read_b64_tr_b16 v[118:119], v9 offset:58368
  s_waitcnt lgkmcnt(0)
  v_mfma_f32_16x16x32_bf16 v[140:143], v[100:103], v[60:63], v[140:143]
  v_mfma_f32_16x16x32_bf16 v[144:147], v[104:107], v[60:63], v[144:147]
  v_mfma_f32_16x16x32_bf16 v[148:151], v[108:111], v[60:63], v[148:151]
  v_mfma_f32_16x16x32_bf16 v[152:155], v[112:115], v[60:63], v[152:155]
  v_mfma_f32_16x16x32_bf16 v[156:159], v[116:119], v[60:63], v[156:159]
  s_waitcnt vmcnt(20)
  s_barrier
  s_add_u32 m0, s51, 40960
  s_add_u32 s46, s66, 532480
  buffer_load_dwordx4 v8, s[4:7], s46 offen  lds
  s_add_u32 m0, s51, 45056
  s_add_u32 s46, s66, 532608
  buffer_load_dwordx4 v8, s[4:7], s46 offen  lds
  s_add_u32 m0, s51, 49152
  s_add_u32 s46, s66, 532736
  buffer_load_dwordx4 v8, s[4:7], s46 offen  lds
  s_add_u32 m0, s51, 53248
  s_add_u32 s46, s66, 532864
  buffer_load_dwordx4 v8, s[4:7], s46 offen  lds
  s_add_u32 m0, s51, 57344
  s_add_u32 s46, s66, 532992
  buffer_load_dwordx4 v8, s[4:7], s46 offen  lds
  ds_read_b64_tr_b16 v[120:121], v9 offset:61440
  ds_read_b64_tr_b16 v[122:123], v9 offset:62464
  ds_read_b64_tr_b16 v[124:125], v10 offset:0
  ds_read_b64_tr_b16 v[126:127], v10 offset:1024
  ds_read_b64_tr_b16 v[128:129], v10 offset:4096
  ds_read_b64_tr_b16 v[130:131], v10 offset:5120
  ds_read_b64_tr_b16 v[132:133], v10 offset:8192
  ds_read_b64_tr_b16 v[134:135], v10 offset:9216
  ds_read_b64_tr_b16 v[136:137], v10 offset:12288
  ds_read_b64_tr_b16 v[138:139], v10 offset:13312
  s_waitcnt lgkmcnt(0)
  v_mfma_f32_16x16x32_bf16 v[160:163], v[120:123], v[60:63], v[160:163]
  v_mfma_f32_16x16x32_bf16 v[164:167], v[124:127], v[60:63], v[164:167]
  v_mfma_f32_16x16x32_bf16 v[168:171], v[128:131], v[60:63], v[168:171]
  v_mfma_f32_16x16x32_bf16 v[172:175], v[132:135], v[60:63], v[172:175]
  v_mfma_f32_16x16x32_bf16 v[176:179], v[136:139], v[60:63], v[176:179]
  s_waitcnt vmcnt(20)
  s_barrier
  s_add_u32 m0, s51, 61440
  s_add_u32 s46, s66, 533120
  buffer_load_dwordx4 v8, s[4:7], s46 offen  lds
  s_add_u32 m0, s51, 65536
  s_add_u32 s46, s66, 533248
  buffer_load_dwordx4 v8, s[4:7], s46 offen  lds
  s_add_u32 m0, s51, 69632
  s_add_u32 s46, s66, 533376
  buffer_load_dwordx4 v8, s[4:7], s46 offen  lds
  s_add_u32 m0, s51, 73728
  s_add_u32 s46, s66, 533504
  buffer_load_dwordx4 v8, s[4:7], s46 offen  lds
  s_add_u32 m0, s51, 77824
  s_add_u32 s46, s66, 533632
  buffer_load_dwordx4 v8, s[4:7], s46 offen  lds
  ds_read_b64_tr_b16 v[100:101], v10 offset:16384
  ds_read_b64_tr_b16 v[102:103], v10 offset:17408
  ds_read_b64_tr_b16 v[104:105], v10 offset:20480
  ds_read_b64_tr_b16 v[106:107], v10 offset:21504
  ds_read_b64_tr_b16 v[108:109], v10 offset:24576
  ds_read_b64_tr_b16 v[110:111], v10 offset:25600
  ds_read_b64_tr_b16 v[112:113], v10 offset:28672
  ds_read_b64_tr_b16 v[114:115], v10 offset:29696
  ds_read_b64_tr_b16 v[116:117], v10 offset:32768
  ds_read_b64_tr_b16 v[118:119], v10 offset:33792
  s_waitcnt lgkmcnt(0)
  v_mfma_f32_16x16x32_bf16 v[140:143], v[100:103], v[64:67], v[140:143]
  v_mfma_f32_16x16x32_bf16 v[144:147], v[104:107], v[64:67], v[144:147]
  v_mfma_f32_16x16x32_bf16 v[148:151], v[108:111], v[64:67], v[148:151]
  v_mfma_f32_16x16x32_bf16 v[152:155], v[112:115], v[64:67], v[152:155]
  v_mfma_f32_16x16x32_bf16 v[156:159], v[116:119], v[64:67], v[156:159]
  s_waitcnt vmcnt(20)
  s_barrier
  s_add_u32 m0, s51, 81920
  s_add_u32 s46, s66, 573440
  buffer_load_dwordx4 v8, s[4:7], s46 offen  lds
  s_add_u32 m0, s51, 86016
  s_add_u32 s46, s66, 573568
  buffer_load_dwordx4 v8, s[4:7], s46 offen  lds
  s_add_u32 m0, s51, 90112
  s_add_u32 s46, s66, 573696
  buffer_load_dwordx4 v8, s[4:7], s46 offen  lds
  s_add_u32 m0, s51, 94208
  s_add_u32 s46, s66, 573824
  buffer_load_dwordx4 v8, s[4:7], s46 offen  lds
  s_add_u32 m0, s51, 98304
  s_add_u32 s46, s66, 573952
  buffer_load_dwordx4 v8, s[4:7], s46 offen  lds
  ds_read_b64_tr_b16 v[120:121], v10 offset:36864
  ds_read_b64_tr_b16 v[122:123], v10 offset:37888
  ds_read_b64_tr_b16 v[124:125], v10 offset:40960
  ds_read_b64_tr_b16 v[126:127], v10 offset:41984
  ds_read_b64_tr_b16 v[128:129], v10 offset:45056
  ds_read_b64_tr_b16 v[130:131], v10 offset:46080
  ds_read_b64_tr_b16 v[132:133], v10 offset:49152
  ds_read_b64_tr_b16 v[134:135], v10 offset:50176
  ds_read_b64_tr_b16 v[136:137], v10 offset:53248
  ds_read_b64_tr_b16 v[138:139], v10 offset:54272
  s_waitcnt lgkmcnt(0)
  v_mfma_f32_16x16x32_bf16 v[160:163], v[120:123], v[64:67], v[160:163]
  v_mfma_f32_16x16x32_bf16 v[164:167], v[124:127], v[64:67], v[164:167]
  v_mfma_f32_16x16x32_bf16 v[168:171], v[128:131], v[64:67], v[168:171]
  v_mfma_f32_16x16x32_bf16 v[172:175], v[132:135], v[64:67], v[172:175]
  v_mfma_f32_16x16x32_bf16 v[176:179], v[136:139], v[64:67], v[176:179]
  s_waitcnt vmcnt(20)
  s_barrier
  s_add_u32 m0, s51, 102400
  s_add_u32 s46, s66, 574080
  buffer_load_dwordx4 v8, s[4:7], s46 offen  lds
  s_add_u32 m0, s51, 106496
  s_add_u32 s46, s66, 574208
  buffer_load_dwordx4 v8, s[4:7], s46 offen  lds
  s_add_u32 m0, s51, 110592
  s_add_u32 s46, s66, 574336
  buffer_load_dwordx4 v8, s[4:7], s46 offen  lds
  s_add_u32 m0, s51, 114688
  s_add_u32 s46, s66, 574464
  buffer_load_dwordx4 v8, s[4:7], s46 offen  lds
  s_add_u32 m0, s51, 118784
  s_add_u32 s46, s66, 574592
  buffer_load_dwordx4 v8, s[4:7], s46 offen  lds
  ds_read_b64_tr_b16 v[100:101], v9 offset:0
  ds_read_b64_tr_b16 v[102:103], v9 offset:1024
  ds_read_b64_tr_b16 v[104:105], v9 offset:4096
  ds_read_b64_tr_b16 v[106:107], v9 offset:5120
  ds_read_b64_tr_b16 v[108:109], v9 offset:8192
  ds_read_b64_tr_b16 v[110:111], v9 offset:9216
  ds_read_b64_tr_b16 v[112:113], v9 offset:12288
  ds_read_b64_tr_b16 v[114:115], v9 offset:13312
  ds_read_b64_tr_b16 v[116:117], v9 offset:16384
  ds_read_b64_tr_b16 v[118:119], v9 offset:17408
  s_waitcnt lgkmcnt(0)
  v_mfma_f32_16x16x32_bf16 v[140:143], v[100:103], v[68:71], v[140:143]
  v_mfma_f32_16x16x32_bf16 v[144:147], v[104:107], v[68:71], v[144:147]
  v_mfma_f32_16x16x32_bf16 v[148:151], v[108:111], v[68:71], v[148:151]
  v_mfma_f32_16x16x32_bf16 v[152:155], v[112:115], v[68:71], v[152:155]
  v_mfma_f32_16x16x32_bf16 v[156:159], v[116:119], v[68:71], v[156:159]
  s_waitcnt vmcnt(20)
  s_barrier
  s_add_u32 m0, s51, 0
  s_add_u32 s46, s66, 614400
  buffer_load_dwordx4 v8, s[4:7], s46 offen  lds
  s_add_u32 m0, s51, 4096
  s_add_u32 s46, s66, 614528
  buffer_load_dwordx4 v8, s[4:7], s46 offen  lds
  s_add_u32 m0, s51, 8192
  s_add_u32 s46, s66, 614656
  buffer_load_dwordx4 v8, s[4:7], s46 offen  lds
  s_add_u32 m0, s51, 12288
  s_add_u32 s46, s66, 614784
  buffer_load_dwordx4 v8, s[4:7], s46 offen  lds
  s_add_u32 m0, s51, 16384
  s_add_u32 s46, s66, 614912
  buffer_load_dwordx4 v8, s[4:7], s46 offen  lds
  ds_read_b64_tr_b16 v[120:121], v9 offset:20480
  ds_read_b64_tr_b16 v[122:123], v9 offset:21504
  ds_read_b64_tr_b16 v[124:125], v9 offset:24576
  ds_read_b64_tr_b16 v[126:127], v9 offset:25600
  ds_read_b64_tr_b16 v[128:129], v9 offset:28672
  ds_read_b64_tr_b16 v[130:131], v9 offset:29696
  ds_read_b64_tr_b16 v[132:133], v9 offset:32768
  ds_read_b64_tr_b16 v[134:135], v9 offset:33792
  ds_read_b64_tr_b16 v[136:137], v9 offset:36864
  ds_read_b64_tr_b16 v[138:139], v9 offset:37888
  s_waitcnt lgkmcnt(0)
  v_mfma_f32_16x16x32_bf16 v[160:163], v[120:123], v[68:71], v[160:163]
  v_mfma_f32_16x16x32_bf16 v[164:167], v[124:127], v[68:71], v[164:167]
  v_mfma_f32_16x16x32_bf16 v[168:171], v[128:131], v[68:71], v[168:171]
  v_mfma_f32_16x16x32_bf16 v[172:175], v[132:135], v[68:71], v[172:175]
  v_mfma_f32_16x16x32_bf16 v[176:179], v[136:139], v[68:71], v[176:179]
  s_waitcnt vmcnt(20)
  s_barrier
  s_add_u32 m0, s51, 20480
  s_add_u32 s46, s66, 615040
  buffer_load_dwordx4 v8, s[4:7], s46 offen  lds
  s_add_u32 m0, s51, 24576
  s_add_u32 s46, s66, 615168
  buffer_load_dwordx4 v8, s[4:7], s46 offen  lds
  s_add_u32 m0, s51, 28672
  s_add_u32 s46, s66, 615296
  buffer_load_dwordx4 v8, s[4:7], s46 offen  lds
  s_add_u32 m0, s51, 32768
  s_add_u32 s46, s66, 615424
  buffer_load_dwordx4 v8, s[4:7], s46 offen  lds
  s_add_u32 m0, s51, 36864
  s_add_u32 s46, s66, 615552
  buffer_load_dwordx4 v8, s[4:7], s46 offen  lds
  ds_read_b64_tr_b16 v[100:101], v9 offset:40960
  ds_read_b64_tr_b16 v[102:103], v9 offset:41984
  ds_read_b64_tr_b16 v[104:105], v9 offset:45056
  ds_read_b64_tr_b16 v[106:107], v9 offset:46080
  ds_read_b64_tr_b16 v[108:109], v9 offset:49152
  ds_read_b64_tr_b16 v[110:111], v9 offset:50176
  ds_read_b64_tr_b16 v[112:113], v9 offset:53248
  ds_read_b64_tr_b16 v[114:115], v9 offset:54272
  ds_read_b64_tr_b16 v[116:117], v9 offset:57344
  ds_read_b64_tr_b16 v[118:119], v9 offset:58368
  s_waitcnt lgkmcnt(0)
  v_mfma_f32_16x16x32_bf16 v[140:143], v[100:103], v[72:75], v[140:143]
  v_mfma_f32_16x16x32_bf16 v[144:147], v[104:107], v[72:75], v[144:147]
  v_mfma_f32_16x16x32_bf16 v[148:151], v[108:111], v[72:75], v[148:151]
  v_mfma_f32_16x16x32_bf16 v[152:155], v[112:115], v[72:75], v[152:155]
  v_mfma_f32_16x16x32_bf16 v[156:159], v[116:119], v[72:75], v[156:159]
  s_waitcnt vmcnt(20)
  s_barrier
  s_add_u32 m0, s51, 40960
  s_add_u32 s46, s66, 655360
  buffer_load_dwordx4 v8, s[4:7], s46 offen  lds
  s_add_u32 m0, s51, 45056
  s_add_u32 s46, s66, 655488
  buffer_load_dwordx4 v8, s[4:7], s46 offen  lds
  s_add_u32 m0, s51, 49152
  s_add_u32 s46, s66, 655616
  buffer_load_dwordx4 v8, s[4:7], s46 offen  lds
  s_add_u32 m0, s51, 53248
  s_add_u32 s46, s66, 655744
  buffer_load_dwordx4 v8, s[4:7], s46 offen  lds
  s_add_u32 m0, s51, 57344
  s_add_u32 s46, s66, 655872
  buffer_load_dwordx4 v8, s[4:7], s46 offen  lds
  ds_read_b64_tr_b16 v[120:121], v9 offset:61440
  ds_read_b64_tr_b16 v[122:123], v9 offset:62464
  ds_read_b64_tr_b16 v[124:125], v10 offset:0
  ds_read_b64_tr_b16 v[126:127], v10 offset:1024
  ds_read_b64_tr_b16 v[128:129], v10 offset:4096
  ds_read_b64_tr_b16 v[130:131], v10 offset:5120
  ds_read_b64_tr_b16 v[132:133], v10 offset:8192
  ds_read_b64_tr_b16 v[134:135], v10 offset:9216
  ds_read_b64_tr_b16 v[136:137], v10 offset:12288
  ds_read_b64_tr_b16 v[138:139], v10 offset:13312
  s_waitcnt lgkmcnt(0)
  v_mfma_f32_16x16x32_bf16 v[160:163], v[120:123], v[72:75], v[160:163]
  v_mfma_f32_16x16x32_bf16 v[164:167], v[124:127], v[72:75], v[164:167]
  v_mfma_f32_16x16x32_bf16 v[168:171], v[128:131], v[72:75], v[168:171]
  v_mfma_f32_16x16x32_bf16 v[172:175], v[132:135], v[72:75], v[172:175]
  v_mfma_f32_16x16x32_bf16 v[176:179], v[136:139], v[72:75], v[176:179]
  s_waitcnt vmcnt(20)
  s_barrier
  s_add_u32 m0, s51, 61440
  s_add_u32 s46, s66, 656000
  buffer_load_dwordx4 v8, s[4:7], s46 offen  lds
  s_add_u32 m0, s51, 65536
  s_add_u32 s46, s66, 656128
  buffer_load_dwordx4 v8, s[4:7], s46 offen  lds
  s_add_u32 m0, s51, 69632
  s_add_u32 s46, s66, 656256
  buffer_load_dwordx4 v8, s[4:7], s46 offen  lds
  s_add_u32 m0, s51, 73728
  s_add_u32 s46, s66, 656384
  buffer_load_dwordx4 v8, s[4:7], s46 offen  lds
  s_add_u32 m0, s51, 77824
  s_add_u32 s46, s66, 656512
  buffer_load_dwordx4 v8, s[4:7], s46 offen  lds
  ds_read_b64_tr_b16 v[100:101], v10 offset:16384
  ds_read_b64_tr_b16 v[102:103], v10 offset:17408
  ds_read_b64_tr_b16 v[104:105], v10 offset:20480
  ds_read_b64_tr_b16 v[106:107], v10 offset:21504
  ds_read_b64_tr_b16 v[108:109], v10 offset:24576
  ds_read_b64_tr_b16 v[110:111], v10 offset:25600
  ds_read_b64_tr_b16 v[112:113], v10 offset:28672
  ds_read_b64_tr_b16 v[114:115], v10 offset:29696
  ds_read_b64_tr_b16 v[116:117], v10 offset:32768
  ds_read_b64_tr_b16 v[118:119], v10 offset:33792
  s_waitcnt lgkmcnt(0)
  v_mfma_f32_16x16x32_bf16 v[140:143], v[100:103], v[76:79], v[140:143]
  v_mfma_f32_16x16x32_bf16 v[144:147], v[104:107], v[76:79], v[144:147]
  v_mfma_f32_16x16x32_bf16 v[148:151], v[108:111], v[76:79], v[148:151]
  v_mfma_f32_16x16x32_bf16 v[152:155], v[112:115], v[76:79], v[152:155]
  v_mfma_f32_16x16x32_bf16 v[156:159], v[116:119], v[76:79], v[156:159]
  s_waitcnt vmcnt(20)
  s_barrier
  s_add_u32 m0, s51, 81920
  s_add_u32 s46, s66, 696320
  buffer_load_dwordx4 v8, s[4:7], s46 offen  lds
  s_add_u32 m0, s51, 86016
  s_add_u32 s46, s66, 696448
  buffer_load_dwordx4 v8, s[4:7], s46 offen  lds
  s_add_u32 m0, s51, 90112
  s_add_u32 s46, s66, 696576
  buffer_load_dwordx4 v8, s[4:7], s46 offen  lds
  s_add_u32 m0, s51, 94208
  s_add_u32 s46, s66, 696704
  buffer_load_dwordx4 v8, s[4:7], s46 offen  lds
  s_add_u32 m0, s51, 98304
  s_add_u32 s46, s66, 696832
  buffer_load_dwordx4 v8, s[4:7], s46 offen  lds
  ds_read_b64_tr_b16 v[120:121], v10 offset:36864
  ds_read_b64_tr_b16 v[122:123], v10 offset:37888
  ds_read_b64_tr_b16 v[124:125], v10 offset:40960
  ds_read_b64_tr_b16 v[126:127], v10 offset:41984
  ds_read_b64_tr_b16 v[128:129], v10 offset:45056
  ds_read_b64_tr_b16 v[130:131], v10 offset:46080
  ds_read_b64_tr_b16 v[132:133], v10 offset:49152
  ds_read_b64_tr_b16 v[134:135], v10 offset:50176
  ds_read_b64_tr_b16 v[136:137], v10 offset:53248
  ds_read_b64_tr_b16 v[138:139], v10 offset:54272
  s_waitcnt lgkmcnt(0)
  v_mfma_f32_16x16x32_bf16 v[160:163], v[120:123], v[76:79], v[160:163]
  v_mfma_f32_16x16x32_bf16 v[164:167], v[124:127], v[76:79], v[164:167]
  v_mfma_f32_16x16x32_bf16 v[168:171], v[128:131], v[76:79], v[168:171]
  v_mfma_f32_16x16x32_bf16 v[172:175], v[132:135], v[76:79], v[172:175]
  v_mfma_f32_16x16x32_bf16 v[176:179], v[136:139], v[76:79], v[176:179]
  s_waitcnt vmcnt(20)
  s_barrier
  s_add_u32 m0, s51, 102400
  s_add_u32 s46, s66, 696960
  buffer_load_dwordx4 v8, s[4:7], s46 offen  lds
  s_add_u32 m0, s51, 106496
  s_add_u32 s46, s66, 697088
  buffer_load_dwordx4 v8, s[4:7], s46 offen  lds
  s_add_u32 m0, s51, 110592
  s_add_u32 s46, s66, 697216
  buffer_load_dwordx4 v8, s[4:7], s46 offen  lds
  s_add_u32 m0, s51, 114688
  s_add_u32 s46, s66, 697344
  buffer_load_dwordx4 v8, s[4:7], s46 offen  lds
  s_add_u32 m0, s51, 118784
  s_add_u32 s46, s66, 697472
  buffer_load_dwordx4 v8, s[4:7], s46 offen  lds
  ds_read_b64_tr_b16 v[100:101], v9 offset:0
  ds_read_b64_tr_b16 v[102:103], v9 offset:1024
  ds_read_b64_tr_b16 v[104:105], v9 offset:4096
  ds_read_b64_tr_b16 v[106:107], v9 offset:5120
  ds_read_b64_tr_b16 v[108:109], v9 offset:8192
  ds_read_b64_tr_b16 v[110:111], v9 offset:9216
  ds_read_b64_tr_b16 v[112:113], v9 offset:12288
  ds_read_b64_tr_b16 v[114:115], v9 offset:13312
  ds_read_b64_tr_b16 v[116:117], v9 offset:16384
  ds_read_b64_tr_b16 v[118:119], v9 offset:17408
  s_waitcnt lgkmcnt(0)
  v_mfma_f32_16x16x32_bf16 v[140:143], v[100:103], v[80:83], v[140:143]
  v_mfma_f32_16x16x32_bf16 v[144:147], v[104:107], v[80:83], v[144:147]
  v_mfma_f32_16x16x32_bf16 v[148:151], v[108:111], v[80:83], v[148:151]
  v_mfma_f32_16x16x32_bf16 v[152:155], v[112:115], v[80:83], v[152:155]
  v_mfma_f32_16x16x32_bf16 v[156:159], v[116:119], v[80:83], v[156:159]
  s_waitcnt vmcnt(20)
  s_barrier
  s_add_u32 m0, s51, 0
  s_add_u32 s46, s66, 737280
  buffer_load_dwordx4 v8, s[4:7], s46 offen  lds
  s_add_u32 m0, s51, 4096
  s_add_u32 s46, s66, 737408
  buffer_load_dwordx4 v8, s[4:7], s46 offen  lds
  s_add_u32 m0, s51, 8192
  s_add_u32 s46, s66, 737536
  buffer_load_dwordx4 v8, s[4:7], s46 offen  lds
  s_add_u32 m0, s51, 12288
  s_add_u32 s46, s66, 737664
  buffer_load_dwordx4 v8, s[4:7], s46 offen  lds
  s_add_u32 m0, s51, 16384
  s_add_u32 s46, s66, 737792
  buffer_load_dwordx4 v8, s[4:7], s46 offen  lds
  ds_read_b64_tr_b16 v[120:121], v9 offset:20480
  ds_read_b64_tr_b16 v[122:123], v9 offset:21504
  ds_read_b64_tr_b16 v[124:125], v9 offset:24576
  ds_read_b64_tr_b16 v[126:127], v9 offset:25600
  ds_read_b64_tr_b16 v[128:129], v9 offset:28672
  ds_read_b64_tr_b16 v[130:131], v9 offset:29696
  ds_read_b64_tr_b16 v[132:133], v9 offset:32768
  ds_read_b64_tr_b16 v[134:135], v9 offset:33792
  ds_read_b64_tr_b16 v[136:137], v9 offset:36864
  ds_read_b64_tr_b16 v[138:139], v9 offset:37888
  s_waitcnt lgkmcnt(0)
  v_mfma_f32_16x16x32_bf16 v[160:163], v[120:123], v[80:83], v[160:163]
  v_mfma_f32_16x16x32_bf16 v[164:167], v[124:127], v[80:83], v[164:167]
  v_mfma_f32_16x16x32_bf16 v[168:171], v[128:131], v[80:83], v[168:171]
  v_mfma_f32_16x16x32_bf16 v[172:175], v[132:135], v[80:83], v[172:175]
  v_mfma_f32_16x16x32_bf16 v[176:179], v[136:139], v[80:83], v[176:179]
  s_waitcnt vmcnt(20)
  s_barrier
  s_add_u32 m0, s51, 20480
  s_add_u32 s46, s66, 737920
  buffer_load_dwordx4 v8, s[4:7], s46 offen  lds
  s_add_u32 m0, s51, 24576
  s_add_u32 s46, s66, 738048
  buffer_load_dwordx4 v8, s[4:7], s46 offen  lds
  s_add_u32 m0, s51, 28672
  s_add_u32 s46, s66, 738176
  buffer_load_dwordx4 v8, s[4:7], s46 offen  lds
  s_add_u32 m0, s51, 32768
  s_add_u32 s46, s66, 738304
  buffer_load_dwordx4 v8, s[4:7], s46 offen  lds
  s_add_u32 m0, s51, 36864
  s_add_u32 s46, s66, 738432
  buffer_load_dwordx4 v8, s[4:7], s46 offen  lds
  ds_read_b64_tr_b16 v[100:101], v9 offset:40960
  ds_read_b64_tr_b16 v[102:103], v9 offset:41984
  ds_read_b64_tr_b16 v[104:105], v9 offset:45056
  ds_read_b64_tr_b16 v[106:107], v9 offset:46080
  ds_read_b64_tr_b16 v[108:109], v9 offset:49152
  ds_read_b64_tr_b16 v[110:111], v9 offset:50176
  ds_read_b64_tr_b16 v[112:113], v9 offset:53248
  ds_read_b64_tr_b16 v[114:115], v9 offset:54272
  ds_read_b64_tr_b16 v[116:117], v9 offset:57344
  ds_read_b64_tr_b16 v[118:119], v9 offset:58368
  s_waitcnt lgkmcnt(0)
  v_mfma_f32_16x16x32_bf16 v[140:143], v[100:103], v[84:87], v[140:143]
  v_mfma_f32_16x16x32_bf16 v[144:147], v[104:107], v[84:87], v[144:147]
  v_mfma_f32_16x16x32_bf16 v[148:151], v[108:111], v[84:87], v[148:151]
  v_mfma_f32_16x16x32_bf16 v[152:155], v[112:115], v[84:87], v[152:155]
  v_mfma_f32_16x16x32_bf16 v[156:159], v[116:119], v[84:87], v[156:159]
  s_waitcnt vmcnt(20)
  s_barrier
  s_add_u32 m0, s51, 40960
  s_add_u32 s46, s66, 778240
  buffer_load_dwordx4 v8, s[4:7], s46 offen  lds
  s_add_u32 m0, s51, 45056
  s_add_u32 s46, s66, 778368
  buffer_load_dwordx4 v8, s[4:7], s46 offen  lds
  s_add_u32 m0, s51, 49152
  s_add_u32 s46, s66, 778496
  buffer_load_dwordx4 v8, s[4:7], s46 offen  lds
  s_add_u32 m0, s51, 53248
  s_add_u32 s46, s66, 778624
  buffer_load_dwordx4 v8, s[4:7], s46 offen  lds
  s_add_u32 m0, s51, 57344
  s_add_u32 s46, s66, 778752
  buffer_load_dwordx4 v8, s[4:7], s46 offen  lds
  ds_read_b64_tr_b16 v[120:121], v9 offset:61440
  ds_read_b64_tr_b16 v[122:123], v9 offset:62464
  ds_read_b64_tr_b16 v[124:125], v10 offset:0
  ds_read_b64_tr_b16 v[126:127], v10 offset:1024
  ds_read_b64_tr_b16 v[128:129], v10 offset:4096
  ds_read_b64_tr_b16 v[130:131], v10 offset:5120
  ds_read_b64_tr_b16 v[132:133], v10 offset:8192
  ds_read_b64_tr_b16 v[134:135], v10 offset:9216
  ds_read_b64_tr_b16 v[136:137], v10 offset:12288
  ds_read_b64_tr_b16 v[138:139], v10 offset:13312
  s_waitcnt lgkmcnt(0)
  v_mfma_f32_16x16x32_bf16 v[160:163], v[120:123], v[84:87], v[160:163]
  v_mfma_f32_16x16x32_bf16 v[164:167], v[124:127], v[84:87], v[164:167]
  v_mfma_f32_16x16x32_bf16 v[168:171], v[128:131], v[84:87], v[168:171]
  v_mfma_f32_16x16x32_bf16 v[172:175], v[132:135], v[84:87], v[172:175]
  v_mfma_f32_16x16x32_bf16 v[176:179], v[136:139], v[84:87], v[176:179]
  s_waitcnt vmcnt(20)
  s_barrier
  s_add_u32 m0, s51, 61440
  s_add_u32 s46, s66, 778880
  buffer_load_dwordx4 v8, s[4:7], s46 offen  lds
  s_add_u32 m0, s51, 65536
  s_add_u32 s46, s66, 779008
  buffer_load_dwordx4 v8, s[4:7], s46 offen  lds
  s_add_u32 m0, s51, 69632
  s_add_u32 s46, s66, 779136
  buffer_load_dwordx4 v8, s[4:7], s46 offen  lds
  s_add_u32 m0, s51, 73728
  s_add_u32 s46, s66, 779264
  buffer_load_dwordx4 v8, s[4:7], s46 offen  lds
  s_add_u32 m0, s51, 77824
  s_add_u32 s46, s66, 779392
  buffer_load_dwordx4 v8, s[4:7], s46 offen  lds
  ds_read_b64_tr_b16 v[100:101], v10 offset:16384
  ds_read_b64_tr_b16 v[102:103], v10 offset:17408
  ds_read_b64_tr_b16 v[104:105], v10 offset:20480
  ds_read_b64_tr_b16 v[106:107], v10 offset:21504
  ds_read_b64_tr_b16 v[108:109], v10 offset:24576
  ds_read_b64_tr_b16 v[110:111], v10 offset:25600
  ds_read_b64_tr_b16 v[112:113], v10 offset:28672
  ds_read_b64_tr_b16 v[114:115], v10 offset:29696
  ds_read_b64_tr_b16 v[116:117], v10 offset:32768
  ds_read_b64_tr_b16 v[118:119], v10 offset:33792
  s_waitcnt lgkmcnt(0)
  v_mfma_f32_16x16x32_bf16 v[140:143], v[100:103], v[88:91], v[140:143]
  v_mfma_f32_16x16x32_bf16 v[144:147], v[104:107], v[88:91], v[144:147]
  v_mfma_f32_16x16x32_bf16 v[148:151], v[108:111], v[88:91], v[148:151]
  v_mfma_f32_16x16x32_bf16 v[152:155], v[112:115], v[88:91], v[152:155]
  v_mfma_f32_16x16x32_bf16 v[156:159], v[116:119], v[88:91], v[156:159]
  s_waitcnt vmcnt(20)
  s_barrier
  ds_read_b64_tr_b16 v[120:121], v10 offset:36864
  ds_read_b64_tr_b16 v[122:123], v10 offset:37888
  ds_read_b64_tr_b16 v[124:125], v10 offset:40960
  ds_read_b64_tr_b16 v[126:127], v10 offset:41984
  ds_read_b64_tr_b16 v[128:129], v10 offset:45056
  ds_read_b64_tr_b16 v[130:131], v10 offset:46080
  ds_read_b64_tr_b16 v[132:133], v10 offset:49152
  ds_read_b64_tr_b16 v[134:135], v10 offset:50176
  ds_read_b64_tr_b16 v[136:137], v10 offset:53248
  ds_read_b64_tr_b16 v[138:139], v10 offset:54272
  s_waitcnt lgkmcnt(0)
  v_mfma_f32_16x16x32_bf16 v[160:163], v[120:123], v[88:91], v[160:163]
  v_mfma_f32_16x16x32_bf16 v[164:167], v[124:127], v[88:91], v[164:167]
  v_mfma_f32_16x16x32_bf16 v[168:171], v[128:131], v[88:91], v[168:171]
  v_mfma_f32_16x16x32_bf16 v[172:175], v[132:135], v[88:91], v[172:175]
  v_mfma_f32_16x16x32_bf16 v[176:179], v[136:139], v[88:91], v[176:179]
  s_waitcnt vmcnt(15)
  s_barrier
  ds_read_b64_tr_b16 v[100:101], v9 offset:0
  ds_read_b64_tr_b16 v[102:103], v9 offset:1024
  ds_read_b64_tr_b16 v[104:105], v9 offset:4096
  ds_read_b64_tr_b16 v[106:107], v9 offset:5120
  ds_read_b64_tr_b16 v[108:109], v9 offset:8192
  ds_read_b64_tr_b16 v[110:111], v9 offset:9216
  ds_read_b64_tr_b16 v[112:113], v9 offset:12288
  ds_read_b64_tr_b16 v[114:115], v9 offset:13312
  ds_read_b64_tr_b16 v[116:117], v9 offset:16384
  ds_read_b64_tr_b16 v[118:119], v9 offset:17408
  s_waitcnt lgkmcnt(0)
  v_mfma_f32_16x16x32_bf16 v[140:143], v[100:103], v[92:95], v[140:143]
  v_mfma_f32_16x16x32_bf16 v[144:147], v[104:107], v[92:95], v[144:147]
  v_mfma_f32_16x16x32_bf16 v[148:151], v[108:111], v[92:95], v[148:151]
  v_mfma_f32_16x16x32_bf16 v[152:155], v[112:115], v[92:95], v[152:155]
  v_mfma_f32_16x16x32_bf16 v[156:159], v[116:119], v[92:95], v[156:159]
  s_waitcnt vmcnt(10)
  s_barrier
  ds_read_b64_tr_b16 v[120:121], v9 offset:20480
  ds_read_b64_tr_b16 v[122:123], v9 offset:21504
  ds_read_b64_tr_b16 v[124:125], v9 offset:24576
  ds_read_b64_tr_b16 v[126:127], v9 offset:25600
  ds_read_b64_tr_b16 v[128:129], v9 offset:28672
  ds_read_b64_tr_b16 v[130:131], v9 offset:29696
  ds_read_b64_tr_b16 v[132:133], v9 offset:32768
  ds_read_b64_tr_b16 v[134:135], v9 offset:33792
  ds_read_b64_tr_b16 v[136:137], v9 offset:36864
  ds_read_b64_tr_b16 v[138:139], v9 offset:37888
  s_waitcnt lgkmcnt(0)
  v_mfma_f32_16x16x32_bf16 v[160:163], v[120:123], v[92:95], v[160:163]
  v_mfma_f32_16x16x32_bf16 v[164:167], v[124:127], v[92:95], v[164:167]
  v_mfma_f32_16x16x32_bf16 v[168:171], v[128:131], v[92:95], v[168:171]
  v_mfma_f32_16x16x32_bf16 v[172:175], v[132:135], v[92:95], v[172:175]
  v_mfma_f32_16x16x32_bf16 v[176:179], v[136:139], v[92:95], v[176:179]
  s_waitcnt vmcnt(5)
  s_barrier
  ds_read_b64_tr_b16 v[100:101], v9 offset:40960
  ds_read_b64_tr_b16 v[102:103], v9 offset:41984
  ds_read_b64_tr_b16 v[104:105], v9 offset:45056
  ds_read_b64_tr_b16 v[106:107], v9 offset:46080
  ds_read_b64_tr_b16 v[108:109], v9 offset:49152
  ds_read_b64_tr_b16 v[110:111], v9 offset:50176
  ds_read_b64_tr_b16 v[112:113], v9 offset:53248
  ds_read_b64_tr_b16 v[114:115], v9 offset:54272
  ds_read_b64_tr_b16 v[116:117], v9 offset:57344
  ds_read_b64_tr_b16 v[118:119], v9 offset:58368
  s_waitcnt lgkmcnt(0)
  v_mfma_f32_16x16x32_bf16 v[140:143], v[100:103], v[96:99], v[140:143]
  v_mfma_f32_16x16x32_bf16 v[144:147], v[104:107], v[96:99], v[144:147]
  v_mfma_f32_16x16x32_bf16 v[148:151], v[108:111], v[96:99], v[148:151]
  v_mfma_f32_16x16x32_bf16 v[152:155], v[112:115], v[96:99], v[152:155]
  v_mfma_f32_16x16x32_bf16 v[156:159], v[116:119], v[96:99], v[156:159]
  s_waitcnt vmcnt(0)
  s_barrier
  ds_read_b64_tr_b16 v[120:121], v9 offset:61440
  ds_read_b64_tr_b16 v[122:123], v9 offset:62464
  ds_read_b64_tr_b16 v[124:125], v10 offset:0
  ds_read_b64_tr_b16 v[126:127], v10 offset:1024
  ds_read_b64_tr_b16 v[128:129], v10 offset:4096
  ds_read_b64_tr_b16 v[130:131], v10 offset:5120
  ds_read_b64_tr_b16 v[132:133], v10 offset:8192
  ds_read_b64_tr_b16 v[134:135], v10 offset:9216
  ds_read_b64_tr_b16 v[136:137], v10 offset:12288
  ds_read_b64_tr_b16 v[138:139], v10 offset:13312
  s_waitcnt lgkmcnt(0)
  v_mfma_f32_16x16x32_bf16 v[160:163], v[120:123], v[96:99], v[160:163]
  v_mfma_f32_16x16x32_bf16 v[164:167], v[124:127], v[96:99], v[164:167]
  v_mfma_f32_16x16x32_bf16 v[168:171], v[128:131], v[96:99], v[168:171]
  v_mfma_f32_16x16x32_bf16 v[172:175], v[132:135], v[96:99], v[172:175]
  v_mfma_f32_16x16x32_bf16 v[176:179], v[136:139], v[96:99], v[176:179]
  s_barrier
  v_cvt_pk_bf16_f32 v140, v140, v141
  v_cvt_pk_bf16_f32 v141, v142, v143
  buffer_store_dwordx2 v[140:141], v12, s[12:15], 0 offen offset:0
  v_cvt_pk_bf16_f32 v144, v144, v145
  v_cvt_pk_bf16_f32 v145, v146, v147
  buffer_store_dwordx2 v[144:145], v12, s[12:15], 0 offen offset:128
  v_cvt_pk_bf16_f32 v148, v148, v149
  v_cvt_pk_bf16_f32 v149, v150, v151
  buffer_store_dwordx2 v[148:149], v12, s[12:15], 0 offen offset:256
  v_cvt_pk_bf16_f32 v152, v152, v153
  v_cvt_pk_bf16_f32 v153, v154, v155
  buffer_store_dwordx2 v[152:153], v12, s[12:15], 0 offen offset:384
  v_cvt_pk_bf16_f32 v156, v156, v157
  v_cvt_pk_bf16_f32 v157, v158, v159
  buffer_store_dwordx2 v[156:157], v12, s[12:15], 0 offen offset:512
  v_cvt_pk_bf16_f32 v160, v160, v161
  v_cvt_pk_bf16_f32 v161, v162, v163
  buffer_store_dwordx2 v[160:161], v12, s[12:15], 0 offen offset:640
  v_cvt_pk_bf16_f32 v164, v164, v165
  v_cvt_pk_bf16_f32 v165, v166, v167
  buffer_store_dwordx2 v[164:165], v12, s[12:15], 0 offen offset:768
  v_cvt_pk_bf16_f32 v168, v168, v169
  v_cvt_pk_bf16_f32 v169, v170, v171
  buffer_store_dwordx2 v[168:169], v12, s[12:15], 0 offen offset:896
  v_cvt_pk_bf16_f32 v172, v172, v173
  v_cvt_pk_bf16_f32 v173, v174, v175
  buffer_store_dwordx2 v[172:173], v12, s[12:15], 0 offen offset:1024
  v_cvt_pk_bf16_f32 v176, v176, v177
  v_cvt_pk_bf16_f32 v177, v178, v179
  buffer_store_dwordx2 v[176:177], v12, s[12:15], 0 offen offset:1152
  s_endpgm
L_recur:
  s_cmp_lt_u32 s44, 8
  s_cbranch_scc1 L_score
  s_cmp_lt_u32 s44, 16
  s_cbranch_scc1 L_value
  s_cmp_lt_u32 s44, 28
  s_cbranch_scc1 rc_nowarm
  s_lshl_b32 s46, s44, 2
  s_add_u32 s46, s46, s43
  s_lshl_b32 s46, s46, 2
  s_add_u32 s46, s46, s42
  s_sub_u32 s46, s46, 448
  s_lshl_b32 s46, s46, 13
  v_lshlrev_b32 v1, 7, v0
  s_add_u32 s47, s46, 0
  buffer_load_dword v250, v1, s[12:15], s47 offen
  s_add_u32 s47, s46, 524288
  buffer_load_dword v250, v1, s[12:15], s47 offen
  s_add_u32 s47, s46, 1048576
  buffer_load_dword v250, v1, s[12:15], s47 offen
  s_add_u32 s47, s46, 1572864
  buffer_load_dword v250, v1, s[12:15], s47 offen
  s_add_u32 s47, s46, 2097152
  buffer_load_dword v250, v1, s[12:15], s47 offen
rc_nowarm:
  s_mov_b32 s50, 0
ss_15:
  v_and_b32 v3, 3, v0
  v_lshlrev_b32 v3, 2, v3
  global_load_dword v2, v3, s[38:39] sc1
  s_add_u32 s50, s50, 1
  s_cmp_gt_u32 s50, 131072
  s_cbranch_scc1 L_fail
  s_waitcnt vmcnt(0)
ss_15_in:
  v_readlane_b32 s46, v2, 0
  v_readlane_b32 s47, v2, 0
  v_readlane_b32 s48, v2, 0
  s_nop 0
  s_min_u32 s47, s47, s48
  s_cmp_lg_u32 s46, 0
  s_cselect_b32 s48, 7, 0
  s_add_u32 s46, s46, s2
  s_xor_b32 s49, s46, s43
  s_and_b32 s49, s49, s48
  s_cbranch_scc1 L_reroll
  s_cmp_lg_u32 s47, 0
  s_cbranch_scc1 ss_ok_16
  s_sleep 6
  s_branch ss_15
ss_ok_16:
  s_cmp_lt_u32 s44, 26
  s_cbranch_scc1 L_owner
  s_branch L_xowner
L_score:
  s_mov_b32 s4, s26
  s_mov_b32 s5, s27
  s_mov_b32 s6, 7864320
  s_mov_b32 s7, 0x20000
  s_mov_b32 s12, s28
  s_mov_b32 s13, s29
  s_mov_b32 s14, 7864320
  s_mov_b32 s15, 0x20000
  v_lshrrev_b32 v136, 3, v0
  v_lshrrev_b32 v137, 2, v136
  v_lshlrev_b32 v137, 3, v137
  v_and_b32 v64, 3, v136
  v_add_u32 v64, v64, v137
  s_and_b32 s46, s42, 1
  s_lshl_b32 s46, s46, 2
  s_lshr_b32 s47, s42, 1
  s_lshl_b32 s47, s47, 4
  s_add_u32 s46, s46, s47
  v_add_u32 v64, s46, v64
  v_mul_u32_u24 v64, 12288, v64
  v_lshrrev_b32 v136, 1, v136
  v_bfe_u32 v137, v0, 1, 2
  v_xor_b32 v136, v136, v137
  v_lshlrev_b32 v136, 5, v136
  v_and_b32 v137, 1, v0
  v_lshlrev_b32 v137, 4, v137
  v_add3_u32 v64, v64, v136, v137
  v_lshrrev_b32 v136, 5, v0
  v_lshlrev_b32 v65, 11, v136
  v_bfe_u32 v136, v0, 2, 3
  v_lshl_add_u32 v65, v136, 7, v65
  v_lshrrev_b32 v136, 1, v136
  v_xor_b32 v136, s42, v136
  v_lshl_add_u32 v65, v136, 5, v65
  v_and_b32 v136, 3, v0
  v_lshl_add_u32 v65, v136, 3, v65
  v_add_u32 v66, 0x10000, v65
  v_add_u32 v67, 0x20000, v65
  v_lshlrev_b32 v1, 4, v0
  v_add_u32 v2, s51, v1
  v_add_u32 v3, 0x10000, v2
  s_mul_i32 s62, s45, 384
  s_mov_b32 s24, 4096
  s_mov_b32 s25, 49152
  s_add_u32 m0, s51, 73728
  s_add_u32 s46, s62, 786432
  buffer_load_dwordx4 v64, s[12:15], s46 offen  lds
  s_add_u32 m0, s51, 77824
  s_add_u32 s46, s62, 1179648
  buffer_load_dwordx4 v64, s[12:15], s46 offen  lds
  s_add_u32 m0, s51, 81920
  s_add_u32 s46, s62, 786560
  buffer_load_dwordx4 v64, s[12:15], s46 offen  lds
  s_add_u32 m0, s51, 86016
  s_add_u32 s46, s62, 1179776
  buffer_load_dwordx4 v64, s[12:15], s46 offen  lds
  s_add_u32 m0, s51, 90112
  s_add_u32 s46, s62, 786688
  buffer_load_dwordx4 v64, s[12:15], s46 offen  lds
  s_add_u32 m0, s51, 94208
  s_add_u32 s46, s62, 1179904
  buffer_load_dwordx4 v64, s[12:15], s46 offen  lds
  s_add_u32 m0, s51, 98304
  s_add_u32 s46, s62, 1572864
  buffer_load_dwordx4 v64, s[12:15], s46 offen  lds
  s_add_u32 m0, s51, 102400
  s_add_u32 s46, s62, 1966080
  buffer_load_dwordx4 v64, s[12:15], s46 offen  lds
  s_add_u32 m0, s51, 106496
  s_add_u32 s46, s62, 1572992
  buffer_load_dwordx4 v64, s[12:15], s46 offen  lds
  s_add_u32 m0, s51, 110592
  s_add_u32 s46, s62, 1966208
  buffer_load_dwordx4 v64, s[12:15], s46 offen  lds
  s_add_u32 m0, s51, 114688
  s_add_u32 s46, s62, 1573120
  buffer_load_dwordx4 v64, s[12:15], s46 offen  lds
  s_add_u32 m0, s51, 118784
  s_add_u32 s46, s62, 1966336
  buffer_load_dwordx4 v64, s[12:15], s46 offen  lds
  s_add_u32 m0, s51, 122880
  s_add_u32 s46, s62, 2359296
  buffer_load_dwordx4 v64, s[12:15], s46 offen  lds
  s_add_u32 m0, s51, 126976
  s_add_u32 s46, s62, 2752512
  buffer_load_dwordx4 v64, s[12:15], s46 offen  lds
  s_add_u32 m0, s51, 131072
  s_add_u32 s46, s62, 2359424
  buffer_load_dwordx4 v64, s[12:15], s46 offen  lds
  s_add_u32 m0, s51, 135168
  s_add_u32 s46, s62, 2752640
  buffer_load_dwordx4 v64, s[12:15], s46 offen  lds
  s_add_u32 m0, s51, 139264
  s_add_u32 s46, s62, 2359552
  buffer_load_dwordx4 v64, s[12:15], s46 offen  lds
  s_add_u32 m0, s51, 143360
  s_add_u32 s46, s62, 2752768
  buffer_load_dwordx4 v64, s[12:15], s46 offen  lds
  s_add_u32 m0, s51, 0
  s_add_u32 s46, s62, 3145728
  buffer_load_dwordx4 v64, s[12:15], s46 offen  lds
  s_add_u32 m0, s51, 4096
  s_add_u32 s46, s62, 3538944
  buffer_load_dwordx4 v64, s[12:15], s46 offen  lds
  s_add_u32 m0, s51, 8192
  s_add_u32 s46, s62, 3145856
  buffer_load_dwordx4 v64, s[12:15], s46 offen  lds
  s_add_u32 m0, s51, 12288
  s_add_u32 s46, s62, 3539072
  buffer_load_dwordx4 v64, s[12:15], s46 offen  lds
  s_add_u32 m0, s51, 16384
  s_add_u32 s46, s62, 3145984
  buffer_load_dwordx4 v64, s[12:15], s46 offen  lds
  s_add_u32 m0, s51, 20480
  s_add_u32 s46, s62, 3539200
  buffer_load_dwordx4 v64, s[12:15], s46 offen  lds
  s_add_u32 m0, s51, 24576
  s_add_u32 s46, s62, 4718592
  buffer_load_dwordx4 v64, s[12:15], s46 offen  lds
  s_add_u32 m0, s51, 28672
  s_add_u32 s46, s62, 5111808
  buffer_load_dwordx4 v64, s[12:15], s46 offen  lds
  s_add_u32 m0, s51, 32768
  s_add_u32 s46, s62, 4718720
  buffer_load_dwordx4 v64, s[12:15], s46 offen  lds
  s_add_u32 m0, s51, 36864
  s_add_u32 s46, s62, 5111936
  buffer_load_dwordx4 v64, s[12:15], s46 offen  lds
  s_add_u32 m0, s51, 40960
  s_add_u32 s46, s62, 4718848
  buffer_load_dwordx4 v64, s[12:15], s46 offen  lds
  s_add_u32 m0, s51, 45056
  s_add_u32 s46, s62, 5112064
  buffer_load_dwordx4 v64, s[12:15], s46 offen  lds
  s_waitcnt vmcnt(24)
  s_barrier
  s_add_u32 m0, s51, 49152
  s_add_u32 s46, s62, 5505024
  buffer_load_dwordx4 v64, s[12:15], s46 offen  lds
  s_add_u32 m0, s51, 53248
  s_add_u32 s46, s62, 5898240
  buffer_load_dwordx4 v64, s[12:15], s46 offen  lds
  s_add_u32 m0, s51, 57344
  s_add_u32 s46, s62, 5505152
  buffer_load_dwordx4 v64, s[12:15], s46 offen  lds
  s_add_u32 m0, s51, 61440
  s_add_u32 s46, s62, 5898368
  buffer_load_dwordx4 v64, s[12:15], s46 offen  lds
  s_add_u32 m0, s51, 65536
  s_add_u32 s46, s62, 5505280
  buffer_load_dwordx4 v64, s[12:15], s46 offen  lds
  s_add_u32 m0, s51, 69632
  s_add_u32 s46, s62, 5898496
  buffer_load_dwordx4 v64, s[12:15], s46 offen  lds
  ds_read_b64_tr_b16 a[0:1], v66 offset:8192
  ds_read_b64_tr_b16 a[2:3], v66 offset:9216
  ds_read_b64_tr_b16 a[4:5], v66 offset:12288
  ds_read_b64_tr_b16 a[6:7], v66 offset:13312
  ds_read_b64_tr_b16 a[8:9], v66 offset:16384
  ds_read_b64_tr_b16 a[10:11], v66 offset:17408
  ds_read_b64_tr_b16 a[12:13], v66 offset:20480
  ds_read_b64_tr_b16 a[14:15], v66 offset:21504
  ds_read_b64_tr_b16 a[16:17], v66 offset:24576
  ds_read_b64_tr_b16 a[18:19], v66 offset:25600
  ds_read_b64_tr_b16 a[20:21], v66 offset:28672
  ds_read_b64_tr_b16 a[22:23], v66 offset:29696
  s_waitcnt lgkmcnt(0)
  s_waitcnt vmcnt(24)
  s_barrier
  s_add_u32 m0, s51, 73728
  s_add_u32 s46, s62, 6291456
  buffer_load_dwordx4 v64, s[12:15], s46 offen  lds
  s_add_u32 m0, s51, 77824
  s_add_u32 s46, s62, 6684672
  buffer_load_dwordx4 v64, s[12:15], s46 offen  lds
  s_add_u32 m0, s51, 81920
  s_add_u32 s46, s62, 6291584
  buffer_load_dwordx4 v64, s[12:15], s46 offen  lds
  s_add_u32 m0, s51, 86016
  s_add_u32 s46, s62, 6684800
  buffer_load_dwordx4 v64, s[12:15], s46 offen  lds
  s_add_u32 m0, s51, 90112
  s_add_u32 s46, s62, 6291712
  buffer_load_dwordx4 v64, s[12:15], s46 offen  lds
  s_add_u32 m0, s51, 94208
  s_add_u32 s46, s62, 6684928
  buffer_load_dwordx4 v64, s[12:15], s46 offen  lds
  ds_read_b64_tr_b16 a[24:25], v66 offset:32768
  ds_read_b64_tr_b16 a[26:27], v66 offset:33792
  ds_read_b64_tr_b16 a[28:29], v66 offset:36864
  ds_read_b64_tr_b16 a[30:31], v66 offset:37888
  ds_read_b64_tr_b16 a[32:33], v66 offset:40960
  ds_read_b64_tr_b16 a[34:35], v66 offset:41984
  ds_read_b64_tr_b16 a[36:37], v66 offset:45056
  ds_read_b64_tr_b16 a[38:39], v66 offset:46080
  ds_read_b64_tr_b16 a[40:41], v66 offset:49152
  ds_read_b64_tr_b16 a[42:43], v66 offset:50176
  ds_read_b64_tr_b16 a[44:45], v66 offset:53248
  ds_read_b64_tr_b16 a[46:47], v66 offset:54272
  s_waitcnt lgkmcnt(0)
  s_waitcnt vmcnt(24)
  s_barrier
  s_add_u32 m0, s51, 98304
  s_add_u32 s46, s62, 7077888
  buffer_load_dwordx4 v64, s[12:15], s46 offen  lds
  s_add_u32 m0, s51, 102400
  s_add_u32 s46, s62, 7471104
  buffer_load_dwordx4 v64, s[12:15], s46 offen  lds
  s_add_u32 m0, s51, 106496
  s_add_u32 s46, s62, 7078016
  buffer_load_dwordx4 v64, s[12:15], s46 offen  lds
  s_add_u32 m0, s51, 110592
  s_add_u32 s46, s62, 7471232
  buffer_load_dwordx4 v64, s[12:15], s46 offen  lds
  s_add_u32 m0, s51, 114688
  s_add_u32 s46, s62, 7078144
  buffer_load_dwordx4 v64, s[12:15], s46 offen  lds
  s_add_u32 m0, s51, 118784
  s_add_u32 s46, s62, 7471360
  buffer_load_dwordx4 v64, s[12:15], s46 offen  lds
  ds_read_b64_tr_b16 a[48:49], v66 offset:57344
  ds_read_b64_tr_b16 a[50:51], v66 offset:58368
  ds_read_b64_tr_b16 a[52:53], v66 offset:61440
  ds_read_b64_tr_b16 a[54:55], v66 offset:62464
  ds_read_b64_tr_b16 a[56:57], v67 offset:0
  ds_read_b64_tr_b16 a[58:59], v67 offset:1024
  ds_read_b64_tr_b16 a[60:61], v67 offset:4096
  ds_read_b64_tr_b16 a[62:63], v67 offset:5120
  ds_read_b64_tr_b16 a[64:65], v67 offset:8192
  ds_read_b64_tr_b16 a[66:67], v67 offset:9216
  ds_read_b64_tr_b16 a[68:69], v67 offset:12288
  ds_read_b64_tr_b16 a[70:71], v67 offset:13312
  s_waitcnt lgkmcnt(0)
  s_waitcnt vmcnt(24)
  s_barrier
  s_add_u32 m0, s51, 122880
  s_add_u32 s46, s62, 0
  buffer_load_dwordx4 v64, s[4:7], s46 offen  lds
  s_add_u32 m0, s51, 126976
  s_add_u32 s46, s62, 393216
  buffer_load_dwordx4 v64, s[4:7], s46 offen  lds
  s_add_u32 m0, s51, 131072
  s_add_u32 s46, s62, 128
  buffer_load_dwordx4 v64, s[4:7], s46 offen  lds
  s_add_u32 m0, s51, 135168
  s_add_u32 s46, s62, 393344
  buffer_load_dwordx4 v64, s[4:7], s46 offen  lds
  s_add_u32 m0, s51, 139264
  s_add_u32 s46, s62, 256
  buffer_load_dwordx4 v64, s[4:7], s46 offen  lds
  s_add_u32 m0, s51, 143360
  s_add_u32 s46, s62, 393472
  buffer_load_dwordx4 v64, s[4:7], s46 offen  lds
  ds_read_b64_tr_b16 a[72:73], v65 offset:0
  ds_read_b64_tr_b16 a[74:75], v65 offset:1024
  ds_read_b64_tr_b16 a[76:77], v65 offset:4096
  ds_read_b64_tr_b16 a[78:79], v65 offset:5120
  ds_read_b64_tr_b16 a[80:81], v65 offset:8192
  ds_read_b64_tr_b16 a[82:83], v65 offset:9216
  ds_read_b64_tr_b16 a[84:85], v65 offset:12288
  ds_read_b64_tr_b16 a[86:87], v65 offset:13312
  ds_read_b64_tr_b16 a[88:89], v65 offset:16384
  ds_read_b64_tr_b16 a[90:91], v65 offset:17408
  ds_read_b64_tr_b16 a[92:93], v65 offset:20480
  ds_read_b64_tr_b16 a[94:95], v65 offset:21504
  s_waitcnt lgkmcnt(0)
  s_waitcnt vmcnt(24)
  s_barrier
  s_add_u32 m0, s51, 0
  s_add_u32 s46, s62, 786432
  buffer_load_dwordx4 v64, s[4:7], s46 offen  lds
  s_add_u32 m0, s51, 4096
  s_add_u32 s46, s62, 1179648
  buffer_load_dwordx4 v64, s[4:7], s46 offen  lds
  s_add_u32 m0, s51, 8192
  s_add_u32 s46, s62, 786560
  buffer_load_dwordx4 v64, s[4:7], s46 offen  lds
  s_add_u32 m0, s51, 12288
  s_add_u32 s46, s62, 1179776
  buffer_load_dwordx4 v64, s[4:7], s46 offen  lds
  s_add_u32 m0, s51, 16384
  s_add_u32 s46, s62, 786688
  buffer_load_dwordx4 v64, s[4:7], s46 offen  lds
  s_add_u32 m0, s51, 20480
  s_add_u32 s46, s62, 1179904
  buffer_load_dwordx4 v64, s[4:7], s46 offen  lds
  ds_read_b64_tr_b16 a[96:97], v65 offset:24576
  ds_read_b64_tr_b16 a[98:99], v65 offset:25600
  ds_read_b64_tr_b16 a[100:101], v65 offset:28672
  ds_read_b64_tr_b16 a[102:103], v65 offset:29696
  ds_read_b64_tr_b16 a[104:105], v65 offset:32768
  ds_read_b64_tr_b16 a[106:107], v65 offset:33792
  ds_read_b64_tr_b16 a[108:109], v65 offset:36864
  ds_read_b64_tr_b16 a[110:111], v65 offset:37888
  ds_read_b64_tr_b16 a[112:113], v65 offset:40960
  ds_read_b64_tr_b16 a[114:115], v65 offset:41984
  ds_read_b64_tr_b16 a[116:117], v65 offset:45056
  ds_read_b64_tr_b16 a[118:119], v65 offset:46080
  s_waitcnt lgkmcnt(0)
  s_waitcnt vmcnt(24)
  s_barrier
  s_add_u32 m0, s51, 24576
  s_add_u32 s46, s62, 1572864
  buffer_load_dwordx4 v64, s[4:7], s46 offen  lds
  s_add_u32 m0, s51, 28672
  s_add_u32 s46, s62, 1966080
  buffer_load_dwordx4 v64, s[4:7], s46 offen  lds
  s_add_u32 m0, s51, 32768
  s_add_u32 s46, s62, 1572992
  buffer_load_dwordx4 v64, s[4:7], s46 offen  lds
  s_add_u32 m0, s51, 36864
  s_add_u32 s46, s62, 1966208
  buffer_load_dwordx4 v64, s[4:7], s46 offen  lds
  s_add_u32 m0, s51, 40960
  s_add_u32 s46, s62, 1573120
  buffer_load_dwordx4 v64, s[4:7], s46 offen  lds
  s_add_u32 m0, s51, 45056
  s_add_u32 s46, s62, 1966336
  buffer_load_dwordx4 v64, s[4:7], s46 offen  lds
  ds_read_b64_tr_b16 a[120:121], v65 offset:49152
  ds_read_b64_tr_b16 a[122:123], v65 offset:50176
  ds_read_b64_tr_b16 a[124:125], v65 offset:53248
  ds_read_b64_tr_b16 a[126:127], v65 offset:54272
  ds_read_b64_tr_b16 a[128:129], v65 offset:57344
  ds_read_b64_tr_b16 a[130:131], v65 offset:58368
  ds_read_b64_tr_b16 a[132:133], v65 offset:61440
  ds_read_b64_tr_b16 a[134:135], v65 offset:62464
  ds_read_b64_tr_b16 a[136:137], v66 offset:0
  ds_read_b64_tr_b16 a[138:139], v66 offset:1024
  ds_read_b64_tr_b16 a[140:141], v66 offset:4096
  ds_read_b64_tr_b16 a[142:143], v66 offset:5120
  s_waitcnt lgkmcnt(0)
  s_waitcnt vmcnt(24)
  s_barrier
  s_add_u32 m0, s51, 49152
  s_add_u32 s46, s62, 3145728
  buffer_load_dwordx4 v64, s[4:7], s46 offen  lds
  s_add_u32 m0, s51, 53248
  s_add_u32 s46, s62, 3538944
  buffer_load_dwordx4 v64, s[4:7], s46 offen  lds
  s_add_u32 m0, s51, 57344
  s_add_u32 s46, s62, 3145856
  buffer_load_dwordx4 v64, s[4:7], s46 offen  lds
  s_add_u32 m0, s51, 61440
  s_add_u32 s46, s62, 3539072
  buffer_load_dwordx4 v64, s[4:7], s46 offen  lds
  s_add_u32 m0, s51, 65536
  s_add_u32 s46, s62, 3145984
  buffer_load_dwordx4 v64, s[4:7], s46 offen  lds
  s_add_u32 m0, s51, 69632
  s_add_u32 s46, s62, 3539200
  buffer_load_dwordx4 v64, s[4:7], s46 offen  lds
  ds_read_b64_tr_b16 a[144:145], v66 offset:8192
  ds_read_b64_tr_b16 a[146:147], v66 offset:9216
  ds_read_b64_tr_b16 a[148:149], v66 offset:12288
  ds_read_b64_tr_b16 a[150:151], v66 offset:13312
  ds_read_b64_tr_b16 a[152:153], v66 offset:16384
  ds_read_b64_tr_b16 a[154:155], v66 offset:17408
  ds_read_b64_tr_b16 a[156:157], v66 offset:20480
  ds_read_b64_tr_b16 a[158:159], v66 offset:21504
  ds_read_b64_tr_b16 a[160:161], v66 offset:24576
  ds_read_b64_tr_b16 a[162:163], v66 offset:25600
  ds_read_b64_tr_b16 a[164:165], v66 offset:28672
  ds_read_b64_tr_b16 a[166:167], v66 offset:29696
  s_waitcnt lgkmcnt(0)
  s_waitcnt vmcnt(24)
  s_barrier
  s_add_u32 m0, s51, 73728
  s_add_u32 s46, s62, 3932160
  buffer_load_dwordx4 v64, s[4:7], s46 offen  lds
  s_add_u32 m0, s51, 77824
  s_add_u32 s46, s62, 4325376
  buffer_load_dwordx4 v64, s[4:7], s46 offen  lds
  s_add_u32 m0, s51, 81920
  s_add_u32 s46, s62, 3932288
  buffer_load_dwordx4 v64, s[4:7], s46 offen  lds
  s_add_u32 m0, s51, 86016
  s_add_u32 s46, s62, 4325504
  buffer_load_dwordx4 v64, s[4:7], s46 offen  lds
  s_add_u32 m0, s51, 90112
  s_add_u32 s46, s62, 3932416
  buffer_load_dwordx4 v64, s[4:7], s46 offen  lds
  s_add_u32 m0, s51, 94208
  s_add_u32 s46, s62, 4325632
  buffer_load_dwordx4 v64, s[4:7], s46 offen  lds
  ds_read_b64_tr_b16 a[168:169], v66 offset:32768
  ds_read_b64_tr_b16 a[170:171], v66 offset:33792
  ds_read_b64_tr_b16 a[172:173], v66 offset:36864
  ds_read_b64_tr_b16 a[174:175], v66 offset:37888
  ds_read_b64_tr_b16 a[176:177], v66 offset:40960
  ds_read_b64_tr_b16 a[178:179], v66 offset:41984
  ds_read_b64_tr_b16 a[180:181], v66 offset:45056
  ds_read_b64_tr_b16 a[182:183], v66 offset:46080
  ds_read_b64_tr_b16 a[184:185], v66 offset:49152
  ds_read_b64_tr_b16 a[186:187], v66 offset:50176
  ds_read_b64_tr_b16 a[188:189], v66 offset:53248
  ds_read_b64_tr_b16 a[190:191], v66 offset:54272
  s_waitcnt lgkmcnt(0)
  s_waitcnt vmcnt(24)
  s_barrier
  s_add_u32 m0, s51, 98304
  s_add_u32 s46, s62, 5505024
  buffer_load_dwordx4 v64, s[4:7], s46 offen  lds
  s_add_u32 m0, s51, 102400
  s_add_u32 s46, s62, 5898240
  buffer_load_dwordx4 v64, s[4:7], s46 offen  lds
  s_add_u32 m0, s51, 106496
  s_add_u32 s46, s62, 5505152
  buffer_load_dwordx4 v64, s[4:7], s46 offen  lds
  s_add_u32 m0, s51, 110592
  s_add_u32 s46, s62, 5898368
  buffer_load_dwordx4 v64, s[4:7], s46 offen  lds
  s_add_u32 m0, s51, 114688
  s_add_u32 s46, s62, 5505280
  buffer_load_dwordx4 v64, s[4:7], s46 offen  lds
  s_add_u32 m0, s51, 118784
  s_add_u32 s46, s62, 5898496
  buffer_load_dwordx4 v64, s[4:7], s46 offen  lds
  ds_read_b64_tr_b16 a[192:193], v66 offset:57344
  ds_read_b64_tr_b16 a[194:195], v66 offset:58368
  ds_read_b64_tr_b16 a[196:197], v66 offset:61440
  ds_read_b64_tr_b16 a[198:199], v66 offset:62464
  ds_read_b64_tr_b16 a[200:201], v67 offset:0
  ds_read_b64_tr_b16 a[202:203], v67 offset:1024
  ds_read_b64_tr_b16 a[204:205], v67 offset:4096
  ds_read_b64_tr_b16 a[206:207], v67 offset:5120
  ds_read_b64_tr_b16 a[208:209], v67 offset:8192
  ds_read_b64_tr_b16 a[210:211], v67 offset:9216
  ds_read_b64_tr_b16 a[212:213], v67 offset:12288
  ds_read_b64_tr_b16 a[214:215], v67 offset:13312
  s_waitcnt lgkmcnt(0)
  s_waitcnt vmcnt(24)
  s_barrier
  v_and_b32 v137, 3, v0
  v_lshlrev_b32 v137, 2, v137
  global_load_dword v136, v137, s[38:39] sc1
  s_add_u32 m0, s51, 122880
  s_add_u32 s46, s62, 6291456
  buffer_load_dwordx4 v64, s[4:7], s46 offen  lds
  s_add_u32 m0, s51, 126976
  s_add_u32 s46, s62, 6684672
  buffer_load_dwordx4 v64, s[4:7], s46 offen  lds
  s_add_u32 m0, s51, 131072
  s_add_u32 s46, s62, 6291584
  buffer_load_dwordx4 v64, s[4:7], s46 offen  lds
  s_add_u32 m0, s51, 135168
  s_add_u32 s46, s62, 6684800
  buffer_load_dwordx4 v64, s[4:7], s46 offen  lds
  s_add_u32 m0, s51, 139264
  s_add_u32 s46, s62, 6291712
  buffer_load_dwordx4 v64, s[4:7], s46 offen  lds
  s_add_u32 m0, s51, 143360
  s_add_u32 s46, s62, 6684928
  buffer_load_dwordx4 v64, s[4:7], s46 offen  lds
  ds_read_b64_tr_b16 a[216:217], v65 offset:0
  ds_read_b64_tr_b16 a[218:219], v65 offset:1024
  ds_read_b64_tr_b16 a[220:221], v65 offset:4096
  ds_read_b64_tr_b16 a[222:223], v65 offset:5120
  ds_read_b64_tr_b16 a[224:225], v65 offset:8192
  ds_read_b64_tr_b16 a[226:227], v65 offset:9216
  ds_read_b64_tr_b16 a[228:229], v65 offset:12288
  ds_read_b64_tr_b16 a[230:231], v65 offset:13312
  ds_read_b64_tr_b16 a[232:233], v65 offset:16384
  ds_read_b64_tr_b16 a[234:235], v65 offset:17408
  ds_read_b64_tr_b16 a[236:237], v65 offset:20480
  ds_read_b64_tr_b16 a[238:239], v65 offset:21504
  s_waitcnt lgkmcnt(0)
  s_waitcnt vmcnt(25)
  s_barrier
  s_add_u32 m0, s51, 0
  s_add_u32 s46, s62, 0
  buffer_load_dwordx4 v64, s[12:15], s46 offen  lds
  s_add_u32 m0, s51, 4096
  s_add_u32 s46, s62, 393216
  buffer_load_dwordx4 v64, s[12:15], s46 offen  lds
  s_add_u32 m0, s51, 8192
  s_add_u32 s46, s62, 128
  buffer_load_dwordx4 v64, s[12:15], s46 offen  lds
  s_add_u32 m0, s51, 12288
  s_add_u32 s46, s62, 393344
  buffer_load_dwordx4 v64, s[12:15], s46 offen  lds
  s_add_u32 m0, s51, 16384
  s_add_u32 s46, s62, 256
  buffer_load_dwordx4 v64, s[12:15], s46 offen  lds
  s_add_u32 m0, s51, 20480
  s_add_u32 s46, s62, 393472
  buffer_load_dwordx4 v64, s[12:15], s46 offen  lds
  ds_read_b64_tr_b16 a[240:241], v65 offset:24576
  ds_read_b64_tr_b16 a[242:243], v65 offset:25600
  ds_read_b64_tr_b16 a[244:245], v65 offset:28672
  ds_read_b64_tr_b16 a[246:247], v65 offset:29696
  ds_read_b64_tr_b16 a[248:249], v65 offset:32768
  ds_read_b64_tr_b16 a[250:251], v65 offset:33792
  ds_read_b64_tr_b16 a[252:253], v65 offset:36864
  ds_read_b64_tr_b16 a[254:255], v65 offset:37888
  ds_read_b64_tr_b16 v[152:153], v65 offset:40960
  ds_read_b64_tr_b16 v[154:155], v65 offset:41984
  ds_read_b64_tr_b16 v[156:157], v65 offset:45056
  ds_read_b64_tr_b16 v[158:159], v65 offset:46080
  s_waitcnt lgkmcnt(0)
  s_waitcnt vmcnt(25)
  s_barrier
  s_add_u32 m0, s51, 24576
  s_add_u32 s46, s62, 3932160
  buffer_load_dwordx4 v64, s[12:15], s46 offen  lds
  s_add_u32 m0, s51, 28672
  s_add_u32 s46, s62, 4325376
  buffer_load_dwordx4 v64, s[12:15], s46 offen  lds
  s_add_u32 m0, s51, 32768
  s_add_u32 s46, s62, 3932288
  buffer_load_dwordx4 v64, s[12:15], s46 offen  lds
  s_add_u32 m0, s51, 36864
  s_add_u32 s46, s62, 4325504
  buffer_load_dwordx4 v64, s[12:15], s46 offen  lds
  s_add_u32 m0, s51, 40960
  s_add_u32 s46, s62, 3932416
  buffer_load_dwordx4 v64, s[12:15], s46 offen  lds
  s_add_u32 m0, s51, 45056
  s_add_u32 s46, s62, 4325632
  buffer_load_dwordx4 v64, s[12:15], s46 offen  lds
  ds_read_b64_tr_b16 v[160:161], v65 offset:49152
  ds_read_b64_tr_b16 v[162:163], v65 offset:50176
  ds_read_b64_tr_b16 v[164:165], v65 offset:53248
  ds_read_b64_tr_b16 v[166:167], v65 offset:54272
  ds_read_b64_tr_b16 v[168:169], v65 offset:57344
  ds_read_b64_tr_b16 v[170:171], v65 offset:58368
  ds_read_b64_tr_b16 v[172:173], v65 offset:61440
  ds_read_b64_tr_b16 v[174:175], v65 offset:62464
  ds_read_b64_tr_b16 v[176:177], v66 offset:0
  ds_read_b64_tr_b16 v[178:179], v66 offset:1024
  ds_read_b64_tr_b16 v[180:181], v66 offset:4096
  ds_read_b64_tr_b16 v[182:183], v66 offset:5120
  s_waitcnt lgkmcnt(0)
  s_waitcnt vmcnt(25)
  s_barrier
  s_add_u32 m0, s51, 49152
  s_add_u32 s46, s62, 2359296
  buffer_load_dwordx4 v64, s[4:7], s46 offen  lds
  s_add_u32 m0, s51, 53248
  s_add_u32 s46, s62, 2752512
  buffer_load_dwordx4 v64, s[4:7], s46 offen  lds
  s_add_u32 m0, s51, 57344
  s_add_u32 s46, s62, 2359424
  buffer_load_dwordx4 v64, s[4:7], s46 offen  lds
  s_add_u32 m0, s51, 61440
  s_add_u32 s46, s62, 2752640
  buffer_load_dwordx4 v64, s[4:7], s46 offen  lds
  s_add_u32 m0, s51, 65536
  s_add_u32 s46, s62, 2359552
  buffer_load_dwordx4 v64, s[4:7], s46 offen  lds
  s_add_u32 m0, s51, 69632
  s_add_u32 s46, s62, 2752768
  buffer_load_dwordx4 v64, s[4:7], s46 offen  lds
  ds_read_b64_tr_b16 v[184:185], v66 offset:8192
  ds_read_b64_tr_b16 v[186:187], v66 offset:9216
  ds_read_b64_tr_b16 v[188:189], v66 offset:12288
  ds_read_b64_tr_b16 v[190:191], v66 offset:13312
  ds_read_b64_tr_b16 v[192:193], v66 offset:16384
  ds_read_b64_tr_b16 v[194:195], v66 offset:17408
  ds_read_b64_tr_b16 v[196:197], v66 offset:20480
  ds_read_b64_tr_b16 v[198:199], v66 offset:21504
  ds_read_b64_tr_b16 v[200:201], v66 offset:24576
  ds_read_b64_tr_b16 v[202:203], v66 offset:25600
  ds_read_b64_tr_b16 v[204:205], v66 offset:28672
  ds_read_b64_tr_b16 v[206:207], v66 offset:29696
  s_waitcnt lgkmcnt(0)
  s_waitcnt vmcnt(25)
  s_barrier
  s_add_u32 m0, s51, 73728
  s_add_u32 s46, s62, 4718592
  buffer_load_dwordx4 v64, s[4:7], s46 offen  lds
  s_add_u32 m0, s51, 77824
  s_add_u32 s46, s62, 5111808
  buffer_load_dwordx4 v64, s[4:7], s46 offen  lds
  s_add_u32 m0, s51, 81920
  s_add_u32 s46, s62, 4718720
  buffer_load_dwordx4 v64, s[4:7], s46 offen  lds
  s_add_u32 m0, s51, 86016
  s_add_u32 s46, s62, 5111936
  buffer_load_dwordx4 v64, s[4:7], s46 offen  lds
  s_add_u32 m0, s51, 90112
  s_add_u32 s46, s62, 4718848
  buffer_load_dwordx4 v64, s[4:7], s46 offen  lds
  s_add_u32 m0, s51, 94208
  s_add_u32 s46, s62, 5112064
  buffer_load_dwordx4 v64, s[4:7], s46 offen  lds
  ds_read_b64_tr_b16 v[208:209], v66 offset:32768
  ds_read_b64_tr_b16 v[210:211], v66 offset:33792
  ds_read_b64_tr_b16 v[212:213], v66 offset:36864
  ds_read_b64_tr_b16 v[214:215], v66 offset:37888
  ds_read_b64_tr_b16 v[216:217], v66 offset:40960
  ds_read_b64_tr_b16 v[218:219], v66 offset:41984
  ds_read_b64_tr_b16 v[220:221], v66 offset:45056
  ds_read_b64_tr_b16 v[222:223], v66 offset:46080
  ds_read_b64_tr_b16 v[224:225], v66 offset:49152
  ds_read_b64_tr_b16 v[226:227], v66 offset:50176
  ds_read_b64_tr_b16 v[228:229], v66 offset:53248
  ds_read_b64_tr_b16 v[230:231], v66 offset:54272
  s_waitcnt lgkmcnt(0)
  s_waitcnt vmcnt(24)
  s_barrier
  s_add_u32 m0, s51, 98304
  s_add_u32 s46, s62, 7077888
  buffer_load_dwordx4 v64, s[4:7], s46 offen  lds
  s_add_u32 m0, s51, 102400
  s_add_u32 s46, s62, 7471104
  buffer_load_dwordx4 v64, s[4:7], s46 offen  lds
  s_add_u32 m0, s51, 106496
  s_add_u32 s46, s62, 7078016
  buffer_load_dwordx4 v64, s[4:7], s46 offen  lds
  s_add_u32 m0, s51, 110592
  s_add_u32 s46, s62, 7471232
  buffer_load_dwordx4 v64, s[4:7], s46 offen  lds
  s_add_u32 m0, s51, 114688
  s_add_u32 s46, s62, 7078144
  buffer_load_dwordx4 v64, s[4:7], s46 offen  lds
  s_add_u32 m0, s51, 118784
  s_add_u32 s46, s62, 7471360
  buffer_load_dwordx4 v64, s[4:7], s46 offen  lds
  ds_read_b64_tr_b16 v[232:233], v66 offset:57344
  ds_read_b64_tr_b16 v[234:235], v66 offset:58368
  ds_read_b64_tr_b16 v[236:237], v66 offset:61440
  ds_read_b64_tr_b16 v[238:239], v66 offset:62464
  ds_read_b64_tr_b16 v[240:241], v67 offset:0
  ds_read_b64_tr_b16 v[242:243], v67 offset:1024
  ds_read_b64_tr_b16 v[244:245], v67 offset:4096
  ds_read_b64_tr_b16 v[246:247], v67 offset:5120
  ds_read_b64_tr_b16 v[248:249], v67 offset:8192
  ds_read_b64_tr_b16 v[250:251], v67 offset:9216
  ds_read_b64_tr_b16 v[252:253], v67 offset:12288
  ds_read_b64_tr_b16 v[254:255], v67 offset:13312
  s_waitcnt lgkmcnt(0)
  s_mov_b32 s50, 0
  s_branch ss_17_in
ss_17:
  v_and_b32 v137, 3, v0
  v_lshlrev_b32 v137, 2, v137
  global_load_dword v136, v137, s[38:39] sc1
  s_add_u32 s50, s50, 1
  s_cmp_gt_u32 s50, 131072
  s_cbranch_scc1 L_fail
  s_waitcnt vmcnt(0)
ss_17_in:
  v_readlane_b32 s46, v136, 0
  v_readlane_b32 s47, v136, 2
  v_readlane_b32 s48, v136, 1
  s_nop 0
  s_min_u32 s47, s47, s48
  s_cmp_lg_u32 s46, 0
  s_cselect_b32 s48, 7, 0
  s_add_u32 s46, s46, s2
  s_xor_b32 s49, s46, s43
  s_and_b32 s49, s49, s48
  s_cbranch_scc1 L_reroll
  s_cmp_lg_u32 s47, 0
  s_cbranch_scc1 ss_ok_18
  s_sleep 6
  s_branch ss_17
ss_ok_18:
  v_readlane_b32 s3, v136, 1
  s_nop 0
  s_and_b32 s3, s3, 0x2000
  s_lshr_b32 s46, s44, 4
  s_lshl_b32 s46, s46, 7
  s_lshl_b32 s47, s43, 4
  s_add_u32 s46, s46, s47
  s_and_b32 s47, s44, 15
  s_add_u32 s46, s46, s47
  s_lshl_b32 s46, s46, 7
  s_add_u32 s46, s46, s3
  s_add_u32 s46, s46, 13369344
  s_add_u32 s40, s8, s46
  s_addc_u32 s41, s9, 0
  s_sub_u32 s47, s44, 0
  s_lshl_b32 s46, s47, 11
  s_lshl_b32 s48, s43, 2
  s_add_u32 s46, s46, s48
  s_add_u32 s46, s46, s3
  s_add_u32 s46, s46, 13385728
  v_lshl_add_u32 v11, v0, 7, s46
  v_mov_b32 v136, 2146435072
  s_cmp_lt_u32 s47, 4
  s_cselect_b32 vcc_lo, 1023, 0
  s_mov_b32 vcc_hi, 0
  v_cndmask_b32 v11, v136, v11, vcc
  v_mov_b32 v7, 0x44444444
  v_mov_b32 v136, 0xeeeeeeee
  v_and_b32 v137, 2, v0
  v_cmp_ne_u32 vcc, 0, v137
  s_nop 1
  v_cndmask_b32 v7, v7, v136, vcc
  s_mov_b32 s68, 1037384597
  s_mov_b32 s70, 3494803967
  v_and_b32 v136, 15, v0
  v_lshrrev_b32 v138, 4, v0
  v_lshlrev_b32 v4, 4, v136
  v_lshl_add_u32 v4, v138, 2, v4
  s_lshl_b32 s46, s42, 8
  s_add_u32 s46, s46, 147456
  v_add_u32 v4, s46, v4
  v_lshlrev_b32 v5, 7, v138
  v_bfe_u32 v137, v0, 2, 2
  v_lshl_add_u32 v5, v137, 4, v5
  v_and_b32 v137, 1, v0
  v_lshl_add_u32 v5, v137, 3, v5
  v_add_u32 v5, 147456, v5
  v_add_u32 v13, 122880, v1
  v_add_u32 v149, 153600, v1
  v_bfe_u32 v140, v0, 1, 2
  v_lshl_add_u32 v140, v140, 2, v137
  v_bfe_u32 v137, v0, 3, 1
  v_lshl_add_u32 v140, v137, 1, v140
  v_cmp_eq_u32 s[18:19], 1, v137
  s_add_u32 s46, s3, 12582912
  s_lshr_b32 s47, s45, 4
  s_add_u32 s47, s47, 1
  s_lshl_b32 s47, s47, 14
  s_and_b32 s48, s45, 15
  s_lshl_b32 s48, s48, 9
  s_add_u32 s47, s47, s48
  s_add_u32 s47, s47, s46
  v_lshrrev_b32 v137, 1, v138
  v_and_b32 v139, 1, v138
  v_lshl_add_u32 v8, v137, 4, v140
  v_lshlrev_b32 v8, 4, v8
  v_lshl_add_u32 v8, v139, 3, v8
  v_add_u32 v8, s47, v8
  s_lshl_b32 s47, s45, 7
  s_and_b32 s48, s45, 1
  s_mul_i32 s48, s48, 120
  s_sub_u32 s47, s47, s48
  s_add_u32 s47, s47, s46
  s_add_u32 s47, s47, 51200
  v_lshlrev_b32 v9, 4, v140
  v_lshl_add_u32 v9, v139, 2, v9
  v_add_u32 v9, s47, v9
  v_lshl_add_u32 v9, v137, 30, v9
  v_lshlrev_b32 v14, 4, v136
  v_lshl_add_u32 v14, v139, 3, v14
  v_lshl_add_u32 v14, v137, 2, v14
  s_lshl_b32 s47, s45, 8
  s_add_u32 s47, s47, 65536
  v_add_u32 v14, s47, v14
  s_lshl_b32 s47, s42, 4
  v_add_u32 v136, s47, v136
  v_lshlrev_b32 v138, 2, v138
  v_sub_u32 v136, v136, v138
  v_cmp_gt_i32 s[72:73], 0, v136
  v_cmp_gt_i32 s[74:75], 1, v136
  v_cmp_gt_i32 s[76:77], 2, v136
  v_cmp_gt_i32 s[78:79], 3, v136
  v_cmp_gt_i32 s[80:81], 16, v136
  v_cmp_gt_i32 s[82:83], 17, v136
  v_cmp_gt_i32 s[84:85], 18, v136
  v_cmp_gt_i32 s[86:87], 19, v136
  s_lshl_b32 s46, s45, 7
  s_lshl_b32 s47, s42, 2
  s_add_u32 s47, s47, s46
  s_add_u32 s47, s47, 1069056
  v_mov_b32 v15, s47
  s_cmp_lg_u32 s42, 2
  s_cbranch_scc1 sc_fl
  v_and_b32 v15, 1, v0
  v_lshlrev_b32 v15, 12, v15
  s_add_u32 s46, s46, 1048576
  v_add_u32 v15, s46, v15
sc_fl:
  s_mov_b32 s23, s45
  s_lshl_b32 s20, s42, 24
  s_add_u32 s20, s20, s3
  s_add_u32 s20, s20, 31457280
  s_xor_b32 s20, s20, 0
  s_lshl_b32 s26, s42, 11
  s_lshl_b32 s46, s42, 24
  s_sub_u32 s26, s26, s46
  s_cmp_eq_u32 s42, 2
  s_cselect_b32 s26, 2012217344, s26
  s_lshl_b32 s21, s42, 12
  s_add_u32 s21, s21, 122880
  s_mov_b32 s22, 12288
  s_mul_i32 s64, s42, 81920
  s_add_u32 s64, s64, s3
  s_add_u32 s64, s64, 14680064
  s_lshr_b32 s27, s45, 3
  s_lshl_b32 s27, s27, 14
  s_and_b32 s46, s45, 7
  s_lshl_b32 s46, s46, 10
  s_add_u32 s27, s27, s46
  s_mov_b32 s61, 0
  s_mov_b32 s52, 0
  s_mov_b32 s58, 0
  s_mov_b32 s65, 524288
  s_mov_b32 s100, 0
  s_add_u32 s46, s42, 3
  s_lshl_b32 s31, s46, 10
  s_cmp_ge_u32 s46, 8
  s_cselect_b32 s47, 40960, 0
  s_add_u32 s31, s31, s47
  s_cmp_ge_u32 s46, 10
  s_cselect_b32 s31, 2146435072, s31
  s_add_u32 s46, s42, 7
  s_lshl_b32 s32, s46, 10
  s_cmp_ge_u32 s46, 8
  s_cselect_b32 s47, 40960, 0
  s_add_u32 s32, s32, s47
  s_cmp_ge_u32 s46, 10
  s_cselect_b32 s32, 2146435072, s32
  s_waitcnt vmcnt(24)
  s_barrier
  ds_read_b64_tr_b16 v[40:41], v65 offset:0
  ds_read_b64_tr_b16 v[42:43], v65 offset:1024
  ds_read_b64_tr_b16 v[44:45], v65 offset:4096
  ds_read_b64_tr_b16 v[46:47], v65 offset:5120
  ds_read_b64_tr_b16 v[48:49], v65 offset:8192
  ds_read_b64_tr_b16 v[50:51], v65 offset:9216
  ds_read_b64_tr_b16 v[52:53], v65 offset:12288
  ds_read_b64_tr_b16 v[54:55], v65 offset:13312
  ds_read_b64_tr_b16 v[56:57], v65 offset:16384
  ds_read_b64_tr_b16 v[58:59], v65 offset:17408
  ds_read_b64_tr_b16 v[60:61], v65 offset:20480
  ds_read_b64_tr_b16 v[62:63], v65 offset:21504
  s_waitcnt lgkmcnt(0)
  s_waitcnt vmcnt(18)
  s_barrier
  ds_write_b128 v2, v[40:43] offset:0
  ds_write_b128 v2, v[44:47] offset:4096
  ds_write_b128 v2, v[48:51] offset:8192
  ds_write_b128 v2, v[52:55] offset:12288
  ds_write_b128 v2, v[56:59] offset:16384
  ds_write_b128 v2, v[60:63] offset:20480
  ds_read_b64_tr_b16 v[16:17], v65 offset:24576
  ds_read_b64_tr_b16 v[18:19], v65 offset:25600
  ds_read_b64_tr_b16 v[20:21], v65 offset:28672
  ds_read_b64_tr_b16 v[22:23], v65 offset:29696
  ds_read_b64_tr_b16 v[24:25], v65 offset:32768
  ds_read_b64_tr_b16 v[26:27], v65 offset:33792
  ds_read_b64_tr_b16 v[28:29], v65 offset:36864
  ds_read_b64_tr_b16 v[30:31], v65 offset:37888
  ds_read_b64_tr_b16 v[32:33], v65 offset:40960
  ds_read_b64_tr_b16 v[34:35], v65 offset:41984
  ds_read_b64_tr_b16 v[36:37], v65 offset:45056
  ds_read_b64_tr_b16 v[38:39], v65 offset:46080
  s_waitcnt lgkmcnt(0)
  s_waitcnt vmcnt(12)
  s_barrier
  ds_write_b128 v2, v[16:19] offset:24576
  ds_write_b128 v2, v[20:23] offset:28672
  ds_write_b128 v2, v[24:27] offset:32768
  ds_write_b128 v2, v[28:31] offset:36864
  ds_write_b128 v2, v[32:35] offset:40960
  ds_write_b128 v2, v[36:39] offset:45056
  ds_read_b64_tr_b16 v[40:41], v65 offset:49152
  ds_read_b64_tr_b16 v[42:43], v65 offset:50176
  ds_read_b64_tr_b16 v[44:45], v65 offset:53248
  ds_read_b64_tr_b16 v[46:47], v65 offset:54272
  ds_read_b64_tr_b16 v[48:49], v65 offset:57344
  ds_read_b64_tr_b16 v[50:51], v65 offset:58368
  ds_read_b64_tr_b16 v[52:53], v65 offset:61440
  ds_read_b64_tr_b16 v[54:55], v65 offset:62464
  ds_read_b64_tr_b16 v[56:57], v66 offset:0
  ds_read_b64_tr_b16 v[58:59], v66 offset:1024
  ds_read_b64_tr_b16 v[60:61], v66 offset:4096
  ds_read_b64_tr_b16 v[62:63], v66 offset:5120
  s_waitcnt lgkmcnt(0)
  s_waitcnt vmcnt(6)
  s_barrier
  ds_write_b128 v2, v[40:43] offset:49152
  ds_write_b128 v2, v[44:47] offset:53248
  ds_write_b128 v2, v[48:51] offset:57344
  ds_write_b128 v2, v[52:55] offset:61440
  ds_write_b128 v3, v[56:59] offset:0
  ds_write_b128 v3, v[60:63] offset:4096
  ds_read_b64_tr_b16 v[16:17], v66 offset:8192
  ds_read_b64_tr_b16 v[18:19], v66 offset:9216
  ds_read_b64_tr_b16 v[20:21], v66 offset:12288
  ds_read_b64_tr_b16 v[22:23], v66 offset:13312
  ds_read_b64_tr_b16 v[24:25], v66 offset:16384
  ds_read_b64_tr_b16 v[26:27], v66 offset:17408
  ds_read_b64_tr_b16 v[28:29], v66 offset:20480
  ds_read_b64_tr_b16 v[30:31], v66 offset:21504
  ds_read_b64_tr_b16 v[32:33], v66 offset:24576
  ds_read_b64_tr_b16 v[34:35], v66 offset:25600
  ds_read_b64_tr_b16 v[36:37], v66 offset:28672
  ds_read_b64_tr_b16 v[38:39], v66 offset:29696
  s_waitcnt lgkmcnt(0)
  s_waitcnt vmcnt(0)
  s_barrier
  ds_write_b128 v3, v[16:19] offset:8192
  ds_write_b128 v3, v[20:23] offset:12288
  ds_write_b128 v3, v[24:27] offset:16384
  ds_write_b128 v3, v[28:31] offset:20480
  ds_write_b128 v3, v[32:35] offset:24576
  ds_write_b128 v3, v[36:39] offset:28672
  ds_read_b64_tr_b16 v[40:41], v66 offset:32768
  ds_read_b64_tr_b16 v[42:43], v66 offset:33792
  ds_read_b64_tr_b16 v[44:45], v66 offset:36864
  ds_read_b64_tr_b16 v[46:47], v66 offset:37888
  ds_read_b64_tr_b16 v[48:49], v66 offset:40960
  ds_read_b64_tr_b16 v[50:51], v66 offset:41984
  ds_read_b64_tr_b16 v[52:53], v66 offset:45056
  ds_read_b64_tr_b16 v[54:55], v66 offset:46080
  ds_read_b64_tr_b16 v[56:57], v66 offset:49152
  ds_read_b64_tr_b16 v[58:59], v66 offset:50176
  ds_read_b64_tr_b16 v[60:61], v66 offset:53248
  ds_read_b64_tr_b16 v[62:63], v66 offset:54272
  s_waitcnt lgkmcnt(0)
  s_barrier
  ds_write_b128 v3, v[40:43] offset:32768
  ds_write_b128 v3, v[44:47] offset:36864
  ds_write_b128 v3, v[48:51] offset:40960
  ds_write_b128 v3, v[52:55] offset:45056
  ds_write_b128 v3, v[56:59] offset:49152
  ds_write_b128 v3, v[60:63] offset:53248
  s_waitcnt lgkmcnt(0)
  s_cmp_lg_u32 s42, 2
  s_cbranch_scc1 sc_k0
  s_mov_b32 s53, 1
  s_cmp_ge_u32 s61, s53
  s_cbranch_scc1 wf_done_19
  s_mov_b32 s50, 0
wf_loop_20:
  buffer_load_dword v136, v15, s[8:11], 0 offen sc1
  s_add_u32 s50, s50, 1
  s_cmp_gt_u32 s50, 131072
  s_cbranch_scc1 L_fail
  s_waitcnt vmcnt(0)
  v_lshrrev_b32 v137, 6, v136
  v_not_b32 v138, v0
  v_or_b32 v137, v137, v138
  v_and_b32 v137, 1, v137
  v_add_u32 v136, v136, v137
  s_nop 1
  v_min_u32_dpp v136, v136, v136 row_ror:8 row_mask:0xf bank_mask:0xf
  s_nop 1
  v_min_u32_dpp v136, v136, v136 row_ror:4 row_mask:0xf bank_mask:0xf
  s_nop 1
  v_min_u32_dpp v136, v136, v136 row_ror:2 row_mask:0xf bank_mask:0xf
  s_nop 1
  v_min_u32_dpp v136, v136, v136 row_ror:1 row_mask:0xf bank_mask:0xf
  v_mov_b32 v137, v136
  s_nop 1
  v_permlane16_swap_b32 v137, v136
  v_min_u32 v136, v136, v137
  v_mov_b32 v137, v136
  s_nop 1
  v_permlane32_swap_b32 v137, v136
  v_min_u32 v136, v136, v137
  s_nop 0
  v_readfirstlane_b32 s61, v136
  s_nop 0
  s_cmp_ge_u32 s61, s53
  s_cbranch_scc1 wf_done_19
  s_sleep 2
  s_branch wf_loop_20
wf_done_19:
sc_k0:
  s_barrier
  s_cmp_eq_u32 s42, 3
  s_cbranch_scc1 scs_loop
  s_mov_b32 m0, s21
  s_lshr_b32 s63, s23, 1
  s_lshl_b32 s63, s63, 14
  s_and_b32 s46, s23, 1
  s_lshl_b32 s46, s46, 12
  s_add_u32 s63, s63, s46
  s_add_u32 s63, s63, s20
  s_lshr_b32 s46, s63, 8
  s_and_b32 s46, s46, 0x2000
  s_xor_b32 s63, s63, s46
  buffer_load_dwordx4 v1, s[8:11], s63 offen offset:0 sc1 lds
  buffer_load_dwordx4 v1, s[8:11], s63 offen offset:1024 sc1 lds
  buffer_load_dwordx4 v1, s[8:11], s63 offen offset:2048 sc1 lds
  buffer_load_dwordx4 v1, s[8:11], s63 offen offset:3072 sc1 lds
  s_waitcnt vmcnt(0)
  s_branch sch_loop
scs_loop:
  s_add_u32 s53, s52, 1
  s_lshl_b32 s56, s58, 2
  s_add_u32 s56, s56, s43
  s_lshl_b32 s56, s56, 16
  s_add_u32 s56, s56, s3
  s_add_u32 s56, s56, 12582912
  v_add_u32 v12, s56, v1
  s_lshl_b32 s66, s58, 18
  s_mov_b64 s[16:17], -1
  s_mov_b32 s71, 0
  ds_read_b128 v[56:59], v2 offset:0
  ds_read_b128 v[60:63], v2 offset:4096
  ds_read_b128 v[64:67], v2 offset:8192
  ds_read_b128 v[68:71], v2 offset:12288
  ds_read_b128 v[72:75], v2 offset:16384
  ds_read_b128 v[76:79], v2 offset:20480
  ds_read_b128 v[80:83], v2 offset:49152
  ds_read_b128 v[84:87], v2 offset:53248
  v_mov_b32 v88, 0
  v_mov_b32 v89, 0
  v_mov_b32 v90, 0
  v_mov_b32 v91, 0
  v_mov_b32 v92, 0
  v_mov_b32 v93, 0
  v_mov_b32 v94, 0
  v_mov_b32 v95, 0
  v_mov_b32 v96, 0
  v_mov_b32 v97, 0
  v_mov_b32 v98, 0
  v_mov_b32 v99, 0
  v_mov_b32 v100, 0
  v_mov_b32 v101, 0
  v_mov_b32 v102, 0
  v_mov_b32 v103, 0
  v_mov_b32 v104, 0
  v_mov_b32 v105, 0
  v_mov_b32 v106, 0
  v_mov_b32 v107, 0
  v_mov_b32 v108, 0
  v_mov_b32 v109, 0
  v_mov_b32 v110, 0
  v_mov_b32 v111, 0
  v_mov_b32 v6, s53
  s_waitcnt lgkmcnt(0)
  s_mov_b32 s50, 0
scs_top:
  s_barrier
  buffer_load_dwordx4 v[16:19], v12, s[8:11], 0 offen offset:0 sc1
  s_add_u32 m0, s51, 153600
  s_barrier
  buffer_load_dwordx4 v[20:23], v12, s[8:11], 0 offen offset:1024 sc1
  s_barrier
  buffer_load_dwordx4 v[24:27], v12, s[8:11], 0 offen offset:2048 sc1
  s_barrier
  buffer_load_dwordx4 v12, s[8:11], s31 offen sc1 lds
  s_add_u32 m0, s51, 157696
  s_barrier
  buffer_load_dwordx4 v12, s[8:11], s32 offen sc1 lds
  s_waitcnt vmcnt(4)
scs_go:
  v_smfmac_f32_16x16x64_bf16 v[88:91], v[16:19], a[192:199], v7
  v_smfmac_f32_16x16x64_bf16 v[92:95], v[16:19], a[200:207], v7
  v_smfmac_f32_16x16x64_bf16 v[96:99], v[16:19], a[208:215], v7
  v_smfmac_f32_16x16x64_bf16 v[100:103], v[16:19], v[56:63], v7
  v_smfmac_f32_16x16x64_bf16 v[104:107], v[16:19], v[64:71], v7
  ds_read_b128 v[56:59], v2 offset:57344
  v_smfmac_f32_16x16x64_bf16 v[108:111], v[16:19], v[72:79], v7
  s_waitcnt vmcnt(3)
  ds_read_b128 v[60:63], v2 offset:61440
  v_smfmac_f32_16x16x64_bf16 v[88:91], v[20:23], a[216:223], v7
  ds_read_b128 v[64:67], v3 offset:0
  v_smfmac_f32_16x16x64_bf16 v[92:95], v[20:23], a[224:231], v7
  ds_read_b128 v[68:71], v3 offset:4096
  v_smfmac_f32_16x16x64_bf16 v[96:99], v[20:23], a[232:239], v7
  s_waitcnt vmcnt(2)
  v_max3_u32 v136, v16, v20, v24
  v_smfmac_f32_16x16x64_bf16 v[100:103], v[20:23], a[0:7], v7
  ds_read_b128 v[72:75], v3 offset:8192
  v_cmp_eq_u32 vcc, -1, v136
  v_smfmac_f32_16x16x64_bf16 v[104:107], v[20:23], a[8:15], v7
  ds_read_b128 v[76:79], v3 offset:12288
  v_smfmac_f32_16x16x64_bf16 v[108:111], v[20:23], a[16:23], v7
  s_cbranch_vccnz scs_ha
  v_smfmac_f32_16x16x64_bf16 v[88:91], v[24:27], a[240:247], v7
  s_waitcnt vmcnt(1)
  s_barrier
  ds_read_b128 v[28:31], v149 offset:0
  v_smfmac_f32_16x16x64_bf16 v[92:95], v[24:27], a[248:255], v7
  ds_read_b128 v[32:35], v149 offset:1024
  v_smfmac_f32_16x16x64_bf16 v[96:99], v[24:27], v[152:159], v7
  ds_read_b128 v[36:39], v149 offset:2048
  v_smfmac_f32_16x16x64_bf16 v[100:103], v[24:27], a[24:31], v7
  ds_read_b128 v[40:43], v149 offset:3072
  v_smfmac_f32_16x16x64_bf16 v[104:107], v[24:27], a[32:39], v7
  v_smfmac_f32_16x16x64_bf16 v[108:111], v[24:27], a[40:47], v7
  s_waitcnt vmcnt(0)
  s_barrier
  s_waitcnt lgkmcnt(3)
  v_smfmac_f32_16x16x64_bf16 v[88:91], v[28:31], v[80:87], v7
  ds_read_b128 v[44:47], v149 offset:4096
  v_smfmac_f32_16x16x64_bf16 v[92:95], v[28:31], v[56:63], v7
  ds_read_b128 v[48:51], v149 offset:5120
  v_smfmac_f32_16x16x64_bf16 v[96:99], v[28:31], v[64:71], v7
  ds_read_b128 v[52:55], v149 offset:6144
  s_waitcnt lgkmcnt(3)
  v_smfmac_f32_16x16x64_bf16 v[88:91], v[32:35], v[160:167], v7
  ds_read_b128 v[80:83], v3 offset:32768
  ds_read_b128 v[16:19], v13 offset:8192
  v_smfmac_f32_16x16x64_bf16 v[92:95], v[32:35], v[168:175], v7
  ds_read_b128 v[84:87], v3 offset:36864
  ds_read_b128 v[20:23], v13 offset:10240
  v_smfmac_f32_16x16x64_bf16 v[96:99], v[32:35], v[176:183], v7
  ds_read_b128 v[56:59], v3 offset:16384
  ds_read_b128 v[24:27], v13 offset:9216
  v_smfmac_f32_16x16x64_bf16 v[88:91], v[36:39], v[184:191], v7
  s_waitcnt lgkmcnt(6)
  v_max3_u32 v136, v28, v32, v36
  v_smfmac_f32_16x16x64_bf16 v[92:95], v[36:39], v[192:199], v7
  ds_read_b128 v[60:63], v3 offset:20480
  v_max3_u32 v136, v136, v40, v44
  v_smfmac_f32_16x16x64_bf16 v[96:99], v[36:39], v[200:207], v7
  ds_read_b128 v[64:67], v3 offset:40960
  v_max3_u32 v136, v136, v48, v52
  v_smfmac_f32_16x16x64_bf16 v[88:91], v[44:47], v[208:215], v7
  ds_read_b128 v[68:71], v3 offset:45056
  v_cmp_eq_u32 vcc, -1, v136
  v_smfmac_f32_16x16x64_bf16 v[88:91], v[48:51], v[232:239], v7
  v_smfmac_f32_16x16x64_bf16 v[88:91], v[40:43], v[72:79], v7
  s_cbranch_vccnz scs_hb
  s_waitcnt lgkmcnt(3)
  v_smfmac_f32_16x16x64_bf16 v[88:91], v[52:55], v[80:87], v7
  ds_read_b128 v[72:75], v3 offset:24576
scs_join:
  v_smfmac_f32_16x16x64_bf16 v[92:95], v[44:47], v[216:223], v7
  ds_read_b128 v[76:79], v3 offset:28672
  v_smfmac_f32_16x16x64_bf16 v[92:95], v[48:51], v[240:247], v7
  ds_read_b128 v[80:83], v3 offset:49152
  s_waitcnt lgkmcnt(3)
  v_add_f32 v88, v88, v90
  v_smfmac_f32_16x16x64_bf16 v[92:95], v[40:43], v[56:63], v7
  ds_read_b128 v[84:87], v3 offset:53248
  v_add_f32 v89, v89, v91
  v_smfmac_f32_16x16x64_bf16 v[92:95], v[52:55], v[64:71], v7
  ds_read_b128 v[56:59], v2 offset:24576
  v_cmp_u_f32 vcc, v88, v89
  v_smfmac_f32_16x16x64_bf16 v[96:99], v[44:47], v[224:231], v7
  ds_read_b128 v[60:63], v2 offset:28672
  v_cvt_pk_bf16_f32 v136, v88, v89
  v_smfmac_f32_16x16x64_bf16 v[96:99], v[48:51], v[248:255], v7
  s_and_b64 vcc, vcc, s[16:17]
  s_cbranch_scc1 scs_redo
  s_waitcnt lgkmcnt(4)
  v_add_f32 v92, v92, v94
  v_smfmac_f32_16x16x64_bf16 v[96:99], v[40:43], v[72:79], v7
  ds_read_b128 v[64:67], v2 offset:32768
  s_waitcnt lgkmcnt(3)
  v_add_f32 v93, v93, v95
  v_smfmac_f32_16x16x64_bf16 v[96:99], v[52:55], v[80:87], v7
  ds_read_b128 v[68:71], v2 offset:36864
  v_cvt_pk_bf16_f32 v137, v92, v93
  v_smfmac_f32_16x16x64_bf16 v[100:103], v[28:31], a[48:55], v7
  ds_write2st64_b32 v4, v136, v137 offset0:0 offset1:4
  v_smfmac_f32_16x16x64_bf16 v[100:103], v[32:35], a[72:79], v7
  ds_read_b128 v[72:75], v2 offset:40960
  v_add_f32 v96, v96, v98
  v_smfmac_f32_16x16x64_bf16 v[100:103], v[40:43], a[96:103], v7
  ds_read_b128 v[76:79], v2 offset:45056
  s_waitcnt lgkmcnt(5)
  v_add_f32 v97, v97, v99
  v_smfmac_f32_16x16x64_bf16 v[100:103], v[36:39], v[56:63], v7
  ds_read_b128 v[80:83], v13 offset:5120
  v_cvt_pk_bf16_f32 v138, v96, v97
  v_smfmac_f32_16x16x64_bf16 v[100:103], v[44:47], a[120:127], v7
  ds_write_b32 v4, v138 offset:2048
  v_smfmac_f32_16x16x64_bf16 v[100:103], v[48:51], a[144:151], v7
  ds_read_b128 v[84:87], v13 offset:7168
  ds_read_b128 v[56:59], v13 offset:0
  s_waitcnt lgkmcnt(6)
  v_smfmac_f32_16x16x64_bf16 v[104:107], v[36:39], v[64:71], v7
  ds_read_b128 v[60:63], v13 offset:2048
  s_waitcnt lgkmcnt(5)
  v_smfmac_f32_16x16x64_bf16 v[108:111], v[36:39], v[72:79], v7
  ds_read_b128 v[64:67], v13 offset:1024
  ds_read_b128 v[68:71], v13 offset:3072
  v_smfmac_f32_16x16x64_bf16 v[100:103], v[52:55], a[168:175], v7
  s_waitcnt lgkmcnt(5)
  s_barrier
  v_smfmac_f32_16x16x64_bf16 v[104:107], v[28:31], a[56:63], v7
  ds_read_b64_tr_b16 v[112:113], v5 offset:0
  ds_read_b64_tr_b16 v[114:115], v5 offset:64
  v_smfmac_f32_16x16x64_bf16 v[104:107], v[32:35], a[80:87], v7
  ds_read_b64_tr_b16 v[116:117], v5 offset:512
  ds_read_b64_tr_b16 v[118:119], v5 offset:576
  v_smfmac_f32_16x16x64_bf16 v[104:107], v[40:43], a[104:111], v7
  ds_read_b64_tr_b16 v[120:121], v5 offset:1024
  ds_read_b64_tr_b16 v[122:123], v5 offset:1088
  v_smfmac_f32_16x16x64_bf16 v[104:107], v[44:47], a[128:135], v7
  ds_read_b64_tr_b16 v[124:125], v5 offset:1536
  ds_read_b64_tr_b16 v[126:127], v5 offset:1600
  v_smfmac_f32_16x16x64_bf16 v[104:107], v[48:51], a[152:159], v7
  ds_read_b64_tr_b16 v[128:129], v5 offset:2048
  ds_read_b64_tr_b16 v[130:131], v5 offset:2112
  v_smfmac_f32_16x16x64_bf16 v[104:107], v[52:55], a[176:183], v7
  ds_read_b64_tr_b16 v[132:133], v5 offset:2560
  ds_read_b64_tr_b16 v[134:135], v5 offset:2624
  buffer_store_dword v6, v11, s[8:11], 0 offen sc1
  v_smfmac_f32_16x16x64_bf16 v[108:111], v[28:31], a[64:71], v7
  ds_read_b128 v[72:75], v13 offset:4096
  v_add_f32 v100, v100, v102
  v_smfmac_f32_16x16x64_bf16 v[108:111], v[32:35], a[88:95], v7
  ds_read_b128 v[76:79], v13 offset:6144
  v_add_f32 v101, v101, v103
  v_smfmac_f32_16x16x64_bf16 v[108:111], v[40:43], a[112:119], v7
  ds_read_b128 v[36:39], v13 offset:11264
  v_cvt_pk_bf16_f32 v139, v100, v101
  v_smfmac_f32_16x16x64_bf16 v[108:111], v[44:47], a[136:143], v7
  v_add_f32 v104, v104, v106
  v_smfmac_f32_16x16x64_bf16 v[108:111], v[48:51], a[160:167], v7
  v_add_f32 v105, v105, v107
  v_smfmac_f32_16x16x64_bf16 v[108:111], v[52:55], a[184:191], v7
  s_waitcnt lgkmcnt(2)
  v_cvt_pk_bf16_f32 v140, v104, v105
  v_mfma_f32_16x16x32_bf16 v[88:91], v[56:59], v[112:115], 0
  ds_write2st64_b32 v4, v139, v140 offset0:12 offset1:16
  v_mfma_f32_16x16x32_bf16 v[92:95], v[60:63], v[112:115], 0
  v_add_f32 v108, v108, v110
  v_add_f32 v109, v109, v111
  v_mfma_f32_16x16x32_bf16 v[88:91], v[64:67], v[116:119], v[88:91]
  v_cvt_pk_bf16_f32 v141, v108, v109
  v_mfma_f32_16x16x32_bf16 v[92:95], v[68:71], v[116:119], v[92:95]
  ds_write_b32 v4, v141 offset:5120
  v_mfma_f32_16x16x32_bf16 v[88:91], v[72:75], v[120:123], v[88:91]
  s_waitcnt lgkmcnt(1)
  s_barrier
  v_mfma_f32_16x16x32_bf16 v[92:95], v[76:79], v[120:123], v[92:95]
  ds_read_b64_tr_b16 v[28:29], v5 offset:3072
  ds_read_b64_tr_b16 v[30:31], v5 offset:3136
  v_mfma_f32_16x16x32_bf16 v[88:91], v[80:83], v[124:127], v[88:91]
  ds_read_b64_tr_b16 v[32:33], v5 offset:3584
  ds_read_b64_tr_b16 v[34:35], v5 offset:3648
  v_mfma_f32_16x16x32_bf16 v[92:95], v[84:87], v[124:127], v[92:95]
  s_waitcnt lgkmcnt(4)
  s_barrier
  v_mfma_f32_16x16x32_bf16 v[88:91], v[16:19], v[128:131], v[88:91]
  ds_read_b64_tr_b16 v[40:41], v5 offset:4096
  ds_read_b64_tr_b16 v[42:43], v5 offset:4160
  v_mfma_f32_16x16x32_bf16 v[92:95], v[20:23], v[128:131], v[92:95]
  ds_read_b64_tr_b16 v[44:45], v5 offset:4608
  ds_read_b64_tr_b16 v[46:47], v5 offset:4672
  v_mfma_f32_16x16x32_bf16 v[88:91], v[24:27], v[132:135], v[88:91]
  ds_read_b64_tr_b16 v[48:49], v5 offset:5120
  ds_read_b64_tr_b16 v[50:51], v5 offset:5184
  v_mfma_f32_16x16x32_bf16 v[92:95], v[36:39], v[132:135], v[92:95]
  ds_read_b64_tr_b16 v[52:53], v5 offset:5632
  s_waitcnt lgkmcnt(7)
  v_mfma_f32_16x16x32_bf16 v[96:99], v[28:31], v[112:115], 0
  ds_read_b64_tr_b16 v[54:55], v5 offset:5696
  v_mfma_f32_16x16x32_bf16 v[96:99], v[32:35], v[116:119], v[96:99]
  s_waitcnt lgkmcnt(6)
  v_max3_f32 v142, v88, v89, v90
  v_max3_f32 v142, v142, v91, v92
  v_mfma_f32_16x16x32_bf16 v[96:99], v[40:43], v[120:123], v[96:99]
  s_waitcnt lgkmcnt(4)
  v_max3_f32 v142, v142, v93, v94
  v_max_f32 v142, v142, v95
  v_mfma_f32_16x16x32_bf16 v[96:99], v[44:47], v[124:127], v[96:99]
  s_waitcnt lgkmcnt(2)
  v_mov_b32 v143, v142
  v_cndmask_b32 v136, v88, v90, s[18:19]
  v_mfma_f32_16x16x32_bf16 v[96:99], v[48:51], v[128:131], v[96:99]
  s_waitcnt lgkmcnt(0)
  v_permlane32_swap_b32 v143, v142
  v_mfma_f32_16x16x32_bf16 v[96:99], v[52:55], v[132:135], v[96:99]
  s_barrier
  v_max_f32 v142, v142, v143
  v_cndmask_b32 v137, v89, v91, s[18:19]
  v_cndmask_b32 v138, v92, v94, s[18:19]
  v_cndmask_b32 v139, v93, v95, s[18:19]
  s_nop 2
  v_max3_f32 v142, v142, v96, v97
  v_max3_f32 v142, v142, v98, v99
  v_mov_b32 v143, v142
  v_cndmask_b32 v140, v96, v98, s[18:19]
  v_cndmask_b32 v141, v97, v99, s[18:19]
  v_permlane16_swap_b32 v143, v142
  v_max_f32 v142, v142, v143
  v_mul_f32 v142, s68, v142
  v_pk_fma_f32 v[136:137], v[136:137], s[68:69], v[142:143] op_sel_hi:[1,0,0] neg_lo:[0,0,1] neg_hi:[0,0,1]
  v_pk_fma_f32 v[138:139], v[138:139], s[68:69], v[142:143] op_sel_hi:[1,0,0] neg_lo:[0,0,1] neg_hi:[0,0,1]
  v_pk_fma_f32 v[140:141], v[140:141], s[68:69], v[142:143] op_sel_hi:[1,0,0] neg_lo:[0,0,1] neg_hi:[0,0,1]
  v_exp_f32 v136, v136
  v_exp_f32 v137, v137
  v_exp_f32 v138, v138
  v_exp_f32 v139, v139
  v_exp_f32 v140, v140
  v_pk_add_f32 v[144:145], v[136:137], v[138:139]
  v_add_f32 v142, v144, v145
  v_add_f32 v143, v144, v145
  v_exp_f32 v141, v141
  s_nop 0
  v_permlane32_swap_b32 v143, v142
  v_pk_add_f32 v[142:143], v[142:143], v[140:141]
  v_add_f32 v142, v142, v143
  s_nop 1
  v_add_f32_dpp v142, v142, v142 row_ror:8 row_mask:0xf bank_mask:0xf
  v_mov_b32 v143, v142
  s_nop 1
  v_permlane16_swap_b32 v143, v142
  v_add_f32 v142, v142, v143
  v_rcp_f32 v142, v142
  s_nop 0
  v_pk_mul_f32 v[136:137], v[136:137], v[142:143] op_sel_hi:[1,0]
  v_pk_mul_f32 v[138:139], v[138:139], v[142:143] op_sel_hi:[1,0]
  v_pk_mul_f32 v[140:141], v[140:141], v[142:143] op_sel_hi:[1,0]
  v_cvt_pk_bf16_f32 v146, v136, v137
  v_cvt_pk_bf16_f32 v147, v138, v139
  v_cvt_pk_bf16_f32 v148, v140, v141
  buffer_store_dword v148, v9, s[8:11], s66 offen sc1
  buffer_store_dwordx2 v[146:147], v8, s[8:11], s66 offen sc1
  v_mov_b32 v150, -1
  v_mov_b32 v151, -1
  s_waitcnt vmcnt(0)
  s_add_u32 s46, s65, 0
  buffer_store_dwordx2 v[150:151], v8, s[8:11], s46 offen sc1
  buffer_store_dword v150, v9, s[8:11], s46 offen sc1
  s_mov_b32 s65, s66
  v_add_u32 v13, s22, v13
  s_sub_u32 s22, 0, s22
  s_add_u32 s58, s58, 1
  s_cmp_eq_u32 s58, 3
  s_cselect_b32 s58, 0, s58
  s_mov_b32 s52, s53
  s_cmp_lt_u32 s52, 64
  s_cbranch_scc1 scs_loop
  s_endpgm
sch_loop:
  s_add_u32 s53, s52, 1
  s_lshl_b32 s56, s58, 2
  s_add_u32 s56, s56, s43
  s_lshl_b32 s56, s56, 16
  s_add_u32 s56, s56, s3
  s_add_u32 s56, s56, 12582912
  v_add_u32 v12, s56, v1
  s_lshl_b32 s66, s58, 18
  s_mov_b64 s[16:17], -1
  s_mov_b32 s71, 0
  ds_read_b128 v[56:59], v2 offset:0
  ds_read_b128 v[60:63], v2 offset:4096
  ds_read_b128 v[64:67], v2 offset:8192
  ds_read_b128 v[68:71], v2 offset:12288
  ds_read_b128 v[72:75], v2 offset:16384
  ds_read_b128 v[76:79], v2 offset:20480
  ds_read_b128 v[80:83], v2 offset:49152
  ds_read_b128 v[84:87], v2 offset:53248
  v_mov_b32 v88, 0
  v_mov_b32 v89, 0
  v_mov_b32 v90, 0
  v_mov_b32 v91, 0
  v_mov_b32 v92, 0
  v_mov_b32 v93, 0
  v_mov_b32 v94, 0
  v_mov_b32 v95, 0
  v_mov_b32 v96, 0
  v_mov_b32 v97, 0
  v_mov_b32 v98, 0
  v_mov_b32 v99, 0
  v_mov_b32 v100, 0
  v_mov_b32 v101, 0
  v_mov_b32 v102, 0
  v_mov_b32 v103, 0
  v_mov_b32 v104, 0
  v_mov_b32 v105, 0
  v_mov_b32 v106, 0
  v_mov_b32 v107, 0
  v_mov_b32 v108, 0
  v_mov_b32 v109, 0
  v_mov_b32 v110, 0
  v_mov_b32 v111, 0
  s_xor_b32 s28, s63, 0x2000
  s_add_u32 s28, s28, s26
  s_add_u32 s29, s28, 16777216
  s_add_u32 s30, s28, 33554432
  s_add_u32 s23, s23, 32
  s_cmp_ge_u32 s23, 1024
  s_cselect_b32 s46, 1024, 0
  s_sub_u32 s23, s23, s46
  s_lshr_b32 s63, s23, 1
  s_lshl_b32 s63, s63, 14
  s_and_b32 s46, s23, 1
  s_lshl_b32 s46, s46, 12
  s_add_u32 s63, s63, s46
  s_add_u32 s63, s63, s20
  s_lshr_b32 s46, s63, 8
  s_and_b32 s46, s46, 0x2000
  s_xor_b32 s63, s63, s46
  s_add_u32 s21, s21, s22
  s_waitcnt vmcnt(0) lgkmcnt(0)
  s_cmp_lg_u32 s42, 2
  s_cbranch_scc1 sc_nobell
  s_add_u32 s49, s52, 2
  s_cmp_ge_u32 s61, s49
  s_cbranch_scc1 wf_done_21
  s_mov_b32 s50, 0
wf_loop_22:
  buffer_load_dword v136, v15, s[8:11], 0 offen sc1
  s_add_u32 s50, s50, 1
  s_cmp_gt_u32 s50, 131072
  s_cbranch_scc1 L_fail
  s_waitcnt vmcnt(0)
  v_lshrrev_b32 v137, 6, v136
  v_not_b32 v138, v0
  v_or_b32 v137, v137, v138
  v_and_b32 v137, 1, v137
  v_add_u32 v136, v136, v137
  s_nop 1
  v_min_u32_dpp v136, v136, v136 row_ror:8 row_mask:0xf bank_mask:0xf
  s_nop 1
  v_min_u32_dpp v136, v136, v136 row_ror:4 row_mask:0xf bank_mask:0xf
  s_nop 1
  v_min_u32_dpp v136, v136, v136 row_ror:2 row_mask:0xf bank_mask:0xf
  s_nop 1
  v_min_u32_dpp v136, v136, v136 row_ror:1 row_mask:0xf bank_mask:0xf
  v_mov_b32 v137, v136
  s_nop 1
  v_permlane16_swap_b32 v137, v136
  v_min_u32 v136, v136, v137
  v_mov_b32 v137, v136
  s_nop 1
  v_permlane32_swap_b32 v137, v136
  v_min_u32 v136, v136, v137
  s_nop 0
  v_readfirstlane_b32 s61, v136
  s_nop 0
  s_cmp_ge_u32 s61, s49
  s_cbranch_scc1 wf_done_21
  s_sleep 2
  s_branch wf_loop_22
wf_done_21:
  s_mov_b32 s50, 0
  s_waitcnt lgkmcnt(0)
  s_mov_b64 s[80:81], 0
  s_mov_b64 s[82:83], 0
  s_cmp_eq_u32 s53, 1
  s_cbranch_scc1 bell_x_24
bell_23:
  s_load_dwordx4 s[80:83], s[40:41], 0 glc
  s_min_u32 s46, s80, s81
  s_min_u32 s47, s82, s83
  s_min_u32 s46, s46, s47
  s_cmp_ge_u32 s46, s53
  s_cbranch_scc1 bell_x_24
  s_min_u32 s46, s80, s81
  s_min_u32 s47, s82, s83
  s_min_u32 s46, s46, s47
  s_cmp_ge_u32 s46, s53
  s_cbranch_scc1 bell_x_24
  s_min_u32 s46, s80, s81
  s_min_u32 s47, s82, s83
  s_min_u32 s46, s46, s47
  s_cmp_ge_u32 s46, s53
  s_cbranch_scc1 bell_x_24
  s_min_u32 s46, s80, s81
  s_min_u32 s47, s82, s83
  s_min_u32 s46, s46, s47
  s_cmp_ge_u32 s46, s53
  s_cbranch_scc1 bell_x_24
  s_min_u32 s46, s80, s81
  s_min_u32 s47, s82, s83
  s_min_u32 s46, s46, s47
  s_cmp_ge_u32 s46, s53
  s_cbranch_scc1 bell_x_24
  s_min_u32 s46, s80, s81
  s_min_u32 s47, s82, s83
  s_min_u32 s46, s46, s47
  s_cmp_ge_u32 s46, s53
  s_cbranch_scc1 bell_x_24
  s_min_u32 s46, s80, s81
  s_min_u32 s47, s82, s83
  s_min_u32 s46, s46, s47
  s_cmp_ge_u32 s46, s53
  s_cbranch_scc1 bell_x_24
  s_add_u32 s50, s50, 1
  s_cmp_lt_u32 s50, 524288
  s_cbranch_scc1 bell_23
  s_branch L_fail
bell_x_24:
sc_nobell:
  s_mov_b32 s50, 0
sch_top:
  s_barrier
  buffer_load_dwordx4 v[16:19], v12, s[8:11], 0 offen offset:0 sc1
  s_add_u32 m0, s51, 153600
  s_barrier
  buffer_load_dwordx4 v[20:23], v12, s[8:11], 0 offen offset:1024 sc1
  s_barrier
  buffer_load_dwordx4 v[24:27], v12, s[8:11], 0 offen offset:2048 sc1
  s_barrier
  buffer_load_dwordx4 v12, s[8:11], s31 offen sc1 lds
  s_add_u32 m0, s51, 157696
  s_barrier
  buffer_load_dwordx4 v12, s[8:11], s32 offen sc1 lds
  s_waitcnt vmcnt(4)
sch_go:
  v_smfmac_f32_16x16x64_bf16 v[88:91], v[16:19], a[192:199], v7
  v_smfmac_f32_16x16x64_bf16 v[92:95], v[16:19], a[200:207], v7
  v_smfmac_f32_16x16x64_bf16 v[96:99], v[16:19], a[208:215], v7
  v_smfmac_f32_16x16x64_bf16 v[100:103], v[16:19], v[56:63], v7
  v_smfmac_f32_16x16x64_bf16 v[104:107], v[16:19], v[64:71], v7
  ds_read_b128 v[56:59], v2 offset:57344
  v_smfmac_f32_16x16x64_bf16 v[108:111], v[16:19], v[72:79], v7
  s_waitcnt vmcnt(3)
  ds_read_b128 v[60:63], v2 offset:61440
  v_smfmac_f32_16x16x64_bf16 v[88:91], v[20:23], a[216:223], v7
  ds_read_b128 v[64:67], v3 offset:0
  v_smfmac_f32_16x16x64_bf16 v[92:95], v[20:23], a[224:231], v7
  ds_read_b128 v[68:71], v3 offset:4096
  v_smfmac_f32_16x16x64_bf16 v[96:99], v[20:23], a[232:239], v7
  s_waitcnt vmcnt(2)
  v_max3_u32 v136, v16, v20, v24
  v_smfmac_f32_16x16x64_bf16 v[100:103], v[20:23], a[0:7], v7
  ds_read_b128 v[72:75], v3 offset:8192
  v_cmp_eq_u32 vcc, -1, v136
  v_smfmac_f32_16x16x64_bf16 v[104:107], v[20:23], a[8:15], v7
  ds_read_b128 v[76:79], v3 offset:12288
  v_smfmac_f32_16x16x64_bf16 v[108:111], v[20:23], a[16:23], v7
  s_cbranch_vccnz sch_ha
  v_smfmac_f32_16x16x64_bf16 v[88:91], v[24:27], a[240:247], v7
  s_waitcnt vmcnt(1)
  s_barrier
  ds_read_b128 v[28:31], v149 offset:0
  v_smfmac_f32_16x16x64_bf16 v[92:95], v[24:27], a[248:255], v7
  ds_read_b128 v[32:35], v149 offset:1024
  v_smfmac_f32_16x16x64_bf16 v[96:99], v[24:27], v[152:159], v7
  ds_read_b128 v[36:39], v149 offset:2048
  v_smfmac_f32_16x16x64_bf16 v[100:103], v[24:27], a[24:31], v7
  ds_read_b128 v[40:43], v149 offset:3072
  v_smfmac_f32_16x16x64_bf16 v[104:107], v[24:27], a[32:39], v7
  v_smfmac_f32_16x16x64_bf16 v[108:111], v[24:27], a[40:47], v7
  s_waitcnt vmcnt(0)
  s_barrier
  s_waitcnt lgkmcnt(3)
  v_smfmac_f32_16x16x64_bf16 v[88:91], v[28:31], v[80:87], v7
  ds_read_b128 v[44:47], v149 offset:4096
  v_smfmac_f32_16x16x64_bf16 v[92:95], v[28:31], v[56:63], v7
  ds_read_b128 v[48:51], v149 offset:5120
  v_smfmac_f32_16x16x64_bf16 v[96:99], v[28:31], v[64:71], v7
  ds_read_b128 v[52:55], v149 offset:6144
  s_waitcnt lgkmcnt(3)
  v_smfmac_f32_16x16x64_bf16 v[88:91], v[32:35], v[160:167], v7
  ds_read_b128 v[80:83], v3 offset:32768
  v_smfmac_f32_16x16x64_bf16 v[92:95], v[32:35], v[168:175], v7
  ds_read_b128 v[84:87], v3 offset:36864
  v_smfmac_f32_16x16x64_bf16 v[96:99], v[32:35], v[176:183], v7
  ds_read_b128 v[56:59], v3 offset:16384
  v_smfmac_f32_16x16x64_bf16 v[88:91], v[36:39], v[184:191], v7
  s_waitcnt lgkmcnt(3)
  v_max3_u32 v136, v28, v32, v36
  v_smfmac_f32_16x16x64_bf16 v[92:95], v[36:39], v[192:199], v7
  ds_read_b128 v[60:63], v3 offset:20480
  v_max3_u32 v136, v136, v40, v44
  v_smfmac_f32_16x16x64_bf16 v[96:99], v[36:39], v[200:207], v7
  ds_read_b128 v[64:67], v3 offset:40960
  v_max3_u32 v136, v136, v48, v52
  v_smfmac_f32_16x16x64_bf16 v[88:91], v[44:47], v[208:215], v7
  ds_read_b128 v[68:71], v3 offset:45056
  v_cmp_eq_u32 vcc, -1, v136
  v_smfmac_f32_16x16x64_bf16 v[88:91], v[48:51], v[232:239], v7
  v_smfmac_f32_16x16x64_bf16 v[88:91], v[40:43], v[72:79], v7
  s_cbranch_vccnz sch_hb
  s_waitcnt lgkmcnt(3)
  v_smfmac_f32_16x16x64_bf16 v[88:91], v[52:55], v[80:87], v7
  ds_read_b128 v[72:75], v3 offset:24576
  s_mov_b32 m0, s21
sch_join:
  v_smfmac_f32_16x16x64_bf16 v[92:95], v[44:47], v[216:223], v7
  ds_read_b128 v[76:79], v3 offset:28672
  buffer_load_dwordx4 v[112:115], v1, s[8:11], s28 offen offset:0 sc1
  v_smfmac_f32_16x16x64_bf16 v[92:95], v[48:51], v[240:247], v7
  ds_read_b128 v[80:83], v3 offset:49152
  s_waitcnt lgkmcnt(3)
  v_add_f32 v88, v88, v90
  v_smfmac_f32_16x16x64_bf16 v[92:95], v[40:43], v[56:63], v7
  ds_read_b128 v[84:87], v3 offset:53248
  v_add_f32 v89, v89, v91
  v_smfmac_f32_16x16x64_bf16 v[92:95], v[52:55], v[64:71], v7
  ds_read_b128 v[56:59], v2 offset:24576
  buffer_load_dwordx4 v[116:119], v1, s[8:11], s28 offen offset:1024 sc1
  v_cmp_u_f32 vcc, v88, v89
  v_smfmac_f32_16x16x64_bf16 v[96:99], v[44:47], v[224:231], v7
  ds_read_b128 v[60:63], v2 offset:28672
  v_cvt_pk_bf16_f32 v136, v88, v89
  v_smfmac_f32_16x16x64_bf16 v[96:99], v[48:51], v[248:255], v7
  s_and_b64 vcc, vcc, s[16:17]
  s_cbranch_scc1 sch_redo
  s_waitcnt lgkmcnt(4)
  v_add_f32 v92, v92, v94
  v_smfmac_f32_16x16x64_bf16 v[96:99], v[40:43], v[72:79], v7
  ds_read_b128 v[64:67], v2 offset:32768
  buffer_load_dwordx4 v[120:123], v1, s[8:11], s29 offen offset:0 sc1
  s_waitcnt lgkmcnt(3)
  v_add_f32 v93, v93, v95
  v_smfmac_f32_16x16x64_bf16 v[96:99], v[52:55], v[80:87], v7
  ds_read_b128 v[68:71], v2 offset:36864
  v_cvt_pk_bf16_f32 v137, v92, v93
  v_smfmac_f32_16x16x64_bf16 v[100:103], v[28:31], a[48:55], v7
  ds_write2st64_b32 v4, v136, v137 offset0:0 offset1:4
  v_smfmac_f32_16x16x64_bf16 v[100:103], v[32:35], a[72:79], v7
  ds_read_b128 v[72:75], v2 offset:40960
  buffer_load_dwordx4 v[124:127], v1, s[8:11], s29 offen offset:1024 sc1
  v_add_f32 v96, v96, v98
  v_smfmac_f32_16x16x64_bf16 v[100:103], v[40:43], a[96:103], v7
  ds_read_b128 v[76:79], v2 offset:45056
  s_waitcnt lgkmcnt(5)
  v_add_f32 v97, v97, v99
  v_smfmac_f32_16x16x64_bf16 v[100:103], v[36:39], v[56:63], v7
  v_cvt_pk_bf16_f32 v138, v96, v97
  v_smfmac_f32_16x16x64_bf16 v[100:103], v[44:47], a[120:127], v7
  ds_write_b32 v4, v138 offset:2048
  buffer_load_dwordx4 v[128:131], v1, s[8:11], s30 offen offset:0 sc1
  v_smfmac_f32_16x16x64_bf16 v[100:103], v[48:51], a[144:151], v7
  s_waitcnt lgkmcnt(3)
  v_smfmac_f32_16x16x64_bf16 v[104:107], v[36:39], v[64:71], v7
  s_waitcnt lgkmcnt(1)
  v_smfmac_f32_16x16x64_bf16 v[108:111], v[36:39], v[72:79], v7
  buffer_load_dwordx4 v[132:135], v1, s[8:11], s30 offen offset:1024 sc1
  v_smfmac_f32_16x16x64_bf16 v[100:103], v[52:55], a[168:175], v7
  s_waitcnt lgkmcnt(0)
  s_barrier
  v_smfmac_f32_16x16x64_bf16 v[104:107], v[28:31], a[56:63], v7
  v_smfmac_f32_16x16x64_bf16 v[104:107], v[32:35], a[80:87], v7
  buffer_load_dwordx4 v1, s[8:11], s63 offen offset:0 sc1 lds
  v_add_f32 v100, v100, v102
  v_smfmac_f32_16x16x64_bf16 v[104:107], v[40:43], a[104:111], v7
  v_add_f32 v101, v101, v103
  v_smfmac_f32_16x16x64_bf16 v[104:107], v[44:47], a[128:135], v7
  v_cvt_pk_bf16_f32 v139, v100, v101
  v_smfmac_f32_16x16x64_bf16 v[104:107], v[48:51], a[152:159], v7
  buffer_load_dwordx4 v1, s[8:11], s63 offen offset:1024 sc1 lds
  v_smfmac_f32_16x16x64_bf16 v[104:107], v[52:55], a[176:183], v7
  v_smfmac_f32_16x16x64_bf16 v[108:111], v[28:31], a[64:71], v7
  v_smfmac_f32_16x16x64_bf16 v[108:111], v[32:35], a[88:95], v7
  buffer_load_dwordx4 v1, s[8:11], s63 offen offset:2048 sc1 lds
  v_add_f32 v104, v104, v106
  v_smfmac_f32_16x16x64_bf16 v[108:111], v[40:43], a[112:119], v7
  v_add_f32 v105, v105, v107
  v_smfmac_f32_16x16x64_bf16 v[108:111], v[44:47], a[136:143], v7
  v_cvt_pk_bf16_f32 v140, v104, v105
  v_smfmac_f32_16x16x64_bf16 v[108:111], v[48:51], a[160:167], v7
  ds_write2st64_b32 v4, v139, v140 offset0:12 offset1:16
  buffer_load_dwordx4 v1, s[8:11], s63 offen offset:3072 sc1 lds
  v_smfmac_f32_16x16x64_bf16 v[108:111], v[52:55], a[184:191], v7
  s_nop 7
  v_add_f32 v108, v108, v110
  v_add_f32 v109, v109, v111
  v_cvt_pk_bf16_f32 v141, v108, v109
  ds_write_b32 v4, v141 offset:5120
  s_waitcnt lgkmcnt(1)
  s_barrier
  s_waitcnt lgkmcnt(0)
  s_barrier
  s_barrier
  s_cmp_ge_u32 s42, 2
  s_cbranch_scc1 sc_nox
  ds_read_b128 v[56:59], v13 offset:0
  ds_read_b128 v[60:63], v13 offset:2048
  ds_read_b128 v[64:67], v13 offset:1024
  ds_read_b128 v[68:71], v13 offset:3072
  ds_read_b128 v[72:75], v13 offset:4096
  ds_read_b128 v[76:79], v13 offset:6144
  ds_read_b128 v[80:83], v13 offset:5120
  ds_read_b128 v[84:87], v13 offset:7168
  ds_read_b128 v[16:19], v13 offset:8192
  ds_read_b128 v[20:23], v13 offset:10240
  ds_read_b128 v[24:27], v13 offset:9216
  ds_read_b128 v[36:39], v13 offset:11264
  s_waitcnt vmcnt(4)
  s_waitcnt lgkmcnt(11)
  v_mfma_f32_16x16x32_bf16 v[88:91], v[56:59], v[112:115], 0
  ds_read_b64_tr_b16 v[28:29], v5 offset:3072
  s_waitcnt lgkmcnt(11)
  v_mfma_f32_16x16x32_bf16 v[92:95], v[60:63], v[112:115], 0
  ds_read_b64_tr_b16 v[30:31], v5 offset:3136
  s_waitcnt lgkmcnt(11)
  v_mfma_f32_16x16x32_bf16 v[88:91], v[64:67], v[116:119], v[88:91]
  ds_read_b64_tr_b16 v[32:33], v5 offset:3584
  s_waitcnt lgkmcnt(11)
  v_mfma_f32_16x16x32_bf16 v[92:95], v[68:71], v[116:119], v[92:95]
  ds_read_b64_tr_b16 v[34:35], v5 offset:3648
  s_waitcnt lgkmcnt(11)
  v_mfma_f32_16x16x32_bf16 v[88:91], v[72:75], v[120:123], v[88:91]
  ds_read_b64_tr_b16 v[40:41], v5 offset:4096
  s_waitcnt lgkmcnt(5)
  v_mfma_f32_16x16x32_bf16 v[92:95], v[76:79], v[120:123], v[92:95]
  ds_read_b64_tr_b16 v[42:43], v5 offset:4160
  v_mfma_f32_16x16x32_bf16 v[88:91], v[80:83], v[124:127], v[88:91]
  ds_read_b64_tr_b16 v[44:45], v5 offset:4608
  v_mfma_f32_16x16x32_bf16 v[92:95], v[84:87], v[124:127], v[92:95]
  ds_read_b64_tr_b16 v[46:47], v5 offset:4672
  v_mfma_f32_16x16x32_bf16 v[88:91], v[16:19], v[128:131], v[88:91]
  ds_read_b64_tr_b16 v[48:49], v5 offset:5120
  v_mfma_f32_16x16x32_bf16 v[92:95], v[20:23], v[128:131], v[92:95]
  ds_read_b64_tr_b16 v[50:51], v5 offset:5184
  v_mfma_f32_16x16x32_bf16 v[88:91], v[24:27], v[132:135], v[88:91]
  ds_read_b64_tr_b16 v[52:53], v5 offset:5632
  v_mfma_f32_16x16x32_bf16 v[92:95], v[36:39], v[132:135], v[92:95]
  ds_read_b64_tr_b16 v[54:55], v5 offset:5696
  s_waitcnt lgkmcnt(5)
  v_mfma_f32_16x16x32_bf16 v[96:99], v[28:31], v[112:115], 0
  v_mfma_f32_16x16x32_bf16 v[96:99], v[32:35], v[116:119], v[96:99]
  v_mfma_f32_16x16x32_bf16 v[96:99], v[40:43], v[120:123], v[96:99]
  s_waitcnt lgkmcnt(2)
  v_mfma_f32_16x16x32_bf16 v[96:99], v[44:47], v[124:127], v[96:99]
  v_mfma_f32_16x16x32_bf16 v[96:99], v[48:51], v[128:131], v[96:99]
  s_waitcnt lgkmcnt(0)
  v_mfma_f32_16x16x32_bf16 v[96:99], v[52:55], v[132:135], v[96:99]
  v_mov_b32 v143, s70
  v_cndmask_b32 v88, v88, v143, s[72:73]
  v_cndmask_b32 v89, v89, v143, s[74:75]
  v_cndmask_b32 v90, v90, v143, s[76:77]
  v_cndmask_b32 v91, v91, v143, s[78:79]
  v_cndmask_b32 v92, v92, v143, s[80:81]
  v_cndmask_b32 v93, v93, v143, s[82:83]
  v_cndmask_b32 v94, v94, v143, s[84:85]
  v_cndmask_b32 v95, v95, v143, s[86:87]
  s_mov_b32 vcc_lo, 0
  s_mov_b32 vcc_hi, -1
  v_cndmask_b32 v96, v96, v98, vcc
  v_cndmask_b32 v97, v97, v99, vcc
  v_max_f32 v142, v88, v89
  v_max3_f32 v142, v142, v90, v91
  v_max3_f32 v142, v142, v92, v93
  v_max3_f32 v142, v142, v94, v95
  v_max3_f32 v142, v142, v96, v97
  v_mov_b32 v143, v142
  s_nop 1
  v_permlane16_swap_b32 v143, v142
  v_max_f32 v142, v142, v143
  v_mov_b32 v143, v142
  s_nop 1
  v_permlane32_swap_b32 v143, v142
  v_max_f32 v142, v142, v143
  v_mul_f32 v142, s68, v142
  v_fma_f32 v88, v88, s68, -v142
  v_fma_f32 v89, v89, s68, -v142
  v_fma_f32 v90, v90, s68, -v142
  v_fma_f32 v91, v91, s68, -v142
  v_fma_f32 v92, v92, s68, -v142
  v_fma_f32 v93, v93, s68, -v142
  v_fma_f32 v94, v94, s68, -v142
  v_fma_f32 v95, v95, s68, -v142
  v_fma_f32 v96, v96, s68, -v142
  v_fma_f32 v97, v97, s68, -v142
  v_exp_f32 v88, v88
  v_exp_f32 v89, v89
  v_exp_f32 v90, v90
  v_exp_f32 v91, v91
  v_exp_f32 v92, v92
  v_exp_f32 v93, v93
  v_exp_f32 v94, v94
  v_exp_f32 v95, v95
  v_exp_f32 v96, v96
  v_exp_f32 v97, v97
  v_add_f32 v142, v88, v89
  v_add_f32 v142, v142, v90
  v_add_f32 v142, v142, v91
  v_add_f32 v142, v142, v92
  v_add_f32 v142, v142, v93
  v_add_f32 v142, v142, v94
  v_add_f32 v142, v142, v95
  v_add_f32 v142, v142, v96
  v_add_f32 v142, v142, v97
  v_mov_b32 v143, v142
  s_nop 1
  v_permlane16_swap_b32 v143, v142
  v_add_f32 v142, v142, v143
  v_mov_b32 v143, v142
  s_nop 1
  v_permlane32_swap_b32 v143, v142
  v_add_f32 v142, v142, v143
  v_rcp_f32 v142, v142
  s_nop 0
  v_mul_f32 v88, v88, v142
  v_mul_f32 v89, v89, v142
  v_mul_f32 v90, v90, v142
  v_mul_f32 v91, v91, v142
  v_mul_f32 v92, v92, v142
  v_mul_f32 v93, v93, v142
  v_mul_f32 v94, v94, v142
  v_mul_f32 v95, v95, v142
  v_mul_f32 v96, v96, v142
  v_mul_f32 v97, v97, v142
  v_cvt_pk_bf16_f32 v144, v88, v89
  v_cvt_pk_bf16_f32 v145, v90, v91
  v_cvt_pk_bf16_f32 v146, v92, v93
  v_cvt_pk_bf16_f32 v147, v94, v95
  v_cvt_pk_bf16_f32 v148, v96, v97
  s_mov_b32 s47, s64
  s_lshr_b32 s46, s47, 8
  s_and_b32 s46, s46, 0x2000
  s_xor_b32 s47, s47, s46
  s_add_u32 s46, s47, s27
  buffer_store_dwordx4 v[144:147], v1, s[8:11], s46 offen sc1
  buffer_store_dword v148, v14, s[8:11], s47 offen sc1
  s_add_u32 s64, s64, 262144
  s_cmp_ge_u32 s64, 16777216
  s_cselect_b32 s46, 2097152, 0
  s_sub_u32 s64, s64, s46
sc_nox:
  v_add_u32 v13, s22, v13
  s_sub_u32 s22, 0, s22
  s_add_u32 s58, s58, 1
  s_cmp_eq_u32 s58, 3
  s_cselect_b32 s58, 0, s58
  s_mov_b32 s52, s53
  s_cmp_lt_u32 s52, 64
  s_cbranch_scc1 sch_loop
  s_waitcnt vmcnt(0)
  s_cmp_ge_u32 s42, 2
  s_cbranch_scc1 L_end
  v_mov_b32 v136, s52
  s_mov_b64 exec, 1
  buffer_store_dword v136, v15, s[8:11], 0 offen sc1
  s_mov_b64 exec, -1
  s_endpgm
scs_ha:
  s_waitcnt lgkmcnt(0)
  ds_read_b128 v[56:59], v2 offset:0
  ds_read_b128 v[60:63], v2 offset:4096
  ds_read_b128 v[64:67], v2 offset:8192
  ds_read_b128 v[68:71], v2 offset:12288
  ds_read_b128 v[72:75], v2 offset:16384
  ds_read_b128 v[76:79], v2 offset:20480
  ds_read_b128 v[80:83], v2 offset:49152
  ds_read_b128 v[84:87], v2 offset:53248
  v_mov_b32 v88, 0
  v_mov_b32 v89, 0
  v_mov_b32 v90, 0
  v_mov_b32 v91, 0
  v_mov_b32 v92, 0
  v_mov_b32 v93, 0
  v_mov_b32 v94, 0
  v_mov_b32 v95, 0
  v_mov_b32 v96, 0
  v_mov_b32 v97, 0
  v_mov_b32 v98, 0
  v_mov_b32 v99, 0
  v_mov_b32 v100, 0
  v_mov_b32 v101, 0
  v_mov_b32 v102, 0
  v_mov_b32 v103, 0
  v_mov_b32 v104, 0
  v_mov_b32 v105, 0
  v_mov_b32 v106, 0
  v_mov_b32 v107, 0
  v_mov_b32 v108, 0
  v_mov_b32 v109, 0
  v_mov_b32 v110, 0
  v_mov_b32 v111, 0
scs_ra:
  buffer_load_dwordx4 v[16:19], v12, s[8:11], 0 offen offset:0 sc1
  buffer_load_dwordx4 v[20:23], v12, s[8:11], 0 offen offset:1024 sc1
  buffer_load_dwordx4 v[24:27], v12, s[8:11], 0 offen offset:2048 sc1
  s_add_u32 s50, s50, 1
  s_cmp_gt_u32 s50, 131072
  s_cbranch_scc1 L_fail
  s_waitcnt vmcnt(0) lgkmcnt(0)
  v_max3_u32 v136, v16, v20, v24
  v_cmp_eq_u32 vcc, -1, v136
  s_cbranch_vccnz scs_ra
  s_branch scs_go
scs_hb:
  s_waitcnt lgkmcnt(0)
  s_add_u32 s50, s50, 1
  s_cmp_gt_u32 s50, 131072
  s_cbranch_scc1 L_fail
  ds_read_b128 v[56:59], v2 offset:0
  ds_read_b128 v[60:63], v2 offset:4096
  ds_read_b128 v[64:67], v2 offset:8192
  ds_read_b128 v[68:71], v2 offset:12288
  ds_read_b128 v[72:75], v2 offset:16384
  ds_read_b128 v[76:79], v2 offset:20480
  ds_read_b128 v[80:83], v2 offset:49152
  ds_read_b128 v[84:87], v2 offset:53248
  v_mov_b32 v88, 0
  v_mov_b32 v89, 0
  v_mov_b32 v90, 0
  v_mov_b32 v91, 0
  v_mov_b32 v92, 0
  v_mov_b32 v93, 0
  v_mov_b32 v94, 0
  v_mov_b32 v95, 0
  v_mov_b32 v96, 0
  v_mov_b32 v97, 0
  v_mov_b32 v98, 0
  v_mov_b32 v99, 0
  v_mov_b32 v100, 0
  v_mov_b32 v101, 0
  v_mov_b32 v102, 0
  v_mov_b32 v103, 0
  v_mov_b32 v104, 0
  v_mov_b32 v105, 0
  v_mov_b32 v106, 0
  v_mov_b32 v107, 0
  v_mov_b32 v108, 0
  v_mov_b32 v109, 0
  v_mov_b32 v110, 0
  v_mov_b32 v111, 0
  s_waitcnt lgkmcnt(0)
  s_branch scs_top
scs_redo:
  s_waitcnt lgkmcnt(0)
  s_mov_b32 s50, 0
scs_poll:
  buffer_load_dwordx4 v[16:19], v12, s[8:11], 0 offen offset:0 sc1
  buffer_load_dwordx4 v[20:23], v12, s[8:11], 0 offen offset:1024 sc1
  buffer_load_dwordx4 v[24:27], v12, s[8:11], 0 offen offset:2048 sc1
  buffer_load_dwordx4 v[28:31], v12, s[8:11], 0 offen offset:3072 sc1
  buffer_load_dwordx4 v[32:35], v12, s[8:11], s24 offen offset:0 sc1
  buffer_load_dwordx4 v[36:39], v12, s[8:11], s24 offen offset:1024 sc1
  buffer_load_dwordx4 v[40:43], v12, s[8:11], s24 offen offset:2048 sc1
  buffer_load_dwordx4 v[44:47], v12, s[8:11], s24 offen offset:3072 sc1
  buffer_load_dwordx4 v[48:51], v12, s[8:11], s25 offen offset:0 sc1
  buffer_load_dwordx4 v[52:55], v12, s[8:11], s25 offen offset:1024 sc1
  s_add_u32 s50, s50, 1
  s_cmp_gt_u32 s50, 131072
  s_cbranch_scc1 L_fail
  s_waitcnt vmcnt(0) lgkmcnt(0)
  v_max_u32 v136, v16, v17
  v_max3_u32 v136, v18, v19, v136
  v_max3_u32 v136, v20, v21, v136
  v_max3_u32 v136, v22, v23, v136
  v_max3_u32 v136, v24, v25, v136
  v_max3_u32 v136, v26, v27, v136
  v_max3_u32 v136, v28, v29, v136
  v_max3_u32 v136, v30, v31, v136
  v_max3_u32 v136, v32, v33, v136
  v_max3_u32 v136, v34, v35, v136
  v_max3_u32 v136, v36, v37, v136
  v_max3_u32 v136, v38, v39, v136
  v_max3_u32 v136, v40, v41, v136
  v_max3_u32 v136, v42, v43, v136
  v_max3_u32 v136, v44, v45, v136
  v_max3_u32 v136, v46, v47, v136
  v_max3_u32 v136, v48, v49, v136
  v_max3_u32 v136, v50, v51, v136
  v_max3_u32 v136, v52, v53, v136
  v_max3_u32 v136, v54, v55, v136
  v_cmp_eq_u32 vcc, -1, v136
  s_cbranch_vccnz scs_poll
  s_mov_b64 s[16:17], 0
  ds_read_b128 v[56:59], v2 offset:0
  ds_read_b128 v[60:63], v2 offset:4096
  ds_read_b128 v[64:67], v2 offset:8192
  ds_read_b128 v[68:71], v2 offset:12288
  ds_read_b128 v[72:75], v2 offset:16384
  ds_read_b128 v[76:79], v2 offset:20480
  ds_read_b128 v[80:83], v2 offset:49152
  ds_read_b128 v[84:87], v2 offset:53248
  v_mov_b32 v88, 0
  v_mov_b32 v89, 0
  v_mov_b32 v90, 0
  v_mov_b32 v91, 0
  v_mov_b32 v92, 0
  v_mov_b32 v93, 0
  v_mov_b32 v94, 0
  v_mov_b32 v95, 0
  v_mov_b32 v96, 0
  v_mov_b32 v97, 0
  v_mov_b32 v98, 0
  v_mov_b32 v99, 0
  v_mov_b32 v100, 0
  v_mov_b32 v101, 0
  v_mov_b32 v102, 0
  v_mov_b32 v103, 0
  v_mov_b32 v104, 0
  v_mov_b32 v105, 0
  v_mov_b32 v106, 0
  v_mov_b32 v107, 0
  v_mov_b32 v108, 0
  v_mov_b32 v109, 0
  v_mov_b32 v110, 0
  v_mov_b32 v111, 0
  s_waitcnt lgkmcnt(0)
  v_smfmac_f32_16x16x64_bf16 v[88:91], v[16:19], a[192:199], v7
  v_smfmac_f32_16x16x64_bf16 v[92:95], v[16:19], a[200:207], v7
  v_smfmac_f32_16x16x64_bf16 v[96:99], v[16:19], a[208:215], v7
  v_smfmac_f32_16x16x64_bf16 v[100:103], v[16:19], v[56:63], v7
  v_smfmac_f32_16x16x64_bf16 v[104:107], v[16:19], v[64:71], v7
  ds_read_b128 v[56:59], v2 offset:57344
  v_smfmac_f32_16x16x64_bf16 v[108:111], v[16:19], v[72:79], v7
  ds_read_b128 v[60:63], v2 offset:61440
  v_smfmac_f32_16x16x64_bf16 v[88:91], v[20:23], a[216:223], v7
  ds_read_b128 v[64:67], v3 offset:0
  v_smfmac_f32_16x16x64_bf16 v[92:95], v[20:23], a[224:231], v7
  ds_read_b128 v[68:71], v3 offset:4096
  v_smfmac_f32_16x16x64_bf16 v[96:99], v[20:23], a[232:239], v7
  v_smfmac_f32_16x16x64_bf16 v[100:103], v[20:23], a[0:7], v7
  ds_read_b128 v[72:75], v3 offset:8192
  v_smfmac_f32_16x16x64_bf16 v[104:107], v[20:23], a[8:15], v7
  ds_read_b128 v[76:79], v3 offset:12288
  v_smfmac_f32_16x16x64_bf16 v[108:111], v[20:23], a[16:23], v7
  v_smfmac_f32_16x16x64_bf16 v[88:91], v[24:27], a[240:247], v7
  v_smfmac_f32_16x16x64_bf16 v[92:95], v[24:27], a[248:255], v7
  v_smfmac_f32_16x16x64_bf16 v[96:99], v[24:27], v[152:159], v7
  v_smfmac_f32_16x16x64_bf16 v[100:103], v[24:27], a[24:31], v7
  v_smfmac_f32_16x16x64_bf16 v[104:107], v[24:27], a[32:39], v7
  v_smfmac_f32_16x16x64_bf16 v[108:111], v[24:27], a[40:47], v7
  v_smfmac_f32_16x16x64_bf16 v[88:91], v[28:31], v[80:87], v7
  s_waitcnt lgkmcnt(0)
  v_smfmac_f32_16x16x64_bf16 v[92:95], v[28:31], v[56:63], v7
  v_smfmac_f32_16x16x64_bf16 v[96:99], v[28:31], v[64:71], v7
  v_smfmac_f32_16x16x64_bf16 v[88:91], v[32:35], v[160:167], v7
  ds_read_b128 v[80:83], v3 offset:32768
  ds_read_b128 v[16:19], v13 offset:8192
  v_smfmac_f32_16x16x64_bf16 v[92:95], v[32:35], v[168:175], v7
  ds_read_b128 v[84:87], v3 offset:36864
  ds_read_b128 v[20:23], v13 offset:10240
  v_smfmac_f32_16x16x64_bf16 v[96:99], v[32:35], v[176:183], v7
  ds_read_b128 v[56:59], v3 offset:16384
  ds_read_b128 v[24:27], v13 offset:9216
  v_smfmac_f32_16x16x64_bf16 v[88:91], v[36:39], v[184:191], v7
  v_smfmac_f32_16x16x64_bf16 v[92:95], v[36:39], v[192:199], v7
  ds_read_b128 v[60:63], v3 offset:20480
  v_smfmac_f32_16x16x64_bf16 v[96:99], v[36:39], v[200:207], v7
  ds_read_b128 v[64:67], v3 offset:40960
  v_smfmac_f32_16x16x64_bf16 v[88:91], v[44:47], v[208:215], v7
  ds_read_b128 v[68:71], v3 offset:45056
  v_smfmac_f32_16x16x64_bf16 v[88:91], v[48:51], v[232:239], v7
  v_smfmac_f32_16x16x64_bf16 v[88:91], v[40:43], v[72:79], v7
  s_waitcnt lgkmcnt(3)
  v_smfmac_f32_16x16x64_bf16 v[88:91], v[52:55], v[80:87], v7
  ds_read_b128 v[72:75], v3 offset:24576
  s_waitcnt lgkmcnt(0)
  s_branch scs_join
sch_ha:
  s_waitcnt lgkmcnt(0)
  ds_read_b128 v[56:59], v2 offset:0
  ds_read_b128 v[60:63], v2 offset:4096
  ds_read_b128 v[64:67], v2 offset:8192
  ds_read_b128 v[68:71], v2 offset:12288
  ds_read_b128 v[72:75], v2 offset:16384
  ds_read_b128 v[76:79], v2 offset:20480
  ds_read_b128 v[80:83], v2 offset:49152
  ds_read_b128 v[84:87], v2 offset:53248
  v_mov_b32 v88, 0
  v_mov_b32 v89, 0
  v_mov_b32 v90, 0
  v_mov_b32 v91, 0
  v_mov_b32 v92, 0
  v_mov_b32 v93, 0
  v_mov_b32 v94, 0
  v_mov_b32 v95, 0
  v_mov_b32 v96, 0
  v_mov_b32 v97, 0
  v_mov_b32 v98, 0
  v_mov_b32 v99, 0
  v_mov_b32 v100, 0
  v_mov_b32 v101, 0
  v_mov_b32 v102, 0
  v_mov_b32 v103, 0
  v_mov_b32 v104, 0
  v_mov_b32 v105, 0
  v_mov_b32 v106, 0
  v_mov_b32 v107, 0
  v_mov_b32 v108, 0
  v_mov_b32 v109, 0
  v_mov_b32 v110, 0
  v_mov_b32 v111, 0
sch_ra:
  buffer_load_dwordx4 v[16:19], v12, s[8:11], 0 offen offset:0 sc1
  buffer_load_dwordx4 v[20:23], v12, s[8:11], 0 offen offset:1024 sc1
  buffer_load_dwordx4 v[24:27], v12, s[8:11], 0 offen offset:2048 sc1
  s_add_u32 s50, s50, 1
  s_cmp_gt_u32 s50, 131072
  s_cbranch_scc1 L_fail
  s_waitcnt vmcnt(0) lgkmcnt(0)
  v_max3_u32 v136, v16, v20, v24
  v_cmp_eq_u32 vcc, -1, v136
  s_cbranch_vccnz sch_ra
  s_branch sch_go
sch_hb:
  s_waitcnt lgkmcnt(0)
  s_add_u32 s50, s50, 1
  s_cmp_gt_u32 s50, 131072
  s_cbranch_scc1 L_fail
  ds_read_b128 v[56:59], v2 offset:0
  ds_read_b128 v[60:63], v2 offset:4096
  ds_read_b128 v[64:67], v2 offset:8192
  ds_read_b128 v[68:71], v2 offset:12288
  ds_read_b128 v[72:75], v2 offset:16384
  ds_read_b128 v[76:79], v2 offset:20480
  ds_read_b128 v[80:83], v2 offset:49152
  ds_read_b128 v[84:87], v2 offset:53248
  v_mov_b32 v88, 0
  v_mov_b32 v89, 0
  v_mov_b32 v90, 0
  v_mov_b32 v91, 0
  v_mov_b32 v92, 0
  v_mov_b32 v93, 0
  v_mov_b32 v94, 0
  v_mov_b32 v95, 0
  v_mov_b32 v96, 0
  v_mov_b32 v97, 0
  v_mov_b32 v98, 0
  v_mov_b32 v99, 0
  v_mov_b32 v100, 0
  v_mov_b32 v101, 0
  v_mov_b32 v102, 0
  v_mov_b32 v103, 0
  v_mov_b32 v104, 0
  v_mov_b32 v105, 0
  v_mov_b32 v106, 0
  v_mov_b32 v107, 0
  v_mov_b32 v108, 0
  v_mov_b32 v109, 0
  v_mov_b32 v110, 0
  v_mov_b32 v111, 0
  s_waitcnt lgkmcnt(0)
  s_branch sch_top
sch_redo:
  s_waitcnt lgkmcnt(0)
  s_mov_b32 s50, 0
sch_poll:
  buffer_load_dwordx4 v[16:19], v12, s[8:11], 0 offen offset:0 sc1
  buffer_load_dwordx4 v[20:23], v12, s[8:11], 0 offen offset:1024 sc1
  buffer_load_dwordx4 v[24:27], v12, s[8:11], 0 offen offset:2048 sc1
  buffer_load_dwordx4 v[28:31], v12, s[8:11], 0 offen offset:3072 sc1
  buffer_load_dwordx4 v[32:35], v12, s[8:11], s24 offen offset:0 sc1
  buffer_load_dwordx4 v[36:39], v12, s[8:11], s24 offen offset:1024 sc1
  buffer_load_dwordx4 v[40:43], v12, s[8:11], s24 offen offset:2048 sc1
  buffer_load_dwordx4 v[44:47], v12, s[8:11], s24 offen offset:3072 sc1
  buffer_load_dwordx4 v[48:51], v12, s[8:11], s25 offen offset:0 sc1
  buffer_load_dwordx4 v[52:55], v12, s[8:11], s25 offen offset:1024 sc1
  s_add_u32 s50, s50, 1
  s_cmp_gt_u32 s50, 131072
  s_cbranch_scc1 L_fail
  s_waitcnt vmcnt(0) lgkmcnt(0)
  v_max_u32 v136, v16, v17
  v_max3_u32 v136, v18, v19, v136
  v_max3_u32 v136, v20, v21, v136
  v_max3_u32 v136, v22, v23, v136
  v_max3_u32 v136, v24, v25, v136
  v_max3_u32 v136, v26, v27, v136
  v_max3_u32 v136, v28, v29, v136
  v_max3_u32 v136, v30, v31, v136
  v_max3_u32 v136, v32, v33, v136
  v_max3_u32 v136, v34, v35, v136
  v_max3_u32 v136, v36, v37, v136
  v_max3_u32 v136, v38, v39, v136
  v_max3_u32 v136, v40, v41, v136
  v_max3_u32 v136, v42, v43, v136
  v_max3_u32 v136, v44, v45, v136
  v_max3_u32 v136, v46, v47, v136
  v_max3_u32 v136, v48, v49, v136
  v_max3_u32 v136, v50, v51, v136
  v_max3_u32 v136, v52, v53, v136
  v_max3_u32 v136, v54, v55, v136
  v_cmp_eq_u32 vcc, -1, v136
  s_cbranch_vccnz sch_poll
  s_mov_b64 s[16:17], 0
  ds_read_b128 v[56:59], v2 offset:0
  ds_read_b128 v[60:63], v2 offset:4096
  ds_read_b128 v[64:67], v2 offset:8192
  ds_read_b128 v[68:71], v2 offset:12288
  ds_read_b128 v[72:75], v2 offset:16384
  ds_read_b128 v[76:79], v2 offset:20480
  ds_read_b128 v[80:83], v2 offset:49152
  ds_read_b128 v[84:87], v2 offset:53248
  v_mov_b32 v88, 0
  v_mov_b32 v89, 0
  v_mov_b32 v90, 0
  v_mov_b32 v91, 0
  v_mov_b32 v92, 0
  v_mov_b32 v93, 0
  v_mov_b32 v94, 0
  v_mov_b32 v95, 0
  v_mov_b32 v96, 0
  v_mov_b32 v97, 0
  v_mov_b32 v98, 0
  v_mov_b32 v99, 0
  v_mov_b32 v100, 0
  v_mov_b32 v101, 0
  v_mov_b32 v102, 0
  v_mov_b32 v103, 0
  v_mov_b32 v104, 0
  v_mov_b32 v105, 0
  v_mov_b32 v106, 0
  v_mov_b32 v107, 0
  v_mov_b32 v108, 0
  v_mov_b32 v109, 0
  v_mov_b32 v110, 0
  v_mov_b32 v111, 0
  s_waitcnt lgkmcnt(0)
  v_smfmac_f32_16x16x64_bf16 v[88:91], v[16:19], a[192:199], v7
  v_smfmac_f32_16x16x64_bf16 v[92:95], v[16:19], a[200:207], v7
  v_smfmac_f32_16x16x64_bf16 v[96:99], v[16:19], a[208:215], v7
  v_smfmac_f32_16x16x64_bf16 v[100:103], v[16:19], v[56:63], v7
  v_smfmac_f32_16x16x64_bf16 v[104:107], v[16:19], v[64:71], v7
  ds_read_b128 v[56:59], v2 offset:57344
  v_smfmac_f32_16x16x64_bf16 v[108:111], v[16:19], v[72:79], v7
  ds_read_b128 v[60:63], v2 offset:61440
  v_smfmac_f32_16x16x64_bf16 v[88:91], v[20:23], a[216:223], v7
  ds_read_b128 v[64:67], v3 offset:0
  v_smfmac_f32_16x16x64_bf16 v[92:95], v[20:23], a[224:231], v7
  ds_read_b128 v[68:71], v3 offset:4096
  v_smfmac_f32_16x16x64_bf16 v[96:99], v[20:23], a[232:239], v7
  v_smfmac_f32_16x16x64_bf16 v[100:103], v[20:23], a[0:7], v7
  ds_read_b128 v[72:75], v3 offset:8192
  v_smfmac_f32_16x16x64_bf16 v[104:107], v[20:23], a[8:15], v7
  ds_read_b128 v[76:79], v3 offset:12288
  v_smfmac_f32_16x16x64_bf16 v[108:111], v[20:23], a[16:23], v7
  v_smfmac_f32_16x16x64_bf16 v[88:91], v[24:27], a[240:247], v7
  v_smfmac_f32_16x16x64_bf16 v[92:95], v[24:27], a[248:255], v7
  v_smfmac_f32_16x16x64_bf16 v[96:99], v[24:27], v[152:159], v7
  v_smfmac_f32_16x16x64_bf16 v[100:103], v[24:27], a[24:31], v7
  v_smfmac_f32_16x16x64_bf16 v[104:107], v[24:27], a[32:39], v7
  v_smfmac_f32_16x16x64_bf16 v[108:111], v[24:27], a[40:47], v7
  v_smfmac_f32_16x16x64_bf16 v[88:91], v[28:31], v[80:87], v7
  s_waitcnt lgkmcnt(0)
  v_smfmac_f32_16x16x64_bf16 v[92:95], v[28:31], v[56:63], v7
  v_smfmac_f32_16x16x64_bf16 v[96:99], v[28:31], v[64:71], v7
  v_smfmac_f32_16x16x64_bf16 v[88:91], v[32:35], v[160:167], v7
  ds_read_b128 v[80:83], v3 offset:32768
  v_smfmac_f32_16x16x64_bf16 v[92:95], v[32:35], v[168:175], v7
  ds_read_b128 v[84:87], v3 offset:36864
  v_smfmac_f32_16x16x64_bf16 v[96:99], v[32:35], v[176:183], v7
  ds_read_b128 v[56:59], v3 offset:16384
  v_smfmac_f32_16x16x64_bf16 v[88:91], v[36:39], v[184:191], v7
  v_smfmac_f32_16x16x64_bf16 v[92:95], v[36:39], v[192:199], v7
  ds_read_b128 v[60:63], v3 offset:20480
  v_smfmac_f32_16x16x64_bf16 v[96:99], v[36:39], v[200:207], v7
  ds_read_b128 v[64:67], v3 offset:40960
  v_smfmac_f32_16x16x64_bf16 v[88:91], v[44:47], v[208:215], v7
  ds_read_b128 v[68:71], v3 offset:45056
  v_smfmac_f32_16x16x64_bf16 v[88:91], v[48:51], v[232:239], v7
  v_smfmac_f32_16x16x64_bf16 v[88:91], v[40:43], v[72:79], v7
  s_waitcnt lgkmcnt(3)
  v_smfmac_f32_16x16x64_bf16 v[88:91], v[52:55], v[80:87], v7
  ds_read_b128 v[72:75], v3 offset:24576
  s_mov_b32 m0, s21
  s_waitcnt lgkmcnt(0)
  s_branch sch_join
L_value:
  s_mov_b32 s4, s30
  s_mov_b32 s5, s31
  s_mov_b32 s6, 7864320
  s_mov_b32 s7, 0x20000
  s_mov_b32 s12, s32
  s_mov_b32 s13, s33
  s_mov_b32 s14, 7864320
  s_mov_b32 s15, 0x20000
  v_lshrrev_b32 v148, 3, v0
  v_lshrrev_b32 v149, 2, v148
  v_lshlrev_b32 v149, 3, v149
  v_and_b32 v64, 3, v148
  v_add_u32 v64, v64, v149
  s_and_b32 s46, s42, 1
  s_lshl_b32 s46, s46, 2
  s_lshr_b32 s47, s42, 1
  s_lshl_b32 s47, s47, 4
  s_add_u32 s46, s46, s47
  v_add_u32 v64, s46, v64
  v_mul_u32_u24 v64, 12288, v64
  v_lshrrev_b32 v148, 1, v148
  v_bfe_u32 v149, v0, 1, 2
  v_xor_b32 v148, v148, v149
  v_lshlrev_b32 v148, 5, v148
  v_and_b32 v149, 1, v0
  v_lshlrev_b32 v149, 4, v149
  v_add3_u32 v64, v64, v148, v149
  v_lshrrev_b32 v148, 3, v0
  v_lshrrev_b32 v149, 2, v148
  v_lshlrev_b32 v149, 3, v149
  v_and_b32 v65, 3, v148
  v_add_u32 v65, v65, v149
  s_and_b32 s46, s42, 1
  s_lshl_b32 s46, s46, 2
  s_lshr_b32 s47, s42, 1
  s_lshl_b32 s47, s47, 4
  s_add_u32 s46, s46, s47
  v_add_u32 v65, s46, v65
  v_mul_u32_u24 v65, 1280, v65
  v_lshrrev_b32 v148, 1, v148
  v_bfe_u32 v149, v0, 1, 2
  v_xor_b32 v148, v148, v149
  v_lshlrev_b32 v148, 5, v148
  v_and_b32 v149, 1, v0
  v_lshlrev_b32 v149, 4, v149
  v_add3_u32 v65, v65, v148, v149
  v_lshrrev_b32 v148, 5, v0
  v_lshlrev_b32 v66, 11, v148
  v_bfe_u32 v148, v0, 2, 3
  v_lshl_add_u32 v66, v148, 7, v66
  v_lshrrev_b32 v148, 1, v148
  v_xor_b32 v148, s42, v148
  v_lshl_add_u32 v66, v148, 5, v66
  v_and_b32 v148, 3, v0
  v_lshl_add_u32 v66, v148, 3, v66
  v_add_u32 v67, 0x10000, v66
  v_add_u32 v68, 0x20000, v66
  v_lshlrev_b32 v1, 4, v0
  v_add_u32 v2, s51, v1
  v_add_u32 v3, 0x10000, v2
  s_mul_i32 s62, s45, 384
  s_mul_i32 s63, s45, 245760
  s_mov_b32 s24, 4096
  s_mov_b32 s25, 49152
  s_add_u32 m0, s51, 73728
  s_add_u32 s46, s62, 786432
  buffer_load_dwordx4 v64, s[4:7], s46 offen  lds
  s_add_u32 m0, s51, 77824
  s_add_u32 s46, s62, 1179648
  buffer_load_dwordx4 v64, s[4:7], s46 offen  lds
  s_add_u32 m0, s51, 81920
  s_add_u32 s46, s62, 786560
  buffer_load_dwordx4 v64, s[4:7], s46 offen  lds
  s_add_u32 m0, s51, 86016
  s_add_u32 s46, s62, 1179776
  buffer_load_dwordx4 v64, s[4:7], s46 offen  lds
  s_add_u32 m0, s51, 90112
  s_add_u32 s46, s62, 786688
  buffer_load_dwordx4 v64, s[4:7], s46 offen  lds
  s_add_u32 m0, s51, 94208
  s_add_u32 s46, s62, 1179904
  buffer_load_dwordx4 v64, s[4:7], s46 offen  lds
  s_add_u32 m0, s51, 98304
  s_add_u32 s46, s62, 1572864
  buffer_load_dwordx4 v64, s[4:7], s46 offen  lds
  s_add_u32 m0, s51, 102400
  s_add_u32 s46, s62, 1966080
  buffer_load_dwordx4 v64, s[4:7], s46 offen  lds
  s_add_u32 m0, s51, 106496
  s_add_u32 s46, s62, 1572992
  buffer_load_dwordx4 v64, s[4:7], s46 offen  lds
  s_add_u32 m0, s51, 110592
  s_add_u32 s46, s62, 1966208
  buffer_load_dwordx4 v64, s[4:7], s46 offen  lds
  s_add_u32 m0, s51, 114688
  s_add_u32 s46, s62, 1573120
  buffer_load_dwordx4 v64, s[4:7], s46 offen  lds
  s_add_u32 m0, s51, 118784
  s_add_u32 s46, s62, 1966336
  buffer_load_dwordx4 v64, s[4:7], s46 offen  lds
  s_add_u32 m0, s51, 122880
  s_add_u32 s46, s62, 2359296
  buffer_load_dwordx4 v64, s[4:7], s46 offen  lds
  s_add_u32 m0, s51, 126976
  s_add_u32 s46, s62, 2752512
  buffer_load_dwordx4 v64, s[4:7], s46 offen  lds
  s_add_u32 m0, s51, 131072
  s_add_u32 s46, s62, 2359424
  buffer_load_dwordx4 v64, s[4:7], s46 offen  lds
  s_add_u32 m0, s51, 135168
  s_add_u32 s46, s62, 2752640
  buffer_load_dwordx4 v64, s[4:7], s46 offen  lds
  s_add_u32 m0, s51, 139264
  s_add_u32 s46, s62, 2359552
  buffer_load_dwordx4 v64, s[4:7], s46 offen  lds
  s_add_u32 m0, s51, 143360
  s_add_u32 s46, s62, 2752768
  buffer_load_dwordx4 v64, s[4:7], s46 offen  lds
  s_add_u32 m0, s51, 0
  s_add_u32 s46, s62, 3932160
  buffer_load_dwordx4 v64, s[4:7], s46 offen  lds
  s_add_u32 m0, s51, 4096
  s_add_u32 s46, s62, 4325376
  buffer_load_dwordx4 v64, s[4:7], s46 offen  lds
  s_add_u32 m0, s51, 8192
  s_add_u32 s46, s62, 3932288
  buffer_load_dwordx4 v64, s[4:7], s46 offen  lds
  s_add_u32 m0, s51, 12288
  s_add_u32 s46, s62, 4325504
  buffer_load_dwordx4 v64, s[4:7], s46 offen  lds
  s_add_u32 m0, s51, 16384
  s_add_u32 s46, s62, 3932416
  buffer_load_dwordx4 v64, s[4:7], s46 offen  lds
  s_add_u32 m0, s51, 20480
  s_add_u32 s46, s62, 4325632
  buffer_load_dwordx4 v64, s[4:7], s46 offen  lds
  s_add_u32 m0, s51, 24576
  s_add_u32 s46, s62, 4718592
  buffer_load_dwordx4 v64, s[4:7], s46 offen  lds
  s_add_u32 m0, s51, 28672
  s_add_u32 s46, s62, 5111808
  buffer_load_dwordx4 v64, s[4:7], s46 offen  lds
  s_add_u32 m0, s51, 32768
  s_add_u32 s46, s62, 4718720
  buffer_load_dwordx4 v64, s[4:7], s46 offen  lds
  s_add_u32 m0, s51, 36864
  s_add_u32 s46, s62, 5111936
  buffer_load_dwordx4 v64, s[4:7], s46 offen  lds
  s_add_u32 m0, s51, 40960
  s_add_u32 s46, s62, 4718848
  buffer_load_dwordx4 v64, s[4:7], s46 offen  lds
  s_add_u32 m0, s51, 45056
  s_add_u32 s46, s62, 5112064
  buffer_load_dwordx4 v64, s[4:7], s46 offen  lds
  s_waitcnt vmcnt(24)
  s_barrier
  s_add_u32 m0, s51, 49152
  s_add_u32 s46, s62, 5505024
  buffer_load_dwordx4 v64, s[4:7], s46 offen  lds
  s_add_u32 m0, s51, 53248
  s_add_u32 s46, s62, 5898240
  buffer_load_dwordx4 v64, s[4:7], s46 offen  lds
  s_add_u32 m0, s51, 57344
  s_add_u32 s46, s62, 5505152
  buffer_load_dwordx4 v64, s[4:7], s46 offen  lds
  s_add_u32 m0, s51, 61440
  s_add_u32 s46, s62, 5898368
  buffer_load_dwordx4 v64, s[4:7], s46 offen  lds
  s_add_u32 m0, s51, 65536
  s_add_u32 s46, s62, 5505280
  buffer_load_dwordx4 v64, s[4:7], s46 offen  lds
  s_add_u32 m0, s51, 69632
  s_add_u32 s46, s62, 5898496
  buffer_load_dwordx4 v64, s[4:7], s46 offen  lds
  ds_read_b64_tr_b16 a[0:1], v67 offset:8192
  ds_read_b64_tr_b16 a[2:3], v67 offset:9216
  ds_read_b64_tr_b16 a[4:5], v67 offset:12288
  ds_read_b64_tr_b16 a[6:7], v67 offset:13312
  ds_read_b64_tr_b16 a[8:9], v67 offset:16384
  ds_read_b64_tr_b16 a[10:11], v67 offset:17408
  ds_read_b64_tr_b16 a[12:13], v67 offset:20480
  ds_read_b64_tr_b16 a[14:15], v67 offset:21504
  ds_read_b64_tr_b16 a[16:17], v67 offset:24576
  ds_read_b64_tr_b16 a[18:19], v67 offset:25600
  ds_read_b64_tr_b16 a[20:21], v67 offset:28672
  ds_read_b64_tr_b16 a[22:23], v67 offset:29696
  s_waitcnt lgkmcnt(0)
  s_waitcnt vmcnt(24)
  s_barrier
  s_add_u32 m0, s51, 73728
  s_add_u32 s46, s62, 7077888
  buffer_load_dwordx4 v64, s[4:7], s46 offen  lds
  s_add_u32 m0, s51, 77824
  s_add_u32 s46, s62, 7471104
  buffer_load_dwordx4 v64, s[4:7], s46 offen  lds
  s_add_u32 m0, s51, 81920
  s_add_u32 s46, s62, 7078016
  buffer_load_dwordx4 v64, s[4:7], s46 offen  lds
  s_add_u32 m0, s51, 86016
  s_add_u32 s46, s62, 7471232
  buffer_load_dwordx4 v64, s[4:7], s46 offen  lds
  s_add_u32 m0, s51, 90112
  s_add_u32 s46, s62, 7078144
  buffer_load_dwordx4 v64, s[4:7], s46 offen  lds
  s_add_u32 m0, s51, 94208
  s_add_u32 s46, s62, 7471360
  buffer_load_dwordx4 v64, s[4:7], s46 offen  lds
  ds_read_b64_tr_b16 a[24:25], v67 offset:32768
  ds_read_b64_tr_b16 a[26:27], v67 offset:33792
  ds_read_b64_tr_b16 a[28:29], v67 offset:36864
  ds_read_b64_tr_b16 a[30:31], v67 offset:37888
  ds_read_b64_tr_b16 a[32:33], v67 offset:40960
  ds_read_b64_tr_b16 a[34:35], v67 offset:41984
  ds_read_b64_tr_b16 a[36:37], v67 offset:45056
  ds_read_b64_tr_b16 a[38:39], v67 offset:46080
  ds_read_b64_tr_b16 a[40:41], v67 offset:49152
  ds_read_b64_tr_b16 a[42:43], v67 offset:50176
  ds_read_b64_tr_b16 a[44:45], v67 offset:53248
  ds_read_b64_tr_b16 a[46:47], v67 offset:54272
  s_waitcnt lgkmcnt(0)
  s_waitcnt vmcnt(24)
  s_barrier
  s_add_u32 m0, s51, 98304
  s_add_u32 s46, s63, 0
  buffer_load_dwordx4 v65, s[12:15], s46 offen  lds
  s_add_u32 m0, s51, 102400
  s_add_u32 s46, s63, 40960
  buffer_load_dwordx4 v65, s[12:15], s46 offen  lds
  s_add_u32 m0, s51, 106496
  s_add_u32 s46, s63, 81920
  buffer_load_dwordx4 v65, s[12:15], s46 offen  lds
  s_add_u32 m0, s51, 110592
  s_add_u32 s46, s63, 122880
  buffer_load_dwordx4 v65, s[12:15], s46 offen  lds
  s_add_u32 m0, s51, 114688
  s_add_u32 s46, s63, 163840
  buffer_load_dwordx4 v65, s[12:15], s46 offen  lds
  s_add_u32 m0, s51, 118784
  s_add_u32 s46, s63, 204800
  buffer_load_dwordx4 v65, s[12:15], s46 offen  lds
  ds_read_b64_tr_b16 a[48:49], v67 offset:57344
  ds_read_b64_tr_b16 a[50:51], v67 offset:58368
  ds_read_b64_tr_b16 a[52:53], v67 offset:61440
  ds_read_b64_tr_b16 a[54:55], v67 offset:62464
  ds_read_b64_tr_b16 a[56:57], v68 offset:0
  ds_read_b64_tr_b16 a[58:59], v68 offset:1024
  ds_read_b64_tr_b16 a[60:61], v68 offset:4096
  ds_read_b64_tr_b16 a[62:63], v68 offset:5120
  ds_read_b64_tr_b16 a[64:65], v68 offset:8192
  ds_read_b64_tr_b16 a[66:67], v68 offset:9216
  ds_read_b64_tr_b16 a[68:69], v68 offset:12288
  ds_read_b64_tr_b16 a[70:71], v68 offset:13312
  s_waitcnt lgkmcnt(0)
  s_waitcnt vmcnt(24)
  s_barrier
  s_add_u32 m0, s51, 122880
  s_add_u32 s46, s63, 128
  buffer_load_dwordx4 v65, s[12:15], s46 offen  lds
  s_add_u32 m0, s51, 126976
  s_add_u32 s46, s63, 41088
  buffer_load_dwordx4 v65, s[12:15], s46 offen  lds
  s_add_u32 m0, s51, 131072
  s_add_u32 s46, s63, 82048
  buffer_load_dwordx4 v65, s[12:15], s46 offen  lds
  s_add_u32 m0, s51, 135168
  s_add_u32 s46, s63, 123008
  buffer_load_dwordx4 v65, s[12:15], s46 offen  lds
  s_add_u32 m0, s51, 139264
  s_add_u32 s46, s63, 163968
  buffer_load_dwordx4 v65, s[12:15], s46 offen  lds
  s_add_u32 m0, s51, 143360
  s_add_u32 s46, s63, 204928
  buffer_load_dwordx4 v65, s[12:15], s46 offen  lds
  ds_read_b64_tr_b16 a[72:73], v66 offset:0
  ds_read_b64_tr_b16 a[74:75], v66 offset:1024
  ds_read_b64_tr_b16 a[76:77], v66 offset:4096
  ds_read_b64_tr_b16 a[78:79], v66 offset:5120
  ds_read_b64_tr_b16 a[80:81], v66 offset:8192
  ds_read_b64_tr_b16 a[82:83], v66 offset:9216
  ds_read_b64_tr_b16 a[84:85], v66 offset:12288
  ds_read_b64_tr_b16 a[86:87], v66 offset:13312
  ds_read_b64_tr_b16 a[88:89], v66 offset:16384
  ds_read_b64_tr_b16 a[90:91], v66 offset:17408
  ds_read_b64_tr_b16 a[92:93], v66 offset:20480
  ds_read_b64_tr_b16 a[94:95], v66 offset:21504
  s_waitcnt lgkmcnt(0)
  s_waitcnt vmcnt(24)
  s_barrier
  s_add_u32 m0, s51, 0
  s_add_u32 s46, s63, 256
  buffer_load_dwordx4 v65, s[12:15], s46 offen  lds
  s_add_u32 m0, s51, 4096
  s_add_u32 s46, s63, 41216
  buffer_load_dwordx4 v65, s[12:15], s46 offen  lds
  s_add_u32 m0, s51, 8192
  s_add_u32 s46, s63, 82176
  buffer_load_dwordx4 v65, s[12:15], s46 offen  lds
  s_add_u32 m0, s51, 12288
  s_add_u32 s46, s63, 123136
  buffer_load_dwordx4 v65, s[12:15], s46 offen  lds
  s_add_u32 m0, s51, 16384
  s_add_u32 s46, s63, 164096
  buffer_load_dwordx4 v65, s[12:15], s46 offen  lds
  s_add_u32 m0, s51, 20480
  s_add_u32 s46, s63, 205056
  buffer_load_dwordx4 v65, s[12:15], s46 offen  lds
  ds_read_b64_tr_b16 a[96:97], v66 offset:24576
  ds_read_b64_tr_b16 a[98:99], v66 offset:25600
  ds_read_b64_tr_b16 a[100:101], v66 offset:28672
  ds_read_b64_tr_b16 a[102:103], v66 offset:29696
  ds_read_b64_tr_b16 a[104:105], v66 offset:32768
  ds_read_b64_tr_b16 a[106:107], v66 offset:33792
  ds_read_b64_tr_b16 a[108:109], v66 offset:36864
  ds_read_b64_tr_b16 a[110:111], v66 offset:37888
  ds_read_b64_tr_b16 a[112:113], v66 offset:40960
  ds_read_b64_tr_b16 a[114:115], v66 offset:41984
  ds_read_b64_tr_b16 a[116:117], v66 offset:45056
  ds_read_b64_tr_b16 a[118:119], v66 offset:46080
  s_waitcnt lgkmcnt(0)
  s_waitcnt vmcnt(24)
  s_barrier
  s_add_u32 m0, s51, 24576
  s_add_u32 s46, s63, 512
  buffer_load_dwordx4 v65, s[12:15], s46 offen  lds
  s_add_u32 m0, s51, 28672
  s_add_u32 s46, s63, 41472
  buffer_load_dwordx4 v65, s[12:15], s46 offen  lds
  s_add_u32 m0, s51, 32768
  s_add_u32 s46, s63, 82432
  buffer_load_dwordx4 v65, s[12:15], s46 offen  lds
  s_add_u32 m0, s51, 36864
  s_add_u32 s46, s63, 123392
  buffer_load_dwordx4 v65, s[12:15], s46 offen  lds
  s_add_u32 m0, s51, 40960
  s_add_u32 s46, s63, 164352
  buffer_load_dwordx4 v65, s[12:15], s46 offen  lds
  s_add_u32 m0, s51, 45056
  s_add_u32 s46, s63, 205312
  buffer_load_dwordx4 v65, s[12:15], s46 offen  lds
  ds_read_b64_tr_b16 a[120:121], v66 offset:49152
  ds_read_b64_tr_b16 a[122:123], v66 offset:50176
  ds_read_b64_tr_b16 a[124:125], v66 offset:53248
  ds_read_b64_tr_b16 a[126:127], v66 offset:54272
  ds_read_b64_tr_b16 a[128:129], v66 offset:57344
  ds_read_b64_tr_b16 a[130:131], v66 offset:58368
  ds_read_b64_tr_b16 a[132:133], v66 offset:61440
  ds_read_b64_tr_b16 a[134:135], v66 offset:62464
  ds_read_b64_tr_b16 a[136:137], v67 offset:0
  ds_read_b64_tr_b16 a[138:139], v67 offset:1024
  ds_read_b64_tr_b16 a[140:141], v67 offset:4096
  ds_read_b64_tr_b16 a[142:143], v67 offset:5120
  s_waitcnt lgkmcnt(0)
  s_waitcnt vmcnt(24)
  s_barrier
  s_add_u32 m0, s51, 49152
  s_add_u32 s46, s63, 640
  buffer_load_dwordx4 v65, s[12:15], s46 offen  lds
  s_add_u32 m0, s51, 53248
  s_add_u32 s46, s63, 41600
  buffer_load_dwordx4 v65, s[12:15], s46 offen  lds
  s_add_u32 m0, s51, 57344
  s_add_u32 s46, s63, 82560
  buffer_load_dwordx4 v65, s[12:15], s46 offen  lds
  s_add_u32 m0, s51, 61440
  s_add_u32 s46, s63, 123520
  buffer_load_dwordx4 v65, s[12:15], s46 offen  lds
  s_add_u32 m0, s51, 65536
  s_add_u32 s46, s63, 164480
  buffer_load_dwordx4 v65, s[12:15], s46 offen  lds
  s_add_u32 m0, s51, 69632
  s_add_u32 s46, s63, 205440
  buffer_load_dwordx4 v65, s[12:15], s46 offen  lds
  ds_read_b64_tr_b16 a[144:145], v67 offset:8192
  ds_read_b64_tr_b16 a[146:147], v67 offset:9216
  ds_read_b64_tr_b16 a[148:149], v67 offset:12288
  ds_read_b64_tr_b16 a[150:151], v67 offset:13312
  ds_read_b64_tr_b16 a[152:153], v67 offset:16384
  ds_read_b64_tr_b16 a[154:155], v67 offset:17408
  ds_read_b64_tr_b16 a[156:157], v67 offset:20480
  ds_read_b64_tr_b16 a[158:159], v67 offset:21504
  ds_read_b64_tr_b16 a[160:161], v67 offset:24576
  ds_read_b64_tr_b16 a[162:163], v67 offset:25600
  ds_read_b64_tr_b16 a[164:165], v67 offset:28672
  ds_read_b64_tr_b16 a[166:167], v67 offset:29696
  s_waitcnt lgkmcnt(0)
  s_waitcnt vmcnt(24)
  s_barrier
  s_add_u32 m0, s51, 73728
  s_add_u32 s46, s63, 768
  buffer_load_dwordx4 v65, s[12:15], s46 offen  lds
  s_add_u32 m0, s51, 77824
  s_add_u32 s46, s63, 41728
  buffer_load_dwordx4 v65, s[12:15], s46 offen  lds
  s_add_u32 m0, s51, 81920
  s_add_u32 s46, s63, 82688
  buffer_load_dwordx4 v65, s[12:15], s46 offen  lds
  s_add_u32 m0, s51, 86016
  s_add_u32 s46, s63, 123648
  buffer_load_dwordx4 v65, s[12:15], s46 offen  lds
  s_add_u32 m0, s51, 90112
  s_add_u32 s46, s63, 164608
  buffer_load_dwordx4 v65, s[12:15], s46 offen  lds
  s_add_u32 m0, s51, 94208
  s_add_u32 s46, s63, 205568
  buffer_load_dwordx4 v65, s[12:15], s46 offen  lds
  ds_read_b64_tr_b16 a[168:169], v67 offset:32768
  ds_read_b64_tr_b16 a[170:171], v67 offset:33792
  ds_read_b64_tr_b16 a[172:173], v67 offset:36864
  ds_read_b64_tr_b16 a[174:175], v67 offset:37888
  ds_read_b64_tr_b16 a[176:177], v67 offset:40960
  ds_read_b64_tr_b16 a[178:179], v67 offset:41984
  ds_read_b64_tr_b16 a[180:181], v67 offset:45056
  ds_read_b64_tr_b16 a[182:183], v67 offset:46080
  ds_read_b64_tr_b16 a[184:185], v67 offset:49152
  ds_read_b64_tr_b16 a[186:187], v67 offset:50176
  ds_read_b64_tr_b16 a[188:189], v67 offset:53248
  ds_read_b64_tr_b16 a[190:191], v67 offset:54272
  s_waitcnt lgkmcnt(0)
  s_waitcnt vmcnt(24)
  s_barrier
  s_add_u32 m0, s51, 98304
  s_add_u32 s46, s63, 896
  buffer_load_dwordx4 v65, s[12:15], s46 offen  lds
  s_add_u32 m0, s51, 102400
  s_add_u32 s46, s63, 41856
  buffer_load_dwordx4 v65, s[12:15], s46 offen  lds
  s_add_u32 m0, s51, 106496
  s_add_u32 s46, s63, 82816
  buffer_load_dwordx4 v65, s[12:15], s46 offen  lds
  s_add_u32 m0, s51, 110592
  s_add_u32 s46, s63, 123776
  buffer_load_dwordx4 v65, s[12:15], s46 offen  lds
  s_add_u32 m0, s51, 114688
  s_add_u32 s46, s63, 164736
  buffer_load_dwordx4 v65, s[12:15], s46 offen  lds
  s_add_u32 m0, s51, 118784
  s_add_u32 s46, s63, 205696
  buffer_load_dwordx4 v65, s[12:15], s46 offen  lds
  ds_read_b64_tr_b16 a[192:193], v67 offset:57344
  ds_read_b64_tr_b16 a[194:195], v67 offset:58368
  ds_read_b64_tr_b16 a[196:197], v67 offset:61440
  ds_read_b64_tr_b16 a[198:199], v67 offset:62464
  ds_read_b64_tr_b16 a[200:201], v68 offset:0
  ds_read_b64_tr_b16 a[202:203], v68 offset:1024
  ds_read_b64_tr_b16 a[204:205], v68 offset:4096
  ds_read_b64_tr_b16 a[206:207], v68 offset:5120
  ds_read_b64_tr_b16 a[208:209], v68 offset:8192
  ds_read_b64_tr_b16 a[210:211], v68 offset:9216
  ds_read_b64_tr_b16 a[212:213], v68 offset:12288
  ds_read_b64_tr_b16 a[214:215], v68 offset:13312
  s_waitcnt lgkmcnt(0)
  s_waitcnt vmcnt(24)
  s_barrier
  v_and_b32 v149, 3, v0
  v_lshlrev_b32 v149, 2, v149
  global_load_dword v148, v149, s[38:39] sc1
  s_add_u32 m0, s51, 122880
  s_add_u32 s46, s63, 1152
  buffer_load_dwordx4 v65, s[12:15], s46 offen  lds
  s_add_u32 m0, s51, 126976
  s_add_u32 s46, s63, 42112
  buffer_load_dwordx4 v65, s[12:15], s46 offen  lds
  s_add_u32 m0, s51, 131072
  s_add_u32 s46, s63, 83072
  buffer_load_dwordx4 v65, s[12:15], s46 offen  lds
  s_add_u32 m0, s51, 135168
  s_add_u32 s46, s63, 124032
  buffer_load_dwordx4 v65, s[12:15], s46 offen  lds
  s_add_u32 m0, s51, 139264
  s_add_u32 s46, s63, 164992
  buffer_load_dwordx4 v65, s[12:15], s46 offen  lds
  s_add_u32 m0, s51, 143360
  s_add_u32 s46, s63, 205952
  buffer_load_dwordx4 v65, s[12:15], s46 offen  lds
  ds_read_b64_tr_b16 a[216:217], v66 offset:0
  ds_read_b64_tr_b16 a[218:219], v66 offset:1024
  ds_read_b64_tr_b16 a[220:221], v66 offset:4096
  ds_read_b64_tr_b16 a[222:223], v66 offset:5120
  ds_read_b64_tr_b16 a[224:225], v66 offset:8192
  ds_read_b64_tr_b16 a[226:227], v66 offset:9216
  ds_read_b64_tr_b16 a[228:229], v66 offset:12288
  ds_read_b64_tr_b16 a[230:231], v66 offset:13312
  ds_read_b64_tr_b16 a[232:233], v66 offset:16384
  ds_read_b64_tr_b16 a[234:235], v66 offset:17408
  ds_read_b64_tr_b16 a[236:237], v66 offset:20480
  ds_read_b64_tr_b16 a[238:239], v66 offset:21504
  s_waitcnt lgkmcnt(0)
  s_waitcnt vmcnt(25)
  s_barrier
  s_add_u32 m0, s51, 0
  s_add_u32 s46, s62, 0
  buffer_load_dwordx4 v64, s[4:7], s46 offen  lds
  s_add_u32 m0, s51, 4096
  s_add_u32 s46, s62, 393216
  buffer_load_dwordx4 v64, s[4:7], s46 offen  lds
  s_add_u32 m0, s51, 8192
  s_add_u32 s46, s62, 128
  buffer_load_dwordx4 v64, s[4:7], s46 offen  lds
  s_add_u32 m0, s51, 12288
  s_add_u32 s46, s62, 393344
  buffer_load_dwordx4 v64, s[4:7], s46 offen  lds
  s_add_u32 m0, s51, 16384
  s_add_u32 s46, s62, 256
  buffer_load_dwordx4 v64, s[4:7], s46 offen  lds
  s_add_u32 m0, s51, 20480
  s_add_u32 s46, s62, 393472
  buffer_load_dwordx4 v64, s[4:7], s46 offen  lds
  ds_read_b64_tr_b16 a[240:241], v66 offset:24576
  ds_read_b64_tr_b16 a[242:243], v66 offset:25600
  ds_read_b64_tr_b16 a[244:245], v66 offset:28672
  ds_read_b64_tr_b16 a[246:247], v66 offset:29696
  ds_read_b64_tr_b16 a[248:249], v66 offset:32768
  ds_read_b64_tr_b16 a[250:251], v66 offset:33792
  ds_read_b64_tr_b16 a[252:253], v66 offset:36864
  ds_read_b64_tr_b16 a[254:255], v66 offset:37888
  ds_read_b64_tr_b16 v[152:153], v66 offset:40960
  ds_read_b64_tr_b16 v[154:155], v66 offset:41984
  ds_read_b64_tr_b16 v[156:157], v66 offset:45056
  ds_read_b64_tr_b16 v[158:159], v66 offset:46080
  s_waitcnt lgkmcnt(0)
  s_waitcnt vmcnt(25)
  s_barrier
  s_add_u32 m0, s51, 24576
  s_add_u32 s46, s62, 3145728
  buffer_load_dwordx4 v64, s[4:7], s46 offen  lds
  s_add_u32 m0, s51, 28672
  s_add_u32 s46, s62, 3538944
  buffer_load_dwordx4 v64, s[4:7], s46 offen  lds
  s_add_u32 m0, s51, 32768
  s_add_u32 s46, s62, 3145856
  buffer_load_dwordx4 v64, s[4:7], s46 offen  lds
  s_add_u32 m0, s51, 36864
  s_add_u32 s46, s62, 3539072
  buffer_load_dwordx4 v64, s[4:7], s46 offen  lds
  s_add_u32 m0, s51, 40960
  s_add_u32 s46, s62, 3145984
  buffer_load_dwordx4 v64, s[4:7], s46 offen  lds
  s_add_u32 m0, s51, 45056
  s_add_u32 s46, s62, 3539200
  buffer_load_dwordx4 v64, s[4:7], s46 offen  lds
  ds_read_b64_tr_b16 v[160:161], v66 offset:49152
  ds_read_b64_tr_b16 v[162:163], v66 offset:50176
  ds_read_b64_tr_b16 v[164:165], v66 offset:53248
  ds_read_b64_tr_b16 v[166:167], v66 offset:54272
  ds_read_b64_tr_b16 v[168:169], v66 offset:57344
  ds_read_b64_tr_b16 v[170:171], v66 offset:58368
  ds_read_b64_tr_b16 v[172:173], v66 offset:61440
  ds_read_b64_tr_b16 v[174:175], v66 offset:62464
  ds_read_b64_tr_b16 v[176:177], v67 offset:0
  ds_read_b64_tr_b16 v[178:179], v67 offset:1024
  ds_read_b64_tr_b16 v[180:181], v67 offset:4096
  ds_read_b64_tr_b16 v[182:183], v67 offset:5120
  s_waitcnt lgkmcnt(0)
  s_waitcnt vmcnt(25)
  s_barrier
  s_add_u32 m0, s51, 49152
  s_add_u32 s46, s62, 6291456
  buffer_load_dwordx4 v64, s[4:7], s46 offen  lds
  s_add_u32 m0, s51, 53248
  s_add_u32 s46, s62, 6684672
  buffer_load_dwordx4 v64, s[4:7], s46 offen  lds
  s_add_u32 m0, s51, 57344
  s_add_u32 s46, s62, 6291584
  buffer_load_dwordx4 v64, s[4:7], s46 offen  lds
  s_add_u32 m0, s51, 61440
  s_add_u32 s46, s62, 6684800
  buffer_load_dwordx4 v64, s[4:7], s46 offen  lds
  s_add_u32 m0, s51, 65536
  s_add_u32 s46, s62, 6291712
  buffer_load_dwordx4 v64, s[4:7], s46 offen  lds
  s_add_u32 m0, s51, 69632
  s_add_u32 s46, s62, 6684928
  buffer_load_dwordx4 v64, s[4:7], s46 offen  lds
  ds_read_b64_tr_b16 v[184:185], v67 offset:8192
  ds_read_b64_tr_b16 v[186:187], v67 offset:9216
  ds_read_b64_tr_b16 v[188:189], v67 offset:12288
  ds_read_b64_tr_b16 v[190:191], v67 offset:13312
  ds_read_b64_tr_b16 v[192:193], v67 offset:16384
  ds_read_b64_tr_b16 v[194:195], v67 offset:17408
  ds_read_b64_tr_b16 v[196:197], v67 offset:20480
  ds_read_b64_tr_b16 v[198:199], v67 offset:21504
  ds_read_b64_tr_b16 v[200:201], v67 offset:24576
  ds_read_b64_tr_b16 v[202:203], v67 offset:25600
  ds_read_b64_tr_b16 v[204:205], v67 offset:28672
  ds_read_b64_tr_b16 v[206:207], v67 offset:29696
  s_waitcnt lgkmcnt(0)
  s_waitcnt vmcnt(25)
  s_barrier
  s_add_u32 m0, s51, 73728
  s_add_u32 s46, s63, 384
  buffer_load_dwordx4 v65, s[12:15], s46 offen  lds
  s_add_u32 m0, s51, 77824
  s_add_u32 s46, s63, 41344
  buffer_load_dwordx4 v65, s[12:15], s46 offen  lds
  s_add_u32 m0, s51, 81920
  s_add_u32 s46, s63, 82304
  buffer_load_dwordx4 v65, s[12:15], s46 offen  lds
  s_add_u32 m0, s51, 86016
  s_add_u32 s46, s63, 123264
  buffer_load_dwordx4 v65, s[12:15], s46 offen  lds
  s_add_u32 m0, s51, 90112
  s_add_u32 s46, s63, 164224
  buffer_load_dwordx4 v65, s[12:15], s46 offen  lds
  s_add_u32 m0, s51, 94208
  s_add_u32 s46, s63, 205184
  buffer_load_dwordx4 v65, s[12:15], s46 offen  lds
  ds_read_b64_tr_b16 v[208:209], v67 offset:32768
  ds_read_b64_tr_b16 v[210:211], v67 offset:33792
  ds_read_b64_tr_b16 v[212:213], v67 offset:36864
  ds_read_b64_tr_b16 v[214:215], v67 offset:37888
  ds_read_b64_tr_b16 v[216:217], v67 offset:40960
  ds_read_b64_tr_b16 v[218:219], v67 offset:41984
  ds_read_b64_tr_b16 v[220:221], v67 offset:45056
  ds_read_b64_tr_b16 v[222:223], v67 offset:46080
  ds_read_b64_tr_b16 v[224:225], v67 offset:49152
  ds_read_b64_tr_b16 v[226:227], v67 offset:50176
  ds_read_b64_tr_b16 v[228:229], v67 offset:53248
  ds_read_b64_tr_b16 v[230:231], v67 offset:54272
  s_waitcnt lgkmcnt(0)
  s_waitcnt vmcnt(24)
  s_barrier
  s_add_u32 m0, s51, 98304
  s_add_u32 s46, s63, 1024
  buffer_load_dwordx4 v65, s[12:15], s46 offen  lds
  s_add_u32 m0, s51, 102400
  s_add_u32 s46, s63, 41984
  buffer_load_dwordx4 v65, s[12:15], s46 offen  lds
  s_add_u32 m0, s51, 106496
  s_add_u32 s46, s63, 82944
  buffer_load_dwordx4 v65, s[12:15], s46 offen  lds
  s_add_u32 m0, s51, 110592
  s_add_u32 s46, s63, 123904
  buffer_load_dwordx4 v65, s[12:15], s46 offen  lds
  s_add_u32 m0, s51, 114688
  s_add_u32 s46, s63, 164864
  buffer_load_dwordx4 v65, s[12:15], s46 offen  lds
  s_add_u32 m0, s51, 118784
  s_add_u32 s46, s63, 205824
  buffer_load_dwordx4 v65, s[12:15], s46 offen  lds
  ds_read_b64_tr_b16 v[232:233], v67 offset:57344
  ds_read_b64_tr_b16 v[234:235], v67 offset:58368
  ds_read_b64_tr_b16 v[236:237], v67 offset:61440
  ds_read_b64_tr_b16 v[238:239], v67 offset:62464
  ds_read_b64_tr_b16 v[240:241], v68 offset:0
  ds_read_b64_tr_b16 v[242:243], v68 offset:1024
  ds_read_b64_tr_b16 v[244:245], v68 offset:4096
  ds_read_b64_tr_b16 v[246:247], v68 offset:5120
  ds_read_b64_tr_b16 v[248:249], v68 offset:8192
  ds_read_b64_tr_b16 v[250:251], v68 offset:9216
  ds_read_b64_tr_b16 v[252:253], v68 offset:12288
  ds_read_b64_tr_b16 v[254:255], v68 offset:13312
  s_waitcnt lgkmcnt(0)
  s_mov_b32 s50, 0
  s_branch ss_25_in
ss_25:
  v_and_b32 v149, 3, v0
  v_lshlrev_b32 v149, 2, v149
  global_load_dword v148, v149, s[38:39] sc1
  s_add_u32 s50, s50, 1
  s_cmp_gt_u32 s50, 131072
  s_cbranch_scc1 L_fail
  s_waitcnt vmcnt(0)
ss_25_in:
  v_readlane_b32 s46, v148, 0
  v_readlane_b32 s47, v148, 2
  v_readlane_b32 s48, v148, 1
  s_nop 0
  s_min_u32 s47, s47, s48
  s_cmp_lg_u32 s46, 0
  s_cselect_b32 s48, 7, 0
  s_add_u32 s46, s46, s2
  s_xor_b32 s49, s46, s43
  s_and_b32 s49, s49, s48
  s_cbranch_scc1 L_reroll
  s_cmp_lg_u32 s47, 0
  s_cbranch_scc1 ss_ok_26
  s_sleep 6
  s_branch ss_25
ss_ok_26:
  v_readlane_b32 s3, v148, 1
  s_nop 0
  s_and_b32 s3, s3, 0x2000
  s_add_u32 s46, s42, 1
  s_lshl_b32 s31, s46, 10
  s_cmp_ge_u32 s46, 8
  s_cselect_b32 s47, 40960, 0
  s_add_u32 s31, s31, s47
  s_cmp_ge_u32 s46, 10
  s_cselect_b32 s31, 2146435072, s31
  s_add_u32 s46, s42, 5
  s_lshl_b32 s32, s46, 10
  s_cmp_ge_u32 s46, 8
  s_cselect_b32 s47, 40960, 0
  s_add_u32 s32, s32, s47
  s_cmp_ge_u32 s46, 10
  s_cselect_b32 s32, 2146435072, s32
  s_add_u32 s46, s42, 9
  s_lshl_b32 s33, s46, 10
  s_cmp_ge_u32 s46, 8
  s_cselect_b32 s47, 40960, 0
  s_add_u32 s33, s33, s47
  s_cmp_ge_u32 s46, 10
  s_cselect_b32 s33, 2146435072, s33
  v_add_u32 v9, 126976, v1
  s_lshr_b32 s46, s44, 4
  s_lshl_b32 s46, s46, 7
  s_lshl_b32 s47, s43, 4
  s_add_u32 s46, s46, s47
  s_and_b32 s47, s44, 15
  s_add_u32 s46, s46, s47
  s_lshl_b32 s46, s46, 7
  s_add_u32 s46, s46, s3
  s_add_u32 s46, s46, 13369344
  s_add_u32 s40, s8, s46
  s_addc_u32 s41, s9, 0
  v_mov_b32 v7, 0x44444444
  v_mov_b32 v148, 0xeeeeeeee
  v_and_b32 v149, 2, v0
  v_cmp_ne_u32 vcc, 0, v149
  s_nop 1
  v_cndmask_b32 v7, v7, v148, vcc
  v_and_b32 v148, 15, v0
  v_lshrrev_b32 v149, 4, v0
  v_lshlrev_b32 v8, 4, v148
  v_lshrrev_b32 v150, 2, v148
  v_lshlrev_b32 v4, 6, v150
  v_and_b32 v150, 1, v148
  v_lshl_add_u32 v4, v150, 5, v4
  v_lshl_add_u32 v4, v149, 3, v4
  v_bfe_u32 v150, v148, 1, 1
  v_lshl_add_u32 v4, v150, 2, v4
  s_and_b32 s46, s42, 1
  s_lshl_b32 s46, s46, 7
  v_xor_b32 v4, s46, v4
  s_lshl_b32 s46, s42, 8
  s_add_u32 s46, s46, 122880
  v_add_u32 v4, s46, v4
  s_lshl_b32 s46, s45, 8
  s_lshl_b32 s47, s42, 14
  s_add_u32 s47, s47, s46
  v_lshl_add_u32 v8, v149, 16, v8
  v_add_u32 v8, s47, v8
  v_lshrrev_b32 v150, 1, v149
  v_lshl_add_u32 v13, v150, 30, v8
  v_mul_u32_u24 v150, 131064, v150
  v_sub_u32 v8, v8, v150
  v_lshlrev_b32 v5, 8, v149
  v_and_b32 v150, 1, v149
  v_lshl_add_u32 v5, v150, 7, v5
  v_lshl_add_u32 v5, v148, 3, v5
  v_xor_b32 v6, 0x80, v5
  v_add_u32 v5, 122880, v5
  v_add_u32 v6, 122880, v6
  s_lshl_b32 s46, s45, 7
  s_lshl_b32 s47, s42, 2
  s_add_u32 s47, s47, s46
  s_add_u32 s47, s47, 1064960
  v_mov_b32 v15, s47
  s_mov_b32 s52, 0
  s_mov_b32 s58, 0
  s_mov_b32 s54, 0
  s_mov_b32 s100, 0
  s_waitcnt vmcnt(24)
  s_barrier
  ds_read_b64_tr_b16 v[40:41], v66 offset:0
  ds_read_b64_tr_b16 v[42:43], v66 offset:1024
  ds_read_b64_tr_b16 v[44:45], v66 offset:4096
  ds_read_b64_tr_b16 v[46:47], v66 offset:5120
  ds_read_b64_tr_b16 v[48:49], v66 offset:8192
  ds_read_b64_tr_b16 v[50:51], v66 offset:9216
  ds_read_b64_tr_b16 v[52:53], v66 offset:12288
  ds_read_b64_tr_b16 v[54:55], v66 offset:13312
  ds_read_b64_tr_b16 v[56:57], v66 offset:16384
  ds_read_b64_tr_b16 v[58:59], v66 offset:17408
  ds_read_b64_tr_b16 v[60:61], v66 offset:20480
  ds_read_b64_tr_b16 v[62:63], v66 offset:21504
  s_waitcnt lgkmcnt(0)
  s_waitcnt vmcnt(18)
  s_barrier
  ds_write_b128 v2, v[40:43] offset:0
  ds_write_b128 v2, v[44:47] offset:4096
  ds_write_b128 v2, v[48:51] offset:8192
  ds_write_b128 v2, v[52:55] offset:12288
  ds_write_b128 v2, v[56:59] offset:16384
  ds_write_b128 v2, v[60:63] offset:20480
  ds_read_b64_tr_b16 v[16:17], v66 offset:24576
  ds_read_b64_tr_b16 v[18:19], v66 offset:25600
  ds_read_b64_tr_b16 v[20:21], v66 offset:28672
  ds_read_b64_tr_b16 v[22:23], v66 offset:29696
  ds_read_b64_tr_b16 v[24:25], v66 offset:32768
  ds_read_b64_tr_b16 v[26:27], v66 offset:33792
  ds_read_b64_tr_b16 v[28:29], v66 offset:36864
  ds_read_b64_tr_b16 v[30:31], v66 offset:37888
  ds_read_b64_tr_b16 v[32:33], v66 offset:40960
  ds_read_b64_tr_b16 v[34:35], v66 offset:41984
  ds_read_b64_tr_b16 v[36:37], v66 offset:45056
  ds_read_b64_tr_b16 v[38:39], v66 offset:46080
  s_waitcnt lgkmcnt(0)
  s_waitcnt vmcnt(12)
  s_barrier
  ds_write_b128 v2, v[16:19] offset:24576
  ds_write_b128 v2, v[20:23] offset:28672
  ds_write_b128 v2, v[24:27] offset:32768
  ds_write_b128 v2, v[28:31] offset:36864
  ds_write_b128 v2, v[32:35] offset:40960
  ds_write_b128 v2, v[36:39] offset:45056
  ds_read_b64_tr_b16 v[40:41], v66 offset:49152
  ds_read_b64_tr_b16 v[42:43], v66 offset:50176
  ds_read_b64_tr_b16 v[44:45], v66 offset:53248
  ds_read_b64_tr_b16 v[46:47], v66 offset:54272
  ds_read_b64_tr_b16 v[48:49], v66 offset:57344
  ds_read_b64_tr_b16 v[50:51], v66 offset:58368
  ds_read_b64_tr_b16 v[52:53], v66 offset:61440
  ds_read_b64_tr_b16 v[54:55], v66 offset:62464
  ds_read_b64_tr_b16 v[56:57], v67 offset:0
  ds_read_b64_tr_b16 v[58:59], v67 offset:1024
  ds_read_b64_tr_b16 v[60:61], v67 offset:4096
  ds_read_b64_tr_b16 v[62:63], v67 offset:5120
  s_waitcnt lgkmcnt(0)
  s_waitcnt vmcnt(6)
  s_barrier
  ds_write_b128 v2, v[40:43] offset:49152
  ds_write_b128 v2, v[44:47] offset:53248
  ds_write_b128 v2, v[48:51] offset:57344
  ds_write_b128 v2, v[52:55] offset:61440
  ds_write_b128 v3, v[56:59] offset:0
  ds_write_b128 v3, v[60:63] offset:4096
  ds_read_b64_tr_b16 v[16:17], v67 offset:8192
  ds_read_b64_tr_b16 v[18:19], v67 offset:9216
  ds_read_b64_tr_b16 v[20:21], v67 offset:12288
  ds_read_b64_tr_b16 v[22:23], v67 offset:13312
  ds_read_b64_tr_b16 v[24:25], v67 offset:16384
  ds_read_b64_tr_b16 v[26:27], v67 offset:17408
  ds_read_b64_tr_b16 v[28:29], v67 offset:20480
  ds_read_b64_tr_b16 v[30:31], v67 offset:21504
  ds_read_b64_tr_b16 v[32:33], v67 offset:24576
  ds_read_b64_tr_b16 v[34:35], v67 offset:25600
  ds_read_b64_tr_b16 v[36:37], v67 offset:28672
  ds_read_b64_tr_b16 v[38:39], v67 offset:29696
  s_waitcnt lgkmcnt(0)
  s_waitcnt vmcnt(0)
  s_barrier
  ds_write_b128 v3, v[16:19] offset:8192
  ds_write_b128 v3, v[20:23] offset:12288
  ds_write_b128 v3, v[24:27] offset:16384
  ds_write_b128 v3, v[28:31] offset:20480
  ds_write_b128 v3, v[32:35] offset:24576
  ds_write_b128 v3, v[36:39] offset:28672
  ds_read_b64_tr_b16 v[40:41], v67 offset:32768
  ds_read_b64_tr_b16 v[42:43], v67 offset:33792
  ds_read_b64_tr_b16 v[44:45], v67 offset:36864
  ds_read_b64_tr_b16 v[46:47], v67 offset:37888
  ds_read_b64_tr_b16 v[48:49], v67 offset:40960
  ds_read_b64_tr_b16 v[50:51], v67 offset:41984
  ds_read_b64_tr_b16 v[52:53], v67 offset:45056
  ds_read_b64_tr_b16 v[54:55], v67 offset:46080
  ds_read_b64_tr_b16 v[56:57], v67 offset:49152
  ds_read_b64_tr_b16 v[58:59], v67 offset:50176
  ds_read_b64_tr_b16 v[60:61], v67 offset:53248
  ds_read_b64_tr_b16 v[62:63], v67 offset:54272
  s_waitcnt lgkmcnt(0)
  s_barrier
  ds_write_b128 v3, v[40:43] offset:32768
  ds_write_b128 v3, v[44:47] offset:36864
  ds_write_b128 v3, v[48:51] offset:40960
  ds_write_b128 v3, v[52:55] offset:45056
  ds_write_b128 v3, v[56:59] offset:49152
  ds_write_b128 v3, v[60:63] offset:53248
  s_waitcnt lgkmcnt(0)
va_loop:
  s_add_u32 s53, s52, 1
  s_lshl_b32 s56, s58, 2
  s_add_u32 s56, s56, s43
  s_lshl_b32 s56, s56, 16
  s_add_u32 s56, s56, s3
  s_add_u32 s56, s56, 12582912
  s_lshl_b32 s72, s54, 21
  s_mul_i32 s46, s58, 655360
  s_add_u32 s72, s72, s46
  s_add_u32 s72, s72, s3
  s_add_u32 s72, s72, 4194304
  s_lshr_b32 s46, s72, 8
  s_and_b32 s46, s46, 0x2000
  s_xor_b32 s72, s72, s46
  s_add_u32 s73, s72, 131072
  s_add_u32 s74, s72, 262144
  s_add_u32 s75, s72, 393216
  s_add_u32 s76, s72, 524288
  v_add_u32 v11, s56, v1
  s_mov_b64 s[16:17], -1
  s_mov_b32 s71, 0
  ds_read_b128 v[56:59], v2 offset:0
  ds_read_b128 v[60:63], v2 offset:4096
  ds_read_b128 v[64:67], v2 offset:8192
  ds_read_b128 v[68:71], v2 offset:12288
  ds_read_b128 v[72:75], v2 offset:16384
  ds_read_b128 v[76:79], v2 offset:20480
  ds_read_b128 v[80:83], v2 offset:24576
  ds_read_b128 v[84:87], v2 offset:28672
  v_mov_b32 v88, 0
  v_mov_b32 v89, 0
  v_mov_b32 v90, 0
  v_mov_b32 v91, 0
  v_mov_b32 v92, 0
  v_mov_b32 v93, 0
  v_mov_b32 v94, 0
  v_mov_b32 v95, 0
  v_mov_b32 v96, 0
  v_mov_b32 v97, 0
  v_mov_b32 v98, 0
  v_mov_b32 v99, 0
  v_mov_b32 v100, 0
  v_mov_b32 v101, 0
  v_mov_b32 v102, 0
  v_mov_b32 v103, 0
  v_mov_b32 v104, 0
  v_mov_b32 v105, 0
  v_mov_b32 v106, 0
  v_mov_b32 v107, 0
  v_mov_b32 v108, 0
  v_mov_b32 v109, 0
  v_mov_b32 v110, 0
  v_mov_b32 v111, 0
  v_mov_b32 v112, 0
  v_mov_b32 v113, 0
  v_mov_b32 v114, 0
  v_mov_b32 v115, 0
  v_mov_b32 v128, 0
  v_mov_b32 v129, 0
  v_mov_b32 v130, 0
  v_mov_b32 v131, 0
  v_mov_b32 v132, 0
  v_mov_b32 v133, 0
  v_mov_b32 v134, 0
  v_mov_b32 v135, 0
  v_mov_b32 v136, 0
  v_mov_b32 v137, 0
  v_mov_b32 v138, 0
  v_mov_b32 v139, 0
  v_mov_b32 v140, 0
  v_mov_b32 v141, 0
  v_mov_b32 v142, 0
  v_mov_b32 v143, 0
  v_mov_b32 v144, 0
  v_mov_b32 v145, 0
  v_mov_b32 v146, 0
  v_mov_b32 v147, 0
  s_waitcnt lgkmcnt(0)
  s_cmp_lg_u32 s42, 3
  s_cbranch_scc1 va_nobell
  s_mov_b32 s50, 0
  s_waitcnt lgkmcnt(0)
  s_mov_b64 s[80:81], 0
  s_mov_b64 s[82:83], 0
  s_cmp_eq_u32 s53, 1
  s_cbranch_scc1 bell_x_28
bell_27:
  s_load_dwordx4 s[80:83], s[40:41], 0 glc
  s_min_u32 s46, s80, s81
  s_min_u32 s47, s82, s83
  s_min_u32 s46, s46, s47
  s_cmp_ge_u32 s46, s53
  s_cbranch_scc1 bell_x_28
  s_min_u32 s46, s80, s81
  s_min_u32 s47, s82, s83
  s_min_u32 s46, s46, s47
  s_cmp_ge_u32 s46, s53
  s_cbranch_scc1 bell_x_28
  s_min_u32 s46, s80, s81
  s_min_u32 s47, s82, s83
  s_min_u32 s46, s46, s47
  s_cmp_ge_u32 s46, s53
  s_cbranch_scc1 bell_x_28
  s_min_u32 s46, s80, s81
  s_min_u32 s47, s82, s83
  s_min_u32 s46, s46, s47
  s_cmp_ge_u32 s46, s53
  s_cbranch_scc1 bell_x_28
  s_min_u32 s46, s80, s81
  s_min_u32 s47, s82, s83
  s_min_u32 s46, s46, s47
  s_cmp_ge_u32 s46, s53
  s_cbranch_scc1 bell_x_28
  s_min_u32 s46, s80, s81
  s_min_u32 s47, s82, s83
  s_min_u32 s46, s46, s47
  s_cmp_ge_u32 s46, s53
  s_cbranch_scc1 bell_x_28
  s_min_u32 s46, s80, s81
  s_min_u32 s47, s82, s83
  s_min_u32 s46, s46, s47
  s_cmp_ge_u32 s46, s53
  s_cbranch_scc1 bell_x_28
  s_add_u32 s50, s50, 1
  s_cmp_lt_u32 s50, 524288
  s_cbranch_scc1 bell_27
  s_branch L_fail
bell_x_28:
va_nobell:
  s_mov_b32 s50, 0
va_top:
  s_add_u32 m0, s51, 126976
  s_barrier
  buffer_load_dwordx4 v11, s[8:11], s31 offen sc1 lds
  s_add_u32 m0, s51, 131072
  s_barrier
  buffer_load_dwordx4 v[16:19], v11, s[8:11], 0 offen offset:0 sc1
  s_barrier
  buffer_load_dwordx4 v11, s[8:11], s32 offen sc1 lds
  s_add_u32 m0, s51, 135168
  s_nop 0
  buffer_load_dwordx4 v11, s[8:11], s33 offen sc1 lds
  s_waitcnt vmcnt(3)
  s_barrier
  ds_read_b128 v[20:23], v9 offset:0
  ds_read_b128 v[24:27], v9 offset:1024
  s_waitcnt vmcnt(2)
va_go:
  v_smfmac_f32_16x16x64_bf16 v[104:107], v[16:19], v[56:63], v7
  ds_read_b128 v[28:31], v9 offset:2048
  v_smfmac_f32_16x16x64_bf16 v[108:111], v[16:19], v[64:71], v7
  ds_read_b128 v[32:35], v9 offset:3072
  v_smfmac_f32_16x16x64_bf16 v[112:115], v[16:19], v[72:79], v7
  ds_read_b128 v[56:59], v2 offset:49152
  s_waitcnt lgkmcnt(4)
  v_smfmac_f32_16x16x64_bf16 v[104:107], v[20:23], a[0:7], v7
  ds_read_b128 v[60:63], v2 offset:53248
  v_cmp_eq_u32 vcc, -1, v16
  v_smfmac_f32_16x16x64_bf16 v[108:111], v[20:23], a[8:15], v7
  ds_read_b128 v[64:67], v2 offset:32768
  v_smfmac_f32_16x16x64_bf16 v[112:115], v[20:23], a[16:23], v7
  s_cbranch_vccnz va_ha
  s_waitcnt lgkmcnt(4)
  v_smfmac_f32_16x16x64_bf16 v[104:107], v[24:27], a[24:31], v7
  s_waitcnt vmcnt(0)
  s_barrier
  ds_read_b128 v[36:39], v9 offset:4096
  v_smfmac_f32_16x16x64_bf16 v[108:111], v[24:27], a[32:39], v7
  ds_read_b128 v[40:43], v9 offset:5120
  v_smfmac_f32_16x16x64_bf16 v[112:115], v[24:27], a[40:47], v7
  ds_read_b128 v[44:47], v9 offset:6144
  v_mov_b32 v16, 0
  v_smfmac_f32_16x16x64_bf16 v[104:107], v[28:31], a[48:55], v7
  ds_read_b128 v[48:51], v9 offset:7168
  s_waitcnt lgkmcnt(4)
  v_smfmac_f32_16x16x64_bf16 v[104:107], v[32:35], v[80:87], v7
  ds_read_b128 v[52:55], v9 offset:8192
  s_waitcnt lgkmcnt(4)
  v_smfmac_f32_16x16x64_bf16 v[104:107], v[36:39], a[72:79], v7
  ds_read_b128 v[68:71], v2 offset:36864
  s_waitcnt lgkmcnt(4)
  v_max3_u32 v12, v20, v24, v28
  v_smfmac_f32_16x16x64_bf16 v[104:107], v[40:43], a[96:103], v7
  s_waitcnt lgkmcnt(3)
  v_max3_u32 v12, v12, v32, v36
  v_smfmac_f32_16x16x64_bf16 v[104:107], v[44:47], a[120:127], v7
  s_waitcnt lgkmcnt(2)
  v_max3_u32 v12, v12, v40, v44
  v_smfmac_f32_16x16x64_bf16 v[104:107], v[48:51], v[56:63], v7
  s_waitcnt lgkmcnt(1)
  v_max3_u32 v12, v12, v48, v52
  v_smfmac_f32_16x16x64_bf16 v[104:107], v[52:55], a[144:151], v7
  ds_read_b128 v[72:75], v2 offset:57344
  v_cmp_eq_u32 vcc, -1, v12
  v_smfmac_f32_16x16x64_bf16 v[108:111], v[28:31], a[56:63], v7
  ds_read_b128 v[76:79], v2 offset:61440
  s_waitcnt lgkmcnt(2)
  v_smfmac_f32_16x16x64_bf16 v[108:111], v[32:35], v[64:71], v7
  s_cbranch_vccnz va_hb
  v_mov_b32 v17, 0
va_join:
  v_smfmac_f32_16x16x64_bf16 v[108:111], v[36:39], a[80:87], v7
  ds_read_b128 v[80:83], v2 offset:40960
  v_add_f32 v104, v104, v106
  v_smfmac_f32_16x16x64_bf16 v[108:111], v[40:43], a[104:111], v7
  ds_read_b128 v[84:87], v2 offset:45056
  v_add_f32 v105, v105, v107
  v_smfmac_f32_16x16x64_bf16 v[108:111], v[44:47], a[128:135], v7
  ds_read_b128 v[56:59], v3 offset:0
  s_waitcnt lgkmcnt(3)
  v_cvt_pk_bf16_f32 v106, v104, v105
  v_smfmac_f32_16x16x64_bf16 v[108:111], v[48:51], v[72:79], v7
  ds_write_b32 v4, v106 offset:0
  v_smfmac_f32_16x16x64_bf16 v[108:111], v[52:55], a[152:159], v7
  ds_read_b128 v[60:63], v3 offset:4096
  v_cmp_u_f32 vcc, v104, v105
  v_smfmac_f32_16x16x64_bf16 v[112:115], v[28:31], a[64:71], v7
  ds_read_b128 v[64:67], v3 offset:8192
  s_waitcnt lgkmcnt(4)
  v_smfmac_f32_16x16x64_bf16 v[112:115], v[32:35], v[80:87], v7
  s_and_b64 vcc, vcc, s[16:17]
  s_cbranch_scc1 va_redo
  v_add_f32 v108, v108, v110
  v_smfmac_f32_16x16x64_bf16 v[112:115], v[36:39], a[88:95], v7
  s_waitcnt lgkmcnt(2)
  s_barrier
  v_add_f32 v109, v109, v111
  v_smfmac_f32_16x16x64_bf16 v[112:115], v[40:43], a[112:119], v7
  ds_read_b64_tr_b16 v[116:117], v5 offset:0
  ds_read_b64_tr_b16 v[118:119], v6 offset:0
  v_smfmac_f32_16x16x64_bf16 v[112:115], v[44:47], a[136:143], v7
  ds_read_b128 v[68:71], v3 offset:12288
  s_waitcnt lgkmcnt(4)
  v_cvt_pk_bf16_f32 v110, v108, v109
  v_smfmac_f32_16x16x64_bf16 v[112:115], v[48:51], v[56:63], v7
  ds_write_b32 v4, v110 offset:1024
  v_smfmac_f32_16x16x64_bf16 v[112:115], v[52:55], a[160:167], v7
  ds_read_b128 v[72:75], v3 offset:32768
  s_waitcnt lgkmcnt(3)
  v_smfmac_f32_16x16x64_bf16 v[128:131], v[116:119], a[168:175], v7
  ds_read_b128 v[76:79], v3 offset:36864
  v_mov_b32 v18, 0
  v_smfmac_f32_16x16x64_bf16 v[132:135], v[116:119], a[192:199], v7
  ds_read_b128 v[80:83], v3 offset:16384
  v_add_f32 v112, v112, v114
  v_smfmac_f32_16x16x64_bf16 v[136:139], v[116:119], a[216:223], v7
  s_waitcnt lgkmcnt(3)
  s_barrier
  v_add_f32 v113, v113, v115
  v_smfmac_f32_16x16x64_bf16 v[140:143], v[116:119], v[64:71], v7
  ds_read_b128 v[84:87], v3 offset:20480
  v_cvt_pk_bf16_f32 v114, v112, v113
  v_smfmac_f32_16x16x64_bf16 v[144:147], v[116:119], a[240:247], v7
  ds_write_b32 v4, v114 offset:2048
  v_smfmac_f32_16x16x64_bf16 v[88:91], v[116:119], v[160:167], v7
  ds_read_b64_tr_b16 v[120:121], v5 offset:1024
  ds_read_b64_tr_b16 v[122:123], v6 offset:1024
  v_smfmac_f32_16x16x64_bf16 v[92:95], v[116:119], v[184:191], v7
  ds_read_b128 v[56:59], v3 offset:24576
  v_mov_b32 v19, 0
  v_smfmac_f32_16x16x64_bf16 v[96:99], v[116:119], v[208:215], v7
  ds_read_b128 v[60:63], v3 offset:28672
  s_waitcnt lgkmcnt(6)
  v_smfmac_f32_16x16x64_bf16 v[100:103], v[116:119], v[72:79], v7
  s_waitcnt lgkmcnt(4)
  s_barrier
  v_smfmac_f32_16x16x64_bf16 v[16:19], v[116:119], v[232:239], v7
  ds_read_b64_tr_b16 v[124:125], v5 offset:2048
  ds_read_b64_tr_b16 v[126:127], v6 offset:2048
  s_waitcnt lgkmcnt(4)
  v_smfmac_f32_16x16x64_bf16 v[128:131], v[120:123], a[176:183], v7
  ds_read_b128 v[64:67], v3 offset:40960
  v_smfmac_f32_16x16x64_bf16 v[132:135], v[120:123], a[200:207], v7
  ds_read_b128 v[68:71], v3 offset:45056
  v_smfmac_f32_16x16x64_bf16 v[136:139], v[120:123], a[224:231], v7
  ds_read_b128 v[72:75], v3 offset:49152
  v_smfmac_f32_16x16x64_bf16 v[140:143], v[120:123], v[80:87], v7
  ds_read_b128 v[76:79], v3 offset:53248
  s_waitcnt lgkmcnt(4)
  v_smfmac_f32_16x16x64_bf16 v[128:131], v[124:127], a[184:191], v7
  v_smfmac_f32_16x16x64_bf16 v[132:135], v[124:127], a[208:215], v7
  v_smfmac_f32_16x16x64_bf16 v[136:139], v[124:127], a[232:239], v7
  v_add_f32 v128, v128, v130
  v_add_f32 v129, v129, v131
  v_cvt_pk_bf16_f32 v128, v128, v129
  v_smfmac_f32_16x16x64_bf16 v[140:143], v[124:127], v[56:63], v7
  v_add_f32 v132, v132, v134
  v_add_f32 v133, v133, v135
  v_cvt_pk_bf16_f32 v129, v132, v133
  v_smfmac_f32_16x16x64_bf16 v[144:147], v[120:123], a[248:255], v7
  v_add_f32 v136, v136, v138
  v_add_f32 v137, v137, v139
  v_permlane16_swap_b32 v128, v129
  v_smfmac_f32_16x16x64_bf16 v[144:147], v[124:127], v[152:159], v7
  buffer_store_dwordx2 v[128:129], v8, s[8:11], s72 offen sc1
  v_cvt_pk_bf16_f32 v136, v136, v137
  v_smfmac_f32_16x16x64_bf16 v[88:91], v[120:123], v[168:175], v7
  v_add_f32 v140, v140, v142
  v_add_f32 v141, v141, v143
  v_smfmac_f32_16x16x64_bf16 v[88:91], v[124:127], v[176:183], v7
  v_cvt_pk_bf16_f32 v137, v140, v141
  v_add_f32 v144, v144, v146
  v_smfmac_f32_16x16x64_bf16 v[92:95], v[120:123], v[192:199], v7
  v_add_f32 v145, v145, v147
  v_permlane16_swap_b32 v136, v137
  v_smfmac_f32_16x16x64_bf16 v[92:95], v[124:127], v[200:207], v7
  buffer_store_dwordx2 v[136:137], v8, s[8:11], s73 offen sc1
  v_cvt_pk_bf16_f32 v144, v144, v145
  v_add_f32 v88, v88, v90
  v_smfmac_f32_16x16x64_bf16 v[96:99], v[120:123], v[216:223], v7
  v_add_f32 v89, v89, v91
  v_cvt_pk_bf16_f32 v145, v88, v89
  v_smfmac_f32_16x16x64_bf16 v[96:99], v[124:127], v[224:231], v7
  s_waitcnt lgkmcnt(0)
  v_add_f32 v92, v92, v94
  v_add_f32 v93, v93, v95
  v_permlane16_swap_b32 v144, v145
  v_smfmac_f32_16x16x64_bf16 v[100:103], v[120:123], v[64:71], v7
  buffer_store_dwordx2 v[144:145], v8, s[8:11], s74 offen sc1
  v_cvt_pk_bf16_f32 v92, v92, v93
  v_smfmac_f32_16x16x64_bf16 v[100:103], v[124:127], v[72:79], v7
  v_add_f32 v96, v96, v98
  v_add_f32 v97, v97, v99
  v_cvt_pk_bf16_f32 v93, v96, v97
  v_smfmac_f32_16x16x64_bf16 v[16:19], v[120:123], v[240:247], v7
  v_smfmac_f32_16x16x64_bf16 v[16:19], v[124:127], v[248:255], v7
  v_add_f32 v100, v100, v102
  v_add_f32 v101, v101, v103
  v_permlane16_swap_b32 v92, v93
  buffer_store_dwordx2 v[92:93], v8, s[8:11], s75 offen sc1
  v_cvt_pk_bf16_f32 v100, v100, v101
  s_nop 2
  v_add_f32 v16, v16, v18
  v_add_f32 v17, v17, v19
  v_cvt_pk_bf16_f32 v101, v16, v17
  s_nop 1
  v_permlane16_swap_b32 v100, v101
  buffer_store_dwordx2 v[100:101], v8, s[8:11], s76 offen sc1
  s_add_u32 s58, s58, 1
  s_cmp_eq_u32 s58, 3
  s_cselect_b32 s58, 0, s58
  s_cmp_eq_u32 s58, 0
  s_addc_u32 s54, s54, 0
  s_cmp_eq_u32 s54, 3
  s_cselect_b32 s54, 0, s54
  s_mov_b32 s52, s53
  s_cmp_lt_u32 s52, 64
  s_cbranch_scc1 va_loop
  s_waitcnt vmcnt(0)
  v_mov_b32 v148, s52
  s_mov_b64 exec, 1
  buffer_store_dword v148, v15, s[8:11], 0 offen sc1
  s_mov_b64 exec, -1
  s_endpgm
va_ha:
  s_waitcnt lgkmcnt(0)
  ds_read_b128 v[56:59], v2 offset:0
  ds_read_b128 v[60:63], v2 offset:4096
  ds_read_b128 v[64:67], v2 offset:8192
  ds_read_b128 v[68:71], v2 offset:12288
  ds_read_b128 v[72:75], v2 offset:16384
  ds_read_b128 v[76:79], v2 offset:20480
  ds_read_b128 v[80:83], v2 offset:24576
  ds_read_b128 v[84:87], v2 offset:28672
  v_mov_b32 v88, 0
  v_mov_b32 v89, 0
  v_mov_b32 v90, 0
  v_mov_b32 v91, 0
  v_mov_b32 v92, 0
  v_mov_b32 v93, 0
  v_mov_b32 v94, 0
  v_mov_b32 v95, 0
  v_mov_b32 v96, 0
  v_mov_b32 v97, 0
  v_mov_b32 v98, 0
  v_mov_b32 v99, 0
  v_mov_b32 v100, 0
  v_mov_b32 v101, 0
  v_mov_b32 v102, 0
  v_mov_b32 v103, 0
  v_mov_b32 v104, 0
  v_mov_b32 v105, 0
  v_mov_b32 v106, 0
  v_mov_b32 v107, 0
  v_mov_b32 v108, 0
  v_mov_b32 v109, 0
  v_mov_b32 v110, 0
  v_mov_b32 v111, 0
  v_mov_b32 v112, 0
  v_mov_b32 v113, 0
  v_mov_b32 v114, 0
  v_mov_b32 v115, 0
  v_mov_b32 v128, 0
  v_mov_b32 v129, 0
  v_mov_b32 v130, 0
  v_mov_b32 v131, 0
  v_mov_b32 v132, 0
  v_mov_b32 v133, 0
  v_mov_b32 v134, 0
  v_mov_b32 v135, 0
  v_mov_b32 v136, 0
  v_mov_b32 v137, 0
  v_mov_b32 v138, 0
  v_mov_b32 v139, 0
  v_mov_b32 v140, 0
  v_mov_b32 v141, 0
  v_mov_b32 v142, 0
  v_mov_b32 v143, 0
  v_mov_b32 v144, 0
  v_mov_b32 v145, 0
  v_mov_b32 v146, 0
  v_mov_b32 v147, 0
va_ra:
  buffer_load_dwordx4 v[16:19], v11, s[8:11], 0 offen offset:0 sc1
  s_add_u32 s50, s50, 1
  s_cmp_gt_u32 s50, 131072
  s_cbranch_scc1 L_fail
  s_waitcnt vmcnt(0) lgkmcnt(0)
  v_cmp_eq_u32 vcc, -1, v16
  s_cbranch_vccnz va_ra
  s_branch va_go
va_hb:
  s_waitcnt lgkmcnt(0)
  s_add_u32 s50, s50, 1
  s_cmp_gt_u32 s50, 131072
  s_cbranch_scc1 L_fail
  ds_read_b128 v[56:59], v2 offset:0
  ds_read_b128 v[60:63], v2 offset:4096
  ds_read_b128 v[64:67], v2 offset:8192
  ds_read_b128 v[68:71], v2 offset:12288
  ds_read_b128 v[72:75], v2 offset:16384
  ds_read_b128 v[76:79], v2 offset:20480
  ds_read_b128 v[80:83], v2 offset:24576
  ds_read_b128 v[84:87], v2 offset:28672
  v_mov_b32 v88, 0
  v_mov_b32 v89, 0
  v_mov_b32 v90, 0
  v_mov_b32 v91, 0
  v_mov_b32 v92, 0
  v_mov_b32 v93, 0
  v_mov_b32 v94, 0
  v_mov_b32 v95, 0
  v_mov_b32 v96, 0
  v_mov_b32 v97, 0
  v_mov_b32 v98, 0
  v_mov_b32 v99, 0
  v_mov_b32 v100, 0
  v_mov_b32 v101, 0
  v_mov_b32 v102, 0
  v_mov_b32 v103, 0
  v_mov_b32 v104, 0
  v_mov_b32 v105, 0
  v_mov_b32 v106, 0
  v_mov_b32 v107, 0
  v_mov_b32 v108, 0
  v_mov_b32 v109, 0
  v_mov_b32 v110, 0
  v_mov_b32 v111, 0
  v_mov_b32 v112, 0
  v_mov_b32 v113, 0
  v_mov_b32 v114, 0
  v_mov_b32 v115, 0
  v_mov_b32 v128, 0
  v_mov_b32 v129, 0
  v_mov_b32 v130, 0
  v_mov_b32 v131, 0
  v_mov_b32 v132, 0
  v_mov_b32 v133, 0
  v_mov_b32 v134, 0
  v_mov_b32 v135, 0
  v_mov_b32 v136, 0
  v_mov_b32 v137, 0
  v_mov_b32 v138, 0
  v_mov_b32 v139, 0
  v_mov_b32 v140, 0
  v_mov_b32 v141, 0
  v_mov_b32 v142, 0
  v_mov_b32 v143, 0
  v_mov_b32 v144, 0
  v_mov_b32 v145, 0
  v_mov_b32 v146, 0
  v_mov_b32 v147, 0
  s_waitcnt lgkmcnt(0)
  s_branch va_top
va_redo:
  s_waitcnt lgkmcnt(0)
  s_mov_b32 s50, 0
va_poll:
  buffer_load_dwordx4 v[16:19], v11, s[8:11], 0 offen offset:0 sc1
  buffer_load_dwordx4 v[20:23], v11, s[8:11], 0 offen offset:1024 sc1
  buffer_load_dwordx4 v[24:27], v11, s[8:11], 0 offen offset:2048 sc1
  buffer_load_dwordx4 v[28:31], v11, s[8:11], 0 offen offset:3072 sc1
  buffer_load_dwordx4 v[32:35], v11, s[8:11], s24 offen offset:0 sc1
  buffer_load_dwordx4 v[36:39], v11, s[8:11], s24 offen offset:1024 sc1
  buffer_load_dwordx4 v[40:43], v11, s[8:11], s24 offen offset:2048 sc1
  buffer_load_dwordx4 v[44:47], v11, s[8:11], s24 offen offset:3072 sc1
  buffer_load_dwordx4 v[48:51], v11, s[8:11], s25 offen offset:0 sc1
  buffer_load_dwordx4 v[52:55], v11, s[8:11], s25 offen offset:1024 sc1
  s_add_u32 s50, s50, 1
  s_cmp_gt_u32 s50, 131072
  s_cbranch_scc1 L_fail
  s_waitcnt vmcnt(0) lgkmcnt(0)
  v_max_u32 v12, v16, v17
  v_max3_u32 v12, v18, v19, v12
  v_max3_u32 v12, v20, v21, v12
  v_max3_u32 v12, v22, v23, v12
  v_max3_u32 v12, v24, v25, v12
  v_max3_u32 v12, v26, v27, v12
  v_max3_u32 v12, v28, v29, v12
  v_max3_u32 v12, v30, v31, v12
  v_max3_u32 v12, v32, v33, v12
  v_max3_u32 v12, v34, v35, v12
  v_max3_u32 v12, v36, v37, v12
  v_max3_u32 v12, v38, v39, v12
  v_max3_u32 v12, v40, v41, v12
  v_max3_u32 v12, v42, v43, v12
  v_max3_u32 v12, v44, v45, v12
  v_max3_u32 v12, v46, v47, v12
  v_max3_u32 v12, v48, v49, v12
  v_max3_u32 v12, v50, v51, v12
  v_max3_u32 v12, v52, v53, v12
  v_max3_u32 v12, v54, v55, v12
  v_cmp_eq_u32 vcc, -1, v12
  s_cbranch_vccnz va_poll
  s_mov_b64 s[16:17], 0
  ds_read_b128 v[56:59], v2 offset:0
  ds_read_b128 v[60:63], v2 offset:4096
  ds_read_b128 v[64:67], v2 offset:8192
  ds_read_b128 v[68:71], v2 offset:12288
  ds_read_b128 v[72:75], v2 offset:16384
  ds_read_b128 v[76:79], v2 offset:20480
  ds_read_b128 v[80:83], v2 offset:24576
  ds_read_b128 v[84:87], v2 offset:28672
  v_mov_b32 v88, 0
  v_mov_b32 v89, 0
  v_mov_b32 v90, 0
  v_mov_b32 v91, 0
  v_mov_b32 v92, 0
  v_mov_b32 v93, 0
  v_mov_b32 v94, 0
  v_mov_b32 v95, 0
  v_mov_b32 v96, 0
  v_mov_b32 v97, 0
  v_mov_b32 v98, 0
  v_mov_b32 v99, 0
  v_mov_b32 v100, 0
  v_mov_b32 v101, 0
  v_mov_b32 v102, 0
  v_mov_b32 v103, 0
  v_mov_b32 v104, 0
  v_mov_b32 v105, 0
  v_mov_b32 v106, 0
  v_mov_b32 v107, 0
  v_mov_b32 v108, 0
  v_mov_b32 v109, 0
  v_mov_b32 v110, 0
  v_mov_b32 v111, 0
  v_mov_b32 v112, 0
  v_mov_b32 v113, 0
  v_mov_b32 v114, 0
  v_mov_b32 v115, 0
  v_mov_b32 v128, 0
  v_mov_b32 v129, 0
  v_mov_b32 v130, 0
  v_mov_b32 v131, 0
  v_mov_b32 v132, 0
  v_mov_b32 v133, 0
  v_mov_b32 v134, 0
  v_mov_b32 v135, 0
  v_mov_b32 v136, 0
  v_mov_b32 v137, 0
  v_mov_b32 v138, 0
  v_mov_b32 v139, 0
  v_mov_b32 v140, 0
  v_mov_b32 v141, 0
  v_mov_b32 v142, 0
  v_mov_b32 v143, 0
  v_mov_b32 v144, 0
  v_mov_b32 v145, 0
  v_mov_b32 v146, 0
  v_mov_b32 v147, 0
  s_waitcnt lgkmcnt(0)
  v_smfmac_f32_16x16x64_bf16 v[104:107], v[16:19], v[56:63], v7
  v_smfmac_f32_16x16x64_bf16 v[108:111], v[16:19], v[64:71], v7
  v_smfmac_f32_16x16x64_bf16 v[112:115], v[16:19], v[72:79], v7
  ds_read_b128 v[56:59], v2 offset:49152
  v_smfmac_f32_16x16x64_bf16 v[104:107], v[20:23], a[0:7], v7
  ds_read_b128 v[60:63], v2 offset:53248
  v_smfmac_f32_16x16x64_bf16 v[108:111], v[20:23], a[8:15], v7
  ds_read_b128 v[64:67], v2 offset:32768
  v_smfmac_f32_16x16x64_bf16 v[112:115], v[20:23], a[16:23], v7
  v_smfmac_f32_16x16x64_bf16 v[104:107], v[24:27], a[24:31], v7
  v_smfmac_f32_16x16x64_bf16 v[108:111], v[24:27], a[32:39], v7
  v_smfmac_f32_16x16x64_bf16 v[112:115], v[24:27], a[40:47], v7
  v_mov_b32 v16, 0
  v_smfmac_f32_16x16x64_bf16 v[104:107], v[28:31], a[48:55], v7
  v_smfmac_f32_16x16x64_bf16 v[104:107], v[32:35], v[80:87], v7
  v_smfmac_f32_16x16x64_bf16 v[104:107], v[36:39], a[72:79], v7
  ds_read_b128 v[68:71], v2 offset:36864
  v_smfmac_f32_16x16x64_bf16 v[104:107], v[40:43], a[96:103], v7
  v_smfmac_f32_16x16x64_bf16 v[104:107], v[44:47], a[120:127], v7
  s_waitcnt lgkmcnt(1)
  v_smfmac_f32_16x16x64_bf16 v[104:107], v[48:51], v[56:63], v7
  v_smfmac_f32_16x16x64_bf16 v[104:107], v[52:55], a[144:151], v7
  ds_read_b128 v[72:75], v2 offset:57344
  v_smfmac_f32_16x16x64_bf16 v[108:111], v[28:31], a[56:63], v7
  ds_read_b128 v[76:79], v2 offset:61440
  s_waitcnt lgkmcnt(2)
  v_smfmac_f32_16x16x64_bf16 v[108:111], v[32:35], v[64:71], v7
  v_mov_b32 v17, 0
  s_waitcnt lgkmcnt(0)
  s_branch va_join
L_owner:
  s_cmp_ge_u32 s42, 2
  s_cbranch_scc1 L_end
  s_mul_i32 s62, s43, 10
  s_add_u32 s62, s62, s44
  s_sub_u32 s62, s62, 16
  s_mov_b32 s12, s24
  s_mov_b32 s13, s25
  s_mov_b32 s14, 10240
  s_mov_b32 s15, 0x20000
  v_mov_b32 v20, -1
  v_mov_b32 v24, 0
  v_mov_b32 v21, -1
  v_mov_b32 v25, 0
  v_mov_b32 v22, -1
  v_mov_b32 v26, 0
  v_mov_b32 v23, -1
  v_mov_b32 v27, 0
  s_lshl_b32 s48, s42, 13
  s_lshl_b32 s46, s62, 8
  s_cmp_ge_u32 s62, 32
  s_cselect_b32 s47, 40960, 0
  s_add_u32 s46, s46, s47
  s_add_u32 s46, s46, s48
  s_add_u32 s46, s46, 12582912
  v_and_b32 v13, 15, v0
  v_lshlrev_b32 v13, 4, v13
  v_lshrrev_b32 v12, 4, v0
  v_lshl_add_u32 v13, v12, 16, v13
  buffer_store_dwordx4 v[20:23], v13, s[8:11], s46 offen sc1
  s_add_u32 s46, s46, 262144
  buffer_store_dwordx4 v[20:23], v13, s[8:11], s46 offen sc1
  s_add_u32 s46, s46, 262144
  buffer_store_dwordx4 v[20:23], v13, s[8:11], s46 offen sc1
  s_add_u32 s46, s46, 262144
  s_lshl_b32 s46, s62, 9
  s_cmp_ge_u32 s62, 16
  s_cselect_b32 s47, 8192, 0
  s_add_u32 s46, s46, s47
  s_cmp_ge_u32 s62, 32
  s_cselect_b32 s47, 10240, 0
  s_add_u32 s46, s46, s47
  s_add_u32 s46, s46, s48
  s_add_u32 s46, s46, 12599296
  v_lshlrev_b32 v13, 3, v0
  buffer_store_dwordx2 v[20:21], v13, s[8:11], s46 offen sc1
  s_add_u32 s46, s46, 262144
  buffer_store_dwordx2 v[20:21], v13, s[8:11], s46 offen sc1
  s_add_u32 s46, s46, 262144
  buffer_store_dwordx2 v[20:21], v13, s[8:11], s46 offen sc1
  s_add_u32 s46, s46, 262144
  v_min_u32 v13, 4, v0
  v_lshlrev_b32 v13, 7, v13
  s_lshl_b32 s46, s62, 1
  s_add_u32 s46, s46, s42
  s_mul_i32 s46, s46, 640
  s_add_u32 s46, s46, 1048576
  buffer_store_dwordx4 v[24:27], v13, s[8:11], s46 offen sc1
  s_and_b32 s46, s62, 31
  s_lshl_b32 s46, s46, 8
  s_add_u32 s46, s46, s48
  s_add_u32 s46, s46, 13369344
  v_and_b32 v13, 1, v0
  v_lshlrev_b32 v13, 7, v13
  v_bfe_u32 v12, v0, 1, 1
  v_lshl_add_u32 v13, v12, 14, v13
  buffer_store_dwordx4 v[24:27], v13, s[8:11], s46 offen sc1
  v_mov_b32 v13, 192
  v_mov_b32 v14, 1
  s_waitcnt vmcnt(0)
  s_mov_b64 exec, 1
  global_atomic_add v12, v13, v14, s[38:39] sc0 sc1
  s_waitcnt vmcnt(0)
  v_readfirstlane_b32 s46, v12
  s_nop 0
  s_cmp_lg_u32 s46, 79
  s_cbranch_scc1 ow_notlast
  v_mov_b32 v13, 8
  global_store_dword v13, v14, s[38:39] sc1
ow_notlast:
  s_mov_b64 exec, -1
  s_mov_b32 s50, 0
ss_29:
  v_and_b32 v11, 3, v0
  v_lshlrev_b32 v11, 2, v11
  global_load_dword v10, v11, s[38:39] sc1
  s_add_u32 s50, s50, 1
  s_cmp_gt_u32 s50, 131072
  s_cbranch_scc1 L_fail
  s_waitcnt vmcnt(0)
ss_29_in:
  v_readlane_b32 s46, v10, 0
  v_readlane_b32 s47, v10, 2
  v_readlane_b32 s48, v10, 1
  s_nop 0
  s_min_u32 s47, s47, s48
  s_cmp_lg_u32 s46, 0
  s_cselect_b32 s48, 7, 0
  s_add_u32 s46, s46, s2
  s_xor_b32 s49, s46, s43
  s_and_b32 s49, s49, s48
  s_cbranch_scc1 L_reroll
  s_cmp_lg_u32 s47, 0
  s_cbranch_scc1 ss_ok_30
  s_sleep 6
  s_branch ss_29
ss_ok_30:
  v_readlane_b32 s3, v10, 1
  s_nop 0
  s_and_b32 s3, s3, 0x2000
  s_lshr_b32 s46, s44, 4
  s_lshl_b32 s46, s46, 7
  s_lshl_b32 s47, s43, 4
  s_add_u32 s46, s46, s47
  s_and_b32 s47, s44, 15
  s_add_u32 s46, s46, s47
  s_lshl_b32 s46, s46, 7
  s_add_u32 s46, s46, s3
  s_add_u32 s46, s46, 13369344
  s_add_u32 s40, s8, s46
  s_addc_u32 s41, s9, 0
  s_sub_u32 s47, s44, 16
  s_lshl_b32 s46, s47, 11
  s_lshl_b32 s48, s43, 2
  s_add_u32 s46, s46, s48
  s_add_u32 s46, s46, s3
  s_add_u32 s46, s46, 13369344
  v_lshl_add_u32 v7, v0, 7, s46
  v_mov_b32 v10, 2146435072
  s_cmp_lt_u32 s47, 4
  s_cselect_b32 vcc_lo, 65535, 0
  s_mov_b32 vcc_hi, 0
  v_cndmask_b32 v7, v10, v7, vcc
  v_mov_b32 v17, 0
  v_lshlrev_b32 v9, 7, v0
  s_and_b32 s46, s62, 3
  s_lshl_b32 s46, s46, 2
  s_add_u32 s46, s46, 1060864
  v_add_u32 v9, s46, v9
  v_and_b32 v18, 3, v0
  v_min_u32 v18, 2, v18
  v_lshlrev_b32 v18, 8, v18
  s_mul_i32 s46, s43, 768
  s_cmp_ge_u32 s44, 21
  s_cselect_b32 s47, 128, 0
  s_add_u32 s46, s46, s47
  s_add_u32 s46, s46, 1073152
  v_add_u32 v18, s46, v18
  v_cmp_lt_u32 vcc, 31, v0
  s_nop 1
  v_cndmask_b32 v9, v9, v18, vcc
  s_cmp_eq_u32 s42, 0
  s_cbranch_scc1 ow_main
  v_mov_b32 v14, 2146435072
  s_lshl_b32 s46, s43, 11
  s_add_u32 s46, s46, s3
  s_add_u32 s46, s46, 13387008
  v_lshl_add_u32 v19, v0, 7, s46
  s_lshl_b32 s46, s43, 7
  s_add_u32 s46, s46, 1077248
  v_writelane_b32 v19, s46, 6
  s_cmp_eq_u32 s44, 20
  s_cselect_b32 vcc_lo, 127, 0
  s_mov_b32 vcc_hi, 0
  v_cndmask_b32 v19, v14, v19, vcc
  s_mov_b32 s53, 1
  v_mov_b32 v15, 0
ow_listen:
  s_add_u32 s46, s53, 2
  s_min_u32 s46, s46, 64
  v_cmp_gt_u32 vcc, s46, v15
  s_nop 0
  s_and_saveexec_b64 s[64:65], vcc
  s_cbranch_execz ow_fresh
  buffer_load_dword v15, v9, s[8:11], 0 offen sc1
ow_fresh:
  s_mov_b64 exec, -1
  s_add_u32 s46, s53, 1
  v_mov_b32 v16, s46
  s_mov_b32 s50, 0
  s_waitcnt lgkmcnt(0)
  s_mov_b64 s[80:81], 0
  s_mov_b64 s[82:83], 0
bell_31:
  s_load_dwordx4 s[80:83], s[40:41], 0 glc
  s_min_u32 s46, s80, s81
  s_min_u32 s47, s82, s83
  s_min_u32 s46, s46, s47
  s_cmp_ge_u32 s46, s53
  s_cbranch_scc1 bell_x_32
  s_min_u32 s46, s80, s81
  s_min_u32 s47, s82, s83
  s_min_u32 s46, s46, s47
  s_cmp_ge_u32 s46, s53
  s_cbranch_scc1 bell_x_32
  s_min_u32 s46, s80, s81
  s_min_u32 s47, s82, s83
  s_min_u32 s46, s46, s47
  s_cmp_ge_u32 s46, s53
  s_cbranch_scc1 bell_x_32
  s_min_u32 s46, s80, s81
  s_min_u32 s47, s82, s83
  s_min_u32 s46, s46, s47
  s_cmp_ge_u32 s46, s53
  s_cbranch_scc1 bell_x_32
  s_min_u32 s46, s80, s81
  s_min_u32 s47, s82, s83
  s_min_u32 s46, s46, s47
  s_cmp_ge_u32 s46, s53
  s_cbranch_scc1 bell_x_32
  s_min_u32 s46, s80, s81
  s_min_u32 s47, s82, s83
  s_min_u32 s46, s46, s47
  s_cmp_ge_u32 s46, s53
  s_cbranch_scc1 bell_x_32
  s_min_u32 s46, s80, s81
  s_min_u32 s47, s82, s83
  s_min_u32 s46, s46, s47
  s_cmp_ge_u32 s46, s53
  s_cbranch_scc1 bell_x_32
  s_add_u32 s50, s50, 1
  s_cmp_lt_u32 s50, 524288
  s_cbranch_scc1 bell_31
  s_branch L_fail
bell_x_32:
  s_barrier
  s_waitcnt vmcnt(0)
  v_mov_b32 v12, v15
  s_nop 1
  v_min_u32_dpp v12, v12, v12 row_ror:8 row_mask:0xf bank_mask:0xf
  s_nop 1
  v_min_u32_dpp v12, v12, v12 row_ror:4 row_mask:0xf bank_mask:0xf
  s_nop 1
  v_min_u32_dpp v12, v12, v12 row_ror:2 row_mask:0xf bank_mask:0xf
  s_nop 1
  v_min_u32_dpp v12, v12, v12 row_ror:1 row_mask:0xf bank_mask:0xf
  v_mov_b32 v13, v12
  s_nop 1
  v_permlane16_swap_b32 v13, v12
  v_min_u32 v12, v12, v13
  v_mov_b32 v13, v12
  s_nop 1
  v_permlane32_swap_b32 v13, v12
  v_min_u32 v12, v12, v13
  ds_write_b32 v17, v12
  s_sub_u32 s46, s53, 1
  s_waitcnt lgkmcnt(0)
  v_mov_b32 v12, s46
  s_barrier
  s_sleep 4
  buffer_store_dword v12, v19, s[8:11], 0 offen sc1
  s_sleep 8
  s_add_u32 s53, s53, 1
  s_cmp_lt_u32 s53, 64
  s_cbranch_scc1 ow_listen
  s_endpgm
ow_main:
  v_mov_b32 v5, 0x44444444
  v_mov_b32 v10, 0xeeeeeeee
  v_and_b32 v11, 2, v0
  v_cmp_ne_u32 vcc, 0, v11
  s_nop 1
  v_cndmask_b32 v5, v5, v10, vcc
  v_lshlrev_b32 v1, 4, v0
  v_and_b32 v10, 15, v0
  v_lshrrev_b32 v11, 4, v0
  v_lshlrev_b32 v2, 3, v10
  v_lshl_add_u32 v2, v11, 8, v2
  v_and_b32 v13, 1, v10
  v_lshl_add_u32 v12, v11, 1, v13
  v_mov_b32 v4, 0x05040100
  v_mov_b32 v14, 0x03020706
  v_cmp_eq_u32 vcc, 1, v13
  s_nop 1
  v_cndmask_b32 v4, v4, v14, vcc
  v_and_b32 v13, 3, v10
  v_lshl_add_u32 v3, v11, 2, v13
  v_lshlrev_b32 v3, 4, v3
  v_lshrrev_b32 v13, 2, v10
  v_lshl_add_u32 v3, v13, 2, v3
  s_lshl_b32 s46, s62, 8
  s_cmp_ge_u32 s62, 32
  s_cselect_b32 s47, 40960, 0
  s_add_u32 s46, s46, s47
  s_add_u32 s46, s46, s3
  s_add_u32 s46, s46, 12582912
  v_add_u32 v3, s46, v3
  v_mul_u32_u24 v12, 1280, v12
  v_and_b32 v13, 14, v10
  v_lshl_add_u32 v12, v13, 1, v12
  s_lshl_b32 s46, s62, 5
  buffer_load_dword v15, v12, s[12:15], s46 offen
  s_lshl_b32 s63, s62, 16
  s_add_u32 s63, s63, s3
  s_add_u32 s63, s63, 81788928
  s_mov_b32 s61, 0
  s_mov_b32 s52, 0
  s_mov_b32 s58, 0
  s_mov_b32 s54, 0
  s_mov_b32 s100, 0
  s_mov_b32 s49, 1
  s_cmp_ge_u32 s61, s49
  s_cbranch_scc1 wf_done_33
  s_mov_b32 s50, 0
wf_loop_34:
  buffer_load_dword v12, v18, s[8:11], 0 offen sc1
  s_add_u32 s50, s50, 1
  s_cmp_gt_u32 s50, 131072
  s_cbranch_scc1 L_fail
  s_waitcnt vmcnt(0)
  v_min_u32_dpp v12, v12, v12 row_ror:8 row_mask:0xf bank_mask:0xf
  s_nop 1
  v_min_u32_dpp v12, v12, v12 row_ror:4 row_mask:0xf bank_mask:0xf
  s_nop 1
  v_min_u32_dpp v12, v12, v12 row_ror:2 row_mask:0xf bank_mask:0xf
  s_nop 1
  v_min_u32_dpp v12, v12, v12 row_ror:1 row_mask:0xf bank_mask:0xf
  v_mov_b32 v13, v12
  s_nop 1
  v_permlane16_swap_b32 v13, v12
  v_min_u32 v12, v12, v13
  v_mov_b32 v13, v12
  s_nop 1
  v_permlane32_swap_b32 v13, v12
  v_min_u32 v12, v12, v13
  s_nop 0
  v_readfirstlane_b32 s61, v12
  s_nop 0
  s_cmp_ge_u32 s61, s49
  s_cbranch_scc1 wf_done_33
  s_sleep 2
  s_branch wf_loop_34
wf_done_33:
  s_mov_b32 s61, 0
  v_min_u32 v15, -2, v15
  s_mov_b32 s46, 0
  buffer_store_dword v15, v3, s[8:11], s46 offen sc1
  s_mov_b32 s46, 65536
  buffer_store_dword v15, v3, s[8:11], s46 offen sc1
  s_mov_b32 s46, 131072
  buffer_store_dword v15, v3, s[8:11], s46 offen sc1
  s_mov_b32 s46, 196608
  buffer_store_dword v15, v3, s[8:11], s46 offen sc1
  v_mov_b32 v16, 1
  buffer_store_dword v16, v7, s[8:11], 0 offen sc1
  s_mov_b32 s49, 1
  s_cmp_ge_u32 s61, s49
  s_cbranch_scc1 wf_done_35
  s_mov_b32 s50, 0
wf_loop_36:
  buffer_load_dword v12, v9, s[8:11], 0 offen sc1
  s_add_u32 s50, s50, 1
  s_cmp_gt_u32 s50, 131072
  s_cbranch_scc1 L_fail
  s_waitcnt vmcnt(0)
  v_min_u32_dpp v12, v12, v12 row_ror:8 row_mask:0xf bank_mask:0xf
  s_nop 1
  v_min_u32_dpp v12, v12, v12 row_ror:4 row_mask:0xf bank_mask:0xf
  s_nop 1
  v_min_u32_dpp v12, v12, v12 row_ror:2 row_mask:0xf bank_mask:0xf
  s_nop 1
  v_min_u32_dpp v12, v12, v12 row_ror:1 row_mask:0xf bank_mask:0xf
  v_mov_b32 v13, v12
  s_nop 1
  v_permlane16_swap_b32 v13, v12
  v_min_u32 v12, v12, v13
  v_mov_b32 v13, v12
  s_nop 1
  v_permlane32_swap_b32 v13, v12
  v_min_u32 v12, v12, v13
  s_nop 0
  v_readfirstlane_b32 s61, v12
  s_nop 0
  s_cmp_ge_u32 s61, s49
  s_cbranch_scc1 wf_done_35
  s_sleep 2
  s_branch wf_loop_36
wf_done_35:
  s_mov_b32 s65, s63
  s_lshr_b32 s46, s65, 8
  s_and_b32 s46, s46, 0x2000
  s_xor_b32 s65, s65, s46
  s_add_u32 s63, s63, 2621440
  s_cmp_ge_u32 s63, 165675008
  s_cselect_b32 s46, 83886080, 0
  s_sub_u32 s63, s63, s46
  s_add_u32 s46, s65, 0
  s_xor_b32 s46, s46, 0x2000
  buffer_load_dwordx4 a[0:3], v1, s[8:11], s46 offen offset:0 sc1
  buffer_load_dwordx4 a[4:7], v1, s[8:11], s46 offen offset:1024 sc1
  buffer_load_dwordx4 a[8:11], v1, s[8:11], s46 offen offset:2048 sc1
  buffer_load_dwordx4 a[12:15], v1, s[8:11], s46 offen offset:3072 sc1
  s_add_u32 s46, s65, 4096
  s_xor_b32 s46, s46, 0x2000
  buffer_load_dwordx4 a[16:19], v1, s[8:11], s46 offen offset:0 sc1
  buffer_load_dwordx4 a[20:23], v1, s[8:11], s46 offen offset:1024 sc1
  buffer_load_dwordx4 a[24:27], v1, s[8:11], s46 offen offset:2048 sc1
  buffer_load_dwordx4 a[28:31], v1, s[8:11], s46 offen offset:3072 sc1
  s_add_u32 s46, s65, 16384
  buffer_load_dwordx4 a[32:35], v1, s[8:11], s46 offen offset:0 sc1
  buffer_load_dwordx4 a[36:39], v1, s[8:11], s46 offen offset:1024 sc1
  buffer_load_dwordx4 a[40:43], v1, s[8:11], s46 offen offset:2048 sc1
  buffer_load_dwordx4 a[44:47], v1, s[8:11], s46 offen offset:3072 sc1
  s_add_u32 s46, s65, 20480
  buffer_load_dwordx4 a[48:51], v1, s[8:11], s46 offen offset:0 sc1
  buffer_load_dwordx4 a[52:55], v1, s[8:11], s46 offen offset:1024 sc1
  buffer_load_dwordx4 a[56:59], v1, s[8:11], s46 offen offset:2048 sc1
  buffer_load_dwordx4 a[60:63], v1, s[8:11], s46 offen offset:3072 sc1
  s_add_u32 s46, s65, 32768
  buffer_load_dwordx4 a[64:67], v1, s[8:11], s46 offen offset:0 sc1
  buffer_load_dwordx4 a[68:71], v1, s[8:11], s46 offen offset:1024 sc1
  buffer_load_dwordx4 a[72:75], v1, s[8:11], s46 offen offset:2048 sc1
  buffer_load_dwordx4 a[76:79], v1, s[8:11], s46 offen offset:3072 sc1
  s_add_u32 s46, s65, 36864
  buffer_load_dwordx4 a[80:83], v1, s[8:11], s46 offen offset:0 sc1
  buffer_load_dwordx4 a[84:87], v1, s[8:11], s46 offen offset:1024 sc1
  buffer_load_dwordx4 a[88:91], v1, s[8:11], s46 offen offset:2048 sc1
  buffer_load_dwordx4 a[92:95], v1, s[8:11], s46 offen offset:3072 sc1
  s_add_u32 s46, s65, 49152
  buffer_load_dwordx4 a[96:99], v1, s[8:11], s46 offen offset:0 sc1
  buffer_load_dwordx4 a[100:103], v1, s[8:11], s46 offen offset:1024 sc1
  buffer_load_dwordx4 a[104:107], v1, s[8:11], s46 offen offset:2048 sc1
  buffer_load_dwordx4 a[108:111], v1, s[8:11], s46 offen offset:3072 sc1
  s_add_u32 s46, s65, 53248
  buffer_load_dwordx4 a[112:115], v1, s[8:11], s46 offen offset:0 sc1
  buffer_load_dwordx4 a[116:119], v1, s[8:11], s46 offen offset:1024 sc1
  buffer_load_dwordx4 a[120:123], v1, s[8:11], s46 offen offset:2048 sc1
  buffer_load_dwordx4 a[124:127], v1, s[8:11], s46 offen offset:3072 sc1
ow_loop:
  s_add_u32 s53, s52, 1
  s_lshl_b32 s56, s58, 2
  s_add_u32 s56, s56, s43
  s_lshl_b32 s56, s56, 16
  s_add_u32 s56, s56, s3
  s_add_u32 s56, s56, 12582912
  s_add_u32 s66, s58, 1
  s_cmp_eq_u32 s66, 3
  s_cselect_b32 s66, 0, s66
  s_lshl_b32 s72, s54, 21
  s_mul_i32 s46, s58, 655360
  s_add_u32 s72, s72, s46
  s_add_u32 s72, s72, s3
  s_add_u32 s72, s72, 4194304
  s_lshr_b32 s46, s72, 8
  s_and_b32 s46, s46, 0x2000
  s_xor_b32 s72, s72, s46
  s_lshl_b32 s46, s62, 14
  s_add_u32 s72, s72, s46
  s_add_u32 s73, s72, 4096
  s_and_b32 s46, s43, 3
  s_lshl_b32 s46, s46, 16
  s_sub_u32 s56, s56, s46
  s_add_u32 s74, s56, 16384
  s_add_u32 s75, s56, 20480
  s_add_u32 s76, s56, 32768
  s_add_u32 s77, s56, 36864
  s_add_u32 s78, s56, 51200
  s_lshl_b32 s80, s66, 18
  s_add_u32 s81, s80, 65536
  s_add_u32 s82, s80, 131072
  s_add_u32 s83, s80, 196608
  s_cmp_lg_u32 s52, 0
  s_addc_u32 s64, s52, 1
  v_mov_b32 v16, s64
  s_mov_b64 s[16:17], -1
  s_mov_b32 s71, 0
  v_mov_b32 v20, 0
  v_mov_b32 v21, 0
  v_mov_b32 v22, 0
  v_mov_b32 v23, 0
  s_waitcnt vmcnt(0)
  s_barrier
  buffer_load_dwordx4 v[24:27], v1, s[8:11], s72 offen offset:0 sc1
  buffer_load_dwordx4 v[28:31], v1, s[8:11], s72 offen offset:1024 sc1
  buffer_load_dwordx4 v[32:35], v1, s[8:11], s72 offen offset:2048 sc1
  buffer_load_dwordx4 v[36:39], v1, s[8:11], s72 offen offset:3072 sc1
  buffer_load_dwordx4 v[40:43], v1, s[8:11], s73 offen offset:0 sc1
  buffer_load_dwordx4 v[44:47], v1, s[8:11], s73 offen offset:1024 sc1
  buffer_load_dwordx4 v[48:51], v1, s[8:11], s73 offen offset:2048 sc1
  buffer_load_dwordx4 v[52:55], v1, s[8:11], s73 offen offset:3072 sc1
  buffer_load_dwordx4 v[56:59], v1, s[8:11], s78 offen offset:0 sc1
  buffer_load_dwordx4 v[60:63], v1, s[8:11], s78 offen offset:1024 sc1
  buffer_load_dwordx4 v[64:67], v1, s[8:11], s78 offen offset:2048 sc1
  buffer_load_dwordx4 v[68:71], v1, s[8:11], s78 offen offset:3072 sc1
  buffer_load_dwordx4 v[72:75], v1, s[8:11], s74 offen offset:0 sc1
  buffer_load_dwordx4 v[76:79], v1, s[8:11], s74 offen offset:1024 sc1
  buffer_load_dwordx4 v[80:83], v1, s[8:11], s74 offen offset:2048 sc1
  buffer_load_dwordx4 v[84:87], v1, s[8:11], s74 offen offset:3072 sc1
  buffer_load_dwordx4 v[88:91], v1, s[8:11], s75 offen offset:0 sc1
  buffer_load_dwordx4 v[92:95], v1, s[8:11], s75 offen offset:1024 sc1
  buffer_load_dwordx4 v[96:99], v1, s[8:11], s75 offen offset:2048 sc1
  buffer_load_dwordx4 v[100:103], v1, s[8:11], s75 offen offset:3072 sc1
  buffer_load_dwordx4 v[104:107], v1, s[8:11], s76 offen offset:0 sc1
  buffer_load_dwordx4 v[108:111], v1, s[8:11], s76 offen offset:1024 sc1
  buffer_load_dwordx4 v[112:115], v1, s[8:11], s76 offen offset:2048 sc1
  buffer_load_dwordx4 v[116:119], v1, s[8:11], s76 offen offset:3072 sc1
  buffer_load_dwordx4 v[120:123], v1, s[8:11], s77 offen offset:0 sc1
  buffer_load_dwordx4 v[124:127], v1, s[8:11], s77 offen offset:1024 sc1
  buffer_load_dwordx4 v[128:131], v1, s[8:11], s77 offen offset:2048 sc1
  buffer_load_dwordx4 v[132:135], v1, s[8:11], s77 offen offset:3072 sc1
ow_go:
  s_waitcnt vmcnt(20)
  buffer_store_dword v16, v7, s[8:11], 0 offen sc1
  s_waitcnt vmcnt(20)
  v_smfmac_f32_16x16x64_bf16 v[20:23], v[56:59], v[24:31], v5
  s_waitcnt vmcnt(19)
  v_smfmac_f32_16x16x64_bf16 v[20:23], v[60:63], v[32:39], v5
  s_waitcnt vmcnt(18)
  v_smfmac_f32_16x16x64_bf16 v[20:23], v[64:67], v[40:47], v5
  s_waitcnt vmcnt(17)
  v_smfmac_f32_16x16x64_bf16 v[20:23], v[68:71], v[48:55], v5
  s_waitcnt vmcnt(16)
  v_smfmac_f32_16x16x64_bf16 v[20:23], v[72:75], a[0:7], v5
  s_waitcnt vmcnt(15)
  v_smfmac_f32_16x16x64_bf16 v[20:23], v[76:79], a[8:15], v5
  s_waitcnt vmcnt(14)
  v_smfmac_f32_16x16x64_bf16 v[20:23], v[80:83], a[16:23], v5
  s_waitcnt vmcnt(13)
  v_smfmac_f32_16x16x64_bf16 v[20:23], v[84:87], a[24:31], v5
  s_waitcnt vmcnt(12)
  v_smfmac_f32_16x16x64_bf16 v[20:23], v[88:91], a[32:39], v5
  s_waitcnt vmcnt(11)
  v_smfmac_f32_16x16x64_bf16 v[20:23], v[92:95], a[40:47], v5
  s_waitcnt vmcnt(10)
  v_smfmac_f32_16x16x64_bf16 v[20:23], v[96:99], a[48:55], v5
  s_waitcnt vmcnt(9)
  v_smfmac_f32_16x16x64_bf16 v[20:23], v[100:103], a[56:63], v5
  s_waitcnt vmcnt(8)
  v_smfmac_f32_16x16x64_bf16 v[20:23], v[104:107], a[64:71], v5
  s_waitcnt vmcnt(7)
  v_smfmac_f32_16x16x64_bf16 v[20:23], v[108:111], a[72:79], v5
  s_waitcnt vmcnt(6)
  v_smfmac_f32_16x16x64_bf16 v[20:23], v[112:115], a[80:87], v5
  s_waitcnt vmcnt(5)
  v_smfmac_f32_16x16x64_bf16 v[20:23], v[116:119], a[88:95], v5
  s_waitcnt vmcnt(4)
  v_smfmac_f32_16x16x64_bf16 v[20:23], v[120:123], a[96:103], v5
  s_waitcnt vmcnt(3)
  v_smfmac_f32_16x16x64_bf16 v[20:23], v[124:127], a[104:111], v5
  s_waitcnt vmcnt(2)
  v_smfmac_f32_16x16x64_bf16 v[20:23], v[128:131], a[112:119], v5
  s_waitcnt vmcnt(1)
  v_smfmac_f32_16x16x64_bf16 v[20:23], v[132:135], a[120:127], v5
  s_nop 7
  v_pk_add_f32 v[20:21], v[20:21], v[22:23]
  v_cmp_u_f32 vcc, v20, v21
  v_cvt_pk_bf16_f32 v10, v20, v21
  s_nop 1
  v_mov_b32_dpp v11, v10 quad_perm:[1,0,3,2] row_mask:0xf bank_mask:0xf
  v_perm_b32 v10, v11, v10, v4
  s_and_b64 vcc, vcc, s[16:17]
  s_cbranch_scc1 ow_redo
  buffer_store_dword v10, v3, s[8:11], s80 offen sc1
  buffer_store_dword v10, v3, s[8:11], s81 offen sc1
  buffer_store_dword v10, v3, s[8:11], s82 offen sc1
  buffer_store_dword v10, v3, s[8:11], s83 offen sc1
  s_barrier
  s_add_u32 s49, s52, 2
  s_cmp_lg_u32 s52, 0
  s_cbranch_scc1 ow_rung
  v_mov_b32 v16, 2
  buffer_store_dword v16, v7, s[8:11], 0 offen sc1
ow_rung:
  s_waitcnt vmcnt(0)
  s_sleep 2
  ds_read_b32 v12, v17
  s_waitcnt lgkmcnt(0)
  v_readfirstlane_b32 s46, v12
  s_nop 0
  s_max_u32 s61, s61, s46
  s_cmp_ge_u32 s61, s49
  s_cbranch_scc1 wf_done_37
  s_mov_b32 s50, 0
wf_loop_38:
  buffer_load_dword v12, v9, s[8:11], 0 offen sc1
  s_add_u32 s50, s50, 1
  s_cmp_gt_u32 s50, 131072
  s_cbranch_scc1 L_fail
  s_waitcnt vmcnt(0)
  v_min_u32_dpp v12, v12, v12 row_ror:8 row_mask:0xf bank_mask:0xf
  s_nop 1
  v_min_u32_dpp v12, v12, v12 row_ror:4 row_mask:0xf bank_mask:0xf
  s_nop 1
  v_min_u32_dpp v12, v12, v12 row_ror:2 row_mask:0xf bank_mask:0xf
  s_nop 1
  v_min_u32_dpp v12, v12, v12 row_ror:1 row_mask:0xf bank_mask:0xf
  v_mov_b32 v13, v12
  s_nop 1
  v_permlane16_swap_b32 v13, v12
  v_min_u32 v12, v12, v13
  v_mov_b32 v13, v12
  s_nop 1
  v_permlane32_swap_b32 v13, v12
  v_min_u32 v12, v12, v13
  s_nop 0
  v_readfirstlane_b32 s61, v12
  s_nop 0
  s_cmp_ge_u32 s61, s49
  s_cbranch_scc1 wf_done_37
  s_sleep 2
  s_branch wf_loop_38
wf_done_37:
  s_mov_b32 s65, s63
  s_lshr_b32 s46, s65, 8
  s_and_b32 s46, s46, 0x2000
  s_xor_b32 s65, s65, s46
  s_add_u32 s63, s63, 2621440
  s_cmp_ge_u32 s63, 165675008
  s_cselect_b32 s46, 83886080, 0
  s_sub_u32 s63, s63, s46
  s_add_u32 s46, s65, 0
  s_xor_b32 s46, s46, 0x2000
  buffer_load_dwordx4 a[0:3], v1, s[8:11], s46 offen offset:0 sc1
  buffer_load_dwordx4 a[4:7], v1, s[8:11], s46 offen offset:1024 sc1
  buffer_load_dwordx4 a[8:11], v1, s[8:11], s46 offen offset:2048 sc1
  buffer_load_dwordx4 a[12:15], v1, s[8:11], s46 offen offset:3072 sc1
  s_add_u32 s46, s65, 4096
  s_xor_b32 s46, s46, 0x2000
  buffer_load_dwordx4 a[16:19], v1, s[8:11], s46 offen offset:0 sc1
  buffer_load_dwordx4 a[20:23], v1, s[8:11], s46 offen offset:1024 sc1
  buffer_load_dwordx4 a[24:27], v1, s[8:11], s46 offen offset:2048 sc1
  buffer_load_dwordx4 a[28:31], v1, s[8:11], s46 offen offset:3072 sc1
  s_add_u32 s46, s65, 16384
  buffer_load_dwordx4 a[32:35], v1, s[8:11], s46 offen offset:0 sc1
  buffer_load_dwordx4 a[36:39], v1, s[8:11], s46 offen offset:1024 sc1
  buffer_load_dwordx4 a[40:43], v1, s[8:11], s46 offen offset:2048 sc1
  buffer_load_dwordx4 a[44:47], v1, s[8:11], s46 offen offset:3072 sc1
  s_add_u32 s46, s65, 20480
  buffer_load_dwordx4 a[48:51], v1, s[8:11], s46 offen offset:0 sc1
  buffer_load_dwordx4 a[52:55], v1, s[8:11], s46 offen offset:1024 sc1
  buffer_load_dwordx4 a[56:59], v1, s[8:11], s46 offen offset:2048 sc1
  buffer_load_dwordx4 a[60:63], v1, s[8:11], s46 offen offset:3072 sc1
  s_add_u32 s46, s65, 32768
  buffer_load_dwordx4 a[64:67], v1, s[8:11], s46 offen offset:0 sc1
  buffer_load_dwordx4 a[68:71], v1, s[8:11], s46 offen offset:1024 sc1
  buffer_load_dwordx4 a[72:75], v1, s[8:11], s46 offen offset:2048 sc1
  buffer_load_dwordx4 a[76:79], v1, s[8:11], s46 offen offset:3072 sc1
  s_add_u32 s46, s65, 36864
  buffer_load_dwordx4 a[80:83], v1, s[8:11], s46 offen offset:0 sc1
  buffer_load_dwordx4 a[84:87], v1, s[8:11], s46 offen offset:1024 sc1
  buffer_load_dwordx4 a[88:91], v1, s[8:11], s46 offen offset:2048 sc1
  buffer_load_dwordx4 a[92:95], v1, s[8:11], s46 offen offset:3072 sc1
  s_add_u32 s46, s65, 49152
  buffer_load_dwordx4 a[96:99], v1, s[8:11], s46 offen offset:0 sc1
  buffer_load_dwordx4 a[100:103], v1, s[8:11], s46 offen offset:1024 sc1
  buffer_load_dwordx4 a[104:107], v1, s[8:11], s46 offen offset:2048 sc1
  buffer_load_dwordx4 a[108:111], v1, s[8:11], s46 offen offset:3072 sc1
  s_add_u32 s46, s65, 53248
  buffer_load_dwordx4 a[112:115], v1, s[8:11], s46 offen offset:0 sc1
  buffer_load_dwordx4 a[116:119], v1, s[8:11], s46 offen offset:1024 sc1
  buffer_load_dwordx4 a[120:123], v1, s[8:11], s46 offen offset:2048 sc1
  buffer_load_dwordx4 a[124:127], v1, s[8:11], s46 offen offset:3072 sc1
  v_mov_b32 v11, -1
  s_lshl_b32 s47, s58, 18
  s_add_u32 s46, s47, 0
  buffer_store_dword v11, v3, s[8:11], s46 offen sc1
  s_add_u32 s46, s47, 65536
  buffer_store_dword v11, v3, s[8:11], s46 offen sc1
  s_add_u32 s46, s47, 131072
  buffer_store_dword v11, v3, s[8:11], s46 offen sc1
  s_add_u32 s46, s47, 196608
  buffer_store_dword v11, v3, s[8:11], s46 offen sc1
  s_mov_b32 s58, s66
  s_cmp_eq_u32 s58, 0
  s_addc_u32 s54, s54, 0
  s_cmp_eq_u32 s54, 3
  s_cselect_b32 s54, 0, s54
  s_mov_b32 s52, s53
  s_cmp_lt_u32 s52, 63
  s_cbranch_scc1 ow_loop
  s_endpgm
ow_redo:
  s_mov_b32 s50, 0
ow_poll:
  buffer_load_dwordx4 v[24:27], v1, s[8:11], s72 offen offset:0 sc1
  buffer_load_dwordx4 v[28:31], v1, s[8:11], s72 offen offset:1024 sc1
  buffer_load_dwordx4 v[32:35], v1, s[8:11], s72 offen offset:2048 sc1
  buffer_load_dwordx4 v[36:39], v1, s[8:11], s72 offen offset:3072 sc1
  buffer_load_dwordx4 v[40:43], v1, s[8:11], s73 offen offset:0 sc1
  buffer_load_dwordx4 v[44:47], v1, s[8:11], s73 offen offset:1024 sc1
  buffer_load_dwordx4 v[48:51], v1, s[8:11], s73 offen offset:2048 sc1
  buffer_load_dwordx4 v[52:55], v1, s[8:11], s73 offen offset:3072 sc1
  buffer_load_dwordx4 v[56:59], v1, s[8:11], s78 offen offset:0 sc1
  buffer_load_dwordx4 v[60:63], v1, s[8:11], s78 offen offset:1024 sc1
  buffer_load_dwordx4 v[64:67], v1, s[8:11], s78 offen offset:2048 sc1
  buffer_load_dwordx4 v[68:71], v1, s[8:11], s78 offen offset:3072 sc1
  buffer_load_dwordx4 v[72:75], v1, s[8:11], s74 offen offset:0 sc1
  buffer_load_dwordx4 v[76:79], v1, s[8:11], s74 offen offset:1024 sc1
  buffer_load_dwordx4 v[80:83], v1, s[8:11], s74 offen offset:2048 sc1
  buffer_load_dwordx4 v[84:87], v1, s[8:11], s74 offen offset:3072 sc1
  buffer_load_dwordx4 v[88:91], v1, s[8:11], s75 offen offset:0 sc1
  buffer_load_dwordx4 v[92:95], v1, s[8:11], s75 offen offset:1024 sc1
  buffer_load_dwordx4 v[96:99], v1, s[8:11], s75 offen offset:2048 sc1
  buffer_load_dwordx4 v[100:103], v1, s[8:11], s75 offen offset:3072 sc1
  buffer_load_dwordx4 v[104:107], v1, s[8:11], s76 offen offset:0 sc1
  buffer_load_dwordx4 v[108:111], v1, s[8:11], s76 offen offset:1024 sc1
  buffer_load_dwordx4 v[112:115], v1, s[8:11], s76 offen offset:2048 sc1
  buffer_load_dwordx4 v[116:119], v1, s[8:11], s76 offen offset:3072 sc1
  buffer_load_dwordx4 v[120:123], v1, s[8:11], s77 offen offset:0 sc1
  buffer_load_dwordx4 v[124:127], v1, s[8:11], s77 offen offset:1024 sc1
  buffer_load_dwordx4 v[128:131], v1, s[8:11], s77 offen offset:2048 sc1
  buffer_load_dwordx4 v[132:135], v1, s[8:11], s77 offen offset:3072 sc1
  s_add_u32 s71, s71, 1
  s_cmp_le_u32 s71, 2
  s_cbranch_scc1 ow_again
  s_add_u32 s50, s50, 1
  s_cmp_gt_u32 s50, 131072
  s_cbranch_scc1 L_fail
  s_waitcnt vmcnt(0)
  v_max_u32 v8, v24, v25
  v_max3_u32 v8, v26, v27, v8
  v_max3_u32 v8, v28, v29, v8
  v_max3_u32 v8, v30, v31, v8
  v_max3_u32 v8, v32, v33, v8
  v_max3_u32 v8, v34, v35, v8
  v_max3_u32 v8, v36, v37, v8
  v_max3_u32 v8, v38, v39, v8
  v_max3_u32 v8, v40, v41, v8
  v_max3_u32 v8, v42, v43, v8
  v_max3_u32 v8, v44, v45, v8
  v_max3_u32 v8, v46, v47, v8
  v_max3_u32 v8, v48, v49, v8
  v_max3_u32 v8, v50, v51, v8
  v_max3_u32 v8, v52, v53, v8
  v_max3_u32 v8, v54, v55, v8
  v_max3_u32 v8, v56, v57, v8
  v_max3_u32 v8, v58, v59, v8
  v_max3_u32 v8, v60, v61, v8
  v_max3_u32 v8, v62, v63, v8
  v_max3_u32 v8, v64, v65, v8
  v_max3_u32 v8, v66, v67, v8
  v_max3_u32 v8, v68, v69, v8
  v_max3_u32 v8, v70, v71, v8
  v_max3_u32 v8, v72, v73, v8
  v_max3_u32 v8, v74, v75, v8
  v_max3_u32 v8, v76, v77, v8
  v_max3_u32 v8, v78, v79, v8
  v_max3_u32 v8, v80, v81, v8
  v_max3_u32 v8, v82, v83, v8
  v_max3_u32 v8, v84, v85, v8
  v_max3_u32 v8, v86, v87, v8
  v_max3_u32 v8, v88, v89, v8
  v_max3_u32 v8, v90, v91, v8
  v_max3_u32 v8, v92, v93, v8
  v_max3_u32 v8, v94, v95, v8
  v_max3_u32 v8, v96, v97, v8
  v_max3_u32 v8, v98, v99, v8
  v_max3_u32 v8, v100, v101, v8
  v_max3_u32 v8, v102, v103, v8
  v_max3_u32 v8, v104, v105, v8
  v_max3_u32 v8, v106, v107, v8
  v_max3_u32 v8, v108, v109, v8
  v_max3_u32 v8, v110, v111, v8
  v_max3_u32 v8, v112, v113, v8
  v_max3_u32 v8, v114, v115, v8
  v_max3_u32 v8, v116, v117, v8
  v_max3_u32 v8, v118, v119, v8
  v_max3_u32 v8, v120, v121, v8
  v_max3_u32 v8, v122, v123, v8
  v_max3_u32 v8, v124, v125, v8
  v_max3_u32 v8, v126, v127, v8
  v_max3_u32 v8, v128, v129, v8
  v_max3_u32 v8, v130, v131, v8
  v_max3_u32 v8, v132, v133, v8
  v_max3_u32 v8, v134, v135, v8
  v_cmp_eq_u32 vcc, -1, v8
  s_cbranch_vccnz ow_poll
  s_mov_b64 s[16:17], 0
ow_again:
  v_mov_b32 v20, 0
  v_mov_b32 v21, 0
  v_mov_b32 v22, 0
  v_mov_b32 v23, 0
  s_branch ow_go
L_xowner:
  s_mov_b32 s12, s36
  s_mov_b32 s13, s37
  s_mov_b32 s14, 5242880
  s_mov_b32 s15, 0x20000
  s_mov_b32 s50, 0
ss_39:
  v_and_b32 v11, 3, v0
  v_lshlrev_b32 v11, 2, v11
  global_load_dword v10, v11, s[38:39] sc1
  s_add_u32 s50, s50, 1
  s_cmp_gt_u32 s50, 131072
  s_cbranch_scc1 L_fail
  s_waitcnt vmcnt(0)
ss_39_in:
  v_readlane_b32 s46, v10, 0
  v_readlane_b32 s47, v10, 1
  v_readlane_b32 s48, v10, 0
  s_nop 0
  s_min_u32 s47, s47, s48
  s_cmp_lg_u32 s46, 0
  s_cselect_b32 s48, 7, 0
  s_add_u32 s46, s46, s2
  s_xor_b32 s49, s46, s43
  s_and_b32 s49, s49, s48
  s_cbranch_scc1 L_reroll
  s_cmp_lg_u32 s47, 0
  s_cbranch_scc1 ss_ok_40
  s_sleep 6
  s_branch ss_39
ss_ok_40:
  v_readlane_b32 s3, v10, 1
  s_nop 0
  s_and_b32 s3, s3, 0x2000
  s_lshr_b32 s46, s44, 4
  s_lshl_b32 s46, s46, 7
  s_lshl_b32 s47, s43, 4
  s_add_u32 s46, s46, s47
  s_and_b32 s47, s44, 15
  s_add_u32 s46, s46, s47
  s_lshl_b32 s46, s46, 7
  s_add_u32 s46, s46, s3
  s_add_u32 s46, s46, 13369344
  s_add_u32 s40, s8, s46
  s_addc_u32 s41, s9, 0
  s_sub_u32 s48, s44, 26
  s_and_b32 s46, s48, 1
  s_mul_i32 s46, s46, 5
  s_mul_i32 s62, s43, 10
  s_add_u32 s62, s62, s46
  s_lshr_b32 s52, s48, 1
  v_lshlrev_b32 v1, 4, v0
  v_and_b32 v10, 7, v0
  v_lshlrev_b32 v10, 7, v10
  v_add_u32 v10, s51, v10
  v_bfe_u32 v11, v0, 3, 2
  v_lshl_add_u32 v2, v11, 2, v10
  v_add_u32 v3, 1064960, v2
  v_add_u32 v2, 1060864, v2
  v_bfe_u32 v11, v0, 3, 1
  v_lshl_add_u32 v4, v11, 2, v10
  v_add_u32 v4, 1069056, v4
  v_cmp_lt_u32 vcc, 31, v0
  s_nop 1
  v_cndmask_b32 v3, v3, v4, vcc
  s_mul_i32 s46, s43, 6
  s_add_u32 s46, s46, s48
  s_lshl_b32 s46, s46, 7
  s_add_u32 s46, s46, 1073152
  v_mov_b32 v15, s46
  v_mov_b32 v11, 2146435072
  s_cmp_eq_u32 s42, 0
  s_cselect_b64 vcc, 1, 0
  v_cndmask_b32 v15, v11, v15, vcc
  s_mul_i32 s46, s42, 10240
  v_add_u32 v5, s46, v1
  v_add_u32 v6, s51, v1
  s_mul_i32 s63, s52, 40
  s_add_u32 s63, s63, s62
  s_lshl_b32 s63, s63, 16
  s_lshl_b32 s46, s42, 14
  s_add_u32 s63, s63, s46
  s_add_u32 s63, s63, s3
  s_add_u32 s63, s63, 81788928
  s_lshr_b32 s46, 1, s42
  s_and_b32 s46, s46, 1
  s_lshl_b32 s46, s46, 13
  s_xor_b32 s63, s63, s46
  s_lshl_b32 s65, s52, 18
  s_add_u32 s65, s65, s3
  s_add_u32 s65, s65, 14680064
  s_lshl_b32 s67, s62, 14
  s_lshl_b32 s46, s42, 11
  s_add_u32 s67, s67, s46
  s_mov_b32 s58, s52
  s_mul_i32 s66, s52, 81920
  v_and_b32 v10, 15, v0
  v_mul_u32_u24 v10, 2560, v10
  v_lshrrev_b32 v11, 4, v0
  v_lshl_add_u32 v10, v11, 3, v10
  s_add_u32 s46, s42, 0
  s_cmp_ge_u32 s46, 5
  s_cselect_b32 s47, 40800, 0
  s_add_u32 s48, s46, s62
  s_lshl_b32 s48, s48, 5
  s_add_u32 s47, s47, s48
  s_add_u32 s47, s47, 1280
  s_cmp_ge_u32 s46, 10
  s_cselect_b32 s47, 2146435072, s47
  v_add_u32 v7, s47, v10
  s_add_u32 s46, s42, 4
  s_cmp_ge_u32 s46, 5
  s_cselect_b32 s47, 40800, 0
  s_add_u32 s48, s46, s62
  s_lshl_b32 s48, s48, 5
  s_add_u32 s47, s47, s48
  s_add_u32 s47, s47, 1280
  s_cmp_ge_u32 s46, 10
  s_cselect_b32 s47, 2146435072, s47
  v_add_u32 v8, s47, v10
  s_add_u32 s46, s42, 8
  s_cmp_ge_u32 s46, 5
  s_cselect_b32 s47, 40800, 0
  s_add_u32 s48, s46, s62
  s_lshl_b32 s48, s48, 5
  s_add_u32 s47, s47, s48
  s_add_u32 s47, s47, 1280
  s_cmp_ge_u32 s46, 10
  s_cselect_b32 s47, 2146435072, s47
  v_add_u32 v9, s47, v10
  v_mov_b32 v224, -1
  v_mov_b32 v225, -1
  v_mov_b32 v226, -1
  v_mov_b32 v227, -1
  s_cmp_lg_u32 s42, 0
  s_cbranch_scc1 xo_clr
  s_mov_b32 s54, 0
xo_clr0:
  s_lshl_b32 s64, s54, 21
  s_mul_i32 s46, s58, 655360
  s_add_u32 s64, s64, s46
  s_add_u32 s64, s64, s3
  s_add_u32 s64, s64, 4194304
  s_lshr_b32 s46, s64, 8
  s_and_b32 s46, s46, 0x2000
  s_xor_b32 s64, s64, s46
  s_add_u32 s64, s64, s67
  s_add_u32 s46, s64, 0
  buffer_store_dwordx4 v[224:227], v1, s[8:11], s46 offen offset:0 sc1
  buffer_store_dwordx4 v[224:227], v1, s[8:11], s46 offen offset:1024 sc1
  buffer_store_dwordx4 v[224:227], v1, s[8:11], s46 offen offset:2048 sc1
  buffer_store_dwordx4 v[224:227], v1, s[8:11], s46 offen offset:3072 sc1
  s_add_u32 s46, s64, 4096
  buffer_store_dwordx4 v[224:227], v1, s[8:11], s46 offen offset:0 sc1
  buffer_store_dwordx4 v[224:227], v1, s[8:11], s46 offen offset:1024 sc1
  buffer_store_dwordx4 v[224:227], v1, s[8:11], s46 offen offset:2048 sc1
  buffer_store_dwordx4 v[224:227], v1, s[8:11], s46 offen offset:3072 sc1
  s_add_u32 s46, s64, 16384
  buffer_store_dwordx4 v[224:227], v1, s[8:11], s46 offen offset:0 sc1
  buffer_store_dwordx4 v[224:227], v1, s[8:11], s46 offen offset:1024 sc1
  buffer_store_dwordx4 v[224:227], v1, s[8:11], s46 offen offset:2048 sc1
  buffer_store_dwordx4 v[224:227], v1, s[8:11], s46 offen offset:3072 sc1
  s_add_u32 s46, s64, 20480
  buffer_store_dwordx4 v[224:227], v1, s[8:11], s46 offen offset:0 sc1
  buffer_store_dwordx4 v[224:227], v1, s[8:11], s46 offen offset:1024 sc1
  buffer_store_dwordx4 v[224:227], v1, s[8:11], s46 offen offset:2048 sc1
  buffer_store_dwordx4 v[224:227], v1, s[8:11], s46 offen offset:3072 sc1
  s_add_u32 s46, s64, 32768
  buffer_store_dwordx4 v[224:227], v1, s[8:11], s46 offen offset:0 sc1
  buffer_store_dwordx4 v[224:227], v1, s[8:11], s46 offen offset:1024 sc1
  buffer_store_dwordx4 v[224:227], v1, s[8:11], s46 offen offset:2048 sc1
  buffer_store_dwordx4 v[224:227], v1, s[8:11], s46 offen offset:3072 sc1
  s_add_u32 s46, s64, 36864
  buffer_store_dwordx4 v[224:227], v1, s[8:11], s46 offen offset:0 sc1
  buffer_store_dwordx4 v[224:227], v1, s[8:11], s46 offen offset:1024 sc1
  buffer_store_dwordx4 v[224:227], v1, s[8:11], s46 offen offset:2048 sc1
  buffer_store_dwordx4 v[224:227], v1, s[8:11], s46 offen offset:3072 sc1
  s_add_u32 s46, s64, 49152
  buffer_store_dwordx4 v[224:227], v1, s[8:11], s46 offen offset:0 sc1
  buffer_store_dwordx4 v[224:227], v1, s[8:11], s46 offen offset:1024 sc1
  buffer_store_dwordx4 v[224:227], v1, s[8:11], s46 offen offset:2048 sc1
  buffer_store_dwordx4 v[224:227], v1, s[8:11], s46 offen offset:3072 sc1
  s_add_u32 s46, s64, 53248
  buffer_store_dwordx4 v[224:227], v1, s[8:11], s46 offen offset:0 sc1
  buffer_store_dwordx4 v[224:227], v1, s[8:11], s46 offen offset:1024 sc1
  buffer_store_dwordx4 v[224:227], v1, s[8:11], s46 offen offset:2048 sc1
  buffer_store_dwordx4 v[224:227], v1, s[8:11], s46 offen offset:3072 sc1
  s_add_u32 s46, s64, 65536
  buffer_store_dwordx4 v[224:227], v1, s[8:11], s46 offen offset:0 sc1
  buffer_store_dwordx4 v[224:227], v1, s[8:11], s46 offen offset:1024 sc1
  buffer_store_dwordx4 v[224:227], v1, s[8:11], s46 offen offset:2048 sc1
  buffer_store_dwordx4 v[224:227], v1, s[8:11], s46 offen offset:3072 sc1
  s_add_u32 s46, s64, 69632
  buffer_store_dwordx4 v[224:227], v1, s[8:11], s46 offen offset:0 sc1
  buffer_store_dwordx4 v[224:227], v1, s[8:11], s46 offen offset:1024 sc1
  buffer_store_dwordx4 v[224:227], v1, s[8:11], s46 offen offset:2048 sc1
  buffer_store_dwordx4 v[224:227], v1, s[8:11], s46 offen offset:3072 sc1
  s_waitcnt vmcnt(20)
  s_add_u32 s54, s54, 1
  s_cmp_lt_u32 s54, 3
  s_cbranch_scc1 xo_clr0
xo_clr:
  s_mov_b32 s50, 0
ss_41:
  v_and_b32 v11, 3, v0
  v_lshlrev_b32 v11, 2, v11
  global_load_dword v10, v11, s[38:39] sc1
  s_add_u32 s50, s50, 1
  s_cmp_gt_u32 s50, 131072
  s_cbranch_scc1 L_fail
  s_waitcnt vmcnt(0)
ss_41_in:
  v_readlane_b32 s46, v10, 0
  v_readlane_b32 s47, v10, 2
  v_readlane_b32 s48, v10, 1
  s_nop 0
  s_min_u32 s47, s47, s48
  s_cmp_lg_u32 s46, 0
  s_cselect_b32 s48, 7, 0
  s_add_u32 s46, s46, s2
  s_xor_b32 s49, s46, s43
  s_and_b32 s49, s49, s48
  s_cbranch_scc1 L_reroll
  s_cmp_lg_u32 s47, 0
  s_cbranch_scc1 ss_ok_42
  s_sleep 6
  s_branch ss_41
ss_ok_42:
  v_readlane_b32 s3, v10, 1
  s_nop 0
  s_and_b32 s3, s3, 0x2000
  s_add_u32 s46, s52, 6
  v_mov_b32 v10, s46
  s_waitcnt vmcnt(0)
  buffer_store_dword v10, v15, s[8:11], 0 offen sc1
  s_mov_b32 s60, 0
  s_mov_b32 s61, 0
  s_mov_b32 s54, 0
  v_lshlrev_b32 v228, 7, v0
xo_loop:
  s_add_u32 s53, s52, 1
  s_cmp_ge_u32 s60, s53
  s_cbranch_scc1 wf_done_43
  s_mov_b32 s50, 0
wf_loop_44:
  buffer_load_dword v10, v2, s[8:11], 0 offen sc1
  s_add_u32 s50, s50, 1
  s_cmp_gt_u32 s50, 131072
  s_cbranch_scc1 L_fail
  s_waitcnt vmcnt(0)
  v_min_u32_dpp v10, v10, v10 row_ror:8 row_mask:0xf bank_mask:0xf
  s_nop 1
  v_min_u32_dpp v10, v10, v10 row_ror:4 row_mask:0xf bank_mask:0xf
  s_nop 1
  v_min_u32_dpp v10, v10, v10 row_ror:2 row_mask:0xf bank_mask:0xf
  s_nop 1
  v_min_u32_dpp v10, v10, v10 row_ror:1 row_mask:0xf bank_mask:0xf
  v_mov_b32 v11, v10
  s_nop 1
  v_permlane16_swap_b32 v11, v10
  v_min_u32 v10, v10, v11
  v_mov_b32 v11, v10
  s_nop 1
  v_permlane32_swap_b32 v11, v10
  v_min_u32 v10, v10, v11
  s_nop 0
  v_readfirstlane_b32 s60, v10
  s_nop 0
  s_cmp_ge_u32 s60, s53
  s_cbranch_scc1 wf_done_43
  s_sleep 2
  s_branch wf_loop_44
wf_done_43:
  s_add_u32 s46, s63, 0
  s_lshr_b32 s47, s46, 8
  s_and_b32 s47, s47, 0x2000
  s_xor_b32 s46, s46, s47
  buffer_load_dwordx4 a[0:3], v1, s[8:11], s46 offen offset:0 sc1
  buffer_load_dwordx4 a[4:7], v1, s[8:11], s46 offen offset:1024 sc1
  buffer_load_dwordx4 a[8:11], v1, s[8:11], s46 offen offset:2048 sc1
  buffer_load_dwordx4 a[12:15], v1, s[8:11], s46 offen offset:3072 sc1
  s_add_u32 s46, s46, 4096
  buffer_load_dwordx4 a[16:19], v1, s[8:11], s46 offen offset:0 sc1
  buffer_load_dwordx4 a[20:23], v1, s[8:11], s46 offen offset:1024 sc1
  buffer_load_dwordx4 a[24:27], v1, s[8:11], s46 offen offset:2048 sc1
  buffer_load_dwordx4 a[28:31], v1, s[8:11], s46 offen offset:3072 sc1
  s_add_u32 s46, s63, 65536
  s_lshr_b32 s47, s46, 8
  s_and_b32 s47, s47, 0x2000
  s_xor_b32 s46, s46, s47
  buffer_load_dwordx4 a[32:35], v1, s[8:11], s46 offen offset:0 sc1
  buffer_load_dwordx4 a[36:39], v1, s[8:11], s46 offen offset:1024 sc1
  buffer_load_dwordx4 a[40:43], v1, s[8:11], s46 offen offset:2048 sc1
  buffer_load_dwordx4 a[44:47], v1, s[8:11], s46 offen offset:3072 sc1
  s_add_u32 s46, s46, 4096
  buffer_load_dwordx4 a[48:51], v1, s[8:11], s46 offen offset:0 sc1
  buffer_load_dwordx4 a[52:55], v1, s[8:11], s46 offen offset:1024 sc1
  buffer_load_dwordx4 a[56:59], v1, s[8:11], s46 offen offset:2048 sc1
  buffer_load_dwordx4 a[60:63], v1, s[8:11], s46 offen offset:3072 sc1
  s_add_u32 s46, s63, 131072
  s_lshr_b32 s47, s46, 8
  s_and_b32 s47, s47, 0x2000
  s_xor_b32 s46, s46, s47
  buffer_load_dwordx4 a[64:67], v1, s[8:11], s46 offen offset:0 sc1
  buffer_load_dwordx4 a[68:71], v1, s[8:11], s46 offen offset:1024 sc1
  buffer_load_dwordx4 a[72:75], v1, s[8:11], s46 offen offset:2048 sc1
  buffer_load_dwordx4 a[76:79], v1, s[8:11], s46 offen offset:3072 sc1
  s_add_u32 s46, s46, 4096
  buffer_load_dwordx4 a[80:83], v1, s[8:11], s46 offen offset:0 sc1
  buffer_load_dwordx4 a[84:87], v1, s[8:11], s46 offen offset:1024 sc1
  buffer_load_dwordx4 a[88:91], v1, s[8:11], s46 offen offset:2048 sc1
  buffer_load_dwordx4 a[92:95], v1, s[8:11], s46 offen offset:3072 sc1
  s_add_u32 s46, s63, 196608
  s_lshr_b32 s47, s46, 8
  s_and_b32 s47, s47, 0x2000
  s_xor_b32 s46, s46, s47
  buffer_load_dwordx4 a[96:99], v1, s[8:11], s46 offen offset:0 sc1
  buffer_load_dwordx4 a[100:103], v1, s[8:11], s46 offen offset:1024 sc1
  buffer_load_dwordx4 a[104:107], v1, s[8:11], s46 offen offset:2048 sc1
  buffer_load_dwordx4 a[108:111], v1, s[8:11], s46 offen offset:3072 sc1
  s_add_u32 s46, s46, 4096
  buffer_load_dwordx4 a[112:115], v1, s[8:11], s46 offen offset:0 sc1
  buffer_load_dwordx4 a[116:119], v1, s[8:11], s46 offen offset:1024 sc1
  buffer_load_dwordx4 a[120:123], v1, s[8:11], s46 offen offset:2048 sc1
  buffer_load_dwordx4 a[124:127], v1, s[8:11], s46 offen offset:3072 sc1
  s_add_u32 s46, s63, 262144
  s_lshr_b32 s47, s46, 8
  s_and_b32 s47, s47, 0x2000
  s_xor_b32 s46, s46, s47
  buffer_load_dwordx4 a[128:131], v1, s[8:11], s46 offen offset:0 sc1
  buffer_load_dwordx4 a[132:135], v1, s[8:11], s46 offen offset:1024 sc1
  buffer_load_dwordx4 a[136:139], v1, s[8:11], s46 offen offset:2048 sc1
  buffer_load_dwordx4 a[140:143], v1, s[8:11], s46 offen offset:3072 sc1
  s_add_u32 s46, s46, 4096
  buffer_load_dwordx4 a[144:147], v1, s[8:11], s46 offen offset:0 sc1
  buffer_load_dwordx4 a[148:151], v1, s[8:11], s46 offen offset:1024 sc1
  buffer_load_dwordx4 a[152:155], v1, s[8:11], s46 offen offset:2048 sc1
  buffer_load_dwordx4 a[156:159], v1, s[8:11], s46 offen offset:3072 sc1
  s_waitcnt vmcnt(24)
  s_cmp_ge_u32 s52, 62
  s_cbranch_scc1 xo_last
  s_cmp_lg_u32 s42, 0
  s_cbranch_scc1 xo_go
  s_mov_b32 s50, 0
box_45:
  s_load_dword s80, s[40:41], 0 glc
  s_add_u32 s50, s50, 1
  s_cmp_gt_u32 s50, 131072
  s_cbranch_scc1 L_fail
  s_waitcnt lgkmcnt(0)
  s_cmp_lt_u32 s80, s53
  s_cbranch_scc1 box_45
  s_branch xo_go
xo_last:
  s_mov_b32 s53, 64
  s_mov_b32 s61, 0
  s_cmp_ge_u32 s61, s53
  s_cbranch_scc1 wf_done_47
  s_mov_b32 s50, 0
wf_loop_48:
  buffer_load_dword v10, v3, s[8:11], 0 offen sc1
  s_add_u32 s50, s50, 1
  s_cmp_gt_u32 s50, 131072
  s_cbranch_scc1 L_fail
  s_waitcnt vmcnt(0)
  v_min_u32_dpp v10, v10, v10 row_ror:8 row_mask:0xf bank_mask:0xf
  s_nop 1
  v_min_u32_dpp v10, v10, v10 row_ror:4 row_mask:0xf bank_mask:0xf
  s_nop 1
  v_min_u32_dpp v10, v10, v10 row_ror:2 row_mask:0xf bank_mask:0xf
  s_nop 1
  v_min_u32_dpp v10, v10, v10 row_ror:1 row_mask:0xf bank_mask:0xf
  v_mov_b32 v11, v10
  s_nop 1
  v_permlane16_swap_b32 v11, v10
  v_min_u32 v10, v10, v11
  v_mov_b32 v11, v10
  s_nop 1
  v_permlane32_swap_b32 v11, v10
  v_min_u32 v10, v10, v11
  s_nop 0
  v_readfirstlane_b32 s61, v10
  s_nop 0
  s_cmp_ge_u32 s61, s53
  s_cbranch_scc1 wf_done_47
  s_sleep 2
  s_branch wf_loop_48
wf_done_47:
xo_go:
  s_barrier
  s_lshl_b32 s64, s54, 21
  s_mul_i32 s46, s58, 655360
  s_add_u32 s64, s64, s46
  s_add_u32 s64, s64, s3
  s_add_u32 s64, s64, 4194304
  s_lshr_b32 s46, s64, 8
  s_and_b32 s46, s46, 0x2000
  s_xor_b32 s64, s64, s46
  s_add_u32 s64, s64, s67
  s_mov_b32 s49, s65
  s_lshr_b32 s46, s49, 8
  s_and_b32 s46, s46, 0x2000
  s_xor_b32 s49, s49, s46
  s_lshl_b32 s47, s42, 14
  s_add_u32 s47, s47, s49
  s_lshl_b32 s48, s42, 11
  s_add_u32 s48, s48, s49
  s_add_u32 s46, s47, 0
  buffer_load_dwordx4 v[56:59], v1, s[8:11], s46 offen sc1
  s_add_u32 s46, s47, 81920
  buffer_load_dwordx4 v[60:63], v1, s[8:11], s46 offen sc1
  s_add_u32 s46, s47, 1024
  buffer_load_dwordx4 v[64:67], v1, s[8:11], s46 offen sc1
  s_add_u32 s46, s47, 82944
  buffer_load_dwordx4 v[68:71], v1, s[8:11], s46 offen sc1
  s_add_u32 s46, s47, 2048
  buffer_load_dwordx4 v[72:75], v1, s[8:11], s46 offen sc1
  s_add_u32 s46, s47, 83968
  buffer_load_dwordx4 v[76:79], v1, s[8:11], s46 offen sc1
  s_add_u32 s46, s47, 3072
  buffer_load_dwordx4 v[80:83], v1, s[8:11], s46 offen sc1
  s_add_u32 s46, s47, 84992
  buffer_load_dwordx4 v[84:87], v1, s[8:11], s46 offen sc1
  s_add_u32 s46, s47, 4096
  buffer_load_dwordx4 v[88:91], v1, s[8:11], s46 offen sc1
  s_add_u32 s46, s47, 86016
  buffer_load_dwordx4 v[92:95], v1, s[8:11], s46 offen sc1
  s_add_u32 s46, s47, 5120
  buffer_load_dwordx4 v[96:99], v1, s[8:11], s46 offen sc1
  s_add_u32 s46, s47, 87040
  buffer_load_dwordx4 v[100:103], v1, s[8:11], s46 offen sc1
  s_add_u32 s46, s47, 6144
  buffer_load_dwordx4 v[104:107], v1, s[8:11], s46 offen sc1
  s_add_u32 s46, s47, 88064
  buffer_load_dwordx4 v[108:111], v1, s[8:11], s46 offen sc1
  s_add_u32 s46, s47, 7168
  buffer_load_dwordx4 v[112:115], v1, s[8:11], s46 offen sc1
  s_add_u32 s46, s47, 89088
  buffer_load_dwordx4 v[116:119], v1, s[8:11], s46 offen sc1
  s_add_u32 s46, s48, 65536
  buffer_load_dwordx4 v[120:123], v1, s[8:11], s46 offen sc1
  s_add_u32 s46, s48, 147456
  buffer_load_dwordx4 v[124:127], v1, s[8:11], s46 offen sc1
  s_add_u32 s46, s48, 66560
  buffer_load_dwordx4 v[128:131], v1, s[8:11], s46 offen sc1
  s_add_u32 s46, s48, 148480
  buffer_load_dwordx4 v[132:135], v1, s[8:11], s46 offen sc1
  s_add_u32 s46, s64, 0
  buffer_load_dwordx4 v[16:19], v1, s[8:11], s46 offen offset:0 sc1
  buffer_load_dwordx4 v[20:23], v1, s[8:11], s46 offen offset:1024 sc1
  s_add_u32 s46, s64, 16384
  buffer_load_dwordx4 v[24:27], v1, s[8:11], s46 offen offset:0 sc1
  buffer_load_dwordx4 v[28:31], v1, s[8:11], s46 offen offset:1024 sc1
  s_add_u32 s46, s64, 32768
  buffer_load_dwordx4 v[32:35], v1, s[8:11], s46 offen offset:0 sc1
  buffer_load_dwordx4 v[36:39], v1, s[8:11], s46 offen offset:1024 sc1
  s_add_u32 s46, s64, 49152
  buffer_load_dwordx4 v[40:43], v1, s[8:11], s46 offen offset:0 sc1
  buffer_load_dwordx4 v[44:47], v1, s[8:11], s46 offen offset:1024 sc1
  s_add_u32 s46, s64, 65536
  buffer_load_dwordx4 v[48:51], v1, s[8:11], s46 offen offset:0 sc1
  buffer_load_dwordx4 v[52:55], v1, s[8:11], s46 offen offset:1024 sc1
  s_waitcnt vmcnt(29)
  v_mfma_f32_16x16x32_bf16 v[136:139], a[0:3], v[56:59], 0
  v_mfma_f32_16x16x32_bf16 v[140:143], a[32:35], v[56:59], 0
  v_mfma_f32_16x16x32_bf16 v[144:147], a[64:67], v[56:59], 0
  v_mfma_f32_16x16x32_bf16 v[148:151], a[96:99], v[56:59], 0
  v_mfma_f32_16x16x32_bf16 v[152:155], a[128:131], v[56:59], 0
  s_waitcnt vmcnt(28)
  v_mfma_f32_16x16x32_bf16 v[156:159], a[0:3], v[60:63], 0
  v_mfma_f32_16x16x32_bf16 v[160:163], a[32:35], v[60:63], 0
  v_mfma_f32_16x16x32_bf16 v[164:167], a[64:67], v[60:63], 0
  v_mfma_f32_16x16x32_bf16 v[168:171], a[96:99], v[60:63], 0
  v_mfma_f32_16x16x32_bf16 v[172:175], a[128:131], v[60:63], 0
  s_waitcnt vmcnt(27)
  v_mfma_f32_16x16x32_bf16 v[136:139], a[4:7], v[64:67], v[136:139]
  v_mfma_f32_16x16x32_bf16 v[140:143], a[36:39], v[64:67], v[140:143]
  v_mfma_f32_16x16x32_bf16 v[144:147], a[68:71], v[64:67], v[144:147]
  v_mfma_f32_16x16x32_bf16 v[148:151], a[100:103], v[64:67], v[148:151]
  v_mfma_f32_16x16x32_bf16 v[152:155], a[132:135], v[64:67], v[152:155]
  s_waitcnt vmcnt(26)
  v_mfma_f32_16x16x32_bf16 v[156:159], a[4:7], v[68:71], v[156:159]
  v_mfma_f32_16x16x32_bf16 v[160:163], a[36:39], v[68:71], v[160:163]
  v_mfma_f32_16x16x32_bf16 v[164:167], a[68:71], v[68:71], v[164:167]
  v_mfma_f32_16x16x32_bf16 v[168:171], a[100:103], v[68:71], v[168:171]
  v_mfma_f32_16x16x32_bf16 v[172:175], a[132:135], v[68:71], v[172:175]
  s_waitcnt vmcnt(25)
  v_mfma_f32_16x16x32_bf16 v[136:139], a[8:11], v[72:75], v[136:139]
  v_mfma_f32_16x16x32_bf16 v[140:143], a[40:43], v[72:75], v[140:143]
  v_mfma_f32_16x16x32_bf16 v[144:147], a[72:75], v[72:75], v[144:147]
  v_mfma_f32_16x16x32_bf16 v[148:151], a[104:107], v[72:75], v[148:151]
  v_mfma_f32_16x16x32_bf16 v[152:155], a[136:139], v[72:75], v[152:155]
  s_waitcnt vmcnt(24)
  v_mfma_f32_16x16x32_bf16 v[156:159], a[8:11], v[76:79], v[156:159]
  v_mfma_f32_16x16x32_bf16 v[160:163], a[40:43], v[76:79], v[160:163]
  v_mfma_f32_16x16x32_bf16 v[164:167], a[72:75], v[76:79], v[164:167]
  v_mfma_f32_16x16x32_bf16 v[168:171], a[104:107], v[76:79], v[168:171]
  v_mfma_f32_16x16x32_bf16 v[172:175], a[136:139], v[76:79], v[172:175]
  s_waitcnt vmcnt(23)
  v_mfma_f32_16x16x32_bf16 v[136:139], a[12:15], v[80:83], v[136:139]
  v_mfma_f32_16x16x32_bf16 v[140:143], a[44:47], v[80:83], v[140:143]
  v_mfma_f32_16x16x32_bf16 v[144:147], a[76:79], v[80:83], v[144:147]
  v_mfma_f32_16x16x32_bf16 v[148:151], a[108:111], v[80:83], v[148:151]
  v_mfma_f32_16x16x32_bf16 v[152:155], a[140:143], v[80:83], v[152:155]
  s_waitcnt vmcnt(22)
  v_mfma_f32_16x16x32_bf16 v[156:159], a[12:15], v[84:87], v[156:159]
  v_mfma_f32_16x16x32_bf16 v[160:163], a[44:47], v[84:87], v[160:163]
  v_mfma_f32_16x16x32_bf16 v[164:167], a[76:79], v[84:87], v[164:167]
  v_mfma_f32_16x16x32_bf16 v[168:171], a[108:111], v[84:87], v[168:171]
  v_mfma_f32_16x16x32_bf16 v[172:175], a[140:143], v[84:87], v[172:175]
  s_waitcnt vmcnt(21)
  v_mfma_f32_16x16x32_bf16 v[136:139], a[16:19], v[88:91], v[136:139]
  v_mfma_f32_16x16x32_bf16 v[140:143], a[48:51], v[88:91], v[140:143]
  v_mfma_f32_16x16x32_bf16 v[144:147], a[80:83], v[88:91], v[144:147]
  v_mfma_f32_16x16x32_bf16 v[148:151], a[112:115], v[88:91], v[148:151]
  v_mfma_f32_16x16x32_bf16 v[152:155], a[144:147], v[88:91], v[152:155]
  s_waitcnt vmcnt(20)
  v_mfma_f32_16x16x32_bf16 v[156:159], a[16:19], v[92:95], v[156:159]
  v_mfma_f32_16x16x32_bf16 v[160:163], a[48:51], v[92:95], v[160:163]
  v_mfma_f32_16x16x32_bf16 v[164:167], a[80:83], v[92:95], v[164:167]
  v_mfma_f32_16x16x32_bf16 v[168:171], a[112:115], v[92:95], v[168:171]
  v_mfma_f32_16x16x32_bf16 v[172:175], a[144:147], v[92:95], v[172:175]
  s_waitcnt vmcnt(19)
  v_mfma_f32_16x16x32_bf16 v[136:139], a[20:23], v[96:99], v[136:139]
  v_mfma_f32_16x16x32_bf16 v[140:143], a[52:55], v[96:99], v[140:143]
  v_mfma_f32_16x16x32_bf16 v[144:147], a[84:87], v[96:99], v[144:147]
  v_mfma_f32_16x16x32_bf16 v[148:151], a[116:119], v[96:99], v[148:151]
  v_mfma_f32_16x16x32_bf16 v[152:155], a[148:151], v[96:99], v[152:155]
  s_waitcnt vmcnt(18)
  v_mfma_f32_16x16x32_bf16 v[156:159], a[20:23], v[100:103], v[156:159]
  v_mfma_f32_16x16x32_bf16 v[160:163], a[52:55], v[100:103], v[160:163]
  v_mfma_f32_16x16x32_bf16 v[164:167], a[84:87], v[100:103], v[164:167]
  v_mfma_f32_16x16x32_bf16 v[168:171], a[116:119], v[100:103], v[168:171]
  v_mfma_f32_16x16x32_bf16 v[172:175], a[148:151], v[100:103], v[172:175]
  s_waitcnt vmcnt(17)
  v_mfma_f32_16x16x32_bf16 v[136:139], a[24:27], v[104:107], v[136:139]
  v_mfma_f32_16x16x32_bf16 v[140:143], a[56:59], v[104:107], v[140:143]
  v_mfma_f32_16x16x32_bf16 v[144:147], a[88:91], v[104:107], v[144:147]
  v_mfma_f32_16x16x32_bf16 v[148:151], a[120:123], v[104:107], v[148:151]
  v_mfma_f32_16x16x32_bf16 v[152:155], a[152:155], v[104:107], v[152:155]
  s_waitcnt vmcnt(16)
  v_mfma_f32_16x16x32_bf16 v[156:159], a[24:27], v[108:111], v[156:159]
  v_mfma_f32_16x16x32_bf16 v[160:163], a[56:59], v[108:111], v[160:163]
  v_mfma_f32_16x16x32_bf16 v[164:167], a[88:91], v[108:111], v[164:167]
  v_mfma_f32_16x16x32_bf16 v[168:171], a[120:123], v[108:111], v[168:171]
  v_mfma_f32_16x16x32_bf16 v[172:175], a[152:155], v[108:111], v[172:175]
  s_waitcnt vmcnt(15)
  v_mfma_f32_16x16x32_bf16 v[136:139], a[28:31], v[112:115], v[136:139]
  v_mfma_f32_16x16x32_bf16 v[140:143], a[60:63], v[112:115], v[140:143]
  v_mfma_f32_16x16x32_bf16 v[144:147], a[92:95], v[112:115], v[144:147]
  v_mfma_f32_16x16x32_bf16 v[148:151], a[124:127], v[112:115], v[148:151]
  v_mfma_f32_16x16x32_bf16 v[152:155], a[156:159], v[112:115], v[152:155]
  s_waitcnt vmcnt(14)
  v_mfma_f32_16x16x32_bf16 v[156:159], a[28:31], v[116:119], v[156:159]
  v_mfma_f32_16x16x32_bf16 v[160:163], a[60:63], v[116:119], v[160:163]
  v_mfma_f32_16x16x32_bf16 v[164:167], a[92:95], v[116:119], v[164:167]
  v_mfma_f32_16x16x32_bf16 v[168:171], a[124:127], v[116:119], v[168:171]
  v_mfma_f32_16x16x32_bf16 v[172:175], a[156:159], v[116:119], v[172:175]
  s_waitcnt vmcnt(8)
  v_mfma_f32_16x16x32_bf16 v[136:139], v[16:19], v[120:123], v[136:139]
  v_mfma_f32_16x16x32_bf16 v[156:159], v[16:19], v[124:127], v[156:159]
  v_mfma_f32_16x16x32_bf16 v[136:139], v[20:23], v[128:131], v[136:139]
  v_mfma_f32_16x16x32_bf16 v[156:159], v[20:23], v[132:135], v[156:159]
  s_waitcnt vmcnt(6)
  v_mfma_f32_16x16x32_bf16 v[140:143], v[24:27], v[120:123], v[140:143]
  v_mfma_f32_16x16x32_bf16 v[160:163], v[24:27], v[124:127], v[160:163]
  v_mfma_f32_16x16x32_bf16 v[140:143], v[28:31], v[128:131], v[140:143]
  v_mfma_f32_16x16x32_bf16 v[160:163], v[28:31], v[132:135], v[160:163]
  s_waitcnt vmcnt(4)
  v_mfma_f32_16x16x32_bf16 v[144:147], v[32:35], v[120:123], v[144:147]
  v_mfma_f32_16x16x32_bf16 v[164:167], v[32:35], v[124:127], v[164:167]
  v_mfma_f32_16x16x32_bf16 v[144:147], v[36:39], v[128:131], v[144:147]
  v_mfma_f32_16x16x32_bf16 v[164:167], v[36:39], v[132:135], v[164:167]
  s_waitcnt vmcnt(2)
  v_mfma_f32_16x16x32_bf16 v[148:151], v[40:43], v[120:123], v[148:151]
  v_mfma_f32_16x16x32_bf16 v[168:171], v[40:43], v[124:127], v[168:171]
  v_mfma_f32_16x16x32_bf16 v[148:151], v[44:47], v[128:131], v[148:151]
  v_mfma_f32_16x16x32_bf16 v[168:171], v[44:47], v[132:135], v[168:171]
  s_waitcnt vmcnt(0)
  v_mfma_f32_16x16x32_bf16 v[152:155], v[48:51], v[120:123], v[152:155]
  v_mfma_f32_16x16x32_bf16 v[172:175], v[48:51], v[124:127], v[172:175]
  v_mfma_f32_16x16x32_bf16 v[152:155], v[52:55], v[128:131], v[152:155]
  v_mfma_f32_16x16x32_bf16 v[172:175], v[52:55], v[132:135], v[172:175]
  s_cmp_ge_u32 s52, 55
  s_cbranch_scc1 xo_nop
  s_add_u32 s46, s64, 0
  buffer_store_dwordx4 v[224:227], v1, s[8:11], s46 offen offset:0 sc1
  buffer_store_dwordx4 v[224:227], v1, s[8:11], s46 offen offset:1024 sc1
  s_add_u32 s46, s64, 16384
  buffer_store_dwordx4 v[224:227], v1, s[8:11], s46 offen offset:0 sc1
  buffer_store_dwordx4 v[224:227], v1, s[8:11], s46 offen offset:1024 sc1
  s_add_u32 s46, s64, 32768
  buffer_store_dwordx4 v[224:227], v1, s[8:11], s46 offen offset:0 sc1
  buffer_store_dwordx4 v[224:227], v1, s[8:11], s46 offen offset:1024 sc1
  s_add_u32 s46, s64, 49152
  buffer_store_dwordx4 v[224:227], v1, s[8:11], s46 offen offset:0 sc1
  buffer_store_dwordx4 v[224:227], v1, s[8:11], s46 offen offset:1024 sc1
  s_add_u32 s46, s64, 65536
  buffer_store_dwordx4 v[224:227], v1, s[8:11], s46 offen offset:0 sc1
  buffer_store_dwordx4 v[224:227], v1, s[8:11], s46 offen offset:1024 sc1
xo_nop:
  ds_write_b128 v5, v[136:139] offset:0
  ds_write_b128 v5, v[140:143] offset:1024
  ds_write_b128 v5, v[144:147] offset:2048
  ds_write_b128 v5, v[148:151] offset:3072
  s_nop 0
  ds_write_b128 v5, v[152:155] offset:4096
  ds_write_b128 v5, v[156:159] offset:5120
  ds_write_b128 v5, v[160:163] offset:6144
  ds_write_b128 v5, v[164:167] offset:7168
  ds_write_b128 v5, v[168:171] offset:8192
  ds_write_b128 v5, v[172:175] offset:9216
  s_waitcnt lgkmcnt(0)
  s_barrier
  ds_read_b128 v[176:179], v6 offset:0
  ds_read_b128 v[180:183], v6 offset:10240
  ds_read_b128 v[184:187], v6 offset:20480
  ds_read_b128 v[188:191], v6 offset:30720
  ds_read_b128 v[192:195], v6 offset:4096
  ds_read_b128 v[196:199], v6 offset:14336
  ds_read_b128 v[200:203], v6 offset:24576
  ds_read_b128 v[204:207], v6 offset:34816
  ds_read_b128 v[208:211], v6 offset:8192
  ds_read_b128 v[212:215], v6 offset:18432
  ds_read_b128 v[216:219], v6 offset:28672
  ds_read_b128 v[220:223], v6 offset:38912
  s_waitcnt lgkmcnt(8)
  v_add_f32 v176, v176, v180
  v_add_f32 v184, v184, v188
  v_add_f32 v176, v176, v184
  v_add_f32 v177, v177, v181
  v_add_f32 v185, v185, v189
  v_add_f32 v177, v177, v185
  v_add_f32 v178, v178, v182
  v_add_f32 v186, v186, v190
  v_add_f32 v178, v178, v186
  v_add_f32 v179, v179, v183
  v_add_f32 v187, v187, v191
  v_add_f32 v179, v179, v187
  v_cvt_pk_bf16_f32 v176, v176, v177
  v_cvt_pk_bf16_f32 v177, v178, v179
  buffer_store_dwordx2 v[176:177], v7, s[12:15], s66 offen
  s_waitcnt lgkmcnt(4)
  v_add_f32 v192, v192, v196
  v_add_f32 v200, v200, v204
  v_add_f32 v192, v192, v200
  v_add_f32 v193, v193, v197
  v_add_f32 v201, v201, v205
  v_add_f32 v193, v193, v201
  v_add_f32 v194, v194, v198
  v_add_f32 v202, v202, v206
  v_add_f32 v194, v194, v202
  v_add_f32 v195, v195, v199
  v_add_f32 v203, v203, v207
  v_add_f32 v195, v195, v203
  v_cvt_pk_bf16_f32 v192, v192, v193
  v_cvt_pk_bf16_f32 v193, v194, v195
  buffer_store_dwordx2 v[192:193], v8, s[12:15], s66 offen
  s_waitcnt lgkmcnt(0)
  v_add_f32 v208, v208, v212
  v_add_f32 v216, v216, v220
  v_add_f32 v208, v208, v216
  v_add_f32 v209, v209, v213
  v_add_f32 v217, v217, v221
  v_add_f32 v209, v209, v217
  v_add_f32 v210, v210, v214
  v_add_f32 v218, v218, v222
  v_add_f32 v210, v210, v218
  v_add_f32 v211, v211, v215
  v_add_f32 v219, v219, v223
  v_add_f32 v211, v211, v219
  v_cvt_pk_bf16_f32 v208, v208, v209
  v_cvt_pk_bf16_f32 v209, v210, v211
  buffer_store_dwordx2 v[208:209], v9, s[12:15], s66 offen
  s_cmp_ge_u32 s52, 61
  s_cbranch_scc1 xo_end
  s_add_u32 s46, s52, 9
  v_mov_b32 v10, s46
  s_waitcnt vmcnt(0)
  s_barrier
  buffer_store_dword v10, v15, s[8:11], 0 offen sc1
  s_add_u32 s54, s54, 1
  s_cmp_eq_u32 s54, 3
  s_cselect_b32 s54, 0, s54
  s_add_u32 s63, s63, 7864320
  s_cmp_ge_u32 s63, 165675008
  s_cselect_b32 s46, 83886080, 0
  s_sub_u32 s63, s63, s46
  s_add_u32 s65, s65, 786432
  s_cmp_ge_u32 s65, 16777216
  s_cselect_b32 s46, 2097152, 0
  s_sub_u32 s65, s65, s46
  s_add_u32 s66, s66, 245760
  s_add_u32 s52, s52, 3
  s_cmp_lt_u32 s52, 64
  s_cbranch_scc1 xo_loop
xo_end:
  s_endpgm
L_end:
  s_endpgm
L_fail:
  s_mov_b32 s4, s38
  s_mov_b32 s5, s39
  s_mov_b32 s6, 256
  s_mov_b32 s7, 0x20000
  s_lshl_b32 s46, s43, 8
  s_or_b32 s46, s46, s44
  s_or_b32 s46, s46, 0x10000
  v_mov_b32 v1, 32
  v_mov_b32 v2, s46
  s_mov_b64 exec, 1
  buffer_store_dword v2, v1, s[4:7], 0 offen sc1
  s_waitcnt vmcnt(0)
  s_endpgm
.section .rodata,"a"
.p2align 6
.amdhsa_kernel concat_heads__sliding_local_dilated__memory_aug_recurrent_mem_tr__prompt_kernel
  .amdhsa_next_free_vgpr 512
  .amdhsa_next_free_sgpr 102
  .amdhsa_accum_offset 256
  .amdhsa_group_segment_fixed_size 0
  .amdhsa_kernarg_size 104
  .amdhsa_user_sgpr_count 2
  .amdhsa_user_sgpr_kernarg_segment_ptr 1
  .amdhsa_system_sgpr_workgroup_id_x 1
.end_amdhsa_kernel
```

```asm
; @launch grid=(256,1,1) block=(256,1,1) lds=163840
.amdgcn_target "amdgcn-amd-amdhsa--gfx950"
.text
.globl concat_heads__sliding_local_dilated__memory_aug_recurrent_mem_tr__prompt_kernel
.p2align 8
.type concat_heads__sliding_local_dilated__memory_aug_recurrent_mem_tr__prompt_kernel,@function
concat_heads__sliding_local_dilated__memory_aug_recurrent_mem_tr__prompt_kernel:
  s_cmp_ge_u32 s2, 256
  s_cbranch_scc1 L_end
  v_lshrrev_b32 v1, 6, v0
  v_and_b32 v0, 63, v0
  v_readfirstlane_b32 s42, v1
  s_getreg_b32 s46, hwreg(HW_REG_XCC_ID)
  s_lshr_b32 s44, s2, 3
  s_lshl_b32 s51, s42, 10
  s_mov_b32 s3, 0
  s_mov_b32 s50, -1
  s_branch L_first
L_reroll:
  s_waitcnt vmcnt(0) lgkmcnt(0)
  s_barrier
L_first:
  s_load_dwordx16 s[16:31], s[0:1], 0
  s_load_dwordx8 s[32:39], s[0:1], 64
  s_load_dwordx2 s[40:41], s[0:1], 96
  s_and_b32 s43, s46, 7
  s_and_b32 s46, s44, 7
  s_lshl_b32 s46, s46, 0
  s_and_b32 s47, s43, 3
  s_lshl_b32 s47, s47, 3
  s_add_u32 s45, s46, s47
  s_waitcnt lgkmcnt(0)
  s_add_u32 s8, s40, 0x1fffff
  s_addc_u32 s9, s41, 0
  s_and_b32 s8, s8, 0xffe00000
  s_mov_b32 s10, 266338304
  s_mov_b32 s11, 0x20000
  s_mov_b32 s4, s38
  s_mov_b32 s5, s39
  s_mov_b32 s6, 256
  s_mov_b32 s7, 0x20000
  s_mov_b32 s12, s22
  s_mov_b32 s13, s23
  s_mov_b32 s14, 2621440
  s_mov_b32 s15, 0x20000
  s_or_b32 s46, s2, s42
  s_cbranch_scc1 L_norot
  v_mov_b32 v1, 0
  s_or_b32 s46, s43, 8
  v_mov_b32 v2, s46
  buffer_store_dword v2, v1, s[4:7], 0 offen sc1
L_norot:
  s_cmp_lg_u32 s50, -1
  s_cbranch_scc1 pr_skip
  s_lshr_b32 s46, s2, 4
  s_cmp_lg_u32 s46, 13
  s_cbranch_scc1 pr_skip
  s_cmp_lg_u32 s42, 0
  s_cbranch_scc1 pr_skip
  v_lshlrev_b32 v1, 2, v0
  s_mov_b32 s66, 0x10000
  s_cmp_ge_u32 s43, 4
  s_cbranch_scc1 pr_report
  s_lshl_b32 s62, s43, 14
  s_and_b32 s46, s44, 1
  s_lshl_b32 s46, s46, 12
  s_add_u32 s62, s62, s46
  s_add_u32 s62, s62, 6160384
  s_add_u32 s65, s62, 8192
  buffer_store_dword v1, v1, s[8:11], s62 offen sc1
  buffer_store_dword v1, v1, s[8:11], s65 offen sc1
  s_mov_b32 s63, -1
  s_mov_b32 s64, -1
  s_waitcnt vmcnt(0)
  s_memtime s[72:73]
  s_waitcnt lgkmcnt(0)
  buffer_store_dword v1, v1, s[8:11], s62 offen sc1
  s_waitcnt vmcnt(0)
  s_memtime s[74:75]
  s_waitcnt lgkmcnt(0)
  s_sub_u32 s46, s74, s72
  s_min_u32 s63, s63, s46
  s_memtime s[72:73]
  s_waitcnt lgkmcnt(0)
  buffer_store_dword v1, v1, s[8:11], s65 offen sc1
  s_waitcnt vmcnt(0)
  s_memtime s[74:75]
  s_waitcnt lgkmcnt(0)
  s_sub_u32 s46, s74, s72
  s_min_u32 s64, s64, s46
  s_memtime s[72:73]
  s_waitcnt lgkmcnt(0)
  buffer_store_dword v1, v1, s[8:11], s62 offen sc1
  s_waitcnt vmcnt(0)
  s_memtime s[74:75]
  s_waitcnt lgkmcnt(0)
  s_sub_u32 s46, s74, s72
  s_min_u32 s63, s63, s46
  s_memtime s[72:73]
  s_waitcnt lgkmcnt(0)
  buffer_store_dword v1, v1, s[8:11], s65 offen sc1
  s_waitcnt vmcnt(0)
  s_memtime s[74:75]
  s_waitcnt lgkmcnt(0)
  s_sub_u32 s46, s74, s72
  s_min_u32 s64, s64, s46
  s_memtime s[72:73]
  s_waitcnt lgkmcnt(0)
  buffer_store_dword v1, v1, s[8:11], s62 offen sc1
  s_waitcnt vmcnt(0)
  s_memtime s[74:75]
  s_waitcnt lgkmcnt(0)
  s_sub_u32 s46, s74, s72
  s_min_u32 s63, s63, s46
  s_memtime s[72:73]
  s_waitcnt lgkmcnt(0)
  buffer_store_dword v1, v1, s[8:11], s65 offen sc1
  s_waitcnt vmcnt(0)
  s_memtime s[74:75]
  s_waitcnt lgkmcnt(0)
  s_sub_u32 s46, s74, s72
  s_min_u32 s64, s64, s46
  s_cmp_lt_u32 s64, s63
  s_cselect_b32 s46, 0x100, 1
  s_min_u32 s47, s63, s64
  s_cmp_lt_u32 s47, 600
  s_cselect_b32 s47, 4, 0
  s_lshl_b32 s46, s46, s47
  s_add_u32 s66, s66, s46
pr_report:
  v_mov_b32 v3, s66
  s_mov_b64 exec, 1
  global_atomic_add v2, v1, v3, s[38:39] offset:128 sc0 sc1
  s_waitcnt vmcnt(0)
  v_readfirstlane_b32 s46, v2
  s_nop 0
  s_add_u32 s46, s46, s66
  s_cmp_lt_u32 s46, 0x100000
  s_cbranch_scc1 pr_done
  s_bfe_u32 s47, s46, 0x80008
  s_and_b32 s46, s46, 0xff
  s_cmp_gt_u32 s47, s46
  s_cselect_b32 s46, 0x2001, 1
  v_mov_b32 v2, s46
  global_store_dword v1, v2, s[38:39] offset:4 sc1
pr_done:
  s_mov_b64 exec, -1
pr_skip:
  s_cmp_lt_u32 s43, 4
  s_cbranch_scc1 L_recur
  s_cmp_ge_u32 s44, 24
  s_cbranch_scc1 L_uw
  s_lshr_b32 s48, s44, 3
  s_cmp_lg_u32 s48, 0
  s_cbranch_scc1 L_noholdq
  s_mov_b32 s50, 0
ss_1:
  v_and_b32 v3, 3, v0
  v_lshlrev_b32 v3, 2, v3
  global_load_dword v2, v3, s[38:39] sc1
  s_add_u32 s50, s50, 1
  s_cmp_gt_u32 s50, 131072
  s_cbranch_scc1 L_fail
  s_waitcnt vmcnt(0)
ss_1_in:
  v_readlane_b32 s46, v2, 0
  v_readlane_b32 s47, v2, 2
  v_readlane_b32 s48, v2, 1
  s_nop 0
  s_min_u32 s47, s47, s48
  s_cmp_lg_u32 s46, 0
  s_cselect_b32 s48, 7, 0
  s_add_u32 s46, s46, s2
  s_xor_b32 s49, s46, s43
  s_and_b32 s49, s49, s48
  s_cbranch_scc1 L_reroll
  s_cmp_lg_u32 s47, 0
  s_cbranch_scc1 ss_ok_2
  s_sleep 6
  s_branch ss_1
ss_ok_2:
  v_readlane_b32 s3, v2, 1
  s_nop 0
  s_and_b32 s3, s3, 0x2000
L_noholdq:
  s_lshr_b32 s48, s44, 3
  s_cmp_eq_u32 s48, 0
  s_cselect_b32 s4, s26, s28
  s_cselect_b32 s5, s27, s29
  s_cmp_eq_u32 s48, 2
  s_cselect_b32 s4, s30, s4
  s_cselect_b32 s5, s31, s5
  s_mov_b32 s6, 7864320
  s_mul_i32 s60, s45, 384
  s_mov_b32 s61, 0
  s_mov_b32 s62, 64
  s_cselect_b32 s63, 136314880, 0
  s_add_u32 s63, s63, 31457280
  s_cmp_lg_u32 s48, 1
  s_cselect_b32 s46, 0x2000, 0
  s_add_u32 s63, s63, s46
  s_mov_b32 s67, s45
  s_lshl_b32 s64, s48, 5
  s_add_u32 s64, s64, s45
  s_lshl_b32 s64, s64, 7
  s_add_u32 s64, s64, 1048576
  v_lshrrev_b32 v10, 3, v0
  v_lshrrev_b32 v11, 2, v10
  v_lshlrev_b32 v11, 3, v11
  v_and_b32 v1, 3, v10
  v_add_u32 v1, v1, v11
  s_and_b32 s46, s42, 1
  s_lshl_b32 s46, s46, 2
  s_lshr_b32 s47, s42, 1
  s_lshl_b32 s47, s47, 4
  s_add_u32 s46, s46, s47
  v_add_u32 v1, s46, v1
  v_mul_u32_u24 v1, 12288, v1
  v_lshrrev_b32 v10, 1, v10
  v_bfe_u32 v11, v0, 1, 2
  v_xor_b32 v10, v10, v11
  v_lshlrev_b32 v10, 5, v10
  v_and_b32 v11, 1, v0
  v_lshlrev_b32 v11, 4, v11
  v_add3_u32 v1, v1, v10, v11
  v_lshrrev_b32 v10, 5, v0
  v_lshlrev_b32 v2, 11, v10
  v_bfe_u32 v10, v0, 2, 3
  v_lshl_add_u32 v2, v10, 7, v2
  v_lshrrev_b32 v10, 1, v10
  v_xor_b32 v10, s42, v10
  v_lshl_add_u32 v2, v10, 5, v2
  v_and_b32 v10, 3, v0
  v_lshl_add_u32 v2, v10, 3, v2
  v_add_u32 v3, 0x10000, v2
  v_add_u32 v4, 0x20000, v2
  v_lshrrev_b32 v10, 3, v0
  s_lshl_b32 s46, s42, 3
  v_add_u32 v10, s46, v10
  v_mul_u32_u24 v5, 1280, v10
  v_bfe_u32 v10, v10, 1, 3
  v_and_b32 v11, 7, v0
  v_xor_b32 v10, v10, v11
  v_lshl_add_u32 v5, v10, 4, v5
  v_and_b32 v10, 15, v0
  v_lshlrev_b32 v6, 7, v10
  v_lshrrev_b32 v10, 1, v10
  v_lshrrev_b32 v11, 4, v0
  v_xor_b32 v10, v10, v11
  v_lshl_add_u32 v6, v10, 4, v6
  v_add_u32 v6, 122880, v6
  v_xor_b32 v7, 64, v6
  v_and_b32 v10, 15, v0
  v_lshlrev_b32 v8, 4, v10
  v_bfe_u32 v10, v0, 4, 1
  v_lshlrev_b32 v10, 11, v10
  v_lshrrev_b32 v11, 5, v0
  v_lshlrev_b32 v11, 8, v11
  v_add3_u32 v8, v8, v10, v11
  s_lshl_b32 s46, s42, 9
  v_add_u32 v8, s46, v8
  v_mov_b32 v9, s64
  v_mov_b32 v10, 2146435072
  s_cmp_eq_u32 s42, 0
  s_cselect_b64 vcc, 1, 0
  v_cndmask_b32 v9, v10, v9, vcc
  s_lshl_b32 s46, s43, 7
  s_add_u32 s46, s46, 1076736
  v_mov_b32 v14, s46
  s_mov_b32 s68, 0
  s_lshr_b32 s70, s44, 5
  s_add_u32 s70, s70, 8
  s_mov_b32 s52, s61
  s_mul_i32 s53, s52, 40960
  s_add_u32 s54, s51, 122880
  s_add_u32 m0, s54, 0
  s_nop 0
  buffer_load_dwordx4 v5, s[12:15], s53 offen offset:0 lds
  s_add_u32 m0, s54, 3968
  s_nop 0
  buffer_load_dwordx4 v5, s[12:15], s53 offen offset:128 lds
  s_add_u32 m0, s54, 7936
  s_nop 0
  buffer_load_dwordx4 v5, s[12:15], s53 offen offset:256 lds
  s_add_u32 m0, s54, 11904
  s_nop 0
  buffer_load_dwordx4 v5, s[12:15], s53 offen offset:384 lds
  s_add_u32 m0, s54, 15872
  s_nop 0
  buffer_load_dwordx4 v5, s[12:15], s53 offen offset:512 lds
  s_add_u32 m0, s54, 19840
  s_nop 0
  buffer_load_dwordx4 v5, s[12:15], s53 offen offset:640 lds
  s_add_u32 m0, s54, 23808
  s_nop 0
  buffer_load_dwordx4 v5, s[12:15], s53 offen offset:768 lds
  s_add_u32 m0, s54, 27776
  s_nop 0
  buffer_load_dwordx4 v5, s[12:15], s53 offen offset:896 lds
  s_add_u32 m0, s54, 31744
  s_nop 0
  buffer_load_dwordx4 v5, s[12:15], s53 offen offset:1024 lds
  s_add_u32 m0, s54, 35712
  s_nop 0
  buffer_load_dwordx4 v5, s[12:15], s53 offen offset:1152 lds
  s_add_u32 m0, s51, 0
  s_add_u32 s46, s60, 0
  buffer_load_dwordx4 v1, s[4:7], s46 offen  lds
  s_add_u32 m0, s51, 4096
  s_add_u32 s46, s60, 128
  buffer_load_dwordx4 v1, s[4:7], s46 offen  lds
  s_add_u32 m0, s51, 8192
  s_add_u32 s46, s60, 256
  buffer_load_dwordx4 v1, s[4:7], s46 offen  lds
  s_add_u32 m0, s51, 12288
  s_add_u32 s46, s60, 393216
  buffer_load_dwordx4 v1, s[4:7], s46 offen  lds
  s_add_u32 m0, s51, 16384
  s_add_u32 s46, s60, 393344
  buffer_load_dwordx4 v1, s[4:7], s46 offen  lds
  s_add_u32 m0, s51, 20480
  s_add_u32 s46, s60, 393472
  buffer_load_dwordx4 v1, s[4:7], s46 offen  lds
  s_add_u32 m0, s51, 24576
  s_add_u32 s46, s60, 786432
  buffer_load_dwordx4 v1, s[4:7], s46 offen  lds
  s_add_u32 m0, s51, 28672
  s_add_u32 s46, s60, 786560
  buffer_load_dwordx4 v1, s[4:7], s46 offen  lds
  s_add_u32 m0, s51, 32768
  s_add_u32 s46, s60, 786688
  buffer_load_dwordx4 v1, s[4:7], s46 offen  lds
  s_add_u32 m0, s51, 36864
  s_add_u32 s46, s60, 1179648
  buffer_load_dwordx4 v1, s[4:7], s46 offen  lds
  s_add_u32 m0, s51, 40960
  s_add_u32 s46, s60, 1179776
  buffer_load_dwordx4 v1, s[4:7], s46 offen  lds
  s_add_u32 m0, s51, 45056
  s_add_u32 s46, s60, 1179904
  buffer_load_dwordx4 v1, s[4:7], s46 offen  lds
  s_add_u32 m0, s51, 49152
  s_add_u32 s46, s60, 1572864
  buffer_load_dwordx4 v1, s[4:7], s46 offen  lds
  s_add_u32 m0, s51, 53248
  s_add_u32 s46, s60, 1572992
  buffer_load_dwordx4 v1, s[4:7], s46 offen  lds
  s_add_u32 m0, s51, 57344
  s_add_u32 s46, s60, 1573120
  buffer_load_dwordx4 v1, s[4:7], s46 offen  lds
  s_add_u32 m0, s51, 61440
  s_add_u32 s46, s60, 1966080
  buffer_load_dwordx4 v1, s[4:7], s46 offen  lds
  s_add_u32 m0, s51, 65536
  s_add_u32 s46, s60, 1966208
  buffer_load_dwordx4 v1, s[4:7], s46 offen  lds
  s_add_u32 m0, s51, 69632
  s_add_u32 s46, s60, 1966336
  buffer_load_dwordx4 v1, s[4:7], s46 offen  lds
  s_add_u32 m0, s51, 73728
  s_add_u32 s46, s60, 2359296
  buffer_load_dwordx4 v1, s[4:7], s46 offen  lds
  s_add_u32 m0, s51, 77824
  s_add_u32 s46, s60, 2359424
  buffer_load_dwordx4 v1, s[4:7], s46 offen  lds
  s_add_u32 m0, s51, 81920
  s_add_u32 s46, s60, 2359552
  buffer_load_dwordx4 v1, s[4:7], s46 offen  lds
  s_add_u32 m0, s51, 86016
  s_add_u32 s46, s60, 2752512
  buffer_load_dwordx4 v1, s[4:7], s46 offen  lds
  s_add_u32 m0, s51, 90112
  s_add_u32 s46, s60, 2752640
  buffer_load_dwordx4 v1, s[4:7], s46 offen  lds
  s_add_u32 m0, s51, 94208
  s_add_u32 s46, s60, 2752768
  buffer_load_dwordx4 v1, s[4:7], s46 offen  lds
  s_waitcnt vmcnt(18)
  s_barrier
  s_add_u32 m0, s51, 98304
  s_add_u32 s46, s60, 3145728
  buffer_load_dwordx4 v1, s[4:7], s46 offen  lds
  s_add_u32 m0, s51, 102400
  s_add_u32 s46, s60, 3145856
  buffer_load_dwordx4 v1, s[4:7], s46 offen  lds
  s_add_u32 m0, s51, 106496
  s_add_u32 s46, s60, 3145984
  buffer_load_dwordx4 v1, s[4:7], s46 offen  lds
  s_add_u32 m0, s51, 110592
  s_add_u32 s46, s60, 3538944
  buffer_load_dwordx4 v1, s[4:7], s46 offen  lds
  s_add_u32 m0, s51, 114688
  s_add_u32 s46, s60, 3539072
  buffer_load_dwordx4 v1, s[4:7], s46 offen  lds
  s_add_u32 m0, s51, 118784
  s_add_u32 s46, s60, 3539200
  buffer_load_dwordx4 v1, s[4:7], s46 offen  lds
  ds_read_b64_tr_b16 a[0:1], v2 offset:0
  ds_read_b64_tr_b16 a[2:3], v2 offset:1024
  ds_read_b64_tr_b16 a[4:5], v2 offset:4096
  ds_read_b64_tr_b16 a[6:7], v2 offset:5120
  ds_read_b64_tr_b16 a[8:9], v2 offset:8192
  ds_read_b64_tr_b16 a[10:11], v2 offset:9216
  ds_read_b64_tr_b16 a[12:13], v2 offset:12288
  ds_read_b64_tr_b16 a[14:15], v2 offset:13312
  ds_read_b64_tr_b16 a[16:17], v2 offset:16384
  ds_read_b64_tr_b16 a[18:19], v2 offset:17408
  ds_read_b64_tr_b16 a[20:21], v2 offset:20480
  ds_read_b64_tr_b16 a[22:23], v2 offset:21504
  s_waitcnt lgkmcnt(0)
  s_waitcnt vmcnt(18)
  s_barrier
  s_add_u32 m0, s51, 0
  s_add_u32 s46, s60, 3932160
  buffer_load_dwordx4 v1, s[4:7], s46 offen  lds
  s_add_u32 m0, s51, 4096
  s_add_u32 s46, s60, 3932288
  buffer_load_dwordx4 v1, s[4:7], s46 offen  lds
  s_add_u32 m0, s51, 8192
  s_add_u32 s46, s60, 3932416
  buffer_load_dwordx4 v1, s[4:7], s46 offen  lds
  s_add_u32 m0, s51, 12288
  s_add_u32 s46, s60, 4325376
  buffer_load_dwordx4 v1, s[4:7], s46 offen  lds
  s_add_u32 m0, s51, 16384
  s_add_u32 s46, s60, 4325504
  buffer_load_dwordx4 v1, s[4:7], s46 offen  lds
  s_add_u32 m0, s51, 20480
  s_add_u32 s46, s60, 4325632
  buffer_load_dwordx4 v1, s[4:7], s46 offen  lds
  ds_read_b64_tr_b16 a[24:25], v2 offset:24576
  ds_read_b64_tr_b16 a[26:27], v2 offset:25600
  ds_read_b64_tr_b16 a[28:29], v2 offset:28672
  ds_read_b64_tr_b16 a[30:31], v2 offset:29696
  ds_read_b64_tr_b16 a[32:33], v2 offset:32768
  ds_read_b64_tr_b16 a[34:35], v2 offset:33792
  ds_read_b64_tr_b16 a[36:37], v2 offset:36864
  ds_read_b64_tr_b16 a[38:39], v2 offset:37888
  ds_read_b64_tr_b16 a[40:41], v2 offset:40960
  ds_read_b64_tr_b16 a[42:43], v2 offset:41984
  ds_read_b64_tr_b16 a[44:45], v2 offset:45056
  ds_read_b64_tr_b16 a[46:47], v2 offset:46080
  s_waitcnt lgkmcnt(0)
  s_waitcnt vmcnt(18)
  s_barrier
  s_add_u32 m0, s51, 24576
  s_add_u32 s46, s60, 4718592
  buffer_load_dwordx4 v1, s[4:7], s46 offen  lds
  s_add_u32 m0, s51, 28672
  s_add_u32 s46, s60, 4718720
  buffer_load_dwordx4 v1, s[4:7], s46 offen  lds
  s_add_u32 m0, s51, 32768
  s_add_u32 s46, s60, 4718848
  buffer_load_dwordx4 v1, s[4:7], s46 offen  lds
  s_add_u32 m0, s51, 36864
  s_add_u32 s46, s60, 5111808
  buffer_load_dwordx4 v1, s[4:7], s46 offen  lds
  s_add_u32 m0, s51, 40960
  s_add_u32 s46, s60, 5111936
  buffer_load_dwordx4 v1, s[4:7], s46 offen  lds
  s_add_u32 m0, s51, 45056
  s_add_u32 s46, s60, 5112064
  buffer_load_dwordx4 v1, s[4:7], s46 offen  lds
  ds_read_b64_tr_b16 a[48:49], v2 offset:49152
  ds_read_b64_tr_b16 a[50:51], v2 offset:50176
  ds_read_b64_tr_b16 a[52:53], v2 offset:53248
  ds_read_b64_tr_b16 a[54:55], v2 offset:54272
  ds_read_b64_tr_b16 a[56:57], v2 offset:57344
  ds_read_b64_tr_b16 a[58:59], v2 offset:58368
  ds_read_b64_tr_b16 a[60:61], v2 offset:61440
  ds_read_b64_tr_b16 a[62:63], v2 offset:62464
  ds_read_b64_tr_b16 a[64:65], v3 offset:0
  ds_read_b64_tr_b16 a[66:67], v3 offset:1024
  ds_read_b64_tr_b16 a[68:69], v3 offset:4096
  ds_read_b64_tr_b16 a[70:71], v3 offset:5120
  s_waitcnt lgkmcnt(0)
  s_waitcnt vmcnt(18)
  s_barrier
  s_add_u32 m0, s51, 49152
  s_add_u32 s46, s60, 5505024
  buffer_load_dwordx4 v1, s[4:7], s46 offen  lds
  s_add_u32 m0, s51, 53248
  s_add_u32 s46, s60, 5505152
  buffer_load_dwordx4 v1, s[4:7], s46 offen  lds
  s_add_u32 m0, s51, 57344
  s_add_u32 s46, s60, 5505280
  buffer_load_dwordx4 v1, s[4:7], s46 offen  lds
  s_add_u32 m0, s51, 61440
  s_add_u32 s46, s60, 5898240
  buffer_load_dwordx4 v1, s[4:7], s46 offen  lds
  s_add_u32 m0, s51, 65536
  s_add_u32 s46, s60, 5898368
  buffer_load_dwordx4 v1, s[4:7], s46 offen  lds
  s_add_u32 m0, s51, 69632
  s_add_u32 s46, s60, 5898496
  buffer_load_dwordx4 v1, s[4:7], s46 offen  lds
  ds_read_b64_tr_b16 a[72:73], v3 offset:8192
  ds_read_b64_tr_b16 a[74:75], v3 offset:9216
  ds_read_b64_tr_b16 a[76:77], v3 offset:12288
  ds_read_b64_tr_b16 a[78:79], v3 offset:13312
  ds_read_b64_tr_b16 a[80:81], v3 offset:16384
  ds_read_b64_tr_b16 a[82:83], v3 offset:17408
  ds_read_b64_tr_b16 a[84:85], v3 offset:20480
  ds_read_b64_tr_b16 a[86:87], v3 offset:21504
  ds_read_b64_tr_b16 a[88:89], v3 offset:24576
  ds_read_b64_tr_b16 a[90:91], v3 offset:25600
  ds_read_b64_tr_b16 a[92:93], v3 offset:28672
  ds_read_b64_tr_b16 a[94:95], v3 offset:29696
  s_waitcnt lgkmcnt(0)
  s_waitcnt vmcnt(18)
  s_barrier
  s_add_u32 m0, s51, 73728
  s_add_u32 s46, s60, 6291456
  buffer_load_dwordx4 v1, s[4:7], s46 offen  lds
  s_add_u32 m0, s51, 77824
  s_add_u32 s46, s60, 6291584
  buffer_load_dwordx4 v1, s[4:7], s46 offen  lds
  s_add_u32 m0, s51, 81920
  s_add_u32 s46, s60, 6291712
  buffer_load_dwordx4 v1, s[4:7], s46 offen  lds
  s_add_u32 m0, s51, 86016
  s_add_u32 s46, s60, 6684672
  buffer_load_dwordx4 v1, s[4:7], s46 offen  lds
  s_add_u32 m0, s51, 90112
  s_add_u32 s46, s60, 6684800
  buffer_load_dwordx4 v1, s[4:7], s46 offen  lds
  s_add_u32 m0, s51, 94208
  s_add_u32 s46, s60, 6684928
  buffer_load_dwordx4 v1, s[4:7], s46 offen  lds
  ds_read_b64_tr_b16 a[96:97], v3 offset:32768
  ds_read_b64_tr_b16 a[98:99], v3 offset:33792
  ds_read_b64_tr_b16 a[100:101], v3 offset:36864
  ds_read_b64_tr_b16 a[102:103], v3 offset:37888
  ds_read_b64_tr_b16 a[104:105], v3 offset:40960
  ds_read_b64_tr_b16 a[106:107], v3 offset:41984
  ds_read_b64_tr_b16 a[108:109], v3 offset:45056
  ds_read_b64_tr_b16 a[110:111], v3 offset:46080
  ds_read_b64_tr_b16 a[112:113], v3 offset:49152
  ds_read_b64_tr_b16 a[114:115], v3 offset:50176
  ds_read_b64_tr_b16 a[116:117], v3 offset:53248
  ds_read_b64_tr_b16 a[118:119], v3 offset:54272
  s_waitcnt lgkmcnt(0)
  s_waitcnt vmcnt(18)
  s_barrier
  v_and_b32 v11, 3, v0
  v_lshlrev_b32 v11, 2, v11
  global_load_dword v10, v11, s[38:39] sc1
  s_add_u32 m0, s51, 98304
  s_add_u32 s46, s60, 7077888
  buffer_load_dwordx4 v1, s[4:7], s46 offen  lds
  s_add_u32 m0, s51, 102400
  s_add_u32 s46, s60, 7078016
  buffer_load_dwordx4 v1, s[4:7], s46 offen  lds
  s_add_u32 m0, s51, 106496
  s_add_u32 s46, s60, 7078144
  buffer_load_dwordx4 v1, s[4:7], s46 offen  lds
  s_add_u32 m0, s51, 110592
  s_add_u32 s46, s60, 7471104
  buffer_load_dwordx4 v1, s[4:7], s46 offen  lds
  s_add_u32 m0, s51, 114688
  s_add_u32 s46, s60, 7471232
  buffer_load_dwordx4 v1, s[4:7], s46 offen  lds
  s_add_u32 m0, s51, 118784
  s_add_u32 s46, s60, 7471360
  buffer_load_dwordx4 v1, s[4:7], s46 offen  lds
  ds_read_b64_tr_b16 a[120:121], v2 offset:0
  ds_read_b64_tr_b16 a[122:123], v2 offset:1024
  ds_read_b64_tr_b16 a[124:125], v2 offset:4096
  ds_read_b64_tr_b16 a[126:127], v2 offset:5120
  ds_read_b64_tr_b16 a[128:129], v2 offset:8192
  ds_read_b64_tr_b16 a[130:131], v2 offset:9216
  ds_read_b64_tr_b16 a[132:133], v2 offset:12288
  ds_read_b64_tr_b16 a[134:135], v2 offset:13312
  ds_read_b64_tr_b16 a[136:137], v2 offset:16384
  ds_read_b64_tr_b16 a[138:139], v2 offset:17408
  ds_read_b64_tr_b16 a[140:141], v2 offset:20480
  ds_read_b64_tr_b16 a[142:143], v2 offset:21504
  s_waitcnt lgkmcnt(0)
  s_waitcnt vmcnt(19)
  s_barrier
  ds_read_b64_tr_b16 a[144:145], v2 offset:24576
  ds_read_b64_tr_b16 a[146:147], v2 offset:25600
  ds_read_b64_tr_b16 a[148:149], v2 offset:28672
  ds_read_b64_tr_b16 a[150:151], v2 offset:29696
  ds_read_b64_tr_b16 a[152:153], v2 offset:32768
  ds_read_b64_tr_b16 a[154:155], v2 offset:33792
  ds_read_b64_tr_b16 a[156:157], v2 offset:36864
  ds_read_b64_tr_b16 a[158:159], v2 offset:37888
  ds_read_b64_tr_b16 a[160:161], v2 offset:40960
  ds_read_b64_tr_b16 a[162:163], v2 offset:41984
  ds_read_b64_tr_b16 a[164:165], v2 offset:45056
  ds_read_b64_tr_b16 a[166:167], v2 offset:46080
  s_waitcnt lgkmcnt(0)
  s_waitcnt vmcnt(13)
  s_barrier
  ds_read_b64_tr_b16 a[168:169], v2 offset:49152
  ds_read_b64_tr_b16 a[170:171], v2 offset:50176
  ds_read_b64_tr_b16 a[172:173], v2 offset:53248
  ds_read_b64_tr_b16 a[174:175], v2 offset:54272
  ds_read_b64_tr_b16 a[176:177], v2 offset:57344
  ds_read_b64_tr_b16 a[178:179], v2 offset:58368
  ds_read_b64_tr_b16 a[180:181], v2 offset:61440
  ds_read_b64_tr_b16 a[182:183], v2 offset:62464
  ds_read_b64_tr_b16 a[184:185], v3 offset:0
  ds_read_b64_tr_b16 a[186:187], v3 offset:1024
  ds_read_b64_tr_b16 a[188:189], v3 offset:4096
  ds_read_b64_tr_b16 a[190:191], v3 offset:5120
  s_waitcnt lgkmcnt(0)
  s_waitcnt vmcnt(7)
  s_barrier
  ds_read_b64_tr_b16 a[192:193], v3 offset:8192
  ds_read_b64_tr_b16 a[194:195], v3 offset:9216
  ds_read_b64_tr_b16 a[196:197], v3 offset:12288
  ds_read_b64_tr_b16 a[198:199], v3 offset:13312
  ds_read_b64_tr_b16 a[200:201], v3 offset:16384
  ds_read_b64_tr_b16 a[202:203], v3 offset:17408
  ds_read_b64_tr_b16 a[204:205], v3 offset:20480
  ds_read_b64_tr_b16 a[206:207], v3 offset:21504
  ds_read_b64_tr_b16 a[208:209], v3 offset:24576
  ds_read_b64_tr_b16 a[210:211], v3 offset:25600
  ds_read_b64_tr_b16 a[212:213], v3 offset:28672
  ds_read_b64_tr_b16 a[214:215], v3 offset:29696
  s_waitcnt lgkmcnt(0)
  s_waitcnt vmcnt(0)
  s_barrier
  ds_read_b64_tr_b16 a[216:217], v3 offset:32768
  ds_read_b64_tr_b16 a[218:219], v3 offset:33792
  ds_read_b64_tr_b16 a[220:221], v3 offset:36864
  ds_read_b64_tr_b16 a[222:223], v3 offset:37888
  ds_read_b64_tr_b16 a[224:225], v3 offset:40960
  ds_read_b64_tr_b16 a[226:227], v3 offset:41984
  ds_read_b64_tr_b16 a[228:229], v3 offset:45056
  ds_read_b64_tr_b16 a[230:231], v3 offset:46080
  ds_read_b64_tr_b16 a[232:233], v3 offset:49152
  ds_read_b64_tr_b16 a[234:235], v3 offset:50176
  ds_read_b64_tr_b16 a[236:237], v3 offset:53248
  ds_read_b64_tr_b16 a[238:239], v3 offset:54272
  s_waitcnt lgkmcnt(0)
  s_mov_b32 s50, 0
  s_branch ss_3_in
ss_3:
  v_and_b32 v11, 3, v0
  v_lshlrev_b32 v11, 2, v11
  global_load_dword v10, v11, s[38:39] sc1
  s_add_u32 s50, s50, 1
  s_cmp_gt_u32 s50, 131072
  s_cbranch_scc1 L_fail
  s_waitcnt vmcnt(0)
ss_3_in:
  v_readlane_b32 s46, v10, 0
  v_readlane_b32 s47, v10, 2
  v_readlane_b32 s48, v10, 1
  s_nop 0
  s_min_u32 s47, s47, s48
  s_cmp_lg_u32 s46, 0
  s_cselect_b32 s48, 7, 0
  s_add_u32 s46, s46, s2
  s_xor_b32 s49, s46, s43
  s_and_b32 s49, s49, s48
  s_cbranch_scc1 L_reroll
  s_cmp_lg_u32 s47, 0
  s_cbranch_scc1 ss_ok_4
  s_sleep 6
  s_branch ss_3
ss_ok_4:
  v_readlane_b32 s3, v10, 1
  s_nop 0
  s_and_b32 s3, s3, 0x2000
  s_barrier
  s_mov_b32 s54, s51
  s_add_u32 s53, s53, 40960
  s_add_u32 m0, s54, 0
  s_nop 0
  buffer_load_dwordx4 v5, s[12:15], s53 offen offset:0 lds
  s_add_u32 m0, s54, 3968
  s_nop 0
  buffer_load_dwordx4 v5, s[12:15], s53 offen offset:128 lds
  s_add_u32 m0, s54, 7936
  s_nop 0
  buffer_load_dwordx4 v5, s[12:15], s53 offen offset:256 lds
  s_add_u32 m0, s54, 11904
  s_nop 0
  buffer_load_dwordx4 v5, s[12:15], s53 offen offset:384 lds
  s_add_u32 m0, s54, 15872
  s_nop 0
  buffer_load_dwordx4 v5, s[12:15], s53 offen offset:512 lds
  s_add_u32 m0, s54, 19840
  s_nop 0
  buffer_load_dwordx4 v5, s[12:15], s53 offen offset:640 lds
  s_add_u32 m0, s54, 23808
  s_nop 0
  buffer_load_dwordx4 v5, s[12:15], s53 offen offset:768 lds
  s_add_u32 m0, s54, 27776
  s_nop 0
  buffer_load_dwordx4 v5, s[12:15], s53 offen offset:896 lds
  s_add_u32 m0, s54, 31744
  s_nop 0
  buffer_load_dwordx4 v5, s[12:15], s53 offen offset:1024 lds
  s_add_u32 m0, s54, 35712
  s_nop 0
  buffer_load_dwordx4 v5, s[12:15], s53 offen offset:1152 lds
  s_mov_b32 s55, 2146435072
  s_mov_b32 s56, 2146435072
  s_mov_b32 s57, 2146435072
  s_xor_b32 s63, s63, s3
  s_mov_b32 s58, 122880
  ds_read_b128 v[16:19], v6 offset:0
  ds_read_b128 v[20:23], v7 offset:0
  ds_read_b128 v[24:27], v6 offset:4096
  ds_read_b128 v[28:31], v7 offset:4096
  s_waitcnt lgkmcnt(3)
pj_loop_5:
  v_mfma_f32_16x16x32_bf16 v[40:43], a[0:3], v[16:19], 0
  ds_read_b128 v[32:35], v6 offset:8192
  v_mfma_f32_16x16x32_bf16 v[48:51], a[4:7], v[16:19], 0
  v_mfma_f32_16x16x32_bf16 v[56:59], a[8:11], v[16:19], 0
  s_waitcnt lgkmcnt(3)
  v_cvt_pk_bf16_f32 v66, v44, v45
  v_mfma_f32_16x16x32_bf16 v[40:43], a[12:15], v[20:23], v[40:43]
  ds_read_b128 v[16:19], v7 offset:8192
  v_cvt_pk_bf16_f32 v67, v46, v47
  v_mfma_f32_16x16x32_bf16 v[48:51], a[16:19], v[20:23], v[48:51]
  v_cvt_pk_bf16_f32 v70, v52, v53
  v_mfma_f32_16x16x32_bf16 v[56:59], a[20:23], v[20:23], v[56:59]
  s_waitcnt lgkmcnt(3)
  v_cvt_pk_bf16_f32 v71, v54, v55
  v_mfma_f32_16x16x32_bf16 v[40:43], a[24:27], v[24:27], v[40:43]
  ds_read_b128 v[20:23], v6 offset:12288
  v_cvt_pk_bf16_f32 v74, v60, v61
  v_mfma_f32_16x16x32_bf16 v[48:51], a[28:31], v[24:27], v[48:51]
  v_cvt_pk_bf16_f32 v75, v62, v63
  v_mfma_f32_16x16x32_bf16 v[56:59], a[32:35], v[24:27], v[56:59]
  s_waitcnt lgkmcnt(3)
  v_mfma_f32_16x16x32_bf16 v[40:43], a[36:39], v[28:31], v[40:43]
  ds_read_b128 v[24:27], v7 offset:12288
  v_permlane16_swap_b32 v64, v66
  v_mfma_f32_16x16x32_bf16 v[48:51], a[40:43], v[28:31], v[48:51]
  v_permlane16_swap_b32 v65, v67
  v_mfma_f32_16x16x32_bf16 v[56:59], a[44:47], v[28:31], v[56:59]
  buffer_store_dwordx4 v[64:67], v8, s[8:11], s55 offen sc1
  s_waitcnt lgkmcnt(3)
  v_mfma_f32_16x16x32_bf16 v[40:43], a[48:51], v[32:35], v[40:43]
  ds_read_b128 v[28:31], v6 offset:16384
  v_permlane16_swap_b32 v68, v70
  v_mfma_f32_16x16x32_bf16 v[48:51], a[52:55], v[32:35], v[48:51]
  v_permlane16_swap_b32 v69, v71
  v_mfma_f32_16x16x32_bf16 v[56:59], a[56:59], v[32:35], v[56:59]
  buffer_store_dwordx4 v[68:71], v8, s[8:11], s56 offen sc1
  s_waitcnt lgkmcnt(3)
  v_mfma_f32_16x16x32_bf16 v[40:43], a[60:63], v[16:19], v[40:43]
  ds_read_b128 v[32:35], v7 offset:16384
  v_permlane16_swap_b32 v72, v74
  v_mfma_f32_16x16x32_bf16 v[48:51], a[64:67], v[16:19], v[48:51]
  v_permlane16_swap_b32 v73, v75
  v_mfma_f32_16x16x32_bf16 v[56:59], a[68:71], v[16:19], v[56:59]
  buffer_store_dwordx4 v[72:75], v8, s[8:11], s57 offen sc1
  s_waitcnt lgkmcnt(3)
  v_mfma_f32_16x16x32_bf16 v[40:43], a[72:75], v[20:23], v[40:43]
  ds_read_b128 v[16:19], v6 offset:20480
  v_mfma_f32_16x16x32_bf16 v[48:51], a[76:79], v[20:23], v[48:51]
  v_mfma_f32_16x16x32_bf16 v[56:59], a[80:83], v[20:23], v[56:59]
  s_waitcnt lgkmcnt(3)
  v_mfma_f32_16x16x32_bf16 v[40:43], a[84:87], v[24:27], v[40:43]
  ds_read_b128 v[20:23], v7 offset:20480
  v_mfma_f32_16x16x32_bf16 v[48:51], a[88:91], v[24:27], v[48:51]
  v_mov_b32 v10, s52
  v_mfma_f32_16x16x32_bf16 v[56:59], a[92:95], v[24:27], v[56:59]
  s_waitcnt lgkmcnt(3)
  v_mfma_f32_16x16x32_bf16 v[40:43], a[96:99], v[28:31], v[40:43]
  ds_read_b128 v[24:27], v6 offset:24576
  v_mfma_f32_16x16x32_bf16 v[48:51], a[100:103], v[28:31], v[48:51]
  s_add_u32 s53, s53, 40960
  s_add_u32 s54, s54, 40960
  v_mfma_f32_16x16x32_bf16 v[56:59], a[104:107], v[28:31], v[56:59]
  s_waitcnt lgkmcnt(3)
  v_mfma_f32_16x16x32_bf16 v[40:43], a[108:111], v[32:35], v[40:43]
  ds_read_b128 v[28:31], v7 offset:24576
  v_mfma_f32_16x16x32_bf16 v[48:51], a[112:115], v[32:35], v[48:51]
  s_cmp_ge_u32 s54, 163840
  s_cselect_b32 s54, s51, s54
  v_mfma_f32_16x16x32_bf16 v[56:59], a[116:119], v[32:35], v[56:59]
  s_waitcnt lgkmcnt(3)
  v_mfma_f32_16x16x32_bf16 v[40:43], a[120:123], v[16:19], v[40:43]
  ds_read_b128 v[32:35], v6 offset:28672
  v_mfma_f32_16x16x32_bf16 v[48:51], a[124:127], v[16:19], v[48:51]
  s_cmp_eq_u32 s58, 122880
  s_cselect_b32 s59, 163840, 0
  v_mfma_f32_16x16x32_bf16 v[56:59], a[128:131], v[16:19], v[56:59]
  s_waitcnt lgkmcnt(3)
  v_mfma_f32_16x16x32_bf16 v[40:43], a[132:135], v[20:23], v[40:43]
  ds_read_b128 v[16:19], v7 offset:28672
  v_mfma_f32_16x16x32_bf16 v[48:51], a[136:139], v[20:23], v[48:51]
  s_sub_u32 s59, 40960, s59
  s_add_u32 s58, s58, s59
  v_mfma_f32_16x16x32_bf16 v[56:59], a[140:143], v[20:23], v[56:59]
  s_cmp_eq_u32 s52, 1
  s_cbranch_scc1 pj_eager
pj_eback:
  s_waitcnt lgkmcnt(3)
  v_mfma_f32_16x16x32_bf16 v[40:43], a[144:147], v[24:27], v[40:43]
  ds_read_b128 v[20:23], v6 offset:32768
  v_mfma_f32_16x16x32_bf16 v[48:51], a[148:151], v[24:27], v[48:51]
  s_lshr_b32 s55, s67, 1
  v_mfma_f32_16x16x32_bf16 v[56:59], a[152:155], v[24:27], v[56:59]
  s_lshl_b32 s55, s55, 14
  s_waitcnt lgkmcnt(3)
  v_mfma_f32_16x16x32_bf16 v[40:43], a[156:159], v[28:31], v[40:43]
  ds_read_b128 v[24:27], v7 offset:32768
  v_mfma_f32_16x16x32_bf16 v[48:51], a[160:163], v[28:31], v[48:51]
  s_and_b32 s56, s67, 1
  v_mfma_f32_16x16x32_bf16 v[56:59], a[164:167], v[28:31], v[56:59]
  s_lshl_b32 s56, s56, 12
  s_waitcnt lgkmcnt(3)
  v_mfma_f32_16x16x32_bf16 v[40:43], a[168:171], v[32:35], v[40:43]
  ds_read_b128 v[28:31], v6 offset:36864
  v_mfma_f32_16x16x32_bf16 v[48:51], a[172:175], v[32:35], v[48:51]
  s_add_u32 s55, s55, s56
  v_mfma_f32_16x16x32_bf16 v[56:59], a[176:179], v[32:35], v[56:59]
  s_add_u32 s55, s55, s63
  s_waitcnt lgkmcnt(3)
  v_mfma_f32_16x16x32_bf16 v[40:43], a[180:183], v[16:19], v[40:43]
  ds_read_b128 v[32:35], v7 offset:36864
  v_mfma_f32_16x16x32_bf16 v[48:51], a[184:187], v[16:19], v[48:51]
  s_lshr_b32 s56, s55, 8
  v_mfma_f32_16x16x32_bf16 v[56:59], a[188:191], v[16:19], v[56:59]
  s_and_b32 s56, s56, 0x2000
  s_waitcnt lgkmcnt(3)
  v_mfma_f32_16x16x32_bf16 v[40:43], a[192:195], v[20:23], v[40:43]
  ds_read_b128 v[16:19], v6 offset:2048
  v_mfma_f32_16x16x32_bf16 v[48:51], a[196:199], v[20:23], v[48:51]
  s_xor_b32 s55, s55, s56
  v_mfma_f32_16x16x32_bf16 v[56:59], a[200:203], v[20:23], v[56:59]
  s_add_u32 s67, s67, 32
  s_waitcnt lgkmcnt(3)
  v_mfma_f32_16x16x32_bf16 v[40:43], a[204:207], v[24:27], v[40:43]
  ds_read_b128 v[20:23], v7 offset:2048
  v_mfma_f32_16x16x32_bf16 v[48:51], a[208:211], v[24:27], v[48:51]
  s_cmp_ge_u32 s67, 1024
  s_cselect_b32 s56, 1024, 0
  v_mfma_f32_16x16x32_bf16 v[56:59], a[212:215], v[24:27], v[56:59]
  s_sub_u32 s67, s67, s56
  s_waitcnt lgkmcnt(3)
  v_mfma_f32_16x16x32_bf16 v[40:43], a[216:219], v[28:31], v[40:43]
  ds_read_b128 v[24:27], v6 offset:6144
  v_mfma_f32_16x16x32_bf16 v[48:51], a[220:223], v[28:31], v[48:51]
  s_add_u32 s56, s55, 16777216
  v_mfma_f32_16x16x32_bf16 v[56:59], a[224:227], v[28:31], v[56:59]
  s_add_u32 s57, s55, 33554432
  s_waitcnt lgkmcnt(3)
  v_mfma_f32_16x16x32_bf16 v[40:43], a[228:231], v[32:35], v[40:43]
  ds_read_b128 v[28:31], v7 offset:6144
  v_mfma_f32_16x16x32_bf16 v[48:51], a[232:235], v[32:35], v[48:51]
  v_mfma_f32_16x16x32_bf16 v[56:59], a[236:239], v[32:35], v[56:59]
  s_waitcnt lgkmcnt(3)
  v_mfma_f32_16x16x32_bf16 v[44:47], a[0:3], v[16:19], 0
  ds_read_b128 v[32:35], v6 offset:10240
  v_mfma_f32_16x16x32_bf16 v[52:55], a[4:7], v[16:19], 0
  v_mfma_f32_16x16x32_bf16 v[60:63], a[8:11], v[16:19], 0
  s_waitcnt lgkmcnt(3)
  v_cvt_pk_bf16_f32 v64, v40, v41
  v_mfma_f32_16x16x32_bf16 v[44:47], a[12:15], v[20:23], v[44:47]
  ds_read_b128 v[16:19], v7 offset:10240
  v_cvt_pk_bf16_f32 v65, v42, v43
  v_mfma_f32_16x16x32_bf16 v[52:55], a[16:19], v[20:23], v[52:55]
  v_cvt_pk_bf16_f32 v68, v48, v49
  v_mfma_f32_16x16x32_bf16 v[60:63], a[20:23], v[20:23], v[60:63]
  s_waitcnt lgkmcnt(3)
  v_cvt_pk_bf16_f32 v69, v50, v51
  v_mfma_f32_16x16x32_bf16 v[44:47], a[24:27], v[24:27], v[44:47]
  ds_read_b128 v[20:23], v6 offset:14336
  v_cvt_pk_bf16_f32 v72, v56, v57
  v_mfma_f32_16x16x32_bf16 v[52:55], a[28:31], v[24:27], v[52:55]
  v_cvt_pk_bf16_f32 v73, v58, v59
  v_mfma_f32_16x16x32_bf16 v[60:63], a[32:35], v[24:27], v[60:63]
  s_waitcnt lgkmcnt(3)
  v_mfma_f32_16x16x32_bf16 v[44:47], a[36:39], v[28:31], v[44:47]
  ds_read_b128 v[24:27], v7 offset:14336
  v_mfma_f32_16x16x32_bf16 v[52:55], a[40:43], v[28:31], v[52:55]
  s_waitcnt vmcnt(0)
  s_barrier
  v_mfma_f32_16x16x32_bf16 v[60:63], a[44:47], v[28:31], v[60:63]
  buffer_store_dword v10, v9, s[8:11], 0 offen sc1
  s_waitcnt lgkmcnt(3)
  v_mfma_f32_16x16x32_bf16 v[44:47], a[48:51], v[32:35], v[44:47]
  ds_read_b128 v[28:31], v6 offset:18432
  s_add_u32 m0, s54, 0
  v_mfma_f32_16x16x32_bf16 v[52:55], a[52:55], v[32:35], v[52:55]
  buffer_load_dwordx4 v5, s[12:15], s53 offen offset:0 lds
  v_mfma_f32_16x16x32_bf16 v[60:63], a[56:59], v[32:35], v[60:63]
  s_waitcnt lgkmcnt(3)
  v_mfma_f32_16x16x32_bf16 v[44:47], a[60:63], v[16:19], v[44:47]
  ds_read_b128 v[32:35], v7 offset:18432
  s_add_u32 m0, s54, 3968
  v_mfma_f32_16x16x32_bf16 v[52:55], a[64:67], v[16:19], v[52:55]
  buffer_load_dwordx4 v5, s[12:15], s53 offen offset:128 lds
  v_mfma_f32_16x16x32_bf16 v[60:63], a[68:71], v[16:19], v[60:63]
  s_waitcnt lgkmcnt(3)
  v_mfma_f32_16x16x32_bf16 v[44:47], a[72:75], v[20:23], v[44:47]
  ds_read_b128 v[16:19], v6 offset:22528
  s_add_u32 m0, s54, 7936
  v_mfma_f32_16x16x32_bf16 v[52:55], a[76:79], v[20:23], v[52:55]
  buffer_load_dwordx4 v5, s[12:15], s53 offen offset:256 lds
  v_mfma_f32_16x16x32_bf16 v[60:63], a[80:83], v[20:23], v[60:63]
  s_waitcnt lgkmcnt(3)
  v_mfma_f32_16x16x32_bf16 v[44:47], a[84:87], v[24:27], v[44:47]
  ds_read_b128 v[20:23], v7 offset:22528
  s_add_u32 m0, s54, 11904
  v_mfma_f32_16x16x32_bf16 v[52:55], a[88:91], v[24:27], v[52:55]
  buffer_load_dwordx4 v5, s[12:15], s53 offen offset:384 lds
  v_mfma_f32_16x16x32_bf16 v[60:63], a[92:95], v[24:27], v[60:63]
  s_waitcnt lgkmcnt(3)
  v_mfma_f32_16x16x32_bf16 v[44:47], a[96:99], v[28:31], v[44:47]
  ds_read_b128 v[24:27], v6 offset:26624
  s_add_u32 m0, s54, 15872
  v_mfma_f32_16x16x32_bf16 v[52:55], a[100:103], v[28:31], v[52:55]
  buffer_load_dwordx4 v5, s[12:15], s53 offen offset:512 lds
  v_mfma_f32_16x16x32_bf16 v[60:63], a[104:107], v[28:31], v[60:63]
  s_waitcnt lgkmcnt(3)
  v_mfma_f32_16x16x32_bf16 v[44:47], a[108:111], v[32:35], v[44:47]
  ds_read_b128 v[28:31], v7 offset:26624
  s_add_u32 m0, s54, 19840
  v_mfma_f32_16x16x32_bf16 v[52:55], a[112:115], v[32:35], v[52:55]
  buffer_load_dwordx4 v5, s[12:15], s53 offen offset:640 lds
  v_mfma_f32_16x16x32_bf16 v[60:63], a[116:119], v[32:35], v[60:63]
  s_waitcnt lgkmcnt(3)
  v_mfma_f32_16x16x32_bf16 v[44:47], a[120:123], v[16:19], v[44:47]
  ds_read_b128 v[32:35], v6 offset:30720
  s_add_u32 m0, s54, 23808
  v_mfma_f32_16x16x32_bf16 v[52:55], a[124:127], v[16:19], v[52:55]
  buffer_load_dwordx4 v5, s[12:15], s53 offen offset:768 lds
  v_mfma_f32_16x16x32_bf16 v[60:63], a[128:131], v[16:19], v[60:63]
  s_waitcnt lgkmcnt(3)
  v_mfma_f32_16x16x32_bf16 v[44:47], a[132:135], v[20:23], v[44:47]
  ds_read_b128 v[16:19], v7 offset:30720
  s_add_u32 m0, s54, 27776
  v_mfma_f32_16x16x32_bf16 v[52:55], a[136:139], v[20:23], v[52:55]
  buffer_load_dwordx4 v5, s[12:15], s53 offen offset:896 lds
  v_mfma_f32_16x16x32_bf16 v[60:63], a[140:143], v[20:23], v[60:63]
  s_waitcnt lgkmcnt(3)
  v_mfma_f32_16x16x32_bf16 v[44:47], a[144:147], v[24:27], v[44:47]
  ds_read_b128 v[20:23], v6 offset:34816
  s_add_u32 m0, s54, 31744
  v_mfma_f32_16x16x32_bf16 v[52:55], a[148:151], v[24:27], v[52:55]
  buffer_load_dwordx4 v5, s[12:15], s53 offen offset:1024 lds
  v_mfma_f32_16x16x32_bf16 v[60:63], a[152:155], v[24:27], v[60:63]
  s_waitcnt lgkmcnt(3)
  v_mfma_f32_16x16x32_bf16 v[44:47], a[156:159], v[28:31], v[44:47]
  ds_read_b128 v[24:27], v7 offset:34816
  s_add_u32 m0, s54, 35712
  v_mfma_f32_16x16x32_bf16 v[52:55], a[160:163], v[28:31], v[52:55]
  buffer_load_dwordx4 v5, s[12:15], s53 offen offset:1152 lds
  v_mfma_f32_16x16x32_bf16 v[60:63], a[164:167], v[28:31], v[60:63]
  s_waitcnt lgkmcnt(3)
  v_mfma_f32_16x16x32_bf16 v[44:47], a[168:171], v[32:35], v[44:47]
  ds_read_b128 v[28:31], v6 offset:38912
  v_mfma_f32_16x16x32_bf16 v[52:55], a[172:175], v[32:35], v[52:55]
  s_max_u32 s69, s52, 25
  s_sub_u32 s69, s69, 25
  v_mfma_f32_16x16x32_bf16 v[60:63], a[176:179], v[32:35], v[60:63]
  s_cmp_eq_u32 s52, s70
  s_cbranch_scc1 pj_warm
pj_wback:
  s_waitcnt lgkmcnt(3)
  v_mfma_f32_16x16x32_bf16 v[44:47], a[180:183], v[16:19], v[44:47]
  ds_read_b128 v[32:35], v7 offset:38912
  v_mfma_f32_16x16x32_bf16 v[52:55], a[184:187], v[16:19], v[52:55]
  v_add_u32 v6, s59, v6
  v_add_u32 v7, s59, v7
  v_mfma_f32_16x16x32_bf16 v[60:63], a[188:191], v[16:19], v[60:63]
  s_waitcnt lgkmcnt(3)
  v_mfma_f32_16x16x32_bf16 v[44:47], a[192:195], v[20:23], v[44:47]
  ds_read_b128 v[16:19], v6 offset:0
  v_mfma_f32_16x16x32_bf16 v[52:55], a[196:199], v[20:23], v[52:55]
  s_cmp_lt_u32 s68, s69
  s_cbranch_scc1 pj_slow
pj_back:
  v_mfma_f32_16x16x32_bf16 v[60:63], a[200:203], v[20:23], v[60:63]
  s_waitcnt lgkmcnt(3)
  v_mfma_f32_16x16x32_bf16 v[44:47], a[204:207], v[24:27], v[44:47]
  ds_read_b128 v[20:23], v7 offset:0
  v_mfma_f32_16x16x32_bf16 v[52:55], a[208:211], v[24:27], v[52:55]
  s_add_u32 s52, s52, 1
  v_mfma_f32_16x16x32_bf16 v[60:63], a[212:215], v[24:27], v[60:63]
  s_waitcnt lgkmcnt(3)
  v_mfma_f32_16x16x32_bf16 v[44:47], a[216:219], v[28:31], v[44:47]
  ds_read_b128 v[24:27], v6 offset:4096
  v_mfma_f32_16x16x32_bf16 v[52:55], a[220:223], v[28:31], v[52:55]
  v_mfma_f32_16x16x32_bf16 v[60:63], a[224:227], v[28:31], v[60:63]
  s_waitcnt lgkmcnt(3)
  v_mfma_f32_16x16x32_bf16 v[44:47], a[228:231], v[32:35], v[44:47]
  ds_read_b128 v[28:31], v7 offset:4096
  v_mfma_f32_16x16x32_bf16 v[52:55], a[232:235], v[32:35], v[52:55]
  s_cmp_lt_u32 s52, s62
  v_mfma_f32_16x16x32_bf16 v[60:63], a[236:239], v[32:35], v[60:63]
  s_waitcnt lgkmcnt(3)
  s_cbranch_scc1 pj_loop_5
  v_cvt_pk_bf16_f32 v66, v44, v45
  v_cvt_pk_bf16_f32 v67, v46, v47
  s_nop 1
  v_cvt_pk_bf16_f32 v70, v52, v53
  v_cvt_pk_bf16_f32 v71, v54, v55
  v_cvt_pk_bf16_f32 v74, v60, v61
  v_cvt_pk_bf16_f32 v75, v62, v63
  v_permlane16_swap_b32 v64, v66
  v_permlane16_swap_b32 v65, v67
  v_permlane16_swap_b32 v68, v70
  v_permlane16_swap_b32 v69, v71
  v_permlane16_swap_b32 v72, v74
  v_permlane16_swap_b32 v73, v75
  buffer_store_dwordx4 v[64:67], v8, s[8:11], s55 offen sc1
  buffer_store_dwordx4 v[68:71], v8, s[8:11], s56 offen sc1
  buffer_store_dwordx4 v[72:75], v8, s[8:11], s57 offen sc1
  v_mov_b32 v10, s52
  s_waitcnt vmcnt(0) lgkmcnt(0)
  s_barrier
  buffer_store_dword v10, v9, s[8:11], 0 offen sc1
  s_branch pj_done
pj_slow:
  s_cmp_ge_u32 s68, s69
  s_cbranch_scc1 wf_done_6
  s_mov_b32 s50, 0
wf_loop_7:
  buffer_load_dword v11, v14, s[8:11], 0 offen sc1
  s_add_u32 s50, s50, 1
  s_cmp_gt_u32 s50, 131072
  s_cbranch_scc1 L_fail
  s_waitcnt vmcnt(0)
  v_readfirstlane_b32 s68, v11
  s_nop 0
  s_cmp_ge_u32 s68, s69
  s_cbranch_scc1 wf_done_6
  s_sleep 2
  s_branch wf_loop_7
wf_done_6:
  s_branch pj_back
pj_eager:
  s_waitcnt vmcnt(0)
  s_barrier
  buffer_store_dword v10, v9, s[8:11], 0 offen sc1
  s_branch pj_eback
pj_warm:
  s_lshl_b32 s46, s44, 2
  s_add_u32 s46, s46, s43
  s_sub_u32 s46, s46, 4
  s_lshl_b32 s46, s46, 2
  s_add_u32 s46, s46, s42
  s_lshl_b32 s46, s46, 13
  v_lshlrev_b32 v11, 7, v0
  s_mov_b32 s4, s16
  s_mov_b32 s5, s17
  s_mov_b32 s6, 2621440
  s_mov_b32 s7, 0x20000
  buffer_load_dword v12, v11, s[4:7], s46 offen
  s_mov_b32 s4, s18
  s_mov_b32 s5, s19
  s_mov_b32 s6, 2457600
  s_mov_b32 s7, 0x20000
  buffer_load_dword v12, v11, s[4:7], s46 offen
  s_mov_b32 s4, s20
  s_mov_b32 s5, s21
  s_mov_b32 s6, 819200
  s_mov_b32 s7, 0x20000
  buffer_load_dword v12, v11, s[4:7], s46 offen
  s_branch pj_wback
pj_done:
  s_branch L_parta
L_uw:
  s_mov_b32 s4, s32
  s_mov_b32 s5, s33
  s_mov_b32 s6, 7864320
  s_mov_b32 s7, 0x20000
  v_lshrrev_b32 v8, 3, v0
  v_lshrrev_b32 v9, 2, v8
  v_lshlrev_b32 v9, 3, v9
  v_and_b32 v1, 3, v8
  v_add_u32 v1, v1, v9
  s_and_b32 s46, s42, 1
  s_lshl_b32 s46, s46, 2
  s_lshr_b32 s47, s42, 1
  s_lshl_b32 s47, s47, 4
  s_add_u32 s46, s46, s47
  v_add_u32 v1, s46, v1
  v_mul_u32_u24 v1, 1280, v1
  v_lshrrev_b32 v8, 1, v8
  v_bfe_u32 v9, v0, 1, 2
  v_xor_b32 v8, v8, v9
  v_lshlrev_b32 v8, 5, v8
  v_and_b32 v9, 1, v0
  v_lshlrev_b32 v9, 4, v9
  v_add3_u32 v1, v1, v8, v9
  v_lshrrev_b32 v8, 5, v0
  v_lshlrev_b32 v2, 11, v8
  v_bfe_u32 v8, v0, 2, 3
  v_lshl_add_u32 v2, v8, 7, v2
  v_lshrrev_b32 v8, 1, v8
  v_xor_b32 v8, s42, v8
  v_lshl_add_u32 v2, v8, 5, v2
  v_and_b32 v8, 3, v0
  v_lshl_add_u32 v2, v8, 3, v2
  v_add_u32 v3, 0x10000, v2
  v_add_u32 v4, 0x20000, v2
  s_mul_i32 s53, s45, 245760
  v_lshlrev_b32 v5, 4, v0
  s_lshl_b32 s46, s45, 7
  s_add_u32 s47, s46, 1056768
  v_mov_b32 v6, s47
  s_lshl_b32 s47, s42, 2
  s_add_u32 s46, s46, s47
  s_add_u32 s46, s46, 1060864
  v_mov_b32 v7, s46
  v_mov_b32 v8, 2146435072
  v_cmp_eq_u32 vcc, 0, v0
  s_nop 1
  v_cndmask_b32 v7, v8, v7, vcc
  v_cndmask_b32 v6, v8, v6, vcc
  s_mov_b32 s60, s51
  s_add_u32 s61, s51, 167780352
  s_mov_b32 s62, s45
  v_mov_b32 v12, v5
  s_lshr_b32 s55, s45, 3
  s_lshl_b32 s55, s55, 14
  s_and_b32 s46, s45, 7
  s_lshl_b32 s46, s46, 10
  s_add_u32 s55, s55, s46
  s_lshl_b32 s46, s42, 16
  s_add_u32 s55, s55, s46
  s_add_u32 s55, s55, 81788928
  s_mov_b32 s52, 0
  s_mov_b32 s56, 0
  s_add_u32 m0, s51, 0
  s_add_u32 s46, s53, 0
  buffer_load_dwordx4 v1, s[4:7], s46 offen  lds
  s_add_u32 m0, s51, 4096
  s_add_u32 s46, s53, 128
  buffer_load_dwordx4 v1, s[4:7], s46 offen  lds
  s_add_u32 m0, s51, 8192
  s_add_u32 s46, s53, 256
  buffer_load_dwordx4 v1, s[4:7], s46 offen  lds
  s_add_u32 m0, s51, 12288
  s_add_u32 s46, s53, 384
  buffer_load_dwordx4 v1, s[4:7], s46 offen  lds
  s_add_u32 m0, s51, 16384
  s_add_u32 s46, s53, 512
  buffer_load_dwordx4 v1, s[4:7], s46 offen  lds
  s_add_u32 m0, s51, 20480
  s_add_u32 s46, s53, 640
  buffer_load_dwordx4 v1, s[4:7], s46 offen  lds
  s_add_u32 m0, s51, 24576
  s_add_u32 s46, s53, 768
  buffer_load_dwordx4 v1, s[4:7], s46 offen  lds
  s_add_u32 m0, s51, 28672
  s_add_u32 s46, s53, 896
  buffer_load_dwordx4 v1, s[4:7], s46 offen  lds
  s_add_u32 m0, s51, 32768
  s_add_u32 s46, s53, 1024
  buffer_load_dwordx4 v1, s[4:7], s46 offen  lds
  s_add_u32 m0, s51, 36864
  s_add_u32 s46, s53, 1152
  buffer_load_dwordx4 v1, s[4:7], s46 offen  lds
  s_add_u32 m0, s51, 40960
  s_add_u32 s46, s53, 40960
  buffer_load_dwordx4 v1, s[4:7], s46 offen  lds
  s_add_u32 m0, s51, 45056
  s_add_u32 s46, s53, 41088
  buffer_load_dwordx4 v1, s[4:7], s46 offen  lds
  s_add_u32 m0, s51, 49152
  s_add_u32 s46, s53, 41216
  buffer_load_dwordx4 v1, s[4:7], s46 offen  lds
  s_add_u32 m0, s51, 53248
  s_add_u32 s46, s53, 41344
  buffer_load_dwordx4 v1, s[4:7], s46 offen  lds
  s_add_u32 m0, s51, 57344
  s_add_u32 s46, s53, 41472
  buffer_load_dwordx4 v1, s[4:7], s46 offen  lds
  s_add_u32 m0, s51, 61440
  s_add_u32 s46, s53, 41600
  buffer_load_dwordx4 v1, s[4:7], s46 offen  lds
  s_add_u32 m0, s51, 65536
  s_add_u32 s46, s53, 41728
  buffer_load_dwordx4 v1, s[4:7], s46 offen  lds
  s_add_u32 m0, s51, 69632
  s_add_u32 s46, s53, 41856
  buffer_load_dwordx4 v1, s[4:7], s46 offen  lds
  s_add_u32 m0, s51, 73728
  s_add_u32 s46, s53, 41984
  buffer_load_dwordx4 v1, s[4:7], s46 offen  lds
  s_add_u32 m0, s51, 77824
  s_add_u32 s46, s53, 42112
  buffer_load_dwordx4 v1, s[4:7], s46 offen  lds
  s_add_u32 m0, s51, 81920
  s_add_u32 s46, s53, 81920
  buffer_load_dwordx4 v1, s[4:7], s46 offen  lds
  s_add_u32 m0, s51, 86016
  s_add_u32 s46, s53, 82048
  buffer_load_dwordx4 v1, s[4:7], s46 offen  lds
  s_add_u32 m0, s51, 90112
  s_add_u32 s46, s53, 82176
  buffer_load_dwordx4 v1, s[4:7], s46 offen  lds
  s_add_u32 m0, s51, 94208
  s_add_u32 s46, s53, 82304
  buffer_load_dwordx4 v1, s[4:7], s46 offen  lds
  s_add_u32 m0, s51, 98304
  s_add_u32 s46, s53, 82432
  buffer_load_dwordx4 v1, s[4:7], s46 offen  lds
  s_add_u32 m0, s51, 102400
  s_add_u32 s46, s53, 82560
  buffer_load_dwordx4 v1, s[4:7], s46 offen  lds
  s_add_u32 m0, s51, 106496
  s_add_u32 s46, s53, 82688
  buffer_load_dwordx4 v1, s[4:7], s46 offen  lds
  s_add_u32 m0, s51, 110592
  s_add_u32 s46, s53, 82816
  buffer_load_dwordx4 v1, s[4:7], s46 offen  lds
  s_add_u32 m0, s51, 114688
  s_add_u32 s46, s53, 82944
  buffer_load_dwordx4 v1, s[4:7], s46 offen  lds
  s_add_u32 m0, s51, 118784
  s_add_u32 s46, s53, 83072
  buffer_load_dwordx4 v1, s[4:7], s46 offen  lds
  s_waitcnt vmcnt(24)
  s_barrier
  s_add_u32 m0, s51, 122880
  s_add_u32 s46, s53, 122880
  buffer_load_dwordx4 v1, s[4:7], s46 offen  lds
  s_add_u32 m0, s51, 126976
  s_add_u32 s46, s53, 123008
  buffer_load_dwordx4 v1, s[4:7], s46 offen  lds
  s_add_u32 m0, s51, 131072
  s_add_u32 s46, s53, 123136
  buffer_load_dwordx4 v1, s[4:7], s46 offen  lds
  s_add_u32 m0, s51, 135168
  s_add_u32 s46, s53, 123264
  buffer_load_dwordx4 v1, s[4:7], s46 offen  lds
  s_add_u32 m0, s51, 139264
  s_add_u32 s46, s53, 123392
  buffer_load_dwordx4 v1, s[4:7], s46 offen  lds
  s_add_u32 m0, s51, 143360
  s_add_u32 s46, s53, 123520
  buffer_load_dwordx4 v1, s[4:7], s46 offen  lds
  ds_read_b64_tr_b16 a[0:1], v2 offset:0
  ds_read_b64_tr_b16 a[2:3], v2 offset:1024
  ds_read_b64_tr_b16 a[24:25], v2 offset:4096
  ds_read_b64_tr_b16 a[26:27], v2 offset:5120
  ds_read_b64_tr_b16 a[48:49], v2 offset:8192
  ds_read_b64_tr_b16 a[50:51], v2 offset:9216
  ds_read_b64_tr_b16 a[72:73], v2 offset:12288
  ds_read_b64_tr_b16 a[74:75], v2 offset:13312
  ds_read_b64_tr_b16 a[96:97], v2 offset:16384
  ds_read_b64_tr_b16 a[98:99], v2 offset:17408
  ds_read_b64_tr_b16 a[120:121], v2 offset:20480
  ds_read_b64_tr_b16 a[122:123], v2 offset:21504
  s_waitcnt lgkmcnt(0)
  s_waitcnt vmcnt(24)
  s_barrier
  s_add_u32 m0, s51, 0
  s_add_u32 s46, s53, 123648
  buffer_load_dwordx4 v1, s[4:7], s46 offen  lds
  s_add_u32 m0, s51, 4096
  s_add_u32 s46, s53, 123776
  buffer_load_dwordx4 v1, s[4:7], s46 offen  lds
  s_add_u32 m0, s51, 8192
  s_add_u32 s46, s53, 123904
  buffer_load_dwordx4 v1, s[4:7], s46 offen  lds
  s_add_u32 m0, s51, 12288
  s_add_u32 s46, s53, 124032
  buffer_load_dwordx4 v1, s[4:7], s46 offen  lds
  s_add_u32 m0, s51, 16384
  s_add_u32 s46, s53, 163840
  buffer_load_dwordx4 v1, s[4:7], s46 offen  lds
  s_add_u32 m0, s51, 20480
  s_add_u32 s46, s53, 163968
  buffer_load_dwordx4 v1, s[4:7], s46 offen  lds
  ds_read_b64_tr_b16 a[144:145], v2 offset:24576
  ds_read_b64_tr_b16 a[146:147], v2 offset:25600
  ds_read_b64_tr_b16 a[168:169], v2 offset:28672
  ds_read_b64_tr_b16 a[170:171], v2 offset:29696
  ds_read_b64_tr_b16 a[192:193], v2 offset:32768
  ds_read_b64_tr_b16 a[194:195], v2 offset:33792
  ds_read_b64_tr_b16 a[216:217], v2 offset:36864
  ds_read_b64_tr_b16 a[218:219], v2 offset:37888
  ds_read_b64_tr_b16 a[4:5], v2 offset:40960
  ds_read_b64_tr_b16 a[6:7], v2 offset:41984
  ds_read_b64_tr_b16 a[28:29], v2 offset:45056
  ds_read_b64_tr_b16 a[30:31], v2 offset:46080
  s_waitcnt lgkmcnt(0)
  s_waitcnt vmcnt(24)
  s_barrier
  s_add_u32 m0, s51, 24576
  s_add_u32 s46, s53, 164096
  buffer_load_dwordx4 v1, s[4:7], s46 offen  lds
  s_add_u32 m0, s51, 28672
  s_add_u32 s46, s53, 164224
  buffer_load_dwordx4 v1, s[4:7], s46 offen  lds
  s_add_u32 m0, s51, 32768
  s_add_u32 s46, s53, 164352
  buffer_load_dwordx4 v1, s[4:7], s46 offen  lds
  s_add_u32 m0, s51, 36864
  s_add_u32 s46, s53, 164480
  buffer_load_dwordx4 v1, s[4:7], s46 offen  lds
  s_add_u32 m0, s51, 40960
  s_add_u32 s46, s53, 164608
  buffer_load_dwordx4 v1, s[4:7], s46 offen  lds
  s_add_u32 m0, s51, 45056
  s_add_u32 s46, s53, 164736
  buffer_load_dwordx4 v1, s[4:7], s46 offen  lds
  ds_read_b64_tr_b16 a[52:53], v2 offset:49152
  ds_read_b64_tr_b16 a[54:55], v2 offset:50176
  ds_read_b64_tr_b16 a[76:77], v2 offset:53248
  ds_read_b64_tr_b16 a[78:79], v2 offset:54272
  ds_read_b64_tr_b16 a[100:101], v2 offset:57344
  ds_read_b64_tr_b16 a[102:103], v2 offset:58368
  ds_read_b64_tr_b16 a[124:125], v2 offset:61440
  ds_read_b64_tr_b16 a[126:127], v2 offset:62464
  ds_read_b64_tr_b16 a[148:149], v3 offset:0
  ds_read_b64_tr_b16 a[150:151], v3 offset:1024
  ds_read_b64_tr_b16 a[172:173], v3 offset:4096
  ds_read_b64_tr_b16 a[174:175], v3 offset:5120
  s_waitcnt lgkmcnt(0)
  s_waitcnt vmcnt(24)
  s_barrier
  s_add_u32 m0, s51, 49152
  s_add_u32 s46, s53, 164864
  buffer_load_dwordx4 v1, s[4:7], s46 offen  lds
  s_add_u32 m0, s51, 53248
  s_add_u32 s46, s53, 164992
  buffer_load_dwordx4 v1, s[4:7], s46 offen  lds
  s_add_u32 m0, s51, 57344
  s_add_u32 s46, s53, 204800
  buffer_load_dwordx4 v1, s[4:7], s46 offen  lds
  s_add_u32 m0, s51, 61440
  s_add_u32 s46, s53, 204928
  buffer_load_dwordx4 v1, s[4:7], s46 offen  lds
  s_add_u32 m0, s51, 65536
  s_add_u32 s46, s53, 205056
  buffer_load_dwordx4 v1, s[4:7], s46 offen  lds
  s_add_u32 m0, s51, 69632
  s_add_u32 s46, s53, 205184
  buffer_load_dwordx4 v1, s[4:7], s46 offen  lds
  ds_read_b64_tr_b16 a[196:197], v3 offset:8192
  ds_read_b64_tr_b16 a[198:199], v3 offset:9216
  ds_read_b64_tr_b16 a[220:221], v3 offset:12288
  ds_read_b64_tr_b16 a[222:223], v3 offset:13312
  ds_read_b64_tr_b16 a[8:9], v3 offset:16384
  ds_read_b64_tr_b16 a[10:11], v3 offset:17408
  ds_read_b64_tr_b16 a[32:33], v3 offset:20480
  ds_read_b64_tr_b16 a[34:35], v3 offset:21504
  ds_read_b64_tr_b16 a[56:57], v3 offset:24576
  ds_read_b64_tr_b16 a[58:59], v3 offset:25600
  ds_read_b64_tr_b16 a[80:81], v3 offset:28672
  ds_read_b64_tr_b16 a[82:83], v3 offset:29696
  s_waitcnt lgkmcnt(0)
  s_waitcnt vmcnt(24)
  s_barrier
  v_and_b32 v9, 3, v0
  v_lshlrev_b32 v9, 2, v9
  global_load_dword v8, v9, s[38:39] sc1
  s_add_u32 m0, s51, 73728
  s_add_u32 s46, s53, 205312
  buffer_load_dwordx4 v1, s[4:7], s46 offen  lds
  s_add_u32 m0, s51, 77824
  s_add_u32 s46, s53, 205440
  buffer_load_dwordx4 v1, s[4:7], s46 offen  lds
  s_add_u32 m0, s51, 81920
  s_add_u32 s46, s53, 205568
  buffer_load_dwordx4 v1, s[4:7], s46 offen  lds
  s_add_u32 m0, s51, 86016
  s_add_u32 s46, s53, 205696
  buffer_load_dwordx4 v1, s[4:7], s46 offen  lds
  s_add_u32 m0, s51, 90112
  s_add_u32 s46, s53, 205824
  buffer_load_dwordx4 v1, s[4:7], s46 offen  lds
  s_add_u32 m0, s51, 94208
  s_add_u32 s46, s53, 205952
  buffer_load_dwordx4 v1, s[4:7], s46 offen  lds
  ds_read_b64_tr_b16 a[104:105], v3 offset:32768
  ds_read_b64_tr_b16 a[106:107], v3 offset:33792
  ds_read_b64_tr_b16 a[128:129], v3 offset:36864
  ds_read_b64_tr_b16 a[130:131], v3 offset:37888
  ds_read_b64_tr_b16 a[152:153], v3 offset:40960
  ds_read_b64_tr_b16 a[154:155], v3 offset:41984
  ds_read_b64_tr_b16 a[176:177], v3 offset:45056
  ds_read_b64_tr_b16 a[178:179], v3 offset:46080
  ds_read_b64_tr_b16 a[200:201], v3 offset:49152
  ds_read_b64_tr_b16 a[202:203], v3 offset:50176
  ds_read_b64_tr_b16 a[224:225], v3 offset:53248
  ds_read_b64_tr_b16 a[226:227], v3 offset:54272
  s_waitcnt lgkmcnt(0)
  s_waitcnt vmcnt(25)
  s_barrier
  ds_read_b64_tr_b16 a[12:13], v3 offset:57344
  ds_read_b64_tr_b16 a[14:15], v3 offset:58368
  ds_read_b64_tr_b16 a[36:37], v3 offset:61440
  ds_read_b64_tr_b16 a[38:39], v3 offset:62464
  ds_read_b64_tr_b16 a[60:61], v4 offset:0
  ds_read_b64_tr_b16 a[62:63], v4 offset:1024
  ds_read_b64_tr_b16 a[84:85], v4 offset:4096
  ds_read_b64_tr_b16 a[86:87], v4 offset:5120
  ds_read_b64_tr_b16 a[108:109], v4 offset:8192
  ds_read_b64_tr_b16 a[110:111], v4 offset:9216
  ds_read_b64_tr_b16 a[132:133], v4 offset:12288
  ds_read_b64_tr_b16 a[134:135], v4 offset:13312
  s_waitcnt lgkmcnt(0)
  s_waitcnt vmcnt(19)
  s_barrier
  ds_read_b64_tr_b16 a[156:157], v2 offset:0
  ds_read_b64_tr_b16 a[158:159], v2 offset:1024
  ds_read_b64_tr_b16 a[180:181], v2 offset:4096
  ds_read_b64_tr_b16 a[182:183], v2 offset:5120
  ds_read_b64_tr_b16 a[204:205], v2 offset:8192
  ds_read_b64_tr_b16 a[206:207], v2 offset:9216
  ds_read_b64_tr_b16 a[228:229], v2 offset:12288
  ds_read_b64_tr_b16 a[230:231], v2 offset:13312
  ds_read_b64_tr_b16 a[16:17], v2 offset:16384
  ds_read_b64_tr_b16 a[18:19], v2 offset:17408
  ds_read_b64_tr_b16 a[40:41], v2 offset:20480
  ds_read_b64_tr_b16 a[42:43], v2 offset:21504
  s_waitcnt lgkmcnt(0)
  s_waitcnt vmcnt(13)
  s_barrier
  ds_read_b64_tr_b16 a[64:65], v2 offset:24576
  ds_read_b64_tr_b16 a[66:67], v2 offset:25600
  ds_read_b64_tr_b16 a[88:89], v2 offset:28672
  ds_read_b64_tr_b16 a[90:91], v2 offset:29696
  ds_read_b64_tr_b16 a[112:113], v2 offset:32768
  ds_read_b64_tr_b16 a[114:115], v2 offset:33792
  ds_read_b64_tr_b16 a[136:137], v2 offset:36864
  ds_read_b64_tr_b16 a[138:139], v2 offset:37888
  ds_read_b64_tr_b16 a[160:161], v2 offset:40960
  ds_read_b64_tr_b16 a[162:163], v2 offset:41984
  ds_read_b64_tr_b16 a[184:185], v2 offset:45056
  ds_read_b64_tr_b16 a[186:187], v2 offset:46080
  s_waitcnt lgkmcnt(0)
  s_waitcnt vmcnt(7)
  s_barrier
  ds_read_b64_tr_b16 a[208:209], v2 offset:49152
  ds_read_b64_tr_b16 a[210:211], v2 offset:50176
  ds_read_b64_tr_b16 a[232:233], v2 offset:53248
  ds_read_b64_tr_b16 a[234:235], v2 offset:54272
  ds_read_b64_tr_b16 a[20:21], v2 offset:57344
  ds_read_b64_tr_b16 a[22:23], v2 offset:58368
  ds_read_b64_tr_b16 a[44:45], v2 offset:61440
  ds_read_b64_tr_b16 a[46:47], v2 offset:62464
  ds_read_b64_tr_b16 a[68:69], v3 offset:0
  ds_read_b64_tr_b16 a[70:71], v3 offset:1024
  ds_read_b64_tr_b16 a[92:93], v3 offset:4096
  ds_read_b64_tr_b16 a[94:95], v3 offset:5120
  s_waitcnt lgkmcnt(0)
  s_waitcnt vmcnt(0)
  s_barrier
  ds_read_b64_tr_b16 a[116:117], v3 offset:8192
  ds_read_b64_tr_b16 a[118:119], v3 offset:9216
  ds_read_b64_tr_b16 a[140:141], v3 offset:12288
  ds_read_b64_tr_b16 a[142:143], v3 offset:13312
  ds_read_b64_tr_b16 a[164:165], v3 offset:16384
  ds_read_b64_tr_b16 a[166:167], v3 offset:17408
  ds_read_b64_tr_b16 a[188:189], v3 offset:20480
  ds_read_b64_tr_b16 a[190:191], v3 offset:21504
  ds_read_b64_tr_b16 a[212:213], v3 offset:24576
  ds_read_b64_tr_b16 a[214:215], v3 offset:25600
  ds_read_b64_tr_b16 a[236:237], v3 offset:28672
  ds_read_b64_tr_b16 a[238:239], v3 offset:29696
  s_waitcnt lgkmcnt(0)
  s_mov_b32 s50, 0
  s_branch ss_8_in
ss_8:
  v_and_b32 v9, 3, v0
  v_lshlrev_b32 v9, 2, v9
  global_load_dword v8, v9, s[38:39] sc1
  s_add_u32 s50, s50, 1
  s_cmp_gt_u32 s50, 131072
  s_cbranch_scc1 L_fail
  s_waitcnt vmcnt(0)
ss_8_in:
  v_readlane_b32 s46, v8, 0
  v_readlane_b32 s47, v8, 2
  v_readlane_b32 s48, v8, 1
  s_nop 0
  s_min_u32 s47, s47, s48
  s_cmp_lg_u32 s46, 0
  s_cselect_b32 s48, 7, 0
  s_add_u32 s46, s46, s2
  s_xor_b32 s49, s46, s43
  s_and_b32 s49, s49, s48
  s_cbranch_scc1 L_reroll
  s_cmp_lg_u32 s47, 0
  s_cbranch_scc1 ss_ok_9
  s_sleep 6
  s_branch ss_8
ss_ok_9:
  v_readlane_b32 s3, v8, 1
  s_nop 0
  s_and_b32 s3, s3, 0x2000
  s_barrier
  s_xor_b32 s61, s61, s3
  s_xor_b32 s55, s55, s3
  s_lshr_b32 s46, s45, 3
  s_lshr_b32 s46, 1, s46
  s_and_b32 s46, s46, 1
  s_lshl_b32 s46, s46, 13
  s_xor_b32 s55, s55, s46
  s_mov_b32 s57, 1
  s_cmp_ge_u32 s56, s57
  s_cbranch_scc1 wf_done_10
  s_mov_b32 s50, 0
wf_loop_11:
  buffer_load_dword v13, v6, s[8:11], 0 offen sc1
  s_add_u32 s50, s50, 1
  s_cmp_gt_u32 s50, 131072
  s_cbranch_scc1 L_fail
  s_waitcnt vmcnt(0)
  v_readfirstlane_b32 s56, v13
  s_nop 0
  s_cmp_ge_u32 s56, s57
  s_cbranch_scc1 wf_done_10
  s_sleep 2
  s_branch wf_loop_11
wf_done_10:
  s_lshr_b32 s54, s62, 1
  s_lshl_b32 s54, s54, 14
  s_and_b32 s47, s62, 1
  s_lshl_b32 s47, s47, 12
  s_add_u32 s54, s54, s47
  s_add_u32 s54, s54, s61
  s_lshr_b32 s47, s54, 8
  s_and_b32 s47, s47, 0x2000
  s_xor_b32 s54, s54, s47
  s_add_u32 m0, s60, 0
  s_add_u32 s47, s54, 0
  buffer_load_dwordx4 v5, s[8:11], s47 offen sc1 lds
  s_add_u32 m0, s60, 4096
  s_add_u32 s47, s54, 16777216
  buffer_load_dwordx4 v5, s[8:11], s47 offen sc1 lds
  s_add_u32 m0, s60, 8192
  s_add_u32 s47, s54, 33554432
  buffer_load_dwordx4 v5, s[8:11], s47 offen sc1 lds
  s_mov_b32 s59, 2146435072
  s_waitcnt vmcnt(0)
  s_barrier
  ds_read_b128 v[16:19], v12 offset:0
  ds_read_b128 v[40:43], v12 offset:2048
  ds_read_b128 v[20:23], v12 offset:1024
  ds_read_b128 v[44:47], v12 offset:3072
  ds_read_b128 v[24:27], v12 offset:4096
  ds_read_b128 v[48:51], v12 offset:6144
  ds_read_b128 v[28:31], v12 offset:5120
  ds_read_b128 v[52:55], v12 offset:7168
  ds_read_b128 v[32:35], v12 offset:8192
  ds_read_b128 v[56:59], v12 offset:10240
  ds_read_b128 v[36:39], v12 offset:9216
  ds_read_b128 v[60:63], v12 offset:11264
u_loop:
  s_waitcnt lgkmcnt(8)
  v_mfma_f32_16x16x32_bf16 v[64:67], v[16:19], a[0:3], 0
  buffer_load_dword v13, v6, s[8:11], 0 offen sc1
  v_mfma_f32_16x16x32_bf16 v[68:71], v[40:43], a[0:3], 0
  v_mfma_f32_16x16x32_bf16 v[64:67], v[20:23], a[4:7], v[64:67]
  v_cvt_pk_bf16_f32 v84, v72, v73
  v_mfma_f32_16x16x32_bf16 v[68:71], v[44:47], a[4:7], v[68:71]
  s_waitcnt lgkmcnt(4)
  v_cvt_pk_bf16_f32 v85, v74, v75
  v_mfma_f32_16x16x32_bf16 v[64:67], v[24:27], a[8:11], v[64:67]
  v_cvt_pk_bf16_f32 v86, v76, v77
  v_mfma_f32_16x16x32_bf16 v[68:71], v[48:51], a[8:11], v[68:71]
  v_cvt_pk_bf16_f32 v87, v78, v79
  v_mfma_f32_16x16x32_bf16 v[64:67], v[28:31], a[12:15], v[64:67]
  buffer_store_dwordx4 v[84:87], v5, s[8:11], s59 offen sc1
  v_mfma_f32_16x16x32_bf16 v[68:71], v[52:55], a[12:15], v[68:71]
  s_add_u32 s58, s55, 0
  s_waitcnt lgkmcnt(0)
  v_mfma_f32_16x16x32_bf16 v[64:67], v[32:35], a[16:19], v[64:67]
  s_lshr_b32 s46, s58, 8
  v_mfma_f32_16x16x32_bf16 v[68:71], v[56:59], a[16:19], v[68:71]
  s_and_b32 s46, s46, 0x2000
  v_mfma_f32_16x16x32_bf16 v[64:67], v[36:39], a[20:23], v[64:67]
  s_xor_b32 s58, s58, s46
  v_mfma_f32_16x16x32_bf16 v[68:71], v[60:63], a[20:23], v[68:71]
  v_mfma_f32_16x16x32_bf16 v[72:75], v[16:19], a[24:27], 0
  s_add_u32 s59, s55, 2359296
  v_mfma_f32_16x16x32_bf16 v[76:79], v[40:43], a[24:27], 0
  s_lshr_b32 s46, s59, 8
  v_mfma_f32_16x16x32_bf16 v[72:75], v[20:23], a[28:31], v[72:75]
  s_and_b32 s46, s46, 0x2000
  v_cvt_pk_bf16_f32 v80, v64, v65
  v_mfma_f32_16x16x32_bf16 v[76:79], v[44:47], a[28:31], v[76:79]
  s_xor_b32 s59, s59, s46
  v_cvt_pk_bf16_f32 v81, v66, v67
  v_mfma_f32_16x16x32_bf16 v[72:75], v[24:27], a[32:35], v[72:75]
  v_cvt_pk_bf16_f32 v82, v68, v69
  v_mfma_f32_16x16x32_bf16 v[76:79], v[48:51], a[32:35], v[76:79]
  s_add_u32 s57, s52, 2
  s_min_u32 s57, s57, 64
  v_cvt_pk_bf16_f32 v83, v70, v71
  v_mfma_f32_16x16x32_bf16 v[72:75], v[28:31], a[36:39], v[72:75]
  buffer_store_dwordx4 v[80:83], v5, s[8:11], s58 offen sc1
  v_mfma_f32_16x16x32_bf16 v[76:79], v[52:55], a[36:39], v[76:79]
  s_add_u32 s58, s55, 262144
  v_mfma_f32_16x16x32_bf16 v[72:75], v[32:35], a[40:43], v[72:75]
  s_lshr_b32 s46, s58, 8
  v_mfma_f32_16x16x32_bf16 v[76:79], v[56:59], a[40:43], v[76:79]
  s_and_b32 s46, s46, 0x2000
  v_mfma_f32_16x16x32_bf16 v[72:75], v[36:39], a[44:47], v[72:75]
  s_xor_b32 s58, s58, s46
  v_mfma_f32_16x16x32_bf16 v[76:79], v[60:63], a[44:47], v[76:79]
  s_xor_b32 s60, s60, 0x4000
  v_mov_b32 v8, s52
  v_mfma_f32_16x16x32_bf16 v[64:67], v[16:19], a[48:51], 0
  s_add_u32 s62, s62, 32
  v_xor_b32 v12, 0x4000, v12
  v_mfma_f32_16x16x32_bf16 v[68:71], v[40:43], a[48:51], 0
  s_cmp_ge_u32 s62, 1024
  s_cselect_b32 s47, 1024, 0
  v_mfma_f32_16x16x32_bf16 v[64:67], v[20:23], a[52:55], v[64:67]
  s_sub_u32 s62, s62, s47
  v_cvt_pk_bf16_f32 v84, v72, v73
  v_mfma_f32_16x16x32_bf16 v[68:71], v[44:47], a[52:55], v[68:71]
  s_lshr_b32 s54, s62, 1
  v_cvt_pk_bf16_f32 v85, v74, v75
  v_mfma_f32_16x16x32_bf16 v[64:67], v[24:27], a[56:59], v[64:67]
  s_lshl_b32 s54, s54, 14
  v_cvt_pk_bf16_f32 v86, v76, v77
  v_mfma_f32_16x16x32_bf16 v[68:71], v[48:51], a[56:59], v[68:71]
  s_and_b32 s47, s62, 1
  v_cvt_pk_bf16_f32 v87, v78, v79
  v_mfma_f32_16x16x32_bf16 v[64:67], v[28:31], a[60:63], v[64:67]
  buffer_store_dwordx4 v[84:87], v5, s[8:11], s58 offen sc1
  s_lshl_b32 s47, s47, 12
  v_mfma_f32_16x16x32_bf16 v[68:71], v[52:55], a[60:63], v[68:71]
  s_add_u32 s58, s55, 524288
  s_add_u32 s54, s54, s47
  v_mfma_f32_16x16x32_bf16 v[64:67], v[32:35], a[64:67], v[64:67]
  s_lshr_b32 s46, s58, 8
  s_add_u32 s54, s54, s61
  v_mfma_f32_16x16x32_bf16 v[68:71], v[56:59], a[64:67], v[68:71]
  s_and_b32 s46, s46, 0x2000
  s_lshr_b32 s47, s54, 8
  v_mfma_f32_16x16x32_bf16 v[64:67], v[36:39], a[68:71], v[64:67]
  s_xor_b32 s58, s58, s46
  s_and_b32 s47, s47, 0x2000
  v_mfma_f32_16x16x32_bf16 v[68:71], v[60:63], a[68:71], v[68:71]
  s_xor_b32 s54, s54, s47
  v_mfma_f32_16x16x32_bf16 v[72:75], v[16:19], a[72:75], 0
  v_mfma_f32_16x16x32_bf16 v[76:79], v[40:43], a[72:75], 0
  v_mfma_f32_16x16x32_bf16 v[72:75], v[20:23], a[76:79], v[72:75]
  v_cvt_pk_bf16_f32 v80, v64, v65
  v_mfma_f32_16x16x32_bf16 v[76:79], v[44:47], a[76:79], v[76:79]
  v_cvt_pk_bf16_f32 v81, v66, v67
  v_mfma_f32_16x16x32_bf16 v[72:75], v[24:27], a[80:83], v[72:75]
  v_cvt_pk_bf16_f32 v82, v68, v69
  v_mfma_f32_16x16x32_bf16 v[76:79], v[48:51], a[80:83], v[76:79]
  v_cvt_pk_bf16_f32 v83, v70, v71
  v_mfma_f32_16x16x32_bf16 v[72:75], v[28:31], a[84:87], v[72:75]
  buffer_store_dwordx4 v[80:83], v5, s[8:11], s58 offen sc1
  v_mfma_f32_16x16x32_bf16 v[76:79], v[52:55], a[84:87], v[76:79]
  s_add_u32 s58, s55, 786432
  v_mfma_f32_16x16x32_bf16 v[72:75], v[32:35], a[88:91], v[72:75]
  s_lshr_b32 s46, s58, 8
  v_mfma_f32_16x16x32_bf16 v[76:79], v[56:59], a[88:91], v[76:79]
  s_and_b32 s46, s46, 0x2000
  v_mfma_f32_16x16x32_bf16 v[72:75], v[36:39], a[92:95], v[72:75]
  s_xor_b32 s58, s58, s46
  s_waitcnt vmcnt(3)
  v_readfirstlane_b32 s56, v13
  v_mfma_f32_16x16x32_bf16 v[76:79], v[60:63], a[92:95], v[76:79]
  buffer_store_dword v8, v7, s[8:11], 0 offen sc1
  v_mfma_f32_16x16x32_bf16 v[64:67], v[16:19], a[96:99], 0
  s_cmp_lt_u32 s56, s57
  s_cbranch_scc1 u_slow
u_back:
  v_mfma_f32_16x16x32_bf16 v[68:71], v[40:43], a[96:99], 0
  s_add_u32 m0, s60, 0
  s_add_u32 s47, s54, 0
  buffer_load_dwordx4 v5, s[8:11], s47 offen sc1 lds
  v_mfma_f32_16x16x32_bf16 v[64:67], v[20:23], a[100:103], v[64:67]
  s_add_u32 m0, s60, 4096
  s_add_u32 s47, s54, 16777216
  buffer_load_dwordx4 v5, s[8:11], s47 offen sc1 lds
  v_cvt_pk_bf16_f32 v84, v72, v73
  v_mfma_f32_16x16x32_bf16 v[68:71], v[44:47], a[100:103], v[68:71]
  s_add_u32 m0, s60, 8192
  s_add_u32 s47, s54, 33554432
  buffer_load_dwordx4 v5, s[8:11], s47 offen sc1 lds
  v_cvt_pk_bf16_f32 v85, v74, v75
  v_mfma_f32_16x16x32_bf16 v[64:67], v[24:27], a[104:107], v[64:67]
  v_cvt_pk_bf16_f32 v86, v76, v77
  v_mfma_f32_16x16x32_bf16 v[68:71], v[48:51], a[104:107], v[68:71]
  v_cvt_pk_bf16_f32 v87, v78, v79
  v_mfma_f32_16x16x32_bf16 v[64:67], v[28:31], a[108:111], v[64:67]
  buffer_store_dwordx4 v[84:87], v5, s[8:11], s58 offen sc1
  v_mfma_f32_16x16x32_bf16 v[68:71], v[52:55], a[108:111], v[68:71]
  s_add_u32 s58, s55, 1048576
  v_mfma_f32_16x16x32_bf16 v[64:67], v[32:35], a[112:115], v[64:67]
  s_lshr_b32 s46, s58, 8
  v_mfma_f32_16x16x32_bf16 v[68:71], v[56:59], a[112:115], v[68:71]
  s_and_b32 s46, s46, 0x2000
  v_mfma_f32_16x16x32_bf16 v[64:67], v[36:39], a[116:119], v[64:67]
  s_xor_b32 s58, s58, s46
  v_mfma_f32_16x16x32_bf16 v[68:71], v[60:63], a[116:119], v[68:71]
  v_mfma_f32_16x16x32_bf16 v[72:75], v[16:19], a[120:123], 0
  v_mfma_f32_16x16x32_bf16 v[76:79], v[40:43], a[120:123], 0
  v_mfma_f32_16x16x32_bf16 v[72:75], v[20:23], a[124:127], v[72:75]
  v_cvt_pk_bf16_f32 v80, v64, v65
  v_mfma_f32_16x16x32_bf16 v[76:79], v[44:47], a[124:127], v[76:79]
  v_cvt_pk_bf16_f32 v81, v66, v67
  v_mfma_f32_16x16x32_bf16 v[72:75], v[24:27], a[128:131], v[72:75]
  v_cvt_pk_bf16_f32 v82, v68, v69
  v_mfma_f32_16x16x32_bf16 v[76:79], v[48:51], a[128:131], v[76:79]
  v_cvt_pk_bf16_f32 v83, v70, v71
  v_mfma_f32_16x16x32_bf16 v[72:75], v[28:31], a[132:135], v[72:75]
  buffer_store_dwordx4 v[80:83], v5, s[8:11], s58 offen sc1
  v_mfma_f32_16x16x32_bf16 v[76:79], v[52:55], a[132:135], v[76:79]
  s_add_u32 s58, s55, 1310720
  v_mfma_f32_16x16x32_bf16 v[72:75], v[32:35], a[136:139], v[72:75]
  s_lshr_b32 s46, s58, 8
  v_mfma_f32_16x16x32_bf16 v[76:79], v[56:59], a[136:139], v[76:79]
  s_and_b32 s46, s46, 0x2000
  v_mfma_f32_16x16x32_bf16 v[72:75], v[36:39], a[140:143], v[72:75]
  s_xor_b32 s58, s58, s46
  v_mfma_f32_16x16x32_bf16 v[76:79], v[60:63], a[140:143], v[76:79]
  v_mfma_f32_16x16x32_bf16 v[64:67], v[16:19], a[144:147], 0
  v_mfma_f32_16x16x32_bf16 v[68:71], v[40:43], a[144:147], 0
  v_mfma_f32_16x16x32_bf16 v[64:67], v[20:23], a[148:151], v[64:67]
  v_cvt_pk_bf16_f32 v84, v72, v73
  v_mfma_f32_16x16x32_bf16 v[68:71], v[44:47], a[148:151], v[68:71]
  v_cvt_pk_bf16_f32 v85, v74, v75
  v_mfma_f32_16x16x32_bf16 v[64:67], v[24:27], a[152:155], v[64:67]
  v_cvt_pk_bf16_f32 v86, v76, v77
  v_mfma_f32_16x16x32_bf16 v[68:71], v[48:51], a[152:155], v[68:71]
  v_cvt_pk_bf16_f32 v87, v78, v79
  v_mfma_f32_16x16x32_bf16 v[64:67], v[28:31], a[156:159], v[64:67]
  buffer_store_dwordx4 v[84:87], v5, s[8:11], s58 offen sc1
  v_mfma_f32_16x16x32_bf16 v[68:71], v[52:55], a[156:159], v[68:71]
  s_add_u32 s58, s55, 1572864
  v_mfma_f32_16x16x32_bf16 v[64:67], v[32:35], a[160:163], v[64:67]
  s_lshr_b32 s46, s58, 8
  v_mfma_f32_16x16x32_bf16 v[68:71], v[56:59], a[160:163], v[68:71]
  s_and_b32 s46, s46, 0x2000
  v_mfma_f32_16x16x32_bf16 v[64:67], v[36:39], a[164:167], v[64:67]
  s_xor_b32 s58, s58, s46
  v_mfma_f32_16x16x32_bf16 v[68:71], v[60:63], a[164:167], v[68:71]
  v_mfma_f32_16x16x32_bf16 v[72:75], v[16:19], a[168:171], 0
  v_mfma_f32_16x16x32_bf16 v[76:79], v[40:43], a[168:171], 0
  v_mfma_f32_16x16x32_bf16 v[72:75], v[20:23], a[172:175], v[72:75]
  v_cvt_pk_bf16_f32 v80, v64, v65
  v_mfma_f32_16x16x32_bf16 v[76:79], v[44:47], a[172:175], v[76:79]
  v_cvt_pk_bf16_f32 v81, v66, v67
  v_mfma_f32_16x16x32_bf16 v[72:75], v[24:27], a[176:179], v[72:75]
  v_cvt_pk_bf16_f32 v82, v68, v69
  v_mfma_f32_16x16x32_bf16 v[76:79], v[48:51], a[176:179], v[76:79]
  v_cvt_pk_bf16_f32 v83, v70, v71
  v_mfma_f32_16x16x32_bf16 v[72:75], v[28:31], a[180:183], v[72:75]
  buffer_store_dwordx4 v[80:83], v5, s[8:11], s58 offen sc1
  v_mfma_f32_16x16x32_bf16 v[76:79], v[52:55], a[180:183], v[76:79]
  s_add_u32 s58, s55, 1835008
  v_mfma_f32_16x16x32_bf16 v[72:75], v[32:35], a[184:187], v[72:75]
  s_lshr_b32 s46, s58, 8
  v_mfma_f32_16x16x32_bf16 v[76:79], v[56:59], a[184:187], v[76:79]
  s_and_b32 s46, s46, 0x2000
  v_mfma_f32_16x16x32_bf16 v[72:75], v[36:39], a[188:191], v[72:75]
  s_xor_b32 s58, s58, s46
  v_mfma_f32_16x16x32_bf16 v[76:79], v[60:63], a[188:191], v[76:79]
  v_mfma_f32_16x16x32_bf16 v[64:67], v[16:19], a[192:195], 0
  v_mfma_f32_16x16x32_bf16 v[68:71], v[40:43], a[192:195], 0
  v_mfma_f32_16x16x32_bf16 v[64:67], v[20:23], a[196:199], v[64:67]
  v_cvt_pk_bf16_f32 v84, v72, v73
  v_mfma_f32_16x16x32_bf16 v[68:71], v[44:47], a[196:199], v[68:71]
  v_cvt_pk_bf16_f32 v85, v74, v75
  v_mfma_f32_16x16x32_bf16 v[64:67], v[24:27], a[200:203], v[64:67]
  v_cvt_pk_bf16_f32 v86, v76, v77
  v_mfma_f32_16x16x32_bf16 v[68:71], v[48:51], a[200:203], v[68:71]
  v_cvt_pk_bf16_f32 v87, v78, v79
  v_mfma_f32_16x16x32_bf16 v[64:67], v[28:31], a[204:207], v[64:67]
  buffer_store_dwordx4 v[84:87], v5, s[8:11], s58 offen sc1
  v_mfma_f32_16x16x32_bf16 v[68:71], v[52:55], a[204:207], v[68:71]
  s_add_u32 s58, s55, 2097152
  v_mfma_f32_16x16x32_bf16 v[64:67], v[32:35], a[208:211], v[64:67]
  s_lshr_b32 s46, s58, 8
  v_mfma_f32_16x16x32_bf16 v[68:71], v[56:59], a[208:211], v[68:71]
  s_and_b32 s46, s46, 0x2000
  v_mfma_f32_16x16x32_bf16 v[64:67], v[36:39], a[212:215], v[64:67]
  s_xor_b32 s58, s58, s46
  s_waitcnt vmcnt(5)
  s_barrier
  v_mfma_f32_16x16x32_bf16 v[68:71], v[60:63], a[212:215], v[68:71]
  s_add_u32 s55, s55, 2621440
  v_mfma_f32_16x16x32_bf16 v[72:75], v[16:19], a[216:219], 0
  ds_read_b128 v[16:19], v12 offset:0
  v_mfma_f32_16x16x32_bf16 v[76:79], v[40:43], a[216:219], 0
  ds_read_b128 v[40:43], v12 offset:2048
  v_mfma_f32_16x16x32_bf16 v[72:75], v[20:23], a[220:223], v[72:75]
  ds_read_b128 v[20:23], v12 offset:1024
  v_cvt_pk_bf16_f32 v80, v64, v65
  v_mfma_f32_16x16x32_bf16 v[76:79], v[44:47], a[220:223], v[76:79]
  ds_read_b128 v[44:47], v12 offset:3072
  v_cvt_pk_bf16_f32 v81, v66, v67
  v_mfma_f32_16x16x32_bf16 v[72:75], v[24:27], a[224:227], v[72:75]
  ds_read_b128 v[24:27], v12 offset:4096
  v_cvt_pk_bf16_f32 v82, v68, v69
  v_mfma_f32_16x16x32_bf16 v[76:79], v[48:51], a[224:227], v[76:79]
  ds_read_b128 v[48:51], v12 offset:6144
  v_cvt_pk_bf16_f32 v83, v70, v71
  v_mfma_f32_16x16x32_bf16 v[72:75], v[28:31], a[228:231], v[72:75]
  buffer_store_dwordx4 v[80:83], v5, s[8:11], s58 offen sc1
  ds_read_b128 v[28:31], v12 offset:5120
  v_mfma_f32_16x16x32_bf16 v[76:79], v[52:55], a[228:231], v[76:79]
  ds_read_b128 v[52:55], v12 offset:7168
  s_cmp_ge_u32 s55, 165675008
  s_cselect_b32 s46, 83886080, 0
  v_mfma_f32_16x16x32_bf16 v[72:75], v[32:35], a[232:235], v[72:75]
  ds_read_b128 v[32:35], v12 offset:8192
  s_sub_u32 s55, s55, s46
  v_mfma_f32_16x16x32_bf16 v[76:79], v[56:59], a[232:235], v[76:79]
  ds_read_b128 v[56:59], v12 offset:10240
  s_add_u32 s52, s52, 1
  v_mfma_f32_16x16x32_bf16 v[72:75], v[36:39], a[236:239], v[72:75]
  ds_read_b128 v[36:39], v12 offset:9216
  s_cmp_lt_u32 s52, 64
  v_mfma_f32_16x16x32_bf16 v[76:79], v[60:63], a[236:239], v[76:79]
  ds_read_b128 v[60:63], v12 offset:11264
  s_cbranch_scc1 u_loop
  s_nop 2
  v_cvt_pk_bf16_f32 v84, v72, v73
  v_cvt_pk_bf16_f32 v85, v74, v75
  s_nop 0
  v_cvt_pk_bf16_f32 v86, v76, v77
  v_cvt_pk_bf16_f32 v87, v78, v79
  buffer_store_dwordx4 v[84:87], v5, s[8:11], s59 offen sc1
  v_mov_b32 v8, s52
  s_waitcnt vmcnt(0) lgkmcnt(0)
  buffer_store_dword v8, v7, s[8:11], 0 offen sc1
  s_branch u_done
u_slow:
  s_cmp_ge_u32 s56, s57
  s_cbranch_scc1 wf_done_12
  s_mov_b32 s50, 0
wf_loop_13:
  buffer_load_dword v13, v6, s[8:11], 0 offen sc1
  s_add_u32 s50, s50, 1
  s_cmp_gt_u32 s50, 131072
  s_cbranch_scc1 L_fail
  s_waitcnt vmcnt(0)
  v_readfirstlane_b32 s56, v13
  s_nop 0
  s_cmp_ge_u32 s56, s57
  s_cbranch_scc1 wf_done_12
  s_sleep 2
  s_branch wf_loop_13
wf_done_12:
  s_branch u_back
u_done:
L_parta:
  s_barrier
  s_lshl_b32 s65, s44, 2
  s_add_u32 s65, s65, s43
  s_sub_u32 s65, s65, 4
  s_cmp_ge_u32 s65, 120
  s_cbranch_scc1 pa_att
  s_mov_b32 s4, s18
  s_mov_b32 s5, s19
  s_mov_b32 s6, 2457600
  s_mov_b32 s7, 0x20000
  s_mov_b32 s12, s16
  s_mov_b32 s13, s17
  s_mov_b32 s14, 2621440
  s_mov_b32 s15, 0x20000
  s_mul_i32 s46, s65, 205
  s_lshr_b32 s46, s46, 11
  s_mul_i32 s47, s46, 10
  s_sub_u32 s47, s65, s47
  s_mul_i32 s60, s47, 384
  s_lshl_b32 s67, s47, 6
  s_mov_b32 s63, 176168960
  s_mul_i32 s61, s46, 6
  s_add_u32 s62, s61, 6
  s_mul_i32 s48, s46, 3
  s_add_u32 s49, s48, 31
  s_add_u32 s48, s48, 28
  s_min_u32 s61, s61, s48
  s_min_u32 s62, s62, s49
  s_add_u32 s67, s67, s61
  s_lshl_b32 s64, s65, 7
  s_add_u32 s64, s64, 1081344
  v_lshrrev_b32 v10, 3, v0
  v_lshrrev_b32 v11, 2, v10
  v_lshlrev_b32 v11, 3, v11
  v_and_b32 v1, 3, v10
  v_add_u32 v1, v1, v11
  s_and_b32 s46, s42, 1
  s_lshl_b32 s46, s46, 2
  s_lshr_b32 s47, s42, 1
  s_lshl_b32 s47, s47, 4
  s_add_u32 s46, s46, s47
  v_add_u32 v1, s46, v1
  v_mul_u32_u24 v1, 3840, v1
  v_lshrrev_b32 v10, 1, v10
  v_bfe_u32 v11, v0, 1, 2
  v_xor_b32 v10, v10, v11
  v_lshlrev_b32 v10, 5, v10
  v_and_b32 v11, 1, v0
  v_lshlrev_b32 v11, 4, v11
  v_add3_u32 v1, v1, v10, v11
  v_lshrrev_b32 v10, 5, v0
  v_lshlrev_b32 v2, 11, v10
  v_bfe_u32 v10, v0, 2, 3
  v_lshl_add_u32 v2, v10, 7, v2
  v_lshrrev_b32 v10, 1, v10
  v_xor_b32 v10, s42, v10
  v_lshl_add_u32 v2, v10, 5, v2
  v_and_b32 v10, 3, v0
  v_lshl_add_u32 v2, v10, 3, v2
  v_add_u32 v3, 0x10000, v2
  v_add_u32 v4, 0x20000, v2
  v_lshrrev_b32 v10, 3, v0
  s_lshl_b32 s46, s42, 3
  v_add_u32 v10, s46, v10
  v_mul_u32_u24 v5, 1280, v10
  v_bfe_u32 v10, v10, 1, 3
  v_and_b32 v11, 7, v0
  v_xor_b32 v10, v10, v11
  v_lshl_add_u32 v5, v10, 4, v5
  v_and_b32 v10, 15, v0
  v_lshlrev_b32 v6, 7, v10
  v_lshrrev_b32 v10, 1, v10
  v_lshrrev_b32 v11, 4, v0
  v_xor_b32 v10, v10, v11
  v_lshl_add_u32 v6, v10, 4, v6
  v_add_u32 v6, 122880, v6
  v_xor_b32 v7, 64, v6
  v_and_b32 v10, 15, v0
  v_lshlrev_b32 v8, 4, v10
  v_bfe_u32 v10, v0, 4, 1
  v_lshlrev_b32 v10, 11, v10
  v_lshrrev_b32 v11, 5, v0
  v_lshlrev_b32 v11, 8, v11
  v_add3_u32 v8, v8, v10, v11
  s_lshl_b32 s46, s42, 9
  v_add_u32 v8, s46, v8
  v_mov_b32 v9, s64
  v_mov_b32 v10, 2146435072
  s_cmp_eq_u32 s42, 0
  s_cselect_b64 vcc, 1, 0
  v_cndmask_b32 v9, v10, v9, vcc
  s_lshl_b32 s46, s43, 7
  s_add_u32 s46, s46, 1076736
  v_mov_b32 v14, s46
  s_mov_b32 s68, 0
  s_lshr_b32 s70, s44, 5
  s_add_u32 s70, s70, 8
  s_mov_b32 s52, s61
  s_mul_i32 s53, s52, 40960
  s_add_u32 s54, s51, 122880
  s_add_u32 m0, s54, 0
  s_nop 0
  buffer_load_dwordx4 v5, s[12:15], s53 offen offset:0 lds
  s_add_u32 m0, s54, 3968
  s_nop 0
  buffer_load_dwordx4 v5, s[12:15], s53 offen offset:128 lds
  s_add_u32 m0, s54, 7936
  s_nop 0
  buffer_load_dwordx4 v5, s[12:15], s53 offen offset:256 lds
  s_add_u32 m0, s54, 11904
  s_nop 0
  buffer_load_dwordx4 v5, s[12:15], s53 offen offset:384 lds
  s_add_u32 m0, s54, 15872
  s_nop 0
  buffer_load_dwordx4 v5, s[12:15], s53 offen offset:512 lds
  s_add_u32 m0, s54, 19840
  s_nop 0
  buffer_load_dwordx4 v5, s[12:15], s53 offen offset:640 lds
  s_add_u32 m0, s54, 23808
  s_nop 0
  buffer_load_dwordx4 v5, s[12:15], s53 offen offset:768 lds
  s_add_u32 m0, s54, 27776
  s_nop 0
  buffer_load_dwordx4 v5, s[12:15], s53 offen offset:896 lds
  s_add_u32 m0, s54, 31744
  s_nop 0
  buffer_load_dwordx4 v5, s[12:15], s53 offen offset:1024 lds
  s_add_u32 m0, s54, 35712
  s_nop 0
  buffer_load_dwordx4 v5, s[12:15], s53 offen offset:1152 lds
  s_add_u32 m0, s51, 0
  s_add_u32 s46, s60, 0
  buffer_load_dwordx4 v1, s[4:7], s46 offen  lds
  s_add_u32 m0, s51, 4096
  s_add_u32 s46, s60, 128
  buffer_load_dwordx4 v1, s[4:7], s46 offen  lds
  s_add_u32 m0, s51, 8192
  s_add_u32 s46, s60, 256
  buffer_load_dwordx4 v1, s[4:7], s46 offen  lds
  s_add_u32 m0, s51, 12288
  s_add_u32 s46, s60, 122880
  buffer_load_dwordx4 v1, s[4:7], s46 offen  lds
  s_add_u32 m0, s51, 16384
  s_add_u32 s46, s60, 123008
  buffer_load_dwordx4 v1, s[4:7], s46 offen  lds
  s_add_u32 m0, s51, 20480
  s_add_u32 s46, s60, 123136
  buffer_load_dwordx4 v1, s[4:7], s46 offen  lds
  s_add_u32 m0, s51, 24576
  s_add_u32 s46, s60, 245760
  buffer_load_dwordx4 v1, s[4:7], s46 offen  lds
  s_add_u32 m0, s51, 28672
  s_add_u32 s46, s60, 245888
  buffer_load_dwordx4 v1, s[4:7], s46 offen  lds
  s_add_u32 m0, s51, 32768
  s_add_u32 s46, s60, 246016
  buffer_load_dwordx4 v1, s[4:7], s46 offen  lds
  s_add_u32 m0, s51, 36864
  s_add_u32 s46, s60, 368640
  buffer_load_dwordx4 v1, s[4:7], s46 offen  lds
  s_add_u32 m0, s51, 40960
  s_add_u32 s46, s60, 368768
  buffer_load_dwordx4 v1, s[4:7], s46 offen  lds
  s_add_u32 m0, s51, 45056
  s_add_u32 s46, s60, 368896
  buffer_load_dwordx4 v1, s[4:7], s46 offen  lds
  s_add_u32 m0, s51, 49152
  s_add_u32 s46, s60, 491520
  buffer_load_dwordx4 v1, s[4:7], s46 offen  lds
  s_add_u32 m0, s51, 53248
  s_add_u32 s46, s60, 491648
  buffer_load_dwordx4 v1, s[4:7], s46 offen  lds
  s_add_u32 m0, s51, 57344
  s_add_u32 s46, s60, 491776
  buffer_load_dwordx4 v1, s[4:7], s46 offen  lds
  s_add_u32 m0, s51, 61440
  s_add_u32 s46, s60, 614400
  buffer_load_dwordx4 v1, s[4:7], s46 offen  lds
  s_add_u32 m0, s51, 65536
  s_add_u32 s46, s60, 614528
  buffer_load_dwordx4 v1, s[4:7], s46 offen  lds
  s_add_u32 m0, s51, 69632
  s_add_u32 s46, s60, 614656
  buffer_load_dwordx4 v1, s[4:7], s46 offen  lds
  s_add_u32 m0, s51, 73728
  s_add_u32 s46, s60, 737280
  buffer_load_dwordx4 v1, s[4:7], s46 offen  lds
  s_add_u32 m0, s51, 77824
  s_add_u32 s46, s60, 737408
  buffer_load_dwordx4 v1, s[4:7], s46 offen  lds
  s_add_u32 m0, s51, 81920
  s_add_u32 s46, s60, 737536
  buffer_load_dwordx4 v1, s[4:7], s46 offen  lds
  s_add_u32 m0, s51, 86016
  s_add_u32 s46, s60, 860160
  buffer_load_dwordx4 v1, s[4:7], s46 offen  lds
  s_add_u32 m0, s51, 90112
  s_add_u32 s46, s60, 860288
  buffer_load_dwordx4 v1, s[4:7], s46 offen  lds
  s_add_u32 m0, s51, 94208
  s_add_u32 s46, s60, 860416
  buffer_load_dwordx4 v1, s[4:7], s46 offen  lds
  s_waitcnt vmcnt(18)
  s_barrier
  s_add_u32 m0, s51, 98304
  s_add_u32 s46, s60, 983040
  buffer_load_dwordx4 v1, s[4:7], s46 offen  lds
  s_add_u32 m0, s51, 102400
  s_add_u32 s46, s60, 983168
  buffer_load_dwordx4 v1, s[4:7], s46 offen  lds
  s_add_u32 m0, s51, 106496
  s_add_u32 s46, s60, 983296
  buffer_load_dwordx4 v1, s[4:7], s46 offen  lds
  s_add_u32 m0, s51, 110592
  s_add_u32 s46, s60, 1105920
  buffer_load_dwordx4 v1, s[4:7], s46 offen  lds
  s_add_u32 m0, s51, 114688
  s_add_u32 s46, s60, 1106048
  buffer_load_dwordx4 v1, s[4:7], s46 offen  lds
  s_add_u32 m0, s51, 118784
  s_add_u32 s46, s60, 1106176
  buffer_load_dwordx4 v1, s[4:7], s46 offen  lds
  ds_read_b64_tr_b16 a[0:1], v2 offset:0
  ds_read_b64_tr_b16 a[2:3], v2 offset:1024
  ds_read_b64_tr_b16 a[4:5], v2 offset:4096
  ds_read_b64_tr_b16 a[6:7], v2 offset:5120
  ds_read_b64_tr_b16 a[8:9], v2 offset:8192
  ds_read_b64_tr_b16 a[10:11], v2 offset:9216
  ds_read_b64_tr_b16 a[12:13], v2 offset:12288
  ds_read_b64_tr_b16 a[14:15], v2 offset:13312
  ds_read_b64_tr_b16 a[16:17], v2 offset:16384
  ds_read_b64_tr_b16 a[18:19], v2 offset:17408
  ds_read_b64_tr_b16 a[20:21], v2 offset:20480
  ds_read_b64_tr_b16 a[22:23], v2 offset:21504
  s_waitcnt lgkmcnt(0)
  s_waitcnt vmcnt(18)
  s_barrier
  s_add_u32 m0, s51, 0
  s_add_u32 s46, s60, 1228800
  buffer_load_dwordx4 v1, s[4:7], s46 offen  lds
  s_add_u32 m0, s51, 4096
  s_add_u32 s46, s60, 1228928
  buffer_load_dwordx4 v1, s[4:7], s46 offen  lds
  s_add_u32 m0, s51, 8192
  s_add_u32 s46, s60, 1229056
  buffer_load_dwordx4 v1, s[4:7], s46 offen  lds
  s_add_u32 m0, s51, 12288
  s_add_u32 s46, s60, 1351680
  buffer_load_dwordx4 v1, s[4:7], s46 offen  lds
  s_add_u32 m0, s51, 16384
  s_add_u32 s46, s60, 1351808
  buffer_load_dwordx4 v1, s[4:7], s46 offen  lds
  s_add_u32 m0, s51, 20480
  s_add_u32 s46, s60, 1351936
  buffer_load_dwordx4 v1, s[4:7], s46 offen  lds
  ds_read_b64_tr_b16 a[24:25], v2 offset:24576
  ds_read_b64_tr_b16 a[26:27], v2 offset:25600
  ds_read_b64_tr_b16 a[28:29], v2 offset:28672
  ds_read_b64_tr_b16 a[30:31], v2 offset:29696
  ds_read_b64_tr_b16 a[32:33], v2 offset:32768
  ds_read_b64_tr_b16 a[34:35], v2 offset:33792
  ds_read_b64_tr_b16 a[36:37], v2 offset:36864
  ds_read_b64_tr_b16 a[38:39], v2 offset:37888
  ds_read_b64_tr_b16 a[40:41], v2 offset:40960
  ds_read_b64_tr_b16 a[42:43], v2 offset:41984
  ds_read_b64_tr_b16 a[44:45], v2 offset:45056
  ds_read_b64_tr_b16 a[46:47], v2 offset:46080
  s_waitcnt lgkmcnt(0)
  s_waitcnt vmcnt(18)
  s_barrier
  s_add_u32 m0, s51, 24576
  s_add_u32 s46, s60, 1474560
  buffer_load_dwordx4 v1, s[4:7], s46 offen  lds
  s_add_u32 m0, s51, 28672
  s_add_u32 s46, s60, 1474688
  buffer_load_dwordx4 v1, s[4:7], s46 offen  lds
  s_add_u32 m0, s51, 32768
  s_add_u32 s46, s60, 1474816
  buffer_load_dwordx4 v1, s[4:7], s46 offen  lds
  s_add_u32 m0, s51, 36864
  s_add_u32 s46, s60, 1597440
  buffer_load_dwordx4 v1, s[4:7], s46 offen  lds
  s_add_u32 m0, s51, 40960
  s_add_u32 s46, s60, 1597568
  buffer_load_dwordx4 v1, s[4:7], s46 offen  lds
  s_add_u32 m0, s51, 45056
  s_add_u32 s46, s60, 1597696
  buffer_load_dwordx4 v1, s[4:7], s46 offen  lds
  ds_read_b64_tr_b16 a[48:49], v2 offset:49152
  ds_read_b64_tr_b16 a[50:51], v2 offset:50176
  ds_read_b64_tr_b16 a[52:53], v2 offset:53248
  ds_read_b64_tr_b16 a[54:55], v2 offset:54272
  ds_read_b64_tr_b16 a[56:57], v2 offset:57344
  ds_read_b64_tr_b16 a[58:59], v2 offset:58368
  ds_read_b64_tr_b16 a[60:61], v2 offset:61440
  ds_read_b64_tr_b16 a[62:63], v2 offset:62464
  ds_read_b64_tr_b16 a[64:65], v3 offset:0
  ds_read_b64_tr_b16 a[66:67], v3 offset:1024
  ds_read_b64_tr_b16 a[68:69], v3 offset:4096
  ds_read_b64_tr_b16 a[70:71], v3 offset:5120
  s_waitcnt lgkmcnt(0)
  s_waitcnt vmcnt(18)
  s_barrier
  s_add_u32 m0, s51, 49152
  s_add_u32 s46, s60, 1720320
  buffer_load_dwordx4 v1, s[4:7], s46 offen  lds
  s_add_u32 m0, s51, 53248
  s_add_u32 s46, s60, 1720448
  buffer_load_dwordx4 v1, s[4:7], s46 offen  lds
  s_add_u32 m0, s51, 57344
  s_add_u32 s46, s60, 1720576
  buffer_load_dwordx4 v1, s[4:7], s46 offen  lds
  s_add_u32 m0, s51, 61440
  s_add_u32 s46, s60, 1843200
  buffer_load_dwordx4 v1, s[4:7], s46 offen  lds
  s_add_u32 m0, s51, 65536
  s_add_u32 s46, s60, 1843328
  buffer_load_dwordx4 v1, s[4:7], s46 offen  lds
  s_add_u32 m0, s51, 69632
  s_add_u32 s46, s60, 1843456
  buffer_load_dwordx4 v1, s[4:7], s46 offen  lds
  ds_read_b64_tr_b16 a[72:73], v3 offset:8192
  ds_read_b64_tr_b16 a[74:75], v3 offset:9216
  ds_read_b64_tr_b16 a[76:77], v3 offset:12288
  ds_read_b64_tr_b16 a[78:79], v3 offset:13312
  ds_read_b64_tr_b16 a[80:81], v3 offset:16384
  ds_read_b64_tr_b16 a[82:83], v3 offset:17408
  ds_read_b64_tr_b16 a[84:85], v3 offset:20480
  ds_read_b64_tr_b16 a[86:87], v3 offset:21504
  ds_read_b64_tr_b16 a[88:89], v3 offset:24576
  ds_read_b64_tr_b16 a[90:91], v3 offset:25600
  ds_read_b64_tr_b16 a[92:93], v3 offset:28672
  ds_read_b64_tr_b16 a[94:95], v3 offset:29696
  s_waitcnt lgkmcnt(0)
  s_waitcnt vmcnt(18)
  s_barrier
  s_add_u32 m0, s51, 73728
  s_add_u32 s46, s60, 1966080
  buffer_load_dwordx4 v1, s[4:7], s46 offen  lds
  s_add_u32 m0, s51, 77824
  s_add_u32 s46, s60, 1966208
  buffer_load_dwordx4 v1, s[4:7], s46 offen  lds
  s_add_u32 m0, s51, 81920
  s_add_u32 s46, s60, 1966336
  buffer_load_dwordx4 v1, s[4:7], s46 offen  lds
  s_add_u32 m0, s51, 86016
  s_add_u32 s46, s60, 2088960
  buffer_load_dwordx4 v1, s[4:7], s46 offen  lds
  s_add_u32 m0, s51, 90112
  s_add_u32 s46, s60, 2089088
  buffer_load_dwordx4 v1, s[4:7], s46 offen  lds
  s_add_u32 m0, s51, 94208
  s_add_u32 s46, s60, 2089216
  buffer_load_dwordx4 v1, s[4:7], s46 offen  lds
  ds_read_b64_tr_b16 a[96:97], v3 offset:32768
  ds_read_b64_tr_b16 a[98:99], v3 offset:33792
  ds_read_b64_tr_b16 a[100:101], v3 offset:36864
  ds_read_b64_tr_b16 a[102:103], v3 offset:37888
  ds_read_b64_tr_b16 a[104:105], v3 offset:40960
  ds_read_b64_tr_b16 a[106:107], v3 offset:41984
  ds_read_b64_tr_b16 a[108:109], v3 offset:45056
  ds_read_b64_tr_b16 a[110:111], v3 offset:46080
  ds_read_b64_tr_b16 a[112:113], v3 offset:49152
  ds_read_b64_tr_b16 a[114:115], v3 offset:50176
  ds_read_b64_tr_b16 a[116:117], v3 offset:53248
  ds_read_b64_tr_b16 a[118:119], v3 offset:54272
  s_waitcnt lgkmcnt(0)
  s_waitcnt vmcnt(18)
  s_barrier
  s_add_u32 m0, s51, 98304
  s_add_u32 s46, s60, 2211840
  buffer_load_dwordx4 v1, s[4:7], s46 offen  lds
  s_add_u32 m0, s51, 102400
  s_add_u32 s46, s60, 2211968
  buffer_load_dwordx4 v1, s[4:7], s46 offen  lds
  s_add_u32 m0, s51, 106496
  s_add_u32 s46, s60, 2212096
  buffer_load_dwordx4 v1, s[4:7], s46 offen  lds
  s_add_u32 m0, s51, 110592
  s_add_u32 s46, s60, 2334720
  buffer_load_dwordx4 v1, s[4:7], s46 offen  lds
  s_add_u32 m0, s51, 114688
  s_add_u32 s46, s60, 2334848
  buffer_load_dwordx4 v1, s[4:7], s46 offen  lds
  s_add_u32 m0, s51, 118784
  s_add_u32 s46, s60, 2334976
  buffer_load_dwordx4 v1, s[4:7], s46 offen  lds
  ds_read_b64_tr_b16 a[120:121], v2 offset:0
  ds_read_b64_tr_b16 a[122:123], v2 offset:1024
  ds_read_b64_tr_b16 a[124:125], v2 offset:4096
  ds_read_b64_tr_b16 a[126:127], v2 offset:5120
  ds_read_b64_tr_b16 a[128:129], v2 offset:8192
  ds_read_b64_tr_b16 a[130:131], v2 offset:9216
  ds_read_b64_tr_b16 a[132:133], v2 offset:12288
  ds_read_b64_tr_b16 a[134:135], v2 offset:13312
  ds_read_b64_tr_b16 a[136:137], v2 offset:16384
  ds_read_b64_tr_b16 a[138:139], v2 offset:17408
  ds_read_b64_tr_b16 a[140:141], v2 offset:20480
  ds_read_b64_tr_b16 a[142:143], v2 offset:21504
  s_waitcnt lgkmcnt(0)
  s_waitcnt vmcnt(18)
  s_barrier
  ds_read_b64_tr_b16 a[144:145], v2 offset:24576
  ds_read_b64_tr_b16 a[146:147], v2 offset:25600
  ds_read_b64_tr_b16 a[148:149], v2 offset:28672
  ds_read_b64_tr_b16 a[150:151], v2 offset:29696
  ds_read_b64_tr_b16 a[152:153], v2 offset:32768
  ds_read_b64_tr_b16 a[154:155], v2 offset:33792
  ds_read_b64_tr_b16 a[156:157], v2 offset:36864
  ds_read_b64_tr_b16 a[158:159], v2 offset:37888
  ds_read_b64_tr_b16 a[160:161], v2 offset:40960
  ds_read_b64_tr_b16 a[162:163], v2 offset:41984
  ds_read_b64_tr_b16 a[164:165], v2 offset:45056
  ds_read_b64_tr_b16 a[166:167], v2 offset:46080
  s_waitcnt lgkmcnt(0)
  s_waitcnt vmcnt(12)
  s_barrier
  ds_read_b64_tr_b16 a[168:169], v2 offset:49152
  ds_read_b64_tr_b16 a[170:171], v2 offset:50176
  ds_read_b64_tr_b16 a[172:173], v2 offset:53248
  ds_read_b64_tr_b16 a[174:175], v2 offset:54272
  ds_read_b64_tr_b16 a[176:177], v2 offset:57344
  ds_read_b64_tr_b16 a[178:179], v2 offset:58368
  ds_read_b64_tr_b16 a[180:181], v2 offset:61440
  ds_read_b64_tr_b16 a[182:183], v2 offset:62464
  ds_read_b64_tr_b16 a[184:185], v3 offset:0
  ds_read_b64_tr_b16 a[186:187], v3 offset:1024
  ds_read_b64_tr_b16 a[188:189], v3 offset:4096
  ds_read_b64_tr_b16 a[190:191], v3 offset:5120
  s_waitcnt lgkmcnt(0)
  s_waitcnt vmcnt(6)
  s_barrier
  ds_read_b64_tr_b16 a[192:193], v3 offset:8192
  ds_read_b64_tr_b16 a[194:195], v3 offset:9216
  ds_read_b64_tr_b16 a[196:197], v3 offset:12288
  ds_read_b64_tr_b16 a[198:199], v3 offset:13312
  ds_read_b64_tr_b16 a[200:201], v3 offset:16384
  ds_read_b64_tr_b16 a[202:203], v3 offset:17408
  ds_read_b64_tr_b16 a[204:205], v3 offset:20480
  ds_read_b64_tr_b16 a[206:207], v3 offset:21504
  ds_read_b64_tr_b16 a[208:209], v3 offset:24576
  ds_read_b64_tr_b16 a[210:211], v3 offset:25600
  ds_read_b64_tr_b16 a[212:213], v3 offset:28672
  ds_read_b64_tr_b16 a[214:215], v3 offset:29696
  s_waitcnt lgkmcnt(0)
  s_waitcnt vmcnt(0)
  s_barrier
  ds_read_b64_tr_b16 a[216:217], v3 offset:32768
  ds_read_b64_tr_b16 a[218:219], v3 offset:33792
  ds_read_b64_tr_b16 a[220:221], v3 offset:36864
  ds_read_b64_tr_b16 a[222:223], v3 offset:37888
  ds_read_b64_tr_b16 a[224:225], v3 offset:40960
  ds_read_b64_tr_b16 a[226:227], v3 offset:41984
  ds_read_b64_tr_b16 a[228:229], v3 offset:45056
  ds_read_b64_tr_b16 a[230:231], v3 offset:46080
  ds_read_b64_tr_b16 a[232:233], v3 offset:49152
  ds_read_b64_tr_b16 a[234:235], v3 offset:50176
  ds_read_b64_tr_b16 a[236:237], v3 offset:53248
  ds_read_b64_tr_b16 a[238:239], v3 offset:54272
  s_waitcnt lgkmcnt(0)
  s_barrier
  s_mov_b32 s54, s51
  s_add_u32 s53, s53, 40960
  s_add_u32 m0, s54, 0
  s_nop 0
  buffer_load_dwordx4 v5, s[12:15], s53 offen offset:0 lds
  s_add_u32 m0, s54, 3968
  s_nop 0
  buffer_load_dwordx4 v5, s[12:15], s53 offen offset:128 lds
  s_add_u32 m0, s54, 7936
  s_nop 0
  buffer_load_dwordx4 v5, s[12:15], s53 offen offset:256 lds
  s_add_u32 m0, s54, 11904
  s_nop 0
  buffer_load_dwordx4 v5, s[12:15], s53 offen offset:384 lds
  s_add_u32 m0, s54, 15872
  s_nop 0
  buffer_load_dwordx4 v5, s[12:15], s53 offen offset:512 lds
  s_add_u32 m0, s54, 19840
  s_nop 0
  buffer_load_dwordx4 v5, s[12:15], s53 offen offset:640 lds
  s_add_u32 m0, s54, 23808
  s_nop 0
  buffer_load_dwordx4 v5, s[12:15], s53 offen offset:768 lds
  s_add_u32 m0, s54, 27776
  s_nop 0
  buffer_load_dwordx4 v5, s[12:15], s53 offen offset:896 lds
  s_add_u32 m0, s54, 31744
  s_nop 0
  buffer_load_dwordx4 v5, s[12:15], s53 offen offset:1024 lds
  s_add_u32 m0, s54, 35712
  s_nop 0
  buffer_load_dwordx4 v5, s[12:15], s53 offen offset:1152 lds
  s_mov_b32 s55, 2146435072
  s_mov_b32 s56, 2146435072
  s_mov_b32 s57, 2146435072
  s_xor_b32 s63, s63, s3
  s_mov_b32 s58, 122880
  ds_read_b128 v[16:19], v6 offset:0
  ds_read_b128 v[20:23], v7 offset:0
  ds_read_b128 v[24:27], v6 offset:4096
  ds_read_b128 v[28:31], v7 offset:4096
  s_waitcnt lgkmcnt(3)
pa_loop_14:
  v_mfma_f32_16x16x32_bf16 v[40:43], a[0:3], v[16:19], 0
  ds_read_b128 v[32:35], v6 offset:8192
  v_mfma_f32_16x16x32_bf16 v[48:51], a[4:7], v[16:19], 0
  v_mfma_f32_16x16x32_bf16 v[56:59], a[8:11], v[16:19], 0
  s_waitcnt lgkmcnt(3)
  v_cvt_pk_bf16_f32 v66, v44, v45
  v_mfma_f32_16x16x32_bf16 v[40:43], a[12:15], v[20:23], v[40:43]
  ds_read_b128 v[16:19], v7 offset:8192
  v_cvt_pk_bf16_f32 v67, v46, v47
  v_mfma_f32_16x16x32_bf16 v[48:51], a[16:19], v[20:23], v[48:51]
  v_cvt_pk_bf16_f32 v70, v52, v53
  v_mfma_f32_16x16x32_bf16 v[56:59], a[20:23], v[20:23], v[56:59]
  s_waitcnt lgkmcnt(3)
  v_cvt_pk_bf16_f32 v71, v54, v55
  v_mfma_f32_16x16x32_bf16 v[40:43], a[24:27], v[24:27], v[40:43]
  ds_read_b128 v[20:23], v6 offset:12288
  v_cvt_pk_bf16_f32 v74, v60, v61
  v_mfma_f32_16x16x32_bf16 v[48:51], a[28:31], v[24:27], v[48:51]
  v_cvt_pk_bf16_f32 v75, v62, v63
  v_mfma_f32_16x16x32_bf16 v[56:59], a[32:35], v[24:27], v[56:59]
  s_waitcnt lgkmcnt(3)
  v_mfma_f32_16x16x32_bf16 v[40:43], a[36:39], v[28:31], v[40:43]
  ds_read_b128 v[24:27], v7 offset:12288
  v_permlane16_swap_b32 v64, v66
  v_mfma_f32_16x16x32_bf16 v[48:51], a[40:43], v[28:31], v[48:51]
  v_permlane16_swap_b32 v65, v67
  v_mfma_f32_16x16x32_bf16 v[56:59], a[44:47], v[28:31], v[56:59]
  buffer_store_dwordx4 v[64:67], v8, s[8:11], s55 offen sc1
  s_waitcnt lgkmcnt(3)
  v_mfma_f32_16x16x32_bf16 v[40:43], a[48:51], v[32:35], v[40:43]
  ds_read_b128 v[28:31], v6 offset:16384
  v_permlane16_swap_b32 v68, v70
  v_mfma_f32_16x16x32_bf16 v[48:51], a[52:55], v[32:35], v[48:51]
  v_permlane16_swap_b32 v69, v71
  v_mfma_f32_16x16x32_bf16 v[56:59], a[56:59], v[32:35], v[56:59]
  buffer_store_dwordx4 v[68:71], v8, s[8:11], s56 offen sc1
  s_waitcnt lgkmcnt(3)
  v_mfma_f32_16x16x32_bf16 v[40:43], a[60:63], v[16:19], v[40:43]
  ds_read_b128 v[32:35], v7 offset:16384
  v_permlane16_swap_b32 v72, v74
  v_mfma_f32_16x16x32_bf16 v[48:51], a[64:67], v[16:19], v[48:51]
  v_permlane16_swap_b32 v73, v75
  v_mfma_f32_16x16x32_bf16 v[56:59], a[68:71], v[16:19], v[56:59]
  buffer_store_dwordx4 v[72:75], v8, s[8:11], s57 offen sc1
  s_waitcnt lgkmcnt(3)
  v_mfma_f32_16x16x32_bf16 v[40:43], a[72:75], v[20:23], v[40:43]
  ds_read_b128 v[16:19], v6 offset:20480
  v_mfma_f32_16x16x32_bf16 v[48:51], a[76:79], v[20:23], v[48:51]
  v_mfma_f32_16x16x32_bf16 v[56:59], a[80:83], v[20:23], v[56:59]
  s_waitcnt lgkmcnt(3)
  v_mfma_f32_16x16x32_bf16 v[40:43], a[84:87], v[24:27], v[40:43]
  ds_read_b128 v[20:23], v7 offset:20480
  v_mfma_f32_16x16x32_bf16 v[48:51], a[88:91], v[24:27], v[48:51]
  v_mov_b32 v10, s52
  v_mfma_f32_16x16x32_bf16 v[56:59], a[92:95], v[24:27], v[56:59]
  s_waitcnt lgkmcnt(3)
  v_mfma_f32_16x16x32_bf16 v[40:43], a[96:99], v[28:31], v[40:43]
  ds_read_b128 v[24:27], v6 offset:24576
  v_mfma_f32_16x16x32_bf16 v[48:51], a[100:103], v[28:31], v[48:51]
  s_add_u32 s53, s53, 40960
  s_add_u32 s54, s54, 40960
  v_mfma_f32_16x16x32_bf16 v[56:59], a[104:107], v[28:31], v[56:59]
  s_waitcnt lgkmcnt(3)
  v_mfma_f32_16x16x32_bf16 v[40:43], a[108:111], v[32:35], v[40:43]
  ds_read_b128 v[28:31], v7 offset:24576
  v_mfma_f32_16x16x32_bf16 v[48:51], a[112:115], v[32:35], v[48:51]
  s_cmp_ge_u32 s54, 163840
  s_cselect_b32 s54, s51, s54
  v_mfma_f32_16x16x32_bf16 v[56:59], a[116:119], v[32:35], v[56:59]
  s_waitcnt lgkmcnt(3)
  v_mfma_f32_16x16x32_bf16 v[40:43], a[120:123], v[16:19], v[40:43]
  ds_read_b128 v[32:35], v6 offset:28672
  v_mfma_f32_16x16x32_bf16 v[48:51], a[124:127], v[16:19], v[48:51]
  s_cmp_eq_u32 s58, 122880
  s_cselect_b32 s59, 163840, 0
  v_mfma_f32_16x16x32_bf16 v[56:59], a[128:131], v[16:19], v[56:59]
  s_waitcnt lgkmcnt(3)
  v_mfma_f32_16x16x32_bf16 v[40:43], a[132:135], v[20:23], v[40:43]
  ds_read_b128 v[16:19], v7 offset:28672
  v_mfma_f32_16x16x32_bf16 v[48:51], a[136:139], v[20:23], v[48:51]
  s_sub_u32 s59, 40960, s59
  s_add_u32 s58, s58, s59
  v_mfma_f32_16x16x32_bf16 v[56:59], a[140:143], v[20:23], v[56:59]
  s_waitcnt lgkmcnt(3)
  v_mfma_f32_16x16x32_bf16 v[40:43], a[144:147], v[24:27], v[40:43]
  ds_read_b128 v[20:23], v6 offset:32768
  v_mfma_f32_16x16x32_bf16 v[48:51], a[148:151], v[24:27], v[48:51]
  s_lshr_b32 s55, s67, 1
  v_mfma_f32_16x16x32_bf16 v[56:59], a[152:155], v[24:27], v[56:59]
  s_lshl_b32 s55, s55, 14
  s_waitcnt lgkmcnt(3)
  v_mfma_f32_16x16x32_bf16 v[40:43], a[156:159], v[28:31], v[40:43]
  ds_read_b128 v[24:27], v7 offset:32768
  v_mfma_f32_16x16x32_bf16 v[48:51], a[160:163], v[28:31], v[48:51]
  s_and_b32 s56, s67, 1
  v_mfma_f32_16x16x32_bf16 v[56:59], a[164:167], v[28:31], v[56:59]
  s_lshl_b32 s56, s56, 12
  s_waitcnt lgkmcnt(3)
  v_mfma_f32_16x16x32_bf16 v[40:43], a[168:171], v[32:35], v[40:43]
  ds_read_b128 v[28:31], v6 offset:36864
  v_mfma_f32_16x16x32_bf16 v[48:51], a[172:175], v[32:35], v[48:51]
  s_add_u32 s55, s55, s56
  v_mfma_f32_16x16x32_bf16 v[56:59], a[176:179], v[32:35], v[56:59]
  s_add_u32 s55, s55, s63
  s_waitcnt lgkmcnt(3)
  v_mfma_f32_16x16x32_bf16 v[40:43], a[180:183], v[16:19], v[40:43]
  ds_read_b128 v[32:35], v7 offset:36864
  v_mfma_f32_16x16x32_bf16 v[48:51], a[184:187], v[16:19], v[48:51]
  s_lshr_b32 s56, s55, 8
  v_mfma_f32_16x16x32_bf16 v[56:59], a[188:191], v[16:19], v[56:59]
  s_and_b32 s56, s56, 0x2000
  s_waitcnt lgkmcnt(3)
  v_mfma_f32_16x16x32_bf16 v[40:43], a[192:195], v[20:23], v[40:43]
  ds_read_b128 v[16:19], v6 offset:2048
  v_mfma_f32_16x16x32_bf16 v[48:51], a[196:199], v[20:23], v[48:51]
  s_xor_b32 s55, s55, s56
  v_mfma_f32_16x16x32_bf16 v[56:59], a[200:203], v[20:23], v[56:59]
  s_add_u32 s67, s67, 1
  s_waitcnt lgkmcnt(3)
  v_mfma_f32_16x16x32_bf16 v[40:43], a[204:207], v[24:27], v[40:43]
  ds_read_b128 v[20:23], v7 offset:2048
  v_mfma_f32_16x16x32_bf16 v[48:51], a[208:211], v[24:27], v[48:51]
  s_add_u32 s56, s55, 16777216
  v_mfma_f32_16x16x32_bf16 v[56:59], a[212:215], v[24:27], v[56:59]
  s_add_u32 s57, s55, 33554432
  s_waitcnt lgkmcnt(3)
  v_mfma_f32_16x16x32_bf16 v[40:43], a[216:219], v[28:31], v[40:43]
  ds_read_b128 v[24:27], v6 offset:6144
  v_mfma_f32_16x16x32_bf16 v[48:51], a[220:223], v[28:31], v[48:51]
  v_mfma_f32_16x16x32_bf16 v[56:59], a[224:227], v[28:31], v[56:59]
  s_waitcnt lgkmcnt(3)
  v_mfma_f32_16x16x32_bf16 v[40:43], a[228:231], v[32:35], v[40:43]
  ds_read_b128 v[28:31], v7 offset:6144
  v_mfma_f32_16x16x32_bf16 v[48:51], a[232:235], v[32:35], v[48:51]
  v_mfma_f32_16x16x32_bf16 v[56:59], a[236:239], v[32:35], v[56:59]
  s_waitcnt lgkmcnt(3)
  v_mfma_f32_16x16x32_bf16 v[44:47], a[0:3], v[16:19], 0
  ds_read_b128 v[32:35], v6 offset:10240
  v_mfma_f32_16x16x32_bf16 v[52:55], a[4:7], v[16:19], 0
  v_mfma_f32_16x16x32_bf16 v[60:63], a[8:11], v[16:19], 0
  s_waitcnt lgkmcnt(3)
  v_cvt_pk_bf16_f32 v64, v40, v41
  v_mfma_f32_16x16x32_bf16 v[44:47], a[12:15], v[20:23], v[44:47]
  ds_read_b128 v[16:19], v7 offset:10240
  v_cvt_pk_bf16_f32 v65, v42, v43
  v_mfma_f32_16x16x32_bf16 v[52:55], a[16:19], v[20:23], v[52:55]
  v_cvt_pk_bf16_f32 v68, v48, v49
  v_mfma_f32_16x16x32_bf16 v[60:63], a[20:23], v[20:23], v[60:63]
  s_waitcnt lgkmcnt(3)
  v_cvt_pk_bf16_f32 v69, v50, v51
  v_mfma_f32_16x16x32_bf16 v[44:47], a[24:27], v[24:27], v[44:47]
  ds_read_b128 v[20:23], v6 offset:14336
  v_cvt_pk_bf16_f32 v72, v56, v57
  v_mfma_f32_16x16x32_bf16 v[52:55], a[28:31], v[24:27], v[52:55]
  v_cvt_pk_bf16_f32 v73, v58, v59
  v_mfma_f32_16x16x32_bf16 v[60:63], a[32:35], v[24:27], v[60:63]
  s_waitcnt lgkmcnt(3)
  v_mfma_f32_16x16x32_bf16 v[44:47], a[36:39], v[28:31], v[44:47]
  ds_read_b128 v[24:27], v7 offset:14336
  v_mfma_f32_16x16x32_bf16 v[52:55], a[40:43], v[28:31], v[52:55]
  s_waitcnt vmcnt(0)
  s_barrier
  v_mfma_f32_16x16x32_bf16 v[60:63], a[44:47], v[28:31], v[60:63]
  buffer_store_dword v10, v9, s[8:11], 0 offen sc1
  s_waitcnt lgkmcnt(3)
  v_mfma_f32_16x16x32_bf16 v[44:47], a[48:51], v[32:35], v[44:47]
  ds_read_b128 v[28:31], v6 offset:18432
  s_add_u32 m0, s54, 0
  v_mfma_f32_16x16x32_bf16 v[52:55], a[52:55], v[32:35], v[52:55]
  buffer_load_dwordx4 v5, s[12:15], s53 offen offset:0 lds
  v_mfma_f32_16x16x32_bf16 v[60:63], a[56:59], v[32:35], v[60:63]
  s_waitcnt lgkmcnt(3)
  v_mfma_f32_16x16x32_bf16 v[44:47], a[60:63], v[16:19], v[44:47]
  ds_read_b128 v[32:35], v7 offset:18432
  s_add_u32 m0, s54, 3968
  v_mfma_f32_16x16x32_bf16 v[52:55], a[64:67], v[16:19], v[52:55]
  buffer_load_dwordx4 v5, s[12:15], s53 offen offset:128 lds
  v_mfma_f32_16x16x32_bf16 v[60:63], a[68:71], v[16:19], v[60:63]
  s_waitcnt lgkmcnt(3)
  v_mfma_f32_16x16x32_bf16 v[44:47], a[72:75], v[20:23], v[44:47]
  ds_read_b128 v[16:19], v6 offset:22528
  s_add_u32 m0, s54, 7936
  v_mfma_f32_16x16x32_bf16 v[52:55], a[76:79], v[20:23], v[52:55]
  buffer_load_dwordx4 v5, s[12:15], s53 offen offset:256 lds
  v_mfma_f32_16x16x32_bf16 v[60:63], a[80:83], v[20:23], v[60:63]
  s_waitcnt lgkmcnt(3)
  v_mfma_f32_16x16x32_bf16 v[44:47], a[84:87], v[24:27], v[44:47]
  ds_read_b128 v[20:23], v7 offset:22528
  s_add_u32 m0, s54, 11904
  v_mfma_f32_16x16x32_bf16 v[52:55], a[88:91], v[24:27], v[52:55]
  buffer_load_dwordx4 v5, s[12:15], s53 offen offset:384 lds
  v_mfma_f32_16x16x32_bf16 v[60:63], a[92:95], v[24:27], v[60:63]
  s_waitcnt lgkmcnt(3)
  v_mfma_f32_16x16x32_bf16 v[44:47], a[96:99], v[28:31], v[44:47]
  ds_read_b128 v[24:27], v6 offset:26624
  s_add_u32 m0, s54, 15872
  v_mfma_f32_16x16x32_bf16 v[52:55], a[100:103], v[28:31], v[52:55]
  buffer_load_dwordx4 v5, s[12:15], s53 offen offset:512 lds
  v_mfma_f32_16x16x32_bf16 v[60:63], a[104:107], v[28:31], v[60:63]
  s_waitcnt lgkmcnt(3)
  v_mfma_f32_16x16x32_bf16 v[44:47], a[108:111], v[32:35], v[44:47]
  ds_read_b128 v[28:31], v7 offset:26624
  s_add_u32 m0, s54, 19840
  v_mfma_f32_16x16x32_bf16 v[52:55], a[112:115], v[32:35], v[52:55]
  buffer_load_dwordx4 v5, s[12:15], s53 offen offset:640 lds
  v_mfma_f32_16x16x32_bf16 v[60:63], a[116:119], v[32:35], v[60:63]
  s_waitcnt lgkmcnt(3)
  v_mfma_f32_16x16x32_bf16 v[44:47], a[120:123], v[16:19], v[44:47]
  ds_read_b128 v[32:35], v6 offset:30720
  s_add_u32 m0, s54, 23808
  v_mfma_f32_16x16x32_bf16 v[52:55], a[124:127], v[16:19], v[52:55]
  buffer_load_dwordx4 v5, s[12:15], s53 offen offset:768 lds
  v_mfma_f32_16x16x32_bf16 v[60:63], a[128:131], v[16:19], v[60:63]
  s_waitcnt lgkmcnt(3)
  v_mfma_f32_16x16x32_bf16 v[44:47], a[132:135], v[20:23], v[44:47]
  ds_read_b128 v[16:19], v7 offset:30720
  s_add_u32 m0, s54, 27776
  v_mfma_f32_16x16x32_bf16 v[52:55], a[136:139], v[20:23], v[52:55]
  buffer_load_dwordx4 v5, s[12:15], s53 offen offset:896 lds
  v_mfma_f32_16x16x32_bf16 v[60:63], a[140:143], v[20:23], v[60:63]
  s_waitcnt lgkmcnt(3)
  v_mfma_f32_16x16x32_bf16 v[44:47], a[144:147], v[24:27], v[44:47]
  ds_read_b128 v[20:23], v6 offset:34816
  s_add_u32 m0, s54, 31744
  v_mfma_f32_16x16x32_bf16 v[52:55], a[148:151], v[24:27], v[52:55]
  buffer_load_dwordx4 v5, s[12:15], s53 offen offset:1024 lds
  v_mfma_f32_16x16x32_bf16 v[60:63], a[152:155], v[24:27], v[60:63]
  s_waitcnt lgkmcnt(3)
  v_mfma_f32_16x16x32_bf16 v[44:47], a[156:159], v[28:31], v[44:47]
  ds_read_b128 v[24:27], v7 offset:34816
  s_add_u32 m0, s54, 35712
  v_mfma_f32_16x16x32_bf16 v[52:55], a[160:163], v[28:31], v[52:55]
  buffer_load_dwordx4 v5, s[12:15], s53 offen offset:1152 lds
  v_mfma_f32_16x16x32_bf16 v[60:63], a[164:167], v[28:31], v[60:63]
  s_waitcnt lgkmcnt(3)
  v_mfma_f32_16x16x32_bf16 v[44:47], a[168:171], v[32:35], v[44:47]
  ds_read_b128 v[28:31], v6 offset:38912
  v_mfma_f32_16x16x32_bf16 v[52:55], a[172:175], v[32:35], v[52:55]
  v_mfma_f32_16x16x32_bf16 v[60:63], a[176:179], v[32:35], v[60:63]
  s_waitcnt lgkmcnt(3)
  v_mfma_f32_16x16x32_bf16 v[44:47], a[180:183], v[16:19], v[44:47]
  ds_read_b128 v[32:35], v7 offset:38912
  v_mfma_f32_16x16x32_bf16 v[52:55], a[184:187], v[16:19], v[52:55]
  v_add_u32 v6, s59, v6
  v_add_u32 v7, s59, v7
  v_mfma_f32_16x16x32_bf16 v[60:63], a[188:191], v[16:19], v[60:63]
  s_waitcnt lgkmcnt(3)
  v_mfma_f32_16x16x32_bf16 v[44:47], a[192:195], v[20:23], v[44:47]
  ds_read_b128 v[16:19], v6 offset:0
  v_mfma_f32_16x16x32_bf16 v[52:55], a[196:199], v[20:23], v[52:55]
  v_mfma_f32_16x16x32_bf16 v[60:63], a[200:203], v[20:23], v[60:63]
  s_waitcnt lgkmcnt(3)
  v_mfma_f32_16x16x32_bf16 v[44:47], a[204:207], v[24:27], v[44:47]
  ds_read_b128 v[20:23], v7 offset:0
  v_mfma_f32_16x16x32_bf16 v[52:55], a[208:211], v[24:27], v[52:55]
  s_add_u32 s52, s52, 1
  v_mfma_f32_16x16x32_bf16 v[60:63], a[212:215], v[24:27], v[60:63]
  s_waitcnt lgkmcnt(3)
  v_mfma_f32_16x16x32_bf16 v[44:47], a[216:219], v[28:31], v[44:47]
  ds_read_b128 v[24:27], v6 offset:4096
  v_mfma_f32_16x16x32_bf16 v[52:55], a[220:223], v[28:31], v[52:55]
  v_mfma_f32_16x16x32_bf16 v[60:63], a[224:227], v[28:31], v[60:63]
  s_waitcnt lgkmcnt(3)
  v_mfma_f32_16x16x32_bf16 v[44:47], a[228:231], v[32:35], v[44:47]
  ds_read_b128 v[28:31], v7 offset:4096
  v_mfma_f32_16x16x32_bf16 v[52:55], a[232:235], v[32:35], v[52:55]
  s_cmp_lt_u32 s52, s62
  v_mfma_f32_16x16x32_bf16 v[60:63], a[236:239], v[32:35], v[60:63]
  s_waitcnt lgkmcnt(3)
  s_cbranch_scc1 pa_loop_14
  v_cvt_pk_bf16_f32 v66, v44, v45
  v_cvt_pk_bf16_f32 v67, v46, v47
  s_nop 1
  v_cvt_pk_bf16_f32 v70, v52, v53
  v_cvt_pk_bf16_f32 v71, v54, v55
  v_cvt_pk_bf16_f32 v74, v60, v61
  v_cvt_pk_bf16_f32 v75, v62, v63
  v_permlane16_swap_b32 v64, v66
  v_permlane16_swap_b32 v65, v67
  v_permlane16_swap_b32 v68, v70
  v_permlane16_swap_b32 v69, v71
  v_permlane16_swap_b32 v72, v74
  v_permlane16_swap_b32 v73, v75
  buffer_store_dwordx4 v[64:67], v8, s[8:11], s55 offen sc1
  buffer_store_dwordx4 v[68:71], v8, s[8:11], s56 offen sc1
  buffer_store_dwordx4 v[72:75], v8, s[8:11], s57 offen sc1
  v_mov_b32 v10, s52
  s_waitcnt vmcnt(0) lgkmcnt(0)
  s_barrier
  buffer_store_dword v10, v9, s[8:11], 0 offen sc1
pa_att:
  v_min_u32 v1, 19, v0
  v_cmp_lt_u32 vcc, 9, v1
  s_lshl_b32 s46, s65, 4
  s_max_u32 s47, s46, 14
  s_sub_u32 s47, s47, 14
  s_lshr_b32 s47, s47, 5
  s_lshr_b32 s48, s46, 5
  v_mov_b32 v2, s47
  v_mov_b32 v3, s48
  v_cndmask_b32 v2, v2, v3, vcc
  v_subrev_u32 v3, 10, v1
  v_cndmask_b32 v1, v1, v3, vcc
  v_mul_u32_u24 v3, 171, v2
  v_lshrrev_b32 v3, 10, v3
  v_max_u32 v4, 28, v2
  v_subrev_u32 v4, 28, v4
  v_mul_u32_u24 v4, 171, v4
  v_lshrrev_b32 v4, 9, v4
  v_max_u32 v3, v3, v4
  v_mul_u32_u24 v3, 10, v3
  v_add_u32 v1, v1, v3
  v_lshlrev_b32 v1, 7, v1
  v_add_u32 v1, 1081344, v1
  v_lshrrev_b32 v3, 4, v0
  s_lshl_b32 s47, s42, 2
  v_add_u32 v3, s47, v3
  v_mul_u32_u24 v3, 5, v3
  s_xor_b32 s47, s3, 176168960
  v_add_u32 v8, 0, v3
  v_mul_u32_u24 v4, 171, v8
  v_lshrrev_b32 v4, 12, v4
  v_mul_u32_u24 v5, 3, v4
  v_lshrrev_b32 v6, 3, v8
  v_sub_u32 v5, v6, v5
  v_and_b32 v8, 7, v8
  v_lshl_add_u32 v8, v8, 8, s47
  v_lshl_add_u32 v8, v4, 19, v8
  v_lshl_add_u32 v8, v5, 24, v8
  v_lshrrev_b32 v4, 8, v8
  v_and_b32 v4, 0x2000, v4
  v_xor_b32 v8, v8, v4
  v_add_u32 v9, 1, v3
  v_mul_u32_u24 v4, 171, v9
  v_lshrrev_b32 v4, 12, v4
  v_mul_u32_u24 v5, 3, v4
  v_lshrrev_b32 v6, 3, v9
  v_sub_u32 v5, v6, v5
  v_and_b32 v9, 7, v9
  v_lshl_add_u32 v9, v9, 8, s47
  v_lshl_add_u32 v9, v4, 19, v9
  v_lshl_add_u32 v9, v5, 24, v9
  v_lshrrev_b32 v4, 8, v9
  v_and_b32 v4, 0x2000, v4
  v_xor_b32 v9, v9, v4
  v_add_u32 v10, 2, v3
  v_mul_u32_u24 v4, 171, v10
  v_lshrrev_b32 v4, 12, v4
  v_mul_u32_u24 v5, 3, v4
  v_lshrrev_b32 v6, 3, v10
  v_sub_u32 v5, v6, v5
  v_and_b32 v10, 7, v10
  v_lshl_add_u32 v10, v10, 8, s47
  v_lshl_add_u32 v10, v4, 19, v10
  v_lshl_add_u32 v10, v5, 24, v10
  v_lshrrev_b32 v4, 8, v10
  v_and_b32 v4, 0x2000, v4
  v_xor_b32 v10, v10, v4
  v_add_u32 v11, 3, v3
  v_mul_u32_u24 v4, 171, v11
  v_lshrrev_b32 v4, 12, v4
  v_mul_u32_u24 v5, 3, v4
  v_lshrrev_b32 v6, 3, v11
  v_sub_u32 v5, v6, v5
  v_and_b32 v11, 7, v11
  v_lshl_add_u32 v11, v11, 8, s47
  v_lshl_add_u32 v11, v4, 19, v11
  v_lshl_add_u32 v11, v5, 24, v11
  v_lshrrev_b32 v4, 8, v11
  v_and_b32 v4, 0x2000, v4
  v_xor_b32 v11, v11, v4
  v_add_u32 v12, 4, v3
  v_mul_u32_u24 v4, 171, v12
  v_lshrrev_b32 v4, 12, v4
  v_mul_u32_u24 v5, 3, v4
  v_lshrrev_b32 v6, 3, v12
  v_sub_u32 v5, v6, v5
  v_and_b32 v12, 7, v12
  v_lshl_add_u32 v12, v12, 8, s47
  v_lshl_add_u32 v12, v4, 19, v12
  v_lshl_add_u32 v12, v5, 24, v12
  v_lshrrev_b32 v4, 8, v12
  v_and_b32 v4, 0x2000, v4
  v_xor_b32 v12, v12, v4
  v_add_u32 v13, 80, v3
  v_mul_u32_u24 v4, 171, v13
  v_lshrrev_b32 v4, 12, v4
  v_mul_u32_u24 v5, 3, v4
  v_lshrrev_b32 v6, 3, v13
  v_sub_u32 v5, v6, v5
  v_and_b32 v13, 7, v13
  v_lshl_add_u32 v13, v13, 8, s47
  v_lshl_add_u32 v13, v4, 19, v13
  v_lshl_add_u32 v13, v5, 24, v13
  v_lshrrev_b32 v4, 8, v13
  v_and_b32 v4, 0x2000, v4
  v_xor_b32 v13, v13, v4
  v_add_u32 v14, 81, v3
  v_mul_u32_u24 v4, 171, v14
  v_lshrrev_b32 v4, 12, v4
  v_mul_u32_u24 v5, 3, v4
  v_lshrrev_b32 v6, 3, v14
  v_sub_u32 v5, v6, v5
  v_and_b32 v14, 7, v14
  v_lshl_add_u32 v14, v14, 8, s47
  v_lshl_add_u32 v14, v4, 19, v14
  v_lshl_add_u32 v14, v5, 24, v14
  v_lshrrev_b32 v4, 8, v14
  v_and_b32 v4, 0x2000, v4
  v_xor_b32 v14, v14, v4
  v_add_u32 v15, 82, v3
  v_mul_u32_u24 v4, 171, v15
  v_lshrrev_b32 v4, 12, v4
  v_mul_u32_u24 v5, 3, v4
  v_lshrrev_b32 v6, 3, v15
  v_sub_u32 v5, v6, v5
  v_and_b32 v15, 7, v15
  v_lshl_add_u32 v15, v15, 8, s47
  v_lshl_add_u32 v15, v4, 19, v15
  v_lshl_add_u32 v15, v5, 24, v15
  v_lshrrev_b32 v4, 8, v15
  v_and_b32 v4, 0x2000, v4
  v_xor_b32 v15, v15, v4
  v_add_u32 v16, 83, v3
  v_mul_u32_u24 v4, 171, v16
  v_lshrrev_b32 v4, 12, v4
  v_mul_u32_u24 v5, 3, v4
  v_lshrrev_b32 v6, 3, v16
  v_sub_u32 v5, v6, v5
  v_and_b32 v16, 7, v16
  v_lshl_add_u32 v16, v16, 8, s47
  v_lshl_add_u32 v16, v4, 19, v16
  v_lshl_add_u32 v16, v5, 24, v16
  v_lshrrev_b32 v4, 8, v16
  v_and_b32 v4, 0x2000, v4
  v_xor_b32 v16, v16, v4
  v_add_u32 v17, 84, v3
  v_mul_u32_u24 v4, 171, v17
  v_lshrrev_b32 v4, 12, v4
  v_mul_u32_u24 v5, 3, v4
  v_lshrrev_b32 v6, 3, v17
  v_sub_u32 v5, v6, v5
  v_and_b32 v17, 7, v17
  v_lshl_add_u32 v17, v17, 8, s47
  v_lshl_add_u32 v17, v4, 19, v17
  v_lshl_add_u32 v17, v5, 24, v17
  v_lshrrev_b32 v4, 8, v17
  v_and_b32 v4, 0x2000, v4
  v_xor_b32 v17, v17, v4
  v_add_u32 v18, 160, v3
  v_mul_u32_u24 v4, 171, v18
  v_lshrrev_b32 v4, 12, v4
  v_mul_u32_u24 v5, 3, v4
  v_lshrrev_b32 v6, 3, v18
  v_sub_u32 v5, v6, v5
  v_and_b32 v18, 7, v18
  v_lshl_add_u32 v18, v18, 8, s47
  v_lshl_add_u32 v18, v4, 19, v18
  v_lshl_add_u32 v18, v5, 24, v18
  v_lshrrev_b32 v4, 8, v18
  v_and_b32 v4, 0x2000, v4
  v_xor_b32 v18, v18, v4
  v_add_u32 v19, 161, v3
  v_mul_u32_u24 v4, 171, v19
  v_lshrrev_b32 v4, 12, v4
  v_mul_u32_u24 v5, 3, v4
  v_lshrrev_b32 v6, 3, v19
  v_sub_u32 v5, v6, v5
  v_and_b32 v19, 7, v19
  v_lshl_add_u32 v19, v19, 8, s47
  v_lshl_add_u32 v19, v4, 19, v19
  v_lshl_add_u32 v19, v5, 24, v19
  v_lshrrev_b32 v4, 8, v19
  v_and_b32 v4, 0x2000, v4
  v_xor_b32 v19, v19, v4
  v_add_u32 v20, 162, v3
  v_mul_u32_u24 v4, 171, v20
  v_lshrrev_b32 v4, 12, v4
  v_mul_u32_u24 v5, 3, v4
  v_lshrrev_b32 v6, 3, v20
  v_sub_u32 v5, v6, v5
  v_and_b32 v20, 7, v20
  v_lshl_add_u32 v20, v20, 8, s47
  v_lshl_add_u32 v20, v4, 19, v20
  v_lshl_add_u32 v20, v5, 24, v20
  v_lshrrev_b32 v4, 8, v20
  v_and_b32 v4, 0x2000, v4
  v_xor_b32 v20, v20, v4
  v_add_u32 v21, 163, v3
  v_mul_u32_u24 v4, 171, v21
  v_lshrrev_b32 v4, 12, v4
  v_mul_u32_u24 v5, 3, v4
  v_lshrrev_b32 v6, 3, v21
  v_sub_u32 v5, v6, v5
  v_and_b32 v21, 7, v21
  v_lshl_add_u32 v21, v21, 8, s47
  v_lshl_add_u32 v21, v4, 19, v21
  v_lshl_add_u32 v21, v5, 24, v21
  v_lshrrev_b32 v4, 8, v21
  v_and_b32 v4, 0x2000, v4
  v_xor_b32 v21, v21, v4
  v_add_u32 v22, 164, v3
  v_mul_u32_u24 v4, 171, v22
  v_lshrrev_b32 v4, 12, v4
  v_mul_u32_u24 v5, 3, v4
  v_lshrrev_b32 v6, 3, v22
  v_sub_u32 v5, v6, v5
  v_and_b32 v22, 7, v22
  v_lshl_add_u32 v22, v22, 8, s47
  v_lshl_add_u32 v22, v4, 19, v22
  v_lshl_add_u32 v22, v5, 24, v22
  v_lshrrev_b32 v4, 8, v22
  v_and_b32 v4, 0x2000, v4
  v_xor_b32 v22, v22, v4
  v_and_b32 v5, 15, v0
  v_add_u32 v6, s46, v5
  v_subrev_u32 v4, 0, v6
  v_max_i32 v4, 0, v4
  v_and_b32 v23, 15, v4
  v_lshlrev_b32 v23, 4, v23
  v_bfe_u32 v7, v4, 4, 2
  v_lshl_add_u32 v23, v7, 11, v23
  v_lshrrev_b32 v4, 6, v4
  v_lshl_add_u32 v23, v4, 14, v23
  v_cmp_gt_u32 s[72:73], 0, v6
  v_subrev_u32 v4, 2, v6
  v_max_i32 v4, 0, v4
  v_and_b32 v24, 15, v4
  v_lshlrev_b32 v24, 4, v24
  v_bfe_u32 v7, v4, 4, 2
  v_lshl_add_u32 v24, v7, 11, v24
  v_lshrrev_b32 v4, 6, v4
  v_lshl_add_u32 v24, v4, 14, v24
  v_cmp_gt_u32 s[74:75], 2, v6
  v_subrev_u32 v4, 4, v6
  v_max_i32 v4, 0, v4
  v_and_b32 v25, 15, v4
  v_lshlrev_b32 v25, 4, v25
  v_bfe_u32 v7, v4, 4, 2
  v_lshl_add_u32 v25, v7, 11, v25
  v_lshrrev_b32 v4, 6, v4
  v_lshl_add_u32 v25, v4, 14, v25
  v_cmp_gt_u32 s[76:77], 4, v6
  v_subrev_u32 v4, 6, v6
  v_max_i32 v4, 0, v4
  v_and_b32 v26, 15, v4
  v_lshlrev_b32 v26, 4, v26
  v_bfe_u32 v7, v4, 4, 2
  v_lshl_add_u32 v26, v7, 11, v26
  v_lshrrev_b32 v4, 6, v4
  v_lshl_add_u32 v26, v4, 14, v26
  v_cmp_gt_u32 s[78:79], 6, v6
  v_subrev_u32 v4, 8, v6
  v_max_i32 v4, 0, v4
  v_and_b32 v27, 15, v4
  v_lshlrev_b32 v27, 4, v27
  v_bfe_u32 v7, v4, 4, 2
  v_lshl_add_u32 v27, v7, 11, v27
  v_lshrrev_b32 v4, 6, v4
  v_lshl_add_u32 v27, v4, 14, v27
  v_cmp_gt_u32 s[80:81], 8, v6
  v_subrev_u32 v4, 10, v6
  v_max_i32 v4, 0, v4
  v_and_b32 v28, 15, v4
  v_lshlrev_b32 v28, 4, v28
  v_bfe_u32 v7, v4, 4, 2
  v_lshl_add_u32 v28, v7, 11, v28
  v_lshrrev_b32 v4, 6, v4
  v_lshl_add_u32 v28, v4, 14, v28
  v_cmp_gt_u32 s[82:83], 10, v6
  v_subrev_u32 v4, 12, v6
  v_max_i32 v4, 0, v4
  v_and_b32 v29, 15, v4
  v_lshlrev_b32 v29, 4, v29
  v_bfe_u32 v7, v4, 4, 2
  v_lshl_add_u32 v29, v7, 11, v29
  v_lshrrev_b32 v4, 6, v4
  v_lshl_add_u32 v29, v4, 14, v29
  v_cmp_gt_u32 s[84:85], 12, v6
  v_subrev_u32 v4, 14, v6
  v_max_i32 v4, 0, v4
  v_and_b32 v30, 15, v4
  v_lshlrev_b32 v30, 4, v30
  v_bfe_u32 v7, v4, 4, 2
  v_lshl_add_u32 v30, v7, 11, v30
  v_lshrrev_b32 v4, 6, v4
  v_lshl_add_u32 v30, v4, 14, v30
  v_cmp_gt_u32 s[86:87], 14, v6
  s_mov_b32 s50, 0
  s_mov_b32 s66, 0
pa_wait:
  buffer_load_dword v4, v1, s[8:11], 0 offen sc1
  s_add_u32 s50, s50, 1
  s_cmp_gt_u32 s50, 131072
  s_cbranch_scc1 L_fail
  s_waitcnt vmcnt(0)
  v_cmp_le_u32 vcc, v4, v2
  s_cbranch_vccnz pa_wait
  v_add_u32 v232, v8, v23
  buffer_load_dwordx4 v[32:35], v232, s[8:11], s66 offen sc1
  v_add_u32 v233, v9, v23
  buffer_load_dwordx4 v[36:39], v233, s[8:11], s66 offen sc1
  v_add_u32 v234, v10, v23
  buffer_load_dwordx4 v[40:43], v234, s[8:11], s66 offen sc1
  v_add_u32 v235, v11, v23
  buffer_load_dwordx4 v[44:47], v235, s[8:11], s66 offen sc1
  v_add_u32 v236, v12, v23
  buffer_load_dwordx4 v[48:51], v236, s[8:11], s66 offen sc1
  v_add_u32 v232, v13, v23
  buffer_load_dwordx4 v[72:75], v232, s[8:11], s66 offen sc1
  v_add_u32 v233, v14, v23
  buffer_load_dwordx4 v[76:79], v233, s[8:11], s66 offen sc1
  v_add_u32 v234, v15, v23
  buffer_load_dwordx4 v[80:83], v234, s[8:11], s66 offen sc1
  v_add_u32 v235, v16, v23
  buffer_load_dwordx4 v[84:87], v235, s[8:11], s66 offen sc1
  v_add_u32 v236, v17, v23
  buffer_load_dwordx4 v[88:91], v236, s[8:11], s66 offen sc1
  v_add_u32 v232, v13, v24
  buffer_load_dwordx4 v[92:95], v232, s[8:11], s66 offen sc1
  v_add_u32 v233, v14, v24
  buffer_load_dwordx4 v[96:99], v233, s[8:11], s66 offen sc1
  v_add_u32 v234, v15, v24
  buffer_load_dwordx4 v[100:103], v234, s[8:11], s66 offen sc1
  v_add_u32 v235, v16, v24
  buffer_load_dwordx4 v[104:107], v235, s[8:11], s66 offen sc1
  v_add_u32 v236, v17, v24
  buffer_load_dwordx4 v[108:111], v236, s[8:11], s66 offen sc1
  v_add_u32 v232, v13, v25
  buffer_load_dwordx4 v[112:115], v232, s[8:11], s66 offen sc1
  v_add_u32 v233, v14, v25
  buffer_load_dwordx4 v[116:119], v233, s[8:11], s66 offen sc1
  v_add_u32 v234, v15, v25
  buffer_load_dwordx4 v[120:123], v234, s[8:11], s66 offen sc1
  v_add_u32 v235, v16, v25
  buffer_load_dwordx4 v[124:127], v235, s[8:11], s66 offen sc1
  v_add_u32 v236, v17, v25
  buffer_load_dwordx4 v[128:131], v236, s[8:11], s66 offen sc1
  v_add_u32 v232, v13, v26
  buffer_load_dwordx4 v[132:135], v232, s[8:11], s66 offen sc1
  v_add_u32 v233, v14, v26
  buffer_load_dwordx4 v[136:139], v233, s[8:11], s66 offen sc1
  v_add_u32 v234, v15, v26
  buffer_load_dwordx4 v[140:143], v234, s[8:11], s66 offen sc1
  v_add_u32 v235, v16, v26
  buffer_load_dwordx4 v[144:147], v235, s[8:11], s66 offen sc1
  v_add_u32 v236, v17, v26
  buffer_load_dwordx4 v[148:151], v236, s[8:11], s66 offen sc1
  v_add_u32 v232, v13, v27
  buffer_load_dwordx4 v[152:155], v232, s[8:11], s66 offen sc1
  v_add_u32 v233, v14, v27
  buffer_load_dwordx4 v[156:159], v233, s[8:11], s66 offen sc1
  v_add_u32 v234, v15, v27
  buffer_load_dwordx4 v[160:163], v234, s[8:11], s66 offen sc1
  v_add_u32 v235, v16, v27
  buffer_load_dwordx4 v[164:167], v235, s[8:11], s66 offen sc1
  v_add_u32 v236, v17, v27
  buffer_load_dwordx4 v[168:171], v236, s[8:11], s66 offen sc1
  v_add_u32 v232, v13, v28
  buffer_load_dwordx4 v[172:175], v232, s[8:11], s66 offen sc1
  v_add_u32 v233, v14, v28
  buffer_load_dwordx4 v[176:179], v233, s[8:11], s66 offen sc1
  v_add_u32 v234, v15, v28
  buffer_load_dwordx4 v[180:183], v234, s[8:11], s66 offen sc1
  v_add_u32 v235, v16, v28
  buffer_load_dwordx4 v[184:187], v235, s[8:11], s66 offen sc1
  v_add_u32 v236, v17, v28
  buffer_load_dwordx4 v[188:191], v236, s[8:11], s66 offen sc1
  v_add_u32 v232, v13, v29
  buffer_load_dwordx4 v[192:195], v232, s[8:11], s66 offen sc1
  v_add_u32 v233, v14, v29
  buffer_load_dwordx4 v[196:199], v233, s[8:11], s66 offen sc1
  v_add_u32 v234, v15, v29
  buffer_load_dwordx4 v[200:203], v234, s[8:11], s66 offen sc1
  v_add_u32 v235, v16, v29
  buffer_load_dwordx4 v[204:207], v235, s[8:11], s66 offen sc1
  v_add_u32 v236, v17, v29
  buffer_load_dwordx4 v[208:211], v236, s[8:11], s66 offen sc1
  v_add_u32 v232, v13, v30
  buffer_load_dwordx4 v[212:215], v232, s[8:11], s66 offen sc1
  v_add_u32 v233, v14, v30
  buffer_load_dwordx4 v[216:219], v233, s[8:11], s66 offen sc1
  v_add_u32 v234, v15, v30
  buffer_load_dwordx4 v[220:223], v234, s[8:11], s66 offen sc1
  v_add_u32 v235, v16, v30
  buffer_load_dwordx4 v[224:227], v235, s[8:11], s66 offen sc1
  v_add_u32 v236, v17, v30
  buffer_load_dwordx4 v[228:231], v236, s[8:11], s66 offen sc1
  s_waitcnt vmcnt(35)
  v_dot2_f32_bf16 v52, v32, v72, 0
  v_dot2_f32_bf16 v60, v42, v82, 0
  v_dot2_f32_bf16 v52, v33, v73, v52
  v_dot2_f32_bf16 v60, v43, v83, v60
  v_dot2_f32_bf16 v52, v34, v74, v52
  v_dot2_f32_bf16 v60, v44, v84, v60
  v_dot2_f32_bf16 v52, v35, v75, v52
  v_dot2_f32_bf16 v60, v45, v85, v60
  v_dot2_f32_bf16 v52, v36, v76, v52
  v_dot2_f32_bf16 v60, v46, v86, v60
  v_dot2_f32_bf16 v52, v37, v77, v52
  v_dot2_f32_bf16 v60, v47, v87, v60
  v_dot2_f32_bf16 v52, v38, v78, v52
  v_dot2_f32_bf16 v60, v48, v88, v60
  v_dot2_f32_bf16 v52, v39, v79, v52
  v_dot2_f32_bf16 v60, v49, v89, v60
  v_dot2_f32_bf16 v52, v40, v80, v52
  v_dot2_f32_bf16 v60, v50, v90, v60
  v_dot2_f32_bf16 v52, v41, v81, v52
  v_dot2_f32_bf16 v60, v51, v91, v60
  v_add_u32 v232, v18, v23
  buffer_load_dwordx4 v[72:75], v232, s[8:11], s66 offen sc1
  v_add_u32 v233, v19, v23
  buffer_load_dwordx4 v[76:79], v233, s[8:11], s66 offen sc1
  v_add_u32 v234, v20, v23
  buffer_load_dwordx4 v[80:83], v234, s[8:11], s66 offen sc1
  v_add_u32 v235, v21, v23
  buffer_load_dwordx4 v[84:87], v235, s[8:11], s66 offen sc1
  v_add_u32 v236, v22, v23
  buffer_load_dwordx4 v[88:91], v236, s[8:11], s66 offen sc1
  s_waitcnt vmcnt(35)
  v_dot2_f32_bf16 v53, v32, v92, 0
  v_dot2_f32_bf16 v61, v42, v102, 0
  v_dot2_f32_bf16 v53, v33, v93, v53
  v_dot2_f32_bf16 v61, v43, v103, v61
  v_dot2_f32_bf16 v53, v34, v94, v53
  v_dot2_f32_bf16 v61, v44, v104, v61
  v_dot2_f32_bf16 v53, v35, v95, v53
  v_dot2_f32_bf16 v61, v45, v105, v61
  v_dot2_f32_bf16 v53, v36, v96, v53
  v_dot2_f32_bf16 v61, v46, v106, v61
  v_dot2_f32_bf16 v53, v37, v97, v53
  v_dot2_f32_bf16 v61, v47, v107, v61
  v_dot2_f32_bf16 v53, v38, v98, v53
  v_dot2_f32_bf16 v61, v48, v108, v61
  v_dot2_f32_bf16 v53, v39, v99, v53
  v_dot2_f32_bf16 v61, v49, v109, v61
  v_dot2_f32_bf16 v53, v40, v100, v53
  v_dot2_f32_bf16 v61, v50, v110, v61
  v_dot2_f32_bf16 v53, v41, v101, v53
  v_dot2_f32_bf16 v61, v51, v111, v61
  v_add_u32 v232, v18, v24
  buffer_load_dwordx4 v[92:95], v232, s[8:11], s66 offen sc1
  v_add_u32 v233, v19, v24
  buffer_load_dwordx4 v[96:99], v233, s[8:11], s66 offen sc1
  v_add_u32 v234, v20, v24
  buffer_load_dwordx4 v[100:103], v234, s[8:11], s66 offen sc1
  v_add_u32 v235, v21, v24
  buffer_load_dwordx4 v[104:107], v235, s[8:11], s66 offen sc1
  v_add_u32 v236, v22, v24
  buffer_load_dwordx4 v[108:111], v236, s[8:11], s66 offen sc1
  s_waitcnt vmcnt(35)
  v_dot2_f32_bf16 v54, v32, v112, 0
  v_dot2_f32_bf16 v62, v42, v122, 0
  v_dot2_f32_bf16 v54, v33, v113, v54
  v_dot2_f32_bf16 v62, v43, v123, v62
  v_dot2_f32_bf16 v54, v34, v114, v54
  v_dot2_f32_bf16 v62, v44, v124, v62
  v_dot2_f32_bf16 v54, v35, v115, v54
  v_dot2_f32_bf16 v62, v45, v125, v62
  v_dot2_f32_bf16 v54, v36, v116, v54
  v_dot2_f32_bf16 v62, v46, v126, v62
  v_dot2_f32_bf16 v54, v37, v117, v54
  v_dot2_f32_bf16 v62, v47, v127, v62
  v_dot2_f32_bf16 v54, v38, v118, v54
  v_dot2_f32_bf16 v62, v48, v128, v62
  v_dot2_f32_bf16 v54, v39, v119, v54
  v_dot2_f32_bf16 v62, v49, v129, v62
  v_dot2_f32_bf16 v54, v40, v120, v54
  v_dot2_f32_bf16 v62, v50, v130, v62
  v_dot2_f32_bf16 v54, v41, v121, v54
  v_dot2_f32_bf16 v62, v51, v131, v62
  v_add_u32 v232, v18, v25
  buffer_load_dwordx4 v[112:115], v232, s[8:11], s66 offen sc1
  v_add_u32 v233, v19, v25
  buffer_load_dwordx4 v[116:119], v233, s[8:11], s66 offen sc1
  v_add_u32 v234, v20, v25
  buffer_load_dwordx4 v[120:123], v234, s[8:11], s66 offen sc1
  v_add_u32 v235, v21, v25
  buffer_load_dwordx4 v[124:127], v235, s[8:11], s66 offen sc1
  v_add_u32 v236, v22, v25
  buffer_load_dwordx4 v[128:131], v236, s[8:11], s66 offen sc1
  s_waitcnt vmcnt(35)
  v_dot2_f32_bf16 v55, v32, v132, 0
  v_dot2_f32_bf16 v63, v42, v142, 0
  v_dot2_f32_bf16 v55, v33, v133, v55
  v_dot2_f32_bf16 v63, v43, v143, v63
  v_dot2_f32_bf16 v55, v34, v134, v55
  v_dot2_f32_bf16 v63, v44, v144, v63
  v_dot2_f32_bf16 v55, v35, v135, v55
  v_dot2_f32_bf16 v63, v45, v145, v63
  v_dot2_f32_bf16 v55, v36, v136, v55
  v_dot2_f32_bf16 v63, v46, v146, v63
  v_dot2_f32_bf16 v55, v37, v137, v55
  v_dot2_f32_bf16 v63, v47, v147, v63
  v_dot2_f32_bf16 v55, v38, v138, v55
  v_dot2_f32_bf16 v63, v48, v148, v63
  v_dot2_f32_bf16 v55, v39, v139, v55
  v_dot2_f32_bf16 v63, v49, v149, v63
  v_dot2_f32_bf16 v55, v40, v140, v55
  v_dot2_f32_bf16 v63, v50, v150, v63
  v_dot2_f32_bf16 v55, v41, v141, v55
  v_dot2_f32_bf16 v63, v51, v151, v63
  v_add_u32 v232, v18, v26
  buffer_load_dwordx4 v[132:135], v232, s[8:11], s66 offen sc1
  v_add_u32 v233, v19, v26
  buffer_load_dwordx4 v[136:139], v233, s[8:11], s66 offen sc1
  v_add_u32 v234, v20, v26
  buffer_load_dwordx4 v[140:143], v234, s[8:11], s66 offen sc1
  v_add_u32 v235, v21, v26
  buffer_load_dwordx4 v[144:147], v235, s[8:11], s66 offen sc1
  v_add_u32 v236, v22, v26
  buffer_load_dwordx4 v[148:151], v236, s[8:11], s66 offen sc1
  s_waitcnt vmcnt(35)
  v_dot2_f32_bf16 v56, v32, v152, 0
  v_dot2_f32_bf16 v64, v42, v162, 0
  v_dot2_f32_bf16 v56, v33, v153, v56
  v_dot2_f32_bf16 v64, v43, v163, v64
  v_dot2_f32_bf16 v56, v34, v154, v56
  v_dot2_f32_bf16 v64, v44, v164, v64
  v_dot2_f32_bf16 v56, v35, v155, v56
  v_dot2_f32_bf16 v64, v45, v165, v64
  v_dot2_f32_bf16 v56, v36, v156, v56
  v_dot2_f32_bf16 v64, v46, v166, v64
  v_dot2_f32_bf16 v56, v37, v157, v56
  v_dot2_f32_bf16 v64, v47, v167, v64
  v_dot2_f32_bf16 v56, v38, v158, v56
  v_dot2_f32_bf16 v64, v48, v168, v64
  v_dot2_f32_bf16 v56, v39, v159, v56
  v_dot2_f32_bf16 v64, v49, v169, v64
  v_dot2_f32_bf16 v56, v40, v160, v56
  v_dot2_f32_bf16 v64, v50, v170, v64
  v_dot2_f32_bf16 v56, v41, v161, v56
  v_dot2_f32_bf16 v64, v51, v171, v64
  v_add_u32 v232, v18, v27
  buffer_load_dwordx4 v[152:155], v232, s[8:11], s66 offen sc1
  v_add_u32 v233, v19, v27
  buffer_load_dwordx4 v[156:159], v233, s[8:11], s66 offen sc1
  v_add_u32 v234, v20, v27
  buffer_load_dwordx4 v[160:163], v234, s[8:11], s66 offen sc1
  v_add_u32 v235, v21, v27
  buffer_load_dwordx4 v[164:167], v235, s[8:11], s66 offen sc1
  v_add_u32 v236, v22, v27
  buffer_load_dwordx4 v[168:171], v236, s[8:11], s66 offen sc1
  s_waitcnt vmcnt(35)
  v_dot2_f32_bf16 v57, v32, v172, 0
  v_dot2_f32_bf16 v65, v42, v182, 0
  v_dot2_f32_bf16 v57, v33, v173, v57
  v_dot2_f32_bf16 v65, v43, v183, v65
  v_dot2_f32_bf16 v57, v34, v174, v57
  v_dot2_f32_bf16 v65, v44, v184, v65
  v_dot2_f32_bf16 v57, v35, v175, v57
  v_dot2_f32_bf16 v65, v45, v185, v65
  v_dot2_f32_bf16 v57, v36, v176, v57
  v_dot2_f32_bf16 v65, v46, v186, v65
  v_dot2_f32_bf16 v57, v37, v177, v57
  v_dot2_f32_bf16 v65, v47, v187, v65
  v_dot2_f32_bf16 v57, v38, v178, v57
  v_dot2_f32_bf16 v65, v48, v188, v65
  v_dot2_f32_bf16 v57, v39, v179, v57
  v_dot2_f32_bf16 v65, v49, v189, v65
  v_dot2_f32_bf16 v57, v40, v180, v57
  v_dot2_f32_bf16 v65, v50, v190, v65
  v_dot2_f32_bf16 v57, v41, v181, v57
  v_dot2_f32_bf16 v65, v51, v191, v65
  v_add_u32 v232, v18, v28
  buffer_load_dwordx4 v[172:175], v232, s[8:11], s66 offen sc1
  v_add_u32 v233, v19, v28
  buffer_load_dwordx4 v[176:179], v233, s[8:11], s66 offen sc1
  v_add_u32 v234, v20, v28
  buffer_load_dwordx4 v[180:183], v234, s[8:11], s66 offen sc1
  v_add_u32 v235, v21, v28
  buffer_load_dwordx4 v[184:187], v235, s[8:11], s66 offen sc1
  v_add_u32 v236, v22, v28
  buffer_load_dwordx4 v[188:191], v236, s[8:11], s66 offen sc1
  s_waitcnt vmcnt(35)
  v_dot2_f32_bf16 v58, v32, v192, 0
  v_dot2_f32_bf16 v66, v42, v202, 0
  v_dot2_f32_bf16 v58, v33, v193, v58
  v_dot2_f32_bf16 v66, v43, v203, v66
  v_dot2_f32_bf16 v58, v34, v194, v58
  v_dot2_f32_bf16 v66, v44, v204, v66
  v_dot2_f32_bf16 v58, v35, v195, v58
  v_dot2_f32_bf16 v66, v45, v205, v66
  v_dot2_f32_bf16 v58, v36, v196, v58
  v_dot2_f32_bf16 v66, v46, v206, v66
  v_dot2_f32_bf16 v58, v37, v197, v58
  v_dot2_f32_bf16 v66, v47, v207, v66
  v_dot2_f32_bf16 v58, v38, v198, v58
  v_dot2_f32_bf16 v66, v48, v208, v66
  v_dot2_f32_bf16 v58, v39, v199, v58
  v_dot2_f32_bf16 v66, v49, v209, v66
  v_dot2_f32_bf16 v58, v40, v200, v58
  v_dot2_f32_bf16 v66, v50, v210, v66
  v_dot2_f32_bf16 v58, v41, v201, v58
  v_dot2_f32_bf16 v66, v51, v211, v66
  v_add_u32 v232, v18, v29
  buffer_load_dwordx4 v[192:195], v232, s[8:11], s66 offen sc1
  v_add_u32 v233, v19, v29
  buffer_load_dwordx4 v[196:199], v233, s[8:11], s66 offen sc1
  v_add_u32 v234, v20, v29
  buffer_load_dwordx4 v[200:203], v234, s[8:11], s66 offen sc1
  v_add_u32 v235, v21, v29
  buffer_load_dwordx4 v[204:207], v235, s[8:11], s66 offen sc1
  v_add_u32 v236, v22, v29
  buffer_load_dwordx4 v[208:211], v236, s[8:11], s66 offen sc1
  s_waitcnt vmcnt(35)
  v_dot2_f32_bf16 v59, v32, v212, 0
  v_dot2_f32_bf16 v67, v42, v222, 0
  v_dot2_f32_bf16 v59, v33, v213, v59
  v_dot2_f32_bf16 v67, v43, v223, v67
  v_dot2_f32_bf16 v59, v34, v214, v59
  v_dot2_f32_bf16 v67, v44, v224, v67
  v_dot2_f32_bf16 v59, v35, v215, v59
  v_dot2_f32_bf16 v67, v45, v225, v67
  v_dot2_f32_bf16 v59, v36, v216, v59
  v_dot2_f32_bf16 v67, v46, v226, v67
  v_dot2_f32_bf16 v59, v37, v217, v59
  v_dot2_f32_bf16 v67, v47, v227, v67
  v_dot2_f32_bf16 v59, v38, v218, v59
  v_dot2_f32_bf16 v67, v48, v228, v67
  v_dot2_f32_bf16 v59, v39, v219, v59
  v_dot2_f32_bf16 v67, v49, v229, v67
  v_dot2_f32_bf16 v59, v40, v220, v59
  v_dot2_f32_bf16 v67, v50, v230, v67
  v_dot2_f32_bf16 v59, v41, v221, v59
  v_dot2_f32_bf16 v67, v51, v231, v67
  v_add_u32 v232, v18, v30
  buffer_load_dwordx4 v[212:215], v232, s[8:11], s66 offen sc1
  v_add_u32 v233, v19, v30
  buffer_load_dwordx4 v[216:219], v233, s[8:11], s66 offen sc1
  v_add_u32 v234, v20, v30
  buffer_load_dwordx4 v[220:223], v234, s[8:11], s66 offen sc1
  v_add_u32 v235, v21, v30
  buffer_load_dwordx4 v[224:227], v235, s[8:11], s66 offen sc1
  v_add_u32 v236, v22, v30
  buffer_load_dwordx4 v[228:231], v236, s[8:11], s66 offen sc1
  s_mov_b32 s46, 1051011932
  v_mov_b32 v232, 3481618353
  v_cndmask_b32 v53, v53, v232, s[74:75]
  v_cndmask_b32 v54, v54, v232, s[76:77]
  v_cndmask_b32 v55, v55, v232, s[78:79]
  v_cndmask_b32 v56, v56, v232, s[80:81]
  v_cndmask_b32 v57, v57, v232, s[82:83]
  v_cndmask_b32 v58, v58, v232, s[84:85]
  v_cndmask_b32 v59, v59, v232, s[86:87]
  v_max_f32 v233, v52, v53
  v_max3_f32 v233, v233, v54, v55
  v_max3_f32 v233, v233, v56, v57
  v_max3_f32 v233, v233, v58, v59
  v_mul_f32 v233, s46, v233
  v_fma_f32 v52, v52, s46, -v233
  v_fma_f32 v53, v53, s46, -v233
  v_fma_f32 v54, v54, s46, -v233
  v_fma_f32 v55, v55, s46, -v233
  v_fma_f32 v56, v56, s46, -v233
  v_fma_f32 v57, v57, s46, -v233
  v_fma_f32 v58, v58, s46, -v233
  v_fma_f32 v59, v59, s46, -v233
  v_exp_f32 v52, v52
  v_exp_f32 v53, v53
  v_exp_f32 v54, v54
  v_exp_f32 v55, v55
  v_exp_f32 v56, v56
  v_exp_f32 v57, v57
  v_exp_f32 v58, v58
  v_exp_f32 v59, v59
  v_add_f32 v233, v52, v53
  v_add_f32 v233, v233, v54
  v_add_f32 v233, v233, v55
  v_add_f32 v233, v233, v56
  v_add_f32 v233, v233, v57
  v_add_f32 v233, v233, v58
  v_add_f32 v233, v233, v59
  v_rcp_f32 v233, v233
  s_nop 0
  v_mul_f32 v52, v52, v233
  v_mul_f32 v53, v53, v233
  v_mul_f32 v54, v54, v233
  v_mul_f32 v55, v55, v233
  v_mul_f32 v56, v56, v233
  v_mul_f32 v57, v57, v233
  v_mul_f32 v58, v58, v233
  v_mul_f32 v59, v59, v233
  v_cndmask_b32 v61, v61, v232, s[74:75]
  v_cndmask_b32 v62, v62, v232, s[76:77]
  v_cndmask_b32 v63, v63, v232, s[78:79]
  v_cndmask_b32 v64, v64, v232, s[80:81]
  v_cndmask_b32 v65, v65, v232, s[82:83]
  v_cndmask_b32 v66, v66, v232, s[84:85]
  v_cndmask_b32 v67, v67, v232, s[86:87]
  v_max_f32 v233, v60, v61
  v_max3_f32 v233, v233, v62, v63
  v_max3_f32 v233, v233, v64, v65
  v_max3_f32 v233, v233, v66, v67
  v_mul_f32 v233, s46, v233
  v_fma_f32 v60, v60, s46, -v233
  v_fma_f32 v61, v61, s46, -v233
  v_fma_f32 v62, v62, s46, -v233
  v_fma_f32 v63, v63, s46, -v233
  v_fma_f32 v64, v64, s46, -v233
  v_fma_f32 v65, v65, s46, -v233
  v_fma_f32 v66, v66, s46, -v233
  v_fma_f32 v67, v67, s46, -v233
  v_exp_f32 v60, v60
  v_exp_f32 v61, v61
  v_exp_f32 v62, v62
  v_exp_f32 v63, v63
  v_exp_f32 v64, v64
  v_exp_f32 v65, v65
  v_exp_f32 v66, v66
  v_exp_f32 v67, v67
  v_add_f32 v233, v60, v61
  v_add_f32 v233, v233, v62
  v_add_f32 v233, v233, v63
  v_add_f32 v233, v233, v64
  v_add_f32 v233, v233, v65
  v_add_f32 v233, v233, v66
  v_add_f32 v233, v233, v67
  v_rcp_f32 v233, v233
  s_nop 0
  v_mul_f32 v60, v60, v233
  v_mul_f32 v61, v61, v233
  v_mul_f32 v62, v62, v233
  v_mul_f32 v63, v63, v233
  v_mul_f32 v64, v64, v233
  v_mul_f32 v65, v65, v233
  v_mul_f32 v66, v66, v233
  v_mul_f32 v67, v67, v233
  v_cvt_pk_bf16_f32 v52, v52, 0
  v_lshlrev_b32 v236, 16, v52
  v_cvt_pk_bf16_f32 v53, v53, 0
  v_lshlrev_b32 v237, 16, v53
  v_cvt_pk_bf16_f32 v54, v54, 0
  v_lshlrev_b32 v238, 16, v54
  v_cvt_pk_bf16_f32 v55, v55, 0
  v_lshlrev_b32 v239, 16, v55
  v_cvt_pk_bf16_f32 v56, v56, 0
  v_lshlrev_b32 v240, 16, v56
  v_cvt_pk_bf16_f32 v57, v57, 0
  v_lshlrev_b32 v241, 16, v57
  v_cvt_pk_bf16_f32 v58, v58, 0
  v_lshlrev_b32 v242, 16, v58
  v_cvt_pk_bf16_f32 v59, v59, 0
  v_lshlrev_b32 v243, 16, v59
  v_cvt_pk_bf16_f32 v60, v60, 0
  v_lshlrev_b32 v244, 16, v60
  v_cvt_pk_bf16_f32 v61, v61, 0
  v_lshlrev_b32 v245, 16, v61
  v_cvt_pk_bf16_f32 v62, v62, 0
  v_lshlrev_b32 v246, 16, v62
  v_cvt_pk_bf16_f32 v63, v63, 0
  v_lshlrev_b32 v247, 16, v63
  v_cvt_pk_bf16_f32 v64, v64, 0
  v_lshlrev_b32 v248, 16, v64
  v_cvt_pk_bf16_f32 v65, v65, 0
  v_lshlrev_b32 v249, 16, v65
  v_cvt_pk_bf16_f32 v66, v66, 0
  v_lshlrev_b32 v250, 16, v66
  v_cvt_pk_bf16_f32 v67, v67, 0
  v_lshlrev_b32 v251, 16, v67
  s_waitcnt vmcnt(35)
  v_dot2_f32_bf16 v8, v72, v52, 0
  v_dot2_f32_bf16 v9, v72, v236, 0
  v_dot2_f32_bf16 v10, v73, v52, 0
  v_dot2_f32_bf16 v11, v73, v236, 0
  v_dot2_f32_bf16 v12, v74, v52, 0
  v_dot2_f32_bf16 v13, v74, v236, 0
  v_dot2_f32_bf16 v14, v75, v52, 0
  v_dot2_f32_bf16 v15, v75, v236, 0
  v_dot2_f32_bf16 v16, v76, v52, 0
  v_dot2_f32_bf16 v17, v76, v236, 0
  v_dot2_f32_bf16 v18, v77, v52, 0
  v_dot2_f32_bf16 v19, v77, v236, 0
  v_dot2_f32_bf16 v20, v78, v52, 0
  v_dot2_f32_bf16 v21, v78, v236, 0
  v_dot2_f32_bf16 v22, v79, v52, 0
  v_dot2_f32_bf16 v23, v79, v236, 0
  v_dot2_f32_bf16 v24, v80, v52, 0
  v_dot2_f32_bf16 v25, v80, v236, 0
  v_dot2_f32_bf16 v26, v81, v52, 0
  v_dot2_f32_bf16 v27, v81, v236, 0
  v_dot2_f32_bf16 v28, v82, v60, 0
  v_dot2_f32_bf16 v29, v82, v244, 0
  v_dot2_f32_bf16 v30, v83, v60, 0
  v_dot2_f32_bf16 v31, v83, v244, 0
  v_dot2_f32_bf16 v32, v84, v60, 0
  v_dot2_f32_bf16 v33, v84, v244, 0
  v_dot2_f32_bf16 v34, v85, v60, 0
  v_dot2_f32_bf16 v35, v85, v244, 0
  v_dot2_f32_bf16 v36, v86, v60, 0
  v_dot2_f32_bf16 v37, v86, v244, 0
  v_dot2_f32_bf16 v38, v87, v60, 0
  v_dot2_f32_bf16 v39, v87, v244, 0
  v_dot2_f32_bf16 v40, v88, v60, 0
  v_dot2_f32_bf16 v41, v88, v244, 0
  v_dot2_f32_bf16 v42, v89, v60, 0
  v_dot2_f32_bf16 v43, v89, v244, 0
  v_dot2_f32_bf16 v44, v90, v60, 0
  v_dot2_f32_bf16 v45, v90, v244, 0
  v_dot2_f32_bf16 v46, v91, v60, 0
  v_dot2_f32_bf16 v47, v91, v244, 0
  s_waitcnt vmcnt(30)
  v_dot2_f32_bf16 v8, v92, v53, v8
  v_dot2_f32_bf16 v9, v92, v237, v9
  v_dot2_f32_bf16 v10, v93, v53, v10
  v_dot2_f32_bf16 v11, v93, v237, v11
  v_dot2_f32_bf16 v12, v94, v53, v12
  v_dot2_f32_bf16 v13, v94, v237, v13
  v_dot2_f32_bf16 v14, v95, v53, v14
  v_dot2_f32_bf16 v15, v95, v237, v15
  v_dot2_f32_bf16 v16, v96, v53, v16
  v_dot2_f32_bf16 v17, v96, v237, v17
  v_dot2_f32_bf16 v18, v97, v53, v18
  v_dot2_f32_bf16 v19, v97, v237, v19
  v_dot2_f32_bf16 v20, v98, v53, v20
  v_dot2_f32_bf16 v21, v98, v237, v21
  v_dot2_f32_bf16 v22, v99, v53, v22
  v_dot2_f32_bf16 v23, v99, v237, v23
  v_dot2_f32_bf16 v24, v100, v53, v24
  v_dot2_f32_bf16 v25, v100, v237, v25
  v_dot2_f32_bf16 v26, v101, v53, v26
  v_dot2_f32_bf16 v27, v101, v237, v27
  v_dot2_f32_bf16 v28, v102, v61, v28
  v_dot2_f32_bf16 v29, v102, v245, v29
  v_dot2_f32_bf16 v30, v103, v61, v30
  v_dot2_f32_bf16 v31, v103, v245, v31
  v_dot2_f32_bf16 v32, v104, v61, v32
  v_dot2_f32_bf16 v33, v104, v245, v33
  v_dot2_f32_bf16 v34, v105, v61, v34
  v_dot2_f32_bf16 v35, v105, v245, v35
  v_dot2_f32_bf16 v36, v106, v61, v36
  v_dot2_f32_bf16 v37, v106, v245, v37
  v_dot2_f32_bf16 v38, v107, v61, v38
  v_dot2_f32_bf16 v39, v107, v245, v39
  v_dot2_f32_bf16 v40, v108, v61, v40
  v_dot2_f32_bf16 v41, v108, v245, v41
  v_dot2_f32_bf16 v42, v109, v61, v42
  v_dot2_f32_bf16 v43, v109, v245, v43
  v_dot2_f32_bf16 v44, v110, v61, v44
  v_dot2_f32_bf16 v45, v110, v245, v45
  v_dot2_f32_bf16 v46, v111, v61, v46
  v_dot2_f32_bf16 v47, v111, v245, v47
  s_waitcnt vmcnt(25)
  v_dot2_f32_bf16 v8, v112, v54, v8
  v_dot2_f32_bf16 v9, v112, v238, v9
  v_dot2_f32_bf16 v10, v113, v54, v10
  v_dot2_f32_bf16 v11, v113, v238, v11
  v_dot2_f32_bf16 v12, v114, v54, v12
  v_dot2_f32_bf16 v13, v114, v238, v13
  v_dot2_f32_bf16 v14, v115, v54, v14
  v_dot2_f32_bf16 v15, v115, v238, v15
  v_dot2_f32_bf16 v16, v116, v54, v16
  v_dot2_f32_bf16 v17, v116, v238, v17
  v_dot2_f32_bf16 v18, v117, v54, v18
  v_dot2_f32_bf16 v19, v117, v238, v19
  v_dot2_f32_bf16 v20, v118, v54, v20
  v_dot2_f32_bf16 v21, v118, v238, v21
  v_dot2_f32_bf16 v22, v119, v54, v22
  v_dot2_f32_bf16 v23, v119, v238, v23
  v_dot2_f32_bf16 v24, v120, v54, v24
  v_dot2_f32_bf16 v25, v120, v238, v25
  v_dot2_f32_bf16 v26, v121, v54, v26
  v_dot2_f32_bf16 v27, v121, v238, v27
  v_dot2_f32_bf16 v28, v122, v62, v28
  v_dot2_f32_bf16 v29, v122, v246, v29
  v_dot2_f32_bf16 v30, v123, v62, v30
  v_dot2_f32_bf16 v31, v123, v246, v31
  v_dot2_f32_bf16 v32, v124, v62, v32
  v_dot2_f32_bf16 v33, v124, v246, v33
  v_dot2_f32_bf16 v34, v125, v62, v34
  v_dot2_f32_bf16 v35, v125, v246, v35
  v_dot2_f32_bf16 v36, v126, v62, v36
  v_dot2_f32_bf16 v37, v126, v246, v37
  v_dot2_f32_bf16 v38, v127, v62, v38
  v_dot2_f32_bf16 v39, v127, v246, v39
  v_dot2_f32_bf16 v40, v128, v62, v40
  v_dot2_f32_bf16 v41, v128, v246, v41
  v_dot2_f32_bf16 v42, v129, v62, v42
  v_dot2_f32_bf16 v43, v129, v246, v43
  v_dot2_f32_bf16 v44, v130, v62, v44
  v_dot2_f32_bf16 v45, v130, v246, v45
  v_dot2_f32_bf16 v46, v131, v62, v46
  v_dot2_f32_bf16 v47, v131, v246, v47
  s_waitcnt vmcnt(20)
  v_dot2_f32_bf16 v8, v132, v55, v8
  v_dot2_f32_bf16 v9, v132, v239, v9
  v_dot2_f32_bf16 v10, v133, v55, v10
  v_dot2_f32_bf16 v11, v133, v239, v11
  v_dot2_f32_bf16 v12, v134, v55, v12
  v_dot2_f32_bf16 v13, v134, v239, v13
  v_dot2_f32_bf16 v14, v135, v55, v14
  v_dot2_f32_bf16 v15, v135, v239, v15
  v_dot2_f32_bf16 v16, v136, v55, v16
  v_dot2_f32_bf16 v17, v136, v239, v17
  v_dot2_f32_bf16 v18, v137, v55, v18
  v_dot2_f32_bf16 v19, v137, v239, v19
  v_dot2_f32_bf16 v20, v138, v55, v20
  v_dot2_f32_bf16 v21, v138, v239, v21
  v_dot2_f32_bf16 v22, v139, v55, v22
  v_dot2_f32_bf16 v23, v139, v239, v23
  v_dot2_f32_bf16 v24, v140, v55, v24
  v_dot2_f32_bf16 v25, v140, v239, v25
  v_dot2_f32_bf16 v26, v141, v55, v26
  v_dot2_f32_bf16 v27, v141, v239, v27
  v_dot2_f32_bf16 v28, v142, v63, v28
  v_dot2_f32_bf16 v29, v142, v247, v29
  v_dot2_f32_bf16 v30, v143, v63, v30
  v_dot2_f32_bf16 v31, v143, v247, v31
  v_dot2_f32_bf16 v32, v144, v63, v32
  v_dot2_f32_bf16 v33, v144, v247, v33
  v_dot2_f32_bf16 v34, v145, v63, v34
  v_dot2_f32_bf16 v35, v145, v247, v35
  v_dot2_f32_bf16 v36, v146, v63, v36
  v_dot2_f32_bf16 v37, v146, v247, v37
  v_dot2_f32_bf16 v38, v147, v63, v38
  v_dot2_f32_bf16 v39, v147, v247, v39
  v_dot2_f32_bf16 v40, v148, v63, v40
  v_dot2_f32_bf16 v41, v148, v247, v41
  v_dot2_f32_bf16 v42, v149, v63, v42
  v_dot2_f32_bf16 v43, v149, v247, v43
  v_dot2_f32_bf16 v44, v150, v63, v44
  v_dot2_f32_bf16 v45, v150, v247, v45
  v_dot2_f32_bf16 v46, v151, v63, v46
  v_dot2_f32_bf16 v47, v151, v247, v47
  s_waitcnt vmcnt(15)
  v_dot2_f32_bf16 v8, v152, v56, v8
  v_dot2_f32_bf16 v9, v152, v240, v9
  v_dot2_f32_bf16 v10, v153, v56, v10
  v_dot2_f32_bf16 v11, v153, v240, v11
  v_dot2_f32_bf16 v12, v154, v56, v12
  v_dot2_f32_bf16 v13, v154, v240, v13
  v_dot2_f32_bf16 v14, v155, v56, v14
  v_dot2_f32_bf16 v15, v155, v240, v15
  v_dot2_f32_bf16 v16, v156, v56, v16
  v_dot2_f32_bf16 v17, v156, v240, v17
  v_dot2_f32_bf16 v18, v157, v56, v18
  v_dot2_f32_bf16 v19, v157, v240, v19
  v_dot2_f32_bf16 v20, v158, v56, v20
  v_dot2_f32_bf16 v21, v158, v240, v21
  v_dot2_f32_bf16 v22, v159, v56, v22
  v_dot2_f32_bf16 v23, v159, v240, v23
  v_dot2_f32_bf16 v24, v160, v56, v24
  v_dot2_f32_bf16 v25, v160, v240, v25
  v_dot2_f32_bf16 v26, v161, v56, v26
  v_dot2_f32_bf16 v27, v161, v240, v27
  v_dot2_f32_bf16 v28, v162, v64, v28
  v_dot2_f32_bf16 v29, v162, v248, v29
  v_dot2_f32_bf16 v30, v163, v64, v30
  v_dot2_f32_bf16 v31, v163, v248, v31
  v_dot2_f32_bf16 v32, v164, v64, v32
  v_dot2_f32_bf16 v33, v164, v248, v33
  v_dot2_f32_bf16 v34, v165, v64, v34
  v_dot2_f32_bf16 v35, v165, v248, v35
  v_dot2_f32_bf16 v36, v166, v64, v36
  v_dot2_f32_bf16 v37, v166, v248, v37
  v_dot2_f32_bf16 v38, v167, v64, v38
  v_dot2_f32_bf16 v39, v167, v248, v39
  v_dot2_f32_bf16 v40, v168, v64, v40
  v_dot2_f32_bf16 v41, v168, v248, v41
  v_dot2_f32_bf16 v42, v169, v64, v42
  v_dot2_f32_bf16 v43, v169, v248, v43
  v_dot2_f32_bf16 v44, v170, v64, v44
  v_dot2_f32_bf16 v45, v170, v248, v45
  v_dot2_f32_bf16 v46, v171, v64, v46
  v_dot2_f32_bf16 v47, v171, v248, v47
  s_waitcnt vmcnt(10)
  v_dot2_f32_bf16 v8, v172, v57, v8
  v_dot2_f32_bf16 v9, v172, v241, v9
  v_dot2_f32_bf16 v10, v173, v57, v10
  v_dot2_f32_bf16 v11, v173, v241, v11
  v_dot2_f32_bf16 v12, v174, v57, v12
  v_dot2_f32_bf16 v13, v174, v241, v13
  v_dot2_f32_bf16 v14, v175, v57, v14
  v_dot2_f32_bf16 v15, v175, v241, v15
  v_dot2_f32_bf16 v16, v176, v57, v16
  v_dot2_f32_bf16 v17, v176, v241, v17
  v_dot2_f32_bf16 v18, v177, v57, v18
  v_dot2_f32_bf16 v19, v177, v241, v19
  v_dot2_f32_bf16 v20, v178, v57, v20
  v_dot2_f32_bf16 v21, v178, v241, v21
  v_dot2_f32_bf16 v22, v179, v57, v22
  v_dot2_f32_bf16 v23, v179, v241, v23
  v_dot2_f32_bf16 v24, v180, v57, v24
  v_dot2_f32_bf16 v25, v180, v241, v25
  v_dot2_f32_bf16 v26, v181, v57, v26
  v_dot2_f32_bf16 v27, v181, v241, v27
  v_dot2_f32_bf16 v28, v182, v65, v28
  v_dot2_f32_bf16 v29, v182, v249, v29
  v_dot2_f32_bf16 v30, v183, v65, v30
  v_dot2_f32_bf16 v31, v183, v249, v31
  v_dot2_f32_bf16 v32, v184, v65, v32
  v_dot2_f32_bf16 v33, v184, v249, v33
  v_dot2_f32_bf16 v34, v185, v65, v34
  v_dot2_f32_bf16 v35, v185, v249, v35
  v_dot2_f32_bf16 v36, v186, v65, v36
  v_dot2_f32_bf16 v37, v186, v249, v37
  v_dot2_f32_bf16 v38, v187, v65, v38
  v_dot2_f32_bf16 v39, v187, v249, v39
  v_dot2_f32_bf16 v40, v188, v65, v40
  v_dot2_f32_bf16 v41, v188, v249, v41
  v_dot2_f32_bf16 v42, v189, v65, v42
  v_dot2_f32_bf16 v43, v189, v249, v43
  v_dot2_f32_bf16 v44, v190, v65, v44
  v_dot2_f32_bf16 v45, v190, v249, v45
  v_dot2_f32_bf16 v46, v191, v65, v46
  v_dot2_f32_bf16 v47, v191, v249, v47
  s_waitcnt vmcnt(5)
  v_dot2_f32_bf16 v8, v192, v58, v8
  v_dot2_f32_bf16 v9, v192, v242, v9
  v_dot2_f32_bf16 v10, v193, v58, v10
  v_dot2_f32_bf16 v11, v193, v242, v11
  v_dot2_f32_bf16 v12, v194, v58, v12
  v_dot2_f32_bf16 v13, v194, v242, v13
  v_dot2_f32_bf16 v14, v195, v58, v14
  v_dot2_f32_bf16 v15, v195, v242, v15
  v_dot2_f32_bf16 v16, v196, v58, v16
  v_dot2_f32_bf16 v17, v196, v242, v17
  v_dot2_f32_bf16 v18, v197, v58, v18
  v_dot2_f32_bf16 v19, v197, v242, v19
  v_dot2_f32_bf16 v20, v198, v58, v20
  v_dot2_f32_bf16 v21, v198, v242, v21
  v_dot2_f32_bf16 v22, v199, v58, v22
  v_dot2_f32_bf16 v23, v199, v242, v23
  v_dot2_f32_bf16 v24, v200, v58, v24
  v_dot2_f32_bf16 v25, v200, v242, v25
  v_dot2_f32_bf16 v26, v201, v58, v26
  v_dot2_f32_bf16 v27, v201, v242, v27
  v_dot2_f32_bf16 v28, v202, v66, v28
  v_dot2_f32_bf16 v29, v202, v250, v29
  v_dot2_f32_bf16 v30, v203, v66, v30
  v_dot2_f32_bf16 v31, v203, v250, v31
  v_dot2_f32_bf16 v32, v204, v66, v32
  v_dot2_f32_bf16 v33, v204, v250, v33
  v_dot2_f32_bf16 v34, v205, v66, v34
  v_dot2_f32_bf16 v35, v205, v250, v35
  v_dot2_f32_bf16 v36, v206, v66, v36
  v_dot2_f32_bf16 v37, v206, v250, v37
  v_dot2_f32_bf16 v38, v207, v66, v38
  v_dot2_f32_bf16 v39, v207, v250, v39
  v_dot2_f32_bf16 v40, v208, v66, v40
  v_dot2_f32_bf16 v41, v208, v250, v41
  v_dot2_f32_bf16 v42, v209, v66, v42
  v_dot2_f32_bf16 v43, v209, v250, v43
  v_dot2_f32_bf16 v44, v210, v66, v44
  v_dot2_f32_bf16 v45, v210, v250, v45
  v_dot2_f32_bf16 v46, v211, v66, v46
  v_dot2_f32_bf16 v47, v211, v250, v47
  s_waitcnt vmcnt(0)
  v_dot2_f32_bf16 v8, v212, v59, v8
  v_dot2_f32_bf16 v9, v212, v243, v9
  v_dot2_f32_bf16 v10, v213, v59, v10
  v_dot2_f32_bf16 v11, v213, v243, v11
  v_dot2_f32_bf16 v12, v214, v59, v12
  v_dot2_f32_bf16 v13, v214, v243, v13
  v_dot2_f32_bf16 v14, v215, v59, v14
  v_dot2_f32_bf16 v15, v215, v243, v15
  v_dot2_f32_bf16 v16, v216, v59, v16
  v_dot2_f32_bf16 v17, v216, v243, v17
  v_dot2_f32_bf16 v18, v217, v59, v18
  v_dot2_f32_bf16 v19, v217, v243, v19
  v_dot2_f32_bf16 v20, v218, v59, v20
  v_dot2_f32_bf16 v21, v218, v243, v21
  v_dot2_f32_bf16 v22, v219, v59, v22
  v_dot2_f32_bf16 v23, v219, v243, v23
  v_dot2_f32_bf16 v24, v220, v59, v24
  v_dot2_f32_bf16 v25, v220, v243, v25
  v_dot2_f32_bf16 v26, v221, v59, v26
  v_dot2_f32_bf16 v27, v221, v243, v27
  v_dot2_f32_bf16 v28, v222, v67, v28
  v_dot2_f32_bf16 v29, v222, v251, v29
  v_dot2_f32_bf16 v30, v223, v67, v30
  v_dot2_f32_bf16 v31, v223, v251, v31
  v_dot2_f32_bf16 v32, v224, v67, v32
  v_dot2_f32_bf16 v33, v224, v251, v33
  v_dot2_f32_bf16 v34, v225, v67, v34
  v_dot2_f32_bf16 v35, v225, v251, v35
  v_dot2_f32_bf16 v36, v226, v67, v36
  v_dot2_f32_bf16 v37, v226, v251, v37
  v_dot2_f32_bf16 v38, v227, v67, v38
  v_dot2_f32_bf16 v39, v227, v251, v39
  v_dot2_f32_bf16 v40, v228, v67, v40
  v_dot2_f32_bf16 v41, v228, v251, v41
  v_dot2_f32_bf16 v42, v229, v67, v42
  v_dot2_f32_bf16 v43, v229, v251, v43
  v_dot2_f32_bf16 v44, v230, v67, v44
  v_dot2_f32_bf16 v45, v230, v251, v45
  v_dot2_f32_bf16 v46, v231, v67, v46
  v_dot2_f32_bf16 v47, v231, v251, v47
  v_cvt_pk_bf16_f32 v72, v8, v9
  v_cvt_pk_bf16_f32 v73, v10, v11
  v_cvt_pk_bf16_f32 v74, v12, v13
  v_cvt_pk_bf16_f32 v75, v14, v15
  v_cvt_pk_bf16_f32 v76, v16, v17
  v_cvt_pk_bf16_f32 v77, v18, v19
  v_cvt_pk_bf16_f32 v78, v20, v21
  v_cvt_pk_bf16_f32 v79, v22, v23
  v_cvt_pk_bf16_f32 v80, v24, v25
  v_cvt_pk_bf16_f32 v81, v26, v27
  v_cvt_pk_bf16_f32 v82, v28, v29
  v_cvt_pk_bf16_f32 v83, v30, v31
  v_cvt_pk_bf16_f32 v84, v32, v33
  v_cvt_pk_bf16_f32 v85, v34, v35
  v_cvt_pk_bf16_f32 v86, v36, v37
  v_cvt_pk_bf16_f32 v87, v38, v39
  v_cvt_pk_bf16_f32 v88, v40, v41
  v_cvt_pk_bf16_f32 v89, v42, v43
  v_cvt_pk_bf16_f32 v90, v44, v45
  v_cvt_pk_bf16_f32 v91, v46, v47
  v_lshlrev_b32 v3, 8, v3
  v_lshl_add_u32 v3, v5, 4, v3
  v_add_u32 v3, 122880, v3
  ds_write_b128 v3, v[72:75] offset:0
  ds_write_b128 v3, v[76:79] offset:256
  ds_write_b128 v3, v[80:83] offset:512
  ds_write_b128 v3, v[84:87] offset:768
  ds_write_b128 v3, v[88:91] offset:1024
  s_waitcnt lgkmcnt(0)
  s_barrier
  v_lshlrev_b32 v13, 4, v0
  v_add_u32 v13, 122880, v13
  ds_read_b128 v[20:23], v13 offset:0
  ds_read_b128 v[24:27], v13 offset:1024
  ds_read_b128 v[28:31], v13 offset:2048
  ds_read_b128 v[32:35], v13 offset:3072
  ds_read_b128 v[36:39], v13 offset:4096
  ds_read_b128 v[40:43], v13 offset:5120
  ds_read_b128 v[44:47], v13 offset:6144
  ds_read_b128 v[48:51], v13 offset:7168
  ds_read_b128 v[52:55], v13 offset:8192
  ds_read_b128 v[56:59], v13 offset:9216
  ds_read_b128 v[60:63], v13 offset:10240
  ds_read_b128 v[64:67], v13 offset:11264
  s_waitcnt lgkmcnt(4)
  ds_read_b128 v[68:71], v13 offset:12288
  ds_read_b128 v[72:75], v13 offset:13312
  ds_read_b128 v[76:79], v13 offset:14336
  ds_read_b128 v[80:83], v13 offset:15360
  ds_read_b128 v[84:87], v13 offset:16384
  ds_read_b128 v[88:91], v13 offset:17408
  ds_read_b128 v[92:95], v13 offset:18432
  ds_read_b128 v[96:99], v13 offset:19456
  s_mov_b32 s4, s20
  s_mov_b32 s5, s21
  s_mov_b32 s6, 819200
  s_mov_b32 s7, 0x20000
  s_mov_b32 s12, s36
  s_mov_b32 s13, s37
  s_mov_b32 s14, 5242880
  s_mov_b32 s15, 0x20000
  v_mul_u32_u24 v12, 2560, v6
  v_lshrrev_b32 v14, 4, v0
  v_lshl_add_u32 v12, v14, 3, v12
  s_lshl_b32 s46, s42, 5
  v_add_u32 v12, s46, v12
  s_mov_b32 s66, 0
  s_waitcnt lgkmcnt(0)
  v_lshrrev_b32 v13, 3, v0
  v_lshrrev_b32 v14, 2, v13
  v_lshlrev_b32 v14, 3, v14
  v_and_b32 v8, 3, v13
  v_add_u32 v8, v8, v14
  s_and_b32 s46, s42, 1
  s_lshl_b32 s46, s46, 2
  s_lshr_b32 s47, s42, 1
  s_lshl_b32 s47, s47, 4
  s_add_u32 s46, s46, s47
  v_add_u32 v8, s46, v8
  v_mul_u32_u24 v8, 1280, v8
  v_lshrrev_b32 v13, 1, v13
  v_bfe_u32 v14, v0, 1, 2
  v_xor_b32 v13, v13, v14
  v_lshlrev_b32 v13, 5, v13
  v_and_b32 v14, 1, v0
  v_lshlrev_b32 v14, 4, v14
  v_add3_u32 v8, v8, v13, v14
  v_lshrrev_b32 v13, 5, v0
  v_lshlrev_b32 v9, 11, v13
  v_bfe_u32 v13, v0, 2, 3
  v_lshl_add_u32 v9, v13, 7, v9
  v_lshrrev_b32 v13, 1, v13
  v_xor_b32 v13, s42, v13
  v_lshl_add_u32 v9, v13, 5, v9
  v_and_b32 v13, 3, v0
  v_lshl_add_u32 v9, v13, 3, v9
  v_add_u32 v10, 0x10000, v9
  v_add_u32 v11, 0x20000, v9
  s_add_u32 m0, s51, 0
  s_add_u32 s46, s66, 0
  buffer_load_dwordx4 v8, s[4:7], s46 offen  lds
  s_add_u32 m0, s51, 4096
  s_add_u32 s46, s66, 128
  buffer_load_dwordx4 v8, s[4:7], s46 offen  lds
  s_add_u32 m0, s51, 8192
  s_add_u32 s46, s66, 256
  buffer_load_dwordx4 v8, s[4:7], s46 offen  lds
  s_add_u32 m0, s51, 12288
  s_add_u32 s46, s66, 384
  buffer_load_dwordx4 v8, s[4:7], s46 offen  lds
  s_add_u32 m0, s51, 16384
  s_add_u32 s46, s66, 512
  buffer_load_dwordx4 v8, s[4:7], s46 offen  lds
  s_add_u32 m0, s51, 20480
  s_add_u32 s46, s66, 640
  buffer_load_dwordx4 v8, s[4:7], s46 offen  lds
  s_add_u32 m0, s51, 24576
  s_add_u32 s46, s66, 768
  buffer_load_dwordx4 v8, s[4:7], s46 offen  lds
  s_add_u32 m0, s51, 28672
  s_add_u32 s46, s66, 896
  buffer_load_dwordx4 v8, s[4:7], s46 offen  lds
  s_add_u32 m0, s51, 32768
  s_add_u32 s46, s66, 1024
  buffer_load_dwordx4 v8, s[4:7], s46 offen  lds
  s_add_u32 m0, s51, 36864
  s_add_u32 s46, s66, 1152
  buffer_load_dwordx4 v8, s[4:7], s46 offen  lds
  s_add_u32 m0, s51, 40960
  s_add_u32 s46, s66, 40960
  buffer_load_dwordx4 v8, s[4:7], s46 offen  lds
  s_add_u32 m0, s51, 45056
  s_add_u32 s46, s66, 41088
  buffer_load_dwordx4 v8, s[4:7], s46 offen  lds
  s_add_u32 m0, s51, 49152
  s_add_u32 s46, s66, 41216
  buffer_load_dwordx4 v8, s[4:7], s46 offen  lds
  s_add_u32 m0, s51, 53248
  s_add_u32 s46, s66, 41344
  buffer_load_dwordx4 v8, s[4:7], s46 offen  lds
  s_add_u32 m0, s51, 57344
  s_add_u32 s46, s66, 41472
  buffer_load_dwordx4 v8, s[4:7], s46 offen  lds
  s_add_u32 m0, s51, 61440
  s_add_u32 s46, s66, 41600
  buffer_load_dwordx4 v8, s[4:7], s46 offen  lds
  s_add_u32 m0, s51, 65536
  s_add_u32 s46, s66, 41728
  buffer_load_dwordx4 v8, s[4:7], s46 offen  lds
  s_add_u32 m0, s51, 69632
  s_add_u32 s46, s66, 41856
  buffer_load_dwordx4 v8, s[4:7], s46 offen  lds
  s_add_u32 m0, s51, 73728
  s_add_u32 s46, s66, 41984
  buffer_load_dwordx4 v8, s[4:7], s46 offen  lds
  s_add_u32 m0, s51, 77824
  s_add_u32 s46, s66, 42112
  buffer_load_dwordx4 v8, s[4:7], s46 offen  lds
  s_add_u32 m0, s51, 81920
  s_add_u32 s46, s66, 81920
  buffer_load_dwordx4 v8, s[4:7], s46 offen  lds
  s_add_u32 m0, s51, 86016
  s_add_u32 s46, s66, 82048
  buffer_load_dwordx4 v8, s[4:7], s46 offen  lds
  s_add_u32 m0, s51, 90112
  s_add_u32 s46, s66, 82176
  buffer_load_dwordx4 v8, s[4:7], s46 offen  lds
  s_add_u32 m0, s51, 94208
  s_add_u32 s46, s66, 82304
  buffer_load_dwordx4 v8, s[4:7], s46 offen  lds
  s_add_u32 m0, s51, 98304
  s_add_u32 s46, s66, 82432
  buffer_load_dwordx4 v8, s[4:7], s46 offen  lds
  s_waitcnt vmcnt(20)
  s_barrier
  s_add_u32 m0, s51, 102400
  s_add_u32 s46, s66, 82560
  buffer_load_dwordx4 v8, s[4:7], s46 offen  lds
  s_add_u32 m0, s51, 106496
  s_add_u32 s46, s66, 82688
  buffer_load_dwordx4 v8, s[4:7], s46 offen  lds
  s_add_u32 m0, s51, 110592
  s_add_u32 s46, s66, 82816
  buffer_load_dwordx4 v8, s[4:7], s46 offen  lds
  s_add_u32 m0, s51, 114688
  s_add_u32 s46, s66, 82944
  buffer_load_dwordx4 v8, s[4:7], s46 offen  lds
  s_add_u32 m0, s51, 118784
  s_add_u32 s46, s66, 83072
  buffer_load_dwordx4 v8, s[4:7], s46 offen  lds
  ds_read_b64_tr_b16 v[100:101], v9 offset:0
  ds_read_b64_tr_b16 v[102:103], v9 offset:1024
  ds_read_b64_tr_b16 v[104:105], v9 offset:4096
  ds_read_b64_tr_b16 v[106:107], v9 offset:5120
  ds_read_b64_tr_b16 v[108:109], v9 offset:8192
  ds_read_b64_tr_b16 v[110:111], v9 offset:9216
  ds_read_b64_tr_b16 v[112:113], v9 offset:12288
  ds_read_b64_tr_b16 v[114:115], v9 offset:13312
  ds_read_b64_tr_b16 v[116:117], v9 offset:16384
  ds_read_b64_tr_b16 v[118:119], v9 offset:17408
  s_waitcnt lgkmcnt(0)
  v_mfma_f32_16x16x32_bf16 v[140:143], v[100:103], v[20:23], 0
  v_mfma_f32_16x16x32_bf16 v[144:147], v[104:107], v[20:23], 0
  v_mfma_f32_16x16x32_bf16 v[148:151], v[108:111], v[20:23], 0
  v_mfma_f32_16x16x32_bf16 v[152:155], v[112:115], v[20:23], 0
  v_mfma_f32_16x16x32_bf16 v[156:159], v[116:119], v[20:23], 0
  s_waitcnt vmcnt(20)
  s_barrier
  s_add_u32 m0, s51, 0
  s_add_u32 s46, s66, 122880
  buffer_load_dwordx4 v8, s[4:7], s46 offen  lds
  s_add_u32 m0, s51, 4096
  s_add_u32 s46, s66, 123008
  buffer_load_dwordx4 v8, s[4:7], s46 offen  lds
  s_add_u32 m0, s51, 8192
  s_add_u32 s46, s66, 123136
  buffer_load_dwordx4 v8, s[4:7], s46 offen  lds
  s_add_u32 m0, s51, 12288
  s_add_u32 s46, s66, 123264
  buffer_load_dwordx4 v8, s[4:7], s46 offen  lds
  s_add_u32 m0, s51, 16384
  s_add_u32 s46, s66, 123392
  buffer_load_dwordx4 v8, s[4:7], s46 offen  lds
  ds_read_b64_tr_b16 v[120:121], v9 offset:20480
  ds_read_b64_tr_b16 v[122:123], v9 offset:21504
  ds_read_b64_tr_b16 v[124:125], v9 offset:24576
  ds_read_b64_tr_b16 v[126:127], v9 offset:25600
  ds_read_b64_tr_b16 v[128:129], v9 offset:28672
  ds_read_b64_tr_b16 v[130:131], v9 offset:29696
  ds_read_b64_tr_b16 v[132:133], v9 offset:32768
  ds_read_b64_tr_b16 v[134:135], v9 offset:33792
  ds_read_b64_tr_b16 v[136:137], v9 offset:36864
  ds_read_b64_tr_b16 v[138:139], v9 offset:37888
  s_waitcnt lgkmcnt(0)
  v_mfma_f32_16x16x32_bf16 v[160:163], v[120:123], v[20:23], 0
  v_mfma_f32_16x16x32_bf16 v[164:167], v[124:127], v[20:23], 0
  v_mfma_f32_16x16x32_bf16 v[168:171], v[128:131], v[20:23], 0
  v_mfma_f32_16x16x32_bf16 v[172:175], v[132:135], v[20:23], 0
  v_mfma_f32_16x16x32_bf16 v[176:179], v[136:139], v[20:23], 0
  s_waitcnt vmcnt(20)
  s_barrier
  s_add_u32 m0, s51, 20480
  s_add_u32 s46, s66, 123520
  buffer_load_dwordx4 v8, s[4:7], s46 offen  lds
  s_add_u32 m0, s51, 24576
  s_add_u32 s46, s66, 123648
  buffer_load_dwordx4 v8, s[4:7], s46 offen  lds
  s_add_u32 m0, s51, 28672
  s_add_u32 s46, s66, 123776
  buffer_load_dwordx4 v8, s[4:7], s46 offen  lds
  s_add_u32 m0, s51, 32768
  s_add_u32 s46, s66, 123904
  buffer_load_dwordx4 v8, s[4:7], s46 offen  lds
  s_add_u32 m0, s51, 36864
  s_add_u32 s46, s66, 124032
  buffer_load_dwordx4 v8, s[4:7], s46 offen  lds
  ds_read_b64_tr_b16 v[100:101], v9 offset:40960
  ds_read_b64_tr_b16 v[102:103], v9 offset:41984
  ds_read_b64_tr_b16 v[104:105], v9 offset:45056
  ds_read_b64_tr_b16 v[106:107], v9 offset:46080
  ds_read_b64_tr_b16 v[108:109], v9 offset:49152
  ds_read_b64_tr_b16 v[110:111], v9 offset:50176
  ds_read_b64_tr_b16 v[112:113], v9 offset:53248
  ds_read_b64_tr_b16 v[114:115], v9 offset:54272
  ds_read_b64_tr_b16 v[116:117], v9 offset:57344
  ds_read_b64_tr_b16 v[118:119], v9 offset:58368
  s_waitcnt lgkmcnt(0)
  v_mfma_f32_16x16x32_bf16 v[140:143], v[100:103], v[24:27], v[140:143]
  v_mfma_f32_16x16x32_bf16 v[144:147], v[104:107], v[24:27], v[144:147]
  v_mfma_f32_16x16x32_bf16 v[148:151], v[108:111], v[24:27], v[148:151]
  v_mfma_f32_16x16x32_bf16 v[152:155], v[112:115], v[24:27], v[152:155]
  v_mfma_f32_16x16x32_bf16 v[156:159], v[116:119], v[24:27], v[156:159]
  s_waitcnt vmcnt(20)
  s_barrier
  s_add_u32 m0, s51, 40960
  s_add_u32 s46, s66, 163840
  buffer_load_dwordx4 v8, s[4:7], s46 offen  lds
  s_add_u32 m0, s51, 45056
  s_add_u32 s46, s66, 163968
  buffer_load_dwordx4 v8, s[4:7], s46 offen  lds
  s_add_u32 m0, s51, 49152
  s_add_u32 s46, s66, 164096
  buffer_load_dwordx4 v8, s[4:7], s46 offen  lds
  s_add_u32 m0, s51, 53248
  s_add_u32 s46, s66, 164224
  buffer_load_dwordx4 v8, s[4:7], s46 offen  lds
  s_add_u32 m0, s51, 57344
  s_add_u32 s46, s66, 164352
  buffer_load_dwordx4 v8, s[4:7], s46 offen  lds
  ds_read_b64_tr_b16 v[120:121], v9 offset:61440
  ds_read_b64_tr_b16 v[122:123], v9 offset:62464
  ds_read_b64_tr_b16 v[124:125], v10 offset:0
  ds_read_b64_tr_b16 v[126:127], v10 offset:1024
  ds_read_b64_tr_b16 v[128:129], v10 offset:4096
  ds_read_b64_tr_b16 v[130:131], v10 offset:5120
  ds_read_b64_tr_b16 v[132:133], v10 offset:8192
  ds_read_b64_tr_b16 v[134:135], v10 offset:9216
  ds_read_b64_tr_b16 v[136:137], v10 offset:12288
  ds_read_b64_tr_b16 v[138:139], v10 offset:13312
  s_waitcnt lgkmcnt(0)
  v_mfma_f32_16x16x32_bf16 v[160:163], v[120:123], v[24:27], v[160:163]
  v_mfma_f32_16x16x32_bf16 v[164:167], v[124:127], v[24:27], v[164:167]
  v_mfma_f32_16x16x32_bf16 v[168:171], v[128:131], v[24:27], v[168:171]
  v_mfma_f32_16x16x32_bf16 v[172:175], v[132:135], v[24:27], v[172:175]
  v_mfma_f32_16x16x32_bf16 v[176:179], v[136:139], v[24:27], v[176:179]
  s_waitcnt vmcnt(20)
  s_barrier
  s_add_u32 m0, s51, 61440
  s_add_u32 s46, s66, 164480
  buffer_load_dwordx4 v8, s[4:7], s46 offen  lds
  s_add_u32 m0, s51, 65536
  s_add_u32 s46, s66, 164608
  buffer_load_dwordx4 v8, s[4:7], s46 offen  lds
  s_add_u32 m0, s51, 69632
  s_add_u32 s46, s66, 164736
  buffer_load_dwordx4 v8, s[4:7], s46 offen  lds
  s_add_u32 m0, s51, 73728
  s_add_u32 s46, s66, 164864
  buffer_load_dwordx4 v8, s[4:7], s46 offen  lds
  s_add_u32 m0, s51, 77824
  s_add_u32 s46, s66, 164992
  buffer_load_dwordx4 v8, s[4:7], s46 offen  lds
  ds_read_b64_tr_b16 v[100:101], v10 offset:16384
  ds_read_b64_tr_b16 v[102:103], v10 offset:17408
  ds_read_b64_tr_b16 v[104:105], v10 offset:20480
  ds_read_b64_tr_b16 v[106:107], v10 offset:21504
  ds_read_b64_tr_b16 v[108:109], v10 offset:24576
  ds_read_b64_tr_b16 v[110:111], v10 offset:25600
  ds_read_b64_tr_b16 v[112:113], v10 offset:28672
  ds_read_b64_tr_b16 v[114:115], v10 offset:29696
  ds_read_b64_tr_b16 v[116:117], v10 offset:32768
  ds_read_b64_tr_b16 v[118:119], v10 offset:33792
  s_waitcnt lgkmcnt(0)
  v_mfma_f32_16x16x32_bf16 v[140:143], v[100:103], v[28:31], v[140:143]
  v_mfma_f32_16x16x32_bf16 v[144:147], v[104:107], v[28:31], v[144:147]
  v_mfma_f32_16x16x32_bf16 v[148:151], v[108:111], v[28:31], v[148:151]
  v_mfma_f32_16x16x32_bf16 v[152:155], v[112:115], v[28:31], v[152:155]
  v_mfma_f32_16x16x32_bf16 v[156:159], v[116:119], v[28:31], v[156:159]
  s_waitcnt vmcnt(20)
  s_barrier
  s_add_u32 m0, s51, 81920
  s_add_u32 s46, s66, 204800
  buffer_load_dwordx4 v8, s[4:7], s46 offen  lds
  s_add_u32 m0, s51, 86016
  s_add_u32 s46, s66, 204928
  buffer_load_dwordx4 v8, s[4:7], s46 offen  lds
  s_add_u32 m0, s51, 90112
  s_add_u32 s46, s66, 205056
  buffer_load_dwordx4 v8, s[4:7], s46 offen  lds
  s_add_u32 m0, s51, 94208
  s_add_u32 s46, s66, 205184
  buffer_load_dwordx4 v8, s[4:7], s46 offen  lds
  s_add_u32 m0, s51, 98304
  s_add_u32 s46, s66, 205312
  buffer_load_dwordx4 v8, s[4:7], s46 offen  lds
  ds_read_b64_tr_b16 v[120:121], v10 offset:36864
  ds_read_b64_tr_b16 v[122:123], v10 offset:37888
  ds_read_b64_tr_b16 v[124:125], v10 offset:40960
  ds_read_b64_tr_b16 v[126:127], v10 offset:41984
  ds_read_b64_tr_b16 v[128:129], v10 offset:45056
  ds_read_b64_tr_b16 v[130:131], v10 offset:46080
  ds_read_b64_tr_b16 v[132:133], v10 offset:49152
  ds_read_b64_tr_b16 v[134:135], v10 offset:50176
  ds_read_b64_tr_b16 v[136:137], v10 offset:53248
  ds_read_b64_tr_b16 v[138:139], v10 offset:54272
  s_waitcnt lgkmcnt(0)
  v_mfma_f32_16x16x32_bf16 v[160:163], v[120:123], v[28:31], v[160:163]
  v_mfma_f32_16x16x32_bf16 v[164:167], v[124:127], v[28:31], v[164:167]
  v_mfma_f32_16x16x32_bf16 v[168:171], v[128:131], v[28:31], v[168:171]
  v_mfma_f32_16x16x32_bf16 v[172:175], v[132:135], v[28:31], v[172:175]
  v_mfma_f32_16x16x32_bf16 v[176:179], v[136:139], v[28:31], v[176:179]
  s_waitcnt vmcnt(20)
  s_barrier
  s_add_u32 m0, s51, 102400
  s_add_u32 s46, s66, 205440
  buffer_load_dwordx4 v8, s[4:7], s46 offen  lds
  s_add_u32 m0, s51, 106496
  s_add_u32 s46, s66, 205568
  buffer_load_dwordx4 v8, s[4:7], s46 offen  lds
  s_add_u32 m0, s51, 110592
  s_add_u32 s46, s66, 205696
  buffer_load_dwordx4 v8, s[4:7], s46 offen  lds
  s_add_u32 m0, s51, 114688
  s_add_u32 s46, s66, 205824
  buffer_load_dwordx4 v8, s[4:7], s46 offen  lds
  s_add_u32 m0, s51, 118784
  s_add_u32 s46, s66, 205952
  buffer_load_dwordx4 v8, s[4:7], s46 offen  lds
  ds_read_b64_tr_b16 v[100:101], v9 offset:0
  ds_read_b64_tr_b16 v[102:103], v9 offset:1024
  ds_read_b64_tr_b16 v[104:105], v9 offset:4096
  ds_read_b64_tr_b16 v[106:107], v9 offset:5120
  ds_read_b64_tr_b16 v[108:109], v9 offset:8192
  ds_read_b64_tr_b16 v[110:111], v9 offset:9216
  ds_read_b64_tr_b16 v[112:113], v9 offset:12288
  ds_read_b64_tr_b16 v[114:115], v9 offset:13312
  ds_read_b64_tr_b16 v[116:117], v9 offset:16384
  ds_read_b64_tr_b16 v[118:119], v9 offset:17408
  s_waitcnt lgkmcnt(0)
  v_mfma_f32_16x16x32_bf16 v[140:143], v[100:103], v[32:35], v[140:143]
  v_mfma_f32_16x16x32_bf16 v[144:147], v[104:107], v[32:35], v[144:147]
  v_mfma_f32_16x16x32_bf16 v[148:151], v[108:111], v[32:35], v[148:151]
  v_mfma_f32_16x16x32_bf16 v[152:155], v[112:115], v[32:35], v[152:155]
  v_mfma_f32_16x16x32_bf16 v[156:159], v[116:119], v[32:35], v[156:159]
  s_waitcnt vmcnt(20)
  s_barrier
  s_add_u32 m0, s51, 0
  s_add_u32 s46, s66, 245760
  buffer_load_dwordx4 v8, s[4:7], s46 offen  lds
  s_add_u32 m0, s51, 4096
  s_add_u32 s46, s66, 245888
  buffer_load_dwordx4 v8, s[4:7], s46 offen  lds
  s_add_u32 m0, s51, 8192
  s_add_u32 s46, s66, 246016
  buffer_load_dwordx4 v8, s[4:7], s46 offen  lds
  s_add_u32 m0, s51, 12288
  s_add_u32 s46, s66, 246144
  buffer_load_dwordx4 v8, s[4:7], s46 offen  lds
  s_add_u32 m0, s51, 16384
  s_add_u32 s46, s66, 246272
  buffer_load_dwordx4 v8, s[4:7], s46 offen  lds
  ds_read_b64_tr_b16 v[120:121], v9 offset:20480
  ds_read_b64_tr_b16 v[122:123], v9 offset:21504
  ds_read_b64_tr_b16 v[124:125], v9 offset:24576
  ds_read_b64_tr_b16 v[126:127], v9 offset:25600
  ds_read_b64_tr_b16 v[128:129], v9 offset:28672
  ds_read_b64_tr_b16 v[130:131], v9 offset:29696
  ds_read_b64_tr_b16 v[132:133], v9 offset:32768
  ds_read_b64_tr_b16 v[134:135], v9 offset:33792
  ds_read_b64_tr_b16 v[136:137], v9 offset:36864
  ds_read_b64_tr_b16 v[138:139], v9 offset:37888
  s_waitcnt lgkmcnt(0)
  v_mfma_f32_16x16x32_bf16 v[160:163], v[120:123], v[32:35], v[160:163]
  v_mfma_f32_16x16x32_bf16 v[164:167], v[124:127], v[32:35], v[164:167]
  v_mfma_f32_16x16x32_bf16 v[168:171], v[128:131], v[32:35], v[168:171]
  v_mfma_f32_16x16x32_bf16 v[172:175], v[132:135], v[32:35], v[172:175]
  v_mfma_f32_16x16x32_bf16 v[176:179], v[136:139], v[32:35], v[176:179]
  s_waitcnt vmcnt(20)
  s_barrier
  s_add_u32 m0, s51, 20480
  s_add_u32 s46, s66, 246400
  buffer_load_dwordx4 v8, s[4:7], s46 offen  lds
  s_add_u32 m0, s51, 24576
  s_add_u32 s46, s66, 246528
  buffer_load_dwordx4 v8, s[4:7], s46 offen  lds
  s_add_u32 m0, s51, 28672
  s_add_u32 s46, s66, 246656
  buffer_load_dwordx4 v8, s[4:7], s46 offen  lds
  s_add_u32 m0, s51, 32768
  s_add_u32 s46, s66, 246784
  buffer_load_dwordx4 v8, s[4:7], s46 offen  lds
  s_add_u32 m0, s51, 36864
  s_add_u32 s46, s66, 246912
  buffer_load_dwordx4 v8, s[4:7], s46 offen  lds
  ds_read_b64_tr_b16 v[100:101], v9 offset:40960
  ds_read_b64_tr_b16 v[102:103], v9 offset:41984
  ds_read_b64_tr_b16 v[104:105], v9 offset:45056
  ds_read_b64_tr_b16 v[106:107], v9 offset:46080
  ds_read_b64_tr_b16 v[108:109], v9 offset:49152
  ds_read_b64_tr_b16 v[110:111], v9 offset:50176
  ds_read_b64_tr_b16 v[112:113], v9 offset:53248
  ds_read_b64_tr_b16 v[114:115], v9 offset:54272
  ds_read_b64_tr_b16 v[116:117], v9 offset:57344
  ds_read_b64_tr_b16 v[118:119], v9 offset:58368
  s_waitcnt lgkmcnt(0)
  v_mfma_f32_16x16x32_bf16 v[140:143], v[100:103], v[36:39], v[140:143]
  v_mfma_f32_16x16x32_bf16 v[144:147], v[104:107], v[36:39], v[144:147]
  v_mfma_f32_16x16x32_bf16 v[148:151], v[108:111], v[36:39], v[148:151]
  v_mfma_f32_16x16x32_bf16 v[152:155], v[112:115], v[36:39], v[152:155]
  v_mfma_f32_16x16x32_bf16 v[156:159], v[116:119], v[36:39], v[156:159]
  s_waitcnt vmcnt(20)
  s_barrier
  s_add_u32 m0, s51, 40960
  s_add_u32 s46, s66, 286720
  buffer_load_dwordx4 v8, s[4:7], s46 offen  lds
  s_add_u32 m0, s51, 45056
  s_add_u32 s46, s66, 286848
  buffer_load_dwordx4 v8, s[4:7], s46 offen  lds
  s_add_u32 m0, s51, 49152
  s_add_u32 s46, s66, 286976
  buffer_load_dwordx4 v8, s[4:7], s46 offen  lds
  s_add_u32 m0, s51, 53248
  s_add_u32 s46, s66, 287104
  buffer_load_dwordx4 v8, s[4:7], s46 offen  lds
  s_add_u32 m0, s51, 57344
  s_add_u32 s46, s66, 287232
  buffer_load_dwordx4 v8, s[4:7], s46 offen  lds
  ds_read_b64_tr_b16 v[120:121], v9 offset:61440
  ds_read_b64_tr_b16 v[122:123], v9 offset:62464
  ds_read_b64_tr_b16 v[124:125], v10 offset:0
  ds_read_b64_tr_b16 v[126:127], v10 offset:1024
  ds_read_b64_tr_b16 v[128:129], v10 offset:4096
  ds_read_b64_tr_b16 v[130:131], v10 offset:5120
  ds_read_b64_tr_b16 v[132:133], v10 offset:8192
  ds_read_b64_tr_b16 v[134:135], v10 offset:9216
  ds_read_b64_tr_b16 v[136:137], v10 offset:12288
  ds_read_b64_tr_b16 v[138:139], v10 offset:13312
  s_waitcnt lgkmcnt(0)
  v_mfma_f32_16x16x32_bf16 v[160:163], v[120:123], v[36:39], v[160:163]
  v_mfma_f32_16x16x32_bf16 v[164:167], v[124:127], v[36:39], v[164:167]
  v_mfma_f32_16x16x32_bf16 v[168:171], v[128:131], v[36:39], v[168:171]
  v_mfma_f32_16x16x32_bf16 v[172:175], v[132:135], v[36:39], v[172:175]
  v_mfma_f32_16x16x32_bf16 v[176:179], v[136:139], v[36:39], v[176:179]
  s_waitcnt vmcnt(20)
  s_barrier
  s_add_u32 m0, s51, 61440
  s_add_u32 s46, s66, 287360
  buffer_load_dwordx4 v8, s[4:7], s46 offen  lds
  s_add_u32 m0, s51, 65536
  s_add_u32 s46, s66, 287488
  buffer_load_dwordx4 v8, s[4:7], s46 offen  lds
  s_add_u32 m0, s51, 69632
  s_add_u32 s46, s66, 287616
  buffer_load_dwordx4 v8, s[4:7], s46 offen  lds
  s_add_u32 m0, s51, 73728
  s_add_u32 s46, s66, 287744
  buffer_load_dwordx4 v8, s[4:7], s46 offen  lds
  s_add_u32 m0, s51, 77824
  s_add_u32 s46, s66, 287872
  buffer_load_dwordx4 v8, s[4:7], s46 offen  lds
  ds_read_b64_tr_b16 v[100:101], v10 offset:16384
  ds_read_b64_tr_b16 v[102:103], v10 offset:17408
  ds_read_b64_tr_b16 v[104:105], v10 offset:20480
  ds_read_b64_tr_b16 v[106:107], v10 offset:21504
  ds_read_b64_tr_b16 v[108:109], v10 offset:24576
  ds_read_b64_tr_b16 v[110:111], v10 offset:25600
  ds_read_b64_tr_b16 v[112:113], v10 offset:28672
  ds_read_b64_tr_b16 v[114:115], v10 offset:29696
  ds_read_b64_tr_b16 v[116:117], v10 offset:32768
  ds_read_b64_tr_b16 v[118:119], v10 offset:33792
  s_waitcnt lgkmcnt(0)
  v_mfma_f32_16x16x32_bf16 v[140:143], v[100:103], v[40:43], v[140:143]
  v_mfma_f32_16x16x32_bf16 v[144:147], v[104:107], v[40:43], v[144:147]
  v_mfma_f32_16x16x32_bf16 v[148:151], v[108:111], v[40:43], v[148:151]
  v_mfma_f32_16x16x32_bf16 v[152:155], v[112:115], v[40:43], v[152:155]
  v_mfma_f32_16x16x32_bf16 v[156:159], v[116:119], v[40:43], v[156:159]
  s_waitcnt vmcnt(20)
  s_barrier
  s_add_u32 m0, s51, 81920
  s_add_u32 s46, s66, 327680
  buffer_load_dwordx4 v8, s[4:7], s46 offen  lds
  s_add_u32 m0, s51, 86016
  s_add_u32 s46, s66, 327808
  buffer_load_dwordx4 v8, s[4:7], s46 offen  lds
  s_add_u32 m0, s51, 90112
  s_add_u32 s46, s66, 327936
  buffer_load_dwordx4 v8, s[4:7], s46 offen  lds
  s_add_u32 m0, s51, 94208
  s_add_u32 s46, s66, 328064
  buffer_load_dwordx4 v8, s[4:7], s46 offen  lds
  s_add_u32 m0, s51, 98304
  s_add_u32 s46, s66, 328192
  buffer_load_dwordx4 v8, s[4:7], s46 offen  lds
  ds_read_b64_tr_b16 v[120:121], v10 offset:36864
  ds_read_b64_tr_b16 v[122:123], v10 offset:37888
  ds_read_b64_tr_b16 v[124:125], v10 offset:40960
  ds_read_b64_tr_b16 v[126:127], v10 offset:41984
  ds_read_b64_tr_b16 v[128:129], v10 offset:45056
  ds_read_b64_tr_b16 v[130:131], v10 offset:46080
  ds_read_b64_tr_b16 v[132:133], v10 offset:49152
  ds_read_b64_tr_b16 v[134:135], v10 offset:50176
  ds_read_b64_tr_b16 v[136:137], v10 offset:53248
  ds_read_b64_tr_b16 v[138:139], v10 offset:54272
  s_waitcnt lgkmcnt(0)
  v_mfma_f32_16x16x32_bf16 v[160:163], v[120:123], v[40:43], v[160:163]
  v_mfma_f32_16x16x32_bf16 v[164:167], v[124:127], v[40:43], v[164:167]
  v_mfma_f32_16x16x32_bf16 v[168:171], v[128:131], v[40:43], v[168:171]
  v_mfma_f32_16x16x32_bf16 v[172:175], v[132:135], v[40:43], v[172:175]
  v_mfma_f32_16x16x32_bf16 v[176:179], v[136:139], v[40:43], v[176:179]
  s_waitcnt vmcnt(20)
  s_barrier
  s_add_u32 m0, s51, 102400
  s_add_u32 s46, s66, 328320
  buffer_load_dwordx4 v8, s[4:7], s46 offen  lds
  s_add_u32 m0, s51, 106496
  s_add_u32 s46, s66, 328448
  buffer_load_dwordx4 v8, s[4:7], s46 offen  lds
  s_add_u32 m0, s51, 110592
  s_add_u32 s46, s66, 328576
  buffer_load_dwordx4 v8, s[4:7], s46 offen  lds
  s_add_u32 m0, s51, 114688
  s_add_u32 s46, s66, 328704
  buffer_load_dwordx4 v8, s[4:7], s46 offen  lds
  s_add_u32 m0, s51, 118784
  s_add_u32 s46, s66, 328832
  buffer_load_dwordx4 v8, s[4:7], s46 offen  lds
  ds_read_b64_tr_b16 v[100:101], v9 offset:0
  ds_read_b64_tr_b16 v[102:103], v9 offset:1024
  ds_read_b64_tr_b16 v[104:105], v9 offset:4096
  ds_read_b64_tr_b16 v[106:107], v9 offset:5120
  ds_read_b64_tr_b16 v[108:109], v9 offset:8192
  ds_read_b64_tr_b16 v[110:111], v9 offset:9216
  ds_read_b64_tr_b16 v[112:113], v9 offset:12288
  ds_read_b64_tr_b16 v[114:115], v9 offset:13312
  ds_read_b64_tr_b16 v[116:117], v9 offset:16384
  ds_read_b64_tr_b16 v[118:119], v9 offset:17408
  s_waitcnt lgkmcnt(0)
  v_mfma_f32_16x16x32_bf16 v[140:143], v[100:103], v[44:47], v[140:143]
  v_mfma_f32_16x16x32_bf16 v[144:147], v[104:107], v[44:47], v[144:147]
  v_mfma_f32_16x16x32_bf16 v[148:151], v[108:111], v[44:47], v[148:151]
  v_mfma_f32_16x16x32_bf16 v[152:155], v[112:115], v[44:47], v[152:155]
  v_mfma_f32_16x16x32_bf16 v[156:159], v[116:119], v[44:47], v[156:159]
  s_waitcnt vmcnt(20)
  s_barrier
  s_add_u32 m0, s51, 0
  s_add_u32 s46, s66, 368640
  buffer_load_dwordx4 v8, s[4:7], s46 offen  lds
  s_add_u32 m0, s51, 4096
  s_add_u32 s46, s66, 368768
  buffer_load_dwordx4 v8, s[4:7], s46 offen  lds
  s_add_u32 m0, s51, 8192
  s_add_u32 s46, s66, 368896
  buffer_load_dwordx4 v8, s[4:7], s46 offen  lds
  s_add_u32 m0, s51, 12288
  s_add_u32 s46, s66, 369024
  buffer_load_dwordx4 v8, s[4:7], s46 offen  lds
  s_add_u32 m0, s51, 16384
  s_add_u32 s46, s66, 369152
  buffer_load_dwordx4 v8, s[4:7], s46 offen  lds
  ds_read_b64_tr_b16 v[120:121], v9 offset:20480
  ds_read_b64_tr_b16 v[122:123], v9 offset:21504
  ds_read_b64_tr_b16 v[124:125], v9 offset:24576
  ds_read_b64_tr_b16 v[126:127], v9 offset:25600
  ds_read_b64_tr_b16 v[128:129], v9 offset:28672
  ds_read_b64_tr_b16 v[130:131], v9 offset:29696
  ds_read_b64_tr_b16 v[132:133], v9 offset:32768
  ds_read_b64_tr_b16 v[134:135], v9 offset:33792
  ds_read_b64_tr_b16 v[136:137], v9 offset:36864
  ds_read_b64_tr_b16 v[138:139], v9 offset:37888
  s_waitcnt lgkmcnt(0)
  v_mfma_f32_16x16x32_bf16 v[160:163], v[120:123], v[44:47], v[160:163]
  v_mfma_f32_16x16x32_bf16 v[164:167], v[124:127], v[44:47], v[164:167]
  v_mfma_f32_16x16x32_bf16 v[168:171], v[128:131], v[44:47], v[168:171]
  v_mfma_f32_16x16x32_bf16 v[172:175], v[132:135], v[44:47], v[172:175]
  v_mfma_f32_16x16x32_bf16 v[176:179], v[136:139], v[44:47], v[176:179]
  s_waitcnt vmcnt(20)
  s_barrier
  s_add_u32 m0, s51, 20480
  s_add_u32 s46, s66, 369280
  buffer_load_dwordx4 v8, s[4:7], s46 offen  lds
  s_add_u32 m0, s51, 24576
  s_add_u32 s46, s66, 369408
  buffer_load_dwordx4 v8, s[4:7], s46 offen  lds
  s_add_u32 m0, s51, 28672
  s_add_u32 s46, s66, 369536
  buffer_load_dwordx4 v8, s[4:7], s46 offen  lds
  s_add_u32 m0, s51, 32768
  s_add_u32 s46, s66, 369664
  buffer_load_dwordx4 v8, s[4:7], s46 offen  lds
  s_add_u32 m0, s51, 36864
  s_add_u32 s46, s66, 369792
  buffer_load_dwordx4 v8, s[4:7], s46 offen  lds
  ds_read_b64_tr_b16 v[100:101], v9 offset:40960
  ds_read_b64_tr_b16 v[102:103], v9 offset:41984
  ds_read_b64_tr_b16 v[104:105], v9 offset:45056
  ds_read_b64_tr_b16 v[106:107], v9 offset:46080
  ds_read_b64_tr_b16 v[108:109], v9 offset:49152
  ds_read_b64_tr_b16 v[110:111], v9 offset:50176
  ds_read_b64_tr_b16 v[112:113], v9 offset:53248
  ds_read_b64_tr_b16 v[114:115], v9 offset:54272
  ds_read_b64_tr_b16 v[116:117], v9 offset:57344
  ds_read_b64_tr_b16 v[118:119], v9 offset:58368
  s_waitcnt lgkmcnt(0)
  v_mfma_f32_16x16x32_bf16 v[140:143], v[100:103], v[48:51], v[140:143]
  v_mfma_f32_16x16x32_bf16 v[144:147], v[104:107], v[48:51], v[144:147]
  v_mfma_f32_16x16x32_bf16 v[148:151], v[108:111], v[48:51], v[148:151]
  v_mfma_f32_16x16x32_bf16 v[152:155], v[112:115], v[48:51], v[152:155]
  v_mfma_f32_16x16x32_bf16 v[156:159], v[116:119], v[48:51], v[156:159]
  s_waitcnt vmcnt(20)
  s_barrier
  s_add_u32 m0, s51, 40960
  s_add_u32 s46, s66, 409600
  buffer_load_dwordx4 v8, s[4:7], s46 offen  lds
  s_add_u32 m0, s51, 45056
  s_add_u32 s46, s66, 409728
  buffer_load_dwordx4 v8, s[4:7], s46 offen  lds
  s_add_u32 m0, s51, 49152
  s_add_u32 s46, s66, 409856
  buffer_load_dwordx4 v8, s[4:7], s46 offen  lds
  s_add_u32 m0, s51, 53248
  s_add_u32 s46, s66, 409984
  buffer_load_dwordx4 v8, s[4:7], s46 offen  lds
  s_add_u32 m0, s51, 57344
  s_add_u32 s46, s66, 410112
  buffer_load_dwordx4 v8, s[4:7], s46 offen  lds
  ds_read_b64_tr_b16 v[120:121], v9 offset:61440
  ds_read_b64_tr_b16 v[122:123], v9 offset:62464
  ds_read_b64_tr_b16 v[124:125], v10 offset:0
  ds_read_b64_tr_b16 v[126:127], v10 offset:1024
  ds_read_b64_tr_b16 v[128:129], v10 offset:4096
  ds_read_b64_tr_b16 v[130:131], v10 offset:5120
  ds_read_b64_tr_b16 v[132:133], v10 offset:8192
  ds_read_b64_tr_b16 v[134:135], v10 offset:9216
  ds_read_b64_tr_b16 v[136:137], v10 offset:12288
  ds_read_b64_tr_b16 v[138:139], v10 offset:13312
  s_waitcnt lgkmcnt(0)
  v_mfma_f32_16x16x32_bf16 v[160:163], v[120:123], v[48:51], v[160:163]
  v_mfma_f32_16x16x32_bf16 v[164:167], v[124:127], v[48:51], v[164:167]
  v_mfma_f32_16x16x32_bf16 v[168:171], v[128:131], v[48:51], v[168:171]
  v_mfma_f32_16x16x32_bf16 v[172:175], v[132:135], v[48:51], v[172:175]
  v_mfma_f32_16x16x32_bf16 v[176:179], v[136:139], v[48:51], v[176:179]
  s_waitcnt vmcnt(20)
  s_barrier
  s_add_u32 m0, s51, 61440
  s_add_u32 s46, s66, 410240
  buffer_load_dwordx4 v8, s[4:7], s46 offen  lds
  s_add_u32 m0, s51, 65536
  s_add_u32 s46, s66, 410368
  buffer_load_dwordx4 v8, s[4:7], s46 offen  lds
  s_add_u32 m0, s51, 69632
  s_add_u32 s46, s66, 410496
  buffer_load_dwordx4 v8, s[4:7], s46 offen  lds
  s_add_u32 m0, s51, 73728
  s_add_u32 s46, s66, 410624
  buffer_load_dwordx4 v8, s[4:7], s46 offen  lds
  s_add_u32 m0, s51, 77824
  s_add_u32 s46, s66, 410752
  buffer_load_dwordx4 v8, s[4:7], s46 offen  lds
  ds_read_b64_tr_b16 v[100:101], v10 offset:16384
  ds_read_b64_tr_b16 v[102:103], v10 offset:17408
  ds_read_b64_tr_b16 v[104:105], v10 offset:20480
  ds_read_b64_tr_b16 v[106:107], v10 offset:21504
  ds_read_b64_tr_b16 v[108:109], v10 offset:24576
  ds_read_b64_tr_b16 v[110:111], v10 offset:25600
  ds_read_b64_tr_b16 v[112:113], v10 offset:28672
  ds_read_b64_tr_b16 v[114:115], v10 offset:29696
  ds_read_b64_tr_b16 v[116:117], v10 offset:32768
  ds_read_b64_tr_b16 v[118:119], v10 offset:33792
  s_waitcnt lgkmcnt(0)
  v_mfma_f32_16x16x32_bf16 v[140:143], v[100:103], v[52:55], v[140:143]
  v_mfma_f32_16x16x32_bf16 v[144:147], v[104:107], v[52:55], v[144:147]
  v_mfma_f32_16x16x32_bf16 v[148:151], v[108:111], v[52:55], v[148:151]
  v_mfma_f32_16x16x32_bf16 v[152:155], v[112:115], v[52:55], v[152:155]
  v_mfma_f32_16x16x32_bf16 v[156:159], v[116:119], v[52:55], v[156:159]
  s_waitcnt vmcnt(20)
  s_barrier
  s_add_u32 m0, s51, 81920
  s_add_u32 s46, s66, 450560
  buffer_load_dwordx4 v8, s[4:7], s46 offen  lds
  s_add_u32 m0, s51, 86016
  s_add_u32 s46, s66, 450688
  buffer_load_dwordx4 v8, s[4:7], s46 offen  lds
  s_add_u32 m0, s51, 90112
  s_add_u32 s46, s66, 450816
  buffer_load_dwordx4 v8, s[4:7], s46 offen  lds
  s_add_u32 m0, s51, 94208
  s_add_u32 s46, s66, 450944
  buffer_load_dwordx4 v8, s[4:7], s46 offen  lds
  s_add_u32 m0, s51, 98304
  s_add_u32 s46, s66, 451072
  buffer_load_dwordx4 v8, s[4:7], s46 offen  lds
  ds_read_b64_tr_b16 v[120:121], v10 offset:36864
  ds_read_b64_tr_b16 v[122:123], v10 offset:37888
  ds_read_b64_tr_b16 v[124:125], v10 offset:40960
  ds_read_b64_tr_b16 v[126:127], v10 offset:41984
  ds_read_b64_tr_b16 v[128:129], v10 offset:45056
  ds_read_b64_tr_b16 v[130:131], v10 offset:46080
  ds_read_b64_tr_b16 v[132:133], v10 offset:49152
  ds_read_b64_tr_b16 v[134:135], v10 offset:50176
  ds_read_b64_tr_b16 v[136:137], v10 offset:53248
  ds_read_b64_tr_b16 v[138:139], v10 offset:54272
  s_waitcnt lgkmcnt(0)
  v_mfma_f32_16x16x32_bf16 v[160:163], v[120:123], v[52:55], v[160:163]
  v_mfma_f32_16x16x32_bf16 v[164:167], v[124:127], v[52:55], v[164:167]
  v_mfma_f32_16x16x32_bf16 v[168:171], v[128:131], v[52:55], v[168:171]
  v_mfma_f32_16x16x32_bf16 v[172:175], v[132:135], v[52:55], v[172:175]
  v_mfma_f32_16x16x32_bf16 v[176:179], v[136:139], v[52:55], v[176:179]
  s_waitcnt vmcnt(20)
  s_barrier
  s_add_u32 m0, s51, 102400
  s_add_u32 s46, s66, 451200
  buffer_load_dwordx4 v8, s[4:7], s46 offen  lds
  s_add_u32 m0, s51, 106496
  s_add_u32 s46, s66, 451328
  buffer_load_dwordx4 v8, s[4:7], s46 offen  lds
  s_add_u32 m0, s51, 110592
  s_add_u32 s46, s66, 451456
  buffer_load_dwordx4 v8, s[4:7], s46 offen  lds
  s_add_u32 m0, s51, 114688
  s_add_u32 s46, s66, 451584
  buffer_load_dwordx4 v8, s[4:7], s46 offen  lds
  s_add_u32 m0, s51, 118784
  s_add_u32 s46, s66, 451712
  buffer_load_dwordx4 v8, s[4:7], s46 offen  lds
  ds_read_b64_tr_b16 v[100:101], v9 offset:0
  ds_read_b64_tr_b16 v[102:103], v9 offset:1024
  ds_read_b64_tr_b16 v[104:105], v9 offset:4096
  ds_read_b64_tr_b16 v[106:107], v9 offset:5120
  ds_read_b64_tr_b16 v[108:109], v9 offset:8192
  ds_read_b64_tr_b16 v[110:111], v9 offset:9216
  ds_read_b64_tr_b16 v[112:113], v9 offset:12288
  ds_read_b64_tr_b16 v[114:115], v9 offset:13312
  ds_read_b64_tr_b16 v[116:117], v9 offset:16384
  ds_read_b64_tr_b16 v[118:119], v9 offset:17408
  s_waitcnt lgkmcnt(0)
  v_mfma_f32_16x16x32_bf16 v[140:143], v[100:103], v[56:59], v[140:143]
  v_mfma_f32_16x16x32_bf16 v[144:147], v[104:107], v[56:59], v[144:147]
  v_mfma_f32_16x16x32_bf16 v[148:151], v[108:111], v[56:59], v[148:151]
  v_mfma_f32_16x16x32_bf16 v[152:155], v[112:115], v[56:59], v[152:155]
  v_mfma_f32_16x16x32_bf16 v[156:159], v[116:119], v[56:59], v[156:159]
  s_waitcnt vmcnt(20)
  s_barrier
  s_add_u32 m0, s51, 0
  s_add_u32 s46, s66, 491520
  buffer_load_dwordx4 v8, s[4:7], s46 offen  lds
  s_add_u32 m0, s51, 4096
  s_add_u32 s46, s66, 491648
  buffer_load_dwordx4 v8, s[4:7], s46 offen  lds
  s_add_u32 m0, s51, 8192
  s_add_u32 s46, s66, 491776
  buffer_load_dwordx4 v8, s[4:7], s46 offen  lds
  s_add_u32 m0, s51, 12288
  s_add_u32 s46, s66, 491904
  buffer_load_dwordx4 v8, s[4:7], s46 offen  lds
  s_add_u32 m0, s51, 16384
  s_add_u32 s46, s66, 492032
  buffer_load_dwordx4 v8, s[4:7], s46 offen  lds
  ds_read_b64_tr_b16 v[120:121], v9 offset:20480
  ds_read_b64_tr_b16 v[122:123], v9 offset:21504
  ds_read_b64_tr_b16 v[124:125], v9 offset:24576
  ds_read_b64_tr_b16 v[126:127], v9 offset:25600
  ds_read_b64_tr_b16 v[128:129], v9 offset:28672
  ds_read_b64_tr_b16 v[130:131], v9 offset:29696
  ds_read_b64_tr_b16 v[132:133], v9 offset:32768
  ds_read_b64_tr_b16 v[134:135], v9 offset:33792
  ds_read_b64_tr_b16 v[136:137], v9 offset:36864
  ds_read_b64_tr_b16 v[138:139], v9 offset:37888
  s_waitcnt lgkmcnt(0)
  v_mfma_f32_16x16x32_bf16 v[160:163], v[120:123], v[56:59], v[160:163]
  v_mfma_f32_16x16x32_bf16 v[164:167], v[124:127], v[56:59], v[164:167]
  v_mfma_f32_16x16x32_bf16 v[168:171], v[128:131], v[56:59], v[168:171]
  v_mfma_f32_16x16x32_bf16 v[172:175], v[132:135], v[56:59], v[172:175]
  v_mfma_f32_16x16x32_bf16 v[176:179], v[136:139], v[56:59], v[176:179]
  s_waitcnt vmcnt(20)
  s_barrier
  s_add_u32 m0, s51, 20480
  s_add_u32 s46, s66, 492160
  buffer_load_dwordx4 v8, s[4:7], s46 offen  lds
  s_add_u32 m0, s51, 24576
  s_add_u32 s46, s66, 492288
  buffer_load_dwordx4 v8, s[4:7], s46 offen  lds
  s_add_u32 m0, s51, 28672
  s_add_u32 s46, s66, 492416
  buffer_load_dwordx4 v8, s[4:7], s46 offen  lds
  s_add_u32 m0, s51, 32768
  s_add_u32 s46, s66, 492544
  buffer_load_dwordx4 v8, s[4:7], s46 offen  lds
  s_add_u32 m0, s51, 36864
  s_add_u32 s46, s66, 492672
  buffer_load_dwordx4 v8, s[4:7], s46 offen  lds
  ds_read_b64_tr_b16 v[100:101], v9 offset:40960
  ds_read_b64_tr_b16 v[102:103], v9 offset:41984
  ds_read_b64_tr_b16 v[104:105], v9 offset:45056
  ds_read_b64_tr_b16 v[106:107], v9 offset:46080
  ds_read_b64_tr_b16 v[108:109], v9 offset:49152
  ds_read_b64_tr_b16 v[110:111], v9 offset:50176
  ds_read_b64_tr_b16 v[112:113], v9 offset:53248
  ds_read_b64_tr_b16 v[114:115], v9 offset:54272
  ds_read_b64_tr_b16 v[116:117], v9 offset:57344
  ds_read_b64_tr_b16 v[118:119], v9 offset:58368
  s_waitcnt lgkmcnt(0)
  v_mfma_f32_16x16x32_bf16 v[140:143], v[100:103], v[60:63], v[140:143]
  v_mfma_f32_16x16x32_bf16 v[144:147], v[104:107], v[60:63], v[144:147]
  v_mfma_f32_16x16x32_bf16 v[148:151], v[108:111], v[60:63], v[148:151]
  v_mfma_f32_16x16x32_bf16 v[152:155], v[112:115], v[60:63], v[152:155]
  v_mfma_f32_16x16x32_bf16 v[156:159], v[116:119], v[60:63], v[156:159]
  s_waitcnt vmcnt(20)
  s_barrier
  s_add_u32 m0, s51, 40960
  s_add_u32 s46, s66, 532480
  buffer_load_dwordx4 v8, s[4:7], s46 offen  lds
  s_add_u32 m0, s51, 45056
  s_add_u32 s46, s66, 532608
  buffer_load_dwordx4 v8, s[4:7], s46 offen  lds
  s_add_u32 m0, s51, 49152
  s_add_u32 s46, s66, 532736
  buffer_load_dwordx4 v8, s[4:7], s46 offen  lds
  s_add_u32 m0, s51, 53248
  s_add_u32 s46, s66, 532864
  buffer_load_dwordx4 v8, s[4:7], s46 offen  lds
  s_add_u32 m0, s51, 57344
  s_add_u32 s46, s66, 532992
  buffer_load_dwordx4 v8, s[4:7], s46 offen  lds
  ds_read_b64_tr_b16 v[120:121], v9 offset:61440
  ds_read_b64_tr_b16 v[122:123], v9 offset:62464
  ds_read_b64_tr_b16 v[124:125], v10 offset:0
  ds_read_b64_tr_b16 v[126:127], v10 offset:1024
  ds_read_b64_tr_b16 v[128:129], v10 offset:4096
  ds_read_b64_tr_b16 v[130:131], v10 offset:5120
  ds_read_b64_tr_b16 v[132:133], v10 offset:8192
  ds_read_b64_tr_b16 v[134:135], v10 offset:9216
  ds_read_b64_tr_b16 v[136:137], v10 offset:12288
  ds_read_b64_tr_b16 v[138:139], v10 offset:13312
  s_waitcnt lgkmcnt(0)
  v_mfma_f32_16x16x32_bf16 v[160:163], v[120:123], v[60:63], v[160:163]
  v_mfma_f32_16x16x32_bf16 v[164:167], v[124:127], v[60:63], v[164:167]
  v_mfma_f32_16x16x32_bf16 v[168:171], v[128:131], v[60:63], v[168:171]
  v_mfma_f32_16x16x32_bf16 v[172:175], v[132:135], v[60:63], v[172:175]
  v_mfma_f32_16x16x32_bf16 v[176:179], v[136:139], v[60:63], v[176:179]
  s_waitcnt vmcnt(20)
  s_barrier
  s_add_u32 m0, s51, 61440
  s_add_u32 s46, s66, 533120
  buffer_load_dwordx4 v8, s[4:7], s46 offen  lds
  s_add_u32 m0, s51, 65536
  s_add_u32 s46, s66, 533248
  buffer_load_dwordx4 v8, s[4:7], s46 offen  lds
  s_add_u32 m0, s51, 69632
  s_add_u32 s46, s66, 533376
  buffer_load_dwordx4 v8, s[4:7], s46 offen  lds
  s_add_u32 m0, s51, 73728
  s_add_u32 s46, s66, 533504
  buffer_load_dwordx4 v8, s[4:7], s46 offen  lds
  s_add_u32 m0, s51, 77824
  s_add_u32 s46, s66, 533632
  buffer_load_dwordx4 v8, s[4:7], s46 offen  lds
  ds_read_b64_tr_b16 v[100:101], v10 offset:16384
  ds_read_b64_tr_b16 v[102:103], v10 offset:17408
  ds_read_b64_tr_b16 v[104:105], v10 offset:20480
  ds_read_b64_tr_b16 v[106:107], v10 offset:21504
  ds_read_b64_tr_b16 v[108:109], v10 offset:24576
  ds_read_b64_tr_b16 v[110:111], v10 offset:25600
  ds_read_b64_tr_b16 v[112:113], v10 offset:28672
  ds_read_b64_tr_b16 v[114:115], v10 offset:29696
  ds_read_b64_tr_b16 v[116:117], v10 offset:32768
  ds_read_b64_tr_b16 v[118:119], v10 offset:33792
  s_waitcnt lgkmcnt(0)
  v_mfma_f32_16x16x32_bf16 v[140:143], v[100:103], v[64:67], v[140:143]
  v_mfma_f32_16x16x32_bf16 v[144:147], v[104:107], v[64:67], v[144:147]
  v_mfma_f32_16x16x32_bf16 v[148:151], v[108:111], v[64:67], v[148:151]
  v_mfma_f32_16x16x32_bf16 v[152:155], v[112:115], v[64:67], v[152:155]
  v_mfma_f32_16x16x32_bf16 v[156:159], v[116:119], v[64:67], v[156:159]
  s_waitcnt vmcnt(20)
  s_barrier
  s_add_u32 m0, s51, 81920
  s_add_u32 s46, s66, 573440
  buffer_load_dwordx4 v8, s[4:7], s46 offen  lds
  s_add_u32 m0, s51, 86016
  s_add_u32 s46, s66, 573568
  buffer_load_dwordx4 v8, s[4:7], s46 offen  lds
  s_add_u32 m0, s51, 90112
  s_add_u32 s46, s66, 573696
  buffer_load_dwordx4 v8, s[4:7], s46 offen  lds
  s_add_u32 m0, s51, 94208
  s_add_u32 s46, s66, 573824
  buffer_load_dwordx4 v8, s[4:7], s46 offen  lds
  s_add_u32 m0, s51, 98304
  s_add_u32 s46, s66, 573952
  buffer_load_dwordx4 v8, s[4:7], s46 offen  lds
  ds_read_b64_tr_b16 v[120:121], v10 offset:36864
  ds_read_b64_tr_b16 v[122:123], v10 offset:37888
  ds_read_b64_tr_b16 v[124:125], v10 offset:40960
  ds_read_b64_tr_b16 v[126:127], v10 offset:41984
  ds_read_b64_tr_b16 v[128:129], v10 offset:45056
  ds_read_b64_tr_b16 v[130:131], v10 offset:46080
  ds_read_b64_tr_b16 v[132:133], v10 offset:49152
  ds_read_b64_tr_b16 v[134:135], v10 offset:50176
  ds_read_b64_tr_b16 v[136:137], v10 offset:53248
  ds_read_b64_tr_b16 v[138:139], v10 offset:54272
  s_waitcnt lgkmcnt(0)
  v_mfma_f32_16x16x32_bf16 v[160:163], v[120:123], v[64:67], v[160:163]
  v_mfma_f32_16x16x32_bf16 v[164:167], v[124:127], v[64:67], v[164:167]
  v_mfma_f32_16x16x32_bf16 v[168:171], v[128:131], v[64:67], v[168:171]
  v_mfma_f32_16x16x32_bf16 v[172:175], v[132:135], v[64:67], v[172:175]
  v_mfma_f32_16x16x32_bf16 v[176:179], v[136:139], v[64:67], v[176:179]
  s_waitcnt vmcnt(20)
  s_barrier
  s_add_u32 m0, s51, 102400
  s_add_u32 s46, s66, 574080
  buffer_load_dwordx4 v8, s[4:7], s46 offen  lds
  s_add_u32 m0, s51, 106496
  s_add_u32 s46, s66, 574208
  buffer_load_dwordx4 v8, s[4:7], s46 offen  lds
  s_add_u32 m0, s51, 110592
  s_add_u32 s46, s66, 574336
  buffer_load_dwordx4 v8, s[4:7], s46 offen  lds
  s_add_u32 m0, s51, 114688
  s_add_u32 s46, s66, 574464
  buffer_load_dwordx4 v8, s[4:7], s46 offen  lds
  s_add_u32 m0, s51, 118784
  s_add_u32 s46, s66, 574592
  buffer_load_dwordx4 v8, s[4:7], s46 offen  lds
  ds_read_b64_tr_b16 v[100:101], v9 offset:0
  ds_read_b64_tr_b16 v[102:103], v9 offset:1024
  ds_read_b64_tr_b16 v[104:105], v9 offset:4096
  ds_read_b64_tr_b16 v[106:107], v9 offset:5120
  ds_read_b64_tr_b16 v[108:109], v9 offset:8192
  ds_read_b64_tr_b16 v[110:111], v9 offset:9216
  ds_read_b64_tr_b16 v[112:113], v9 offset:12288
  ds_read_b64_tr_b16 v[114:115], v9 offset:13312
  ds_read_b64_tr_b16 v[116:117], v9 offset:16384
  ds_read_b64_tr_b16 v[118:119], v9 offset:17408
  s_waitcnt lgkmcnt(0)
  v_mfma_f32_16x16x32_bf16 v[140:143], v[100:103], v[68:71], v[140:143]
  v_mfma_f32_16x16x32_bf16 v[144:147], v[104:107], v[68:71], v[144:147]
  v_mfma_f32_16x16x32_bf16 v[148:151], v[108:111], v[68:71], v[148:151]
  v_mfma_f32_16x16x32_bf16 v[152:155], v[112:115], v[68:71], v[152:155]
  v_mfma_f32_16x16x32_bf16 v[156:159], v[116:119], v[68:71], v[156:159]
  s_waitcnt vmcnt(20)
  s_barrier
  s_add_u32 m0, s51, 0
  s_add_u32 s46, s66, 614400
  buffer_load_dwordx4 v8, s[4:7], s46 offen  lds
  s_add_u32 m0, s51, 4096
  s_add_u32 s46, s66, 614528
  buffer_load_dwordx4 v8, s[4:7], s46 offen  lds
  s_add_u32 m0, s51, 8192
  s_add_u32 s46, s66, 614656
  buffer_load_dwordx4 v8, s[4:7], s46 offen  lds
  s_add_u32 m0, s51, 12288
  s_add_u32 s46, s66, 614784
  buffer_load_dwordx4 v8, s[4:7], s46 offen  lds
  s_add_u32 m0, s51, 16384
  s_add_u32 s46, s66, 614912
  buffer_load_dwordx4 v8, s[4:7], s46 offen  lds
  ds_read_b64_tr_b16 v[120:121], v9 offset:20480
  ds_read_b64_tr_b16 v[122:123], v9 offset:21504
  ds_read_b64_tr_b16 v[124:125], v9 offset:24576
  ds_read_b64_tr_b16 v[126:127], v9 offset:25600
  ds_read_b64_tr_b16 v[128:129], v9 offset:28672
  ds_read_b64_tr_b16 v[130:131], v9 offset:29696
  ds_read_b64_tr_b16 v[132:133], v9 offset:32768
  ds_read_b64_tr_b16 v[134:135], v9 offset:33792
  ds_read_b64_tr_b16 v[136:137], v9 offset:36864
  ds_read_b64_tr_b16 v[138:139], v9 offset:37888
  s_waitcnt lgkmcnt(0)
  v_mfma_f32_16x16x32_bf16 v[160:163], v[120:123], v[68:71], v[160:163]
  v_mfma_f32_16x16x32_bf16 v[164:167], v[124:127], v[68:71], v[164:167]
  v_mfma_f32_16x16x32_bf16 v[168:171], v[128:131], v[68:71], v[168:171]
  v_mfma_f32_16x16x32_bf16 v[172:175], v[132:135], v[68:71], v[172:175]
  v_mfma_f32_16x16x32_bf16 v[176:179], v[136:139], v[68:71], v[176:179]
  s_waitcnt vmcnt(20)
  s_barrier
  s_add_u32 m0, s51, 20480
  s_add_u32 s46, s66, 615040
  buffer_load_dwordx4 v8, s[4:7], s46 offen  lds
  s_add_u32 m0, s51, 24576
  s_add_u32 s46, s66, 615168
  buffer_load_dwordx4 v8, s[4:7], s46 offen  lds
  s_add_u32 m0, s51, 28672
  s_add_u32 s46, s66, 615296
  buffer_load_dwordx4 v8, s[4:7], s46 offen  lds
  s_add_u32 m0, s51, 32768
  s_add_u32 s46, s66, 615424
  buffer_load_dwordx4 v8, s[4:7], s46 offen  lds
  s_add_u32 m0, s51, 36864
  s_add_u32 s46, s66, 615552
  buffer_load_dwordx4 v8, s[4:7], s46 offen  lds
  ds_read_b64_tr_b16 v[100:101], v9 offset:40960
  ds_read_b64_tr_b16 v[102:103], v9 offset:41984
  ds_read_b64_tr_b16 v[104:105], v9 offset:45056
  ds_read_b64_tr_b16 v[106:107], v9 offset:46080
  ds_read_b64_tr_b16 v[108:109], v9 offset:49152
  ds_read_b64_tr_b16 v[110:111], v9 offset:50176
  ds_read_b64_tr_b16 v[112:113], v9 offset:53248
  ds_read_b64_tr_b16 v[114:115], v9 offset:54272
  ds_read_b64_tr_b16 v[116:117], v9 offset:57344
  ds_read_b64_tr_b16 v[118:119], v9 offset:58368
  s_waitcnt lgkmcnt(0)
  v_mfma_f32_16x16x32_bf16 v[140:143], v[100:103], v[72:75], v[140:143]
  v_mfma_f32_16x16x32_bf16 v[144:147], v[104:107], v[72:75], v[144:147]
  v_mfma_f32_16x16x32_bf16 v[148:151], v[108:111], v[72:75], v[148:151]
  v_mfma_f32_16x16x32_bf16 v[152:155], v[112:115], v[72:75], v[152:155]
  v_mfma_f32_16x16x32_bf16 v[156:159], v[116:119], v[72:75], v[156:159]
  s_waitcnt vmcnt(20)
  s_barrier
  s_add_u32 m0, s51, 40960
  s_add_u32 s46, s66, 655360
  buffer_load_dwordx4 v8, s[4:7], s46 offen  lds
  s_add_u32 m0, s51, 45056
  s_add_u32 s46, s66, 655488
  buffer_load_dwordx4 v8, s[4:7], s46 offen  lds
  s_add_u32 m0, s51, 49152
  s_add_u32 s46, s66, 655616
  buffer_load_dwordx4 v8, s[4:7], s46 offen  lds
  s_add_u32 m0, s51, 53248
  s_add_u32 s46, s66, 655744
  buffer_load_dwordx4 v8, s[4:7], s46 offen  lds
  s_add_u32 m0, s51, 57344
  s_add_u32 s46, s66, 655872
  buffer_load_dwordx4 v8, s[4:7], s46 offen  lds
  ds_read_b64_tr_b16 v[120:121], v9 offset:61440
  ds_read_b64_tr_b16 v[122:123], v9 offset:62464
  ds_read_b64_tr_b16 v[124:125], v10 offset:0
  ds_read_b64_tr_b16 v[126:127], v10 offset:1024
  ds_read_b64_tr_b16 v[128:129], v10 offset:4096
  ds_read_b64_tr_b16 v[130:131], v10 offset:5120
  ds_read_b64_tr_b16 v[132:133], v10 offset:8192
  ds_read_b64_tr_b16 v[134:135], v10 offset:9216
  ds_read_b64_tr_b16 v[136:137], v10 offset:12288
  ds_read_b64_tr_b16 v[138:139], v10 offset:13312
  s_waitcnt lgkmcnt(0)
  v_mfma_f32_16x16x32_bf16 v[160:163], v[120:123], v[72:75], v[160:163]
  v_mfma_f32_16x16x32_bf16 v[164:167], v[124:127], v[72:75], v[164:167]
  v_mfma_f32_16x16x32_bf16 v[168:171], v[128:131], v[72:75], v[168:171]
  v_mfma_f32_16x16x32_bf16 v[172:175], v[132:135], v[72:75], v[172:175]
  v_mfma_f32_16x16x32_bf16 v[176:179], v[136:139], v[72:75], v[176:179]
  s_waitcnt vmcnt(20)
  s_barrier
  s_add_u32 m0, s51, 61440
  s_add_u32 s46, s66, 656000
  buffer_load_dwordx4 v8, s[4:7], s46 offen  lds
  s_add_u32 m0, s51, 65536
  s_add_u32 s46, s66, 656128
  buffer_load_dwordx4 v8, s[4:7], s46 offen  lds
  s_add_u32 m0, s51, 69632
  s_add_u32 s46, s66, 656256
  buffer_load_dwordx4 v8, s[4:7], s46 offen  lds
  s_add_u32 m0, s51, 73728
  s_add_u32 s46, s66, 656384
  buffer_load_dwordx4 v8, s[4:7], s46 offen  lds
  s_add_u32 m0, s51, 77824
  s_add_u32 s46, s66, 656512
  buffer_load_dwordx4 v8, s[4:7], s46 offen  lds
  ds_read_b64_tr_b16 v[100:101], v10 offset:16384
  ds_read_b64_tr_b16 v[102:103], v10 offset:17408
  ds_read_b64_tr_b16 v[104:105], v10 offset:20480
  ds_read_b64_tr_b16 v[106:107], v10 offset:21504
  ds_read_b64_tr_b16 v[108:109], v10 offset:24576
  ds_read_b64_tr_b16 v[110:111], v10 offset:25600
  ds_read_b64_tr_b16 v[112:113], v10 offset:28672
  ds_read_b64_tr_b16 v[114:115], v10 offset:29696
  ds_read_b64_tr_b16 v[116:117], v10 offset:32768
  ds_read_b64_tr_b16 v[118:119], v10 offset:33792
  s_waitcnt lgkmcnt(0)
  v_mfma_f32_16x16x32_bf16 v[140:143], v[100:103], v[76:79], v[140:143]
  v_mfma_f32_16x16x32_bf16 v[144:147], v[104:107], v[76:79], v[144:147]
  v_mfma_f32_16x16x32_bf16 v[148:151], v[108:111], v[76:79], v[148:151]
  v_mfma_f32_16x16x32_bf16 v[152:155], v[112:115], v[76:79], v[152:155]
  v_mfma_f32_16x16x32_bf16 v[156:159], v[116:119], v[76:79], v[156:159]
  s_waitcnt vmcnt(20)
  s_barrier
  s_add_u32 m0, s51, 81920
  s_add_u32 s46, s66, 696320
  buffer_load_dwordx4 v8, s[4:7], s46 offen  lds
  s_add_u32 m0, s51, 86016
  s_add_u32 s46, s66, 696448
  buffer_load_dwordx4 v8, s[4:7], s46 offen  lds
  s_add_u32 m0, s51, 90112
  s_add_u32 s46, s66, 696576
  buffer_load_dwordx4 v8, s[4:7], s46 offen  lds
  s_add_u32 m0, s51, 94208
  s_add_u32 s46, s66, 696704
  buffer_load_dwordx4 v8, s[4:7], s46 offen  lds
  s_add_u32 m0, s51, 98304
  s_add_u32 s46, s66, 696832
  buffer_load_dwordx4 v8, s[4:7], s46 offen  lds
  ds_read_b64_tr_b16 v[120:121], v10 offset:36864
  ds_read_b64_tr_b16 v[122:123], v10 offset:37888
  ds_read_b64_tr_b16 v[124:125], v10 offset:40960
  ds_read_b64_tr_b16 v[126:127], v10 offset:41984
  ds_read_b64_tr_b16 v[128:129], v10 offset:45056
  ds_read_b64_tr_b16 v[130:131], v10 offset:46080
  ds_read_b64_tr_b16 v[132:133], v10 offset:49152
  ds_read_b64_tr_b16 v[134:135], v10 offset:50176
  ds_read_b64_tr_b16 v[136:137], v10 offset:53248
  ds_read_b64_tr_b16 v[138:139], v10 offset:54272
  s_waitcnt lgkmcnt(0)
  v_mfma_f32_16x16x32_bf16 v[160:163], v[120:123], v[76:79], v[160:163]
  v_mfma_f32_16x16x32_bf16 v[164:167], v[124:127], v[76:79], v[164:167]
  v_mfma_f32_16x16x32_bf16 v[168:171], v[128:131], v[76:79], v[168:171]
  v_mfma_f32_16x16x32_bf16 v[172:175], v[132:135], v[76:79], v[172:175]
  v_mfma_f32_16x16x32_bf16 v[176:179], v[136:139], v[76:79], v[176:179]
  s_waitcnt vmcnt(20)
  s_barrier
  s_add_u32 m0, s51, 102400
  s_add_u32 s46, s66, 696960
  buffer_load_dwordx4 v8, s[4:7], s46 offen  lds
  s_add_u32 m0, s51, 106496
  s_add_u32 s46, s66, 697088
  buffer_load_dwordx4 v8, s[4:7], s46 offen  lds
  s_add_u32 m0, s51, 110592
  s_add_u32 s46, s66, 697216
  buffer_load_dwordx4 v8, s[4:7], s46 offen  lds
  s_add_u32 m0, s51, 114688
  s_add_u32 s46, s66, 697344
  buffer_load_dwordx4 v8, s[4:7], s46 offen  lds
  s_add_u32 m0, s51, 118784
  s_add_u32 s46, s66, 697472
  buffer_load_dwordx4 v8, s[4:7], s46 offen  lds
  ds_read_b64_tr_b16 v[100:101], v9 offset:0
  ds_read_b64_tr_b16 v[102:103], v9 offset:1024
  ds_read_b64_tr_b16 v[104:105], v9 offset:4096
  ds_read_b64_tr_b16 v[106:107], v9 offset:5120
  ds_read_b64_tr_b16 v[108:109], v9 offset:8192
  ds_read_b64_tr_b16 v[110:111], v9 offset:9216
  ds_read_b64_tr_b16 v[112:113], v9 offset:12288
  ds_read_b64_tr_b16 v[114:115], v9 offset:13312
  ds_read_b64_tr_b16 v[116:117], v9 offset:16384
  ds_read_b64_tr_b16 v[118:119], v9 offset:17408
  s_waitcnt lgkmcnt(0)
  v_mfma_f32_16x16x32_bf16 v[140:143], v[100:103], v[80:83], v[140:143]
  v_mfma_f32_16x16x32_bf16 v[144:147], v[104:107], v[80:83], v[144:147]
  v_mfma_f32_16x16x32_bf16 v[148:151], v[108:111], v[80:83], v[148:151]
  v_mfma_f32_16x16x32_bf16 v[152:155], v[112:115], v[80:83], v[152:155]
  v_mfma_f32_16x16x32_bf16 v[156:159], v[116:119], v[80:83], v[156:159]
  s_waitcnt vmcnt(20)
  s_barrier
  s_add_u32 m0, s51, 0
  s_add_u32 s46, s66, 737280
  buffer_load_dwordx4 v8, s[4:7], s46 offen  lds
  s_add_u32 m0, s51, 4096
  s_add_u32 s46, s66, 737408
  buffer_load_dwordx4 v8, s[4:7], s46 offen  lds
  s_add_u32 m0, s51, 8192
  s_add_u32 s46, s66, 737536
  buffer_load_dwordx4 v8, s[4:7], s46 offen  lds
  s_add_u32 m0, s51, 12288
  s_add_u32 s46, s66, 737664
  buffer_load_dwordx4 v8, s[4:7], s46 offen  lds
  s_add_u32 m0, s51, 16384
  s_add_u32 s46, s66, 737792
  buffer_load_dwordx4 v8, s[4:7], s46 offen  lds
  ds_read_b64_tr_b16 v[120:121], v9 offset:20480
  ds_read_b64_tr_b16 v[122:123], v9 offset:21504
  ds_read_b64_tr_b16 v[124:125], v9 offset:24576
  ds_read_b64_tr_b16 v[126:127], v9 offset:25600
  ds_read_b64_tr_b16 v[128:129], v9 offset:28672
  ds_read_b64_tr_b16 v[130:131], v9 offset:29696
  ds_read_b64_tr_b16 v[132:133], v9 offset:32768
  ds_read_b64_tr_b16 v[134:135], v9 offset:33792
  ds_read_b64_tr_b16 v[136:137], v9 offset:36864
  ds_read_b64_tr_b16 v[138:139], v9 offset:37888
  s_waitcnt lgkmcnt(0)
  v_mfma_f32_16x16x32_bf16 v[160:163], v[120:123], v[80:83], v[160:163]
  v_mfma_f32_16x16x32_bf16 v[164:167], v[124:127], v[80:83], v[164:167]
  v_mfma_f32_16x16x32_bf16 v[168:171], v[128:131], v[80:83], v[168:171]
  v_mfma_f32_16x16x32_bf16 v[172:175], v[132:135], v[80:83], v[172:175]
  v_mfma_f32_16x16x32_bf16 v[176:179], v[136:139], v[80:83], v[176:179]
  s_waitcnt vmcnt(20)
  s_barrier
  s_add_u32 m0, s51, 20480
  s_add_u32 s46, s66, 737920
  buffer_load_dwordx4 v8, s[4:7], s46 offen  lds
  s_add_u32 m0, s51, 24576
  s_add_u32 s46, s66, 738048
  buffer_load_dwordx4 v8, s[4:7], s46 offen  lds
  s_add_u32 m0, s51, 28672
  s_add_u32 s46, s66, 738176
  buffer_load_dwordx4 v8, s[4:7], s46 offen  lds
  s_add_u32 m0, s51, 32768
  s_add_u32 s46, s66, 738304
  buffer_load_dwordx4 v8, s[4:7], s46 offen  lds
  s_add_u32 m0, s51, 36864
  s_add_u32 s46, s66, 738432
  buffer_load_dwordx4 v8, s[4:7], s46 offen  lds
  ds_read_b64_tr_b16 v[100:101], v9 offset:40960
  ds_read_b64_tr_b16 v[102:103], v9 offset:41984
  ds_read_b64_tr_b16 v[104:105], v9 offset:45056
  ds_read_b64_tr_b16 v[106:107], v9 offset:46080
  ds_read_b64_tr_b16 v[108:109], v9 offset:49152
  ds_read_b64_tr_b16 v[110:111], v9 offset:50176
  ds_read_b64_tr_b16 v[112:113], v9 offset:53248
  ds_read_b64_tr_b16 v[114:115], v9 offset:54272
  ds_read_b64_tr_b16 v[116:117], v9 offset:57344
  ds_read_b64_tr_b16 v[118:119], v9 offset:58368
  s_waitcnt lgkmcnt(0)
  v_mfma_f32_16x16x32_bf16 v[140:143], v[100:103], v[84:87], v[140:143]
  v_mfma_f32_16x16x32_bf16 v[144:147], v[104:107], v[84:87], v[144:147]
  v_mfma_f32_16x16x32_bf16 v[148:151], v[108:111], v[84:87], v[148:151]
  v_mfma_f32_16x16x32_bf16 v[152:155], v[112:115], v[84:87], v[152:155]
  v_mfma_f32_16x16x32_bf16 v[156:159], v[116:119], v[84:87], v[156:159]
  s_waitcnt vmcnt(20)
  s_barrier
  s_add_u32 m0, s51, 40960
  s_add_u32 s46, s66, 778240
  buffer_load_dwordx4 v8, s[4:7], s46 offen  lds
  s_add_u32 m0, s51, 45056
  s_add_u32 s46, s66, 778368
  buffer_load_dwordx4 v8, s[4:7], s46 offen  lds
  s_add_u32 m0, s51, 49152
  s_add_u32 s46, s66, 778496
  buffer_load_dwordx4 v8, s[4:7], s46 offen  lds
  s_add_u32 m0, s51, 53248
  s_add_u32 s46, s66, 778624
  buffer_load_dwordx4 v8, s[4:7], s46 offen  lds
  s_add_u32 m0, s51, 57344
  s_add_u32 s46, s66, 778752
  buffer_load_dwordx4 v8, s[4:7], s46 offen  lds
  ds_read_b64_tr_b16 v[120:121], v9 offset:61440
  ds_read_b64_tr_b16 v[122:123], v9 offset:62464
  ds_read_b64_tr_b16 v[124:125], v10 offset:0
  ds_read_b64_tr_b16 v[126:127], v10 offset:1024
  ds_read_b64_tr_b16 v[128:129], v10 offset:4096
  ds_read_b64_tr_b16 v[130:131], v10 offset:5120
  ds_read_b64_tr_b16 v[132:133], v10 offset:8192
  ds_read_b64_tr_b16 v[134:135], v10 offset:9216
  ds_read_b64_tr_b16 v[136:137], v10 offset:12288
  ds_read_b64_tr_b16 v[138:139], v10 offset:13312
  s_waitcnt lgkmcnt(0)
  v_mfma_f32_16x16x32_bf16 v[160:163], v[120:123], v[84:87], v[160:163]
  v_mfma_f32_16x16x32_bf16 v[164:167], v[124:127], v[84:87], v[164:167]
  v_mfma_f32_16x16x32_bf16 v[168:171], v[128:131], v[84:87], v[168:171]
  v_mfma_f32_16x16x32_bf16 v[172:175], v[132:135], v[84:87], v[172:175]
  v_mfma_f32_16x16x32_bf16 v[176:179], v[136:139], v[84:87], v[176:179]
  s_waitcnt vmcnt(20)
  s_barrier
  s_add_u32 m0, s51, 61440
  s_add_u32 s46, s66, 778880
  buffer_load_dwordx4 v8, s[4:7], s46 offen  lds
  s_add_u32 m0, s51, 65536
  s_add_u32 s46, s66, 779008
  buffer_load_dwordx4 v8, s[4:7], s46 offen  lds
  s_add_u32 m0, s51, 69632
  s_add_u32 s46, s66, 779136
  buffer_load_dwordx4 v8, s[4:7], s46 offen  lds
  s_add_u32 m0, s51, 73728
  s_add_u32 s46, s66, 779264
  buffer_load_dwordx4 v8, s[4:7], s46 offen  lds
  s_add_u32 m0, s51, 77824
  s_add_u32 s46, s66, 779392
  buffer_load_dwordx4 v8, s[4:7], s46 offen  lds
  ds_read_b64_tr_b16 v[100:101], v10 offset:16384
  ds_read_b64_tr_b16 v[102:103], v10 offset:17408
  ds_read_b64_tr_b16 v[104:105], v10 offset:20480
  ds_read_b64_tr_b16 v[106:107], v10 offset:21504
  ds_read_b64_tr_b16 v[108:109], v10 offset:24576
  ds_read_b64_tr_b16 v[110:111], v10 offset:25600
  ds_read_b64_tr_b16 v[112:113], v10 offset:28672
  ds_read_b64_tr_b16 v[114:115], v10 offset:29696
  ds_read_b64_tr_b16 v[116:117], v10 offset:32768
  ds_read_b64_tr_b16 v[118:119], v10 offset:33792
  s_waitcnt lgkmcnt(0)
  v_mfma_f32_16x16x32_bf16 v[140:143], v[100:103], v[88:91], v[140:143]
  v_mfma_f32_16x16x32_bf16 v[144:147], v[104:107], v[88:91], v[144:147]
  v_mfma_f32_16x16x32_bf16 v[148:151], v[108:111], v[88:91], v[148:151]
  v_mfma_f32_16x16x32_bf16 v[152:155], v[112:115], v[88:91], v[152:155]
  v_mfma_f32_16x16x32_bf16 v[156:159], v[116:119], v[88:91], v[156:159]
  s_waitcnt vmcnt(20)
  s_barrier
  ds_read_b64_tr_b16 v[120:121], v10 offset:36864
  ds_read_b64_tr_b16 v[122:123], v10 offset:37888
  ds_read_b64_tr_b16 v[124:125], v10 offset:40960
  ds_read_b64_tr_b16 v[126:127], v10 offset:41984
  ds_read_b64_tr_b16 v[128:129], v10 offset:45056
  ds_read_b64_tr_b16 v[130:131], v10 offset:46080
  ds_read_b64_tr_b16 v[132:133], v10 offset:49152
  ds_read_b64_tr_b16 v[134:135], v10 offset:50176
  ds_read_b64_tr_b16 v[136:137], v10 offset:53248
  ds_read_b64_tr_b16 v[138:139], v10 offset:54272
  s_waitcnt lgkmcnt(0)
  v_mfma_f32_16x16x32_bf16 v[160:163], v[120:123], v[88:91], v[160:163]
  v_mfma_f32_16x16x32_bf16 v[164:167], v[124:127], v[88:91], v[164:167]
  v_mfma_f32_16x16x32_bf16 v[168:171], v[128:131], v[88:91], v[168:171]
  v_mfma_f32_16x16x32_bf16 v[172:175], v[132:135], v[88:91], v[172:175]
  v_mfma_f32_16x16x32_bf16 v[176:179], v[136:139], v[88:91], v[176:179]
  s_waitcnt vmcnt(15)
  s_barrier
  ds_read_b64_tr_b16 v[100:101], v9 offset:0
  ds_read_b64_tr_b16 v[102:103], v9 offset:1024
  ds_read_b64_tr_b16 v[104:105], v9 offset:4096
  ds_read_b64_tr_b16 v[106:107], v9 offset:5120
  ds_read_b64_tr_b16 v[108:109], v9 offset:8192
  ds_read_b64_tr_b16 v[110:111], v9 offset:9216
  ds_read_b64_tr_b16 v[112:113], v9 offset:12288
  ds_read_b64_tr_b16 v[114:115], v9 offset:13312
  ds_read_b64_tr_b16 v[116:117], v9 offset:16384
  ds_read_b64_tr_b16 v[118:119], v9 offset:17408
  s_waitcnt lgkmcnt(0)
  v_mfma_f32_16x16x32_bf16 v[140:143], v[100:103], v[92:95], v[140:143]
  v_mfma_f32_16x16x32_bf16 v[144:147], v[104:107], v[92:95], v[144:147]
  v_mfma_f32_16x16x32_bf16 v[148:151], v[108:111], v[92:95], v[148:151]
  v_mfma_f32_16x16x32_bf16 v[152:155], v[112:115], v[92:95], v[152:155]
  v_mfma_f32_16x16x32_bf16 v[156:159], v[116:119], v[92:95], v[156:159]
  s_waitcnt vmcnt(10)
  s_barrier
  ds_read_b64_tr_b16 v[120:121], v9 offset:20480
  ds_read_b64_tr_b16 v[122:123], v9 offset:21504
  ds_read_b64_tr_b16 v[124:125], v9 offset:24576
  ds_read_b64_tr_b16 v[126:127], v9 offset:25600
  ds_read_b64_tr_b16 v[128:129], v9 offset:28672
  ds_read_b64_tr_b16 v[130:131], v9 offset:29696
  ds_read_b64_tr_b16 v[132:133], v9 offset:32768
  ds_read_b64_tr_b16 v[134:135], v9 offset:33792
  ds_read_b64_tr_b16 v[136:137], v9 offset:36864
  ds_read_b64_tr_b16 v[138:139], v9 offset:37888
  s_waitcnt lgkmcnt(0)
  v_mfma_f32_16x16x32_bf16 v[160:163], v[120:123], v[92:95], v[160:163]
  v_mfma_f32_16x16x32_bf16 v[164:167], v[124:127], v[92:95], v[164:167]
  v_mfma_f32_16x16x32_bf16 v[168:171], v[128:131], v[92:95], v[168:171]
  v_mfma_f32_16x16x32_bf16 v[172:175], v[132:135], v[92:95], v[172:175]
  v_mfma_f32_16x16x32_bf16 v[176:179], v[136:139], v[92:95], v[176:179]
  s_waitcnt vmcnt(5)
  s_barrier
  ds_read_b64_tr_b16 v[100:101], v9 offset:40960
  ds_read_b64_tr_b16 v[102:103], v9 offset:41984
  ds_read_b64_tr_b16 v[104:105], v9 offset:45056
  ds_read_b64_tr_b16 v[106:107], v9 offset:46080
  ds_read_b64_tr_b16 v[108:109], v9 offset:49152
  ds_read_b64_tr_b16 v[110:111], v9 offset:50176
  ds_read_b64_tr_b16 v[112:113], v9 offset:53248
  ds_read_b64_tr_b16 v[114:115], v9 offset:54272
  ds_read_b64_tr_b16 v[116:117], v9 offset:57344
  ds_read_b64_tr_b16 v[118:119], v9 offset:58368
  s_waitcnt lgkmcnt(0)
  v_mfma_f32_16x16x32_bf16 v[140:143], v[100:103], v[96:99], v[140:143]
  v_mfma_f32_16x16x32_bf16 v[144:147], v[104:107], v[96:99], v[144:147]
  v_mfma_f32_16x16x32_bf16 v[148:151], v[108:111], v[96:99], v[148:151]
  v_mfma_f32_16x16x32_bf16 v[152:155], v[112:115], v[96:99], v[152:155]
  v_mfma_f32_16x16x32_bf16 v[156:159], v[116:119], v[96:99], v[156:159]
  s_waitcnt vmcnt(0)
  s_barrier
  ds_read_b64_tr_b16 v[120:121], v9 offset:61440
  ds_read_b64_tr_b16 v[122:123], v9 offset:62464
  ds_read_b64_tr_b16 v[124:125], v10 offset:0
  ds_read_b64_tr_b16 v[126:127], v10 offset:1024
  ds_read_b64_tr_b16 v[128:129], v10 offset:4096
  ds_read_b64_tr_b16 v[130:131], v10 offset:5120
  ds_read_b64_tr_b16 v[132:133], v10 offset:8192
  ds_read_b64_tr_b16 v[134:135], v10 offset:9216
  ds_read_b64_tr_b16 v[136:137], v10 offset:12288
  ds_read_b64_tr_b16 v[138:139], v10 offset:13312
  s_waitcnt lgkmcnt(0)
  v_mfma_f32_16x16x32_bf16 v[160:163], v[120:123], v[96:99], v[160:163]
  v_mfma_f32_16x16x32_bf16 v[164:167], v[124:127], v[96:99], v[164:167]
  v_mfma_f32_16x16x32_bf16 v[168:171], v[128:131], v[96:99], v[168:171]
  v_mfma_f32_16x16x32_bf16 v[172:175], v[132:135], v[96:99], v[172:175]
  v_mfma_f32_16x16x32_bf16 v[176:179], v[136:139], v[96:99], v[176:179]
  s_barrier
  v_cvt_pk_bf16_f32 v140, v140, v141
  v_cvt_pk_bf16_f32 v141, v142, v143
  buffer_store_dwordx2 v[140:141], v12, s[12:15], 0 offen offset:0
  v_cvt_pk_bf16_f32 v144, v144, v145
  v_cvt_pk_bf16_f32 v145, v146, v147
  buffer_store_dwordx2 v[144:145], v12, s[12:15], 0 offen offset:128
  v_cvt_pk_bf16_f32 v148, v148, v149
  v_cvt_pk_bf16_f32 v149, v150, v151
  buffer_store_dwordx2 v[148:149], v12, s[12:15], 0 offen offset:256
  v_cvt_pk_bf16_f32 v152, v152, v153
  v_cvt_pk_bf16_f32 v153, v154, v155
  buffer_store_dwordx2 v[152:153], v12, s[12:15], 0 offen offset:384
  v_cvt_pk_bf16_f32 v156, v156, v157
  v_cvt_pk_bf16_f32 v157, v158, v159
  buffer_store_dwordx2 v[156:157], v12, s[12:15], 0 offen offset:512
  v_cvt_pk_bf16_f32 v160, v160, v161
  v_cvt_pk_bf16_f32 v161, v162, v163
  buffer_store_dwordx2 v[160:161], v12, s[12:15], 0 offen offset:640
  v_cvt_pk_bf16_f32 v164, v164, v165
  v_cvt_pk_bf16_f32 v165, v166, v167
  buffer_store_dwordx2 v[164:165], v12, s[12:15], 0 offen offset:768
  v_cvt_pk_bf16_f32 v168, v168, v169
  v_cvt_pk_bf16_f32 v169, v170, v171
  buffer_store_dwordx2 v[168:169], v12, s[12:15], 0 offen offset:896
  v_cvt_pk_bf16_f32 v172, v172, v173
  v_cvt_pk_bf16_f32 v173, v174, v175
  buffer_store_dwordx2 v[172:173], v12, s[12:15], 0 offen offset:1024
  v_cvt_pk_bf16_f32 v176, v176, v177
  v_cvt_pk_bf16_f32 v177, v178, v179
  buffer_store_dwordx2 v[176:177], v12, s[12:15], 0 offen offset:1152
  s_endpgm
L_recur:
  s_cmp_lt_u32 s44, 8
  s_cbranch_scc1 L_score
  s_cmp_lt_u32 s44, 16
  s_cbranch_scc1 L_value
  s_cmp_lt_u32 s44, 28
  s_cbranch_scc1 rc_nowarm
  s_lshl_b32 s46, s44, 2
  s_add_u32 s46, s46, s43
  s_lshl_b32 s46, s46, 2
  s_add_u32 s46, s46, s42
  s_sub_u32 s46, s46, 448
  s_lshl_b32 s46, s46, 13
  v_lshlrev_b32 v1, 7, v0
  s_add_u32 s47, s46, 0
  buffer_load_dword v250, v1, s[12:15], s47 offen
  s_add_u32 s47, s46, 524288
  buffer_load_dword v250, v1, s[12:15], s47 offen
  s_add_u32 s47, s46, 1048576
  buffer_load_dword v250, v1, s[12:15], s47 offen
  s_add_u32 s47, s46, 1572864
  buffer_load_dword v250, v1, s[12:15], s47 offen
  s_add_u32 s47, s46, 2097152
  buffer_load_dword v250, v1, s[12:15], s47 offen
rc_nowarm:
  s_mov_b32 s50, 0
ss_15:
  v_and_b32 v3, 3, v0
  v_lshlrev_b32 v3, 2, v3
  global_load_dword v2, v3, s[38:39] sc1
  s_add_u32 s50, s50, 1
  s_cmp_gt_u32 s50, 131072
  s_cbranch_scc1 L_fail
  s_waitcnt vmcnt(0)
ss_15_in:
  v_readlane_b32 s46, v2, 0
  v_readlane_b32 s47, v2, 0
  v_readlane_b32 s48, v2, 0
  s_nop 0
  s_min_u32 s47, s47, s48
  s_cmp_lg_u32 s46, 0
  s_cselect_b32 s48, 7, 0
  s_add_u32 s46, s46, s2
  s_xor_b32 s49, s46, s43
  s_and_b32 s49, s49, s48
  s_cbranch_scc1 L_reroll
  s_cmp_lg_u32 s47, 0
  s_cbranch_scc1 ss_ok_16
  s_sleep 6
  s_branch ss_15
ss_ok_16:
  s_cmp_lt_u32 s44, 26
  s_cbranch_scc1 L_owner
  s_branch L_xowner
L_score:
  s_mov_b32 s4, s26
  s_mov_b32 s5, s27
  s_mov_b32 s6, 7864320
  s_mov_b32 s7, 0x20000
  s_mov_b32 s12, s28
  s_mov_b32 s13, s29
  s_mov_b32 s14, 7864320
  s_mov_b32 s15, 0x20000
  v_lshrrev_b32 v136, 3, v0
  v_lshrrev_b32 v137, 2, v136
  v_lshlrev_b32 v137, 3, v137
  v_and_b32 v64, 3, v136
  v_add_u32 v64, v64, v137
  s_and_b32 s46, s42, 1
  s_lshl_b32 s46, s46, 2
  s_lshr_b32 s47, s42, 1
  s_lshl_b32 s47, s47, 4
  s_add_u32 s46, s46, s47
  v_add_u32 v64, s46, v64
  v_mul_u32_u24 v64, 12288, v64
  v_lshrrev_b32 v136, 1, v136
  v_bfe_u32 v137, v0, 1, 2
  v_xor_b32 v136, v136, v137
  v_lshlrev_b32 v136, 5, v136
  v_and_b32 v137, 1, v0
  v_lshlrev_b32 v137, 4, v137
  v_add3_u32 v64, v64, v136, v137
  v_lshrrev_b32 v136, 5, v0
  v_lshlrev_b32 v65, 11, v136
  v_bfe_u32 v136, v0, 2, 3
  v_lshl_add_u32 v65, v136, 7, v65
  v_lshrrev_b32 v136, 1, v136
  v_xor_b32 v136, s42, v136
  v_lshl_add_u32 v65, v136, 5, v65
  v_and_b32 v136, 3, v0
  v_lshl_add_u32 v65, v136, 3, v65
  v_add_u32 v66, 0x10000, v65
  v_add_u32 v67, 0x20000, v65
  v_lshlrev_b32 v1, 4, v0
  v_add_u32 v2, s51, v1
  v_add_u32 v3, 0x10000, v2
  s_mul_i32 s62, s45, 384
  s_mov_b32 s24, 4096
  s_mov_b32 s25, 49152
  s_add_u32 m0, s51, 73728
  s_add_u32 s46, s62, 786432
  buffer_load_dwordx4 v64, s[12:15], s46 offen  lds
  s_add_u32 m0, s51, 77824
  s_add_u32 s46, s62, 1179648
  buffer_load_dwordx4 v64, s[12:15], s46 offen  lds
  s_add_u32 m0, s51, 81920
  s_add_u32 s46, s62, 786560
  buffer_load_dwordx4 v64, s[12:15], s46 offen  lds
  s_add_u32 m0, s51, 86016
  s_add_u32 s46, s62, 1179776
  buffer_load_dwordx4 v64, s[12:15], s46 offen  lds
  s_add_u32 m0, s51, 90112
  s_add_u32 s46, s62, 786688
  buffer_load_dwordx4 v64, s[12:15], s46 offen  lds
  s_add_u32 m0, s51, 94208
  s_add_u32 s46, s62, 1179904
  buffer_load_dwordx4 v64, s[12:15], s46 offen  lds
  s_add_u32 m0, s51, 98304
  s_add_u32 s46, s62, 1572864
  buffer_load_dwordx4 v64, s[12:15], s46 offen  lds
  s_add_u32 m0, s51, 102400
  s_add_u32 s46, s62, 1966080
  buffer_load_dwordx4 v64, s[12:15], s46 offen  lds
  s_add_u32 m0, s51, 106496
  s_add_u32 s46, s62, 1572992
  buffer_load_dwordx4 v64, s[12:15], s46 offen  lds
  s_add_u32 m0, s51, 110592
  s_add_u32 s46, s62, 1966208
  buffer_load_dwordx4 v64, s[12:15], s46 offen  lds
  s_add_u32 m0, s51, 114688
  s_add_u32 s46, s62, 1573120
  buffer_load_dwordx4 v64, s[12:15], s46 offen  lds
  s_add_u32 m0, s51, 118784
  s_add_u32 s46, s62, 1966336
  buffer_load_dwordx4 v64, s[12:15], s46 offen  lds
  s_add_u32 m0, s51, 122880
  s_add_u32 s46, s62, 2359296
  buffer_load_dwordx4 v64, s[12:15], s46 offen  lds
  s_add_u32 m0, s51, 126976
  s_add_u32 s46, s62, 2752512
  buffer_load_dwordx4 v64, s[12:15], s46 offen  lds
  s_add_u32 m0, s51, 131072
  s_add_u32 s46, s62, 2359424
  buffer_load_dwordx4 v64, s[12:15], s46 offen  lds
  s_add_u32 m0, s51, 135168
  s_add_u32 s46, s62, 2752640
  buffer_load_dwordx4 v64, s[12:15], s46 offen  lds
  s_add_u32 m0, s51, 139264
  s_add_u32 s46, s62, 2359552
  buffer_load_dwordx4 v64, s[12:15], s46 offen  lds
  s_add_u32 m0, s51, 143360
  s_add_u32 s46, s62, 2752768
  buffer_load_dwordx4 v64, s[12:15], s46 offen  lds
  s_add_u32 m0, s51, 0
  s_add_u32 s46, s62, 3145728
  buffer_load_dwordx4 v64, s[12:15], s46 offen  lds
  s_add_u32 m0, s51, 4096
  s_add_u32 s46, s62, 3538944
  buffer_load_dwordx4 v64, s[12:15], s46 offen  lds
  s_add_u32 m0, s51, 8192
  s_add_u32 s46, s62, 3145856
  buffer_load_dwordx4 v64, s[12:15], s46 offen  lds
  s_add_u32 m0, s51, 12288
  s_add_u32 s46, s62, 3539072
  buffer_load_dwordx4 v64, s[12:15], s46 offen  lds
  s_add_u32 m0, s51, 16384
  s_add_u32 s46, s62, 3145984
  buffer_load_dwordx4 v64, s[12:15], s46 offen  lds
  s_add_u32 m0, s51, 20480
  s_add_u32 s46, s62, 3539200
  buffer_load_dwordx4 v64, s[12:15], s46 offen  lds
  s_add_u32 m0, s51, 24576
  s_add_u32 s46, s62, 4718592
  buffer_load_dwordx4 v64, s[12:15], s46 offen  lds
  s_add_u32 m0, s51, 28672
  s_add_u32 s46, s62, 5111808
  buffer_load_dwordx4 v64, s[12:15], s46 offen  lds
  s_add_u32 m0, s51, 32768
  s_add_u32 s46, s62, 4718720
  buffer_load_dwordx4 v64, s[12:15], s46 offen  lds
  s_add_u32 m0, s51, 36864
  s_add_u32 s46, s62, 5111936
  buffer_load_dwordx4 v64, s[12:15], s46 offen  lds
  s_add_u32 m0, s51, 40960
  s_add_u32 s46, s62, 4718848
  buffer_load_dwordx4 v64, s[12:15], s46 offen  lds
  s_add_u32 m0, s51, 45056
  s_add_u32 s46, s62, 5112064
  buffer_load_dwordx4 v64, s[12:15], s46 offen  lds
  s_waitcnt vmcnt(24)
  s_barrier
  s_add_u32 m0, s51, 49152
  s_add_u32 s46, s62, 5505024
  buffer_load_dwordx4 v64, s[12:15], s46 offen  lds
  s_add_u32 m0, s51, 53248
  s_add_u32 s46, s62, 5898240
  buffer_load_dwordx4 v64, s[12:15], s46 offen  lds
  s_add_u32 m0, s51, 57344
  s_add_u32 s46, s62, 5505152
  buffer_load_dwordx4 v64, s[12:15], s46 offen  lds
  s_add_u32 m0, s51, 61440
  s_add_u32 s46, s62, 5898368
  buffer_load_dwordx4 v64, s[12:15], s46 offen  lds
  s_add_u32 m0, s51, 65536
  s_add_u32 s46, s62, 5505280
  buffer_load_dwordx4 v64, s[12:15], s46 offen  lds
  s_add_u32 m0, s51, 69632
  s_add_u32 s46, s62, 5898496
  buffer_load_dwordx4 v64, s[12:15], s46 offen  lds
  ds_read_b64_tr_b16 a[0:1], v66 offset:8192
  ds_read_b64_tr_b16 a[2:3], v66 offset:9216
  ds_read_b64_tr_b16 a[4:5], v66 offset:12288
  ds_read_b64_tr_b16 a[6:7], v66 offset:13312
  ds_read_b64_tr_b16 a[8:9], v66 offset:16384
  ds_read_b64_tr_b16 a[10:11], v66 offset:17408
  ds_read_b64_tr_b16 a[12:13], v66 offset:20480
  ds_read_b64_tr_b16 a[14:15], v66 offset:21504
  ds_read_b64_tr_b16 a[16:17], v66 offset:24576
  ds_read_b64_tr_b16 a[18:19], v66 offset:25600
  ds_read_b64_tr_b16 a[20:21], v66 offset:28672
  ds_read_b64_tr_b16 a[22:23], v66 offset:29696
  s_waitcnt lgkmcnt(0)
  s_waitcnt vmcnt(24)
  s_barrier
  s_add_u32 m0, s51, 73728
  s_add_u32 s46, s62, 6291456
  buffer_load_dwordx4 v64, s[12:15], s46 offen  lds
  s_add_u32 m0, s51, 77824
  s_add_u32 s46, s62, 6684672
  buffer_load_dwordx4 v64, s[12:15], s46 offen  lds
  s_add_u32 m0, s51, 81920
  s_add_u32 s46, s62, 6291584
  buffer_load_dwordx4 v64, s[12:15], s46 offen  lds
  s_add_u32 m0, s51, 86016
  s_add_u32 s46, s62, 6684800
  buffer_load_dwordx4 v64, s[12:15], s46 offen  lds
  s_add_u32 m0, s51, 90112
  s_add_u32 s46, s62, 6291712
  buffer_load_dwordx4 v64, s[12:15], s46 offen  lds
  s_add_u32 m0, s51, 94208
  s_add_u32 s46, s62, 6684928
  buffer_load_dwordx4 v64, s[12:15], s46 offen  lds
  ds_read_b64_tr_b16 a[24:25], v66 offset:32768
  ds_read_b64_tr_b16 a[26:27], v66 offset:33792
  ds_read_b64_tr_b16 a[28:29], v66 offset:36864
  ds_read_b64_tr_b16 a[30:31], v66 offset:37888
  ds_read_b64_tr_b16 a[32:33], v66 offset:40960
  ds_read_b64_tr_b16 a[34:35], v66 offset:41984
  ds_read_b64_tr_b16 a[36:37], v66 offset:45056
  ds_read_b64_tr_b16 a[38:39], v66 offset:46080
  ds_read_b64_tr_b16 a[40:41], v66 offset:49152
  ds_read_b64_tr_b16 a[42:43], v66 offset:50176
  ds_read_b64_tr_b16 a[44:45], v66 offset:53248
  ds_read_b64_tr_b16 a[46:47], v66 offset:54272
  s_waitcnt lgkmcnt(0)
  s_waitcnt vmcnt(24)
  s_barrier
  s_add_u32 m0, s51, 98304
  s_add_u32 s46, s62, 7077888
  buffer_load_dwordx4 v64, s[12:15], s46 offen  lds
  s_add_u32 m0, s51, 102400
  s_add_u32 s46, s62, 7471104
  buffer_load_dwordx4 v64, s[12:15], s46 offen  lds
  s_add_u32 m0, s51, 106496
  s_add_u32 s46, s62, 7078016
  buffer_load_dwordx4 v64, s[12:15], s46 offen  lds
  s_add_u32 m0, s51, 110592
  s_add_u32 s46, s62, 7471232
  buffer_load_dwordx4 v64, s[12:15], s46 offen  lds
  s_add_u32 m0, s51, 114688
  s_add_u32 s46, s62, 7078144
  buffer_load_dwordx4 v64, s[12:15], s46 offen  lds
  s_add_u32 m0, s51, 118784
  s_add_u32 s46, s62, 7471360
  buffer_load_dwordx4 v64, s[12:15], s46 offen  lds
  ds_read_b64_tr_b16 a[48:49], v66 offset:57344
  ds_read_b64_tr_b16 a[50:51], v66 offset:58368
  ds_read_b64_tr_b16 a[52:53], v66 offset:61440
  ds_read_b64_tr_b16 a[54:55], v66 offset:62464
  ds_read_b64_tr_b16 a[56:57], v67 offset:0
  ds_read_b64_tr_b16 a[58:59], v67 offset:1024
  ds_read_b64_tr_b16 a[60:61], v67 offset:4096
  ds_read_b64_tr_b16 a[62:63], v67 offset:5120
  ds_read_b64_tr_b16 a[64:65], v67 offset:8192
  ds_read_b64_tr_b16 a[66:67], v67 offset:9216
  ds_read_b64_tr_b16 a[68:69], v67 offset:12288
  ds_read_b64_tr_b16 a[70:71], v67 offset:13312
  s_waitcnt lgkmcnt(0)
  s_waitcnt vmcnt(24)
  s_barrier
  s_add_u32 m0, s51, 122880
  s_add_u32 s46, s62, 0
  buffer_load_dwordx4 v64, s[4:7], s46 offen  lds
  s_add_u32 m0, s51, 126976
  s_add_u32 s46, s62, 393216
  buffer_load_dwordx4 v64, s[4:7], s46 offen  lds
  s_add_u32 m0, s51, 131072
  s_add_u32 s46, s62, 128
  buffer_load_dwordx4 v64, s[4:7], s46 offen  lds
  s_add_u32 m0, s51, 135168
  s_add_u32 s46, s62, 393344
  buffer_load_dwordx4 v64, s[4:7], s46 offen  lds
  s_add_u32 m0, s51, 139264
  s_add_u32 s46, s62, 256
  buffer_load_dwordx4 v64, s[4:7], s46 offen  lds
  s_add_u32 m0, s51, 143360
  s_add_u32 s46, s62, 393472
  buffer_load_dwordx4 v64, s[4:7], s46 offen  lds
  ds_read_b64_tr_b16 a[72:73], v65 offset:0
  ds_read_b64_tr_b16 a[74:75], v65 offset:1024
  ds_read_b64_tr_b16 a[76:77], v65 offset:4096
  ds_read_b64_tr_b16 a[78:79], v65 offset:5120
  ds_read_b64_tr_b16 a[80:81], v65 offset:8192
  ds_read_b64_tr_b16 a[82:83], v65 offset:9216
  ds_read_b64_tr_b16 a[84:85], v65 offset:12288
  ds_read_b64_tr_b16 a[86:87], v65 offset:13312
  ds_read_b64_tr_b16 a[88:89], v65 offset:16384
  ds_read_b64_tr_b16 a[90:91], v65 offset:17408
  ds_read_b64_tr_b16 a[92:93], v65 offset:20480
  ds_read_b64_tr_b16 a[94:95], v65 offset:21504
  s_waitcnt lgkmcnt(0)
  s_waitcnt vmcnt(24)
  s_barrier
  s_add_u32 m0, s51, 0
  s_add_u32 s46, s62, 786432
  buffer_load_dwordx4 v64, s[4:7], s46 offen  lds
  s_add_u32 m0, s51, 4096
  s_add_u32 s46, s62, 1179648
  buffer_load_dwordx4 v64, s[4:7], s46 offen  lds
  s_add_u32 m0, s51, 8192
  s_add_u32 s46, s62, 786560
  buffer_load_dwordx4 v64, s[4:7], s46 offen  lds
  s_add_u32 m0, s51, 12288
  s_add_u32 s46, s62, 1179776
  buffer_load_dwordx4 v64, s[4:7], s46 offen  lds
  s_add_u32 m0, s51, 16384
  s_add_u32 s46, s62, 786688
  buffer_load_dwordx4 v64, s[4:7], s46 offen  lds
  s_add_u32 m0, s51, 20480
  s_add_u32 s46, s62, 1179904
  buffer_load_dwordx4 v64, s[4:7], s46 offen  lds
  ds_read_b64_tr_b16 a[96:97], v65 offset:24576
  ds_read_b64_tr_b16 a[98:99], v65 offset:25600
  ds_read_b64_tr_b16 a[100:101], v65 offset:28672
  ds_read_b64_tr_b16 a[102:103], v65 offset:29696
  ds_read_b64_tr_b16 a[104:105], v65 offset:32768
  ds_read_b64_tr_b16 a[106:107], v65 offset:33792
  ds_read_b64_tr_b16 a[108:109], v65 offset:36864
  ds_read_b64_tr_b16 a[110:111], v65 offset:37888
  ds_read_b64_tr_b16 a[112:113], v65 offset:40960
  ds_read_b64_tr_b16 a[114:115], v65 offset:41984
  ds_read_b64_tr_b16 a[116:117], v65 offset:45056
  ds_read_b64_tr_b16 a[118:119], v65 offset:46080
  s_waitcnt lgkmcnt(0)
  s_waitcnt vmcnt(24)
  s_barrier
  s_add_u32 m0, s51, 24576
  s_add_u32 s46, s62, 1572864
  buffer_load_dwordx4 v64, s[4:7], s46 offen  lds
  s_add_u32 m0, s51, 28672
  s_add_u32 s46, s62, 1966080
  buffer_load_dwordx4 v64, s[4:7], s46 offen  lds
  s_add_u32 m0, s51, 32768
  s_add_u32 s46, s62, 1572992
  buffer_load_dwordx4 v64, s[4:7], s46 offen  lds
  s_add_u32 m0, s51, 36864
  s_add_u32 s46, s62, 1966208
  buffer_load_dwordx4 v64, s[4:7], s46 offen  lds
  s_add_u32 m0, s51, 40960
  s_add_u32 s46, s62, 1573120
  buffer_load_dwordx4 v64, s[4:7], s46 offen  lds
  s_add_u32 m0, s51, 45056
  s_add_u32 s46, s62, 1966336
  buffer_load_dwordx4 v64, s[4:7], s46 offen  lds
  ds_read_b64_tr_b16 a[120:121], v65 offset:49152
  ds_read_b64_tr_b16 a[122:123], v65 offset:50176
  ds_read_b64_tr_b16 a[124:125], v65 offset:53248
  ds_read_b64_tr_b16 a[126:127], v65 offset:54272
  ds_read_b64_tr_b16 a[128:129], v65 offset:57344
  ds_read_b64_tr_b16 a[130:131], v65 offset:58368
  ds_read_b64_tr_b16 a[132:133], v65 offset:61440
  ds_read_b64_tr_b16 a[134:135], v65 offset:62464
  ds_read_b64_tr_b16 a[136:137], v66 offset:0
  ds_read_b64_tr_b16 a[138:139], v66 offset:1024
  ds_read_b64_tr_b16 a[140:141], v66 offset:4096
  ds_read_b64_tr_b16 a[142:143], v66 offset:5120
  s_waitcnt lgkmcnt(0)
  s_waitcnt vmcnt(24)
  s_barrier
  s_add_u32 m0, s51, 49152
  s_add_u32 s46, s62, 3145728
  buffer_load_dwordx4 v64, s[4:7], s46 offen  lds
  s_add_u32 m0, s51, 53248
  s_add_u32 s46, s62, 3538944
  buffer_load_dwordx4 v64, s[4:7], s46 offen  lds
  s_add_u32 m0, s51, 57344
  s_add_u32 s46, s62, 3145856
  buffer_load_dwordx4 v64, s[4:7], s46 offen  lds
  s_add_u32 m0, s51, 61440
  s_add_u32 s46, s62, 3539072
  buffer_load_dwordx4 v64, s[4:7], s46 offen  lds
  s_add_u32 m0, s51, 65536
  s_add_u32 s46, s62, 3145984
  buffer_load_dwordx4 v64, s[4:7], s46 offen  lds
  s_add_u32 m0, s51, 69632
  s_add_u32 s46, s62, 3539200
  buffer_load_dwordx4 v64, s[4:7], s46 offen  lds
  ds_read_b64_tr_b16 a[144:145], v66 offset:8192
  ds_read_b64_tr_b16 a[146:147], v66 offset:9216
  ds_read_b64_tr_b16 a[148:149], v66 offset:12288
  ds_read_b64_tr_b16 a[150:151], v66 offset:13312
  ds_read_b64_tr_b16 a[152:153], v66 offset:16384
  ds_read_b64_tr_b16 a[154:155], v66 offset:17408
  ds_read_b64_tr_b16 a[156:157], v66 offset:20480
  ds_read_b64_tr_b16 a[158:159], v66 offset:21504
  ds_read_b64_tr_b16 a[160:161], v66 offset:24576
  ds_read_b64_tr_b16 a[162:163], v66 offset:25600
  ds_read_b64_tr_b16 a[164:165], v66 offset:28672
  ds_read_b64_tr_b16 a[166:167], v66 offset:29696
  s_waitcnt lgkmcnt(0)
  s_waitcnt vmcnt(24)
  s_barrier
  s_add_u32 m0, s51, 73728
  s_add_u32 s46, s62, 3932160
  buffer_load_dwordx4 v64, s[4:7], s46 offen  lds
  s_add_u32 m0, s51, 77824
  s_add_u32 s46, s62, 4325376
  buffer_load_dwordx4 v64, s[4:7], s46 offen  lds
  s_add_u32 m0, s51, 81920
  s_add_u32 s46, s62, 3932288
  buffer_load_dwordx4 v64, s[4:7], s46 offen  lds
  s_add_u32 m0, s51, 86016
  s_add_u32 s46, s62, 4325504
  buffer_load_dwordx4 v64, s[4:7], s46 offen  lds
  s_add_u32 m0, s51, 90112
  s_add_u32 s46, s62, 3932416
  buffer_load_dwordx4 v64, s[4:7], s46 offen  lds
  s_add_u32 m0, s51, 94208
  s_add_u32 s46, s62, 4325632
  buffer_load_dwordx4 v64, s[4:7], s46 offen  lds
  ds_read_b64_tr_b16 a[168:169], v66 offset:32768
  ds_read_b64_tr_b16 a[170:171], v66 offset:33792
  ds_read_b64_tr_b16 a[172:173], v66 offset:36864
  ds_read_b64_tr_b16 a[174:175], v66 offset:37888
  ds_read_b64_tr_b16 a[176:177], v66 offset:40960
  ds_read_b64_tr_b16 a[178:179], v66 offset:41984
  ds_read_b64_tr_b16 a[180:181], v66 offset:45056
  ds_read_b64_tr_b16 a[182:183], v66 offset:46080
  ds_read_b64_tr_b16 a[184:185], v66 offset:49152
  ds_read_b64_tr_b16 a[186:187], v66 offset:50176
  ds_read_b64_tr_b16 a[188:189], v66 offset:53248
  ds_read_b64_tr_b16 a[190:191], v66 offset:54272
  s_waitcnt lgkmcnt(0)
  s_waitcnt vmcnt(24)
  s_barrier
  s_add_u32 m0, s51, 98304
  s_add_u32 s46, s62, 5505024
  buffer_load_dwordx4 v64, s[4:7], s46 offen  lds
  s_add_u32 m0, s51, 102400
  s_add_u32 s46, s62, 5898240
  buffer_load_dwordx4 v64, s[4:7], s46 offen  lds
  s_add_u32 m0, s51, 106496
  s_add_u32 s46, s62, 5505152
  buffer_load_dwordx4 v64, s[4:7], s46 offen  lds
  s_add_u32 m0, s51, 110592
  s_add_u32 s46, s62, 5898368
  buffer_load_dwordx4 v64, s[4:7], s46 offen  lds
  s_add_u32 m0, s51, 114688
  s_add_u32 s46, s62, 5505280
  buffer_load_dwordx4 v64, s[4:7], s46 offen  lds
  s_add_u32 m0, s51, 118784
  s_add_u32 s46, s62, 5898496
  buffer_load_dwordx4 v64, s[4:7], s46 offen  lds
  ds_read_b64_tr_b16 a[192:193], v66 offset:57344
  ds_read_b64_tr_b16 a[194:195], v66 offset:58368
  ds_read_b64_tr_b16 a[196:197], v66 offset:61440
  ds_read_b64_tr_b16 a[198:199], v66 offset:62464
  ds_read_b64_tr_b16 a[200:201], v67 offset:0
  ds_read_b64_tr_b16 a[202:203], v67 offset:1024
  ds_read_b64_tr_b16 a[204:205], v67 offset:4096
  ds_read_b64_tr_b16 a[206:207], v67 offset:5120
  ds_read_b64_tr_b16 a[208:209], v67 offset:8192
  ds_read_b64_tr_b16 a[210:211], v67 offset:9216
  ds_read_b64_tr_b16 a[212:213], v67 offset:12288
  ds_read_b64_tr_b16 a[214:215], v67 offset:13312
  s_waitcnt lgkmcnt(0)
  s_waitcnt vmcnt(24)
  s_barrier
  v_and_b32 v137, 3, v0
  v_lshlrev_b32 v137, 2, v137
  global_load_dword v136, v137, s[38:39] sc1
  s_add_u32 m0, s51, 122880
  s_add_u32 s46, s62, 6291456
  buffer_load_dwordx4 v64, s[4:7], s46 offen  lds
  s_add_u32 m0, s51, 126976
  s_add_u32 s46, s62, 6684672
  buffer_load_dwordx4 v64, s[4:7], s46 offen  lds
  s_add_u32 m0, s51, 131072
  s_add_u32 s46, s62, 6291584
  buffer_load_dwordx4 v64, s[4:7], s46 offen  lds
  s_add_u32 m0, s51, 135168
  s_add_u32 s46, s62, 6684800
  buffer_load_dwordx4 v64, s[4:7], s46 offen  lds
  s_add_u32 m0, s51, 139264
  s_add_u32 s46, s62, 6291712
  buffer_load_dwordx4 v64, s[4:7], s46 offen  lds
  s_add_u32 m0, s51, 143360
  s_add_u32 s46, s62, 6684928
  buffer_load_dwordx4 v64, s[4:7], s46 offen  lds
  ds_read_b64_tr_b16 a[216:217], v65 offset:0
  ds_read_b64_tr_b16 a[218:219], v65 offset:1024
  ds_read_b64_tr_b16 a[220:221], v65 offset:4096
  ds_read_b64_tr_b16 a[222:223], v65 offset:5120
  ds_read_b64_tr_b16 a[224:225], v65 offset:8192
  ds_read_b64_tr_b16 a[226:227], v65 offset:9216
  ds_read_b64_tr_b16 a[228:229], v65 offset:12288
  ds_read_b64_tr_b16 a[230:231], v65 offset:13312
  ds_read_b64_tr_b16 a[232:233], v65 offset:16384
  ds_read_b64_tr_b16 a[234:235], v65 offset:17408
  ds_read_b64_tr_b16 a[236:237], v65 offset:20480
  ds_read_b64_tr_b16 a[238:239], v65 offset:21504
  s_waitcnt lgkmcnt(0)
  s_waitcnt vmcnt(25)
  s_barrier
  s_add_u32 m0, s51, 0
  s_add_u32 s46, s62, 0
  buffer_load_dwordx4 v64, s[12:15], s46 offen  lds
  s_add_u32 m0, s51, 4096
  s_add_u32 s46, s62, 393216
  buffer_load_dwordx4 v64, s[12:15], s46 offen  lds
  s_add_u32 m0, s51, 8192
  s_add_u32 s46, s62, 128
  buffer_load_dwordx4 v64, s[12:15], s46 offen  lds
  s_add_u32 m0, s51, 12288
  s_add_u32 s46, s62, 393344
  buffer_load_dwordx4 v64, s[12:15], s46 offen  lds
  s_add_u32 m0, s51, 16384
  s_add_u32 s46, s62, 256
  buffer_load_dwordx4 v64, s[12:15], s46 offen  lds
  s_add_u32 m0, s51, 20480
  s_add_u32 s46, s62, 393472
  buffer_load_dwordx4 v64, s[12:15], s46 offen  lds
  ds_read_b64_tr_b16 a[240:241], v65 offset:24576
  ds_read_b64_tr_b16 a[242:243], v65 offset:25600
  ds_read_b64_tr_b16 a[244:245], v65 offset:28672
  ds_read_b64_tr_b16 a[246:247], v65 offset:29696
  ds_read_b64_tr_b16 a[248:249], v65 offset:32768
  ds_read_b64_tr_b16 a[250:251], v65 offset:33792
  ds_read_b64_tr_b16 a[252:253], v65 offset:36864
  ds_read_b64_tr_b16 a[254:255], v65 offset:37888
  ds_read_b64_tr_b16 v[152:153], v65 offset:40960
  ds_read_b64_tr_b16 v[154:155], v65 offset:41984
  ds_read_b64_tr_b16 v[156:157], v65 offset:45056
  ds_read_b64_tr_b16 v[158:159], v65 offset:46080
  s_waitcnt lgkmcnt(0)
  s_waitcnt vmcnt(25)
  s_barrier
  s_add_u32 m0, s51, 24576
  s_add_u32 s46, s62, 3932160
  buffer_load_dwordx4 v64, s[12:15], s46 offen  lds
  s_add_u32 m0, s51, 28672
  s_add_u32 s46, s62, 4325376
  buffer_load_dwordx4 v64, s[12:15], s46 offen  lds
  s_add_u32 m0, s51, 32768
  s_add_u32 s46, s62, 3932288
  buffer_load_dwordx4 v64, s[12:15], s46 offen  lds
  s_add_u32 m0, s51, 36864
  s_add_u32 s46, s62, 4325504
  buffer_load_dwordx4 v64, s[12:15], s46 offen  lds
  s_add_u32 m0, s51, 40960
  s_add_u32 s46, s62, 3932416
  buffer_load_dwordx4 v64, s[12:15], s46 offen  lds
  s_add_u32 m0, s51, 45056
  s_add_u32 s46, s62, 4325632
  buffer_load_dwordx4 v64, s[12:15], s46 offen  lds
  ds_read_b64_tr_b16 v[160:161], v65 offset:49152
  ds_read_b64_tr_b16 v[162:163], v65 offset:50176
  ds_read_b64_tr_b16 v[164:165], v65 offset:53248
  ds_read_b64_tr_b16 v[166:167], v65 offset:54272
  ds_read_b64_tr_b16 v[168:169], v65 offset:57344
  ds_read_b64_tr_b16 v[170:171], v65 offset:58368
  ds_read_b64_tr_b16 v[172:173], v65 offset:61440
  ds_read_b64_tr_b16 v[174:175], v65 offset:62464
  ds_read_b64_tr_b16 v[176:177], v66 offset:0
  ds_read_b64_tr_b16 v[178:179], v66 offset:1024
  ds_read_b64_tr_b16 v[180:181], v66 offset:4096
  ds_read_b64_tr_b16 v[182:183], v66 offset:5120
  s_waitcnt lgkmcnt(0)
  s_waitcnt vmcnt(25)
  s_barrier
  s_add_u32 m0, s51, 49152
  s_add_u32 s46, s62, 2359296
  buffer_load_dwordx4 v64, s[4:7], s46 offen  lds
  s_add_u32 m0, s51, 53248
  s_add_u32 s46, s62, 2752512
  buffer_load_dwordx4 v64, s[4:7], s46 offen  lds
  s_add_u32 m0, s51, 57344
  s_add_u32 s46, s62, 2359424
  buffer_load_dwordx4 v64, s[4:7], s46 offen  lds
  s_add_u32 m0, s51, 61440
  s_add_u32 s46, s62, 2752640
  buffer_load_dwordx4 v64, s[4:7], s46 offen  lds
  s_add_u32 m0, s51, 65536
  s_add_u32 s46, s62, 2359552
  buffer_load_dwordx4 v64, s[4:7], s46 offen  lds
  s_add_u32 m0, s51, 69632
  s_add_u32 s46, s62, 2752768
  buffer_load_dwordx4 v64, s[4:7], s46 offen  lds
  ds_read_b64_tr_b16 v[184:185], v66 offset:8192
  ds_read_b64_tr_b16 v[186:187], v66 offset:9216
  ds_read_b64_tr_b16 v[188:189], v66 offset:12288
  ds_read_b64_tr_b16 v[190:191], v66 offset:13312
  ds_read_b64_tr_b16 v[192:193], v66 offset:16384
  ds_read_b64_tr_b16 v[194:195], v66 offset:17408
  ds_read_b64_tr_b16 v[196:197], v66 offset:20480
  ds_read_b64_tr_b16 v[198:199], v66 offset:21504
  ds_read_b64_tr_b16 v[200:201], v66 offset:24576
  ds_read_b64_tr_b16 v[202:203], v66 offset:25600
  ds_read_b64_tr_b16 v[204:205], v66 offset:28672
  ds_read_b64_tr_b16 v[206:207], v66 offset:29696
  s_waitcnt lgkmcnt(0)
  s_waitcnt vmcnt(25)
  s_barrier
  s_add_u32 m0, s51, 73728
  s_add_u32 s46, s62, 4718592
  buffer_load_dwordx4 v64, s[4:7], s46 offen  lds
  s_add_u32 m0, s51, 77824
  s_add_u32 s46, s62, 5111808
  buffer_load_dwordx4 v64, s[4:7], s46 offen  lds
  s_add_u32 m0, s51, 81920
  s_add_u32 s46, s62, 4718720
  buffer_load_dwordx4 v64, s[4:7], s46 offen  lds
  s_add_u32 m0, s51, 86016
  s_add_u32 s46, s62, 5111936
  buffer_load_dwordx4 v64, s[4:7], s46 offen  lds
  s_add_u32 m0, s51, 90112
  s_add_u32 s46, s62, 4718848
  buffer_load_dwordx4 v64, s[4:7], s46 offen  lds
  s_add_u32 m0, s51, 94208
  s_add_u32 s46, s62, 5112064
  buffer_load_dwordx4 v64, s[4:7], s46 offen  lds
  ds_read_b64_tr_b16 v[208:209], v66 offset:32768
  ds_read_b64_tr_b16 v[210:211], v66 offset:33792
  ds_read_b64_tr_b16 v[212:213], v66 offset:36864
  ds_read_b64_tr_b16 v[214:215], v66 offset:37888
  ds_read_b64_tr_b16 v[216:217], v66 offset:40960
  ds_read_b64_tr_b16 v[218:219], v66 offset:41984
  ds_read_b64_tr_b16 v[220:221], v66 offset:45056
  ds_read_b64_tr_b16 v[222:223], v66 offset:46080
  ds_read_b64_tr_b16 v[224:225], v66 offset:49152
  ds_read_b64_tr_b16 v[226:227], v66 offset:50176
  ds_read_b64_tr_b16 v[228:229], v66 offset:53248
  ds_read_b64_tr_b16 v[230:231], v66 offset:54272
  s_waitcnt lgkmcnt(0)
  s_waitcnt vmcnt(24)
  s_barrier
  s_add_u32 m0, s51, 98304
  s_add_u32 s46, s62, 7077888
  buffer_load_dwordx4 v64, s[4:7], s46 offen  lds
  s_add_u32 m0, s51, 102400
  s_add_u32 s46, s62, 7471104
  buffer_load_dwordx4 v64, s[4:7], s46 offen  lds
  s_add_u32 m0, s51, 106496
  s_add_u32 s46, s62, 7078016
  buffer_load_dwordx4 v64, s[4:7], s46 offen  lds
  s_add_u32 m0, s51, 110592
  s_add_u32 s46, s62, 7471232
  buffer_load_dwordx4 v64, s[4:7], s46 offen  lds
  s_add_u32 m0, s51, 114688
  s_add_u32 s46, s62, 7078144
  buffer_load_dwordx4 v64, s[4:7], s46 offen  lds
  s_add_u32 m0, s51, 118784
  s_add_u32 s46, s62, 7471360
  buffer_load_dwordx4 v64, s[4:7], s46 offen  lds
  ds_read_b64_tr_b16 v[232:233], v66 offset:57344
  ds_read_b64_tr_b16 v[234:235], v66 offset:58368
  ds_read_b64_tr_b16 v[236:237], v66 offset:61440
  ds_read_b64_tr_b16 v[238:239], v66 offset:62464
  ds_read_b64_tr_b16 v[240:241], v67 offset:0
  ds_read_b64_tr_b16 v[242:243], v67 offset:1024
  ds_read_b64_tr_b16 v[244:245], v67 offset:4096
  ds_read_b64_tr_b16 v[246:247], v67 offset:5120
  ds_read_b64_tr_b16 v[248:249], v67 offset:8192
  ds_read_b64_tr_b16 v[250:251], v67 offset:9216
  ds_read_b64_tr_b16 v[252:253], v67 offset:12288
  ds_read_b64_tr_b16 v[254:255], v67 offset:13312
  s_waitcnt lgkmcnt(0)
  s_mov_b32 s50, 0
  s_branch ss_17_in
ss_17:
  v_and_b32 v137, 3, v0
  v_lshlrev_b32 v137, 2, v137
  global_load_dword v136, v137, s[38:39] sc1
  s_add_u32 s50, s50, 1
  s_cmp_gt_u32 s50, 131072
  s_cbranch_scc1 L_fail
  s_waitcnt vmcnt(0)
ss_17_in:
  v_readlane_b32 s46, v136, 0
  v_readlane_b32 s47, v136, 2
  v_readlane_b32 s48, v136, 1
  s_nop 0
  s_min_u32 s47, s47, s48
  s_cmp_lg_u32 s46, 0
  s_cselect_b32 s48, 7, 0
  s_add_u32 s46, s46, s2
  s_xor_b32 s49, s46, s43
  s_and_b32 s49, s49, s48
  s_cbranch_scc1 L_reroll
  s_cmp_lg_u32 s47, 0
  s_cbranch_scc1 ss_ok_18
  s_sleep 6
  s_branch ss_17
ss_ok_18:
  v_readlane_b32 s3, v136, 1
  s_nop 0
  s_and_b32 s3, s3, 0x2000
  s_lshr_b32 s46, s44, 4
  s_lshl_b32 s46, s46, 7
  s_lshl_b32 s47, s43, 4
  s_add_u32 s46, s46, s47
  s_and_b32 s47, s44, 15
  s_add_u32 s46, s46, s47
  s_lshl_b32 s46, s46, 7
  s_add_u32 s46, s46, s3
  s_add_u32 s46, s46, 13369344
  s_add_u32 s40, s8, s46
  s_addc_u32 s41, s9, 0
  s_sub_u32 s47, s44, 0
  s_lshl_b32 s46, s47, 11
  s_lshl_b32 s48, s43, 2
  s_add_u32 s46, s46, s48
  s_add_u32 s46, s46, s3
  s_add_u32 s46, s46, 13385728
  v_lshl_add_u32 v11, v0, 7, s46
  v_mov_b32 v136, 2146435072
  s_cmp_lt_u32 s47, 4
  s_cselect_b32 vcc_lo, 1023, 0
  s_mov_b32 vcc_hi, 0
  v_cndmask_b32 v11, v136, v11, vcc
  v_mov_b32 v7, 0x44444444
  v_mov_b32 v136, 0xeeeeeeee
  v_and_b32 v137, 2, v0
  v_cmp_ne_u32 vcc, 0, v137
  s_nop 1
  v_cndmask_b32 v7, v7, v136, vcc
  s_mov_b32 s68, 1037384597
  s_mov_b32 s70, 3494803967
  v_and_b32 v136, 15, v0
  v_lshrrev_b32 v138, 4, v0
  v_lshlrev_b32 v4, 4, v136
  v_lshl_add_u32 v4, v138, 2, v4
  s_lshl_b32 s46, s42, 8
  s_add_u32 s46, s46, 147456
  v_add_u32 v4, s46, v4
  v_lshlrev_b32 v5, 7, v138
  v_bfe_u32 v137, v0, 2, 2
  v_lshl_add_u32 v5, v137, 4, v5
  v_and_b32 v137, 1, v0
  v_lshl_add_u32 v5, v137, 3, v5
  v_add_u32 v5, 147456, v5
  v_add_u32 v13, 122880, v1
  v_add_u32 v149, 153600, v1
  v_bfe_u32 v140, v0, 1, 2
  v_lshl_add_u32 v140, v140, 2, v137
  v_bfe_u32 v137, v0, 3, 1
  v_lshl_add_u32 v140, v137, 1, v140
  v_cmp_eq_u32 s[18:19], 1, v137
  s_add_u32 s46, s3, 12582912
  s_lshr_b32 s47, s45, 4
  s_add_u32 s47, s47, 1
  s_lshl_b32 s47, s47, 14
  s_and_b32 s48, s45, 15
  s_lshl_b32 s48, s48, 9
  s_add_u32 s47, s47, s48
  s_add_u32 s47, s47, s46
  v_lshrrev_b32 v137, 1, v138
  v_and_b32 v139, 1, v138
  v_lshl_add_u32 v8, v137, 4, v140
  v_lshlrev_b32 v8, 4, v8
  v_lshl_add_u32 v8, v139, 3, v8
  v_add_u32 v8, s47, v8
  s_lshl_b32 s47, s45, 7
  s_and_b32 s48, s45, 1
  s_mul_i32 s48, s48, 120
  s_sub_u32 s47, s47, s48
  s_add_u32 s47, s47, s46
  s_add_u32 s47, s47, 51200
  v_lshlrev_b32 v9, 4, v140
  v_lshl_add_u32 v9, v139, 2, v9
  v_add_u32 v9, s47, v9
  v_lshl_add_u32 v9, v137, 30, v9
  v_lshlrev_b32 v14, 4, v136
  v_lshl_add_u32 v14, v139, 3, v14
  v_lshl_add_u32 v14, v137, 2, v14
  s_lshl_b32 s47, s45, 8
  s_add_u32 s47, s47, 65536
  v_add_u32 v14, s47, v14
  s_lshl_b32 s47, s42, 4
  v_add_u32 v136, s47, v136
  v_lshlrev_b32 v138, 2, v138
  v_sub_u32 v136, v136, v138
  v_cmp_gt_i32 s[72:73], 0, v136
  v_cmp_gt_i32 s[74:75], 1, v136
  v_cmp_gt_i32 s[76:77], 2, v136
  v_cmp_gt_i32 s[78:79], 3, v136
  v_cmp_gt_i32 s[80:81], 16, v136
  v_cmp_gt_i32 s[82:83], 17, v136
  v_cmp_gt_i32 s[84:85], 18, v136
  v_cmp_gt_i32 s[86:87], 19, v136
  s_lshl_b32 s46, s45, 7
  s_lshl_b32 s47, s42, 2
  s_add_u32 s47, s47, s46
  s_add_u32 s47, s47, 1069056
  v_mov_b32 v15, s47
  s_cmp_lg_u32 s42, 2
  s_cbranch_scc1 sc_fl
  v_and_b32 v15, 1, v0
  v_lshlrev_b32 v15, 12, v15
  s_add_u32 s46, s46, 1048576
  v_add_u32 v15, s46, v15
sc_fl:
  s_mov_b32 s23, s45
  s_lshl_b32 s20, s42, 24
  s_add_u32 s20, s20, s3
  s_add_u32 s20, s20, 31457280
  s_xor_b32 s20, s20, 0
  s_lshl_b32 s26, s42, 11
  s_lshl_b32 s46, s42, 24
  s_sub_u32 s26, s26, s46
  s_cmp_eq_u32 s42, 2
  s_cselect_b32 s26, 2012217344, s26
  s_lshl_b32 s21, s42, 12
  s_add_u32 s21, s21, 122880
  s_mov_b32 s22, 12288
  s_mul_i32 s64, s42, 81920
  s_add_u32 s64, s64, s3
  s_add_u32 s64, s64, 14680064
  s_lshr_b32 s27, s45, 3
  s_lshl_b32 s27, s27, 14
  s_and_b32 s46, s45, 7
  s_lshl_b32 s46, s46, 10
  s_add_u32 s27, s27, s46
  s_mov_b32 s61, 0
  s_mov_b32 s52, 0
  s_mov_b32 s58, 0
  s_mov_b32 s65, 524288
  s_mov_b32 s100, 0
  s_add_u32 s46, s42, 3
  s_lshl_b32 s31, s46, 10
  s_cmp_ge_u32 s46, 8
  s_cselect_b32 s47, 40960, 0
  s_add_u32 s31, s31, s47
  s_cmp_ge_u32 s46, 10
  s_cselect_b32 s31, 2146435072, s31
  s_add_u32 s46, s42, 7
  s_lshl_b32 s32, s46, 10
  s_cmp_ge_u32 s46, 8
  s_cselect_b32 s47, 40960, 0
  s_add_u32 s32, s32, s47
  s_cmp_ge_u32 s46, 10
  s_cselect_b32 s32, 2146435072, s32
  s_waitcnt vmcnt(24)
  s_barrier
  ds_read_b64_tr_b16 v[40:41], v65 offset:0
  ds_read_b64_tr_b16 v[42:43], v65 offset:1024
  ds_read_b64_tr_b16 v[44:45], v65 offset:4096
  ds_read_b64_tr_b16 v[46:47], v65 offset:5120
  ds_read_b64_tr_b16 v[48:49], v65 offset:8192
  ds_read_b64_tr_b16 v[50:51], v65 offset:9216
  ds_read_b64_tr_b16 v[52:53], v65 offset:12288
  ds_read_b64_tr_b16 v[54:55], v65 offset:13312
  ds_read_b64_tr_b16 v[56:57], v65 offset:16384
  ds_read_b64_tr_b16 v[58:59], v65 offset:17408
  ds_read_b64_tr_b16 v[60:61], v65 offset:20480
  ds_read_b64_tr_b16 v[62:63], v65 offset:21504
  s_waitcnt lgkmcnt(0)
  s_waitcnt vmcnt(18)
  s_barrier
  ds_write_b128 v2, v[40:43] offset:0
  ds_write_b128 v2, v[44:47] offset:4096
  ds_write_b128 v2, v[48:51] offset:8192
  ds_write_b128 v2, v[52:55] offset:12288
  ds_write_b128 v2, v[56:59] offset:16384
  ds_write_b128 v2, v[60:63] offset:20480
  ds_read_b64_tr_b16 v[16:17], v65 offset:24576
  ds_read_b64_tr_b16 v[18:19], v65 offset:25600
  ds_read_b64_tr_b16 v[20:21], v65 offset:28672
  ds_read_b64_tr_b16 v[22:23], v65 offset:29696
  ds_read_b64_tr_b16 v[24:25], v65 offset:32768
  ds_read_b64_tr_b16 v[26:27], v65 offset:33792
  ds_read_b64_tr_b16 v[28:29], v65 offset:36864
  ds_read_b64_tr_b16 v[30:31], v65 offset:37888
  ds_read_b64_tr_b16 v[32:33], v65 offset:40960
  ds_read_b64_tr_b16 v[34:35], v65 offset:41984
  ds_read_b64_tr_b16 v[36:37], v65 offset:45056
  ds_read_b64_tr_b16 v[38:39], v65 offset:46080
  s_waitcnt lgkmcnt(0)
  s_waitcnt vmcnt(12)
  s_barrier
  ds_write_b128 v2, v[16:19] offset:24576
  ds_write_b128 v2, v[20:23] offset:28672
  ds_write_b128 v2, v[24:27] offset:32768
  ds_write_b128 v2, v[28:31] offset:36864
  ds_write_b128 v2, v[32:35] offset:40960
  ds_write_b128 v2, v[36:39] offset:45056
  ds_read_b64_tr_b16 v[40:41], v65 offset:49152
  ds_read_b64_tr_b16 v[42:43], v65 offset:50176
  ds_read_b64_tr_b16 v[44:45], v65 offset:53248
  ds_read_b64_tr_b16 v[46:47], v65 offset:54272
  ds_read_b64_tr_b16 v[48:49], v65 offset:57344
  ds_read_b64_tr_b16 v[50:51], v65 offset:58368
  ds_read_b64_tr_b16 v[52:53], v65 offset:61440
  ds_read_b64_tr_b16 v[54:55], v65 offset:62464
  ds_read_b64_tr_b16 v[56:57], v66 offset:0
  ds_read_b64_tr_b16 v[58:59], v66 offset:1024
  ds_read_b64_tr_b16 v[60:61], v66 offset:4096
  ds_read_b64_tr_b16 v[62:63], v66 offset:5120
  s_waitcnt lgkmcnt(0)
  s_waitcnt vmcnt(6)
  s_barrier
  ds_write_b128 v2, v[40:43] offset:49152
  ds_write_b128 v2, v[44:47] offset:53248
  ds_write_b128 v2, v[48:51] offset:57344
  ds_write_b128 v2, v[52:55] offset:61440
  ds_write_b128 v3, v[56:59] offset:0
  ds_write_b128 v3, v[60:63] offset:4096
  ds_read_b64_tr_b16 v[16:17], v66 offset:8192
  ds_read_b64_tr_b16 v[18:19], v66 offset:9216
  ds_read_b64_tr_b16 v[20:21], v66 offset:12288
  ds_read_b64_tr_b16 v[22:23], v66 offset:13312
  ds_read_b64_tr_b16 v[24:25], v66 offset:16384
  ds_read_b64_tr_b16 v[26:27], v66 offset:17408
  ds_read_b64_tr_b16 v[28:29], v66 offset:20480
  ds_read_b64_tr_b16 v[30:31], v66 offset:21504
  ds_read_b64_tr_b16 v[32:33], v66 offset:24576
  ds_read_b64_tr_b16 v[34:35], v66 offset:25600
  ds_read_b64_tr_b16 v[36:37], v66 offset:28672
  ds_read_b64_tr_b16 v[38:39], v66 offset:29696
  s_waitcnt lgkmcnt(0)
  s_waitcnt vmcnt(0)
  s_barrier
  ds_write_b128 v3, v[16:19] offset:8192
  ds_write_b128 v3, v[20:23] offset:12288
  ds_write_b128 v3, v[24:27] offset:16384
  ds_write_b128 v3, v[28:31] offset:20480
  ds_write_b128 v3, v[32:35] offset:24576
  ds_write_b128 v3, v[36:39] offset:28672
  ds_read_b64_tr_b16 v[40:41], v66 offset:32768
  ds_read_b64_tr_b16 v[42:43], v66 offset:33792
  ds_read_b64_tr_b16 v[44:45], v66 offset:36864
  ds_read_b64_tr_b16 v[46:47], v66 offset:37888
  ds_read_b64_tr_b16 v[48:49], v66 offset:40960
  ds_read_b64_tr_b16 v[50:51], v66 offset:41984
  ds_read_b64_tr_b16 v[52:53], v66 offset:45056
  ds_read_b64_tr_b16 v[54:55], v66 offset:46080
  ds_read_b64_tr_b16 v[56:57], v66 offset:49152
  ds_read_b64_tr_b16 v[58:59], v66 offset:50176
  ds_read_b64_tr_b16 v[60:61], v66 offset:53248
  ds_read_b64_tr_b16 v[62:63], v66 offset:54272
  s_waitcnt lgkmcnt(0)
  s_barrier
  ds_write_b128 v3, v[40:43] offset:32768
  ds_write_b128 v3, v[44:47] offset:36864
  ds_write_b128 v3, v[48:51] offset:40960
  ds_write_b128 v3, v[52:55] offset:45056
  ds_write_b128 v3, v[56:59] offset:49152
  ds_write_b128 v3, v[60:63] offset:53248
  s_waitcnt lgkmcnt(0)
  s_cmp_lg_u32 s42, 2
  s_cbranch_scc1 sc_k0
  s_mov_b32 s53, 1
  s_cmp_ge_u32 s61, s53
  s_cbranch_scc1 wf_done_19
  s_mov_b32 s50, 0
wf_loop_20:
  buffer_load_dword v136, v15, s[8:11], 0 offen sc1
  s_add_u32 s50, s50, 1
  s_cmp_gt_u32 s50, 131072
  s_cbranch_scc1 L_fail
  s_waitcnt vmcnt(0)
  v_lshrrev_b32 v137, 6, v136
  v_not_b32 v138, v0
  v_or_b32 v137, v137, v138
  v_and_b32 v137, 1, v137
  v_add_u32 v136, v136, v137
  s_nop 1
  v_min_u32_dpp v136, v136, v136 row_ror:8 row_mask:0xf bank_mask:0xf
  s_nop 1
  v_min_u32_dpp v136, v136, v136 row_ror:4 row_mask:0xf bank_mask:0xf
  s_nop 1
  v_min_u32_dpp v136, v136, v136 row_ror:2 row_mask:0xf bank_mask:0xf
  s_nop 1
  v_min_u32_dpp v136, v136, v136 row_ror:1 row_mask:0xf bank_mask:0xf
  v_mov_b32 v137, v136
  s_nop 1
  v_permlane16_swap_b32 v137, v136
  v_min_u32 v136, v136, v137
  v_mov_b32 v137, v136
  s_nop 1
  v_permlane32_swap_b32 v137, v136
  v_min_u32 v136, v136, v137
  s_nop 0
  v_readfirstlane_b32 s61, v136
  s_nop 0
  s_cmp_ge_u32 s61, s53
  s_cbranch_scc1 wf_done_19
  s_sleep 2
  s_branch wf_loop_20
wf_done_19:
sc_k0:
  s_barrier
  s_cmp_eq_u32 s42, 3
  s_cbranch_scc1 scs_loop
  s_mov_b32 m0, s21
  s_lshr_b32 s63, s23, 1
  s_lshl_b32 s63, s63, 14
  s_and_b32 s46, s23, 1
  s_lshl_b32 s46, s46, 12
  s_add_u32 s63, s63, s46
  s_add_u32 s63, s63, s20
  s_lshr_b32 s46, s63, 8
  s_and_b32 s46, s46, 0x2000
  s_xor_b32 s63, s63, s46
  buffer_load_dwordx4 v1, s[8:11], s63 offen offset:0 sc1 lds
  buffer_load_dwordx4 v1, s[8:11], s63 offen offset:1024 sc1 lds
  buffer_load_dwordx4 v1, s[8:11], s63 offen offset:2048 sc1 lds
  buffer_load_dwordx4 v1, s[8:11], s63 offen offset:3072 sc1 lds
  s_waitcnt vmcnt(0)
  s_branch sch_loop
scs_loop:
  s_add_u32 s53, s52, 1
  s_lshl_b32 s56, s58, 2
  s_add_u32 s56, s56, s43
  s_lshl_b32 s56, s56, 16
  s_add_u32 s56, s56, s3
  s_add_u32 s56, s56, 12582912
  v_add_u32 v12, s56, v1
  s_lshl_b32 s66, s58, 18
  s_mov_b64 s[16:17], -1
  s_mov_b32 s71, 0
  ds_read_b128 v[56:59], v2 offset:0
  ds_read_b128 v[60:63], v2 offset:4096
  ds_read_b128 v[64:67], v2 offset:8192
  ds_read_b128 v[68:71], v2 offset:12288
  ds_read_b128 v[72:75], v2 offset:16384
  ds_read_b128 v[76:79], v2 offset:20480
  ds_read_b128 v[80:83], v2 offset:49152
  ds_read_b128 v[84:87], v2 offset:53248
  v_mov_b32 v88, 0
  v_mov_b32 v89, 0
  v_mov_b32 v90, 0
  v_mov_b32 v91, 0
  v_mov_b32 v92, 0
  v_mov_b32 v93, 0
  v_mov_b32 v94, 0
  v_mov_b32 v95, 0
  v_mov_b32 v96, 0
  v_mov_b32 v97, 0
  v_mov_b32 v98, 0
  v_mov_b32 v99, 0
  v_mov_b32 v100, 0
  v_mov_b32 v101, 0
  v_mov_b32 v102, 0
  v_mov_b32 v103, 0
  v_mov_b32 v104, 0
  v_mov_b32 v105, 0
  v_mov_b32 v106, 0
  v_mov_b32 v107, 0
  v_mov_b32 v108, 0
  v_mov_b32 v109, 0
  v_mov_b32 v110, 0
  v_mov_b32 v111, 0
  v_mov_b32 v6, s53
  s_waitcnt lgkmcnt(0)
  s_mov_b32 s50, 0
scs_top:
  s_barrier
  buffer_load_dwordx4 v[16:19], v12, s[8:11], 0 offen offset:0 sc1
  s_add_u32 m0, s51, 153600
  s_barrier
  buffer_load_dwordx4 v[20:23], v12, s[8:11], 0 offen offset:1024 sc1
  s_barrier
  buffer_load_dwordx4 v[24:27], v12, s[8:11], 0 offen offset:2048 sc1
  s_barrier
  buffer_load_dwordx4 v12, s[8:11], s31 offen sc1 lds
  s_add_u32 m0, s51, 157696
  s_barrier
  buffer_load_dwordx4 v12, s[8:11], s32 offen sc1 lds
  s_waitcnt vmcnt(4)
scs_go:
  v_smfmac_f32_16x16x64_bf16 v[88:91], v[16:19], a[192:199], v7
  v_smfmac_f32_16x16x64_bf16 v[92:95], v[16:19], a[200:207], v7
  v_smfmac_f32_16x16x64_bf16 v[96:99], v[16:19], a[208:215], v7
  v_smfmac_f32_16x16x64_bf16 v[100:103], v[16:19], v[56:63], v7
  v_smfmac_f32_16x16x64_bf16 v[104:107], v[16:19], v[64:71], v7
  ds_read_b128 v[56:59], v2 offset:57344
  v_smfmac_f32_16x16x64_bf16 v[108:111], v[16:19], v[72:79], v7
  s_waitcnt vmcnt(3)
  ds_read_b128 v[60:63], v2 offset:61440
  v_smfmac_f32_16x16x64_bf16 v[88:91], v[20:23], a[216:223], v7
  ds_read_b128 v[64:67], v3 offset:0
  v_smfmac_f32_16x16x64_bf16 v[92:95], v[20:23], a[224:231], v7
  ds_read_b128 v[68:71], v3 offset:4096
  v_smfmac_f32_16x16x64_bf16 v[96:99], v[20:23], a[232:239], v7
  s_waitcnt vmcnt(2)
  v_max3_u32 v136, v16, v20, v24
  v_smfmac_f32_16x16x64_bf16 v[100:103], v[20:23], a[0:7], v7
  ds_read_b128 v[72:75], v3 offset:8192
  v_cmp_eq_u32 vcc, -1, v136
  v_smfmac_f32_16x16x64_bf16 v[104:107], v[20:23], a[8:15], v7
  ds_read_b128 v[76:79], v3 offset:12288
  v_smfmac_f32_16x16x64_bf16 v[108:111], v[20:23], a[16:23], v7
  s_cbranch_vccnz scs_ha
  v_smfmac_f32_16x16x64_bf16 v[88:91], v[24:27], a[240:247], v7
  s_waitcnt vmcnt(1)
  s_barrier
  ds_read_b128 v[28:31], v149 offset:0
  v_smfmac_f32_16x16x64_bf16 v[92:95], v[24:27], a[248:255], v7
  ds_read_b128 v[32:35], v149 offset:1024
  v_smfmac_f32_16x16x64_bf16 v[96:99], v[24:27], v[152:159], v7
  ds_read_b128 v[36:39], v149 offset:2048
  v_smfmac_f32_16x16x64_bf16 v[100:103], v[24:27], a[24:31], v7
  ds_read_b128 v[40:43], v149 offset:3072
  v_smfmac_f32_16x16x64_bf16 v[104:107], v[24:27], a[32:39], v7
  v_smfmac_f32_16x16x64_bf16 v[108:111], v[24:27], a[40:47], v7
  s_waitcnt vmcnt(0)
  s_barrier
  s_waitcnt lgkmcnt(3)
  v_smfmac_f32_16x16x64_bf16 v[88:91], v[28:31], v[80:87], v7
  ds_read_b128 v[44:47], v149 offset:4096
  v_smfmac_f32_16x16x64_bf16 v[92:95], v[28:31], v[56:63], v7
  ds_read_b128 v[48:51], v149 offset:5120
  v_smfmac_f32_16x16x64_bf16 v[96:99], v[28:31], v[64:71], v7
  ds_read_b128 v[52:55], v149 offset:6144
  s_waitcnt lgkmcnt(3)
  v_smfmac_f32_16x16x64_bf16 v[88:91], v[32:35], v[160:167], v7
  ds_read_b128 v[80:83], v3 offset:32768
  ds_read_b128 v[16:19], v13 offset:8192
  v_smfmac_f32_16x16x64_bf16 v[92:95], v[32:35], v[168:175], v7
  ds_read_b128 v[84:87], v3 offset:36864
  ds_read_b128 v[20:23], v13 offset:10240
  v_smfmac_f32_16x16x64_bf16 v[96:99], v[32:35], v[176:183], v7
  ds_read_b128 v[56:59], v3 offset:16384
  ds_read_b128 v[24:27], v13 offset:9216
  v_smfmac_f32_16x16x64_bf16 v[88:91], v[36:39], v[184:191], v7
  s_waitcnt lgkmcnt(6)
  v_max3_u32 v136, v28, v32, v36
  v_smfmac_f32_16x16x64_bf16 v[92:95], v[36:39], v[192:199], v7
  ds_read_b128 v[60:63], v3 offset:20480
  v_max3_u32 v136, v136, v40, v44
  v_smfmac_f32_16x16x64_bf16 v[96:99], v[36:39], v[200:207], v7
  ds_read_b128 v[64:67], v3 offset:40960
  v_max3_u32 v136, v136, v48, v52
  v_smfmac_f32_16x16x64_bf16 v[88:91], v[44:47], v[208:215], v7
  ds_read_b128 v[68:71], v3 offset:45056
  v_cmp_eq_u32 vcc, -1, v136
  v_smfmac_f32_16x16x64_bf16 v[88:91], v[48:51], v[232:239], v7
  v_smfmac_f32_16x16x64_bf16 v[88:91], v[40:43], v[72:79], v7
  s_cbranch_vccnz scs_hb
  s_waitcnt lgkmcnt(3)
  v_smfmac_f32_16x16x64_bf16 v[88:91], v[52:55], v[80:87], v7
  ds_read_b128 v[72:75], v3 offset:24576
scs_join:
  v_smfmac_f32_16x16x64_bf16 v[92:95], v[44:47], v[216:223], v7
  ds_read_b128 v[76:79], v3 offset:28672
  v_smfmac_f32_16x16x64_bf16 v[92:95], v[48:51], v[240:247], v7
  ds_read_b128 v[80:83], v3 offset:49152
  s_waitcnt lgkmcnt(3)
  v_add_f32 v88, v88, v90
  v_smfmac_f32_16x16x64_bf16 v[92:95], v[40:43], v[56:63], v7
  ds_read_b128 v[84:87], v3 offset:53248
  v_add_f32 v89, v89, v91
  v_smfmac_f32_16x16x64_bf16 v[92:95], v[52:55], v[64:71], v7
  ds_read_b128 v[56:59], v2 offset:24576
  v_cmp_u_f32 vcc, v88, v89
  v_smfmac_f32_16x16x64_bf16 v[96:99], v[44:47], v[224:231], v7
  ds_read_b128 v[60:63], v2 offset:28672
  v_cvt_pk_bf16_f32 v136, v88, v89
  v_smfmac_f32_16x16x64_bf16 v[96:99], v[48:51], v[248:255], v7
  s_and_b64 vcc, vcc, s[16:17]
  s_cbranch_scc1 scs_redo
  s_waitcnt lgkmcnt(4)
  v_add_f32 v92, v92, v94
  v_smfmac_f32_16x16x64_bf16 v[96:99], v[40:43], v[72:79], v7
  ds_read_b128 v[64:67], v2 offset:32768
  s_waitcnt lgkmcnt(3)
  v_add_f32 v93, v93, v95
  v_smfmac_f32_16x16x64_bf16 v[96:99], v[52:55], v[80:87], v7
  ds_read_b128 v[68:71], v2 offset:36864
  v_cvt_pk_bf16_f32 v137, v92, v93
  v_smfmac_f32_16x16x64_bf16 v[100:103], v[28:31], a[48:55], v7
  ds_write2st64_b32 v4, v136, v137 offset0:0 offset1:4
  v_smfmac_f32_16x16x64_bf16 v[100:103], v[32:35], a[72:79], v7
  ds_read_b128 v[72:75], v2 offset:40960
  v_add_f32 v96, v96, v98
  v_smfmac_f32_16x16x64_bf16 v[100:103], v[40:43], a[96:103], v7
  ds_read_b128 v[76:79], v2 offset:45056
  s_waitcnt lgkmcnt(5)
  v_add_f32 v97, v97, v99
  v_smfmac_f32_16x16x64_bf16 v[100:103], v[36:39], v[56:63], v7
  ds_read_b128 v[80:83], v13 offset:5120
  v_cvt_pk_bf16_f32 v138, v96, v97
  v_smfmac_f32_16x16x64_bf16 v[100:103], v[44:47], a[120:127], v7
  ds_write_b32 v4, v138 offset:2048
  v_smfmac_f32_16x16x64_bf16 v[100:103], v[48:51], a[144:151], v7
  ds_read_b128 v[84:87], v13 offset:7168
  ds_read_b128 v[56:59], v13 offset:0
  s_waitcnt lgkmcnt(6)
  v_smfmac_f32_16x16x64_bf16 v[104:107], v[36:39], v[64:71], v7
  ds_read_b128 v[60:63], v13 offset:2048
  s_waitcnt lgkmcnt(5)
  v_smfmac_f32_16x16x64_bf16 v[108:111], v[36:39], v[72:79], v7
  ds_read_b128 v[64:67], v13 offset:1024
  ds_read_b128 v[68:71], v13 offset:3072
  v_smfmac_f32_16x16x64_bf16 v[100:103], v[52:55], a[168:175], v7
  s_waitcnt lgkmcnt(5)
  s_barrier
  v_smfmac_f32_16x16x64_bf16 v[104:107], v[28:31], a[56:63], v7
  ds_read_b64_tr_b16 v[112:113], v5 offset:0
  ds_read_b64_tr_b16 v[114:115], v5 offset:64
  v_smfmac_f32_16x16x64_bf16 v[104:107], v[32:35], a[80:87], v7
  ds_read_b64_tr_b16 v[116:117], v5 offset:512
  ds_read_b64_tr_b16 v[118:119], v5 offset:576
  v_smfmac_f32_16x16x64_bf16 v[104:107], v[40:43], a[104:111], v7
  ds_read_b64_tr_b16 v[120:121], v5 offset:1024
  ds_read_b64_tr_b16 v[122:123], v5 offset:1088
  v_smfmac_f32_16x16x64_bf16 v[104:107], v[44:47], a[128:135], v7
  ds_read_b64_tr_b16 v[124:125], v5 offset:1536
  ds_read_b64_tr_b16 v[126:127], v5 offset:1600
  buffer_store_dword v6, v11, s[8:11], 0 offen sc1
  v_smfmac_f32_16x16x64_bf16 v[104:107], v[48:51], a[152:159], v7
  ds_read_b64_tr_b16 v[128:129], v5 offset:2048
  ds_read_b64_tr_b16 v[130:131], v5 offset:2112
  v_smfmac_f32_16x16x64_bf16 v[104:107], v[52:55], a[176:183], v7
  ds_read_b64_tr_b16 v[132:133], v5 offset:2560
  ds_read_b64_tr_b16 v[134:135], v5 offset:2624
  v_smfmac_f32_16x16x64_bf16 v[108:111], v[28:31], a[64:71], v7
  ds_read_b128 v[72:75], v13 offset:4096
  v_add_f32 v100, v100, v102
  v_smfmac_f32_16x16x64_bf16 v[108:111], v[32:35], a[88:95], v7
  ds_read_b128 v[76:79], v13 offset:6144
  v_add_f32 v101, v101, v103
  v_smfmac_f32_16x16x64_bf16 v[108:111], v[40:43], a[112:119], v7
  ds_read_b128 v[36:39], v13 offset:11264
  v_cvt_pk_bf16_f32 v139, v100, v101
  v_smfmac_f32_16x16x64_bf16 v[108:111], v[44:47], a[136:143], v7
  v_add_f32 v104, v104, v106
  v_smfmac_f32_16x16x64_bf16 v[108:111], v[48:51], a[160:167], v7
  v_add_f32 v105, v105, v107
  v_smfmac_f32_16x16x64_bf16 v[108:111], v[52:55], a[184:191], v7
  s_waitcnt lgkmcnt(2)
  v_cvt_pk_bf16_f32 v140, v104, v105
  v_mfma_f32_16x16x32_bf16 v[88:91], v[56:59], v[112:115], 0
  ds_write2st64_b32 v4, v139, v140 offset0:12 offset1:16
  v_mfma_f32_16x16x32_bf16 v[92:95], v[60:63], v[112:115], 0
  v_add_f32 v108, v108, v110
  v_add_f32 v109, v109, v111
  v_mfma_f32_16x16x32_bf16 v[88:91], v[64:67], v[116:119], v[88:91]
  v_cvt_pk_bf16_f32 v141, v108, v109
  v_mfma_f32_16x16x32_bf16 v[92:95], v[68:71], v[116:119], v[92:95]
  ds_write_b32 v4, v141 offset:5120
  v_mfma_f32_16x16x32_bf16 v[88:91], v[72:75], v[120:123], v[88:91]
  s_waitcnt lgkmcnt(1)
  s_barrier
  v_mfma_f32_16x16x32_bf16 v[92:95], v[76:79], v[120:123], v[92:95]
  ds_read_b64_tr_b16 v[28:29], v5 offset:3072
  ds_read_b64_tr_b16 v[30:31], v5 offset:3136
  v_mfma_f32_16x16x32_bf16 v[88:91], v[80:83], v[124:127], v[88:91]
  ds_read_b64_tr_b16 v[32:33], v5 offset:3584
  ds_read_b64_tr_b16 v[34:35], v5 offset:3648
  v_mfma_f32_16x16x32_bf16 v[92:95], v[84:87], v[124:127], v[92:95]
  s_waitcnt lgkmcnt(4)
  s_barrier
  v_mfma_f32_16x16x32_bf16 v[88:91], v[16:19], v[128:131], v[88:91]
  ds_read_b64_tr_b16 v[40:41], v5 offset:4096
  ds_read_b64_tr_b16 v[42:43], v5 offset:4160
  v_mfma_f32_16x16x32_bf16 v[92:95], v[20:23], v[128:131], v[92:95]
  ds_read_b64_tr_b16 v[44:45], v5 offset:4608
  ds_read_b64_tr_b16 v[46:47], v5 offset:4672
  v_mfma_f32_16x16x32_bf16 v[88:91], v[24:27], v[132:135], v[88:91]
  ds_read_b64_tr_b16 v[48:49], v5 offset:5120
  ds_read_b64_tr_b16 v[50:51], v5 offset:5184
  v_mfma_f32_16x16x32_bf16 v[92:95], v[36:39], v[132:135], v[92:95]
  ds_read_b64_tr_b16 v[52:53], v5 offset:5632
  s_waitcnt lgkmcnt(7)
  v_mfma_f32_16x16x32_bf16 v[96:99], v[28:31], v[112:115], 0
  ds_read_b64_tr_b16 v[54:55], v5 offset:5696
  v_mfma_f32_16x16x32_bf16 v[96:99], v[32:35], v[116:119], v[96:99]
  s_waitcnt lgkmcnt(6)
  v_max3_f32 v142, v88, v89, v90
  v_max3_f32 v142, v142, v91, v92
  v_mfma_f32_16x16x32_bf16 v[96:99], v[40:43], v[120:123], v[96:99]
  s_waitcnt lgkmcnt(4)
  v_max3_f32 v142, v142, v93, v94
  v_max_f32 v142, v142, v95
  v_mfma_f32_16x16x32_bf16 v[96:99], v[44:47], v[124:127], v[96:99]
  s_waitcnt lgkmcnt(2)
  v_mov_b32 v143, v142
  v_cndmask_b32 v136, v88, v90, s[18:19]
  v_mfma_f32_16x16x32_bf16 v[96:99], v[48:51], v[128:131], v[96:99]
  s_waitcnt lgkmcnt(0)
  v_permlane32_swap_b32 v143, v142
  v_mfma_f32_16x16x32_bf16 v[96:99], v[52:55], v[132:135], v[96:99]
  s_barrier
  v_max_f32 v142, v142, v143
  v_cndmask_b32 v137, v89, v91, s[18:19]
  v_cndmask_b32 v138, v92, v94, s[18:19]
  v_cndmask_b32 v139, v93, v95, s[18:19]
  s_nop 2
  v_max3_f32 v142, v142, v96, v97
  v_max3_f32 v142, v142, v98, v99
  v_mov_b32 v143, v142
  v_cndmask_b32 v140, v96, v98, s[18:19]
  v_cndmask_b32 v141, v97, v99, s[18:19]
  v_permlane16_swap_b32 v143, v142
  v_max_f32 v142, v142, v143
  v_mul_f32 v142, s68, v142
  v_pk_fma_f32 v[136:137], v[136:137], s[68:69], v[142:143] op_sel_hi:[1,0,0] neg_lo:[0,0,1] neg_hi:[0,0,1]
  v_pk_fma_f32 v[138:139], v[138:139], s[68:69], v[142:143] op_sel_hi:[1,0,0] neg_lo:[0,0,1] neg_hi:[0,0,1]
  v_pk_fma_f32 v[140:141], v[140:141], s[68:69], v[142:143] op_sel_hi:[1,0,0] neg_lo:[0,0,1] neg_hi:[0,0,1]
  v_exp_f32 v136, v136
  v_exp_f32 v137, v137
  v_exp_f32 v138, v138
  v_exp_f32 v139, v139
  v_exp_f32 v140, v140
  v_pk_add_f32 v[144:145], v[136:137], v[138:139]
  v_add_f32 v142, v144, v145
  v_add_f32 v143, v144, v145
  v_exp_f32 v141, v141
  s_nop 0
  v_permlane32_swap_b32 v143, v142
  v_pk_add_f32 v[142:143], v[142:143], v[140:141]
  v_add_f32 v142, v142, v143
  s_nop 1
  v_add_f32_dpp v142, v142, v142 row_ror:8 row_mask:0xf bank_mask:0xf
  v_mov_b32 v143, v142
  s_nop 1
  v_permlane16_swap_b32 v143, v142
  v_add_f32 v142, v142, v143
  v_rcp_f32 v142, v142
  s_nop 0
  v_pk_mul_f32 v[136:137], v[136:137], v[142:143] op_sel_hi:[1,0]
  v_pk_mul_f32 v[138:139], v[138:139], v[142:143] op_sel_hi:[1,0]
  v_pk_mul_f32 v[140:141], v[140:141], v[142:143] op_sel_hi:[1,0]
  v_cvt_pk_bf16_f32 v146, v136, v137
  v_cvt_pk_bf16_f32 v147, v138, v139
  v_cvt_pk_bf16_f32 v148, v140, v141
  buffer_store_dwordx2 v[146:147], v8, s[8:11], s66 offen sc1
  buffer_store_dword v148, v9, s[8:11], s66 offen sc1
  v_mov_b32 v150, -1
  v_mov_b32 v151, -1
  s_waitcnt vmcnt(0)
  s_add_u32 s46, s65, 0
  buffer_store_dwordx2 v[150:151], v8, s[8:11], s46 offen sc1
  buffer_store_dword v150, v9, s[8:11], s46 offen sc1
  s_mov_b32 s65, s66
  v_add_u32 v13, s22, v13
  s_sub_u32 s22, 0, s22
  s_add_u32 s58, s58, 1
  s_cmp_eq_u32 s58, 3
  s_cselect_b32 s58, 0, s58
  s_mov_b32 s52, s53
  s_cmp_lt_u32 s52, 64
  s_cbranch_scc1 scs_loop
  s_endpgm
sch_loop:
  s_add_u32 s53, s52, 1
  s_lshl_b32 s56, s58, 2
  s_add_u32 s56, s56, s43
  s_lshl_b32 s56, s56, 16
  s_add_u32 s56, s56, s3
  s_add_u32 s56, s56, 12582912
  v_add_u32 v12, s56, v1
  s_lshl_b32 s66, s58, 18
  s_mov_b64 s[16:17], -1
  s_mov_b32 s71, 0
  ds_read_b128 v[56:59], v2 offset:0
  ds_read_b128 v[60:63], v2 offset:4096
  ds_read_b128 v[64:67], v2 offset:8192
  ds_read_b128 v[68:71], v2 offset:12288
  ds_read_b128 v[72:75], v2 offset:16384
  ds_read_b128 v[76:79], v2 offset:20480
  ds_read_b128 v[80:83], v2 offset:49152
  ds_read_b128 v[84:87], v2 offset:53248
  v_mov_b32 v88, 0
  v_mov_b32 v89, 0
  v_mov_b32 v90, 0
  v_mov_b32 v91, 0
  v_mov_b32 v92, 0
  v_mov_b32 v93, 0
  v_mov_b32 v94, 0
  v_mov_b32 v95, 0
  v_mov_b32 v96, 0
  v_mov_b32 v97, 0
  v_mov_b32 v98, 0
  v_mov_b32 v99, 0
  v_mov_b32 v100, 0
  v_mov_b32 v101, 0
  v_mov_b32 v102, 0
  v_mov_b32 v103, 0
  v_mov_b32 v104, 0
  v_mov_b32 v105, 0
  v_mov_b32 v106, 0
  v_mov_b32 v107, 0
  v_mov_b32 v108, 0
  v_mov_b32 v109, 0
  v_mov_b32 v110, 0
  v_mov_b32 v111, 0
  s_xor_b32 s28, s63, 0x2000
  s_add_u32 s28, s28, s26
  s_add_u32 s29, s28, 16777216
  s_add_u32 s30, s28, 33554432
  s_add_u32 s23, s23, 32
  s_cmp_ge_u32 s23, 1024
  s_cselect_b32 s46, 1024, 0
  s_sub_u32 s23, s23, s46
  s_lshr_b32 s63, s23, 1
  s_lshl_b32 s63, s63, 14
  s_and_b32 s46, s23, 1
  s_lshl_b32 s46, s46, 12
  s_add_u32 s63, s63, s46
  s_add_u32 s63, s63, s20
  s_lshr_b32 s46, s63, 8
  s_and_b32 s46, s46, 0x2000
  s_xor_b32 s63, s63, s46
  s_add_u32 s21, s21, s22
  s_waitcnt vmcnt(0) lgkmcnt(0)
  s_cmp_lg_u32 s42, 2
  s_cbranch_scc1 sc_nobell
  s_add_u32 s49, s52, 2
  s_cmp_ge_u32 s61, s49
  s_cbranch_scc1 wf_done_21
  s_mov_b32 s50, 0
wf_loop_22:
  buffer_load_dword v136, v15, s[8:11], 0 offen sc1
  s_add_u32 s50, s50, 1
  s_cmp_gt_u32 s50, 131072
  s_cbranch_scc1 L_fail
  s_waitcnt vmcnt(0)
  v_lshrrev_b32 v137, 6, v136
  v_not_b32 v138, v0
  v_or_b32 v137, v137, v138
  v_and_b32 v137, 1, v137
  v_add_u32 v136, v136, v137
  s_nop 1
  v_min_u32_dpp v136, v136, v136 row_ror:8 row_mask:0xf bank_mask:0xf
  s_nop 1
  v_min_u32_dpp v136, v136, v136 row_ror:4 row_mask:0xf bank_mask:0xf
  s_nop 1
  v_min_u32_dpp v136, v136, v136 row_ror:2 row_mask:0xf bank_mask:0xf
  s_nop 1
  v_min_u32_dpp v136, v136, v136 row_ror:1 row_mask:0xf bank_mask:0xf
  v_mov_b32 v137, v136
  s_nop 1
  v_permlane16_swap_b32 v137, v136
  v_min_u32 v136, v136, v137
  v_mov_b32 v137, v136
  s_nop 1
  v_permlane32_swap_b32 v137, v136
  v_min_u32 v136, v136, v137
  s_nop 0
  v_readfirstlane_b32 s61, v136
  s_nop 0
  s_cmp_ge_u32 s61, s49
  s_cbranch_scc1 wf_done_21
  s_sleep 2
  s_branch wf_loop_22
wf_done_21:
  s_mov_b32 s50, 0
  s_waitcnt lgkmcnt(0)
  s_mov_b64 s[80:81], 0
  s_mov_b64 s[82:83], 0
  s_cmp_eq_u32 s53, 1
  s_cbranch_scc1 bell_x_24
bell_23:
  s_load_dwordx4 s[80:83], s[40:41], 0 glc
  s_min_u32 s46, s80, s81
  s_min_u32 s47, s82, s83
  s_min_u32 s46, s46, s47
  s_cmp_ge_u32 s46, s53
  s_cbranch_scc1 bell_x_24
  s_min_u32 s46, s80, s81
  s_min_u32 s47, s82, s83
  s_min_u32 s46, s46, s47
  s_cmp_ge_u32 s46, s53
  s_cbranch_scc1 bell_x_24
  s_min_u32 s46, s80, s81
  s_min_u32 s47, s82, s83
  s_min_u32 s46, s46, s47
  s_cmp_ge_u32 s46, s53
  s_cbranch_scc1 bell_x_24
  s_min_u32 s46, s80, s81
  s_min_u32 s47, s82, s83
  s_min_u32 s46, s46, s47
  s_cmp_ge_u32 s46, s53
  s_cbranch_scc1 bell_x_24
  s_min_u32 s46, s80, s81
  s_min_u32 s47, s82, s83
  s_min_u32 s46, s46, s47
  s_cmp_ge_u32 s46, s53
  s_cbranch_scc1 bell_x_24
  s_min_u32 s46, s80, s81
  s_min_u32 s47, s82, s83
  s_min_u32 s46, s46, s47
  s_cmp_ge_u32 s46, s53
  s_cbranch_scc1 bell_x_24
  s_min_u32 s46, s80, s81
  s_min_u32 s47, s82, s83
  s_min_u32 s46, s46, s47
  s_cmp_ge_u32 s46, s53
  s_cbranch_scc1 bell_x_24
  s_min_u32 s46, s80, s81
  s_min_u32 s47, s82, s83
  s_min_u32 s46, s46, s47
  s_cmp_ge_u32 s46, s53
  s_cbranch_scc1 bell_x_24
  s_min_u32 s46, s80, s81
  s_min_u32 s47, s82, s83
  s_min_u32 s46, s46, s47
  s_cmp_ge_u32 s46, s53
  s_cbranch_scc1 bell_x_24
  s_min_u32 s46, s80, s81
  s_min_u32 s47, s82, s83
  s_min_u32 s46, s46, s47
  s_cmp_ge_u32 s46, s53
  s_cbranch_scc1 bell_x_24
  s_add_u32 s50, s50, 1
  s_cmp_lt_u32 s50, 524288
  s_cbranch_scc1 bell_23
  s_branch L_fail
bell_x_24:
sc_nobell:
  s_mov_b32 s50, 0
sch_top:
  s_barrier
  buffer_load_dwordx4 v[16:19], v12, s[8:11], 0 offen offset:0 sc1
  s_add_u32 m0, s51, 153600
  s_barrier
  buffer_load_dwordx4 v[20:23], v12, s[8:11], 0 offen offset:1024 sc1
  s_barrier
  buffer_load_dwordx4 v[24:27], v12, s[8:11], 0 offen offset:2048 sc1
  s_barrier
  buffer_load_dwordx4 v12, s[8:11], s31 offen sc1 lds
  s_add_u32 m0, s51, 157696
  s_barrier
  buffer_load_dwordx4 v12, s[8:11], s32 offen sc1 lds
  s_waitcnt vmcnt(4)
sch_go:
  v_smfmac_f32_16x16x64_bf16 v[88:91], v[16:19], a[192:199], v7
  v_smfmac_f32_16x16x64_bf16 v[92:95], v[16:19], a[200:207], v7
  v_smfmac_f32_16x16x64_bf16 v[96:99], v[16:19], a[208:215], v7
  v_smfmac_f32_16x16x64_bf16 v[100:103], v[16:19], v[56:63], v7
  v_smfmac_f32_16x16x64_bf16 v[104:107], v[16:19], v[64:71], v7
  ds_read_b128 v[56:59], v2 offset:57344
  v_smfmac_f32_16x16x64_bf16 v[108:111], v[16:19], v[72:79], v7
  s_waitcnt vmcnt(3)
  ds_read_b128 v[60:63], v2 offset:61440
  v_smfmac_f32_16x16x64_bf16 v[88:91], v[20:23], a[216:223], v7
  ds_read_b128 v[64:67], v3 offset:0
  v_smfmac_f32_16x16x64_bf16 v[92:95], v[20:23], a[224:231], v7
  ds_read_b128 v[68:71], v3 offset:4096
  v_smfmac_f32_16x16x64_bf16 v[96:99], v[20:23], a[232:239], v7
  s_waitcnt vmcnt(2)
  v_max3_u32 v136, v16, v20, v24
  v_smfmac_f32_16x16x64_bf16 v[100:103], v[20:23], a[0:7], v7
  ds_read_b128 v[72:75], v3 offset:8192
  v_cmp_eq_u32 vcc, -1, v136
  v_smfmac_f32_16x16x64_bf16 v[104:107], v[20:23], a[8:15], v7
  ds_read_b128 v[76:79], v3 offset:12288
  v_smfmac_f32_16x16x64_bf16 v[108:111], v[20:23], a[16:23], v7
  s_cbranch_vccnz sch_ha
  v_smfmac_f32_16x16x64_bf16 v[88:91], v[24:27], a[240:247], v7
  s_waitcnt vmcnt(1)
  s_barrier
  ds_read_b128 v[28:31], v149 offset:0
  v_smfmac_f32_16x16x64_bf16 v[92:95], v[24:27], a[248:255], v7
  ds_read_b128 v[32:35], v149 offset:1024
  v_smfmac_f32_16x16x64_bf16 v[96:99], v[24:27], v[152:159], v7
  ds_read_b128 v[36:39], v149 offset:2048
  v_smfmac_f32_16x16x64_bf16 v[100:103], v[24:27], a[24:31], v7
  ds_read_b128 v[40:43], v149 offset:3072
  v_smfmac_f32_16x16x64_bf16 v[104:107], v[24:27], a[32:39], v7
  v_smfmac_f32_16x16x64_bf16 v[108:111], v[24:27], a[40:47], v7
  s_waitcnt vmcnt(0)
  s_barrier
  s_waitcnt lgkmcnt(3)
  v_smfmac_f32_16x16x64_bf16 v[88:91], v[28:31], v[80:87], v7
  ds_read_b128 v[44:47], v149 offset:4096
  v_smfmac_f32_16x16x64_bf16 v[92:95], v[28:31], v[56:63], v7
  ds_read_b128 v[48:51], v149 offset:5120
  v_smfmac_f32_16x16x64_bf16 v[96:99], v[28:31], v[64:71], v7
  ds_read_b128 v[52:55], v149 offset:6144
  s_waitcnt lgkmcnt(3)
  v_smfmac_f32_16x16x64_bf16 v[88:91], v[32:35], v[160:167], v7
  ds_read_b128 v[80:83], v3 offset:32768
  v_smfmac_f32_16x16x64_bf16 v[92:95], v[32:35], v[168:175], v7
  ds_read_b128 v[84:87], v3 offset:36864
  v_smfmac_f32_16x16x64_bf16 v[96:99], v[32:35], v[176:183], v7
  ds_read_b128 v[56:59], v3 offset:16384
  v_smfmac_f32_16x16x64_bf16 v[88:91], v[36:39], v[184:191], v7
  s_waitcnt lgkmcnt(3)
  v_max3_u32 v136, v28, v32, v36
  v_smfmac_f32_16x16x64_bf16 v[92:95], v[36:39], v[192:199], v7
  ds_read_b128 v[60:63], v3 offset:20480
  v_max3_u32 v136, v136, v40, v44
  v_smfmac_f32_16x16x64_bf16 v[96:99], v[36:39], v[200:207], v7
  ds_read_b128 v[64:67], v3 offset:40960
  v_max3_u32 v136, v136, v48, v52
  v_smfmac_f32_16x16x64_bf16 v[88:91], v[44:47], v[208:215], v7
  ds_read_b128 v[68:71], v3 offset:45056
  v_cmp_eq_u32 vcc, -1, v136
  v_smfmac_f32_16x16x64_bf16 v[88:91], v[48:51], v[232:239], v7
  v_smfmac_f32_16x16x64_bf16 v[88:91], v[40:43], v[72:79], v7
  s_cbranch_vccnz sch_hb
  s_waitcnt lgkmcnt(3)
  v_smfmac_f32_16x16x64_bf16 v[88:91], v[52:55], v[80:87], v7
  ds_read_b128 v[72:75], v3 offset:24576
  s_mov_b32 m0, s21
sch_join:
  v_smfmac_f32_16x16x64_bf16 v[92:95], v[44:47], v[216:223], v7
  ds_read_b128 v[76:79], v3 offset:28672
  buffer_load_dwordx4 v[112:115], v1, s[8:11], s28 offen offset:0 sc1
  v_smfmac_f32_16x16x64_bf16 v[92:95], v[48:51], v[240:247], v7
  ds_read_b128 v[80:83], v3 offset:49152
  s_waitcnt lgkmcnt(3)
  v_add_f32 v88, v88, v90
  v_smfmac_f32_16x16x64_bf16 v[92:95], v[40:43], v[56:63], v7
  ds_read_b128 v[84:87], v3 offset:53248
  v_add_f32 v89, v89, v91
  v_smfmac_f32_16x16x64_bf16 v[92:95], v[52:55], v[64:71], v7
  ds_read_b128 v[56:59], v2 offset:24576
  buffer_load_dwordx4 v[116:119], v1, s[8:11], s28 offen offset:1024 sc1
  v_cmp_u_f32 vcc, v88, v89
  v_smfmac_f32_16x16x64_bf16 v[96:99], v[44:47], v[224:231], v7
  ds_read_b128 v[60:63], v2 offset:28672
  v_cvt_pk_bf16_f32 v136, v88, v89
  v_smfmac_f32_16x16x64_bf16 v[96:99], v[48:51], v[248:255], v7
  s_and_b64 vcc, vcc, s[16:17]
  s_cbranch_scc1 sch_redo
  s_waitcnt lgkmcnt(4)
  v_add_f32 v92, v92, v94
  v_smfmac_f32_16x16x64_bf16 v[96:99], v[40:43], v[72:79], v7
  ds_read_b128 v[64:67], v2 offset:32768
  buffer_load_dwordx4 v[120:123], v1, s[8:11], s29 offen offset:0 sc1
  s_waitcnt lgkmcnt(3)
  v_add_f32 v93, v93, v95
  v_smfmac_f32_16x16x64_bf16 v[96:99], v[52:55], v[80:87], v7
  ds_read_b128 v[68:71], v2 offset:36864
  v_cvt_pk_bf16_f32 v137, v92, v93
  v_smfmac_f32_16x16x64_bf16 v[100:103], v[28:31], a[48:55], v7
  ds_write2st64_b32 v4, v136, v137 offset0:0 offset1:4
  v_smfmac_f32_16x16x64_bf16 v[100:103], v[32:35], a[72:79], v7
  ds_read_b128 v[72:75], v2 offset:40960
  buffer_load_dwordx4 v[124:127], v1, s[8:11], s29 offen offset:1024 sc1
  v_add_f32 v96, v96, v98
  v_smfmac_f32_16x16x64_bf16 v[100:103], v[40:43], a[96:103], v7
  ds_read_b128 v[76:79], v2 offset:45056
  s_waitcnt lgkmcnt(5)
  v_add_f32 v97, v97, v99
  v_smfmac_f32_16x16x64_bf16 v[100:103], v[36:39], v[56:63], v7
  v_cvt_pk_bf16_f32 v138, v96, v97
  v_smfmac_f32_16x16x64_bf16 v[100:103], v[44:47], a[120:127], v7
  ds_write_b32 v4, v138 offset:2048
  buffer_load_dwordx4 v[128:131], v1, s[8:11], s30 offen offset:0 sc1
  v_smfmac_f32_16x16x64_bf16 v[100:103], v[48:51], a[144:151], v7
  s_waitcnt lgkmcnt(3)
  v_smfmac_f32_16x16x64_bf16 v[104:107], v[36:39], v[64:71], v7
  s_waitcnt lgkmcnt(1)
  v_smfmac_f32_16x16x64_bf16 v[108:111], v[36:39], v[72:79], v7
  buffer_load_dwordx4 v[132:135], v1, s[8:11], s30 offen offset:1024 sc1
  v_smfmac_f32_16x16x64_bf16 v[100:103], v[52:55], a[168:175], v7
  s_waitcnt lgkmcnt(0)
  s_barrier
  v_smfmac_f32_16x16x64_bf16 v[104:107], v[28:31], a[56:63], v7
  v_smfmac_f32_16x16x64_bf16 v[104:107], v[32:35], a[80:87], v7
  buffer_load_dwordx4 v1, s[8:11], s63 offen offset:0 sc1 lds
  v_add_f32 v100, v100, v102
  v_smfmac_f32_16x16x64_bf16 v[104:107], v[40:43], a[104:111], v7
  v_add_f32 v101, v101, v103
  v_smfmac_f32_16x16x64_bf16 v[104:107], v[44:47], a[128:135], v7
  v_cvt_pk_bf16_f32 v139, v100, v101
  v_smfmac_f32_16x16x64_bf16 v[104:107], v[48:51], a[152:159], v7
  buffer_load_dwordx4 v1, s[8:11], s63 offen offset:1024 sc1 lds
  v_smfmac_f32_16x16x64_bf16 v[104:107], v[52:55], a[176:183], v7
  v_smfmac_f32_16x16x64_bf16 v[108:111], v[28:31], a[64:71], v7
  v_smfmac_f32_16x16x64_bf16 v[108:111], v[32:35], a[88:95], v7
  buffer_load_dwordx4 v1, s[8:11], s63 offen offset:2048 sc1 lds
  v_add_f32 v104, v104, v106
  v_smfmac_f32_16x16x64_bf16 v[108:111], v[40:43], a[112:119], v7
  v_add_f32 v105, v105, v107
  v_smfmac_f32_16x16x64_bf16 v[108:111], v[44:47], a[136:143], v7
  v_cvt_pk_bf16_f32 v140, v104, v105
  v_smfmac_f32_16x16x64_bf16 v[108:111], v[48:51], a[160:167], v7
  ds_write2st64_b32 v4, v139, v140 offset0:12 offset1:16
  buffer_load_dwordx4 v1, s[8:11], s63 offen offset:3072 sc1 lds
  v_smfmac_f32_16x16x64_bf16 v[108:111], v[52:55], a[184:191], v7
  s_nop 7
  v_add_f32 v108, v108, v110
  v_add_f32 v109, v109, v111
  v_cvt_pk_bf16_f32 v141, v108, v109
  ds_write_b32 v4, v141 offset:5120
  s_waitcnt lgkmcnt(1)
  s_barrier
  s_waitcnt lgkmcnt(0)
  s_barrier
  s_barrier
  s_cmp_ge_u32 s42, 2
  s_cbranch_scc1 sc_nox
  ds_read_b128 v[56:59], v13 offset:0
  ds_read_b128 v[60:63], v13 offset:2048
  ds_read_b128 v[64:67], v13 offset:1024
  ds_read_b128 v[68:71], v13 offset:3072
  ds_read_b128 v[72:75], v13 offset:4096
  ds_read_b128 v[76:79], v13 offset:6144
  ds_read_b128 v[80:83], v13 offset:5120
  ds_read_b128 v[84:87], v13 offset:7168
  ds_read_b128 v[16:19], v13 offset:8192
  ds_read_b128 v[20:23], v13 offset:10240
  ds_read_b128 v[24:27], v13 offset:9216
  ds_read_b128 v[36:39], v13 offset:11264
  s_waitcnt vmcnt(4)
  s_waitcnt lgkmcnt(11)
  v_mfma_f32_16x16x32_bf16 v[88:91], v[56:59], v[112:115], 0
  ds_read_b64_tr_b16 v[28:29], v5 offset:3072
  s_waitcnt lgkmcnt(11)
  v_mfma_f32_16x16x32_bf16 v[92:95], v[60:63], v[112:115], 0
  ds_read_b64_tr_b16 v[30:31], v5 offset:3136
  s_waitcnt lgkmcnt(11)
  v_mfma_f32_16x16x32_bf16 v[88:91], v[64:67], v[116:119], v[88:91]
  ds_read_b64_tr_b16 v[32:33], v5 offset:3584
  s_waitcnt lgkmcnt(11)
  v_mfma_f32_16x16x32_bf16 v[92:95], v[68:71], v[116:119], v[92:95]
  ds_read_b64_tr_b16 v[34:35], v5 offset:3648
  s_waitcnt lgkmcnt(11)
  v_mfma_f32_16x16x32_bf16 v[88:91], v[72:75], v[120:123], v[88:91]
  ds_read_b64_tr_b16 v[40:41], v5 offset:4096
  s_waitcnt lgkmcnt(5)
  v_mfma_f32_16x16x32_bf16 v[92:95], v[76:79], v[120:123], v[92:95]
  ds_read_b64_tr_b16 v[42:43], v5 offset:4160
  v_mfma_f32_16x16x32_bf16 v[88:91], v[80:83], v[124:127], v[88:91]
  ds_read_b64_tr_b16 v[44:45], v5 offset:4608
  v_mfma_f32_16x16x32_bf16 v[92:95], v[84:87], v[124:127], v[92:95]
  ds_read_b64_tr_b16 v[46:47], v5 offset:4672
  v_mfma_f32_16x16x32_bf16 v[88:91], v[16:19], v[128:131], v[88:91]
  ds_read_b64_tr_b16 v[48:49], v5 offset:5120
  v_mfma_f32_16x16x32_bf16 v[92:95], v[20:23], v[128:131], v[92:95]
  ds_read_b64_tr_b16 v[50:51], v5 offset:5184
  v_mfma_f32_16x16x32_bf16 v[88:91], v[24:27], v[132:135], v[88:91]
  ds_read_b64_tr_b16 v[52:53], v5 offset:5632
  v_mfma_f32_16x16x32_bf16 v[92:95], v[36:39], v[132:135], v[92:95]
  ds_read_b64_tr_b16 v[54:55], v5 offset:5696
  s_waitcnt lgkmcnt(5)
  v_mfma_f32_16x16x32_bf16 v[96:99], v[28:31], v[112:115], 0
  v_mfma_f32_16x16x32_bf16 v[96:99], v[32:35], v[116:119], v[96:99]
  v_mfma_f32_16x16x32_bf16 v[96:99], v[40:43], v[120:123], v[96:99]
  s_waitcnt lgkmcnt(2)
  v_mfma_f32_16x16x32_bf16 v[96:99], v[44:47], v[124:127], v[96:99]
  v_mfma_f32_16x16x32_bf16 v[96:99], v[48:51], v[128:131], v[96:99]
  s_waitcnt lgkmcnt(0)
  v_mfma_f32_16x16x32_bf16 v[96:99], v[52:55], v[132:135], v[96:99]
  v_mov_b32 v143, s70
  v_cndmask_b32 v88, v88, v143, s[72:73]
  v_cndmask_b32 v89, v89, v143, s[74:75]
  v_cndmask_b32 v90, v90, v143, s[76:77]
  v_cndmask_b32 v91, v91, v143, s[78:79]
  v_cndmask_b32 v92, v92, v143, s[80:81]
  v_cndmask_b32 v93, v93, v143, s[82:83]
  v_cndmask_b32 v94, v94, v143, s[84:85]
  v_cndmask_b32 v95, v95, v143, s[86:87]
  s_mov_b32 vcc_lo, 0
  s_mov_b32 vcc_hi, -1
  v_cndmask_b32 v96, v96, v98, vcc
  v_cndmask_b32 v97, v97, v99, vcc
  v_max_f32 v142, v88, v89
  v_max3_f32 v142, v142, v90, v91
  v_max3_f32 v142, v142, v92, v93
  v_max3_f32 v142, v142, v94, v95
  v_max3_f32 v142, v142, v96, v97
  v_mov_b32 v143, v142
  s_nop 1
  v_permlane16_swap_b32 v143, v142
  v_max_f32 v142, v142, v143
  v_mov_b32 v143, v142
  s_nop 1
  v_permlane32_swap_b32 v143, v142
  v_max_f32 v142, v142, v143
  v_mul_f32 v142, s68, v142
  v_fma_f32 v88, v88, s68, -v142
  v_fma_f32 v89, v89, s68, -v142
  v_fma_f32 v90, v90, s68, -v142
  v_fma_f32 v91, v91, s68, -v142
  v_fma_f32 v92, v92, s68, -v142
  v_fma_f32 v93, v93, s68, -v142
  v_fma_f32 v94, v94, s68, -v142
  v_fma_f32 v95, v95, s68, -v142
  v_fma_f32 v96, v96, s68, -v142
  v_fma_f32 v97, v97, s68, -v142
  v_exp_f32 v88, v88
  v_exp_f32 v89, v89
  v_exp_f32 v90, v90
  v_exp_f32 v91, v91
  v_exp_f32 v92, v92
  v_exp_f32 v93, v93
  v_exp_f32 v94, v94
  v_exp_f32 v95, v95
  v_exp_f32 v96, v96
  v_exp_f32 v97, v97
  v_add_f32 v142, v88, v89
  v_add_f32 v142, v142, v90
  v_add_f32 v142, v142, v91
  v_add_f32 v142, v142, v92
  v_add_f32 v142, v142, v93
  v_add_f32 v142, v142, v94
  v_add_f32 v142, v142, v95
  v_add_f32 v142, v142, v96
  v_add_f32 v142, v142, v97
  v_mov_b32 v143, v142
  s_nop 1
  v_permlane16_swap_b32 v143, v142
  v_add_f32 v142, v142, v143
  v_mov_b32 v143, v142
  s_nop 1
  v_permlane32_swap_b32 v143, v142
  v_add_f32 v142, v142, v143
  v_rcp_f32 v142, v142
  s_nop 0
  v_mul_f32 v88, v88, v142
  v_mul_f32 v89, v89, v142
  v_mul_f32 v90, v90, v142
  v_mul_f32 v91, v91, v142
  v_mul_f32 v92, v92, v142
  v_mul_f32 v93, v93, v142
  v_mul_f32 v94, v94, v142
  v_mul_f32 v95, v95, v142
  v_mul_f32 v96, v96, v142
  v_mul_f32 v97, v97, v142
  v_cvt_pk_bf16_f32 v144, v88, v89
  v_cvt_pk_bf16_f32 v145, v90, v91
  v_cvt_pk_bf16_f32 v146, v92, v93
  v_cvt_pk_bf16_f32 v147, v94, v95
  v_cvt_pk_bf16_f32 v148, v96, v97
  s_mov_b32 s47, s64
  s_lshr_b32 s46, s47, 8
  s_and_b32 s46, s46, 0x2000
  s_xor_b32 s47, s47, s46
  s_add_u32 s46, s47, s27
  buffer_store_dwordx4 v[144:147], v1, s[8:11], s46 offen sc1
  buffer_store_dword v148, v14, s[8:11], s47 offen sc1
  s_add_u32 s64, s64, 262144
  s_cmp_ge_u32 s64, 16777216
  s_cselect_b32 s46, 2097152, 0
  s_sub_u32 s64, s64, s46
sc_nox:
  v_add_u32 v13, s22, v13
  s_sub_u32 s22, 0, s22
  s_add_u32 s58, s58, 1
  s_cmp_eq_u32 s58, 3
  s_cselect_b32 s58, 0, s58
  s_mov_b32 s52, s53
  s_cmp_lt_u32 s52, 64
  s_cbranch_scc1 sch_loop
  s_waitcnt vmcnt(0)
  s_cmp_ge_u32 s42, 2
  s_cbranch_scc1 L_end
  v_mov_b32 v136, s52
  s_mov_b64 exec, 1
  buffer_store_dword v136, v15, s[8:11], 0 offen sc1
  s_mov_b64 exec, -1
  s_endpgm
scs_ha:
  s_waitcnt lgkmcnt(0)
  ds_read_b128 v[56:59], v2 offset:0
  ds_read_b128 v[60:63], v2 offset:4096
  ds_read_b128 v[64:67], v2 offset:8192
  ds_read_b128 v[68:71], v2 offset:12288
  ds_read_b128 v[72:75], v2 offset:16384
  ds_read_b128 v[76:79], v2 offset:20480
  ds_read_b128 v[80:83], v2 offset:49152
  ds_read_b128 v[84:87], v2 offset:53248
  v_mov_b32 v88, 0
  v_mov_b32 v89, 0
  v_mov_b32 v90, 0
  v_mov_b32 v91, 0
  v_mov_b32 v92, 0
  v_mov_b32 v93, 0
  v_mov_b32 v94, 0
  v_mov_b32 v95, 0
  v_mov_b32 v96, 0
  v_mov_b32 v97, 0
  v_mov_b32 v98, 0
  v_mov_b32 v99, 0
  v_mov_b32 v100, 0
  v_mov_b32 v101, 0
  v_mov_b32 v102, 0
  v_mov_b32 v103, 0
  v_mov_b32 v104, 0
  v_mov_b32 v105, 0
  v_mov_b32 v106, 0
  v_mov_b32 v107, 0
  v_mov_b32 v108, 0
  v_mov_b32 v109, 0
  v_mov_b32 v110, 0
  v_mov_b32 v111, 0
scs_ra:
  buffer_load_dwordx4 v[16:19], v12, s[8:11], 0 offen offset:0 sc1
  buffer_load_dwordx4 v[20:23], v12, s[8:11], 0 offen offset:1024 sc1
  buffer_load_dwordx4 v[24:27], v12, s[8:11], 0 offen offset:2048 sc1
  s_add_u32 s50, s50, 1
  s_cmp_gt_u32 s50, 131072
  s_cbranch_scc1 L_fail
  s_waitcnt vmcnt(0) lgkmcnt(0)
  v_max3_u32 v136, v16, v20, v24
  v_cmp_eq_u32 vcc, -1, v136
  s_cbranch_vccnz scs_ra
  s_branch scs_go
scs_hb:
  s_waitcnt lgkmcnt(0)
  s_add_u32 s50, s50, 1
  s_cmp_gt_u32 s50, 131072
  s_cbranch_scc1 L_fail
  ds_read_b128 v[56:59], v2 offset:0
  ds_read_b128 v[60:63], v2 offset:4096
  ds_read_b128 v[64:67], v2 offset:8192
  ds_read_b128 v[68:71], v2 offset:12288
  ds_read_b128 v[72:75], v2 offset:16384
  ds_read_b128 v[76:79], v2 offset:20480
  ds_read_b128 v[80:83], v2 offset:49152
  ds_read_b128 v[84:87], v2 offset:53248
  v_mov_b32 v88, 0
  v_mov_b32 v89, 0
  v_mov_b32 v90, 0
  v_mov_b32 v91, 0
  v_mov_b32 v92, 0
  v_mov_b32 v93, 0
  v_mov_b32 v94, 0
  v_mov_b32 v95, 0
  v_mov_b32 v96, 0
  v_mov_b32 v97, 0
  v_mov_b32 v98, 0
  v_mov_b32 v99, 0
  v_mov_b32 v100, 0
  v_mov_b32 v101, 0
  v_mov_b32 v102, 0
  v_mov_b32 v103, 0
  v_mov_b32 v104, 0
  v_mov_b32 v105, 0
  v_mov_b32 v106, 0
  v_mov_b32 v107, 0
  v_mov_b32 v108, 0
  v_mov_b32 v109, 0
  v_mov_b32 v110, 0
  v_mov_b32 v111, 0
  s_waitcnt lgkmcnt(0)
  s_branch scs_top
scs_redo:
  s_waitcnt lgkmcnt(0)
  s_mov_b32 s50, 0
scs_poll:
  buffer_load_dwordx4 v[16:19], v12, s[8:11], 0 offen offset:0 sc1
  buffer_load_dwordx4 v[20:23], v12, s[8:11], 0 offen offset:1024 sc1
  buffer_load_dwordx4 v[24:27], v12, s[8:11], 0 offen offset:2048 sc1
  buffer_load_dwordx4 v[28:31], v12, s[8:11], 0 offen offset:3072 sc1
  buffer_load_dwordx4 v[32:35], v12, s[8:11], s24 offen offset:0 sc1
  buffer_load_dwordx4 v[36:39], v12, s[8:11], s24 offen offset:1024 sc1
  buffer_load_dwordx4 v[40:43], v12, s[8:11], s24 offen offset:2048 sc1
  buffer_load_dwordx4 v[44:47], v12, s[8:11], s24 offen offset:3072 sc1
  buffer_load_dwordx4 v[48:51], v12, s[8:11], s25 offen offset:0 sc1
  buffer_load_dwordx4 v[52:55], v12, s[8:11], s25 offen offset:1024 sc1
  s_add_u32 s50, s50, 1
  s_cmp_gt_u32 s50, 131072
  s_cbranch_scc1 L_fail
  s_waitcnt vmcnt(0) lgkmcnt(0)
  v_max_u32 v136, v16, v17
  v_max3_u32 v136, v18, v19, v136
  v_max3_u32 v136, v20, v21, v136
  v_max3_u32 v136, v22, v23, v136
  v_max3_u32 v136, v24, v25, v136
  v_max3_u32 v136, v26, v27, v136
  v_max3_u32 v136, v28, v29, v136
  v_max3_u32 v136, v30, v31, v136
  v_max3_u32 v136, v32, v33, v136
  v_max3_u32 v136, v34, v35, v136
  v_max3_u32 v136, v36, v37, v136
  v_max3_u32 v136, v38, v39, v136
  v_max3_u32 v136, v40, v41, v136
  v_max3_u32 v136, v42, v43, v136
  v_max3_u32 v136, v44, v45, v136
  v_max3_u32 v136, v46, v47, v136
  v_max3_u32 v136, v48, v49, v136
  v_max3_u32 v136, v50, v51, v136
  v_max3_u32 v136, v52, v53, v136
  v_max3_u32 v136, v54, v55, v136
  v_cmp_eq_u32 vcc, -1, v136
  s_cbranch_vccnz scs_poll
  s_mov_b64 s[16:17], 0
  ds_read_b128 v[56:59], v2 offset:0
  ds_read_b128 v[60:63], v2 offset:4096
  ds_read_b128 v[64:67], v2 offset:8192
  ds_read_b128 v[68:71], v2 offset:12288
  ds_read_b128 v[72:75], v2 offset:16384
  ds_read_b128 v[76:79], v2 offset:20480
  ds_read_b128 v[80:83], v2 offset:49152
  ds_read_b128 v[84:87], v2 offset:53248
  v_mov_b32 v88, 0
  v_mov_b32 v89, 0
  v_mov_b32 v90, 0
  v_mov_b32 v91, 0
  v_mov_b32 v92, 0
  v_mov_b32 v93, 0
  v_mov_b32 v94, 0
  v_mov_b32 v95, 0
  v_mov_b32 v96, 0
  v_mov_b32 v97, 0
  v_mov_b32 v98, 0
  v_mov_b32 v99, 0
  v_mov_b32 v100, 0
  v_mov_b32 v101, 0
  v_mov_b32 v102, 0
  v_mov_b32 v103, 0
  v_mov_b32 v104, 0
  v_mov_b32 v105, 0
  v_mov_b32 v106, 0
  v_mov_b32 v107, 0
  v_mov_b32 v108, 0
  v_mov_b32 v109, 0
  v_mov_b32 v110, 0
  v_mov_b32 v111, 0
  s_waitcnt lgkmcnt(0)
  v_smfmac_f32_16x16x64_bf16 v[88:91], v[16:19], a[192:199], v7
  v_smfmac_f32_16x16x64_bf16 v[92:95], v[16:19], a[200:207], v7
  v_smfmac_f32_16x16x64_bf16 v[96:99], v[16:19], a[208:215], v7
  v_smfmac_f32_16x16x64_bf16 v[100:103], v[16:19], v[56:63], v7
  v_smfmac_f32_16x16x64_bf16 v[104:107], v[16:19], v[64:71], v7
  ds_read_b128 v[56:59], v2 offset:57344
  v_smfmac_f32_16x16x64_bf16 v[108:111], v[16:19], v[72:79], v7
  ds_read_b128 v[60:63], v2 offset:61440
  v_smfmac_f32_16x16x64_bf16 v[88:91], v[20:23], a[216:223], v7
  ds_read_b128 v[64:67], v3 offset:0
  v_smfmac_f32_16x16x64_bf16 v[92:95], v[20:23], a[224:231], v7
  ds_read_b128 v[68:71], v3 offset:4096
  v_smfmac_f32_16x16x64_bf16 v[96:99], v[20:23], a[232:239], v7
  v_smfmac_f32_16x16x64_bf16 v[100:103], v[20:23], a[0:7], v7
  ds_read_b128 v[72:75], v3 offset:8192
  v_smfmac_f32_16x16x64_bf16 v[104:107], v[20:23], a[8:15], v7
  ds_read_b128 v[76:79], v3 offset:12288
  v_smfmac_f32_16x16x64_bf16 v[108:111], v[20:23], a[16:23], v7
  v_smfmac_f32_16x16x64_bf16 v[88:91], v[24:27], a[240:247], v7
  v_smfmac_f32_16x16x64_bf16 v[92:95], v[24:27], a[248:255], v7
  v_smfmac_f32_16x16x64_bf16 v[96:99], v[24:27], v[152:159], v7
  v_smfmac_f32_16x16x64_bf16 v[100:103], v[24:27], a[24:31], v7
  v_smfmac_f32_16x16x64_bf16 v[104:107], v[24:27], a[32:39], v7
  v_smfmac_f32_16x16x64_bf16 v[108:111], v[24:27], a[40:47], v7
  v_smfmac_f32_16x16x64_bf16 v[88:91], v[28:31], v[80:87], v7
  s_waitcnt lgkmcnt(0)
  v_smfmac_f32_16x16x64_bf16 v[92:95], v[28:31], v[56:63], v7
  v_smfmac_f32_16x16x64_bf16 v[96:99], v[28:31], v[64:71], v7
  v_smfmac_f32_16x16x64_bf16 v[88:91], v[32:35], v[160:167], v7
  ds_read_b128 v[80:83], v3 offset:32768
  ds_read_b128 v[16:19], v13 offset:8192
  v_smfmac_f32_16x16x64_bf16 v[92:95], v[32:35], v[168:175], v7
  ds_read_b128 v[84:87], v3 offset:36864
  ds_read_b128 v[20:23], v13 offset:10240
  v_smfmac_f32_16x16x64_bf16 v[96:99], v[32:35], v[176:183], v7
  ds_read_b128 v[56:59], v3 offset:16384
  ds_read_b128 v[24:27], v13 offset:9216
  v_smfmac_f32_16x16x64_bf16 v[88:91], v[36:39], v[184:191], v7
  v_smfmac_f32_16x16x64_bf16 v[92:95], v[36:39], v[192:199], v7
  ds_read_b128 v[60:63], v3 offset:20480
  v_smfmac_f32_16x16x64_bf16 v[96:99], v[36:39], v[200:207], v7
  ds_read_b128 v[64:67], v3 offset:40960
  v_smfmac_f32_16x16x64_bf16 v[88:91], v[44:47], v[208:215], v7
  ds_read_b128 v[68:71], v3 offset:45056
  v_smfmac_f32_16x16x64_bf16 v[88:91], v[48:51], v[232:239], v7
  v_smfmac_f32_16x16x64_bf16 v[88:91], v[40:43], v[72:79], v7
  s_waitcnt lgkmcnt(3)
  v_smfmac_f32_16x16x64_bf16 v[88:91], v[52:55], v[80:87], v7
  ds_read_b128 v[72:75], v3 offset:24576
  s_waitcnt lgkmcnt(0)
  s_branch scs_join
sch_ha:
  s_waitcnt lgkmcnt(0)
  ds_read_b128 v[56:59], v2 offset:0
  ds_read_b128 v[60:63], v2 offset:4096
  ds_read_b128 v[64:67], v2 offset:8192
  ds_read_b128 v[68:71], v2 offset:12288
  ds_read_b128 v[72:75], v2 offset:16384
  ds_read_b128 v[76:79], v2 offset:20480
  ds_read_b128 v[80:83], v2 offset:49152
  ds_read_b128 v[84:87], v2 offset:53248
  v_mov_b32 v88, 0
  v_mov_b32 v89, 0
  v_mov_b32 v90, 0
  v_mov_b32 v91, 0
  v_mov_b32 v92, 0
  v_mov_b32 v93, 0
  v_mov_b32 v94, 0
  v_mov_b32 v95, 0
  v_mov_b32 v96, 0
  v_mov_b32 v97, 0
  v_mov_b32 v98, 0
  v_mov_b32 v99, 0
  v_mov_b32 v100, 0
  v_mov_b32 v101, 0
  v_mov_b32 v102, 0
  v_mov_b32 v103, 0
  v_mov_b32 v104, 0
  v_mov_b32 v105, 0
  v_mov_b32 v106, 0
  v_mov_b32 v107, 0
  v_mov_b32 v108, 0
  v_mov_b32 v109, 0
  v_mov_b32 v110, 0
  v_mov_b32 v111, 0
sch_ra:
  buffer_load_dwordx4 v[16:19], v12, s[8:11], 0 offen offset:0 sc1
  buffer_load_dwordx4 v[20:23], v12, s[8:11], 0 offen offset:1024 sc1
  buffer_load_dwordx4 v[24:27], v12, s[8:11], 0 offen offset:2048 sc1
  s_add_u32 s50, s50, 1
  s_cmp_gt_u32 s50, 131072
  s_cbranch_scc1 L_fail
  s_waitcnt vmcnt(0) lgkmcnt(0)
  v_max3_u32 v136, v16, v20, v24
  v_cmp_eq_u32 vcc, -1, v136
  s_cbranch_vccnz sch_ra
  s_branch sch_go
sch_hb:
  s_waitcnt lgkmcnt(0)
  s_add_u32 s50, s50, 1
  s_cmp_gt_u32 s50, 131072
  s_cbranch_scc1 L_fail
  ds_read_b128 v[56:59], v2 offset:0
  ds_read_b128 v[60:63], v2 offset:4096
  ds_read_b128 v[64:67], v2 offset:8192
  ds_read_b128 v[68:71], v2 offset:12288
  ds_read_b128 v[72:75], v2 offset:16384
  ds_read_b128 v[76:79], v2 offset:20480
  ds_read_b128 v[80:83], v2 offset:49152
  ds_read_b128 v[84:87], v2 offset:53248
  v_mov_b32 v88, 0
  v_mov_b32 v89, 0
  v_mov_b32 v90, 0
  v_mov_b32 v91, 0
  v_mov_b32 v92, 0
  v_mov_b32 v93, 0
  v_mov_b32 v94, 0
  v_mov_b32 v95, 0
  v_mov_b32 v96, 0
  v_mov_b32 v97, 0
  v_mov_b32 v98, 0
  v_mov_b32 v99, 0
  v_mov_b32 v100, 0
  v_mov_b32 v101, 0
  v_mov_b32 v102, 0
  v_mov_b32 v103, 0
  v_mov_b32 v104, 0
  v_mov_b32 v105, 0
  v_mov_b32 v106, 0
  v_mov_b32 v107, 0
  v_mov_b32 v108, 0
  v_mov_b32 v109, 0
  v_mov_b32 v110, 0
  v_mov_b32 v111, 0
  s_waitcnt lgkmcnt(0)
  s_branch sch_top
sch_redo:
  s_waitcnt lgkmcnt(0)
  s_mov_b32 s50, 0
sch_poll:
  buffer_load_dwordx4 v[16:19], v12, s[8:11], 0 offen offset:0 sc1
  buffer_load_dwordx4 v[20:23], v12, s[8:11], 0 offen offset:1024 sc1
  buffer_load_dwordx4 v[24:27], v12, s[8:11], 0 offen offset:2048 sc1
  buffer_load_dwordx4 v[28:31], v12, s[8:11], 0 offen offset:3072 sc1
  buffer_load_dwordx4 v[32:35], v12, s[8:11], s24 offen offset:0 sc1
  buffer_load_dwordx4 v[36:39], v12, s[8:11], s24 offen offset:1024 sc1
  buffer_load_dwordx4 v[40:43], v12, s[8:11], s24 offen offset:2048 sc1
  buffer_load_dwordx4 v[44:47], v12, s[8:11], s24 offen offset:3072 sc1
  buffer_load_dwordx4 v[48:51], v12, s[8:11], s25 offen offset:0 sc1
  buffer_load_dwordx4 v[52:55], v12, s[8:11], s25 offen offset:1024 sc1
  s_add_u32 s50, s50, 1
  s_cmp_gt_u32 s50, 131072
  s_cbranch_scc1 L_fail
  s_waitcnt vmcnt(0) lgkmcnt(0)
  v_max_u32 v136, v16, v17
  v_max3_u32 v136, v18, v19, v136
  v_max3_u32 v136, v20, v21, v136
  v_max3_u32 v136, v22, v23, v136
  v_max3_u32 v136, v24, v25, v136
  v_max3_u32 v136, v26, v27, v136
  v_max3_u32 v136, v28, v29, v136
  v_max3_u32 v136, v30, v31, v136
  v_max3_u32 v136, v32, v33, v136
  v_max3_u32 v136, v34, v35, v136
  v_max3_u32 v136, v36, v37, v136
  v_max3_u32 v136, v38, v39, v136
  v_max3_u32 v136, v40, v41, v136
  v_max3_u32 v136, v42, v43, v136
  v_max3_u32 v136, v44, v45, v136
  v_max3_u32 v136, v46, v47, v136
  v_max3_u32 v136, v48, v49, v136
  v_max3_u32 v136, v50, v51, v136
  v_max3_u32 v136, v52, v53, v136
  v_max3_u32 v136, v54, v55, v136
  v_cmp_eq_u32 vcc, -1, v136
  s_cbranch_vccnz sch_poll
  s_mov_b64 s[16:17], 0
  ds_read_b128 v[56:59], v2 offset:0
  ds_read_b128 v[60:63], v2 offset:4096
  ds_read_b128 v[64:67], v2 offset:8192
  ds_read_b128 v[68:71], v2 offset:12288
  ds_read_b128 v[72:75], v2 offset:16384
  ds_read_b128 v[76:79], v2 offset:20480
  ds_read_b128 v[80:83], v2 offset:49152
  ds_read_b128 v[84:87], v2 offset:53248
  v_mov_b32 v88, 0
  v_mov_b32 v89, 0
  v_mov_b32 v90, 0
  v_mov_b32 v91, 0
  v_mov_b32 v92, 0
  v_mov_b32 v93, 0
  v_mov_b32 v94, 0
  v_mov_b32 v95, 0
  v_mov_b32 v96, 0
  v_mov_b32 v97, 0
  v_mov_b32 v98, 0
  v_mov_b32 v99, 0
  v_mov_b32 v100, 0
  v_mov_b32 v101, 0
  v_mov_b32 v102, 0
  v_mov_b32 v103, 0
  v_mov_b32 v104, 0
  v_mov_b32 v105, 0
  v_mov_b32 v106, 0
  v_mov_b32 v107, 0
  v_mov_b32 v108, 0
  v_mov_b32 v109, 0
  v_mov_b32 v110, 0
  v_mov_b32 v111, 0
  s_waitcnt lgkmcnt(0)
  v_smfmac_f32_16x16x64_bf16 v[88:91], v[16:19], a[192:199], v7
  v_smfmac_f32_16x16x64_bf16 v[92:95], v[16:19], a[200:207], v7
  v_smfmac_f32_16x16x64_bf16 v[96:99], v[16:19], a[208:215], v7
  v_smfmac_f32_16x16x64_bf16 v[100:103], v[16:19], v[56:63], v7
  v_smfmac_f32_16x16x64_bf16 v[104:107], v[16:19], v[64:71], v7
  ds_read_b128 v[56:59], v2 offset:57344
  v_smfmac_f32_16x16x64_bf16 v[108:111], v[16:19], v[72:79], v7
  ds_read_b128 v[60:63], v2 offset:61440
  v_smfmac_f32_16x16x64_bf16 v[88:91], v[20:23], a[216:223], v7
  ds_read_b128 v[64:67], v3 offset:0
  v_smfmac_f32_16x16x64_bf16 v[92:95], v[20:23], a[224:231], v7
  ds_read_b128 v[68:71], v3 offset:4096
  v_smfmac_f32_16x16x64_bf16 v[96:99], v[20:23], a[232:239], v7
  v_smfmac_f32_16x16x64_bf16 v[100:103], v[20:23], a[0:7], v7
  ds_read_b128 v[72:75], v3 offset:8192
  v_smfmac_f32_16x16x64_bf16 v[104:107], v[20:23], a[8:15], v7
  ds_read_b128 v[76:79], v3 offset:12288
  v_smfmac_f32_16x16x64_bf16 v[108:111], v[20:23], a[16:23], v7
  v_smfmac_f32_16x16x64_bf16 v[88:91], v[24:27], a[240:247], v7
  v_smfmac_f32_16x16x64_bf16 v[92:95], v[24:27], a[248:255], v7
  v_smfmac_f32_16x16x64_bf16 v[96:99], v[24:27], v[152:159], v7
  v_smfmac_f32_16x16x64_bf16 v[100:103], v[24:27], a[24:31], v7
  v_smfmac_f32_16x16x64_bf16 v[104:107], v[24:27], a[32:39], v7
  v_smfmac_f32_16x16x64_bf16 v[108:111], v[24:27], a[40:47], v7
  v_smfmac_f32_16x16x64_bf16 v[88:91], v[28:31], v[80:87], v7
  s_waitcnt lgkmcnt(0)
  v_smfmac_f32_16x16x64_bf16 v[92:95], v[28:31], v[56:63], v7
  v_smfmac_f32_16x16x64_bf16 v[96:99], v[28:31], v[64:71], v7
  v_smfmac_f32_16x16x64_bf16 v[88:91], v[32:35], v[160:167], v7
  ds_read_b128 v[80:83], v3 offset:32768
  v_smfmac_f32_16x16x64_bf16 v[92:95], v[32:35], v[168:175], v7
  ds_read_b128 v[84:87], v3 offset:36864
  v_smfmac_f32_16x16x64_bf16 v[96:99], v[32:35], v[176:183], v7
  ds_read_b128 v[56:59], v3 offset:16384
  v_smfmac_f32_16x16x64_bf16 v[88:91], v[36:39], v[184:191], v7
  v_smfmac_f32_16x16x64_bf16 v[92:95], v[36:39], v[192:199], v7
  ds_read_b128 v[60:63], v3 offset:20480
  v_smfmac_f32_16x16x64_bf16 v[96:99], v[36:39], v[200:207], v7
  ds_read_b128 v[64:67], v3 offset:40960
  v_smfmac_f32_16x16x64_bf16 v[88:91], v[44:47], v[208:215], v7
  ds_read_b128 v[68:71], v3 offset:45056
  v_smfmac_f32_16x16x64_bf16 v[88:91], v[48:51], v[232:239], v7
  v_smfmac_f32_16x16x64_bf16 v[88:91], v[40:43], v[72:79], v7
  s_waitcnt lgkmcnt(3)
  v_smfmac_f32_16x16x64_bf16 v[88:91], v[52:55], v[80:87], v7
  ds_read_b128 v[72:75], v3 offset:24576
  s_mov_b32 m0, s21
  s_waitcnt lgkmcnt(0)
  s_branch sch_join
L_value:
  s_mov_b32 s4, s30
  s_mov_b32 s5, s31
  s_mov_b32 s6, 7864320
  s_mov_b32 s7, 0x20000
  s_mov_b32 s12, s32
  s_mov_b32 s13, s33
  s_mov_b32 s14, 7864320
  s_mov_b32 s15, 0x20000
  v_lshrrev_b32 v148, 3, v0
  v_lshrrev_b32 v149, 2, v148
  v_lshlrev_b32 v149, 3, v149
  v_and_b32 v64, 3, v148
  v_add_u32 v64, v64, v149
  s_and_b32 s46, s42, 1
  s_lshl_b32 s46, s46, 2
  s_lshr_b32 s47, s42, 1
  s_lshl_b32 s47, s47, 4
  s_add_u32 s46, s46, s47
  v_add_u32 v64, s46, v64
  v_mul_u32_u24 v64, 12288, v64
  v_lshrrev_b32 v148, 1, v148
  v_bfe_u32 v149, v0, 1, 2
  v_xor_b32 v148, v148, v149
  v_lshlrev_b32 v148, 5, v148
  v_and_b32 v149, 1, v0
  v_lshlrev_b32 v149, 4, v149
  v_add3_u32 v64, v64, v148, v149
  v_lshrrev_b32 v148, 3, v0
  v_lshrrev_b32 v149, 2, v148
  v_lshlrev_b32 v149, 3, v149
  v_and_b32 v65, 3, v148
  v_add_u32 v65, v65, v149
  s_and_b32 s46, s42, 1
  s_lshl_b32 s46, s46, 2
  s_lshr_b32 s47, s42, 1
  s_lshl_b32 s47, s47, 4
  s_add_u32 s46, s46, s47
  v_add_u32 v65, s46, v65
  v_mul_u32_u24 v65, 1280, v65
  v_lshrrev_b32 v148, 1, v148
  v_bfe_u32 v149, v0, 1, 2
  v_xor_b32 v148, v148, v149
  v_lshlrev_b32 v148, 5, v148
  v_and_b32 v149, 1, v0
  v_lshlrev_b32 v149, 4, v149
  v_add3_u32 v65, v65, v148, v149
  v_lshrrev_b32 v148, 5, v0
  v_lshlrev_b32 v66, 11, v148
  v_bfe_u32 v148, v0, 2, 3
  v_lshl_add_u32 v66, v148, 7, v66
  v_lshrrev_b32 v148, 1, v148
  v_xor_b32 v148, s42, v148
  v_lshl_add_u32 v66, v148, 5, v66
  v_and_b32 v148, 3, v0
  v_lshl_add_u32 v66, v148, 3, v66
  v_add_u32 v67, 0x10000, v66
  v_add_u32 v68, 0x20000, v66
  v_lshlrev_b32 v1, 4, v0
  v_add_u32 v2, s51, v1
  v_add_u32 v3, 0x10000, v2
  s_mul_i32 s62, s45, 384
  s_mul_i32 s63, s45, 245760
  s_mov_b32 s24, 4096
  s_mov_b32 s25, 49152
  s_add_u32 m0, s51, 73728
  s_add_u32 s46, s62, 786432
  buffer_load_dwordx4 v64, s[4:7], s46 offen  lds
  s_add_u32 m0, s51, 77824
  s_add_u32 s46, s62, 1179648
  buffer_load_dwordx4 v64, s[4:7], s46 offen  lds
  s_add_u32 m0, s51, 81920
  s_add_u32 s46, s62, 786560
  buffer_load_dwordx4 v64, s[4:7], s46 offen  lds
  s_add_u32 m0, s51, 86016
  s_add_u32 s46, s62, 1179776
  buffer_load_dwordx4 v64, s[4:7], s46 offen  lds
  s_add_u32 m0, s51, 90112
  s_add_u32 s46, s62, 786688
  buffer_load_dwordx4 v64, s[4:7], s46 offen  lds
  s_add_u32 m0, s51, 94208
  s_add_u32 s46, s62, 1179904
  buffer_load_dwordx4 v64, s[4:7], s46 offen  lds
  s_add_u32 m0, s51, 98304
  s_add_u32 s46, s62, 1572864
  buffer_load_dwordx4 v64, s[4:7], s46 offen  lds
  s_add_u32 m0, s51, 102400
  s_add_u32 s46, s62, 1966080
  buffer_load_dwordx4 v64, s[4:7], s46 offen  lds
  s_add_u32 m0, s51, 106496
  s_add_u32 s46, s62, 1572992
  buffer_load_dwordx4 v64, s[4:7], s46 offen  lds
  s_add_u32 m0, s51, 110592
  s_add_u32 s46, s62, 1966208
  buffer_load_dwordx4 v64, s[4:7], s46 offen  lds
  s_add_u32 m0, s51, 114688
  s_add_u32 s46, s62, 1573120
  buffer_load_dwordx4 v64, s[4:7], s46 offen  lds
  s_add_u32 m0, s51, 118784
  s_add_u32 s46, s62, 1966336
  buffer_load_dwordx4 v64, s[4:7], s46 offen  lds
  s_add_u32 m0, s51, 122880
  s_add_u32 s46, s62, 2359296
  buffer_load_dwordx4 v64, s[4:7], s46 offen  lds
  s_add_u32 m0, s51, 126976
  s_add_u32 s46, s62, 2752512
  buffer_load_dwordx4 v64, s[4:7], s46 offen  lds
  s_add_u32 m0, s51, 131072
  s_add_u32 s46, s62, 2359424
  buffer_load_dwordx4 v64, s[4:7], s46 offen  lds
  s_add_u32 m0, s51, 135168
  s_add_u32 s46, s62, 2752640
  buffer_load_dwordx4 v64, s[4:7], s46 offen  lds
  s_add_u32 m0, s51, 139264
  s_add_u32 s46, s62, 2359552
  buffer_load_dwordx4 v64, s[4:7], s46 offen  lds
  s_add_u32 m0, s51, 143360
  s_add_u32 s46, s62, 2752768
  buffer_load_dwordx4 v64, s[4:7], s46 offen  lds
  s_add_u32 m0, s51, 0
  s_add_u32 s46, s62, 3932160
  buffer_load_dwordx4 v64, s[4:7], s46 offen  lds
  s_add_u32 m0, s51, 4096
  s_add_u32 s46, s62, 4325376
  buffer_load_dwordx4 v64, s[4:7], s46 offen  lds
  s_add_u32 m0, s51, 8192
  s_add_u32 s46, s62, 3932288
  buffer_load_dwordx4 v64, s[4:7], s46 offen  lds
  s_add_u32 m0, s51, 12288
  s_add_u32 s46, s62, 4325504
  buffer_load_dwordx4 v64, s[4:7], s46 offen  lds
  s_add_u32 m0, s51, 16384
  s_add_u32 s46, s62, 3932416
  buffer_load_dwordx4 v64, s[4:7], s46 offen  lds
  s_add_u32 m0, s51, 20480
  s_add_u32 s46, s62, 4325632
  buffer_load_dwordx4 v64, s[4:7], s46 offen  lds
  s_add_u32 m0, s51, 24576
  s_add_u32 s46, s62, 4718592
  buffer_load_dwordx4 v64, s[4:7], s46 offen  lds
  s_add_u32 m0, s51, 28672
  s_add_u32 s46, s62, 5111808
  buffer_load_dwordx4 v64, s[4:7], s46 offen  lds
  s_add_u32 m0, s51, 32768
  s_add_u32 s46, s62, 4718720
  buffer_load_dwordx4 v64, s[4:7], s46 offen  lds
  s_add_u32 m0, s51, 36864
  s_add_u32 s46, s62, 5111936
  buffer_load_dwordx4 v64, s[4:7], s46 offen  lds
  s_add_u32 m0, s51, 40960
  s_add_u32 s46, s62, 4718848
  buffer_load_dwordx4 v64, s[4:7], s46 offen  lds
  s_add_u32 m0, s51, 45056
  s_add_u32 s46, s62, 5112064
  buffer_load_dwordx4 v64, s[4:7], s46 offen  lds
  s_waitcnt vmcnt(24)
  s_barrier
  s_add_u32 m0, s51, 49152
  s_add_u32 s46, s62, 5505024
  buffer_load_dwordx4 v64, s[4:7], s46 offen  lds
  s_add_u32 m0, s51, 53248
  s_add_u32 s46, s62, 5898240
  buffer_load_dwordx4 v64, s[4:7], s46 offen  lds
  s_add_u32 m0, s51, 57344
  s_add_u32 s46, s62, 5505152
  buffer_load_dwordx4 v64, s[4:7], s46 offen  lds
  s_add_u32 m0, s51, 61440
  s_add_u32 s46, s62, 5898368
  buffer_load_dwordx4 v64, s[4:7], s46 offen  lds
  s_add_u32 m0, s51, 65536
  s_add_u32 s46, s62, 5505280
  buffer_load_dwordx4 v64, s[4:7], s46 offen  lds
  s_add_u32 m0, s51, 69632
  s_add_u32 s46, s62, 5898496
  buffer_load_dwordx4 v64, s[4:7], s46 offen  lds
  ds_read_b64_tr_b16 a[0:1], v67 offset:8192
  ds_read_b64_tr_b16 a[2:3], v67 offset:9216
  ds_read_b64_tr_b16 a[4:5], v67 offset:12288
  ds_read_b64_tr_b16 a[6:7], v67 offset:13312
  ds_read_b64_tr_b16 a[8:9], v67 offset:16384
  ds_read_b64_tr_b16 a[10:11], v67 offset:17408
  ds_read_b64_tr_b16 a[12:13], v67 offset:20480
  ds_read_b64_tr_b16 a[14:15], v67 offset:21504
  ds_read_b64_tr_b16 a[16:17], v67 offset:24576
  ds_read_b64_tr_b16 a[18:19], v67 offset:25600
  ds_read_b64_tr_b16 a[20:21], v67 offset:28672
  ds_read_b64_tr_b16 a[22:23], v67 offset:29696
  s_waitcnt lgkmcnt(0)
  s_waitcnt vmcnt(24)
  s_barrier
  s_add_u32 m0, s51, 73728
  s_add_u32 s46, s62, 7077888
  buffer_load_dwordx4 v64, s[4:7], s46 offen  lds
  s_add_u32 m0, s51, 77824
  s_add_u32 s46, s62, 7471104
  buffer_load_dwordx4 v64, s[4:7], s46 offen  lds
  s_add_u32 m0, s51, 81920
  s_add_u32 s46, s62, 7078016
  buffer_load_dwordx4 v64, s[4:7], s46 offen  lds
  s_add_u32 m0, s51, 86016
  s_add_u32 s46, s62, 7471232
  buffer_load_dwordx4 v64, s[4:7], s46 offen  lds
  s_add_u32 m0, s51, 90112
  s_add_u32 s46, s62, 7078144
  buffer_load_dwordx4 v64, s[4:7], s46 offen  lds
  s_add_u32 m0, s51, 94208
  s_add_u32 s46, s62, 7471360
  buffer_load_dwordx4 v64, s[4:7], s46 offen  lds
  ds_read_b64_tr_b16 a[24:25], v67 offset:32768
  ds_read_b64_tr_b16 a[26:27], v67 offset:33792
  ds_read_b64_tr_b16 a[28:29], v67 offset:36864
  ds_read_b64_tr_b16 a[30:31], v67 offset:37888
  ds_read_b64_tr_b16 a[32:33], v67 offset:40960
  ds_read_b64_tr_b16 a[34:35], v67 offset:41984
  ds_read_b64_tr_b16 a[36:37], v67 offset:45056
  ds_read_b64_tr_b16 a[38:39], v67 offset:46080
  ds_read_b64_tr_b16 a[40:41], v67 offset:49152
  ds_read_b64_tr_b16 a[42:43], v67 offset:50176
  ds_read_b64_tr_b16 a[44:45], v67 offset:53248
  ds_read_b64_tr_b16 a[46:47], v67 offset:54272
  s_waitcnt lgkmcnt(0)
  s_waitcnt vmcnt(24)
  s_barrier
  s_add_u32 m0, s51, 98304
  s_add_u32 s46, s63, 0
  buffer_load_dwordx4 v65, s[12:15], s46 offen  lds
  s_add_u32 m0, s51, 102400
  s_add_u32 s46, s63, 40960
  buffer_load_dwordx4 v65, s[12:15], s46 offen  lds
  s_add_u32 m0, s51, 106496
  s_add_u32 s46, s63, 81920
  buffer_load_dwordx4 v65, s[12:15], s46 offen  lds
  s_add_u32 m0, s51, 110592
  s_add_u32 s46, s63, 122880
  buffer_load_dwordx4 v65, s[12:15], s46 offen  lds
  s_add_u32 m0, s51, 114688
  s_add_u32 s46, s63, 163840
  buffer_load_dwordx4 v65, s[12:15], s46 offen  lds
  s_add_u32 m0, s51, 118784
  s_add_u32 s46, s63, 204800
  buffer_load_dwordx4 v65, s[12:15], s46 offen  lds
  ds_read_b64_tr_b16 a[48:49], v67 offset:57344
  ds_read_b64_tr_b16 a[50:51], v67 offset:58368
  ds_read_b64_tr_b16 a[52:53], v67 offset:61440
  ds_read_b64_tr_b16 a[54:55], v67 offset:62464
  ds_read_b64_tr_b16 a[56:57], v68 offset:0
  ds_read_b64_tr_b16 a[58:59], v68 offset:1024
  ds_read_b64_tr_b16 a[60:61], v68 offset:4096
  ds_read_b64_tr_b16 a[62:63], v68 offset:5120
  ds_read_b64_tr_b16 a[64:65], v68 offset:8192
  ds_read_b64_tr_b16 a[66:67], v68 offset:9216
  ds_read_b64_tr_b16 a[68:69], v68 offset:12288
  ds_read_b64_tr_b16 a[70:71], v68 offset:13312
  s_waitcnt lgkmcnt(0)
  s_waitcnt vmcnt(24)
  s_barrier
  s_add_u32 m0, s51, 122880
  s_add_u32 s46, s63, 128
  buffer_load_dwordx4 v65, s[12:15], s46 offen  lds
  s_add_u32 m0, s51, 126976
  s_add_u32 s46, s63, 41088
  buffer_load_dwordx4 v65, s[12:15], s46 offen  lds
  s_add_u32 m0, s51, 131072
  s_add_u32 s46, s63, 82048
  buffer_load_dwordx4 v65, s[12:15], s46 offen  lds
  s_add_u32 m0, s51, 135168
  s_add_u32 s46, s63, 123008
  buffer_load_dwordx4 v65, s[12:15], s46 offen  lds
  s_add_u32 m0, s51, 139264
  s_add_u32 s46, s63, 163968
  buffer_load_dwordx4 v65, s[12:15], s46 offen  lds
  s_add_u32 m0, s51, 143360
  s_add_u32 s46, s63, 204928
  buffer_load_dwordx4 v65, s[12:15], s46 offen  lds
  ds_read_b64_tr_b16 a[72:73], v66 offset:0
  ds_read_b64_tr_b16 a[74:75], v66 offset:1024
  ds_read_b64_tr_b16 a[76:77], v66 offset:4096
  ds_read_b64_tr_b16 a[78:79], v66 offset:5120
  ds_read_b64_tr_b16 a[80:81], v66 offset:8192
  ds_read_b64_tr_b16 a[82:83], v66 offset:9216
  ds_read_b64_tr_b16 a[84:85], v66 offset:12288
  ds_read_b64_tr_b16 a[86:87], v66 offset:13312
  ds_read_b64_tr_b16 a[88:89], v66 offset:16384
  ds_read_b64_tr_b16 a[90:91], v66 offset:17408
  ds_read_b64_tr_b16 a[92:93], v66 offset:20480
  ds_read_b64_tr_b16 a[94:95], v66 offset:21504
  s_waitcnt lgkmcnt(0)
  s_waitcnt vmcnt(24)
  s_barrier
  s_add_u32 m0, s51, 0
  s_add_u32 s46, s63, 256
  buffer_load_dwordx4 v65, s[12:15], s46 offen  lds
  s_add_u32 m0, s51, 4096
  s_add_u32 s46, s63, 41216
  buffer_load_dwordx4 v65, s[12:15], s46 offen  lds
  s_add_u32 m0, s51, 8192
  s_add_u32 s46, s63, 82176
  buffer_load_dwordx4 v65, s[12:15], s46 offen  lds
  s_add_u32 m0, s51, 12288
  s_add_u32 s46, s63, 123136
  buffer_load_dwordx4 v65, s[12:15], s46 offen  lds
  s_add_u32 m0, s51, 16384
  s_add_u32 s46, s63, 164096
  buffer_load_dwordx4 v65, s[12:15], s46 offen  lds
  s_add_u32 m0, s51, 20480
  s_add_u32 s46, s63, 205056
  buffer_load_dwordx4 v65, s[12:15], s46 offen  lds
  ds_read_b64_tr_b16 a[96:97], v66 offset:24576
  ds_read_b64_tr_b16 a[98:99], v66 offset:25600
  ds_read_b64_tr_b16 a[100:101], v66 offset:28672
  ds_read_b64_tr_b16 a[102:103], v66 offset:29696
  ds_read_b64_tr_b16 a[104:105], v66 offset:32768
  ds_read_b64_tr_b16 a[106:107], v66 offset:33792
  ds_read_b64_tr_b16 a[108:109], v66 offset:36864
  ds_read_b64_tr_b16 a[110:111], v66 offset:37888
  ds_read_b64_tr_b16 a[112:113], v66 offset:40960
  ds_read_b64_tr_b16 a[114:115], v66 offset:41984
  ds_read_b64_tr_b16 a[116:117], v66 offset:45056
  ds_read_b64_tr_b16 a[118:119], v66 offset:46080
  s_waitcnt lgkmcnt(0)
  s_waitcnt vmcnt(24)
  s_barrier
  s_add_u32 m0, s51, 24576
  s_add_u32 s46, s63, 512
  buffer_load_dwordx4 v65, s[12:15], s46 offen  lds
  s_add_u32 m0, s51, 28672
  s_add_u32 s46, s63, 41472
  buffer_load_dwordx4 v65, s[12:15], s46 offen  lds
  s_add_u32 m0, s51, 32768
  s_add_u32 s46, s63, 82432
  buffer_load_dwordx4 v65, s[12:15], s46 offen  lds
  s_add_u32 m0, s51, 36864
  s_add_u32 s46, s63, 123392
  buffer_load_dwordx4 v65, s[12:15], s46 offen  lds
  s_add_u32 m0, s51, 40960
  s_add_u32 s46, s63, 164352
  buffer_load_dwordx4 v65, s[12:15], s46 offen  lds
  s_add_u32 m0, s51, 45056
  s_add_u32 s46, s63, 205312
  buffer_load_dwordx4 v65, s[12:15], s46 offen  lds
  ds_read_b64_tr_b16 a[120:121], v66 offset:49152
  ds_read_b64_tr_b16 a[122:123], v66 offset:50176
  ds_read_b64_tr_b16 a[124:125], v66 offset:53248
  ds_read_b64_tr_b16 a[126:127], v66 offset:54272
  ds_read_b64_tr_b16 a[128:129], v66 offset:57344
  ds_read_b64_tr_b16 a[130:131], v66 offset:58368
  ds_read_b64_tr_b16 a[132:133], v66 offset:61440
  ds_read_b64_tr_b16 a[134:135], v66 offset:62464
  ds_read_b64_tr_b16 a[136:137], v67 offset:0
  ds_read_b64_tr_b16 a[138:139], v67 offset:1024
  ds_read_b64_tr_b16 a[140:141], v67 offset:4096
  ds_read_b64_tr_b16 a[142:143], v67 offset:5120
  s_waitcnt lgkmcnt(0)
  s_waitcnt vmcnt(24)
  s_barrier
  s_add_u32 m0, s51, 49152
  s_add_u32 s46, s63, 640
  buffer_load_dwordx4 v65, s[12:15], s46 offen  lds
  s_add_u32 m0, s51, 53248
  s_add_u32 s46, s63, 41600
  buffer_load_dwordx4 v65, s[12:15], s46 offen  lds
  s_add_u32 m0, s51, 57344
  s_add_u32 s46, s63, 82560
  buffer_load_dwordx4 v65, s[12:15], s46 offen  lds
  s_add_u32 m0, s51, 61440
  s_add_u32 s46, s63, 123520
  buffer_load_dwordx4 v65, s[12:15], s46 offen  lds
  s_add_u32 m0, s51, 65536
  s_add_u32 s46, s63, 164480
  buffer_load_dwordx4 v65, s[12:15], s46 offen  lds
  s_add_u32 m0, s51, 69632
  s_add_u32 s46, s63, 205440
  buffer_load_dwordx4 v65, s[12:15], s46 offen  lds
  ds_read_b64_tr_b16 a[144:145], v67 offset:8192
  ds_read_b64_tr_b16 a[146:147], v67 offset:9216
  ds_read_b64_tr_b16 a[148:149], v67 offset:12288
  ds_read_b64_tr_b16 a[150:151], v67 offset:13312
  ds_read_b64_tr_b16 a[152:153], v67 offset:16384
  ds_read_b64_tr_b16 a[154:155], v67 offset:17408
  ds_read_b64_tr_b16 a[156:157], v67 offset:20480
  ds_read_b64_tr_b16 a[158:159], v67 offset:21504
  ds_read_b64_tr_b16 a[160:161], v67 offset:24576
  ds_read_b64_tr_b16 a[162:163], v67 offset:25600
  ds_read_b64_tr_b16 a[164:165], v67 offset:28672
  ds_read_b64_tr_b16 a[166:167], v67 offset:29696
  s_waitcnt lgkmcnt(0)
  s_waitcnt vmcnt(24)
  s_barrier
  s_add_u32 m0, s51, 73728
  s_add_u32 s46, s63, 768
  buffer_load_dwordx4 v65, s[12:15], s46 offen  lds
  s_add_u32 m0, s51, 77824
  s_add_u32 s46, s63, 41728
  buffer_load_dwordx4 v65, s[12:15], s46 offen  lds
  s_add_u32 m0, s51, 81920
  s_add_u32 s46, s63, 82688
  buffer_load_dwordx4 v65, s[12:15], s46 offen  lds
  s_add_u32 m0, s51, 86016
  s_add_u32 s46, s63, 123648
  buffer_load_dwordx4 v65, s[12:15], s46 offen  lds
  s_add_u32 m0, s51, 90112
  s_add_u32 s46, s63, 164608
  buffer_load_dwordx4 v65, s[12:15], s46 offen  lds
  s_add_u32 m0, s51, 94208
  s_add_u32 s46, s63, 205568
  buffer_load_dwordx4 v65, s[12:15], s46 offen  lds
  ds_read_b64_tr_b16 a[168:169], v67 offset:32768
  ds_read_b64_tr_b16 a[170:171], v67 offset:33792
  ds_read_b64_tr_b16 a[172:173], v67 offset:36864
  ds_read_b64_tr_b16 a[174:175], v67 offset:37888
  ds_read_b64_tr_b16 a[176:177], v67 offset:40960
  ds_read_b64_tr_b16 a[178:179], v67 offset:41984
  ds_read_b64_tr_b16 a[180:181], v67 offset:45056
  ds_read_b64_tr_b16 a[182:183], v67 offset:46080
  ds_read_b64_tr_b16 a[184:185], v67 offset:49152
  ds_read_b64_tr_b16 a[186:187], v67 offset:50176
  ds_read_b64_tr_b16 a[188:189], v67 offset:53248
  ds_read_b64_tr_b16 a[190:191], v67 offset:54272
  s_waitcnt lgkmcnt(0)
  s_waitcnt vmcnt(24)
  s_barrier
  s_add_u32 m0, s51, 98304
  s_add_u32 s46, s63, 896
  buffer_load_dwordx4 v65, s[12:15], s46 offen  lds
  s_add_u32 m0, s51, 102400
  s_add_u32 s46, s63, 41856
  buffer_load_dwordx4 v65, s[12:15], s46 offen  lds
  s_add_u32 m0, s51, 106496
  s_add_u32 s46, s63, 82816
  buffer_load_dwordx4 v65, s[12:15], s46 offen  lds
  s_add_u32 m0, s51, 110592
  s_add_u32 s46, s63, 123776
  buffer_load_dwordx4 v65, s[12:15], s46 offen  lds
  s_add_u32 m0, s51, 114688
  s_add_u32 s46, s63, 164736
  buffer_load_dwordx4 v65, s[12:15], s46 offen  lds
  s_add_u32 m0, s51, 118784
  s_add_u32 s46, s63, 205696
  buffer_load_dwordx4 v65, s[12:15], s46 offen  lds
  ds_read_b64_tr_b16 a[192:193], v67 offset:57344
  ds_read_b64_tr_b16 a[194:195], v67 offset:58368
  ds_read_b64_tr_b16 a[196:197], v67 offset:61440
  ds_read_b64_tr_b16 a[198:199], v67 offset:62464
  ds_read_b64_tr_b16 a[200:201], v68 offset:0
  ds_read_b64_tr_b16 a[202:203], v68 offset:1024
  ds_read_b64_tr_b16 a[204:205], v68 offset:4096
  ds_read_b64_tr_b16 a[206:207], v68 offset:5120
  ds_read_b64_tr_b16 a[208:209], v68 offset:8192
  ds_read_b64_tr_b16 a[210:211], v68 offset:9216
  ds_read_b64_tr_b16 a[212:213], v68 offset:12288
  ds_read_b64_tr_b16 a[214:215], v68 offset:13312
  s_waitcnt lgkmcnt(0)
  s_waitcnt vmcnt(24)
  s_barrier
  v_and_b32 v149, 3, v0
  v_lshlrev_b32 v149, 2, v149
  global_load_dword v148, v149, s[38:39] sc1
  s_add_u32 m0, s51, 122880
  s_add_u32 s46, s63, 1152
  buffer_load_dwordx4 v65, s[12:15], s46 offen  lds
  s_add_u32 m0, s51, 126976
  s_add_u32 s46, s63, 42112
  buffer_load_dwordx4 v65, s[12:15], s46 offen  lds
  s_add_u32 m0, s51, 131072
  s_add_u32 s46, s63, 83072
  buffer_load_dwordx4 v65, s[12:15], s46 offen  lds
  s_add_u32 m0, s51, 135168
  s_add_u32 s46, s63, 124032
  buffer_load_dwordx4 v65, s[12:15], s46 offen  lds
  s_add_u32 m0, s51, 139264
  s_add_u32 s46, s63, 164992
  buffer_load_dwordx4 v65, s[12:15], s46 offen  lds
  s_add_u32 m0, s51, 143360
  s_add_u32 s46, s63, 205952
  buffer_load_dwordx4 v65, s[12:15], s46 offen  lds
  ds_read_b64_tr_b16 a[216:217], v66 offset:0
  ds_read_b64_tr_b16 a[218:219], v66 offset:1024
  ds_read_b64_tr_b16 a[220:221], v66 offset:4096
  ds_read_b64_tr_b16 a[222:223], v66 offset:5120
  ds_read_b64_tr_b16 a[224:225], v66 offset:8192
  ds_read_b64_tr_b16 a[226:227], v66 offset:9216
  ds_read_b64_tr_b16 a[228:229], v66 offset:12288
  ds_read_b64_tr_b16 a[230:231], v66 offset:13312
  ds_read_b64_tr_b16 a[232:233], v66 offset:16384
  ds_read_b64_tr_b16 a[234:235], v66 offset:17408
  ds_read_b64_tr_b16 a[236:237], v66 offset:20480
  ds_read_b64_tr_b16 a[238:239], v66 offset:21504
  s_waitcnt lgkmcnt(0)
  s_waitcnt vmcnt(25)
  s_barrier
  s_add_u32 m0, s51, 0
  s_add_u32 s46, s62, 0
  buffer_load_dwordx4 v64, s[4:7], s46 offen  lds
  s_add_u32 m0, s51, 4096
  s_add_u32 s46, s62, 393216
  buffer_load_dwordx4 v64, s[4:7], s46 offen  lds
  s_add_u32 m0, s51, 8192
  s_add_u32 s46, s62, 128
  buffer_load_dwordx4 v64, s[4:7], s46 offen  lds
  s_add_u32 m0, s51, 12288
  s_add_u32 s46, s62, 393344
  buffer_load_dwordx4 v64, s[4:7], s46 offen  lds
  s_add_u32 m0, s51, 16384
  s_add_u32 s46, s62, 256
  buffer_load_dwordx4 v64, s[4:7], s46 offen  lds
  s_add_u32 m0, s51, 20480
  s_add_u32 s46, s62, 393472
  buffer_load_dwordx4 v64, s[4:7], s46 offen  lds
  ds_read_b64_tr_b16 a[240:241], v66 offset:24576
  ds_read_b64_tr_b16 a[242:243], v66 offset:25600
  ds_read_b64_tr_b16 a[244:245], v66 offset:28672
  ds_read_b64_tr_b16 a[246:247], v66 offset:29696
  ds_read_b64_tr_b16 a[248:249], v66 offset:32768
  ds_read_b64_tr_b16 a[250:251], v66 offset:33792
  ds_read_b64_tr_b16 a[252:253], v66 offset:36864
  ds_read_b64_tr_b16 a[254:255], v66 offset:37888
  ds_read_b64_tr_b16 v[152:153], v66 offset:40960
  ds_read_b64_tr_b16 v[154:155], v66 offset:41984
  ds_read_b64_tr_b16 v[156:157], v66 offset:45056
  ds_read_b64_tr_b16 v[158:159], v66 offset:46080
  s_waitcnt lgkmcnt(0)
  s_waitcnt vmcnt(25)
  s_barrier
  s_add_u32 m0, s51, 24576
  s_add_u32 s46, s62, 3145728
  buffer_load_dwordx4 v64, s[4:7], s46 offen  lds
  s_add_u32 m0, s51, 28672
  s_add_u32 s46, s62, 3538944
  buffer_load_dwordx4 v64, s[4:7], s46 offen  lds
  s_add_u32 m0, s51, 32768
  s_add_u32 s46, s62, 3145856
  buffer_load_dwordx4 v64, s[4:7], s46 offen  lds
  s_add_u32 m0, s51, 36864
  s_add_u32 s46, s62, 3539072
  buffer_load_dwordx4 v64, s[4:7], s46 offen  lds
  s_add_u32 m0, s51, 40960
  s_add_u32 s46, s62, 3145984
  buffer_load_dwordx4 v64, s[4:7], s46 offen  lds
  s_add_u32 m0, s51, 45056
  s_add_u32 s46, s62, 3539200
  buffer_load_dwordx4 v64, s[4:7], s46 offen  lds
  ds_read_b64_tr_b16 v[160:161], v66 offset:49152
  ds_read_b64_tr_b16 v[162:163], v66 offset:50176
  ds_read_b64_tr_b16 v[164:165], v66 offset:53248
  ds_read_b64_tr_b16 v[166:167], v66 offset:54272
  ds_read_b64_tr_b16 v[168:169], v66 offset:57344
  ds_read_b64_tr_b16 v[170:171], v66 offset:58368
  ds_read_b64_tr_b16 v[172:173], v66 offset:61440
  ds_read_b64_tr_b16 v[174:175], v66 offset:62464
  ds_read_b64_tr_b16 v[176:177], v67 offset:0
  ds_read_b64_tr_b16 v[178:179], v67 offset:1024
  ds_read_b64_tr_b16 v[180:181], v67 offset:4096
  ds_read_b64_tr_b16 v[182:183], v67 offset:5120
  s_waitcnt lgkmcnt(0)
  s_waitcnt vmcnt(25)
  s_barrier
  s_add_u32 m0, s51, 49152
  s_add_u32 s46, s62, 6291456
  buffer_load_dwordx4 v64, s[4:7], s46 offen  lds
  s_add_u32 m0, s51, 53248
  s_add_u32 s46, s62, 6684672
  buffer_load_dwordx4 v64, s[4:7], s46 offen  lds
  s_add_u32 m0, s51, 57344
  s_add_u32 s46, s62, 6291584
  buffer_load_dwordx4 v64, s[4:7], s46 offen  lds
  s_add_u32 m0, s51, 61440
  s_add_u32 s46, s62, 6684800
  buffer_load_dwordx4 v64, s[4:7], s46 offen  lds
  s_add_u32 m0, s51, 65536
  s_add_u32 s46, s62, 6291712
  buffer_load_dwordx4 v64, s[4:7], s46 offen  lds
  s_add_u32 m0, s51, 69632
  s_add_u32 s46, s62, 6684928
  buffer_load_dwordx4 v64, s[4:7], s46 offen  lds
  ds_read_b64_tr_b16 v[184:185], v67 offset:8192
  ds_read_b64_tr_b16 v[186:187], v67 offset:9216
  ds_read_b64_tr_b16 v[188:189], v67 offset:12288
  ds_read_b64_tr_b16 v[190:191], v67 offset:13312
  ds_read_b64_tr_b16 v[192:193], v67 offset:16384
  ds_read_b64_tr_b16 v[194:195], v67 offset:17408
  ds_read_b64_tr_b16 v[196:197], v67 offset:20480
  ds_read_b64_tr_b16 v[198:199], v67 offset:21504
  ds_read_b64_tr_b16 v[200:201], v67 offset:24576
  ds_read_b64_tr_b16 v[202:203], v67 offset:25600
  ds_read_b64_tr_b16 v[204:205], v67 offset:28672
  ds_read_b64_tr_b16 v[206:207], v67 offset:29696
  s_waitcnt lgkmcnt(0)
  s_waitcnt vmcnt(25)
  s_barrier
  s_add_u32 m0, s51, 73728
  s_add_u32 s46, s63, 384
  buffer_load_dwordx4 v65, s[12:15], s46 offen  lds
  s_add_u32 m0, s51, 77824
  s_add_u32 s46, s63, 41344
  buffer_load_dwordx4 v65, s[12:15], s46 offen  lds
  s_add_u32 m0, s51, 81920
  s_add_u32 s46, s63, 82304
  buffer_load_dwordx4 v65, s[12:15], s46 offen  lds
  s_add_u32 m0, s51, 86016
  s_add_u32 s46, s63, 123264
  buffer_load_dwordx4 v65, s[12:15], s46 offen  lds
  s_add_u32 m0, s51, 90112
  s_add_u32 s46, s63, 164224
  buffer_load_dwordx4 v65, s[12:15], s46 offen  lds
  s_add_u32 m0, s51, 94208
  s_add_u32 s46, s63, 205184
  buffer_load_dwordx4 v65, s[12:15], s46 offen  lds
  ds_read_b64_tr_b16 v[208:209], v67 offset:32768
  ds_read_b64_tr_b16 v[210:211], v67 offset:33792
  ds_read_b64_tr_b16 v[212:213], v67 offset:36864
  ds_read_b64_tr_b16 v[214:215], v67 offset:37888
  ds_read_b64_tr_b16 v[216:217], v67 offset:40960
  ds_read_b64_tr_b16 v[218:219], v67 offset:41984
  ds_read_b64_tr_b16 v[220:221], v67 offset:45056
  ds_read_b64_tr_b16 v[222:223], v67 offset:46080
  ds_read_b64_tr_b16 v[224:225], v67 offset:49152
  ds_read_b64_tr_b16 v[226:227], v67 offset:50176
  ds_read_b64_tr_b16 v[228:229], v67 offset:53248
  ds_read_b64_tr_b16 v[230:231], v67 offset:54272
  s_waitcnt lgkmcnt(0)
  s_waitcnt vmcnt(24)
  s_barrier
  s_add_u32 m0, s51, 98304
  s_add_u32 s46, s63, 1024
  buffer_load_dwordx4 v65, s[12:15], s46 offen  lds
  s_add_u32 m0, s51, 102400
  s_add_u32 s46, s63, 41984
  buffer_load_dwordx4 v65, s[12:15], s46 offen  lds
  s_add_u32 m0, s51, 106496
  s_add_u32 s46, s63, 82944
  buffer_load_dwordx4 v65, s[12:15], s46 offen  lds
  s_add_u32 m0, s51, 110592
  s_add_u32 s46, s63, 123904
  buffer_load_dwordx4 v65, s[12:15], s46 offen  lds
  s_add_u32 m0, s51, 114688
  s_add_u32 s46, s63, 164864
  buffer_load_dwordx4 v65, s[12:15], s46 offen  lds
  s_add_u32 m0, s51, 118784
  s_add_u32 s46, s63, 205824
  buffer_load_dwordx4 v65, s[12:15], s46 offen  lds
  ds_read_b64_tr_b16 v[232:233], v67 offset:57344
  ds_read_b64_tr_b16 v[234:235], v67 offset:58368
  ds_read_b64_tr_b16 v[236:237], v67 offset:61440
  ds_read_b64_tr_b16 v[238:239], v67 offset:62464
  ds_read_b64_tr_b16 v[240:241], v68 offset:0
  ds_read_b64_tr_b16 v[242:243], v68 offset:1024
  ds_read_b64_tr_b16 v[244:245], v68 offset:4096
  ds_read_b64_tr_b16 v[246:247], v68 offset:5120
  ds_read_b64_tr_b16 v[248:249], v68 offset:8192
  ds_read_b64_tr_b16 v[250:251], v68 offset:9216
  ds_read_b64_tr_b16 v[252:253], v68 offset:12288
  ds_read_b64_tr_b16 v[254:255], v68 offset:13312
  s_waitcnt lgkmcnt(0)
  s_mov_b32 s50, 0
  s_branch ss_25_in
ss_25:
  v_and_b32 v149, 3, v0
  v_lshlrev_b32 v149, 2, v149
  global_load_dword v148, v149, s[38:39] sc1
  s_add_u32 s50, s50, 1
  s_cmp_gt_u32 s50, 131072
  s_cbranch_scc1 L_fail
  s_waitcnt vmcnt(0)
ss_25_in:
  v_readlane_b32 s46, v148, 0
  v_readlane_b32 s47, v148, 2
  v_readlane_b32 s48, v148, 1
  s_nop 0
  s_min_u32 s47, s47, s48
  s_cmp_lg_u32 s46, 0
  s_cselect_b32 s48, 7, 0
  s_add_u32 s46, s46, s2
  s_xor_b32 s49, s46, s43
  s_and_b32 s49, s49, s48
  s_cbranch_scc1 L_reroll
  s_cmp_lg_u32 s47, 0
  s_cbranch_scc1 ss_ok_26
  s_sleep 6
  s_branch ss_25
ss_ok_26:
  v_readlane_b32 s3, v148, 1
  s_nop 0
  s_and_b32 s3, s3, 0x2000
  s_add_u32 s46, s42, 1
  s_lshl_b32 s31, s46, 10
  s_cmp_ge_u32 s46, 8
  s_cselect_b32 s47, 40960, 0
  s_add_u32 s31, s31, s47
  s_cmp_ge_u32 s46, 10
  s_cselect_b32 s31, 2146435072, s31
  s_add_u32 s46, s42, 5
  s_lshl_b32 s32, s46, 10
  s_cmp_ge_u32 s46, 8
  s_cselect_b32 s47, 40960, 0
  s_add_u32 s32, s32, s47
  s_cmp_ge_u32 s46, 10
  s_cselect_b32 s32, 2146435072, s32
  s_add_u32 s46, s42, 9
  s_lshl_b32 s33, s46, 10
  s_cmp_ge_u32 s46, 8
  s_cselect_b32 s47, 40960, 0
  s_add_u32 s33, s33, s47
  s_cmp_ge_u32 s46, 10
  s_cselect_b32 s33, 2146435072, s33
  v_add_u32 v9, 126976, v1
  s_lshr_b32 s46, s44, 4
  s_lshl_b32 s46, s46, 7
  s_lshl_b32 s47, s43, 4
  s_add_u32 s46, s46, s47
  s_and_b32 s47, s44, 15
  s_add_u32 s46, s46, s47
  s_lshl_b32 s46, s46, 7
  s_add_u32 s46, s46, s3
  s_add_u32 s46, s46, 13369344
  s_add_u32 s40, s8, s46
  s_addc_u32 s41, s9, 0
  v_mov_b32 v7, 0x44444444
  v_mov_b32 v148, 0xeeeeeeee
  v_and_b32 v149, 2, v0
  v_cmp_ne_u32 vcc, 0, v149
  s_nop 1
  v_cndmask_b32 v7, v7, v148, vcc
  v_and_b32 v148, 15, v0
  v_lshrrev_b32 v149, 4, v0
  v_lshlrev_b32 v8, 4, v148
  v_lshrrev_b32 v150, 2, v148
  v_lshlrev_b32 v4, 6, v150
  v_and_b32 v150, 1, v148
  v_lshl_add_u32 v4, v150, 5, v4
  v_lshl_add_u32 v4, v149, 3, v4
  v_bfe_u32 v150, v148, 1, 1
  v_lshl_add_u32 v4, v150, 2, v4
  s_and_b32 s46, s42, 1
  s_lshl_b32 s46, s46, 7
  v_xor_b32 v4, s46, v4
  s_lshl_b32 s46, s42, 8
  s_add_u32 s46, s46, 122880
  v_add_u32 v4, s46, v4
  s_lshl_b32 s46, s45, 8
  s_lshl_b32 s47, s42, 14
  s_add_u32 s47, s47, s46
  v_lshl_add_u32 v8, v149, 16, v8
  v_add_u32 v8, s47, v8
  v_lshrrev_b32 v150, 1, v149
  v_lshl_add_u32 v13, v150, 30, v8
  v_mul_u32_u24 v150, 131064, v150
  v_sub_u32 v8, v8, v150
  v_lshlrev_b32 v5, 8, v149
  v_and_b32 v150, 1, v149
  v_lshl_add_u32 v5, v150, 7, v5
  v_lshl_add_u32 v5, v148, 3, v5
  v_xor_b32 v6, 0x80, v5
  v_add_u32 v5, 122880, v5
  v_add_u32 v6, 122880, v6
  s_lshl_b32 s46, s45, 7
  s_lshl_b32 s47, s42, 2
  s_add_u32 s47, s47, s46
  s_add_u32 s47, s47, 1064960
  v_mov_b32 v15, s47
  s_mov_b32 s52, 0
  s_mov_b32 s58, 0
  s_mov_b32 s54, 0
  s_mov_b32 s100, 0
  s_waitcnt vmcnt(24)
  s_barrier
  ds_read_b64_tr_b16 v[40:41], v66 offset:0
  ds_read_b64_tr_b16 v[42:43], v66 offset:1024
  ds_read_b64_tr_b16 v[44:45], v66 offset:4096
  ds_read_b64_tr_b16 v[46:47], v66 offset:5120
  ds_read_b64_tr_b16 v[48:49], v66 offset:8192
  ds_read_b64_tr_b16 v[50:51], v66 offset:9216
  ds_read_b64_tr_b16 v[52:53], v66 offset:12288
  ds_read_b64_tr_b16 v[54:55], v66 offset:13312
  ds_read_b64_tr_b16 v[56:57], v66 offset:16384
  ds_read_b64_tr_b16 v[58:59], v66 offset:17408
  ds_read_b64_tr_b16 v[60:61], v66 offset:20480
  ds_read_b64_tr_b16 v[62:63], v66 offset:21504
  s_waitcnt lgkmcnt(0)
  s_waitcnt vmcnt(18)
  s_barrier
  ds_write_b128 v2, v[40:43] offset:0
  ds_write_b128 v2, v[44:47] offset:4096
  ds_write_b128 v2, v[48:51] offset:8192
  ds_write_b128 v2, v[52:55] offset:12288
  ds_write_b128 v2, v[56:59] offset:16384
  ds_write_b128 v2, v[60:63] offset:20480
  ds_read_b64_tr_b16 v[16:17], v66 offset:24576
  ds_read_b64_tr_b16 v[18:19], v66 offset:25600
  ds_read_b64_tr_b16 v[20:21], v66 offset:28672
  ds_read_b64_tr_b16 v[22:23], v66 offset:29696
  ds_read_b64_tr_b16 v[24:25], v66 offset:32768
  ds_read_b64_tr_b16 v[26:27], v66 offset:33792
  ds_read_b64_tr_b16 v[28:29], v66 offset:36864
  ds_read_b64_tr_b16 v[30:31], v66 offset:37888
  ds_read_b64_tr_b16 v[32:33], v66 offset:40960
  ds_read_b64_tr_b16 v[34:35], v66 offset:41984
  ds_read_b64_tr_b16 v[36:37], v66 offset:45056
  ds_read_b64_tr_b16 v[38:39], v66 offset:46080
  s_waitcnt lgkmcnt(0)
  s_waitcnt vmcnt(12)
  s_barrier
  ds_write_b128 v2, v[16:19] offset:24576
  ds_write_b128 v2, v[20:23] offset:28672
  ds_write_b128 v2, v[24:27] offset:32768
  ds_write_b128 v2, v[28:31] offset:36864
  ds_write_b128 v2, v[32:35] offset:40960
  ds_write_b128 v2, v[36:39] offset:45056
  ds_read_b64_tr_b16 v[40:41], v66 offset:49152
  ds_read_b64_tr_b16 v[42:43], v66 offset:50176
  ds_read_b64_tr_b16 v[44:45], v66 offset:53248
  ds_read_b64_tr_b16 v[46:47], v66 offset:54272
  ds_read_b64_tr_b16 v[48:49], v66 offset:57344
  ds_read_b64_tr_b16 v[50:51], v66 offset:58368
  ds_read_b64_tr_b16 v[52:53], v66 offset:61440
  ds_read_b64_tr_b16 v[54:55], v66 offset:62464
  ds_read_b64_tr_b16 v[56:57], v67 offset:0
  ds_read_b64_tr_b16 v[58:59], v67 offset:1024
  ds_read_b64_tr_b16 v[60:61], v67 offset:4096
  ds_read_b64_tr_b16 v[62:63], v67 offset:5120
  s_waitcnt lgkmcnt(0)
  s_waitcnt vmcnt(6)
  s_barrier
  ds_write_b128 v2, v[40:43] offset:49152
  ds_write_b128 v2, v[44:47] offset:53248
  ds_write_b128 v2, v[48:51] offset:57344
  ds_write_b128 v2, v[52:55] offset:61440
  ds_write_b128 v3, v[56:59] offset:0
  ds_write_b128 v3, v[60:63] offset:4096
  ds_read_b64_tr_b16 v[16:17], v67 offset:8192
  ds_read_b64_tr_b16 v[18:19], v67 offset:9216
  ds_read_b64_tr_b16 v[20:21], v67 offset:12288
  ds_read_b64_tr_b16 v[22:23], v67 offset:13312
  ds_read_b64_tr_b16 v[24:25], v67 offset:16384
  ds_read_b64_tr_b16 v[26:27], v67 offset:17408
  ds_read_b64_tr_b16 v[28:29], v67 offset:20480
  ds_read_b64_tr_b16 v[30:31], v67 offset:21504
  ds_read_b64_tr_b16 v[32:33], v67 offset:24576
  ds_read_b64_tr_b16 v[34:35], v67 offset:25600
  ds_read_b64_tr_b16 v[36:37], v67 offset:28672
  ds_read_b64_tr_b16 v[38:39], v67 offset:29696
  s_waitcnt lgkmcnt(0)
  s_waitcnt vmcnt(0)
  s_barrier
  ds_write_b128 v3, v[16:19] offset:8192
  ds_write_b128 v3, v[20:23] offset:12288
  ds_write_b128 v3, v[24:27] offset:16384
  ds_write_b128 v3, v[28:31] offset:20480
  ds_write_b128 v3, v[32:35] offset:24576
  ds_write_b128 v3, v[36:39] offset:28672
  ds_read_b64_tr_b16 v[40:41], v67 offset:32768
  ds_read_b64_tr_b16 v[42:43], v67 offset:33792
  ds_read_b64_tr_b16 v[44:45], v67 offset:36864
  ds_read_b64_tr_b16 v[46:47], v67 offset:37888
  ds_read_b64_tr_b16 v[48:49], v67 offset:40960
  ds_read_b64_tr_b16 v[50:51], v67 offset:41984
  ds_read_b64_tr_b16 v[52:53], v67 offset:45056
  ds_read_b64_tr_b16 v[54:55], v67 offset:46080
  ds_read_b64_tr_b16 v[56:57], v67 offset:49152
  ds_read_b64_tr_b16 v[58:59], v67 offset:50176
  ds_read_b64_tr_b16 v[60:61], v67 offset:53248
  ds_read_b64_tr_b16 v[62:63], v67 offset:54272
  s_waitcnt lgkmcnt(0)
  s_barrier
  ds_write_b128 v3, v[40:43] offset:32768
  ds_write_b128 v3, v[44:47] offset:36864
  ds_write_b128 v3, v[48:51] offset:40960
  ds_write_b128 v3, v[52:55] offset:45056
  ds_write_b128 v3, v[56:59] offset:49152
  ds_write_b128 v3, v[60:63] offset:53248
  s_waitcnt lgkmcnt(0)
va_loop:
  s_add_u32 s53, s52, 1
  s_lshl_b32 s56, s58, 2
  s_add_u32 s56, s56, s43
  s_lshl_b32 s56, s56, 16
  s_add_u32 s56, s56, s3
  s_add_u32 s56, s56, 12582912
  s_lshl_b32 s72, s54, 21
  s_mul_i32 s46, s58, 655360
  s_add_u32 s72, s72, s46
  s_add_u32 s72, s72, s3
  s_add_u32 s72, s72, 4194304
  s_lshr_b32 s46, s72, 8
  s_and_b32 s46, s46, 0x2000
  s_xor_b32 s72, s72, s46
  s_add_u32 s73, s72, 131072
  s_add_u32 s74, s72, 262144
  s_add_u32 s75, s72, 393216
  s_add_u32 s76, s72, 524288
  v_add_u32 v11, s56, v1
  s_mov_b64 s[16:17], -1
  s_mov_b32 s71, 0
  ds_read_b128 v[56:59], v2 offset:0
  ds_read_b128 v[60:63], v2 offset:4096
  ds_read_b128 v[64:67], v2 offset:8192
  ds_read_b128 v[68:71], v2 offset:12288
  ds_read_b128 v[72:75], v2 offset:16384
  ds_read_b128 v[76:79], v2 offset:20480
  ds_read_b128 v[80:83], v2 offset:24576
  ds_read_b128 v[84:87], v2 offset:28672
  v_mov_b32 v88, 0
  v_mov_b32 v89, 0
  v_mov_b32 v90, 0
  v_mov_b32 v91, 0
  v_mov_b32 v92, 0
  v_mov_b32 v93, 0
  v_mov_b32 v94, 0
  v_mov_b32 v95, 0
  v_mov_b32 v96, 0
  v_mov_b32 v97, 0
  v_mov_b32 v98, 0
  v_mov_b32 v99, 0
  v_mov_b32 v100, 0
  v_mov_b32 v101, 0
  v_mov_b32 v102, 0
  v_mov_b32 v103, 0
  v_mov_b32 v104, 0
  v_mov_b32 v105, 0
  v_mov_b32 v106, 0
  v_mov_b32 v107, 0
  v_mov_b32 v108, 0
  v_mov_b32 v109, 0
  v_mov_b32 v110, 0
  v_mov_b32 v111, 0
  v_mov_b32 v112, 0
  v_mov_b32 v113, 0
  v_mov_b32 v114, 0
  v_mov_b32 v115, 0
  v_mov_b32 v128, 0
  v_mov_b32 v129, 0
  v_mov_b32 v130, 0
  v_mov_b32 v131, 0
  v_mov_b32 v132, 0
  v_mov_b32 v133, 0
  v_mov_b32 v134, 0
  v_mov_b32 v135, 0
  v_mov_b32 v136, 0
  v_mov_b32 v137, 0
  v_mov_b32 v138, 0
  v_mov_b32 v139, 0
  v_mov_b32 v140, 0
  v_mov_b32 v141, 0
  v_mov_b32 v142, 0
  v_mov_b32 v143, 0
  v_mov_b32 v144, 0
  v_mov_b32 v145, 0
  v_mov_b32 v146, 0
  v_mov_b32 v147, 0
  s_waitcnt lgkmcnt(0)
  s_cmp_lg_u32 s42, 3
  s_cbranch_scc1 va_nobell
  s_mov_b32 s50, 0
  s_waitcnt lgkmcnt(0)
  s_mov_b64 s[80:81], 0
  s_mov_b64 s[82:83], 0
  s_cmp_eq_u32 s53, 1
  s_cbranch_scc1 bell_x_28
bell_27:
  s_load_dwordx4 s[80:83], s[40:41], 0 glc
  s_min_u32 s46, s80, s81
  s_min_u32 s47, s82, s83
  s_min_u32 s46, s46, s47
  s_cmp_ge_u32 s46, s53
  s_cbranch_scc1 bell_x_28
  s_min_u32 s46, s80, s81
  s_min_u32 s47, s82, s83
  s_min_u32 s46, s46, s47
  s_cmp_ge_u32 s46, s53
  s_cbranch_scc1 bell_x_28
  s_min_u32 s46, s80, s81
  s_min_u32 s47, s82, s83
  s_min_u32 s46, s46, s47
  s_cmp_ge_u32 s46, s53
  s_cbranch_scc1 bell_x_28
  s_min_u32 s46, s80, s81
  s_min_u32 s47, s82, s83
  s_min_u32 s46, s46, s47
  s_cmp_ge_u32 s46, s53
  s_cbranch_scc1 bell_x_28
  s_min_u32 s46, s80, s81
  s_min_u32 s47, s82, s83
  s_min_u32 s46, s46, s47
  s_cmp_ge_u32 s46, s53
  s_cbranch_scc1 bell_x_28
  s_min_u32 s46, s80, s81
  s_min_u32 s47, s82, s83
  s_min_u32 s46, s46, s47
  s_cmp_ge_u32 s46, s53
  s_cbranch_scc1 bell_x_28
  s_min_u32 s46, s80, s81
  s_min_u32 s47, s82, s83
  s_min_u32 s46, s46, s47
  s_cmp_ge_u32 s46, s53
  s_cbranch_scc1 bell_x_28
  s_min_u32 s46, s80, s81
  s_min_u32 s47, s82, s83
  s_min_u32 s46, s46, s47
  s_cmp_ge_u32 s46, s53
  s_cbranch_scc1 bell_x_28
  s_min_u32 s46, s80, s81
  s_min_u32 s47, s82, s83
  s_min_u32 s46, s46, s47
  s_cmp_ge_u32 s46, s53
  s_cbranch_scc1 bell_x_28
  s_min_u32 s46, s80, s81
  s_min_u32 s47, s82, s83
  s_min_u32 s46, s46, s47
  s_cmp_ge_u32 s46, s53
  s_cbranch_scc1 bell_x_28
  s_add_u32 s50, s50, 1
  s_cmp_lt_u32 s50, 524288
  s_cbranch_scc1 bell_27
  s_branch L_fail
bell_x_28:
va_nobell:
  s_mov_b32 s50, 0
va_top:
  s_add_u32 m0, s51, 126976
  s_barrier
  buffer_load_dwordx4 v11, s[8:11], s31 offen sc1 lds
  s_add_u32 m0, s51, 131072
  s_barrier
  buffer_load_dwordx4 v[16:19], v11, s[8:11], 0 offen offset:0 sc1
  s_barrier
  buffer_load_dwordx4 v11, s[8:11], s32 offen sc1 lds
  s_add_u32 m0, s51, 135168
  s_nop 0
  buffer_load_dwordx4 v11, s[8:11], s33 offen sc1 lds
  s_waitcnt vmcnt(3)
  s_barrier
  ds_read_b128 v[20:23], v9 offset:0
  ds_read_b128 v[24:27], v9 offset:1024
  s_waitcnt vmcnt(2)
va_go:
  v_smfmac_f32_16x16x64_bf16 v[104:107], v[16:19], v[56:63], v7
  ds_read_b128 v[28:31], v9 offset:2048
  v_smfmac_f32_16x16x64_bf16 v[108:111], v[16:19], v[64:71], v7
  ds_read_b128 v[32:35], v9 offset:3072
  v_smfmac_f32_16x16x64_bf16 v[112:115], v[16:19], v[72:79], v7
  ds_read_b128 v[56:59], v2 offset:49152
  s_waitcnt lgkmcnt(4)
  v_smfmac_f32_16x16x64_bf16 v[104:107], v[20:23], a[0:7], v7
  ds_read_b128 v[60:63], v2 offset:53248
  v_cmp_eq_u32 vcc, -1, v16
  v_smfmac_f32_16x16x64_bf16 v[108:111], v[20:23], a[8:15], v7
  ds_read_b128 v[64:67], v2 offset:32768
  v_smfmac_f32_16x16x64_bf16 v[112:115], v[20:23], a[16:23], v7
  s_cbranch_vccnz va_ha
  s_waitcnt lgkmcnt(4)
  v_smfmac_f32_16x16x64_bf16 v[104:107], v[24:27], a[24:31], v7
  s_waitcnt vmcnt(0)
  s_barrier
  ds_read_b128 v[36:39], v9 offset:4096
  v_smfmac_f32_16x16x64_bf16 v[108:111], v[24:27], a[32:39], v7
  ds_read_b128 v[40:43], v9 offset:5120
  v_smfmac_f32_16x16x64_bf16 v[112:115], v[24:27], a[40:47], v7
  ds_read_b128 v[44:47], v9 offset:6144
  v_mov_b32 v16, 0
  v_smfmac_f32_16x16x64_bf16 v[104:107], v[28:31], a[48:55], v7
  ds_read_b128 v[48:51], v9 offset:7168
  s_waitcnt lgkmcnt(4)
  v_smfmac_f32_16x16x64_bf16 v[104:107], v[32:35], v[80:87], v7
  ds_read_b128 v[52:55], v9 offset:8192
  s_waitcnt lgkmcnt(4)
  v_smfmac_f32_16x16x64_bf16 v[104:107], v[36:39], a[72:79], v7
  ds_read_b128 v[68:71], v2 offset:36864
  s_waitcnt lgkmcnt(4)
  v_max3_u32 v12, v20, v24, v28
  v_smfmac_f32_16x16x64_bf16 v[104:107], v[40:43], a[96:103], v7
  s_waitcnt lgkmcnt(3)
  v_max3_u32 v12, v12, v32, v36
  v_smfmac_f32_16x16x64_bf16 v[104:107], v[44:47], a[120:127], v7
  s_waitcnt lgkmcnt(2)
  v_max3_u32 v12, v12, v40, v44
  v_smfmac_f32_16x16x64_bf16 v[104:107], v[48:51], v[56:63], v7
  s_waitcnt lgkmcnt(1)
  v_max3_u32 v12, v12, v48, v52
  v_smfmac_f32_16x16x64_bf16 v[104:107], v[52:55], a[144:151], v7
  ds_read_b128 v[72:75], v2 offset:57344
  v_cmp_eq_u32 vcc, -1, v12
  v_smfmac_f32_16x16x64_bf16 v[108:111], v[28:31], a[56:63], v7
  ds_read_b128 v[76:79], v2 offset:61440
  s_waitcnt lgkmcnt(2)
  v_smfmac_f32_16x16x64_bf16 v[108:111], v[32:35], v[64:71], v7
  s_cbranch_vccnz va_hb
  v_mov_b32 v17, 0
va_join:
  v_smfmac_f32_16x16x64_bf16 v[108:111], v[36:39], a[80:87], v7
  ds_read_b128 v[80:83], v2 offset:40960
  v_add_f32 v104, v104, v106
  v_smfmac_f32_16x16x64_bf16 v[108:111], v[40:43], a[104:111], v7
  ds_read_b128 v[84:87], v2 offset:45056
  v_add_f32 v105, v105, v107
  v_smfmac_f32_16x16x64_bf16 v[108:111], v[44:47], a[128:135], v7
  ds_read_b128 v[56:59], v3 offset:0
  s_waitcnt lgkmcnt(3)
  v_cvt_pk_bf16_f32 v106, v104, v105
  v_smfmac_f32_16x16x64_bf16 v[108:111], v[48:51], v[72:79], v7
  ds_write_b32 v4, v106 offset:0
  v_smfmac_f32_16x16x64_bf16 v[108:111], v[52:55], a[152:159], v7
  ds_read_b128 v[60:63], v3 offset:4096
  v_cmp_u_f32 vcc, v104, v105
  v_smfmac_f32_16x16x64_bf16 v[112:115], v[28:31], a[64:71], v7
  ds_read_b128 v[64:67], v3 offset:8192
  s_waitcnt lgkmcnt(4)
  v_smfmac_f32_16x16x64_bf16 v[112:115], v[32:35], v[80:87], v7
  s_and_b64 vcc, vcc, s[16:17]
  s_cbranch_scc1 va_redo
  v_add_f32 v108, v108, v110
  v_smfmac_f32_16x16x64_bf16 v[112:115], v[36:39], a[88:95], v7
  s_waitcnt lgkmcnt(2)
  s_barrier
  v_add_f32 v109, v109, v111
  v_smfmac_f32_16x16x64_bf16 v[112:115], v[40:43], a[112:119], v7
  ds_read_b64_tr_b16 v[116:117], v5 offset:0
  ds_read_b64_tr_b16 v[118:119], v6 offset:0
  v_smfmac_f32_16x16x64_bf16 v[112:115], v[44:47], a[136:143], v7
  ds_read_b128 v[68:71], v3 offset:12288
  s_waitcnt lgkmcnt(4)
  v_cvt_pk_bf16_f32 v110, v108, v109
  v_smfmac_f32_16x16x64_bf16 v[112:115], v[48:51], v[56:63], v7
  ds_write_b32 v4, v110 offset:1024
  v_smfmac_f32_16x16x64_bf16 v[112:115], v[52:55], a[160:167], v7
  ds_read_b128 v[72:75], v3 offset:32768
  s_waitcnt lgkmcnt(3)
  v_smfmac_f32_16x16x64_bf16 v[128:131], v[116:119], a[168:175], v7
  ds_read_b128 v[76:79], v3 offset:36864
  v_mov_b32 v18, 0
  v_smfmac_f32_16x16x64_bf16 v[132:135], v[116:119], a[192:199], v7
  ds_read_b128 v[80:83], v3 offset:16384
  v_add_f32 v112, v112, v114
  v_smfmac_f32_16x16x64_bf16 v[136:139], v[116:119], a[216:223], v7
  s_waitcnt lgkmcnt(3)
  s_barrier
  v_add_f32 v113, v113, v115
  v_smfmac_f32_16x16x64_bf16 v[140:143], v[116:119], v[64:71], v7
  ds_read_b128 v[84:87], v3 offset:20480
  v_cvt_pk_bf16_f32 v114, v112, v113
  v_smfmac_f32_16x16x64_bf16 v[144:147], v[116:119], a[240:247], v7
  ds_write_b32 v4, v114 offset:2048
  v_smfmac_f32_16x16x64_bf16 v[88:91], v[116:119], v[160:167], v7
  ds_read_b64_tr_b16 v[120:121], v5 offset:1024
  ds_read_b64_tr_b16 v[122:123], v6 offset:1024
  v_smfmac_f32_16x16x64_bf16 v[92:95], v[116:119], v[184:191], v7
  ds_read_b128 v[56:59], v3 offset:24576
  v_mov_b32 v19, 0
  v_smfmac_f32_16x16x64_bf16 v[96:99], v[116:119], v[208:215], v7
  ds_read_b128 v[60:63], v3 offset:28672
  s_waitcnt lgkmcnt(6)
  v_smfmac_f32_16x16x64_bf16 v[100:103], v[116:119], v[72:79], v7
  s_waitcnt lgkmcnt(4)
  s_barrier
  v_smfmac_f32_16x16x64_bf16 v[16:19], v[116:119], v[232:239], v7
  ds_read_b64_tr_b16 v[124:125], v5 offset:2048
  ds_read_b64_tr_b16 v[126:127], v6 offset:2048
  s_waitcnt lgkmcnt(4)
  v_smfmac_f32_16x16x64_bf16 v[128:131], v[120:123], a[176:183], v7
  ds_read_b128 v[64:67], v3 offset:40960
  v_smfmac_f32_16x16x64_bf16 v[132:135], v[120:123], a[200:207], v7
  ds_read_b128 v[68:71], v3 offset:45056
  v_smfmac_f32_16x16x64_bf16 v[136:139], v[120:123], a[224:231], v7
  ds_read_b128 v[72:75], v3 offset:49152
  v_smfmac_f32_16x16x64_bf16 v[140:143], v[120:123], v[80:87], v7
  ds_read_b128 v[76:79], v3 offset:53248
  s_waitcnt lgkmcnt(4)
  v_smfmac_f32_16x16x64_bf16 v[128:131], v[124:127], a[184:191], v7
  v_smfmac_f32_16x16x64_bf16 v[132:135], v[124:127], a[208:215], v7
  v_smfmac_f32_16x16x64_bf16 v[136:139], v[124:127], a[232:239], v7
  v_add_f32 v128, v128, v130
  v_add_f32 v129, v129, v131
  v_cvt_pk_bf16_f32 v128, v128, v129
  v_smfmac_f32_16x16x64_bf16 v[140:143], v[124:127], v[56:63], v7
  v_add_f32 v132, v132, v134
  v_add_f32 v133, v133, v135
  v_cvt_pk_bf16_f32 v129, v132, v133
  v_smfmac_f32_16x16x64_bf16 v[144:147], v[120:123], a[248:255], v7
  v_add_f32 v136, v136, v138
  v_add_f32 v137, v137, v139
  v_permlane16_swap_b32 v128, v129
  v_smfmac_f32_16x16x64_bf16 v[144:147], v[124:127], v[152:159], v7
  buffer_store_dwordx2 v[128:129], v8, s[8:11], s72 offen sc1
  v_cvt_pk_bf16_f32 v136, v136, v137
  v_smfmac_f32_16x16x64_bf16 v[88:91], v[120:123], v[168:175], v7
  v_add_f32 v140, v140, v142
  v_add_f32 v141, v141, v143
  v_smfmac_f32_16x16x64_bf16 v[88:91], v[124:127], v[176:183], v7
  v_cvt_pk_bf16_f32 v137, v140, v141
  v_add_f32 v144, v144, v146
  v_smfmac_f32_16x16x64_bf16 v[92:95], v[120:123], v[192:199], v7
  v_add_f32 v145, v145, v147
  v_permlane16_swap_b32 v136, v137
  v_smfmac_f32_16x16x64_bf16 v[92:95], v[124:127], v[200:207], v7
  buffer_store_dwordx2 v[136:137], v8, s[8:11], s73 offen sc1
  v_cvt_pk_bf16_f32 v144, v144, v145
  v_add_f32 v88, v88, v90
  v_smfmac_f32_16x16x64_bf16 v[96:99], v[120:123], v[216:223], v7
  v_add_f32 v89, v89, v91
  v_cvt_pk_bf16_f32 v145, v88, v89
  v_smfmac_f32_16x16x64_bf16 v[96:99], v[124:127], v[224:231], v7
  s_waitcnt lgkmcnt(0)
  v_add_f32 v92, v92, v94
  v_add_f32 v93, v93, v95
  v_permlane16_swap_b32 v144, v145
  v_smfmac_f32_16x16x64_bf16 v[100:103], v[120:123], v[64:71], v7
  buffer_store_dwordx2 v[144:145], v8, s[8:11], s74 offen sc1
  v_cvt_pk_bf16_f32 v92, v92, v93
  v_smfmac_f32_16x16x64_bf16 v[100:103], v[124:127], v[72:79], v7
  v_add_f32 v96, v96, v98
  v_add_f32 v97, v97, v99
  v_cvt_pk_bf16_f32 v93, v96, v97
  v_smfmac_f32_16x16x64_bf16 v[16:19], v[120:123], v[240:247], v7
  v_smfmac_f32_16x16x64_bf16 v[16:19], v[124:127], v[248:255], v7
  v_add_f32 v100, v100, v102
  v_add_f32 v101, v101, v103
  v_permlane16_swap_b32 v92, v93
  buffer_store_dwordx2 v[92:93], v8, s[8:11], s75 offen sc1
  v_cvt_pk_bf16_f32 v100, v100, v101
  s_nop 2
  v_add_f32 v16, v16, v18
  v_add_f32 v17, v17, v19
  v_cvt_pk_bf16_f32 v101, v16, v17
  s_nop 1
  v_permlane16_swap_b32 v100, v101
  buffer_store_dwordx2 v[100:101], v8, s[8:11], s76 offen sc1
  s_add_u32 s58, s58, 1
  s_cmp_eq_u32 s58, 3
  s_cselect_b32 s58, 0, s58
  s_cmp_eq_u32 s58, 0
  s_addc_u32 s54, s54, 0
  s_cmp_eq_u32 s54, 3
  s_cselect_b32 s54, 0, s54
  s_mov_b32 s52, s53
  s_cmp_lt_u32 s52, 64
  s_cbranch_scc1 va_loop
  s_waitcnt vmcnt(0)
  v_mov_b32 v148, s52
  s_mov_b64 exec, 1
  buffer_store_dword v148, v15, s[8:11], 0 offen sc1
  s_mov_b64 exec, -1
  s_endpgm
va_ha:
  s_waitcnt lgkmcnt(0)
  ds_read_b128 v[56:59], v2 offset:0
  ds_read_b128 v[60:63], v2 offset:4096
  ds_read_b128 v[64:67], v2 offset:8192
  ds_read_b128 v[68:71], v2 offset:12288
  ds_read_b128 v[72:75], v2 offset:16384
  ds_read_b128 v[76:79], v2 offset:20480
  ds_read_b128 v[80:83], v2 offset:24576
  ds_read_b128 v[84:87], v2 offset:28672
  v_mov_b32 v88, 0
  v_mov_b32 v89, 0
  v_mov_b32 v90, 0
  v_mov_b32 v91, 0
  v_mov_b32 v92, 0
  v_mov_b32 v93, 0
  v_mov_b32 v94, 0
  v_mov_b32 v95, 0
  v_mov_b32 v96, 0
  v_mov_b32 v97, 0
  v_mov_b32 v98, 0
  v_mov_b32 v99, 0
  v_mov_b32 v100, 0
  v_mov_b32 v101, 0
  v_mov_b32 v102, 0
  v_mov_b32 v103, 0
  v_mov_b32 v104, 0
  v_mov_b32 v105, 0
  v_mov_b32 v106, 0
  v_mov_b32 v107, 0
  v_mov_b32 v108, 0
  v_mov_b32 v109, 0
  v_mov_b32 v110, 0
  v_mov_b32 v111, 0
  v_mov_b32 v112, 0
  v_mov_b32 v113, 0
  v_mov_b32 v114, 0
  v_mov_b32 v115, 0
  v_mov_b32 v128, 0
  v_mov_b32 v129, 0
  v_mov_b32 v130, 0
  v_mov_b32 v131, 0
  v_mov_b32 v132, 0
  v_mov_b32 v133, 0
  v_mov_b32 v134, 0
  v_mov_b32 v135, 0
  v_mov_b32 v136, 0
  v_mov_b32 v137, 0
  v_mov_b32 v138, 0
  v_mov_b32 v139, 0
  v_mov_b32 v140, 0
  v_mov_b32 v141, 0
  v_mov_b32 v142, 0
  v_mov_b32 v143, 0
  v_mov_b32 v144, 0
  v_mov_b32 v145, 0
  v_mov_b32 v146, 0
  v_mov_b32 v147, 0
va_ra:
  buffer_load_dwordx4 v[16:19], v11, s[8:11], 0 offen offset:0 sc1
  s_add_u32 s50, s50, 1
  s_cmp_gt_u32 s50, 131072
  s_cbranch_scc1 L_fail
  s_waitcnt vmcnt(0) lgkmcnt(0)
  v_cmp_eq_u32 vcc, -1, v16
  s_cbranch_vccnz va_ra
  s_branch va_go
va_hb:
  s_waitcnt lgkmcnt(0)
  s_add_u32 s50, s50, 1
  s_cmp_gt_u32 s50, 131072
  s_cbranch_scc1 L_fail
  ds_read_b128 v[56:59], v2 offset:0
  ds_read_b128 v[60:63], v2 offset:4096
  ds_read_b128 v[64:67], v2 offset:8192
  ds_read_b128 v[68:71], v2 offset:12288
  ds_read_b128 v[72:75], v2 offset:16384
  ds_read_b128 v[76:79], v2 offset:20480
  ds_read_b128 v[80:83], v2 offset:24576
  ds_read_b128 v[84:87], v2 offset:28672
  v_mov_b32 v88, 0
  v_mov_b32 v89, 0
  v_mov_b32 v90, 0
  v_mov_b32 v91, 0
  v_mov_b32 v92, 0
  v_mov_b32 v93, 0
  v_mov_b32 v94, 0
  v_mov_b32 v95, 0
  v_mov_b32 v96, 0
  v_mov_b32 v97, 0
  v_mov_b32 v98, 0
  v_mov_b32 v99, 0
  v_mov_b32 v100, 0
  v_mov_b32 v101, 0
  v_mov_b32 v102, 0
  v_mov_b32 v103, 0
  v_mov_b32 v104, 0
  v_mov_b32 v105, 0
  v_mov_b32 v106, 0
  v_mov_b32 v107, 0
  v_mov_b32 v108, 0
  v_mov_b32 v109, 0
  v_mov_b32 v110, 0
  v_mov_b32 v111, 0
  v_mov_b32 v112, 0
  v_mov_b32 v113, 0
  v_mov_b32 v114, 0
  v_mov_b32 v115, 0
  v_mov_b32 v128, 0
  v_mov_b32 v129, 0
  v_mov_b32 v130, 0
  v_mov_b32 v131, 0
  v_mov_b32 v132, 0
  v_mov_b32 v133, 0
  v_mov_b32 v134, 0
  v_mov_b32 v135, 0
  v_mov_b32 v136, 0
  v_mov_b32 v137, 0
  v_mov_b32 v138, 0
  v_mov_b32 v139, 0
  v_mov_b32 v140, 0
  v_mov_b32 v141, 0
  v_mov_b32 v142, 0
  v_mov_b32 v143, 0
  v_mov_b32 v144, 0
  v_mov_b32 v145, 0
  v_mov_b32 v146, 0
  v_mov_b32 v147, 0
  s_waitcnt lgkmcnt(0)
  s_branch va_top
va_redo:
  s_waitcnt lgkmcnt(0)
  s_mov_b32 s50, 0
va_poll:
  buffer_load_dwordx4 v[16:19], v11, s[8:11], 0 offen offset:0 sc1
  buffer_load_dwordx4 v[20:23], v11, s[8:11], 0 offen offset:1024 sc1
  buffer_load_dwordx4 v[24:27], v11, s[8:11], 0 offen offset:2048 sc1
  buffer_load_dwordx4 v[28:31], v11, s[8:11], 0 offen offset:3072 sc1
  buffer_load_dwordx4 v[32:35], v11, s[8:11], s24 offen offset:0 sc1
  buffer_load_dwordx4 v[36:39], v11, s[8:11], s24 offen offset:1024 sc1
  buffer_load_dwordx4 v[40:43], v11, s[8:11], s24 offen offset:2048 sc1
  buffer_load_dwordx4 v[44:47], v11, s[8:11], s24 offen offset:3072 sc1
  buffer_load_dwordx4 v[48:51], v11, s[8:11], s25 offen offset:0 sc1
  buffer_load_dwordx4 v[52:55], v11, s[8:11], s25 offen offset:1024 sc1
  s_add_u32 s50, s50, 1
  s_cmp_gt_u32 s50, 131072
  s_cbranch_scc1 L_fail
  s_waitcnt vmcnt(0) lgkmcnt(0)
  v_max_u32 v12, v16, v17
  v_max3_u32 v12, v18, v19, v12
  v_max3_u32 v12, v20, v21, v12
  v_max3_u32 v12, v22, v23, v12
  v_max3_u32 v12, v24, v25, v12
  v_max3_u32 v12, v26, v27, v12
  v_max3_u32 v12, v28, v29, v12
  v_max3_u32 v12, v30, v31, v12
  v_max3_u32 v12, v32, v33, v12
  v_max3_u32 v12, v34, v35, v12
  v_max3_u32 v12, v36, v37, v12
  v_max3_u32 v12, v38, v39, v12
  v_max3_u32 v12, v40, v41, v12
  v_max3_u32 v12, v42, v43, v12
  v_max3_u32 v12, v44, v45, v12
  v_max3_u32 v12, v46, v47, v12
  v_max3_u32 v12, v48, v49, v12
  v_max3_u32 v12, v50, v51, v12
  v_max3_u32 v12, v52, v53, v12
  v_max3_u32 v12, v54, v55, v12
  v_cmp_eq_u32 vcc, -1, v12
  s_cbranch_vccnz va_poll
  s_mov_b64 s[16:17], 0
  ds_read_b128 v[56:59], v2 offset:0
  ds_read_b128 v[60:63], v2 offset:4096
  ds_read_b128 v[64:67], v2 offset:8192
  ds_read_b128 v[68:71], v2 offset:12288
  ds_read_b128 v[72:75], v2 offset:16384
  ds_read_b128 v[76:79], v2 offset:20480
  ds_read_b128 v[80:83], v2 offset:24576
  ds_read_b128 v[84:87], v2 offset:28672
  v_mov_b32 v88, 0
  v_mov_b32 v89, 0
  v_mov_b32 v90, 0
  v_mov_b32 v91, 0
  v_mov_b32 v92, 0
  v_mov_b32 v93, 0
  v_mov_b32 v94, 0
  v_mov_b32 v95, 0
  v_mov_b32 v96, 0
  v_mov_b32 v97, 0
  v_mov_b32 v98, 0
  v_mov_b32 v99, 0
  v_mov_b32 v100, 0
  v_mov_b32 v101, 0
  v_mov_b32 v102, 0
  v_mov_b32 v103, 0
  v_mov_b32 v104, 0
  v_mov_b32 v105, 0
  v_mov_b32 v106, 0
  v_mov_b32 v107, 0
  v_mov_b32 v108, 0
  v_mov_b32 v109, 0
  v_mov_b32 v110, 0
  v_mov_b32 v111, 0
  v_mov_b32 v112, 0
  v_mov_b32 v113, 0
  v_mov_b32 v114, 0
  v_mov_b32 v115, 0
  v_mov_b32 v128, 0
  v_mov_b32 v129, 0
  v_mov_b32 v130, 0
  v_mov_b32 v131, 0
  v_mov_b32 v132, 0
  v_mov_b32 v133, 0
  v_mov_b32 v134, 0
  v_mov_b32 v135, 0
  v_mov_b32 v136, 0
  v_mov_b32 v137, 0
  v_mov_b32 v138, 0
  v_mov_b32 v139, 0
  v_mov_b32 v140, 0
  v_mov_b32 v141, 0
  v_mov_b32 v142, 0
  v_mov_b32 v143, 0
  v_mov_b32 v144, 0
  v_mov_b32 v145, 0
  v_mov_b32 v146, 0
  v_mov_b32 v147, 0
  s_waitcnt lgkmcnt(0)
  v_smfmac_f32_16x16x64_bf16 v[104:107], v[16:19], v[56:63], v7
  v_smfmac_f32_16x16x64_bf16 v[108:111], v[16:19], v[64:71], v7
  v_smfmac_f32_16x16x64_bf16 v[112:115], v[16:19], v[72:79], v7
  ds_read_b128 v[56:59], v2 offset:49152
  v_smfmac_f32_16x16x64_bf16 v[104:107], v[20:23], a[0:7], v7
  ds_read_b128 v[60:63], v2 offset:53248
  v_smfmac_f32_16x16x64_bf16 v[108:111], v[20:23], a[8:15], v7
  ds_read_b128 v[64:67], v2 offset:32768
  v_smfmac_f32_16x16x64_bf16 v[112:115], v[20:23], a[16:23], v7
  v_smfmac_f32_16x16x64_bf16 v[104:107], v[24:27], a[24:31], v7
  v_smfmac_f32_16x16x64_bf16 v[108:111], v[24:27], a[32:39], v7
  v_smfmac_f32_16x16x64_bf16 v[112:115], v[24:27], a[40:47], v7
  v_mov_b32 v16, 0
  v_smfmac_f32_16x16x64_bf16 v[104:107], v[28:31], a[48:55], v7
  v_smfmac_f32_16x16x64_bf16 v[104:107], v[32:35], v[80:87], v7
  v_smfmac_f32_16x16x64_bf16 v[104:107], v[36:39], a[72:79], v7
  ds_read_b128 v[68:71], v2 offset:36864
  v_smfmac_f32_16x16x64_bf16 v[104:107], v[40:43], a[96:103], v7
  v_smfmac_f32_16x16x64_bf16 v[104:107], v[44:47], a[120:127], v7
  s_waitcnt lgkmcnt(1)
  v_smfmac_f32_16x16x64_bf16 v[104:107], v[48:51], v[56:63], v7
  v_smfmac_f32_16x16x64_bf16 v[104:107], v[52:55], a[144:151], v7
  ds_read_b128 v[72:75], v2 offset:57344
  v_smfmac_f32_16x16x64_bf16 v[108:111], v[28:31], a[56:63], v7
  ds_read_b128 v[76:79], v2 offset:61440
  s_waitcnt lgkmcnt(2)
  v_smfmac_f32_16x16x64_bf16 v[108:111], v[32:35], v[64:71], v7
  v_mov_b32 v17, 0
  s_waitcnt lgkmcnt(0)
  s_branch va_join
L_owner:
  s_cmp_ge_u32 s42, 2
  s_cbranch_scc1 L_end
  s_mul_i32 s62, s43, 10
  s_add_u32 s62, s62, s44
  s_sub_u32 s62, s62, 16
  s_mov_b32 s12, s24
  s_mov_b32 s13, s25
  s_mov_b32 s14, 10240
  s_mov_b32 s15, 0x20000
  v_mov_b32 v20, -1
  v_mov_b32 v24, 0
  v_mov_b32 v21, -1
  v_mov_b32 v25, 0
  v_mov_b32 v22, -1
  v_mov_b32 v26, 0
  v_mov_b32 v23, -1
  v_mov_b32 v27, 0
  s_lshl_b32 s48, s42, 13
  s_lshl_b32 s46, s62, 8
  s_cmp_ge_u32 s62, 32
  s_cselect_b32 s47, 40960, 0
  s_add_u32 s46, s46, s47
  s_add_u32 s46, s46, s48
  s_add_u32 s46, s46, 12582912
  v_and_b32 v13, 15, v0
  v_lshlrev_b32 v13, 4, v13
  v_lshrrev_b32 v12, 4, v0
  v_lshl_add_u32 v13, v12, 16, v13
  buffer_store_dwordx4 v[20:23], v13, s[8:11], s46 offen sc1
  s_add_u32 s46, s46, 262144
  buffer_store_dwordx4 v[20:23], v13, s[8:11], s46 offen sc1
  s_add_u32 s46, s46, 262144
  buffer_store_dwordx4 v[20:23], v13, s[8:11], s46 offen sc1
  s_add_u32 s46, s46, 262144
  s_lshl_b32 s46, s62, 9
  s_cmp_ge_u32 s62, 16
  s_cselect_b32 s47, 8192, 0
  s_add_u32 s46, s46, s47
  s_cmp_ge_u32 s62, 32
  s_cselect_b32 s47, 10240, 0
  s_add_u32 s46, s46, s47
  s_add_u32 s46, s46, s48
  s_add_u32 s46, s46, 12599296
  v_lshlrev_b32 v13, 3, v0
  buffer_store_dwordx2 v[20:21], v13, s[8:11], s46 offen sc1
  s_add_u32 s46, s46, 262144
  buffer_store_dwordx2 v[20:21], v13, s[8:11], s46 offen sc1
  s_add_u32 s46, s46, 262144
  buffer_store_dwordx2 v[20:21], v13, s[8:11], s46 offen sc1
  s_add_u32 s46, s46, 262144
  v_min_u32 v13, 4, v0
  v_lshlrev_b32 v13, 7, v13
  s_lshl_b32 s46, s62, 1
  s_add_u32 s46, s46, s42
  s_mul_i32 s46, s46, 640
  s_add_u32 s46, s46, 1048576
  buffer_store_dwordx4 v[24:27], v13, s[8:11], s46 offen sc1
  s_and_b32 s46, s62, 31
  s_lshl_b32 s46, s46, 8
  s_add_u32 s46, s46, s48
  s_add_u32 s46, s46, 13369344
  v_and_b32 v13, 1, v0
  v_lshlrev_b32 v13, 7, v13
  v_bfe_u32 v12, v0, 1, 1
  v_lshl_add_u32 v13, v12, 14, v13
  buffer_store_dwordx4 v[24:27], v13, s[8:11], s46 offen sc1
  v_mov_b32 v13, 192
  v_mov_b32 v14, 1
  s_waitcnt vmcnt(0)
  s_mov_b64 exec, 1
  global_atomic_add v12, v13, v14, s[38:39] sc0 sc1
  s_waitcnt vmcnt(0)
  v_readfirstlane_b32 s46, v12
  s_nop 0
  s_cmp_lg_u32 s46, 79
  s_cbranch_scc1 ow_notlast
  v_mov_b32 v13, 8
  global_store_dword v13, v14, s[38:39] sc1
ow_notlast:
  s_mov_b64 exec, -1
  s_mov_b32 s50, 0
ss_29:
  v_and_b32 v11, 3, v0
  v_lshlrev_b32 v11, 2, v11
  global_load_dword v10, v11, s[38:39] sc1
  s_add_u32 s50, s50, 1
  s_cmp_gt_u32 s50, 131072
  s_cbranch_scc1 L_fail
  s_waitcnt vmcnt(0)
ss_29_in:
  v_readlane_b32 s46, v10, 0
  v_readlane_b32 s47, v10, 2
  v_readlane_b32 s48, v10, 1
  s_nop 0
  s_min_u32 s47, s47, s48
  s_cmp_lg_u32 s46, 0
  s_cselect_b32 s48, 7, 0
  s_add_u32 s46, s46, s2
  s_xor_b32 s49, s46, s43
  s_and_b32 s49, s49, s48
  s_cbranch_scc1 L_reroll
  s_cmp_lg_u32 s47, 0
  s_cbranch_scc1 ss_ok_30
  s_sleep 6
  s_branch ss_29
ss_ok_30:
  v_readlane_b32 s3, v10, 1
  s_nop 0
  s_and_b32 s3, s3, 0x2000
  s_lshr_b32 s46, s44, 4
  s_lshl_b32 s46, s46, 7
  s_lshl_b32 s47, s43, 4
  s_add_u32 s46, s46, s47
  s_and_b32 s47, s44, 15
  s_add_u32 s46, s46, s47
  s_lshl_b32 s46, s46, 7
  s_add_u32 s46, s46, s3
  s_add_u32 s46, s46, 13369344
  s_add_u32 s40, s8, s46
  s_addc_u32 s41, s9, 0
  s_sub_u32 s47, s44, 16
  s_lshl_b32 s46, s47, 11
  s_lshl_b32 s48, s43, 2
  s_add_u32 s46, s46, s48
  s_add_u32 s46, s46, s3
  s_add_u32 s46, s46, 13369344
  v_lshl_add_u32 v7, v0, 7, s46
  v_mov_b32 v10, 2146435072
  s_cmp_lt_u32 s47, 4
  s_cselect_b32 vcc_lo, 65535, 0
  s_mov_b32 vcc_hi, 0
  v_cndmask_b32 v7, v10, v7, vcc
  v_mov_b32 v17, 0
  v_lshlrev_b32 v9, 7, v0
  s_and_b32 s46, s62, 3
  s_lshl_b32 s46, s46, 2
  s_add_u32 s46, s46, 1060864
  v_add_u32 v9, s46, v9
  v_and_b32 v18, 3, v0
  v_min_u32 v18, 2, v18
  v_lshlrev_b32 v18, 8, v18
  s_mul_i32 s46, s43, 768
  s_cmp_ge_u32 s44, 21
  s_cselect_b32 s47, 128, 0
  s_add_u32 s46, s46, s47
  s_add_u32 s46, s46, 1073152
  v_add_u32 v18, s46, v18
  v_cmp_lt_u32 vcc, 31, v0
  s_nop 1
  v_cndmask_b32 v9, v9, v18, vcc
  s_cmp_eq_u32 s42, 0
  s_cbranch_scc1 ow_main
  v_mov_b32 v14, 2146435072
  s_lshl_b32 s46, s43, 11
  s_add_u32 s46, s46, s3
  s_add_u32 s46, s46, 13387008
  v_lshl_add_u32 v19, v0, 7, s46
  s_lshl_b32 s46, s43, 7
  s_add_u32 s46, s46, 1077248
  v_writelane_b32 v19, s46, 6
  s_cmp_eq_u32 s44, 20
  s_cselect_b32 vcc_lo, 127, 0
  s_mov_b32 vcc_hi, 0
  v_cndmask_b32 v19, v14, v19, vcc
  s_mov_b32 s53, 1
  v_mov_b32 v15, 0
ow_listen:
  s_add_u32 s46, s53, 2
  s_min_u32 s46, s46, 64
  v_cmp_gt_u32 vcc, s46, v15
  s_nop 0
  s_and_saveexec_b64 s[64:65], vcc
  s_cbranch_execz ow_fresh
  buffer_load_dword v15, v9, s[8:11], 0 offen sc1
ow_fresh:
  s_mov_b64 exec, -1
  s_add_u32 s46, s53, 1
  v_mov_b32 v16, s46
  s_mov_b32 s50, 0
  s_waitcnt lgkmcnt(0)
  s_mov_b64 s[80:81], 0
  s_mov_b64 s[82:83], 0
bell_31:
  s_load_dwordx4 s[80:83], s[40:41], 0 glc
  s_min_u32 s46, s80, s81
  s_min_u32 s47, s82, s83
  s_min_u32 s46, s46, s47
  s_cmp_ge_u32 s46, s53
  s_cbranch_scc1 bell_x_32
  s_min_u32 s46, s80, s81
  s_min_u32 s47, s82, s83
  s_min_u32 s46, s46, s47
  s_cmp_ge_u32 s46, s53
  s_cbranch_scc1 bell_x_32
  s_min_u32 s46, s80, s81
  s_min_u32 s47, s82, s83
  s_min_u32 s46, s46, s47
  s_cmp_ge_u32 s46, s53
  s_cbranch_scc1 bell_x_32
  s_min_u32 s46, s80, s81
  s_min_u32 s47, s82, s83
  s_min_u32 s46, s46, s47
  s_cmp_ge_u32 s46, s53
  s_cbranch_scc1 bell_x_32
  s_min_u32 s46, s80, s81
  s_min_u32 s47, s82, s83
  s_min_u32 s46, s46, s47
  s_cmp_ge_u32 s46, s53
  s_cbranch_scc1 bell_x_32
  s_min_u32 s46, s80, s81
  s_min_u32 s47, s82, s83
  s_min_u32 s46, s46, s47
  s_cmp_ge_u32 s46, s53
  s_cbranch_scc1 bell_x_32
  s_min_u32 s46, s80, s81
  s_min_u32 s47, s82, s83
  s_min_u32 s46, s46, s47
  s_cmp_ge_u32 s46, s53
  s_cbranch_scc1 bell_x_32
  s_min_u32 s46, s80, s81
  s_min_u32 s47, s82, s83
  s_min_u32 s46, s46, s47
  s_cmp_ge_u32 s46, s53
  s_cbranch_scc1 bell_x_32
  s_min_u32 s46, s80, s81
  s_min_u32 s47, s82, s83
  s_min_u32 s46, s46, s47
  s_cmp_ge_u32 s46, s53
  s_cbranch_scc1 bell_x_32
  s_min_u32 s46, s80, s81
  s_min_u32 s47, s82, s83
  s_min_u32 s46, s46, s47
  s_cmp_ge_u32 s46, s53
  s_cbranch_scc1 bell_x_32
  s_add_u32 s50, s50, 1
  s_cmp_lt_u32 s50, 524288
  s_cbranch_scc1 bell_31
  s_branch L_fail
bell_x_32:
  s_barrier
  s_waitcnt vmcnt(0)
  v_mov_b32 v12, v15
  s_nop 1
  v_min_u32_dpp v12, v12, v12 row_ror:8 row_mask:0xf bank_mask:0xf
  s_nop 1
  v_min_u32_dpp v12, v12, v12 row_ror:4 row_mask:0xf bank_mask:0xf
  s_nop 1
  v_min_u32_dpp v12, v12, v12 row_ror:2 row_mask:0xf bank_mask:0xf
  s_nop 1
  v_min_u32_dpp v12, v12, v12 row_ror:1 row_mask:0xf bank_mask:0xf
  v_mov_b32 v13, v12
  s_nop 1
  v_permlane16_swap_b32 v13, v12
  v_min_u32 v12, v12, v13
  v_mov_b32 v13, v12
  s_nop 1
  v_permlane32_swap_b32 v13, v12
  v_min_u32 v12, v12, v13
  ds_write_b32 v17, v12
  s_sub_u32 s46, s53, 1
  s_waitcnt lgkmcnt(0)
  v_mov_b32 v12, s46
  s_barrier
  s_sleep 0
  buffer_store_dword v12, v19, s[8:11], 0 offen sc1
  s_sleep 8
  s_add_u32 s53, s53, 1
  s_cmp_lt_u32 s53, 64
  s_cbranch_scc1 ow_listen
  s_endpgm
ow_main:
  v_mov_b32 v5, 0x44444444
  v_mov_b32 v10, 0xeeeeeeee
  v_and_b32 v11, 2, v0
  v_cmp_ne_u32 vcc, 0, v11
  s_nop 1
  v_cndmask_b32 v5, v5, v10, vcc
  v_lshlrev_b32 v1, 4, v0
  v_and_b32 v10, 15, v0
  v_lshrrev_b32 v11, 4, v0
  v_lshlrev_b32 v2, 3, v10
  v_lshl_add_u32 v2, v11, 8, v2
  v_and_b32 v13, 1, v10
  v_lshl_add_u32 v12, v11, 1, v13
  v_mov_b32 v4, 0x05040100
  v_mov_b32 v14, 0x03020706
  v_cmp_eq_u32 vcc, 1, v13
  s_nop 1
  v_cndmask_b32 v4, v4, v14, vcc
  v_and_b32 v13, 3, v10
  v_lshl_add_u32 v3, v11, 2, v13
  v_lshlrev_b32 v3, 4, v3
  v_lshrrev_b32 v13, 2, v10
  v_lshl_add_u32 v3, v13, 2, v3
  s_lshl_b32 s46, s62, 8
  s_cmp_ge_u32 s62, 32
  s_cselect_b32 s47, 40960, 0
  s_add_u32 s46, s46, s47
  s_add_u32 s46, s46, s3
  s_add_u32 s46, s46, 12582912
  v_add_u32 v3, s46, v3
  v_mul_u32_u24 v12, 1280, v12
  v_and_b32 v13, 14, v10
  v_lshl_add_u32 v12, v13, 1, v12
  s_lshl_b32 s46, s62, 5
  buffer_load_dword v15, v12, s[12:15], s46 offen
  s_lshl_b32 s63, s62, 16
  s_add_u32 s63, s63, s3
  s_add_u32 s63, s63, 81788928
  s_mov_b32 s61, 0
  s_mov_b32 s52, 0
  s_mov_b32 s58, 0
  s_mov_b32 s54, 0
  s_mov_b32 s100, 0
  s_mov_b32 s49, 1
  s_cmp_ge_u32 s61, s49
  s_cbranch_scc1 wf_done_33
  s_mov_b32 s50, 0
wf_loop_34:
  buffer_load_dword v12, v18, s[8:11], 0 offen sc1
  s_add_u32 s50, s50, 1
  s_cmp_gt_u32 s50, 131072
  s_cbranch_scc1 L_fail
  s_waitcnt vmcnt(0)
  v_min_u32_dpp v12, v12, v12 row_ror:8 row_mask:0xf bank_mask:0xf
  s_nop 1
  v_min_u32_dpp v12, v12, v12 row_ror:4 row_mask:0xf bank_mask:0xf
  s_nop 1
  v_min_u32_dpp v12, v12, v12 row_ror:2 row_mask:0xf bank_mask:0xf
  s_nop 1
  v_min_u32_dpp v12, v12, v12 row_ror:1 row_mask:0xf bank_mask:0xf
  v_mov_b32 v13, v12
  s_nop 1
  v_permlane16_swap_b32 v13, v12
  v_min_u32 v12, v12, v13
  v_mov_b32 v13, v12
  s_nop 1
  v_permlane32_swap_b32 v13, v12
  v_min_u32 v12, v12, v13
  s_nop 0
  v_readfirstlane_b32 s61, v12
  s_nop 0
  s_cmp_ge_u32 s61, s49
  s_cbranch_scc1 wf_done_33
  s_sleep 2
  s_branch wf_loop_34
wf_done_33:
  s_mov_b32 s61, 0
  v_min_u32 v15, -2, v15
  s_mov_b32 s46, 0
  buffer_store_dword v15, v3, s[8:11], s46 offen sc1
  s_mov_b32 s46, 65536
  buffer_store_dword v15, v3, s[8:11], s46 offen sc1
  s_mov_b32 s46, 131072
  buffer_store_dword v15, v3, s[8:11], s46 offen sc1
  s_mov_b32 s46, 196608
  buffer_store_dword v15, v3, s[8:11], s46 offen sc1
  v_mov_b32 v16, 1
  buffer_store_dword v16, v7, s[8:11], 0 offen sc1
  s_mov_b32 s49, 1
  s_cmp_ge_u32 s61, s49
  s_cbranch_scc1 wf_done_35
  s_mov_b32 s50, 0
wf_loop_36:
  buffer_load_dword v12, v9, s[8:11], 0 offen sc1
  s_add_u32 s50, s50, 1
  s_cmp_gt_u32 s50, 131072
  s_cbranch_scc1 L_fail
  s_waitcnt vmcnt(0)
  v_min_u32_dpp v12, v12, v12 row_ror:8 row_mask:0xf bank_mask:0xf
  s_nop 1
  v_min_u32_dpp v12, v12, v12 row_ror:4 row_mask:0xf bank_mask:0xf
  s_nop 1
  v_min_u32_dpp v12, v12, v12 row_ror:2 row_mask:0xf bank_mask:0xf
  s_nop 1
  v_min_u32_dpp v12, v12, v12 row_ror:1 row_mask:0xf bank_mask:0xf
  v_mov_b32 v13, v12
  s_nop 1
  v_permlane16_swap_b32 v13, v12
  v_min_u32 v12, v12, v13
  v_mov_b32 v13, v12
  s_nop 1
  v_permlane32_swap_b32 v13, v12
  v_min_u32 v12, v12, v13
  s_nop 0
  v_readfirstlane_b32 s61, v12
  s_nop 0
  s_cmp_ge_u32 s61, s49
  s_cbranch_scc1 wf_done_35
  s_sleep 2
  s_branch wf_loop_36
wf_done_35:
  s_mov_b32 s65, s63
  s_lshr_b32 s46, s65, 8
  s_and_b32 s46, s46, 0x2000
  s_xor_b32 s65, s65, s46
  s_add_u32 s63, s63, 2621440
  s_cmp_ge_u32 s63, 165675008
  s_cselect_b32 s46, 83886080, 0
  s_sub_u32 s63, s63, s46
  s_add_u32 s46, s65, 0
  s_xor_b32 s46, s46, 0x2000
  buffer_load_dwordx4 a[0:3], v1, s[8:11], s46 offen offset:0 sc1
  buffer_load_dwordx4 a[4:7], v1, s[8:11], s46 offen offset:1024 sc1
  buffer_load_dwordx4 a[8:11], v1, s[8:11], s46 offen offset:2048 sc1
  buffer_load_dwordx4 a[12:15], v1, s[8:11], s46 offen offset:3072 sc1
  s_add_u32 s46, s65, 4096
  s_xor_b32 s46, s46, 0x2000
  buffer_load_dwordx4 a[16:19], v1, s[8:11], s46 offen offset:0 sc1
  buffer_load_dwordx4 a[20:23], v1, s[8:11], s46 offen offset:1024 sc1
  buffer_load_dwordx4 a[24:27], v1, s[8:11], s46 offen offset:2048 sc1
  buffer_load_dwordx4 a[28:31], v1, s[8:11], s46 offen offset:3072 sc1
  s_add_u32 s46, s65, 16384
  buffer_load_dwordx4 a[32:35], v1, s[8:11], s46 offen offset:0 sc1
  buffer_load_dwordx4 a[36:39], v1, s[8:11], s46 offen offset:1024 sc1
  buffer_load_dwordx4 a[40:43], v1, s[8:11], s46 offen offset:2048 sc1
  buffer_load_dwordx4 a[44:47], v1, s[8:11], s46 offen offset:3072 sc1
  s_add_u32 s46, s65, 20480
  buffer_load_dwordx4 a[48:51], v1, s[8:11], s46 offen offset:0 sc1
  buffer_load_dwordx4 a[52:55], v1, s[8:11], s46 offen offset:1024 sc1
  buffer_load_dwordx4 a[56:59], v1, s[8:11], s46 offen offset:2048 sc1
  buffer_load_dwordx4 a[60:63], v1, s[8:11], s46 offen offset:3072 sc1
  s_add_u32 s46, s65, 32768
  buffer_load_dwordx4 a[64:67], v1, s[8:11], s46 offen offset:0 sc1
  buffer_load_dwordx4 a[68:71], v1, s[8:11], s46 offen offset:1024 sc1
  buffer_load_dwordx4 a[72:75], v1, s[8:11], s46 offen offset:2048 sc1
  buffer_load_dwordx4 a[76:79], v1, s[8:11], s46 offen offset:3072 sc1
  s_add_u32 s46, s65, 36864
  buffer_load_dwordx4 a[80:83], v1, s[8:11], s46 offen offset:0 sc1
  buffer_load_dwordx4 a[84:87], v1, s[8:11], s46 offen offset:1024 sc1
  buffer_load_dwordx4 a[88:91], v1, s[8:11], s46 offen offset:2048 sc1
  buffer_load_dwordx4 a[92:95], v1, s[8:11], s46 offen offset:3072 sc1
  s_add_u32 s46, s65, 49152
  buffer_load_dwordx4 a[96:99], v1, s[8:11], s46 offen offset:0 sc1
  buffer_load_dwordx4 a[100:103], v1, s[8:11], s46 offen offset:1024 sc1
  buffer_load_dwordx4 a[104:107], v1, s[8:11], s46 offen offset:2048 sc1
  buffer_load_dwordx4 a[108:111], v1, s[8:11], s46 offen offset:3072 sc1
  s_add_u32 s46, s65, 53248
  buffer_load_dwordx4 a[112:115], v1, s[8:11], s46 offen offset:0 sc1
  buffer_load_dwordx4 a[116:119], v1, s[8:11], s46 offen offset:1024 sc1
  buffer_load_dwordx4 a[120:123], v1, s[8:11], s46 offen offset:2048 sc1
  buffer_load_dwordx4 a[124:127], v1, s[8:11], s46 offen offset:3072 sc1
ow_loop:
  s_add_u32 s53, s52, 1
  s_lshl_b32 s56, s58, 2
  s_add_u32 s56, s56, s43
  s_lshl_b32 s56, s56, 16
  s_add_u32 s56, s56, s3
  s_add_u32 s56, s56, 12582912
  s_add_u32 s66, s58, 1
  s_cmp_eq_u32 s66, 3
  s_cselect_b32 s66, 0, s66
  s_lshl_b32 s72, s54, 21
  s_mul_i32 s46, s58, 655360
  s_add_u32 s72, s72, s46
  s_add_u32 s72, s72, s3
  s_add_u32 s72, s72, 4194304
  s_lshr_b32 s46, s72, 8
  s_and_b32 s46, s46, 0x2000
  s_xor_b32 s72, s72, s46
  s_lshl_b32 s46, s62, 14
  s_add_u32 s72, s72, s46
  s_add_u32 s73, s72, 4096
  s_and_b32 s46, s43, 3
  s_lshl_b32 s46, s46, 16
  s_sub_u32 s56, s56, s46
  s_add_u32 s74, s56, 16384
  s_add_u32 s75, s56, 20480
  s_add_u32 s76, s56, 32768
  s_add_u32 s77, s56, 36864
  s_add_u32 s78, s56, 51200
  s_lshl_b32 s80, s66, 18
  s_add_u32 s81, s80, 65536
  s_add_u32 s82, s80, 131072
  s_add_u32 s83, s80, 196608
  s_cmp_lg_u32 s52, 0
  s_addc_u32 s64, s52, 1
  v_mov_b32 v16, s64
  s_mov_b64 s[16:17], -1
  s_mov_b32 s71, 0
  v_mov_b32 v20, 0
  v_mov_b32 v21, 0
  v_mov_b32 v22, 0
  v_mov_b32 v23, 0
  s_waitcnt vmcnt(0)
  s_barrier
  buffer_load_dwordx4 v[24:27], v1, s[8:11], s72 offen offset:0 sc1
  buffer_load_dwordx4 v[28:31], v1, s[8:11], s72 offen offset:1024 sc1
  buffer_load_dwordx4 v[32:35], v1, s[8:11], s72 offen offset:2048 sc1
  buffer_load_dwordx4 v[36:39], v1, s[8:11], s72 offen offset:3072 sc1
  buffer_load_dwordx4 v[40:43], v1, s[8:11], s73 offen offset:0 sc1
  buffer_load_dwordx4 v[44:47], v1, s[8:11], s73 offen offset:1024 sc1
  buffer_load_dwordx4 v[48:51], v1, s[8:11], s73 offen offset:2048 sc1
  buffer_load_dwordx4 v[52:55], v1, s[8:11], s73 offen offset:3072 sc1
  buffer_load_dwordx4 v[72:75], v1, s[8:11], s74 offen offset:0 sc1
  buffer_load_dwordx4 v[76:79], v1, s[8:11], s74 offen offset:1024 sc1
  buffer_load_dwordx4 v[80:83], v1, s[8:11], s74 offen offset:2048 sc1
  buffer_load_dwordx4 v[84:87], v1, s[8:11], s74 offen offset:3072 sc1
  buffer_load_dwordx4 v[88:91], v1, s[8:11], s75 offen offset:0 sc1
  buffer_load_dwordx4 v[92:95], v1, s[8:11], s75 offen offset:1024 sc1
  buffer_load_dwordx4 v[96:99], v1, s[8:11], s75 offen offset:2048 sc1
  buffer_load_dwordx4 v[100:103], v1, s[8:11], s75 offen offset:3072 sc1
  buffer_load_dwordx4 v[104:107], v1, s[8:11], s76 offen offset:0 sc1
  buffer_load_dwordx4 v[108:111], v1, s[8:11], s76 offen offset:1024 sc1
  buffer_load_dwordx4 v[112:115], v1, s[8:11], s76 offen offset:2048 sc1
  buffer_load_dwordx4 v[116:119], v1, s[8:11], s76 offen offset:3072 sc1
  buffer_load_dwordx4 v[120:123], v1, s[8:11], s77 offen offset:0 sc1
  buffer_load_dwordx4 v[124:127], v1, s[8:11], s77 offen offset:1024 sc1
  buffer_load_dwordx4 v[128:131], v1, s[8:11], s77 offen offset:2048 sc1
  buffer_load_dwordx4 v[132:135], v1, s[8:11], s77 offen offset:3072 sc1
  buffer_load_dwordx4 v[56:59], v1, s[8:11], s78 offen offset:0 sc1
  buffer_load_dwordx4 v[60:63], v1, s[8:11], s78 offen offset:1024 sc1
  buffer_load_dwordx4 v[64:67], v1, s[8:11], s78 offen offset:2048 sc1
  buffer_load_dwordx4 v[68:71], v1, s[8:11], s78 offen offset:3072 sc1
ow_go:
  s_waitcnt vmcnt(20)
  buffer_store_dword v16, v7, s[8:11], 0 offen sc1
  s_waitcnt vmcnt(20)
  v_smfmac_f32_16x16x64_bf16 v[20:23], v[72:75], a[0:7], v5
  s_waitcnt vmcnt(19)
  v_smfmac_f32_16x16x64_bf16 v[20:23], v[76:79], a[8:15], v5
  s_waitcnt vmcnt(18)
  v_smfmac_f32_16x16x64_bf16 v[20:23], v[80:83], a[16:23], v5
  s_waitcnt vmcnt(17)
  v_smfmac_f32_16x16x64_bf16 v[20:23], v[84:87], a[24:31], v5
  s_waitcnt vmcnt(16)
  v_smfmac_f32_16x16x64_bf16 v[20:23], v[88:91], a[32:39], v5
  s_waitcnt vmcnt(15)
  v_smfmac_f32_16x16x64_bf16 v[20:23], v[92:95], a[40:47], v5
  s_waitcnt vmcnt(14)
  v_smfmac_f32_16x16x64_bf16 v[20:23], v[96:99], a[48:55], v5
  s_waitcnt vmcnt(13)
  v_smfmac_f32_16x16x64_bf16 v[20:23], v[100:103], a[56:63], v5
  s_waitcnt vmcnt(12)
  v_smfmac_f32_16x16x64_bf16 v[20:23], v[104:107], a[64:71], v5
  s_waitcnt vmcnt(11)
  v_smfmac_f32_16x16x64_bf16 v[20:23], v[108:111], a[72:79], v5
  s_waitcnt vmcnt(10)
  v_smfmac_f32_16x16x64_bf16 v[20:23], v[112:115], a[80:87], v5
  s_waitcnt vmcnt(9)
  v_smfmac_f32_16x16x64_bf16 v[20:23], v[116:119], a[88:95], v5
  s_waitcnt vmcnt(8)
  v_smfmac_f32_16x16x64_bf16 v[20:23], v[120:123], a[96:103], v5
  s_waitcnt vmcnt(7)
  v_smfmac_f32_16x16x64_bf16 v[20:23], v[124:127], a[104:111], v5
  s_waitcnt vmcnt(6)
  v_smfmac_f32_16x16x64_bf16 v[20:23], v[128:131], a[112:119], v5
  s_waitcnt vmcnt(5)
  v_smfmac_f32_16x16x64_bf16 v[20:23], v[132:135], a[120:127], v5
  s_waitcnt vmcnt(4)
  v_smfmac_f32_16x16x64_bf16 v[20:23], v[56:59], v[24:31], v5
  s_waitcnt vmcnt(3)
  v_smfmac_f32_16x16x64_bf16 v[20:23], v[60:63], v[32:39], v5
  s_waitcnt vmcnt(2)
  v_smfmac_f32_16x16x64_bf16 v[20:23], v[64:67], v[40:47], v5
  s_waitcnt vmcnt(1)
  v_smfmac_f32_16x16x64_bf16 v[20:23], v[68:71], v[48:55], v5
  s_nop 7
  v_pk_add_f32 v[20:21], v[20:21], v[22:23]
  v_cmp_u_f32 vcc, v20, v21
  v_cvt_pk_bf16_f32 v10, v20, v21
  s_nop 1
  v_mov_b32_dpp v11, v10 quad_perm:[1,0,3,2] row_mask:0xf bank_mask:0xf
  v_perm_b32 v10, v11, v10, v4
  s_and_b64 vcc, vcc, s[16:17]
  s_cbranch_scc1 ow_redo
  buffer_store_dword v10, v3, s[8:11], s80 offen sc1
  buffer_store_dword v10, v3, s[8:11], s81 offen sc1
  buffer_store_dword v10, v3, s[8:11], s82 offen sc1
  buffer_store_dword v10, v3, s[8:11], s83 offen sc1
  s_barrier
  s_add_u32 s49, s52, 2
  s_cmp_lg_u32 s52, 0
  s_cbranch_scc1 ow_rung
  v_mov_b32 v16, 2
  buffer_store_dword v16, v7, s[8:11], 0 offen sc1
ow_rung:
  s_waitcnt vmcnt(0)
  ds_read_b32 v12, v17
  s_waitcnt lgkmcnt(0)
  v_readfirstlane_b32 s46, v12
  s_nop 0
  s_max_u32 s61, s61, s46
  s_cmp_ge_u32 s61, s49
  s_cbranch_scc1 wf_done_37
  s_mov_b32 s50, 0
wf_loop_38:
  buffer_load_dword v12, v9, s[8:11], 0 offen sc1
  s_add_u32 s50, s50, 1
  s_cmp_gt_u32 s50, 131072
  s_cbranch_scc1 L_fail
  s_waitcnt vmcnt(0)
  v_min_u32_dpp v12, v12, v12 row_ror:8 row_mask:0xf bank_mask:0xf
  s_nop 1
  v_min_u32_dpp v12, v12, v12 row_ror:4 row_mask:0xf bank_mask:0xf
  s_nop 1
  v_min_u32_dpp v12, v12, v12 row_ror:2 row_mask:0xf bank_mask:0xf
  s_nop 1
  v_min_u32_dpp v12, v12, v12 row_ror:1 row_mask:0xf bank_mask:0xf
  v_mov_b32 v13, v12
  s_nop 1
  v_permlane16_swap_b32 v13, v12
  v_min_u32 v12, v12, v13
  v_mov_b32 v13, v12
  s_nop 1
  v_permlane32_swap_b32 v13, v12
  v_min_u32 v12, v12, v13
  s_nop 0
  v_readfirstlane_b32 s61, v12
  s_nop 0
  s_cmp_ge_u32 s61, s49
  s_cbranch_scc1 wf_done_37
  s_sleep 2
  s_branch wf_loop_38
wf_done_37:
  s_mov_b32 s65, s63
  s_lshr_b32 s46, s65, 8
  s_and_b32 s46, s46, 0x2000
  s_xor_b32 s65, s65, s46
  s_add_u32 s63, s63, 2621440
  s_cmp_ge_u32 s63, 165675008
  s_cselect_b32 s46, 83886080, 0
  s_sub_u32 s63, s63, s46
  s_add_u32 s46, s65, 0
  s_xor_b32 s46, s46, 0x2000
  buffer_load_dwordx4 a[0:3], v1, s[8:11], s46 offen offset:0 sc1
  buffer_load_dwordx4 a[4:7], v1, s[8:11], s46 offen offset:1024 sc1
  buffer_load_dwordx4 a[8:11], v1, s[8:11], s46 offen offset:2048 sc1
  buffer_load_dwordx4 a[12:15], v1, s[8:11], s46 offen offset:3072 sc1
  s_add_u32 s46, s65, 4096
  s_xor_b32 s46, s46, 0x2000
  buffer_load_dwordx4 a[16:19], v1, s[8:11], s46 offen offset:0 sc1
  buffer_load_dwordx4 a[20:23], v1, s[8:11], s46 offen offset:1024 sc1
  buffer_load_dwordx4 a[24:27], v1, s[8:11], s46 offen offset:2048 sc1
  buffer_load_dwordx4 a[28:31], v1, s[8:11], s46 offen offset:3072 sc1
  s_add_u32 s46, s65, 16384
  buffer_load_dwordx4 a[32:35], v1, s[8:11], s46 offen offset:0 sc1
  buffer_load_dwordx4 a[36:39], v1, s[8:11], s46 offen offset:1024 sc1
  buffer_load_dwordx4 a[40:43], v1, s[8:11], s46 offen offset:2048 sc1
  buffer_load_dwordx4 a[44:47], v1, s[8:11], s46 offen offset:3072 sc1
  s_add_u32 s46, s65, 20480
  buffer_load_dwordx4 a[48:51], v1, s[8:11], s46 offen offset:0 sc1
  buffer_load_dwordx4 a[52:55], v1, s[8:11], s46 offen offset:1024 sc1
  buffer_load_dwordx4 a[56:59], v1, s[8:11], s46 offen offset:2048 sc1
  buffer_load_dwordx4 a[60:63], v1, s[8:11], s46 offen offset:3072 sc1
  s_add_u32 s46, s65, 32768
  buffer_load_dwordx4 a[64:67], v1, s[8:11], s46 offen offset:0 sc1
  buffer_load_dwordx4 a[68:71], v1, s[8:11], s46 offen offset:1024 sc1
  buffer_load_dwordx4 a[72:75], v1, s[8:11], s46 offen offset:2048 sc1
  buffer_load_dwordx4 a[76:79], v1, s[8:11], s46 offen offset:3072 sc1
  s_add_u32 s46, s65, 36864
  buffer_load_dwordx4 a[80:83], v1, s[8:11], s46 offen offset:0 sc1
  buffer_load_dwordx4 a[84:87], v1, s[8:11], s46 offen offset:1024 sc1
  buffer_load_dwordx4 a[88:91], v1, s[8:11], s46 offen offset:2048 sc1
  buffer_load_dwordx4 a[92:95], v1, s[8:11], s46 offen offset:3072 sc1
  s_add_u32 s46, s65, 49152
  buffer_load_dwordx4 a[96:99], v1, s[8:11], s46 offen offset:0 sc1
  buffer_load_dwordx4 a[100:103], v1, s[8:11], s46 offen offset:1024 sc1
  buffer_load_dwordx4 a[104:107], v1, s[8:11], s46 offen offset:2048 sc1
  buffer_load_dwordx4 a[108:111], v1, s[8:11], s46 offen offset:3072 sc1
  s_add_u32 s46, s65, 53248
  buffer_load_dwordx4 a[112:115], v1, s[8:11], s46 offen offset:0 sc1
  buffer_load_dwordx4 a[116:119], v1, s[8:11], s46 offen offset:1024 sc1
  buffer_load_dwordx4 a[120:123], v1, s[8:11], s46 offen offset:2048 sc1
  buffer_load_dwordx4 a[124:127], v1, s[8:11], s46 offen offset:3072 sc1
  v_mov_b32 v11, -1
  s_lshl_b32 s47, s58, 18
  s_add_u32 s46, s47, 0
  buffer_store_dword v11, v3, s[8:11], s46 offen sc1
  s_add_u32 s46, s47, 65536
  buffer_store_dword v11, v3, s[8:11], s46 offen sc1
  s_add_u32 s46, s47, 131072
  buffer_store_dword v11, v3, s[8:11], s46 offen sc1
  s_add_u32 s46, s47, 196608
  buffer_store_dword v11, v3, s[8:11], s46 offen sc1
  s_mov_b32 s58, s66
  s_cmp_eq_u32 s58, 0
  s_addc_u32 s54, s54, 0
  s_cmp_eq_u32 s54, 3
  s_cselect_b32 s54, 0, s54
  s_mov_b32 s52, s53
  s_cmp_lt_u32 s52, 63
  s_cbranch_scc1 ow_loop
  s_endpgm
ow_redo:
  s_mov_b32 s50, 0
ow_poll:
  buffer_load_dwordx4 v[24:27], v1, s[8:11], s72 offen offset:0 sc1
  buffer_load_dwordx4 v[28:31], v1, s[8:11], s72 offen offset:1024 sc1
  buffer_load_dwordx4 v[32:35], v1, s[8:11], s72 offen offset:2048 sc1
  buffer_load_dwordx4 v[36:39], v1, s[8:11], s72 offen offset:3072 sc1
  buffer_load_dwordx4 v[40:43], v1, s[8:11], s73 offen offset:0 sc1
  buffer_load_dwordx4 v[44:47], v1, s[8:11], s73 offen offset:1024 sc1
  buffer_load_dwordx4 v[48:51], v1, s[8:11], s73 offen offset:2048 sc1
  buffer_load_dwordx4 v[52:55], v1, s[8:11], s73 offen offset:3072 sc1
  buffer_load_dwordx4 v[72:75], v1, s[8:11], s74 offen offset:0 sc1
  buffer_load_dwordx4 v[76:79], v1, s[8:11], s74 offen offset:1024 sc1
  buffer_load_dwordx4 v[80:83], v1, s[8:11], s74 offen offset:2048 sc1
  buffer_load_dwordx4 v[84:87], v1, s[8:11], s74 offen offset:3072 sc1
  buffer_load_dwordx4 v[88:91], v1, s[8:11], s75 offen offset:0 sc1
  buffer_load_dwordx4 v[92:95], v1, s[8:11], s75 offen offset:1024 sc1
  buffer_load_dwordx4 v[96:99], v1, s[8:11], s75 offen offset:2048 sc1
  buffer_load_dwordx4 v[100:103], v1, s[8:11], s75 offen offset:3072 sc1
  buffer_load_dwordx4 v[104:107], v1, s[8:11], s76 offen offset:0 sc1
  buffer_load_dwordx4 v[108:111], v1, s[8:11], s76 offen offset:1024 sc1
  buffer_load_dwordx4 v[112:115], v1, s[8:11], s76 offen offset:2048 sc1
  buffer_load_dwordx4 v[116:119], v1, s[8:11], s76 offen offset:3072 sc1
  buffer_load_dwordx4 v[120:123], v1, s[8:11], s77 offen offset:0 sc1
  buffer_load_dwordx4 v[124:127], v1, s[8:11], s77 offen offset:1024 sc1
  buffer_load_dwordx4 v[128:131], v1, s[8:11], s77 offen offset:2048 sc1
  buffer_load_dwordx4 v[132:135], v1, s[8:11], s77 offen offset:3072 sc1
  buffer_load_dwordx4 v[56:59], v1, s[8:11], s78 offen offset:0 sc1
  buffer_load_dwordx4 v[60:63], v1, s[8:11], s78 offen offset:1024 sc1
  buffer_load_dwordx4 v[64:67], v1, s[8:11], s78 offen offset:2048 sc1
  buffer_load_dwordx4 v[68:71], v1, s[8:11], s78 offen offset:3072 sc1
  s_add_u32 s71, s71, 1
  s_cmp_le_u32 s71, 2
  s_cbranch_scc1 ow_again
  s_add_u32 s50, s50, 1
  s_cmp_gt_u32 s50, 131072
  s_cbranch_scc1 L_fail
  s_waitcnt vmcnt(0)
  v_max_u32 v8, v24, v25
  v_max3_u32 v8, v26, v27, v8
  v_max3_u32 v8, v28, v29, v8
  v_max3_u32 v8, v30, v31, v8
  v_max3_u32 v8, v32, v33, v8
  v_max3_u32 v8, v34, v35, v8
  v_max3_u32 v8, v36, v37, v8
  v_max3_u32 v8, v38, v39, v8
  v_max3_u32 v8, v40, v41, v8
  v_max3_u32 v8, v42, v43, v8
  v_max3_u32 v8, v44, v45, v8
  v_max3_u32 v8, v46, v47, v8
  v_max3_u32 v8, v48, v49, v8
  v_max3_u32 v8, v50, v51, v8
  v_max3_u32 v8, v52, v53, v8
  v_max3_u32 v8, v54, v55, v8
  v_max3_u32 v8, v56, v57, v8
  v_max3_u32 v8, v58, v59, v8
  v_max3_u32 v8, v60, v61, v8
  v_max3_u32 v8, v62, v63, v8
  v_max3_u32 v8, v64, v65, v8
  v_max3_u32 v8, v66, v67, v8
  v_max3_u32 v8, v68, v69, v8
  v_max3_u32 v8, v70, v71, v8
  v_max3_u32 v8, v72, v73, v8
  v_max3_u32 v8, v74, v75, v8
  v_max3_u32 v8, v76, v77, v8
  v_max3_u32 v8, v78, v79, v8
  v_max3_u32 v8, v80, v81, v8
  v_max3_u32 v8, v82, v83, v8
  v_max3_u32 v8, v84, v85, v8
  v_max3_u32 v8, v86, v87, v8
  v_max3_u32 v8, v88, v89, v8
  v_max3_u32 v8, v90, v91, v8
  v_max3_u32 v8, v92, v93, v8
  v_max3_u32 v8, v94, v95, v8
  v_max3_u32 v8, v96, v97, v8
  v_max3_u32 v8, v98, v99, v8
  v_max3_u32 v8, v100, v101, v8
  v_max3_u32 v8, v102, v103, v8
  v_max3_u32 v8, v104, v105, v8
  v_max3_u32 v8, v106, v107, v8
  v_max3_u32 v8, v108, v109, v8
  v_max3_u32 v8, v110, v111, v8
  v_max3_u32 v8, v112, v113, v8
  v_max3_u32 v8, v114, v115, v8
  v_max3_u32 v8, v116, v117, v8
  v_max3_u32 v8, v118, v119, v8
  v_max3_u32 v8, v120, v121, v8
  v_max3_u32 v8, v122, v123, v8
  v_max3_u32 v8, v124, v125, v8
  v_max3_u32 v8, v126, v127, v8
  v_max3_u32 v8, v128, v129, v8
  v_max3_u32 v8, v130, v131, v8
  v_max3_u32 v8, v132, v133, v8
  v_max3_u32 v8, v134, v135, v8
  v_cmp_eq_u32 vcc, -1, v8
  s_cbranch_vccnz ow_poll
  s_mov_b64 s[16:17], 0
ow_again:
  v_mov_b32 v20, 0
  v_mov_b32 v21, 0
  v_mov_b32 v22, 0
  v_mov_b32 v23, 0
  s_branch ow_go
L_xowner:
  s_mov_b32 s12, s36
  s_mov_b32 s13, s37
  s_mov_b32 s14, 5242880
  s_mov_b32 s15, 0x20000
  s_mov_b32 s50, 0
ss_39:
  v_and_b32 v11, 3, v0
  v_lshlrev_b32 v11, 2, v11
  global_load_dword v10, v11, s[38:39] sc1
  s_add_u32 s50, s50, 1
  s_cmp_gt_u32 s50, 131072
  s_cbranch_scc1 L_fail
  s_waitcnt vmcnt(0)
ss_39_in:
  v_readlane_b32 s46, v10, 0
  v_readlane_b32 s47, v10, 1
  v_readlane_b32 s48, v10, 0
  s_nop 0
  s_min_u32 s47, s47, s48
  s_cmp_lg_u32 s46, 0
  s_cselect_b32 s48, 7, 0
  s_add_u32 s46, s46, s2
  s_xor_b32 s49, s46, s43
  s_and_b32 s49, s49, s48
  s_cbranch_scc1 L_reroll
  s_cmp_lg_u32 s47, 0
  s_cbranch_scc1 ss_ok_40
  s_sleep 6
  s_branch ss_39
ss_ok_40:
  v_readlane_b32 s3, v10, 1
  s_nop 0
  s_and_b32 s3, s3, 0x2000
  s_lshr_b32 s46, s44, 4
  s_lshl_b32 s46, s46, 7
  s_lshl_b32 s47, s43, 4
  s_add_u32 s46, s46, s47
  s_and_b32 s47, s44, 15
  s_add_u32 s46, s46, s47
  s_lshl_b32 s46, s46, 7
  s_add_u32 s46, s46, s3
  s_add_u32 s46, s46, 13369344
  s_add_u32 s40, s8, s46
  s_addc_u32 s41, s9, 0
  s_sub_u32 s48, s44, 26
  s_and_b32 s46, s48, 1
  s_mul_i32 s46, s46, 5
  s_mul_i32 s62, s43, 10
  s_add_u32 s62, s62, s46
  s_lshr_b32 s52, s48, 1
  v_lshlrev_b32 v1, 4, v0
  v_and_b32 v10, 7, v0
  v_lshlrev_b32 v10, 7, v10
  v_add_u32 v10, s51, v10
  v_bfe_u32 v11, v0, 3, 2
  v_lshl_add_u32 v2, v11, 2, v10
  v_add_u32 v3, 1064960, v2
  v_add_u32 v2, 1060864, v2
  v_bfe_u32 v11, v0, 3, 1
  v_lshl_add_u32 v4, v11, 2, v10
  v_add_u32 v4, 1069056, v4
  v_cmp_lt_u32 vcc, 31, v0
  s_nop 1
  v_cndmask_b32 v3, v3, v4, vcc
  s_mul_i32 s46, s43, 6
  s_add_u32 s46, s46, s48
  s_lshl_b32 s46, s46, 7
  s_add_u32 s46, s46, 1073152
  v_mov_b32 v15, s46
  v_mov_b32 v11, 2146435072
  s_cmp_eq_u32 s42, 0
  s_cselect_b64 vcc, 1, 0
  v_cndmask_b32 v15, v11, v15, vcc
  s_mul_i32 s46, s42, 10240
  v_add_u32 v5, s46, v1
  v_add_u32 v6, s51, v1
  s_mul_i32 s63, s52, 40
  s_add_u32 s63, s63, s62
  s_lshl_b32 s63, s63, 16
  s_lshl_b32 s46, s42, 14
  s_add_u32 s63, s63, s46
  s_add_u32 s63, s63, s3
  s_add_u32 s63, s63, 81788928
  s_lshr_b32 s46, 1, s42
  s_and_b32 s46, s46, 1
  s_lshl_b32 s46, s46, 13
  s_xor_b32 s63, s63, s46
  s_lshl_b32 s65, s52, 18
  s_add_u32 s65, s65, s3
  s_add_u32 s65, s65, 14680064
  s_lshl_b32 s67, s62, 14
  s_lshl_b32 s46, s42, 11
  s_add_u32 s67, s67, s46
  s_mov_b32 s58, s52
  s_mul_i32 s66, s52, 81920
  v_and_b32 v10, 15, v0
  v_mul_u32_u24 v10, 2560, v10
  v_lshrrev_b32 v11, 4, v0
  v_lshl_add_u32 v10, v11, 3, v10
  s_add_u32 s46, s42, 0
  s_cmp_ge_u32 s46, 5
  s_cselect_b32 s47, 40800, 0
  s_add_u32 s48, s46, s62
  s_lshl_b32 s48, s48, 5
  s_add_u32 s47, s47, s48
  s_add_u32 s47, s47, 1280
  s_cmp_ge_u32 s46, 10
  s_cselect_b32 s47, 2146435072, s47
  v_add_u32 v7, s47, v10
  s_add_u32 s46, s42, 4
  s_cmp_ge_u32 s46, 5
  s_cselect_b32 s47, 40800, 0
  s_add_u32 s48, s46, s62
  s_lshl_b32 s48, s48, 5
  s_add_u32 s47, s47, s48
  s_add_u32 s47, s47, 1280
  s_cmp_ge_u32 s46, 10
  s_cselect_b32 s47, 2146435072, s47
  v_add_u32 v8, s47, v10
  s_add_u32 s46, s42, 8
  s_cmp_ge_u32 s46, 5
  s_cselect_b32 s47, 40800, 0
  s_add_u32 s48, s46, s62
  s_lshl_b32 s48, s48, 5
  s_add_u32 s47, s47, s48
  s_add_u32 s47, s47, 1280
  s_cmp_ge_u32 s46, 10
  s_cselect_b32 s47, 2146435072, s47
  v_add_u32 v9, s47, v10
  v_mov_b32 v224, -1
  v_mov_b32 v225, -1
  v_mov_b32 v226, -1
  v_mov_b32 v227, -1
  s_cmp_lg_u32 s42, 0
  s_cbranch_scc1 xo_clr
  s_mov_b32 s54, 0
xo_clr0:
  s_lshl_b32 s64, s54, 21
  s_mul_i32 s46, s58, 655360
  s_add_u32 s64, s64, s46
  s_add_u32 s64, s64, s3
  s_add_u32 s64, s64, 4194304
  s_lshr_b32 s46, s64, 8
  s_and_b32 s46, s46, 0x2000
  s_xor_b32 s64, s64, s46
  s_add_u32 s64, s64, s67
  s_add_u32 s46, s64, 0
  buffer_store_dwordx4 v[224:227], v1, s[8:11], s46 offen offset:0 sc1
  buffer_store_dwordx4 v[224:227], v1, s[8:11], s46 offen offset:1024 sc1
  buffer_store_dwordx4 v[224:227], v1, s[8:11], s46 offen offset:2048 sc1
  buffer_store_dwordx4 v[224:227], v1, s[8:11], s46 offen offset:3072 sc1
  s_add_u32 s46, s64, 4096
  buffer_store_dwordx4 v[224:227], v1, s[8:11], s46 offen offset:0 sc1
  buffer_store_dwordx4 v[224:227], v1, s[8:11], s46 offen offset:1024 sc1
  buffer_store_dwordx4 v[224:227], v1, s[8:11], s46 offen offset:2048 sc1
  buffer_store_dwordx4 v[224:227], v1, s[8:11], s46 offen offset:3072 sc1
  s_add_u32 s46, s64, 16384
  buffer_store_dwordx4 v[224:227], v1, s[8:11], s46 offen offset:0 sc1
  buffer_store_dwordx4 v[224:227], v1, s[8:11], s46 offen offset:1024 sc1
  buffer_store_dwordx4 v[224:227], v1, s[8:11], s46 offen offset:2048 sc1
  buffer_store_dwordx4 v[224:227], v1, s[8:11], s46 offen offset:3072 sc1
  s_add_u32 s46, s64, 20480
  buffer_store_dwordx4 v[224:227], v1, s[8:11], s46 offen offset:0 sc1
  buffer_store_dwordx4 v[224:227], v1, s[8:11], s46 offen offset:1024 sc1
  buffer_store_dwordx4 v[224:227], v1, s[8:11], s46 offen offset:2048 sc1
  buffer_store_dwordx4 v[224:227], v1, s[8:11], s46 offen offset:3072 sc1
  s_add_u32 s46, s64, 32768
  buffer_store_dwordx4 v[224:227], v1, s[8:11], s46 offen offset:0 sc1
  buffer_store_dwordx4 v[224:227], v1, s[8:11], s46 offen offset:1024 sc1
  buffer_store_dwordx4 v[224:227], v1, s[8:11], s46 offen offset:2048 sc1
  buffer_store_dwordx4 v[224:227], v1, s[8:11], s46 offen offset:3072 sc1
  s_add_u32 s46, s64, 36864
  buffer_store_dwordx4 v[224:227], v1, s[8:11], s46 offen offset:0 sc1
  buffer_store_dwordx4 v[224:227], v1, s[8:11], s46 offen offset:1024 sc1
  buffer_store_dwordx4 v[224:227], v1, s[8:11], s46 offen offset:2048 sc1
  buffer_store_dwordx4 v[224:227], v1, s[8:11], s46 offen offset:3072 sc1
  s_add_u32 s46, s64, 49152
  buffer_store_dwordx4 v[224:227], v1, s[8:11], s46 offen offset:0 sc1
  buffer_store_dwordx4 v[224:227], v1, s[8:11], s46 offen offset:1024 sc1
  buffer_store_dwordx4 v[224:227], v1, s[8:11], s46 offen offset:2048 sc1
  buffer_store_dwordx4 v[224:227], v1, s[8:11], s46 offen offset:3072 sc1
  s_add_u32 s46, s64, 53248
  buffer_store_dwordx4 v[224:227], v1, s[8:11], s46 offen offset:0 sc1
  buffer_store_dwordx4 v[224:227], v1, s[8:11], s46 offen offset:1024 sc1
  buffer_store_dwordx4 v[224:227], v1, s[8:11], s46 offen offset:2048 sc1
  buffer_store_dwordx4 v[224:227], v1, s[8:11], s46 offen offset:3072 sc1
  s_add_u32 s46, s64, 65536
  buffer_store_dwordx4 v[224:227], v1, s[8:11], s46 offen offset:0 sc1
  buffer_store_dwordx4 v[224:227], v1, s[8:11], s46 offen offset:1024 sc1
  buffer_store_dwordx4 v[224:227], v1, s[8:11], s46 offen offset:2048 sc1
  buffer_store_dwordx4 v[224:227], v1, s[8:11], s46 offen offset:3072 sc1
  s_add_u32 s46, s64, 69632
  buffer_store_dwordx4 v[224:227], v1, s[8:11], s46 offen offset:0 sc1
  buffer_store_dwordx4 v[224:227], v1, s[8:11], s46 offen offset:1024 sc1
  buffer_store_dwordx4 v[224:227], v1, s[8:11], s46 offen offset:2048 sc1
  buffer_store_dwordx4 v[224:227], v1, s[8:11], s46 offen offset:3072 sc1
  s_waitcnt vmcnt(20)
  s_add_u32 s54, s54, 1
  s_cmp_lt_u32 s54, 3
  s_cbranch_scc1 xo_clr0
xo_clr:
  s_mov_b32 s50, 0
ss_41:
  v_and_b32 v11, 3, v0
  v_lshlrev_b32 v11, 2, v11
  global_load_dword v10, v11, s[38:39] sc1
  s_add_u32 s50, s50, 1
  s_cmp_gt_u32 s50, 131072
  s_cbranch_scc1 L_fail
  s_waitcnt vmcnt(0)
ss_41_in:
  v_readlane_b32 s46, v10, 0
  v_readlane_b32 s47, v10, 2
  v_readlane_b32 s48, v10, 1
  s_nop 0
  s_min_u32 s47, s47, s48
  s_cmp_lg_u32 s46, 0
  s_cselect_b32 s48, 7, 0
  s_add_u32 s46, s46, s2
  s_xor_b32 s49, s46, s43
  s_and_b32 s49, s49, s48
  s_cbranch_scc1 L_reroll
  s_cmp_lg_u32 s47, 0
  s_cbranch_scc1 ss_ok_42
  s_sleep 6
  s_branch ss_41
ss_ok_42:
  v_readlane_b32 s3, v10, 1
  s_nop 0
  s_and_b32 s3, s3, 0x2000
  s_add_u32 s46, s52, 6
  v_mov_b32 v10, s46
  s_waitcnt vmcnt(0)
  buffer_store_dword v10, v15, s[8:11], 0 offen sc1
  s_mov_b32 s60, 0
  s_mov_b32 s61, 0
  s_mov_b32 s54, 0
  v_lshlrev_b32 v228, 7, v0
xo_loop:
  s_add_u32 s53, s52, 1
  s_cmp_ge_u32 s60, s53
  s_cbranch_scc1 wf_done_43
  s_mov_b32 s50, 0
wf_loop_44:
  buffer_load_dword v10, v2, s[8:11], 0 offen sc1
  s_add_u32 s50, s50, 1
  s_cmp_gt_u32 s50, 131072
  s_cbranch_scc1 L_fail
  s_waitcnt vmcnt(0)
  v_min_u32_dpp v10, v10, v10 row_ror:8 row_mask:0xf bank_mask:0xf
  s_nop 1
  v_min_u32_dpp v10, v10, v10 row_ror:4 row_mask:0xf bank_mask:0xf
  s_nop 1
  v_min_u32_dpp v10, v10, v10 row_ror:2 row_mask:0xf bank_mask:0xf
  s_nop 1
  v_min_u32_dpp v10, v10, v10 row_ror:1 row_mask:0xf bank_mask:0xf
  v_mov_b32 v11, v10
  s_nop 1
  v_permlane16_swap_b32 v11, v10
  v_min_u32 v10, v10, v11
  v_mov_b32 v11, v10
  s_nop 1
  v_permlane32_swap_b32 v11, v10
  v_min_u32 v10, v10, v11
  s_nop 0
  v_readfirstlane_b32 s60, v10
  s_nop 0
  s_cmp_ge_u32 s60, s53
  s_cbranch_scc1 wf_done_43
  s_sleep 2
  s_branch wf_loop_44
wf_done_43:
  s_add_u32 s46, s63, 0
  s_lshr_b32 s47, s46, 8
  s_and_b32 s47, s47, 0x2000
  s_xor_b32 s46, s46, s47
  buffer_load_dwordx4 a[0:3], v1, s[8:11], s46 offen offset:0 sc1
  buffer_load_dwordx4 a[4:7], v1, s[8:11], s46 offen offset:1024 sc1
  buffer_load_dwordx4 a[8:11], v1, s[8:11], s46 offen offset:2048 sc1
  buffer_load_dwordx4 a[12:15], v1, s[8:11], s46 offen offset:3072 sc1
  s_add_u32 s46, s46, 4096
  buffer_load_dwordx4 a[16:19], v1, s[8:11], s46 offen offset:0 sc1
  buffer_load_dwordx4 a[20:23], v1, s[8:11], s46 offen offset:1024 sc1
  buffer_load_dwordx4 a[24:27], v1, s[8:11], s46 offen offset:2048 sc1
  buffer_load_dwordx4 a[28:31], v1, s[8:11], s46 offen offset:3072 sc1
  s_add_u32 s46, s63, 65536
  s_lshr_b32 s47, s46, 8
  s_and_b32 s47, s47, 0x2000
  s_xor_b32 s46, s46, s47
  buffer_load_dwordx4 a[32:35], v1, s[8:11], s46 offen offset:0 sc1
  buffer_load_dwordx4 a[36:39], v1, s[8:11], s46 offen offset:1024 sc1
  buffer_load_dwordx4 a[40:43], v1, s[8:11], s46 offen offset:2048 sc1
  buffer_load_dwordx4 a[44:47], v1, s[8:11], s46 offen offset:3072 sc1
  s_add_u32 s46, s46, 4096
  buffer_load_dwordx4 a[48:51], v1, s[8:11], s46 offen offset:0 sc1
  buffer_load_dwordx4 a[52:55], v1, s[8:11], s46 offen offset:1024 sc1
  buffer_load_dwordx4 a[56:59], v1, s[8:11], s46 offen offset:2048 sc1
  buffer_load_dwordx4 a[60:63], v1, s[8:11], s46 offen offset:3072 sc1
  s_add_u32 s46, s63, 131072
  s_lshr_b32 s47, s46, 8
  s_and_b32 s47, s47, 0x2000
  s_xor_b32 s46, s46, s47
  buffer_load_dwordx4 a[64:67], v1, s[8:11], s46 offen offset:0 sc1
  buffer_load_dwordx4 a[68:71], v1, s[8:11], s46 offen offset:1024 sc1
  buffer_load_dwordx4 a[72:75], v1, s[8:11], s46 offen offset:2048 sc1
  buffer_load_dwordx4 a[76:79], v1, s[8:11], s46 offen offset:3072 sc1
  s_add_u32 s46, s46, 4096
  buffer_load_dwordx4 a[80:83], v1, s[8:11], s46 offen offset:0 sc1
  buffer_load_dwordx4 a[84:87], v1, s[8:11], s46 offen offset:1024 sc1
  buffer_load_dwordx4 a[88:91], v1, s[8:11], s46 offen offset:2048 sc1
  buffer_load_dwordx4 a[92:95], v1, s[8:11], s46 offen offset:3072 sc1
  s_add_u32 s46, s63, 196608
  s_lshr_b32 s47, s46, 8
  s_and_b32 s47, s47, 0x2000
  s_xor_b32 s46, s46, s47
  buffer_load_dwordx4 a[96:99], v1, s[8:11], s46 offen offset:0 sc1
  buffer_load_dwordx4 a[100:103], v1, s[8:11], s46 offen offset:1024 sc1
  buffer_load_dwordx4 a[104:107], v1, s[8:11], s46 offen offset:2048 sc1
  buffer_load_dwordx4 a[108:111], v1, s[8:11], s46 offen offset:3072 sc1
  s_add_u32 s46, s46, 4096
  buffer_load_dwordx4 a[112:115], v1, s[8:11], s46 offen offset:0 sc1
  buffer_load_dwordx4 a[116:119], v1, s[8:11], s46 offen offset:1024 sc1
  buffer_load_dwordx4 a[120:123], v1, s[8:11], s46 offen offset:2048 sc1
  buffer_load_dwordx4 a[124:127], v1, s[8:11], s46 offen offset:3072 sc1
  s_add_u32 s46, s63, 262144
  s_lshr_b32 s47, s46, 8
  s_and_b32 s47, s47, 0x2000
  s_xor_b32 s46, s46, s47
  buffer_load_dwordx4 a[128:131], v1, s[8:11], s46 offen offset:0 sc1
  buffer_load_dwordx4 a[132:135], v1, s[8:11], s46 offen offset:1024 sc1
  buffer_load_dwordx4 a[136:139], v1, s[8:11], s46 offen offset:2048 sc1
  buffer_load_dwordx4 a[140:143], v1, s[8:11], s46 offen offset:3072 sc1
  s_add_u32 s46, s46, 4096
  buffer_load_dwordx4 a[144:147], v1, s[8:11], s46 offen offset:0 sc1
  buffer_load_dwordx4 a[148:151], v1, s[8:11], s46 offen offset:1024 sc1
  buffer_load_dwordx4 a[152:155], v1, s[8:11], s46 offen offset:2048 sc1
  buffer_load_dwordx4 a[156:159], v1, s[8:11], s46 offen offset:3072 sc1
  s_waitcnt vmcnt(24)
  s_cmp_ge_u32 s52, 62
  s_cbranch_scc1 xo_last
  s_cmp_lg_u32 s42, 0
  s_cbranch_scc1 xo_go
  s_mov_b32 s50, 0
box_45:
  s_load_dword s80, s[40:41], 0 glc
  s_add_u32 s50, s50, 1
  s_cmp_gt_u32 s50, 131072
  s_cbranch_scc1 L_fail
  s_waitcnt lgkmcnt(0)
  s_cmp_lt_u32 s80, s53
  s_cbranch_scc1 box_45
  s_branch xo_go
xo_last:
  s_mov_b32 s53, 64
  s_mov_b32 s61, 0
  s_cmp_ge_u32 s61, s53
  s_cbranch_scc1 wf_done_47
  s_mov_b32 s50, 0
wf_loop_48:
  buffer_load_dword v10, v3, s[8:11], 0 offen sc1
  s_add_u32 s50, s50, 1
  s_cmp_gt_u32 s50, 131072
  s_cbranch_scc1 L_fail
  s_waitcnt vmcnt(0)
  v_min_u32_dpp v10, v10, v10 row_ror:8 row_mask:0xf bank_mask:0xf
  s_nop 1
  v_min_u32_dpp v10, v10, v10 row_ror:4 row_mask:0xf bank_mask:0xf
  s_nop 1
  v_min_u32_dpp v10, v10, v10 row_ror:2 row_mask:0xf bank_mask:0xf
  s_nop 1
  v_min_u32_dpp v10, v10, v10 row_ror:1 row_mask:0xf bank_mask:0xf
  v_mov_b32 v11, v10
  s_nop 1
  v_permlane16_swap_b32 v11, v10
  v_min_u32 v10, v10, v11
  v_mov_b32 v11, v10
  s_nop 1
  v_permlane32_swap_b32 v11, v10
  v_min_u32 v10, v10, v11
  s_nop 0
  v_readfirstlane_b32 s61, v10
  s_nop 0
  s_cmp_ge_u32 s61, s53
  s_cbranch_scc1 wf_done_47
  s_sleep 2
  s_branch wf_loop_48
wf_done_47:
xo_go:
  s_barrier
  s_lshl_b32 s64, s54, 21
  s_mul_i32 s46, s58, 655360
  s_add_u32 s64, s64, s46
  s_add_u32 s64, s64, s3
  s_add_u32 s64, s64, 4194304
  s_lshr_b32 s46, s64, 8
  s_and_b32 s46, s46, 0x2000
  s_xor_b32 s64, s64, s46
  s_add_u32 s64, s64, s67
  s_mov_b32 s49, s65
  s_lshr_b32 s46, s49, 8
  s_and_b32 s46, s46, 0x2000
  s_xor_b32 s49, s49, s46
  s_lshl_b32 s47, s42, 14
  s_add_u32 s47, s47, s49
  s_lshl_b32 s48, s42, 11
  s_add_u32 s48, s48, s49
  s_add_u32 s46, s47, 0
  buffer_load_dwordx4 v[56:59], v1, s[8:11], s46 offen sc1
  s_add_u32 s46, s47, 81920
  buffer_load_dwordx4 v[60:63], v1, s[8:11], s46 offen sc1
  s_add_u32 s46, s47, 1024
  buffer_load_dwordx4 v[64:67], v1, s[8:11], s46 offen sc1
  s_add_u32 s46, s47, 82944
  buffer_load_dwordx4 v[68:71], v1, s[8:11], s46 offen sc1
  s_add_u32 s46, s47, 2048
  buffer_load_dwordx4 v[72:75], v1, s[8:11], s46 offen sc1
  s_add_u32 s46, s47, 83968
  buffer_load_dwordx4 v[76:79], v1, s[8:11], s46 offen sc1
  s_add_u32 s46, s47, 3072
  buffer_load_dwordx4 v[80:83], v1, s[8:11], s46 offen sc1
  s_add_u32 s46, s47, 84992
  buffer_load_dwordx4 v[84:87], v1, s[8:11], s46 offen sc1
  s_add_u32 s46, s47, 4096
  buffer_load_dwordx4 v[88:91], v1, s[8:11], s46 offen sc1
  s_add_u32 s46, s47, 86016
  buffer_load_dwordx4 v[92:95], v1, s[8:11], s46 offen sc1
  s_add_u32 s46, s47, 5120
  buffer_load_dwordx4 v[96:99], v1, s[8:11], s46 offen sc1
  s_add_u32 s46, s47, 87040
  buffer_load_dwordx4 v[100:103], v1, s[8:11], s46 offen sc1
  s_add_u32 s46, s47, 6144
  buffer_load_dwordx4 v[104:107], v1, s[8:11], s46 offen sc1
  s_add_u32 s46, s47, 88064
  buffer_load_dwordx4 v[108:111], v1, s[8:11], s46 offen sc1
  s_add_u32 s46, s47, 7168
  buffer_load_dwordx4 v[112:115], v1, s[8:11], s46 offen sc1
  s_add_u32 s46, s47, 89088
  buffer_load_dwordx4 v[116:119], v1, s[8:11], s46 offen sc1
  s_add_u32 s46, s48, 65536
  buffer_load_dwordx4 v[120:123], v1, s[8:11], s46 offen sc1
  s_add_u32 s46, s48, 147456
  buffer_load_dwordx4 v[124:127], v1, s[8:11], s46 offen sc1
  s_add_u32 s46, s48, 66560
  buffer_load_dwordx4 v[128:131], v1, s[8:11], s46 offen sc1
  s_add_u32 s46, s48, 148480
  buffer_load_dwordx4 v[132:135], v1, s[8:11], s46 offen sc1
  s_add_u32 s46, s64, 0
  buffer_load_dwordx4 v[16:19], v1, s[8:11], s46 offen offset:0 sc1
  buffer_load_dwordx4 v[20:23], v1, s[8:11], s46 offen offset:1024 sc1
  s_add_u32 s46, s64, 16384
  buffer_load_dwordx4 v[24:27], v1, s[8:11], s46 offen offset:0 sc1
  buffer_load_dwordx4 v[28:31], v1, s[8:11], s46 offen offset:1024 sc1
  s_add_u32 s46, s64, 32768
  buffer_load_dwordx4 v[32:35], v1, s[8:11], s46 offen offset:0 sc1
  buffer_load_dwordx4 v[36:39], v1, s[8:11], s46 offen offset:1024 sc1
  s_add_u32 s46, s64, 49152
  buffer_load_dwordx4 v[40:43], v1, s[8:11], s46 offen offset:0 sc1
  buffer_load_dwordx4 v[44:47], v1, s[8:11], s46 offen offset:1024 sc1
  s_add_u32 s46, s64, 65536
  buffer_load_dwordx4 v[48:51], v1, s[8:11], s46 offen offset:0 sc1
  buffer_load_dwordx4 v[52:55], v1, s[8:11], s46 offen offset:1024 sc1
  s_waitcnt vmcnt(29)
  v_mfma_f32_16x16x32_bf16 v[136:139], a[0:3], v[56:59], 0
  v_mfma_f32_16x16x32_bf16 v[140:143], a[32:35], v[56:59], 0
  v_mfma_f32_16x16x32_bf16 v[144:147], a[64:67], v[56:59], 0
  v_mfma_f32_16x16x32_bf16 v[148:151], a[96:99], v[56:59], 0
  v_mfma_f32_16x16x32_bf16 v[152:155], a[128:131], v[56:59], 0
  s_waitcnt vmcnt(28)
  v_mfma_f32_16x16x32_bf16 v[156:159], a[0:3], v[60:63], 0
  v_mfma_f32_16x16x32_bf16 v[160:163], a[32:35], v[60:63], 0
  v_mfma_f32_16x16x32_bf16 v[164:167], a[64:67], v[60:63], 0
  v_mfma_f32_16x16x32_bf16 v[168:171], a[96:99], v[60:63], 0
  v_mfma_f32_16x16x32_bf16 v[172:175], a[128:131], v[60:63], 0
  s_waitcnt vmcnt(27)
  v_mfma_f32_16x16x32_bf16 v[136:139], a[4:7], v[64:67], v[136:139]
  v_mfma_f32_16x16x32_bf16 v[140:143], a[36:39], v[64:67], v[140:143]
  v_mfma_f32_16x16x32_bf16 v[144:147], a[68:71], v[64:67], v[144:147]
  v_mfma_f32_16x16x32_bf16 v[148:151], a[100:103], v[64:67], v[148:151]
  v_mfma_f32_16x16x32_bf16 v[152:155], a[132:135], v[64:67], v[152:155]
  s_waitcnt vmcnt(26)
  v_mfma_f32_16x16x32_bf16 v[156:159], a[4:7], v[68:71], v[156:159]
  v_mfma_f32_16x16x32_bf16 v[160:163], a[36:39], v[68:71], v[160:163]
  v_mfma_f32_16x16x32_bf16 v[164:167], a[68:71], v[68:71], v[164:167]
  v_mfma_f32_16x16x32_bf16 v[168:171], a[100:103], v[68:71], v[168:171]
  v_mfma_f32_16x16x32_bf16 v[172:175], a[132:135], v[68:71], v[172:175]
  s_waitcnt vmcnt(25)
  v_mfma_f32_16x16x32_bf16 v[136:139], a[8:11], v[72:75], v[136:139]
  v_mfma_f32_16x16x32_bf16 v[140:143], a[40:43], v[72:75], v[140:143]
  v_mfma_f32_16x16x32_bf16 v[144:147], a[72:75], v[72:75], v[144:147]
  v_mfma_f32_16x16x32_bf16 v[148:151], a[104:107], v[72:75], v[148:151]
  v_mfma_f32_16x16x32_bf16 v[152:155], a[136:139], v[72:75], v[152:155]
  s_waitcnt vmcnt(24)
  v_mfma_f32_16x16x32_bf16 v[156:159], a[8:11], v[76:79], v[156:159]
  v_mfma_f32_16x16x32_bf16 v[160:163], a[40:43], v[76:79], v[160:163]
  v_mfma_f32_16x16x32_bf16 v[164:167], a[72:75], v[76:79], v[164:167]
  v_mfma_f32_16x16x32_bf16 v[168:171], a[104:107], v[76:79], v[168:171]
  v_mfma_f32_16x16x32_bf16 v[172:175], a[136:139], v[76:79], v[172:175]
  s_waitcnt vmcnt(23)
  v_mfma_f32_16x16x32_bf16 v[136:139], a[12:15], v[80:83], v[136:139]
  v_mfma_f32_16x16x32_bf16 v[140:143], a[44:47], v[80:83], v[140:143]
  v_mfma_f32_16x16x32_bf16 v[144:147], a[76:79], v[80:83], v[144:147]
  v_mfma_f32_16x16x32_bf16 v[148:151], a[108:111], v[80:83], v[148:151]
  v_mfma_f32_16x16x32_bf16 v[152:155], a[140:143], v[80:83], v[152:155]
  s_waitcnt vmcnt(22)
  v_mfma_f32_16x16x32_bf16 v[156:159], a[12:15], v[84:87], v[156:159]
  v_mfma_f32_16x16x32_bf16 v[160:163], a[44:47], v[84:87], v[160:163]
  v_mfma_f32_16x16x32_bf16 v[164:167], a[76:79], v[84:87], v[164:167]
  v_mfma_f32_16x16x32_bf16 v[168:171], a[108:111], v[84:87], v[168:171]
  v_mfma_f32_16x16x32_bf16 v[172:175], a[140:143], v[84:87], v[172:175]
  s_waitcnt vmcnt(21)
  v_mfma_f32_16x16x32_bf16 v[136:139], a[16:19], v[88:91], v[136:139]
  v_mfma_f32_16x16x32_bf16 v[140:143], a[48:51], v[88:91], v[140:143]
  v_mfma_f32_16x16x32_bf16 v[144:147], a[80:83], v[88:91], v[144:147]
  v_mfma_f32_16x16x32_bf16 v[148:151], a[112:115], v[88:91], v[148:151]
  v_mfma_f32_16x16x32_bf16 v[152:155], a[144:147], v[88:91], v[152:155]
  s_waitcnt vmcnt(20)
  v_mfma_f32_16x16x32_bf16 v[156:159], a[16:19], v[92:95], v[156:159]
  v_mfma_f32_16x16x32_bf16 v[160:163], a[48:51], v[92:95], v[160:163]
  v_mfma_f32_16x16x32_bf16 v[164:167], a[80:83], v[92:95], v[164:167]
  v_mfma_f32_16x16x32_bf16 v[168:171], a[112:115], v[92:95], v[168:171]
  v_mfma_f32_16x16x32_bf16 v[172:175], a[144:147], v[92:95], v[172:175]
  s_waitcnt vmcnt(19)
  v_mfma_f32_16x16x32_bf16 v[136:139], a[20:23], v[96:99], v[136:139]
  v_mfma_f32_16x16x32_bf16 v[140:143], a[52:55], v[96:99], v[140:143]
  v_mfma_f32_16x16x32_bf16 v[144:147], a[84:87], v[96:99], v[144:147]
  v_mfma_f32_16x16x32_bf16 v[148:151], a[116:119], v[96:99], v[148:151]
  v_mfma_f32_16x16x32_bf16 v[152:155], a[148:151], v[96:99], v[152:155]
  s_waitcnt vmcnt(18)
  v_mfma_f32_16x16x32_bf16 v[156:159], a[20:23], v[100:103], v[156:159]
  v_mfma_f32_16x16x32_bf16 v[160:163], a[52:55], v[100:103], v[160:163]
  v_mfma_f32_16x16x32_bf16 v[164:167], a[84:87], v[100:103], v[164:167]
  v_mfma_f32_16x16x32_bf16 v[168:171], a[116:119], v[100:103], v[168:171]
  v_mfma_f32_16x16x32_bf16 v[172:175], a[148:151], v[100:103], v[172:175]
  s_waitcnt vmcnt(17)
  v_mfma_f32_16x16x32_bf16 v[136:139], a[24:27], v[104:107], v[136:139]
  v_mfma_f32_16x16x32_bf16 v[140:143], a[56:59], v[104:107], v[140:143]
  v_mfma_f32_16x16x32_bf16 v[144:147], a[88:91], v[104:107], v[144:147]
  v_mfma_f32_16x16x32_bf16 v[148:151], a[120:123], v[104:107], v[148:151]
  v_mfma_f32_16x16x32_bf16 v[152:155], a[152:155], v[104:107], v[152:155]
  s_waitcnt vmcnt(16)
  v_mfma_f32_16x16x32_bf16 v[156:159], a[24:27], v[108:111], v[156:159]
  v_mfma_f32_16x16x32_bf16 v[160:163], a[56:59], v[108:111], v[160:163]
  v_mfma_f32_16x16x32_bf16 v[164:167], a[88:91], v[108:111], v[164:167]
  v_mfma_f32_16x16x32_bf16 v[168:171], a[120:123], v[108:111], v[168:171]
  v_mfma_f32_16x16x32_bf16 v[172:175], a[152:155], v[108:111], v[172:175]
  s_waitcnt vmcnt(15)
  v_mfma_f32_16x16x32_bf16 v[136:139], a[28:31], v[112:115], v[136:139]
  v_mfma_f32_16x16x32_bf16 v[140:143], a[60:63], v[112:115], v[140:143]
  v_mfma_f32_16x16x32_bf16 v[144:147], a[92:95], v[112:115], v[144:147]
  v_mfma_f32_16x16x32_bf16 v[148:151], a[124:127], v[112:115], v[148:151]
  v_mfma_f32_16x16x32_bf16 v[152:155], a[156:159], v[112:115], v[152:155]
  s_waitcnt vmcnt(14)
  v_mfma_f32_16x16x32_bf16 v[156:159], a[28:31], v[116:119], v[156:159]
  v_mfma_f32_16x16x32_bf16 v[160:163], a[60:63], v[116:119], v[160:163]
  v_mfma_f32_16x16x32_bf16 v[164:167], a[92:95], v[116:119], v[164:167]
  v_mfma_f32_16x16x32_bf16 v[168:171], a[124:127], v[116:119], v[168:171]
  v_mfma_f32_16x16x32_bf16 v[172:175], a[156:159], v[116:119], v[172:175]
  s_waitcnt vmcnt(8)
  v_mfma_f32_16x16x32_bf16 v[136:139], v[16:19], v[120:123], v[136:139]
  v_mfma_f32_16x16x32_bf16 v[156:159], v[16:19], v[124:127], v[156:159]
  v_mfma_f32_16x16x32_bf16 v[136:139], v[20:23], v[128:131], v[136:139]
  v_mfma_f32_16x16x32_bf16 v[156:159], v[20:23], v[132:135], v[156:159]
  s_waitcnt vmcnt(6)
  v_mfma_f32_16x16x32_bf16 v[140:143], v[24:27], v[120:123], v[140:143]
  v_mfma_f32_16x16x32_bf16 v[160:163], v[24:27], v[124:127], v[160:163]
  v_mfma_f32_16x16x32_bf16 v[140:143], v[28:31], v[128:131], v[140:143]
  v_mfma_f32_16x16x32_bf16 v[160:163], v[28:31], v[132:135], v[160:163]
  s_waitcnt vmcnt(4)
  v_mfma_f32_16x16x32_bf16 v[144:147], v[32:35], v[120:123], v[144:147]
  v_mfma_f32_16x16x32_bf16 v[164:167], v[32:35], v[124:127], v[164:167]
  v_mfma_f32_16x16x32_bf16 v[144:147], v[36:39], v[128:131], v[144:147]
  v_mfma_f32_16x16x32_bf16 v[164:167], v[36:39], v[132:135], v[164:167]
  s_waitcnt vmcnt(2)
  v_mfma_f32_16x16x32_bf16 v[148:151], v[40:43], v[120:123], v[148:151]
  v_mfma_f32_16x16x32_bf16 v[168:171], v[40:43], v[124:127], v[168:171]
  v_mfma_f32_16x16x32_bf16 v[148:151], v[44:47], v[128:131], v[148:151]
  v_mfma_f32_16x16x32_bf16 v[168:171], v[44:47], v[132:135], v[168:171]
  s_waitcnt vmcnt(0)
  v_mfma_f32_16x16x32_bf16 v[152:155], v[48:51], v[120:123], v[152:155]
  v_mfma_f32_16x16x32_bf16 v[172:175], v[48:51], v[124:127], v[172:175]
  v_mfma_f32_16x16x32_bf16 v[152:155], v[52:55], v[128:131], v[152:155]
  v_mfma_f32_16x16x32_bf16 v[172:175], v[52:55], v[132:135], v[172:175]
  s_cmp_ge_u32 s52, 55
  s_cbranch_scc1 xo_nop
  s_add_u32 s46, s64, 0
  buffer_store_dwordx4 v[224:227], v1, s[8:11], s46 offen offset:0 sc1
  buffer_store_dwordx4 v[224:227], v1, s[8:11], s46 offen offset:1024 sc1
  s_add_u32 s46, s64, 16384
  buffer_store_dwordx4 v[224:227], v1, s[8:11], s46 offen offset:0 sc1
  buffer_store_dwordx4 v[224:227], v1, s[8:11], s46 offen offset:1024 sc1
  s_add_u32 s46, s64, 32768
  buffer_store_dwordx4 v[224:227], v1, s[8:11], s46 offen offset:0 sc1
  buffer_store_dwordx4 v[224:227], v1, s[8:11], s46 offen offset:1024 sc1
  s_add_u32 s46, s64, 49152
  buffer_store_dwordx4 v[224:227], v1, s[8:11], s46 offen offset:0 sc1
  buffer_store_dwordx4 v[224:227], v1, s[8:11], s46 offen offset:1024 sc1
  s_add_u32 s46, s64, 65536
  buffer_store_dwordx4 v[224:227], v1, s[8:11], s46 offen offset:0 sc1
  buffer_store_dwordx4 v[224:227], v1, s[8:11], s46 offen offset:1024 sc1
xo_nop:
  ds_write_b128 v5, v[136:139] offset:0
  ds_write_b128 v5, v[140:143] offset:1024
  ds_write_b128 v5, v[144:147] offset:2048
  ds_write_b128 v5, v[148:151] offset:3072
  s_nop 0
  ds_write_b128 v5, v[152:155] offset:4096
  ds_write_b128 v5, v[156:159] offset:5120
  ds_write_b128 v5, v[160:163] offset:6144
  ds_write_b128 v5, v[164:167] offset:7168
  ds_write_b128 v5, v[168:171] offset:8192
  ds_write_b128 v5, v[172:175] offset:9216
  s_waitcnt lgkmcnt(0)
  s_barrier
  ds_read_b128 v[176:179], v6 offset:0
  ds_read_b128 v[180:183], v6 offset:10240
  ds_read_b128 v[184:187], v6 offset:20480
  ds_read_b128 v[188:191], v6 offset:30720
  ds_read_b128 v[192:195], v6 offset:4096
  ds_read_b128 v[196:199], v6 offset:14336
  ds_read_b128 v[200:203], v6 offset:24576
  ds_read_b128 v[204:207], v6 offset:34816
  ds_read_b128 v[208:211], v6 offset:8192
  ds_read_b128 v[212:215], v6 offset:18432
  ds_read_b128 v[216:219], v6 offset:28672
  ds_read_b128 v[220:223], v6 offset:38912
  s_waitcnt lgkmcnt(8)
  v_add_f32 v176, v176, v180
  v_add_f32 v184, v184, v188
  v_add_f32 v176, v176, v184
  v_add_f32 v177, v177, v181
  v_add_f32 v185, v185, v189
  v_add_f32 v177, v177, v185
  v_add_f32 v178, v178, v182
  v_add_f32 v186, v186, v190
  v_add_f32 v178, v178, v186
  v_add_f32 v179, v179, v183
  v_add_f32 v187, v187, v191
  v_add_f32 v179, v179, v187
  v_cvt_pk_bf16_f32 v176, v176, v177
  v_cvt_pk_bf16_f32 v177, v178, v179
  buffer_store_dwordx2 v[176:177], v7, s[12:15], s66 offen
  s_waitcnt lgkmcnt(4)
  v_add_f32 v192, v192, v196
  v_add_f32 v200, v200, v204
  v_add_f32 v192, v192, v200
  v_add_f32 v193, v193, v197
  v_add_f32 v201, v201, v205
  v_add_f32 v193, v193, v201
  v_add_f32 v194, v194, v198
  v_add_f32 v202, v202, v206
  v_add_f32 v194, v194, v202
  v_add_f32 v195, v195, v199
  v_add_f32 v203, v203, v207
  v_add_f32 v195, v195, v203
  v_cvt_pk_bf16_f32 v192, v192, v193
  v_cvt_pk_bf16_f32 v193, v194, v195
  buffer_store_dwordx2 v[192:193], v8, s[12:15], s66 offen
  s_waitcnt lgkmcnt(0)
  v_add_f32 v208, v208, v212
  v_add_f32 v216, v216, v220
  v_add_f32 v208, v208, v216
  v_add_f32 v209, v209, v213
  v_add_f32 v217, v217, v221
  v_add_f32 v209, v209, v217
  v_add_f32 v210, v210, v214
  v_add_f32 v218, v218, v222
  v_add_f32 v210, v210, v218
  v_add_f32 v211, v211, v215
  v_add_f32 v219, v219, v223
  v_add_f32 v211, v211, v219
  v_cvt_pk_bf16_f32 v208, v208, v209
  v_cvt_pk_bf16_f32 v209, v210, v211
  buffer_store_dwordx2 v[208:209], v9, s[12:15], s66 offen
  s_cmp_ge_u32 s52, 61
  s_cbranch_scc1 xo_end
  s_add_u32 s46, s52, 9
  v_mov_b32 v10, s46
  s_waitcnt vmcnt(0)
  s_barrier
  buffer_store_dword v10, v15, s[8:11], 0 offen sc1
  s_add_u32 s54, s54, 1
  s_cmp_eq_u32 s54, 3
  s_cselect_b32 s54, 0, s54
  s_add_u32 s63, s63, 7864320
  s_cmp_ge_u32 s63, 165675008
  s_cselect_b32 s46, 83886080, 0
  s_sub_u32 s63, s63, s46
  s_add_u32 s65, s65, 786432
  s_cmp_ge_u32 s65, 16777216
  s_cselect_b32 s46, 2097152, 0
  s_sub_u32 s65, s65, s46
  s_add_u32 s66, s66, 245760
  s_add_u32 s52, s52, 3
  s_cmp_lt_u32 s52, 64
  s_cbranch_scc1 xo_loop
xo_end:
  s_endpgm
L_end:
  s_endpgm
L_fail:
  s_mov_b32 s4, s38
  s_mov_b32 s5, s39
  s_mov_b32 s6, 256
  s_mov_b32 s7, 0x20000
  s_lshl_b32 s46, s43, 8
  s_or_b32 s46, s46, s44
  s_or_b32 s46, s46, 0x10000
  v_mov_b32 v1, 32
  v_mov_b32 v2, s46
  s_mov_b64 exec, 1
  buffer_store_dword v2, v1, s[4:7], 0 offen sc1
  s_waitcnt vmcnt(0)
  s_endpgm
.section .rodata,"a"
.p2align 6
.amdhsa_kernel concat_heads__sliding_local_dilated__memory_aug_recurrent_mem_tr__prompt_kernel
  .amdhsa_next_free_vgpr 512
  .amdhsa_next_free_sgpr 102
  .amdhsa_accum_offset 256
  .amdhsa_group_segment_fixed_size 0
  .amdhsa_kernarg_size 104
  .amdhsa_user_sgpr_count 2
  .amdhsa_user_sgpr_kernarg_segment_ptr 1
  .amdhsa_system_sgpr_workgroup_id_x 1
.end_amdhsa_kernel
```

```asm
; @launch kernel=concat_heads__sliding_local_dilated__memory_aug_recurrent_mem_tr__prompt_kernel grid=(256,1,1) block=(256,1,1) lds=163840
.amdgcn_target "amdgcn-amd-amdhsa--gfx950"
.text
.globl concat_heads__sliding_local_dilated__memory_aug_recurrent_mem_tr__prompt_kernel
.p2align 8
.type concat_heads__sliding_local_dilated__memory_aug_recurrent_mem_tr__prompt_kernel,@function
concat_heads__sliding_local_dilated__memory_aug_recurrent_mem_tr__prompt_kernel:
  s_cmp_ge_u32 s2, 256
  s_cbranch_scc1 L_end
  v_lshrrev_b32 v1, 6, v0
  v_and_b32 v0, 63, v0
  v_readfirstlane_b32 s42, v1
  s_getreg_b32 s46, hwreg(HW_REG_XCC_ID)
  s_lshr_b32 s44, s2, 3
  s_lshl_b32 s51, s42, 10
  s_mov_b32 s3, 0
  s_mov_b32 s50, -1
  s_branch L_first
L_reroll:
  s_waitcnt vmcnt(0) lgkmcnt(0)
  s_barrier
L_first:
  s_load_dwordx16 s[16:31], s[0:1], 0
  s_load_dwordx8 s[32:39], s[0:1], 64
  s_load_dwordx2 s[40:41], s[0:1], 96
  s_and_b32 s43, s46, 7
  s_and_b32 s46, s44, 7
  s_lshl_b32 s46, s46, 0
  s_and_b32 s47, s43, 3
  s_lshl_b32 s47, s47, 3
  s_add_u32 s45, s46, s47
  s_waitcnt lgkmcnt(0)
  s_add_u32 s8, s40, 0x1fffff
  s_addc_u32 s9, s41, 0
  s_and_b32 s8, s8, 0xffe00000
  s_mov_b32 s10, 266338304
  s_mov_b32 s11, 0x20000
  s_mov_b32 s4, s38
  s_mov_b32 s5, s39
  s_mov_b32 s6, 256
  s_mov_b32 s7, 0x20000
  s_mov_b32 s12, s22
  s_mov_b32 s13, s23
  s_mov_b32 s14, 2621440
  s_mov_b32 s15, 0x20000
  s_or_b32 s46, s2, s42
  s_cbranch_scc1 L_norot
  v_mov_b32 v1, 0
  s_or_b32 s46, s43, 8
  v_mov_b32 v2, s46
  buffer_store_dword v2, v1, s[4:7], 0 offen sc1
L_norot:
  s_cmp_lg_u32 s50, -1
  s_cbranch_scc1 pr_skip
  s_lshr_b32 s46, s2, 4
  s_cmp_lg_u32 s46, 13
  s_cbranch_scc1 pr_skip
  s_cmp_lg_u32 s42, 0
  s_cbranch_scc1 pr_skip
  v_lshlrev_b32 v1, 2, v0
  s_mov_b32 s66, 0x10000
  s_cmp_ge_u32 s43, 4
  s_cbranch_scc1 pr_report
  s_lshl_b32 s62, s43, 14
  s_and_b32 s46, s44, 1
  s_lshl_b32 s46, s46, 12
  s_add_u32 s62, s62, s46
  s_add_u32 s62, s62, 6160384
  s_add_u32 s65, s62, 8192
  buffer_store_dword v1, v1, s[8:11], s62 offen sc1
  buffer_store_dword v1, v1, s[8:11], s65 offen sc1
  s_mov_b32 s63, -1
  s_mov_b32 s64, -1
  s_waitcnt vmcnt(0)
  s_memtime s[72:73]
  s_waitcnt lgkmcnt(0)
  buffer_store_dword v1, v1, s[8:11], s62 offen sc1
  s_waitcnt vmcnt(0)
  s_memtime s[74:75]
  s_waitcnt lgkmcnt(0)
  s_sub_u32 s46, s74, s72
  s_min_u32 s63, s63, s46
  s_memtime s[72:73]
  s_waitcnt lgkmcnt(0)
  buffer_store_dword v1, v1, s[8:11], s65 offen sc1
  s_waitcnt vmcnt(0)
  s_memtime s[74:75]
  s_waitcnt lgkmcnt(0)
  s_sub_u32 s46, s74, s72
  s_min_u32 s64, s64, s46
  s_memtime s[72:73]
  s_waitcnt lgkmcnt(0)
  buffer_store_dword v1, v1, s[8:11], s62 offen sc1
  s_waitcnt vmcnt(0)
  s_memtime s[74:75]
  s_waitcnt lgkmcnt(0)
  s_sub_u32 s46, s74, s72
  s_min_u32 s63, s63, s46
  s_memtime s[72:73]
  s_waitcnt lgkmcnt(0)
  buffer_store_dword v1, v1, s[8:11], s65 offen sc1
  s_waitcnt vmcnt(0)
  s_memtime s[74:75]
  s_waitcnt lgkmcnt(0)
  s_sub_u32 s46, s74, s72
  s_min_u32 s64, s64, s46
  s_memtime s[72:73]
  s_waitcnt lgkmcnt(0)
  buffer_store_dword v1, v1, s[8:11], s62 offen sc1
  s_waitcnt vmcnt(0)
  s_memtime s[74:75]
  s_waitcnt lgkmcnt(0)
  s_sub_u32 s46, s74, s72
  s_min_u32 s63, s63, s46
  s_memtime s[72:73]
  s_waitcnt lgkmcnt(0)
  buffer_store_dword v1, v1, s[8:11], s65 offen sc1
  s_waitcnt vmcnt(0)
  s_memtime s[74:75]
  s_waitcnt lgkmcnt(0)
  s_sub_u32 s46, s74, s72
  s_min_u32 s64, s64, s46
  s_cmp_lt_u32 s64, s63
  s_cselect_b32 s46, 0x100, 1
  s_min_u32 s47, s63, s64
  s_cmp_lt_u32 s47, 600
  s_cselect_b32 s47, 4, 0
  s_lshl_b32 s46, s46, s47
  s_add_u32 s66, s66, s46
pr_report:
  v_mov_b32 v3, s66
  s_mov_b64 exec, 1
  global_atomic_add v2, v1, v3, s[38:39] offset:128 sc0 sc1
  s_waitcnt vmcnt(0)
  v_readfirstlane_b32 s46, v2
  s_nop 0
  s_add_u32 s46, s46, s66
  s_cmp_lt_u32 s46, 0x100000
  s_cbranch_scc1 pr_done
  s_bfe_u32 s47, s46, 0x80008
  s_and_b32 s46, s46, 0xff
  s_cmp_gt_u32 s47, s46
  s_cselect_b32 s46, 0x2001, 1
  v_mov_b32 v2, s46
  global_store_dword v1, v2, s[38:39] offset:4 sc1
pr_done:
  s_mov_b64 exec, -1
pr_skip:
  s_cmp_lt_u32 s43, 4
  s_cbranch_scc1 L_recur
  s_cmp_ge_u32 s44, 24
  s_cbranch_scc1 L_uw
  s_lshr_b32 s48, s44, 3
  s_cmp_lg_u32 s48, 0
  s_cbranch_scc1 L_noholdq
  s_mov_b32 s50, 0
ss_1:
  v_and_b32 v3, 3, v0
  v_lshlrev_b32 v3, 2, v3
  global_load_dword v2, v3, s[38:39] sc1
  s_add_u32 s50, s50, 1
  s_cmp_gt_u32 s50, 131072
  s_cbranch_scc1 L_fail
  s_waitcnt vmcnt(0)
ss_1_in:
  v_readlane_b32 s46, v2, 0
  v_readlane_b32 s47, v2, 2
  v_readlane_b32 s48, v2, 1
  s_nop 0
  s_min_u32 s47, s47, s48
  s_cmp_lg_u32 s46, 0
  s_cselect_b32 s48, 7, 0
  s_add_u32 s46, s46, s2
  s_xor_b32 s49, s46, s43
  s_and_b32 s49, s49, s48
  s_cbranch_scc1 L_reroll
  s_cmp_lg_u32 s47, 0
  s_cbranch_scc1 ss_ok_2
  s_sleep 6
  s_branch ss_1
ss_ok_2:
  v_readlane_b32 s3, v2, 1
  s_nop 0
  s_and_b32 s3, s3, 0x2000
L_noholdq:
  s_lshr_b32 s48, s44, 3
  s_cmp_eq_u32 s48, 0
  s_cselect_b32 s4, s26, s28
  s_cselect_b32 s5, s27, s29
  s_cmp_eq_u32 s48, 2
  s_cselect_b32 s4, s30, s4
  s_cselect_b32 s5, s31, s5
  s_mov_b32 s6, 7864320
  s_mul_i32 s60, s45, 384
  s_mov_b32 s61, 0
  s_mov_b32 s62, 64
  s_cselect_b32 s63, 136314880, 0
  s_add_u32 s63, s63, 31457280
  s_cmp_lg_u32 s48, 1
  s_cselect_b32 s46, 0x2000, 0
  s_add_u32 s63, s63, s46
  s_mov_b32 s67, s45
  s_lshl_b32 s64, s48, 5
  s_add_u32 s64, s64, s45
  s_lshl_b32 s64, s64, 7
  s_add_u32 s64, s64, 1048576
  v_lshrrev_b32 v10, 3, v0
  v_lshrrev_b32 v11, 2, v10
  v_lshlrev_b32 v11, 3, v11
  v_and_b32 v1, 3, v10
  v_add_u32 v1, v1, v11
  s_and_b32 s46, s42, 1
  s_lshl_b32 s46, s46, 2
  s_lshr_b32 s47, s42, 1
  s_lshl_b32 s47, s47, 4
  s_add_u32 s46, s46, s47
  v_add_u32 v1, s46, v1
  v_mul_u32_u24 v1, 12288, v1
  v_lshrrev_b32 v10, 1, v10
  v_bfe_u32 v11, v0, 1, 2
  v_xor_b32 v10, v10, v11
  v_lshlrev_b32 v10, 5, v10
  v_and_b32 v11, 1, v0
  v_lshlrev_b32 v11, 4, v11
  v_add3_u32 v1, v1, v10, v11
  v_lshrrev_b32 v10, 5, v0
  v_lshlrev_b32 v2, 11, v10
  v_bfe_u32 v10, v0, 2, 3
  v_lshl_add_u32 v2, v10, 7, v2
  v_lshrrev_b32 v10, 1, v10
  v_xor_b32 v10, s42, v10
  v_lshl_add_u32 v2, v10, 5, v2
  v_and_b32 v10, 3, v0
  v_lshl_add_u32 v2, v10, 3, v2
  v_add_u32 v3, 0x10000, v2
  v_add_u32 v4, 0x20000, v2
  v_lshrrev_b32 v10, 3, v0
  s_lshl_b32 s46, s42, 3
  v_add_u32 v10, s46, v10
  v_mul_u32_u24 v5, 1280, v10
  v_bfe_u32 v10, v10, 1, 3
  v_and_b32 v11, 7, v0
  v_xor_b32 v10, v10, v11
  v_lshl_add_u32 v5, v10, 4, v5
  v_and_b32 v10, 15, v0
  v_lshlrev_b32 v6, 7, v10
  v_lshrrev_b32 v10, 1, v10
  v_lshrrev_b32 v11, 4, v0
  v_xor_b32 v10, v10, v11
  v_lshl_add_u32 v6, v10, 4, v6
  v_add_u32 v6, 122880, v6
  v_xor_b32 v7, 64, v6
  v_and_b32 v10, 15, v0
  v_lshlrev_b32 v8, 4, v10
  v_bfe_u32 v10, v0, 4, 1
  v_lshlrev_b32 v10, 11, v10
  v_lshrrev_b32 v11, 5, v0
  v_lshlrev_b32 v11, 8, v11
  v_add3_u32 v8, v8, v10, v11
  s_lshl_b32 s46, s42, 9
  v_add_u32 v8, s46, v8
  v_mov_b32 v9, s64
  v_mov_b32 v10, 2146435072
  s_cmp_eq_u32 s42, 0
  s_cselect_b64 vcc, 1, 0
  v_cndmask_b32 v9, v10, v9, vcc
  s_lshl_b32 s46, s43, 7
  s_add_u32 s46, s46, 1076736
  v_mov_b32 v14, s46
  s_mov_b32 s68, 0
  s_lshr_b32 s70, s44, 5
  s_add_u32 s70, s70, 8
  s_mov_b32 s52, s61
  s_mul_i32 s53, s52, 40960
  s_add_u32 s54, s51, 122880
  s_add_u32 m0, s54, 0
  s_nop 0
  buffer_load_dwordx4 v5, s[12:15], s53 offen offset:0 lds
  s_add_u32 m0, s54, 3968
  s_nop 0
  buffer_load_dwordx4 v5, s[12:15], s53 offen offset:128 lds
  s_add_u32 m0, s54, 7936
  s_nop 0
  buffer_load_dwordx4 v5, s[12:15], s53 offen offset:256 lds
  s_add_u32 m0, s54, 11904
  s_nop 0
  buffer_load_dwordx4 v5, s[12:15], s53 offen offset:384 lds
  s_add_u32 m0, s54, 15872
  s_nop 0
  buffer_load_dwordx4 v5, s[12:15], s53 offen offset:512 lds
  s_add_u32 m0, s54, 19840
  s_nop 0
  buffer_load_dwordx4 v5, s[12:15], s53 offen offset:640 lds
  s_add_u32 m0, s54, 23808
  s_nop 0
  buffer_load_dwordx4 v5, s[12:15], s53 offen offset:768 lds
  s_add_u32 m0, s54, 27776
  s_nop 0
  buffer_load_dwordx4 v5, s[12:15], s53 offen offset:896 lds
  s_add_u32 m0, s54, 31744
  s_nop 0
  buffer_load_dwordx4 v5, s[12:15], s53 offen offset:1024 lds
  s_add_u32 m0, s54, 35712
  s_nop 0
  buffer_load_dwordx4 v5, s[12:15], s53 offen offset:1152 lds
  s_add_u32 m0, s51, 0
  s_add_u32 s46, s60, 0
  buffer_load_dwordx4 v1, s[4:7], s46 offen  lds
  s_add_u32 m0, s51, 4096
  s_add_u32 s46, s60, 128
  buffer_load_dwordx4 v1, s[4:7], s46 offen  lds
  s_add_u32 m0, s51, 8192
  s_add_u32 s46, s60, 256
  buffer_load_dwordx4 v1, s[4:7], s46 offen  lds
  s_add_u32 m0, s51, 12288
  s_add_u32 s46, s60, 393216
  buffer_load_dwordx4 v1, s[4:7], s46 offen  lds
  s_add_u32 m0, s51, 16384
  s_add_u32 s46, s60, 393344
  buffer_load_dwordx4 v1, s[4:7], s46 offen  lds
  s_add_u32 m0, s51, 20480
  s_add_u32 s46, s60, 393472
  buffer_load_dwordx4 v1, s[4:7], s46 offen  lds
  s_add_u32 m0, s51, 24576
  s_add_u32 s46, s60, 786432
  buffer_load_dwordx4 v1, s[4:7], s46 offen  lds
  s_add_u32 m0, s51, 28672
  s_add_u32 s46, s60, 786560
  buffer_load_dwordx4 v1, s[4:7], s46 offen  lds
  s_add_u32 m0, s51, 32768
  s_add_u32 s46, s60, 786688
  buffer_load_dwordx4 v1, s[4:7], s46 offen  lds
  s_add_u32 m0, s51, 36864
  s_add_u32 s46, s60, 1179648
  buffer_load_dwordx4 v1, s[4:7], s46 offen  lds
  s_add_u32 m0, s51, 40960
  s_add_u32 s46, s60, 1179776
  buffer_load_dwordx4 v1, s[4:7], s46 offen  lds
  s_add_u32 m0, s51, 45056
  s_add_u32 s46, s60, 1179904
  buffer_load_dwordx4 v1, s[4:7], s46 offen  lds
  s_add_u32 m0, s51, 49152
  s_add_u32 s46, s60, 1572864
  buffer_load_dwordx4 v1, s[4:7], s46 offen  lds
  s_add_u32 m0, s51, 53248
  s_add_u32 s46, s60, 1572992
  buffer_load_dwordx4 v1, s[4:7], s46 offen  lds
  s_add_u32 m0, s51, 57344
  s_add_u32 s46, s60, 1573120
  buffer_load_dwordx4 v1, s[4:7], s46 offen  lds
  s_add_u32 m0, s51, 61440
  s_add_u32 s46, s60, 1966080
  buffer_load_dwordx4 v1, s[4:7], s46 offen  lds
  s_add_u32 m0, s51, 65536
  s_add_u32 s46, s60, 1966208
  buffer_load_dwordx4 v1, s[4:7], s46 offen  lds
  s_add_u32 m0, s51, 69632
  s_add_u32 s46, s60, 1966336
  buffer_load_dwordx4 v1, s[4:7], s46 offen  lds
  s_add_u32 m0, s51, 73728
  s_add_u32 s46, s60, 2359296
  buffer_load_dwordx4 v1, s[4:7], s46 offen  lds
  s_add_u32 m0, s51, 77824
  s_add_u32 s46, s60, 2359424
  buffer_load_dwordx4 v1, s[4:7], s46 offen  lds
  s_add_u32 m0, s51, 81920
  s_add_u32 s46, s60, 2359552
  buffer_load_dwordx4 v1, s[4:7], s46 offen  lds
  s_add_u32 m0, s51, 86016
  s_add_u32 s46, s60, 2752512
  buffer_load_dwordx4 v1, s[4:7], s46 offen  lds
  s_add_u32 m0, s51, 90112
  s_add_u32 s46, s60, 2752640
  buffer_load_dwordx4 v1, s[4:7], s46 offen  lds
  s_add_u32 m0, s51, 94208
  s_add_u32 s46, s60, 2752768
  buffer_load_dwordx4 v1, s[4:7], s46 offen  lds
  s_waitcnt vmcnt(18)
  s_barrier
  s_add_u32 m0, s51, 98304
  s_add_u32 s46, s60, 3145728
  buffer_load_dwordx4 v1, s[4:7], s46 offen  lds
  s_add_u32 m0, s51, 102400
  s_add_u32 s46, s60, 3145856
  buffer_load_dwordx4 v1, s[4:7], s46 offen  lds
  s_add_u32 m0, s51, 106496
  s_add_u32 s46, s60, 3145984
  buffer_load_dwordx4 v1, s[4:7], s46 offen  lds
  s_add_u32 m0, s51, 110592
  s_add_u32 s46, s60, 3538944
  buffer_load_dwordx4 v1, s[4:7], s46 offen  lds
  s_add_u32 m0, s51, 114688
  s_add_u32 s46, s60, 3539072
  buffer_load_dwordx4 v1, s[4:7], s46 offen  lds
  s_add_u32 m0, s51, 118784
  s_add_u32 s46, s60, 3539200
  buffer_load_dwordx4 v1, s[4:7], s46 offen  lds
  ds_read_b64_tr_b16 a[0:1], v2 offset:0
  ds_read_b64_tr_b16 a[2:3], v2 offset:1024
  ds_read_b64_tr_b16 a[4:5], v2 offset:4096
  ds_read_b64_tr_b16 a[6:7], v2 offset:5120
  ds_read_b64_tr_b16 a[8:9], v2 offset:8192
  ds_read_b64_tr_b16 a[10:11], v2 offset:9216
  ds_read_b64_tr_b16 a[12:13], v2 offset:12288
  ds_read_b64_tr_b16 a[14:15], v2 offset:13312
  ds_read_b64_tr_b16 a[16:17], v2 offset:16384
  ds_read_b64_tr_b16 a[18:19], v2 offset:17408
  ds_read_b64_tr_b16 a[20:21], v2 offset:20480
  ds_read_b64_tr_b16 a[22:23], v2 offset:21504
  s_waitcnt lgkmcnt(0)
  s_waitcnt vmcnt(18)
  s_barrier
  s_add_u32 m0, s51, 0
  s_add_u32 s46, s60, 3932160
  buffer_load_dwordx4 v1, s[4:7], s46 offen  lds
  s_add_u32 m0, s51, 4096
  s_add_u32 s46, s60, 3932288
  buffer_load_dwordx4 v1, s[4:7], s46 offen  lds
  s_add_u32 m0, s51, 8192
  s_add_u32 s46, s60, 3932416
  buffer_load_dwordx4 v1, s[4:7], s46 offen  lds
  s_add_u32 m0, s51, 12288
  s_add_u32 s46, s60, 4325376
  buffer_load_dwordx4 v1, s[4:7], s46 offen  lds
  s_add_u32 m0, s51, 16384
  s_add_u32 s46, s60, 4325504
  buffer_load_dwordx4 v1, s[4:7], s46 offen  lds
  s_add_u32 m0, s51, 20480
  s_add_u32 s46, s60, 4325632
  buffer_load_dwordx4 v1, s[4:7], s46 offen  lds
  ds_read_b64_tr_b16 a[24:25], v2 offset:24576
  ds_read_b64_tr_b16 a[26:27], v2 offset:25600
  ds_read_b64_tr_b16 a[28:29], v2 offset:28672
  ds_read_b64_tr_b16 a[30:31], v2 offset:29696
  ds_read_b64_tr_b16 a[32:33], v2 offset:32768
  ds_read_b64_tr_b16 a[34:35], v2 offset:33792
  ds_read_b64_tr_b16 a[36:37], v2 offset:36864
  ds_read_b64_tr_b16 a[38:39], v2 offset:37888
  ds_read_b64_tr_b16 a[40:41], v2 offset:40960
  ds_read_b64_tr_b16 a[42:43], v2 offset:41984
  ds_read_b64_tr_b16 a[44:45], v2 offset:45056
  ds_read_b64_tr_b16 a[46:47], v2 offset:46080
  s_waitcnt lgkmcnt(0)
  s_waitcnt vmcnt(18)
  s_barrier
  s_add_u32 m0, s51, 24576
  s_add_u32 s46, s60, 4718592
  buffer_load_dwordx4 v1, s[4:7], s46 offen  lds
  s_add_u32 m0, s51, 28672
  s_add_u32 s46, s60, 4718720
  buffer_load_dwordx4 v1, s[4:7], s46 offen  lds
  s_add_u32 m0, s51, 32768
  s_add_u32 s46, s60, 4718848
  buffer_load_dwordx4 v1, s[4:7], s46 offen  lds
  s_add_u32 m0, s51, 36864
  s_add_u32 s46, s60, 5111808
  buffer_load_dwordx4 v1, s[4:7], s46 offen  lds
  s_add_u32 m0, s51, 40960
  s_add_u32 s46, s60, 5111936
  buffer_load_dwordx4 v1, s[4:7], s46 offen  lds
  s_add_u32 m0, s51, 45056
  s_add_u32 s46, s60, 5112064
  buffer_load_dwordx4 v1, s[4:7], s46 offen  lds
  ds_read_b64_tr_b16 a[48:49], v2 offset:49152
  ds_read_b64_tr_b16 a[50:51], v2 offset:50176
  ds_read_b64_tr_b16 a[52:53], v2 offset:53248
  ds_read_b64_tr_b16 a[54:55], v2 offset:54272
  ds_read_b64_tr_b16 a[56:57], v2 offset:57344
  ds_read_b64_tr_b16 a[58:59], v2 offset:58368
  ds_read_b64_tr_b16 a[60:61], v2 offset:61440
  ds_read_b64_tr_b16 a[62:63], v2 offset:62464
  ds_read_b64_tr_b16 a[64:65], v3 offset:0
  ds_read_b64_tr_b16 a[66:67], v3 offset:1024
  ds_read_b64_tr_b16 a[68:69], v3 offset:4096
  ds_read_b64_tr_b16 a[70:71], v3 offset:5120
  s_waitcnt lgkmcnt(0)
  s_waitcnt vmcnt(18)
  s_barrier
  s_add_u32 m0, s51, 49152
  s_add_u32 s46, s60, 5505024
  buffer_load_dwordx4 v1, s[4:7], s46 offen  lds
  s_add_u32 m0, s51, 53248
  s_add_u32 s46, s60, 5505152
  buffer_load_dwordx4 v1, s[4:7], s46 offen  lds
  s_add_u32 m0, s51, 57344
  s_add_u32 s46, s60, 5505280
  buffer_load_dwordx4 v1, s[4:7], s46 offen  lds
  s_add_u32 m0, s51, 61440
  s_add_u32 s46, s60, 5898240
  buffer_load_dwordx4 v1, s[4:7], s46 offen  lds
  s_add_u32 m0, s51, 65536
  s_add_u32 s46, s60, 5898368
  buffer_load_dwordx4 v1, s[4:7], s46 offen  lds
  s_add_u32 m0, s51, 69632
  s_add_u32 s46, s60, 5898496
  buffer_load_dwordx4 v1, s[4:7], s46 offen  lds
  ds_read_b64_tr_b16 a[72:73], v3 offset:8192
  ds_read_b64_tr_b16 a[74:75], v3 offset:9216
  ds_read_b64_tr_b16 a[76:77], v3 offset:12288
  ds_read_b64_tr_b16 a[78:79], v3 offset:13312
  ds_read_b64_tr_b16 a[80:81], v3 offset:16384
  ds_read_b64_tr_b16 a[82:83], v3 offset:17408
  ds_read_b64_tr_b16 a[84:85], v3 offset:20480
  ds_read_b64_tr_b16 a[86:87], v3 offset:21504
  ds_read_b64_tr_b16 a[88:89], v3 offset:24576
  ds_read_b64_tr_b16 a[90:91], v3 offset:25600
  ds_read_b64_tr_b16 a[92:93], v3 offset:28672
  ds_read_b64_tr_b16 a[94:95], v3 offset:29696
  s_waitcnt lgkmcnt(0)
  s_waitcnt vmcnt(18)
  s_barrier
  s_add_u32 m0, s51, 73728
  s_add_u32 s46, s60, 6291456
  buffer_load_dwordx4 v1, s[4:7], s46 offen  lds
  s_add_u32 m0, s51, 77824
  s_add_u32 s46, s60, 6291584
  buffer_load_dwordx4 v1, s[4:7], s46 offen  lds
  s_add_u32 m0, s51, 81920
  s_add_u32 s46, s60, 6291712
  buffer_load_dwordx4 v1, s[4:7], s46 offen  lds
  s_add_u32 m0, s51, 86016
  s_add_u32 s46, s60, 6684672
  buffer_load_dwordx4 v1, s[4:7], s46 offen  lds
  s_add_u32 m0, s51, 90112
  s_add_u32 s46, s60, 6684800
  buffer_load_dwordx4 v1, s[4:7], s46 offen  lds
  s_add_u32 m0, s51, 94208
  s_add_u32 s46, s60, 6684928
  buffer_load_dwordx4 v1, s[4:7], s46 offen  lds
  ds_read_b64_tr_b16 a[96:97], v3 offset:32768
  ds_read_b64_tr_b16 a[98:99], v3 offset:33792
  ds_read_b64_tr_b16 a[100:101], v3 offset:36864
  ds_read_b64_tr_b16 a[102:103], v3 offset:37888
  ds_read_b64_tr_b16 a[104:105], v3 offset:40960
  ds_read_b64_tr_b16 a[106:107], v3 offset:41984
  ds_read_b64_tr_b16 a[108:109], v3 offset:45056
  ds_read_b64_tr_b16 a[110:111], v3 offset:46080
  ds_read_b64_tr_b16 a[112:113], v3 offset:49152
  ds_read_b64_tr_b16 a[114:115], v3 offset:50176
  ds_read_b64_tr_b16 a[116:117], v3 offset:53248
  ds_read_b64_tr_b16 a[118:119], v3 offset:54272
  s_waitcnt lgkmcnt(0)
  s_waitcnt vmcnt(18)
  s_barrier
  v_and_b32 v11, 3, v0
  v_lshlrev_b32 v11, 2, v11
  global_load_dword v10, v11, s[38:39] sc1
  s_add_u32 m0, s51, 98304
  s_add_u32 s46, s60, 7077888
  buffer_load_dwordx4 v1, s[4:7], s46 offen  lds
  s_add_u32 m0, s51, 102400
  s_add_u32 s46, s60, 7078016
  buffer_load_dwordx4 v1, s[4:7], s46 offen  lds
  s_add_u32 m0, s51, 106496
  s_add_u32 s46, s60, 7078144
  buffer_load_dwordx4 v1, s[4:7], s46 offen  lds
  s_add_u32 m0, s51, 110592
  s_add_u32 s46, s60, 7471104
  buffer_load_dwordx4 v1, s[4:7], s46 offen  lds
  s_add_u32 m0, s51, 114688
  s_add_u32 s46, s60, 7471232
  buffer_load_dwordx4 v1, s[4:7], s46 offen  lds
  s_add_u32 m0, s51, 118784
  s_add_u32 s46, s60, 7471360
  buffer_load_dwordx4 v1, s[4:7], s46 offen  lds
  ds_read_b64_tr_b16 a[120:121], v2 offset:0
  ds_read_b64_tr_b16 a[122:123], v2 offset:1024
  ds_read_b64_tr_b16 a[124:125], v2 offset:4096
  ds_read_b64_tr_b16 a[126:127], v2 offset:5120
  ds_read_b64_tr_b16 a[128:129], v2 offset:8192
  ds_read_b64_tr_b16 a[130:131], v2 offset:9216
  ds_read_b64_tr_b16 a[132:133], v2 offset:12288
  ds_read_b64_tr_b16 a[134:135], v2 offset:13312
  ds_read_b64_tr_b16 a[136:137], v2 offset:16384
  ds_read_b64_tr_b16 a[138:139], v2 offset:17408
  ds_read_b64_tr_b16 a[140:141], v2 offset:20480
  ds_read_b64_tr_b16 a[142:143], v2 offset:21504
  s_waitcnt lgkmcnt(0)
  s_waitcnt vmcnt(19)
  s_barrier
  ds_read_b64_tr_b16 a[144:145], v2 offset:24576
  ds_read_b64_tr_b16 a[146:147], v2 offset:25600
  ds_read_b64_tr_b16 a[148:149], v2 offset:28672
  ds_read_b64_tr_b16 a[150:151], v2 offset:29696
  ds_read_b64_tr_b16 a[152:153], v2 offset:32768
  ds_read_b64_tr_b16 a[154:155], v2 offset:33792
  ds_read_b64_tr_b16 a[156:157], v2 offset:36864
  ds_read_b64_tr_b16 a[158:159], v2 offset:37888
  ds_read_b64_tr_b16 a[160:161], v2 offset:40960
  ds_read_b64_tr_b16 a[162:163], v2 offset:41984
  ds_read_b64_tr_b16 a[164:165], v2 offset:45056
  ds_read_b64_tr_b16 a[166:167], v2 offset:46080
  s_waitcnt lgkmcnt(0)
  s_waitcnt vmcnt(13)
  s_barrier
  ds_read_b64_tr_b16 a[168:169], v2 offset:49152
  ds_read_b64_tr_b16 a[170:171], v2 offset:50176
  ds_read_b64_tr_b16 a[172:173], v2 offset:53248
  ds_read_b64_tr_b16 a[174:175], v2 offset:54272
  ds_read_b64_tr_b16 a[176:177], v2 offset:57344
  ds_read_b64_tr_b16 a[178:179], v2 offset:58368
  ds_read_b64_tr_b16 a[180:181], v2 offset:61440
  ds_read_b64_tr_b16 a[182:183], v2 offset:62464
  ds_read_b64_tr_b16 a[184:185], v3 offset:0
  ds_read_b64_tr_b16 a[186:187], v3 offset:1024
  ds_read_b64_tr_b16 a[188:189], v3 offset:4096
  ds_read_b64_tr_b16 a[190:191], v3 offset:5120
  s_waitcnt lgkmcnt(0)
  s_waitcnt vmcnt(7)
  s_barrier
  ds_read_b64_tr_b16 a[192:193], v3 offset:8192
  ds_read_b64_tr_b16 a[194:195], v3 offset:9216
  ds_read_b64_tr_b16 a[196:197], v3 offset:12288
  ds_read_b64_tr_b16 a[198:199], v3 offset:13312
  ds_read_b64_tr_b16 a[200:201], v3 offset:16384
  ds_read_b64_tr_b16 a[202:203], v3 offset:17408
  ds_read_b64_tr_b16 a[204:205], v3 offset:20480
  ds_read_b64_tr_b16 a[206:207], v3 offset:21504
  ds_read_b64_tr_b16 a[208:209], v3 offset:24576
  ds_read_b64_tr_b16 a[210:211], v3 offset:25600
  ds_read_b64_tr_b16 a[212:213], v3 offset:28672
  ds_read_b64_tr_b16 a[214:215], v3 offset:29696
  s_waitcnt lgkmcnt(0)
  s_waitcnt vmcnt(0)
  s_barrier
  ds_read_b64_tr_b16 a[216:217], v3 offset:32768
  ds_read_b64_tr_b16 a[218:219], v3 offset:33792
  ds_read_b64_tr_b16 a[220:221], v3 offset:36864
  ds_read_b64_tr_b16 a[222:223], v3 offset:37888
  ds_read_b64_tr_b16 a[224:225], v3 offset:40960
  ds_read_b64_tr_b16 a[226:227], v3 offset:41984
  ds_read_b64_tr_b16 a[228:229], v3 offset:45056
  ds_read_b64_tr_b16 a[230:231], v3 offset:46080
  ds_read_b64_tr_b16 a[232:233], v3 offset:49152
  ds_read_b64_tr_b16 a[234:235], v3 offset:50176
  ds_read_b64_tr_b16 a[236:237], v3 offset:53248
  ds_read_b64_tr_b16 a[238:239], v3 offset:54272
  s_waitcnt lgkmcnt(0)
  s_mov_b32 s50, 0
  s_branch ss_3_in
ss_3:
  v_and_b32 v11, 3, v0
  v_lshlrev_b32 v11, 2, v11
  global_load_dword v10, v11, s[38:39] sc1
  s_add_u32 s50, s50, 1
  s_cmp_gt_u32 s50, 131072
  s_cbranch_scc1 L_fail
  s_waitcnt vmcnt(0)
ss_3_in:
  v_readlane_b32 s46, v10, 0
  v_readlane_b32 s47, v10, 2
  v_readlane_b32 s48, v10, 1
  s_nop 0
  s_min_u32 s47, s47, s48
  s_cmp_lg_u32 s46, 0
  s_cselect_b32 s48, 7, 0
  s_add_u32 s46, s46, s2
  s_xor_b32 s49, s46, s43
  s_and_b32 s49, s49, s48
  s_cbranch_scc1 L_reroll
  s_cmp_lg_u32 s47, 0
  s_cbranch_scc1 ss_ok_4
  s_sleep 6
  s_branch ss_3
ss_ok_4:
  v_readlane_b32 s3, v10, 1
  s_nop 0
  s_and_b32 s3, s3, 0x2000
  s_barrier
  s_mov_b32 s54, s51
  s_add_u32 s53, s53, 40960
  s_add_u32 m0, s54, 0
  s_nop 0
  buffer_load_dwordx4 v5, s[12:15], s53 offen offset:0 lds
  s_add_u32 m0, s54, 3968
  s_nop 0
  buffer_load_dwordx4 v5, s[12:15], s53 offen offset:128 lds
  s_add_u32 m0, s54, 7936
  s_nop 0
  buffer_load_dwordx4 v5, s[12:15], s53 offen offset:256 lds
  s_add_u32 m0, s54, 11904
  s_nop 0
  buffer_load_dwordx4 v5, s[12:15], s53 offen offset:384 lds
  s_add_u32 m0, s54, 15872
  s_nop 0
  buffer_load_dwordx4 v5, s[12:15], s53 offen offset:512 lds
  s_add_u32 m0, s54, 19840
  s_nop 0
  buffer_load_dwordx4 v5, s[12:15], s53 offen offset:640 lds
  s_add_u32 m0, s54, 23808
  s_nop 0
  buffer_load_dwordx4 v5, s[12:15], s53 offen offset:768 lds
  s_add_u32 m0, s54, 27776
  s_nop 0
  buffer_load_dwordx4 v5, s[12:15], s53 offen offset:896 lds
  s_add_u32 m0, s54, 31744
  s_nop 0
  buffer_load_dwordx4 v5, s[12:15], s53 offen offset:1024 lds
  s_add_u32 m0, s54, 35712
  s_nop 0
  buffer_load_dwordx4 v5, s[12:15], s53 offen offset:1152 lds
  s_mov_b32 s55, 2146435072
  s_mov_b32 s56, 2146435072
  s_mov_b32 s57, 2146435072
  s_xor_b32 s63, s63, s3
  s_mov_b32 s58, 122880
  ds_read_b128 v[16:19], v6 offset:0
  ds_read_b128 v[20:23], v7 offset:0
  ds_read_b128 v[24:27], v6 offset:4096
  ds_read_b128 v[28:31], v7 offset:4096
  s_waitcnt lgkmcnt(3)
pj_loop_5:
  v_mfma_f32_16x16x32_bf16 v[40:43], a[0:3], v[16:19], 0
  ds_read_b128 v[32:35], v6 offset:8192
  v_mfma_f32_16x16x32_bf16 v[48:51], a[4:7], v[16:19], 0
  v_mfma_f32_16x16x32_bf16 v[56:59], a[8:11], v[16:19], 0
  s_waitcnt lgkmcnt(3)
  v_cvt_pk_bf16_f32 v66, v44, v45
  v_mfma_f32_16x16x32_bf16 v[40:43], a[12:15], v[20:23], v[40:43]
  ds_read_b128 v[16:19], v7 offset:8192
  v_cvt_pk_bf16_f32 v67, v46, v47
  v_mfma_f32_16x16x32_bf16 v[48:51], a[16:19], v[20:23], v[48:51]
  v_cvt_pk_bf16_f32 v70, v52, v53
  v_mfma_f32_16x16x32_bf16 v[56:59], a[20:23], v[20:23], v[56:59]
  s_waitcnt lgkmcnt(3)
  v_cvt_pk_bf16_f32 v71, v54, v55
  v_mfma_f32_16x16x32_bf16 v[40:43], a[24:27], v[24:27], v[40:43]
  ds_read_b128 v[20:23], v6 offset:12288
  v_cvt_pk_bf16_f32 v74, v60, v61
  v_mfma_f32_16x16x32_bf16 v[48:51], a[28:31], v[24:27], v[48:51]
  v_cvt_pk_bf16_f32 v75, v62, v63
  v_mfma_f32_16x16x32_bf16 v[56:59], a[32:35], v[24:27], v[56:59]
  s_waitcnt lgkmcnt(3)
  v_mfma_f32_16x16x32_bf16 v[40:43], a[36:39], v[28:31], v[40:43]
  ds_read_b128 v[24:27], v7 offset:12288
  v_permlane16_swap_b32 v64, v66
  v_mfma_f32_16x16x32_bf16 v[48:51], a[40:43], v[28:31], v[48:51]
  v_permlane16_swap_b32 v65, v67
  v_mfma_f32_16x16x32_bf16 v[56:59], a[44:47], v[28:31], v[56:59]
  buffer_store_dwordx4 v[64:67], v8, s[8:11], s55 offen sc1
  s_waitcnt lgkmcnt(3)
  v_mfma_f32_16x16x32_bf16 v[40:43], a[48:51], v[32:35], v[40:43]
  ds_read_b128 v[28:31], v6 offset:16384
  v_permlane16_swap_b32 v68, v70
  v_mfma_f32_16x16x32_bf16 v[48:51], a[52:55], v[32:35], v[48:51]
  v_permlane16_swap_b32 v69, v71
  v_mfma_f32_16x16x32_bf16 v[56:59], a[56:59], v[32:35], v[56:59]
  buffer_store_dwordx4 v[68:71], v8, s[8:11], s56 offen sc1
  s_waitcnt lgkmcnt(3)
  v_mfma_f32_16x16x32_bf16 v[40:43], a[60:63], v[16:19], v[40:43]
  ds_read_b128 v[32:35], v7 offset:16384
  v_permlane16_swap_b32 v72, v74
  v_mfma_f32_16x16x32_bf16 v[48:51], a[64:67], v[16:19], v[48:51]
  v_permlane16_swap_b32 v73, v75
  v_mfma_f32_16x16x32_bf16 v[56:59], a[68:71], v[16:19], v[56:59]
  buffer_store_dwordx4 v[72:75], v8, s[8:11], s57 offen sc1
  s_waitcnt lgkmcnt(3)
  v_mfma_f32_16x16x32_bf16 v[40:43], a[72:75], v[20:23], v[40:43]
  ds_read_b128 v[16:19], v6 offset:20480
  v_mfma_f32_16x16x32_bf16 v[48:51], a[76:79], v[20:23], v[48:51]
  v_mfma_f32_16x16x32_bf16 v[56:59], a[80:83], v[20:23], v[56:59]
  s_waitcnt lgkmcnt(3)
  v_mfma_f32_16x16x32_bf16 v[40:43], a[84:87], v[24:27], v[40:43]
  ds_read_b128 v[20:23], v7 offset:20480
  v_mfma_f32_16x16x32_bf16 v[48:51], a[88:91], v[24:27], v[48:51]
  v_mov_b32 v10, s52
  v_mfma_f32_16x16x32_bf16 v[56:59], a[92:95], v[24:27], v[56:59]
  s_waitcnt lgkmcnt(3)
  v_mfma_f32_16x16x32_bf16 v[40:43], a[96:99], v[28:31], v[40:43]
  ds_read_b128 v[24:27], v6 offset:24576
  v_mfma_f32_16x16x32_bf16 v[48:51], a[100:103], v[28:31], v[48:51]
  s_add_u32 s53, s53, 40960
  s_add_u32 s54, s54, 40960
  v_mfma_f32_16x16x32_bf16 v[56:59], a[104:107], v[28:31], v[56:59]
  s_waitcnt lgkmcnt(3)
  v_mfma_f32_16x16x32_bf16 v[40:43], a[108:111], v[32:35], v[40:43]
  ds_read_b128 v[28:31], v7 offset:24576
  v_mfma_f32_16x16x32_bf16 v[48:51], a[112:115], v[32:35], v[48:51]
  s_cmp_ge_u32 s54, 163840
  s_cselect_b32 s54, s51, s54
  v_mfma_f32_16x16x32_bf16 v[56:59], a[116:119], v[32:35], v[56:59]
  s_waitcnt lgkmcnt(3)
  v_mfma_f32_16x16x32_bf16 v[40:43], a[120:123], v[16:19], v[40:43]
  ds_read_b128 v[32:35], v6 offset:28672
  v_mfma_f32_16x16x32_bf16 v[48:51], a[124:127], v[16:19], v[48:51]
  s_cmp_eq_u32 s58, 122880
  s_cselect_b32 s59, 163840, 0
  v_mfma_f32_16x16x32_bf16 v[56:59], a[128:131], v[16:19], v[56:59]
  s_waitcnt lgkmcnt(3)
  v_mfma_f32_16x16x32_bf16 v[40:43], a[132:135], v[20:23], v[40:43]
  ds_read_b128 v[16:19], v7 offset:28672
  v_mfma_f32_16x16x32_bf16 v[48:51], a[136:139], v[20:23], v[48:51]
  s_sub_u32 s59, 40960, s59
  s_add_u32 s58, s58, s59
  v_mfma_f32_16x16x32_bf16 v[56:59], a[140:143], v[20:23], v[56:59]
  s_cmp_eq_u32 s52, 1
  s_cbranch_scc1 pj_eager
pj_eback:
  s_waitcnt lgkmcnt(3)
  v_mfma_f32_16x16x32_bf16 v[40:43], a[144:147], v[24:27], v[40:43]
  ds_read_b128 v[20:23], v6 offset:32768
  v_mfma_f32_16x16x32_bf16 v[48:51], a[148:151], v[24:27], v[48:51]
  s_lshr_b32 s55, s67, 1
  v_mfma_f32_16x16x32_bf16 v[56:59], a[152:155], v[24:27], v[56:59]
  s_lshl_b32 s55, s55, 14
  s_waitcnt lgkmcnt(3)
  v_mfma_f32_16x16x32_bf16 v[40:43], a[156:159], v[28:31], v[40:43]
  ds_read_b128 v[24:27], v7 offset:32768
  v_mfma_f32_16x16x32_bf16 v[48:51], a[160:163], v[28:31], v[48:51]
  s_and_b32 s56, s67, 1
  v_mfma_f32_16x16x32_bf16 v[56:59], a[164:167], v[28:31], v[56:59]
  s_lshl_b32 s56, s56, 12
  s_waitcnt lgkmcnt(3)
  v_mfma_f32_16x16x32_bf16 v[40:43], a[168:171], v[32:35], v[40:43]
  ds_read_b128 v[28:31], v6 offset:36864
  v_mfma_f32_16x16x32_bf16 v[48:51], a[172:175], v[32:35], v[48:51]
  s_add_u32 s55, s55, s56
  v_mfma_f32_16x16x32_bf16 v[56:59], a[176:179], v[32:35], v[56:59]
  s_add_u32 s55, s55, s63
  s_waitcnt lgkmcnt(3)
  v_mfma_f32_16x16x32_bf16 v[40:43], a[180:183], v[16:19], v[40:43]
  ds_read_b128 v[32:35], v7 offset:36864
  v_mfma_f32_16x16x32_bf16 v[48:51], a[184:187], v[16:19], v[48:51]
  s_lshr_b32 s56, s55, 8
  v_mfma_f32_16x16x32_bf16 v[56:59], a[188:191], v[16:19], v[56:59]
  s_and_b32 s56, s56, 0x2000
  s_waitcnt lgkmcnt(3)
  v_mfma_f32_16x16x32_bf16 v[40:43], a[192:195], v[20:23], v[40:43]
  ds_read_b128 v[16:19], v6 offset:2048
  v_mfma_f32_16x16x32_bf16 v[48:51], a[196:199], v[20:23], v[48:51]
  s_xor_b32 s55, s55, s56
  v_mfma_f32_16x16x32_bf16 v[56:59], a[200:203], v[20:23], v[56:59]
  s_add_u32 s67, s67, 32
  s_waitcnt lgkmcnt(3)
  v_mfma_f32_16x16x32_bf16 v[40:43], a[204:207], v[24:27], v[40:43]
  ds_read_b128 v[20:23], v7 offset:2048
  v_mfma_f32_16x16x32_bf16 v[48:51], a[208:211], v[24:27], v[48:51]
  s_cmp_ge_u32 s67, 1024
  s_cselect_b32 s56, 1024, 0
  v_mfma_f32_16x16x32_bf16 v[56:59], a[212:215], v[24:27], v[56:59]
  s_sub_u32 s67, s67, s56
  s_waitcnt lgkmcnt(3)
  v_mfma_f32_16x16x32_bf16 v[40:43], a[216:219], v[28:31], v[40:43]
  ds_read_b128 v[24:27], v6 offset:6144
  v_mfma_f32_16x16x32_bf16 v[48:51], a[220:223], v[28:31], v[48:51]
  s_add_u32 s56, s55, 16777216
  v_mfma_f32_16x16x32_bf16 v[56:59], a[224:227], v[28:31], v[56:59]
  s_add_u32 s57, s55, 33554432
  s_waitcnt lgkmcnt(3)
  v_mfma_f32_16x16x32_bf16 v[40:43], a[228:231], v[32:35], v[40:43]
  ds_read_b128 v[28:31], v7 offset:6144
  v_mfma_f32_16x16x32_bf16 v[48:51], a[232:235], v[32:35], v[48:51]
  v_mfma_f32_16x16x32_bf16 v[56:59], a[236:239], v[32:35], v[56:59]
  s_waitcnt lgkmcnt(3)
  v_mfma_f32_16x16x32_bf16 v[44:47], a[0:3], v[16:19], 0
  ds_read_b128 v[32:35], v6 offset:10240
  v_mfma_f32_16x16x32_bf16 v[52:55], a[4:7], v[16:19], 0
  v_mfma_f32_16x16x32_bf16 v[60:63], a[8:11], v[16:19], 0
  s_waitcnt lgkmcnt(3)
  v_cvt_pk_bf16_f32 v64, v40, v41
  v_mfma_f32_16x16x32_bf16 v[44:47], a[12:15], v[20:23], v[44:47]
  ds_read_b128 v[16:19], v7 offset:10240
  v_cvt_pk_bf16_f32 v65, v42, v43
  v_mfma_f32_16x16x32_bf16 v[52:55], a[16:19], v[20:23], v[52:55]
  v_cvt_pk_bf16_f32 v68, v48, v49
  v_mfma_f32_16x16x32_bf16 v[60:63], a[20:23], v[20:23], v[60:63]
  s_waitcnt lgkmcnt(3)
  v_cvt_pk_bf16_f32 v69, v50, v51
  v_mfma_f32_16x16x32_bf16 v[44:47], a[24:27], v[24:27], v[44:47]
  ds_read_b128 v[20:23], v6 offset:14336
  v_cvt_pk_bf16_f32 v72, v56, v57
  v_mfma_f32_16x16x32_bf16 v[52:55], a[28:31], v[24:27], v[52:55]
  v_cvt_pk_bf16_f32 v73, v58, v59
  v_mfma_f32_16x16x32_bf16 v[60:63], a[32:35], v[24:27], v[60:63]
  s_waitcnt lgkmcnt(3)
  v_mfma_f32_16x16x32_bf16 v[44:47], a[36:39], v[28:31], v[44:47]
  ds_read_b128 v[24:27], v7 offset:14336
  v_mfma_f32_16x16x32_bf16 v[52:55], a[40:43], v[28:31], v[52:55]
  s_waitcnt vmcnt(0)
  s_barrier
  v_mfma_f32_16x16x32_bf16 v[60:63], a[44:47], v[28:31], v[60:63]
  buffer_store_dword v10, v9, s[8:11], 0 offen sc1
  s_waitcnt lgkmcnt(3)
  v_mfma_f32_16x16x32_bf16 v[44:47], a[48:51], v[32:35], v[44:47]
  ds_read_b128 v[28:31], v6 offset:18432
  s_add_u32 m0, s54, 0
  v_mfma_f32_16x16x32_bf16 v[52:55], a[52:55], v[32:35], v[52:55]
  buffer_load_dwordx4 v5, s[12:15], s53 offen offset:0 lds
  v_mfma_f32_16x16x32_bf16 v[60:63], a[56:59], v[32:35], v[60:63]
  s_waitcnt lgkmcnt(3)
  v_mfma_f32_16x16x32_bf16 v[44:47], a[60:63], v[16:19], v[44:47]
  ds_read_b128 v[32:35], v7 offset:18432
  s_add_u32 m0, s54, 3968
  v_mfma_f32_16x16x32_bf16 v[52:55], a[64:67], v[16:19], v[52:55]
  buffer_load_dwordx4 v5, s[12:15], s53 offen offset:128 lds
  v_mfma_f32_16x16x32_bf16 v[60:63], a[68:71], v[16:19], v[60:63]
  s_waitcnt lgkmcnt(3)
  v_mfma_f32_16x16x32_bf16 v[44:47], a[72:75], v[20:23], v[44:47]
  ds_read_b128 v[16:19], v6 offset:22528
  s_add_u32 m0, s54, 7936
  v_mfma_f32_16x16x32_bf16 v[52:55], a[76:79], v[20:23], v[52:55]
  buffer_load_dwordx4 v5, s[12:15], s53 offen offset:256 lds
  v_mfma_f32_16x16x32_bf16 v[60:63], a[80:83], v[20:23], v[60:63]
  s_waitcnt lgkmcnt(3)
  v_mfma_f32_16x16x32_bf16 v[44:47], a[84:87], v[24:27], v[44:47]
  ds_read_b128 v[20:23], v7 offset:22528
  s_add_u32 m0, s54, 11904
  v_mfma_f32_16x16x32_bf16 v[52:55], a[88:91], v[24:27], v[52:55]
  buffer_load_dwordx4 v5, s[12:15], s53 offen offset:384 lds
  v_mfma_f32_16x16x32_bf16 v[60:63], a[92:95], v[24:27], v[60:63]
  s_waitcnt lgkmcnt(3)
  v_mfma_f32_16x16x32_bf16 v[44:47], a[96:99], v[28:31], v[44:47]
  ds_read_b128 v[24:27], v6 offset:26624
  s_add_u32 m0, s54, 15872
  v_mfma_f32_16x16x32_bf16 v[52:55], a[100:103], v[28:31], v[52:55]
  buffer_load_dwordx4 v5, s[12:15], s53 offen offset:512 lds
  v_mfma_f32_16x16x32_bf16 v[60:63], a[104:107], v[28:31], v[60:63]
  s_waitcnt lgkmcnt(3)
  v_mfma_f32_16x16x32_bf16 v[44:47], a[108:111], v[32:35], v[44:47]
  ds_read_b128 v[28:31], v7 offset:26624
  s_add_u32 m0, s54, 19840
  v_mfma_f32_16x16x32_bf16 v[52:55], a[112:115], v[32:35], v[52:55]
  buffer_load_dwordx4 v5, s[12:15], s53 offen offset:640 lds
  v_mfma_f32_16x16x32_bf16 v[60:63], a[116:119], v[32:35], v[60:63]
  s_waitcnt lgkmcnt(3)
  v_mfma_f32_16x16x32_bf16 v[44:47], a[120:123], v[16:19], v[44:47]
  ds_read_b128 v[32:35], v6 offset:30720
  s_add_u32 m0, s54, 23808
  v_mfma_f32_16x16x32_bf16 v[52:55], a[124:127], v[16:19], v[52:55]
  buffer_load_dwordx4 v5, s[12:15], s53 offen offset:768 lds
  v_mfma_f32_16x16x32_bf16 v[60:63], a[128:131], v[16:19], v[60:63]
  s_waitcnt lgkmcnt(3)
  v_mfma_f32_16x16x32_bf16 v[44:47], a[132:135], v[20:23], v[44:47]
  ds_read_b128 v[16:19], v7 offset:30720
  s_add_u32 m0, s54, 27776
  v_mfma_f32_16x16x32_bf16 v[52:55], a[136:139], v[20:23], v[52:55]
  buffer_load_dwordx4 v5, s[12:15], s53 offen offset:896 lds
  v_mfma_f32_16x16x32_bf16 v[60:63], a[140:143], v[20:23], v[60:63]
  s_waitcnt lgkmcnt(3)
  v_mfma_f32_16x16x32_bf16 v[44:47], a[144:147], v[24:27], v[44:47]
  ds_read_b128 v[20:23], v6 offset:34816
  s_add_u32 m0, s54, 31744
  v_mfma_f32_16x16x32_bf16 v[52:55], a[148:151], v[24:27], v[52:55]
  buffer_load_dwordx4 v5, s[12:15], s53 offen offset:1024 lds
  v_mfma_f32_16x16x32_bf16 v[60:63], a[152:155], v[24:27], v[60:63]
  s_waitcnt lgkmcnt(3)
  v_mfma_f32_16x16x32_bf16 v[44:47], a[156:159], v[28:31], v[44:47]
  ds_read_b128 v[24:27], v7 offset:34816
  s_add_u32 m0, s54, 35712
  v_mfma_f32_16x16x32_bf16 v[52:55], a[160:163], v[28:31], v[52:55]
  buffer_load_dwordx4 v5, s[12:15], s53 offen offset:1152 lds
  v_mfma_f32_16x16x32_bf16 v[60:63], a[164:167], v[28:31], v[60:63]
  s_waitcnt lgkmcnt(3)
  v_mfma_f32_16x16x32_bf16 v[44:47], a[168:171], v[32:35], v[44:47]
  ds_read_b128 v[28:31], v6 offset:38912
  v_mfma_f32_16x16x32_bf16 v[52:55], a[172:175], v[32:35], v[52:55]
  s_max_u32 s69, s52, 25
  s_sub_u32 s69, s69, 25
  v_mfma_f32_16x16x32_bf16 v[60:63], a[176:179], v[32:35], v[60:63]
  s_cmp_eq_u32 s52, s70
  s_cbranch_scc1 pj_warm
pj_wback:
  s_waitcnt lgkmcnt(3)
  v_mfma_f32_16x16x32_bf16 v[44:47], a[180:183], v[16:19], v[44:47]
  ds_read_b128 v[32:35], v7 offset:38912
  v_mfma_f32_16x16x32_bf16 v[52:55], a[184:187], v[16:19], v[52:55]
  v_add_u32 v6, s59, v6
  v_add_u32 v7, s59, v7
  v_mfma_f32_16x16x32_bf16 v[60:63], a[188:191], v[16:19], v[60:63]
  s_waitcnt lgkmcnt(3)
  v_mfma_f32_16x16x32_bf16 v[44:47], a[192:195], v[20:23], v[44:47]
  ds_read_b128 v[16:19], v6 offset:0
  v_mfma_f32_16x16x32_bf16 v[52:55], a[196:199], v[20:23], v[52:55]
  s_cmp_lt_u32 s68, s69
  s_cbranch_scc1 pj_slow
pj_back:
  v_mfma_f32_16x16x32_bf16 v[60:63], a[200:203], v[20:23], v[60:63]
  s_waitcnt lgkmcnt(3)
  v_mfma_f32_16x16x32_bf16 v[44:47], a[204:207], v[24:27], v[44:47]
  ds_read_b128 v[20:23], v7 offset:0
  v_mfma_f32_16x16x32_bf16 v[52:55], a[208:211], v[24:27], v[52:55]
  s_add_u32 s52, s52, 1
  v_mfma_f32_16x16x32_bf16 v[60:63], a[212:215], v[24:27], v[60:63]
  s_waitcnt lgkmcnt(3)
  v_mfma_f32_16x16x32_bf16 v[44:47], a[216:219], v[28:31], v[44:47]
  ds_read_b128 v[24:27], v6 offset:4096
  v_mfma_f32_16x16x32_bf16 v[52:55], a[220:223], v[28:31], v[52:55]
  v_mfma_f32_16x16x32_bf16 v[60:63], a[224:227], v[28:31], v[60:63]
  s_waitcnt lgkmcnt(3)
  v_mfma_f32_16x16x32_bf16 v[44:47], a[228:231], v[32:35], v[44:47]
  ds_read_b128 v[28:31], v7 offset:4096
  v_mfma_f32_16x16x32_bf16 v[52:55], a[232:235], v[32:35], v[52:55]
  s_cmp_lt_u32 s52, s62
  v_mfma_f32_16x16x32_bf16 v[60:63], a[236:239], v[32:35], v[60:63]
  s_waitcnt lgkmcnt(3)
  s_cbranch_scc1 pj_loop_5
  v_cvt_pk_bf16_f32 v66, v44, v45
  v_cvt_pk_bf16_f32 v67, v46, v47
  s_nop 1
  v_cvt_pk_bf16_f32 v70, v52, v53
  v_cvt_pk_bf16_f32 v71, v54, v55
  v_cvt_pk_bf16_f32 v74, v60, v61
  v_cvt_pk_bf16_f32 v75, v62, v63
  v_permlane16_swap_b32 v64, v66
  v_permlane16_swap_b32 v65, v67
  v_permlane16_swap_b32 v68, v70
  v_permlane16_swap_b32 v69, v71
  v_permlane16_swap_b32 v72, v74
  v_permlane16_swap_b32 v73, v75
  buffer_store_dwordx4 v[64:67], v8, s[8:11], s55 offen sc1
  buffer_store_dwordx4 v[68:71], v8, s[8:11], s56 offen sc1
  buffer_store_dwordx4 v[72:75], v8, s[8:11], s57 offen sc1
  v_mov_b32 v10, s52
  s_waitcnt vmcnt(0) lgkmcnt(0)
  s_barrier
  buffer_store_dword v10, v9, s[8:11], 0 offen sc1
  s_branch pj_done
pj_slow:
  s_cmp_ge_u32 s68, s69
  s_cbranch_scc1 wf_done_6
  s_mov_b32 s50, 0
wf_loop_7:
  buffer_load_dword v11, v14, s[8:11], 0 offen sc1
  s_add_u32 s50, s50, 1
  s_cmp_gt_u32 s50, 131072
  s_cbranch_scc1 L_fail
  s_waitcnt vmcnt(0)
  v_readfirstlane_b32 s68, v11
  s_nop 0
  s_cmp_ge_u32 s68, s69
  s_cbranch_scc1 wf_done_6
  s_sleep 2
  s_branch wf_loop_7
wf_done_6:
  s_branch pj_back
pj_eager:
  s_waitcnt vmcnt(0)
  s_barrier
  buffer_store_dword v10, v9, s[8:11], 0 offen sc1
  s_branch pj_eback
pj_warm:
  s_lshl_b32 s46, s44, 2
  s_add_u32 s46, s46, s43
  s_sub_u32 s46, s46, 4
  s_lshl_b32 s46, s46, 2
  s_add_u32 s46, s46, s42
  s_lshl_b32 s46, s46, 13
  v_lshlrev_b32 v11, 7, v0
  s_mov_b32 s4, s16
  s_mov_b32 s5, s17
  s_mov_b32 s6, 2621440
  s_mov_b32 s7, 0x20000
  buffer_load_dword v12, v11, s[4:7], s46 offen
  s_mov_b32 s4, s18
  s_mov_b32 s5, s19
  s_mov_b32 s6, 2457600
  s_mov_b32 s7, 0x20000
  buffer_load_dword v12, v11, s[4:7], s46 offen
  s_mov_b32 s4, s20
  s_mov_b32 s5, s21
  s_mov_b32 s6, 819200
  s_mov_b32 s7, 0x20000
  buffer_load_dword v12, v11, s[4:7], s46 offen
  s_branch pj_wback
pj_done:
  s_branch L_parta
L_uw:
  s_mov_b32 s4, s32
  s_mov_b32 s5, s33
  s_mov_b32 s6, 7864320
  s_mov_b32 s7, 0x20000
  v_lshrrev_b32 v8, 3, v0
  v_lshrrev_b32 v9, 2, v8
  v_lshlrev_b32 v9, 3, v9
  v_and_b32 v1, 3, v8
  v_add_u32 v1, v1, v9
  s_and_b32 s46, s42, 1
  s_lshl_b32 s46, s46, 2
  s_lshr_b32 s47, s42, 1
  s_lshl_b32 s47, s47, 4
  s_add_u32 s46, s46, s47
  v_add_u32 v1, s46, v1
  v_mul_u32_u24 v1, 1280, v1
  v_lshrrev_b32 v8, 1, v8
  v_bfe_u32 v9, v0, 1, 2
  v_xor_b32 v8, v8, v9
  v_lshlrev_b32 v8, 5, v8
  v_and_b32 v9, 1, v0
  v_lshlrev_b32 v9, 4, v9
  v_add3_u32 v1, v1, v8, v9
  v_lshrrev_b32 v8, 5, v0
  v_lshlrev_b32 v2, 11, v8
  v_bfe_u32 v8, v0, 2, 3
  v_lshl_add_u32 v2, v8, 7, v2
  v_lshrrev_b32 v8, 1, v8
  v_xor_b32 v8, s42, v8
  v_lshl_add_u32 v2, v8, 5, v2
  v_and_b32 v8, 3, v0
  v_lshl_add_u32 v2, v8, 3, v2
  v_add_u32 v3, 0x10000, v2
  v_add_u32 v4, 0x20000, v2
  s_mul_i32 s53, s45, 245760
  v_lshlrev_b32 v5, 4, v0
  s_lshl_b32 s46, s45, 7
  s_add_u32 s47, s46, 1056768
  v_mov_b32 v6, s47
  s_lshl_b32 s47, s42, 2
  s_add_u32 s46, s46, s47
  s_add_u32 s46, s46, 1060864
  v_mov_b32 v7, s46
  v_mov_b32 v8, 2146435072
  v_cmp_eq_u32 vcc, 0, v0
  s_nop 1
  v_cndmask_b32 v7, v8, v7, vcc
  v_cndmask_b32 v6, v8, v6, vcc
  s_mov_b32 s60, s51
  s_add_u32 s61, s51, 167780352
  s_mov_b32 s62, s45
  v_mov_b32 v12, v5
  s_lshr_b32 s55, s45, 3
  s_lshl_b32 s55, s55, 14
  s_and_b32 s46, s45, 7
  s_lshl_b32 s46, s46, 10
  s_add_u32 s55, s55, s46
  s_lshl_b32 s46, s42, 16
  s_add_u32 s55, s55, s46
  s_add_u32 s55, s55, 81788928
  s_mov_b32 s52, 0
  s_mov_b32 s56, 0
  s_add_u32 m0, s51, 0
  s_add_u32 s46, s53, 0
  buffer_load_dwordx4 v1, s[4:7], s46 offen  lds
  s_add_u32 m0, s51, 4096
  s_add_u32 s46, s53, 128
  buffer_load_dwordx4 v1, s[4:7], s46 offen  lds
  s_add_u32 m0, s51, 8192
  s_add_u32 s46, s53, 256
  buffer_load_dwordx4 v1, s[4:7], s46 offen  lds
  s_add_u32 m0, s51, 12288
  s_add_u32 s46, s53, 384
  buffer_load_dwordx4 v1, s[4:7], s46 offen  lds
  s_add_u32 m0, s51, 16384
  s_add_u32 s46, s53, 512
  buffer_load_dwordx4 v1, s[4:7], s46 offen  lds
  s_add_u32 m0, s51, 20480
  s_add_u32 s46, s53, 640
  buffer_load_dwordx4 v1, s[4:7], s46 offen  lds
  s_add_u32 m0, s51, 24576
  s_add_u32 s46, s53, 768
  buffer_load_dwordx4 v1, s[4:7], s46 offen  lds
  s_add_u32 m0, s51, 28672
  s_add_u32 s46, s53, 896
  buffer_load_dwordx4 v1, s[4:7], s46 offen  lds
  s_add_u32 m0, s51, 32768
  s_add_u32 s46, s53, 1024
  buffer_load_dwordx4 v1, s[4:7], s46 offen  lds
  s_add_u32 m0, s51, 36864
  s_add_u32 s46, s53, 1152
  buffer_load_dwordx4 v1, s[4:7], s46 offen  lds
  s_add_u32 m0, s51, 40960
  s_add_u32 s46, s53, 40960
  buffer_load_dwordx4 v1, s[4:7], s46 offen  lds
  s_add_u32 m0, s51, 45056
  s_add_u32 s46, s53, 41088
  buffer_load_dwordx4 v1, s[4:7], s46 offen  lds
  s_add_u32 m0, s51, 49152
  s_add_u32 s46, s53, 41216
  buffer_load_dwordx4 v1, s[4:7], s46 offen  lds
  s_add_u32 m0, s51, 53248
  s_add_u32 s46, s53, 41344
  buffer_load_dwordx4 v1, s[4:7], s46 offen  lds
  s_add_u32 m0, s51, 57344
  s_add_u32 s46, s53, 41472
  buffer_load_dwordx4 v1, s[4:7], s46 offen  lds
  s_add_u32 m0, s51, 61440
  s_add_u32 s46, s53, 41600
  buffer_load_dwordx4 v1, s[4:7], s46 offen  lds
  s_add_u32 m0, s51, 65536
  s_add_u32 s46, s53, 41728
  buffer_load_dwordx4 v1, s[4:7], s46 offen  lds
  s_add_u32 m0, s51, 69632
  s_add_u32 s46, s53, 41856
  buffer_load_dwordx4 v1, s[4:7], s46 offen  lds
  s_add_u32 m0, s51, 73728
  s_add_u32 s46, s53, 41984
  buffer_load_dwordx4 v1, s[4:7], s46 offen  lds
  s_add_u32 m0, s51, 77824
  s_add_u32 s46, s53, 42112
  buffer_load_dwordx4 v1, s[4:7], s46 offen  lds
  s_add_u32 m0, s51, 81920
  s_add_u32 s46, s53, 81920
  buffer_load_dwordx4 v1, s[4:7], s46 offen  lds
  s_add_u32 m0, s51, 86016
  s_add_u32 s46, s53, 82048
  buffer_load_dwordx4 v1, s[4:7], s46 offen  lds
  s_add_u32 m0, s51, 90112
  s_add_u32 s46, s53, 82176
  buffer_load_dwordx4 v1, s[4:7], s46 offen  lds
  s_add_u32 m0, s51, 94208
  s_add_u32 s46, s53, 82304
  buffer_load_dwordx4 v1, s[4:7], s46 offen  lds
  s_add_u32 m0, s51, 98304
  s_add_u32 s46, s53, 82432
  buffer_load_dwordx4 v1, s[4:7], s46 offen  lds
  s_add_u32 m0, s51, 102400
  s_add_u32 s46, s53, 82560
  buffer_load_dwordx4 v1, s[4:7], s46 offen  lds
  s_add_u32 m0, s51, 106496
  s_add_u32 s46, s53, 82688
  buffer_load_dwordx4 v1, s[4:7], s46 offen  lds
  s_add_u32 m0, s51, 110592
  s_add_u32 s46, s53, 82816
  buffer_load_dwordx4 v1, s[4:7], s46 offen  lds
  s_add_u32 m0, s51, 114688
  s_add_u32 s46, s53, 82944
  buffer_load_dwordx4 v1, s[4:7], s46 offen  lds
  s_add_u32 m0, s51, 118784
  s_add_u32 s46, s53, 83072
  buffer_load_dwordx4 v1, s[4:7], s46 offen  lds
  s_waitcnt vmcnt(24)
  s_barrier
  s_add_u32 m0, s51, 122880
  s_add_u32 s46, s53, 122880
  buffer_load_dwordx4 v1, s[4:7], s46 offen  lds
  s_add_u32 m0, s51, 126976
  s_add_u32 s46, s53, 123008
  buffer_load_dwordx4 v1, s[4:7], s46 offen  lds
  s_add_u32 m0, s51, 131072
  s_add_u32 s46, s53, 123136
  buffer_load_dwordx4 v1, s[4:7], s46 offen  lds
  s_add_u32 m0, s51, 135168
  s_add_u32 s46, s53, 123264
  buffer_load_dwordx4 v1, s[4:7], s46 offen  lds
  s_add_u32 m0, s51, 139264
  s_add_u32 s46, s53, 123392
  buffer_load_dwordx4 v1, s[4:7], s46 offen  lds
  s_add_u32 m0, s51, 143360
  s_add_u32 s46, s53, 123520
  buffer_load_dwordx4 v1, s[4:7], s46 offen  lds
  ds_read_b64_tr_b16 a[0:1], v2 offset:0
  ds_read_b64_tr_b16 a[2:3], v2 offset:1024
  ds_read_b64_tr_b16 a[24:25], v2 offset:4096
  ds_read_b64_tr_b16 a[26:27], v2 offset:5120
  ds_read_b64_tr_b16 a[48:49], v2 offset:8192
  ds_read_b64_tr_b16 a[50:51], v2 offset:9216
  ds_read_b64_tr_b16 a[72:73], v2 offset:12288
  ds_read_b64_tr_b16 a[74:75], v2 offset:13312
  ds_read_b64_tr_b16 a[96:97], v2 offset:16384
  ds_read_b64_tr_b16 a[98:99], v2 offset:17408
  ds_read_b64_tr_b16 a[120:121], v2 offset:20480
  ds_read_b64_tr_b16 a[122:123], v2 offset:21504
  s_waitcnt lgkmcnt(0)
  s_waitcnt vmcnt(24)
  s_barrier
  s_add_u32 m0, s51, 0
  s_add_u32 s46, s53, 123648
  buffer_load_dwordx4 v1, s[4:7], s46 offen  lds
  s_add_u32 m0, s51, 4096
  s_add_u32 s46, s53, 123776
  buffer_load_dwordx4 v1, s[4:7], s46 offen  lds
  s_add_u32 m0, s51, 8192
  s_add_u32 s46, s53, 123904
  buffer_load_dwordx4 v1, s[4:7], s46 offen  lds
  s_add_u32 m0, s51, 12288
  s_add_u32 s46, s53, 124032
  buffer_load_dwordx4 v1, s[4:7], s46 offen  lds
  s_add_u32 m0, s51, 16384
  s_add_u32 s46, s53, 163840
  buffer_load_dwordx4 v1, s[4:7], s46 offen  lds
  s_add_u32 m0, s51, 20480
  s_add_u32 s46, s53, 163968
  buffer_load_dwordx4 v1, s[4:7], s46 offen  lds
  ds_read_b64_tr_b16 a[144:145], v2 offset:24576
  ds_read_b64_tr_b16 a[146:147], v2 offset:25600
  ds_read_b64_tr_b16 a[168:169], v2 offset:28672
  ds_read_b64_tr_b16 a[170:171], v2 offset:29696
  ds_read_b64_tr_b16 a[192:193], v2 offset:32768
  ds_read_b64_tr_b16 a[194:195], v2 offset:33792
  ds_read_b64_tr_b16 a[216:217], v2 offset:36864
  ds_read_b64_tr_b16 a[218:219], v2 offset:37888
  ds_read_b64_tr_b16 a[4:5], v2 offset:40960
  ds_read_b64_tr_b16 a[6:7], v2 offset:41984
  ds_read_b64_tr_b16 a[28:29], v2 offset:45056
  ds_read_b64_tr_b16 a[30:31], v2 offset:46080
  s_waitcnt lgkmcnt(0)
  s_waitcnt vmcnt(24)
  s_barrier
  s_add_u32 m0, s51, 24576
  s_add_u32 s46, s53, 164096
  buffer_load_dwordx4 v1, s[4:7], s46 offen  lds
  s_add_u32 m0, s51, 28672
  s_add_u32 s46, s53, 164224
  buffer_load_dwordx4 v1, s[4:7], s46 offen  lds
  s_add_u32 m0, s51, 32768
  s_add_u32 s46, s53, 164352
  buffer_load_dwordx4 v1, s[4:7], s46 offen  lds
  s_add_u32 m0, s51, 36864
  s_add_u32 s46, s53, 164480
  buffer_load_dwordx4 v1, s[4:7], s46 offen  lds
  s_add_u32 m0, s51, 40960
  s_add_u32 s46, s53, 164608
  buffer_load_dwordx4 v1, s[4:7], s46 offen  lds
  s_add_u32 m0, s51, 45056
  s_add_u32 s46, s53, 164736
  buffer_load_dwordx4 v1, s[4:7], s46 offen  lds
  ds_read_b64_tr_b16 a[52:53], v2 offset:49152
  ds_read_b64_tr_b16 a[54:55], v2 offset:50176
  ds_read_b64_tr_b16 a[76:77], v2 offset:53248
  ds_read_b64_tr_b16 a[78:79], v2 offset:54272
  ds_read_b64_tr_b16 a[100:101], v2 offset:57344
  ds_read_b64_tr_b16 a[102:103], v2 offset:58368
  ds_read_b64_tr_b16 a[124:125], v2 offset:61440
  ds_read_b64_tr_b16 a[126:127], v2 offset:62464
  ds_read_b64_tr_b16 a[148:149], v3 offset:0
  ds_read_b64_tr_b16 a[150:151], v3 offset:1024
  ds_read_b64_tr_b16 a[172:173], v3 offset:4096
  ds_read_b64_tr_b16 a[174:175], v3 offset:5120
  s_waitcnt lgkmcnt(0)
  s_waitcnt vmcnt(24)
  s_barrier
  s_add_u32 m0, s51, 49152
  s_add_u32 s46, s53, 164864
  buffer_load_dwordx4 v1, s[4:7], s46 offen  lds
  s_add_u32 m0, s51, 53248
  s_add_u32 s46, s53, 164992
  buffer_load_dwordx4 v1, s[4:7], s46 offen  lds
  s_add_u32 m0, s51, 57344
  s_add_u32 s46, s53, 204800
  buffer_load_dwordx4 v1, s[4:7], s46 offen  lds
  s_add_u32 m0, s51, 61440
  s_add_u32 s46, s53, 204928
  buffer_load_dwordx4 v1, s[4:7], s46 offen  lds
  s_add_u32 m0, s51, 65536
  s_add_u32 s46, s53, 205056
  buffer_load_dwordx4 v1, s[4:7], s46 offen  lds
  s_add_u32 m0, s51, 69632
  s_add_u32 s46, s53, 205184
  buffer_load_dwordx4 v1, s[4:7], s46 offen  lds
  ds_read_b64_tr_b16 a[196:197], v3 offset:8192
  ds_read_b64_tr_b16 a[198:199], v3 offset:9216
  ds_read_b64_tr_b16 a[220:221], v3 offset:12288
  ds_read_b64_tr_b16 a[222:223], v3 offset:13312
  ds_read_b64_tr_b16 a[8:9], v3 offset:16384
  ds_read_b64_tr_b16 a[10:11], v3 offset:17408
  ds_read_b64_tr_b16 a[32:33], v3 offset:20480
  ds_read_b64_tr_b16 a[34:35], v3 offset:21504
  ds_read_b64_tr_b16 a[56:57], v3 offset:24576
  ds_read_b64_tr_b16 a[58:59], v3 offset:25600
  ds_read_b64_tr_b16 a[80:81], v3 offset:28672
  ds_read_b64_tr_b16 a[82:83], v3 offset:29696
  s_waitcnt lgkmcnt(0)
  s_waitcnt vmcnt(24)
  s_barrier
  v_and_b32 v9, 3, v0
  v_lshlrev_b32 v9, 2, v9
  global_load_dword v8, v9, s[38:39] sc1
  s_add_u32 m0, s51, 73728
  s_add_u32 s46, s53, 205312
  buffer_load_dwordx4 v1, s[4:7], s46 offen  lds
  s_add_u32 m0, s51, 77824
  s_add_u32 s46, s53, 205440
  buffer_load_dwordx4 v1, s[4:7], s46 offen  lds
  s_add_u32 m0, s51, 81920
  s_add_u32 s46, s53, 205568
  buffer_load_dwordx4 v1, s[4:7], s46 offen  lds
  s_add_u32 m0, s51, 86016
  s_add_u32 s46, s53, 205696
  buffer_load_dwordx4 v1, s[4:7], s46 offen  lds
  s_add_u32 m0, s51, 90112
  s_add_u32 s46, s53, 205824
  buffer_load_dwordx4 v1, s[4:7], s46 offen  lds
  s_add_u32 m0, s51, 94208
  s_add_u32 s46, s53, 205952
  buffer_load_dwordx4 v1, s[4:7], s46 offen  lds
  ds_read_b64_tr_b16 a[104:105], v3 offset:32768
  ds_read_b64_tr_b16 a[106:107], v3 offset:33792
  ds_read_b64_tr_b16 a[128:129], v3 offset:36864
  ds_read_b64_tr_b16 a[130:131], v3 offset:37888
  ds_read_b64_tr_b16 a[152:153], v3 offset:40960
  ds_read_b64_tr_b16 a[154:155], v3 offset:41984
  ds_read_b64_tr_b16 a[176:177], v3 offset:45056
  ds_read_b64_tr_b16 a[178:179], v3 offset:46080
  ds_read_b64_tr_b16 a[200:201], v3 offset:49152
  ds_read_b64_tr_b16 a[202:203], v3 offset:50176
  ds_read_b64_tr_b16 a[224:225], v3 offset:53248
  ds_read_b64_tr_b16 a[226:227], v3 offset:54272
  s_waitcnt lgkmcnt(0)
  s_waitcnt vmcnt(25)
  s_barrier
  ds_read_b64_tr_b16 a[12:13], v3 offset:57344
  ds_read_b64_tr_b16 a[14:15], v3 offset:58368
  ds_read_b64_tr_b16 a[36:37], v3 offset:61440
  ds_read_b64_tr_b16 a[38:39], v3 offset:62464
  ds_read_b64_tr_b16 a[60:61], v4 offset:0
  ds_read_b64_tr_b16 a[62:63], v4 offset:1024
  ds_read_b64_tr_b16 a[84:85], v4 offset:4096
  ds_read_b64_tr_b16 a[86:87], v4 offset:5120
  ds_read_b64_tr_b16 a[108:109], v4 offset:8192
  ds_read_b64_tr_b16 a[110:111], v4 offset:9216
  ds_read_b64_tr_b16 a[132:133], v4 offset:12288
  ds_read_b64_tr_b16 a[134:135], v4 offset:13312
  s_waitcnt lgkmcnt(0)
  s_waitcnt vmcnt(19)
  s_barrier
  ds_read_b64_tr_b16 a[156:157], v2 offset:0
  ds_read_b64_tr_b16 a[158:159], v2 offset:1024
  ds_read_b64_tr_b16 a[180:181], v2 offset:4096
  ds_read_b64_tr_b16 a[182:183], v2 offset:5120
  ds_read_b64_tr_b16 a[204:205], v2 offset:8192
  ds_read_b64_tr_b16 a[206:207], v2 offset:9216
  ds_read_b64_tr_b16 a[228:229], v2 offset:12288
  ds_read_b64_tr_b16 a[230:231], v2 offset:13312
  ds_read_b64_tr_b16 a[16:17], v2 offset:16384
  ds_read_b64_tr_b16 a[18:19], v2 offset:17408
  ds_read_b64_tr_b16 a[40:41], v2 offset:20480
  ds_read_b64_tr_b16 a[42:43], v2 offset:21504
  s_waitcnt lgkmcnt(0)
  s_waitcnt vmcnt(13)
  s_barrier
  ds_read_b64_tr_b16 a[64:65], v2 offset:24576
  ds_read_b64_tr_b16 a[66:67], v2 offset:25600
  ds_read_b64_tr_b16 a[88:89], v2 offset:28672
  ds_read_b64_tr_b16 a[90:91], v2 offset:29696
  ds_read_b64_tr_b16 a[112:113], v2 offset:32768
  ds_read_b64_tr_b16 a[114:115], v2 offset:33792
  ds_read_b64_tr_b16 a[136:137], v2 offset:36864
  ds_read_b64_tr_b16 a[138:139], v2 offset:37888
  ds_read_b64_tr_b16 a[160:161], v2 offset:40960
  ds_read_b64_tr_b16 a[162:163], v2 offset:41984
  ds_read_b64_tr_b16 a[184:185], v2 offset:45056
  ds_read_b64_tr_b16 a[186:187], v2 offset:46080
  s_waitcnt lgkmcnt(0)
  s_waitcnt vmcnt(7)
  s_barrier
  ds_read_b64_tr_b16 a[208:209], v2 offset:49152
  ds_read_b64_tr_b16 a[210:211], v2 offset:50176
  ds_read_b64_tr_b16 a[232:233], v2 offset:53248
  ds_read_b64_tr_b16 a[234:235], v2 offset:54272
  ds_read_b64_tr_b16 a[20:21], v2 offset:57344
  ds_read_b64_tr_b16 a[22:23], v2 offset:58368
  ds_read_b64_tr_b16 a[44:45], v2 offset:61440
  ds_read_b64_tr_b16 a[46:47], v2 offset:62464
  ds_read_b64_tr_b16 a[68:69], v3 offset:0
  ds_read_b64_tr_b16 a[70:71], v3 offset:1024
  ds_read_b64_tr_b16 a[92:93], v3 offset:4096
  ds_read_b64_tr_b16 a[94:95], v3 offset:5120
  s_waitcnt lgkmcnt(0)
  s_waitcnt vmcnt(0)
  s_barrier
  ds_read_b64_tr_b16 a[116:117], v3 offset:8192
  ds_read_b64_tr_b16 a[118:119], v3 offset:9216
  ds_read_b64_tr_b16 a[140:141], v3 offset:12288
  ds_read_b64_tr_b16 a[142:143], v3 offset:13312
  ds_read_b64_tr_b16 a[164:165], v3 offset:16384
  ds_read_b64_tr_b16 a[166:167], v3 offset:17408
  ds_read_b64_tr_b16 a[188:189], v3 offset:20480
  ds_read_b64_tr_b16 a[190:191], v3 offset:21504
  ds_read_b64_tr_b16 a[212:213], v3 offset:24576
  ds_read_b64_tr_b16 a[214:215], v3 offset:25600
  ds_read_b64_tr_b16 a[236:237], v3 offset:28672
  ds_read_b64_tr_b16 a[238:239], v3 offset:29696
  s_waitcnt lgkmcnt(0)
  s_mov_b32 s50, 0
  s_branch ss_8_in
ss_8:
  v_and_b32 v9, 3, v0
  v_lshlrev_b32 v9, 2, v9
  global_load_dword v8, v9, s[38:39] sc1
  s_add_u32 s50, s50, 1
  s_cmp_gt_u32 s50, 131072
  s_cbranch_scc1 L_fail
  s_waitcnt vmcnt(0)
ss_8_in:
  v_readlane_b32 s46, v8, 0
  v_readlane_b32 s47, v8, 2
  v_readlane_b32 s48, v8, 1
  s_nop 0
  s_min_u32 s47, s47, s48
  s_cmp_lg_u32 s46, 0
  s_cselect_b32 s48, 7, 0
  s_add_u32 s46, s46, s2
  s_xor_b32 s49, s46, s43
  s_and_b32 s49, s49, s48
  s_cbranch_scc1 L_reroll
  s_cmp_lg_u32 s47, 0
  s_cbranch_scc1 ss_ok_9
  s_sleep 6
  s_branch ss_8
ss_ok_9:
  v_readlane_b32 s3, v8, 1
  s_nop 0
  s_and_b32 s3, s3, 0x2000
  s_barrier
  s_xor_b32 s61, s61, s3
  s_xor_b32 s55, s55, s3
  s_lshr_b32 s46, s45, 3
  s_lshr_b32 s46, 1, s46
  s_and_b32 s46, s46, 1
  s_lshl_b32 s46, s46, 13
  s_xor_b32 s55, s55, s46
  s_mov_b32 s57, 1
  s_cmp_ge_u32 s56, s57
  s_cbranch_scc1 wf_done_10
  s_mov_b32 s50, 0
wf_loop_11:
  buffer_load_dword v13, v6, s[8:11], 0 offen sc1
  s_add_u32 s50, s50, 1
  s_cmp_gt_u32 s50, 131072
  s_cbranch_scc1 L_fail
  s_waitcnt vmcnt(0)
  v_readfirstlane_b32 s56, v13
  s_nop 0
  s_cmp_ge_u32 s56, s57
  s_cbranch_scc1 wf_done_10
  s_sleep 2
  s_branch wf_loop_11
wf_done_10:
  s_lshr_b32 s54, s62, 1
  s_lshl_b32 s54, s54, 14
  s_and_b32 s47, s62, 1
  s_lshl_b32 s47, s47, 12
  s_add_u32 s54, s54, s47
  s_add_u32 s54, s54, s61
  s_lshr_b32 s47, s54, 8
  s_and_b32 s47, s47, 0x2000
  s_xor_b32 s54, s54, s47
  s_add_u32 m0, s60, 0
  s_add_u32 s47, s54, 0
  buffer_load_dwordx4 v5, s[8:11], s47 offen sc1 lds
  s_add_u32 m0, s60, 4096
  s_add_u32 s47, s54, 16777216
  buffer_load_dwordx4 v5, s[8:11], s47 offen sc1 lds
  s_add_u32 m0, s60, 8192
  s_add_u32 s47, s54, 33554432
  buffer_load_dwordx4 v5, s[8:11], s47 offen sc1 lds
  s_mov_b32 s59, 2146435072
  s_waitcnt vmcnt(0)
  s_barrier
  ds_read_b128 v[16:19], v12 offset:0
  ds_read_b128 v[40:43], v12 offset:2048
  ds_read_b128 v[20:23], v12 offset:1024
  ds_read_b128 v[44:47], v12 offset:3072
  ds_read_b128 v[24:27], v12 offset:4096
  ds_read_b128 v[48:51], v12 offset:6144
  ds_read_b128 v[28:31], v12 offset:5120
  ds_read_b128 v[52:55], v12 offset:7168
  ds_read_b128 v[32:35], v12 offset:8192
  ds_read_b128 v[56:59], v12 offset:10240
  ds_read_b128 v[36:39], v12 offset:9216
  ds_read_b128 v[60:63], v12 offset:11264
u_loop:
  s_waitcnt lgkmcnt(8)
  v_mfma_f32_16x16x32_bf16 v[64:67], v[16:19], a[0:3], 0
  buffer_load_dword v13, v6, s[8:11], 0 offen sc1
  v_mfma_f32_16x16x32_bf16 v[68:71], v[40:43], a[0:3], 0
  v_mfma_f32_16x16x32_bf16 v[64:67], v[20:23], a[4:7], v[64:67]
  v_cvt_pk_bf16_f32 v84, v72, v73
  v_mfma_f32_16x16x32_bf16 v[68:71], v[44:47], a[4:7], v[68:71]
  s_waitcnt lgkmcnt(4)
  v_cvt_pk_bf16_f32 v85, v74, v75
  v_mfma_f32_16x16x32_bf16 v[64:67], v[24:27], a[8:11], v[64:67]
  v_cvt_pk_bf16_f32 v86, v76, v77
  v_mfma_f32_16x16x32_bf16 v[68:71], v[48:51], a[8:11], v[68:71]
  v_cvt_pk_bf16_f32 v87, v78, v79
  v_mfma_f32_16x16x32_bf16 v[64:67], v[28:31], a[12:15], v[64:67]
  buffer_store_dwordx4 v[84:87], v5, s[8:11], s59 offen sc1
  v_mfma_f32_16x16x32_bf16 v[68:71], v[52:55], a[12:15], v[68:71]
  s_add_u32 s58, s55, 0
  s_waitcnt lgkmcnt(0)
  v_mfma_f32_16x16x32_bf16 v[64:67], v[32:35], a[16:19], v[64:67]
  s_lshr_b32 s46, s58, 8
  v_mfma_f32_16x16x32_bf16 v[68:71], v[56:59], a[16:19], v[68:71]
  s_and_b32 s46, s46, 0x2000
  v_mfma_f32_16x16x32_bf16 v[64:67], v[36:39], a[20:23], v[64:67]
  s_xor_b32 s58, s58, s46
  v_mfma_f32_16x16x32_bf16 v[68:71], v[60:63], a[20:23], v[68:71]
  v_mfma_f32_16x16x32_bf16 v[72:75], v[16:19], a[24:27], 0
  s_add_u32 s59, s55, 2359296
  v_mfma_f32_16x16x32_bf16 v[76:79], v[40:43], a[24:27], 0
  s_lshr_b32 s46, s59, 8
  v_mfma_f32_16x16x32_bf16 v[72:75], v[20:23], a[28:31], v[72:75]
  s_and_b32 s46, s46, 0x2000
  v_cvt_pk_bf16_f32 v80, v64, v65
  v_mfma_f32_16x16x32_bf16 v[76:79], v[44:47], a[28:31], v[76:79]
  s_xor_b32 s59, s59, s46
  v_cvt_pk_bf16_f32 v81, v66, v67
  v_mfma_f32_16x16x32_bf16 v[72:75], v[24:27], a[32:35], v[72:75]
  v_cvt_pk_bf16_f32 v82, v68, v69
  v_mfma_f32_16x16x32_bf16 v[76:79], v[48:51], a[32:35], v[76:79]
  s_add_u32 s57, s52, 2
  s_min_u32 s57, s57, 64
  v_cvt_pk_bf16_f32 v83, v70, v71
  v_mfma_f32_16x16x32_bf16 v[72:75], v[28:31], a[36:39], v[72:75]
  buffer_store_dwordx4 v[80:83], v5, s[8:11], s58 offen sc1
  v_mfma_f32_16x16x32_bf16 v[76:79], v[52:55], a[36:39], v[76:79]
  s_add_u32 s58, s55, 262144
  v_mfma_f32_16x16x32_bf16 v[72:75], v[32:35], a[40:43], v[72:75]
  s_lshr_b32 s46, s58, 8
  v_mfma_f32_16x16x32_bf16 v[76:79], v[56:59], a[40:43], v[76:79]
  s_and_b32 s46, s46, 0x2000
  v_mfma_f32_16x16x32_bf16 v[72:75], v[36:39], a[44:47], v[72:75]
  s_xor_b32 s58, s58, s46
  v_mfma_f32_16x16x32_bf16 v[76:79], v[60:63], a[44:47], v[76:79]
  s_xor_b32 s60, s60, 0x4000
  v_mov_b32 v8, s52
  v_mfma_f32_16x16x32_bf16 v[64:67], v[16:19], a[48:51], 0
  s_add_u32 s62, s62, 32
  v_xor_b32 v12, 0x4000, v12
  v_mfma_f32_16x16x32_bf16 v[68:71], v[40:43], a[48:51], 0
  s_cmp_ge_u32 s62, 1024
  s_cselect_b32 s47, 1024, 0
  v_mfma_f32_16x16x32_bf16 v[64:67], v[20:23], a[52:55], v[64:67]
  s_sub_u32 s62, s62, s47
  v_cvt_pk_bf16_f32 v84, v72, v73
  v_mfma_f32_16x16x32_bf16 v[68:71], v[44:47], a[52:55], v[68:71]
  s_lshr_b32 s54, s62, 1
  v_cvt_pk_bf16_f32 v85, v74, v75
  v_mfma_f32_16x16x32_bf16 v[64:67], v[24:27], a[56:59], v[64:67]
  s_lshl_b32 s54, s54, 14
  v_cvt_pk_bf16_f32 v86, v76, v77
  v_mfma_f32_16x16x32_bf16 v[68:71], v[48:51], a[56:59], v[68:71]
  s_and_b32 s47, s62, 1
  v_cvt_pk_bf16_f32 v87, v78, v79
  v_mfma_f32_16x16x32_bf16 v[64:67], v[28:31], a[60:63], v[64:67]
  buffer_store_dwordx4 v[84:87], v5, s[8:11], s58 offen sc1
  s_lshl_b32 s47, s47, 12
  v_mfma_f32_16x16x32_bf16 v[68:71], v[52:55], a[60:63], v[68:71]
  s_add_u32 s58, s55, 524288
  s_add_u32 s54, s54, s47
  v_mfma_f32_16x16x32_bf16 v[64:67], v[32:35], a[64:67], v[64:67]
  s_lshr_b32 s46, s58, 8
  s_add_u32 s54, s54, s61
  v_mfma_f32_16x16x32_bf16 v[68:71], v[56:59], a[64:67], v[68:71]
  s_and_b32 s46, s46, 0x2000
  s_lshr_b32 s47, s54, 8
  v_mfma_f32_16x16x32_bf16 v[64:67], v[36:39], a[68:71], v[64:67]
  s_xor_b32 s58, s58, s46
  s_and_b32 s47, s47, 0x2000
  v_mfma_f32_16x16x32_bf16 v[68:71], v[60:63], a[68:71], v[68:71]
  s_xor_b32 s54, s54, s47
  v_mfma_f32_16x16x32_bf16 v[72:75], v[16:19], a[72:75], 0
  v_mfma_f32_16x16x32_bf16 v[76:79], v[40:43], a[72:75], 0
  v_mfma_f32_16x16x32_bf16 v[72:75], v[20:23], a[76:79], v[72:75]
  v_cvt_pk_bf16_f32 v80, v64, v65
  v_mfma_f32_16x16x32_bf16 v[76:79], v[44:47], a[76:79], v[76:79]
  v_cvt_pk_bf16_f32 v81, v66, v67
  v_mfma_f32_16x16x32_bf16 v[72:75], v[24:27], a[80:83], v[72:75]
  v_cvt_pk_bf16_f32 v82, v68, v69
  v_mfma_f32_16x16x32_bf16 v[76:79], v[48:51], a[80:83], v[76:79]
  v_cvt_pk_bf16_f32 v83, v70, v71
  v_mfma_f32_16x16x32_bf16 v[72:75], v[28:31], a[84:87], v[72:75]
  buffer_store_dwordx4 v[80:83], v5, s[8:11], s58 offen sc1
  v_mfma_f32_16x16x32_bf16 v[76:79], v[52:55], a[84:87], v[76:79]
  s_add_u32 s58, s55, 786432
  v_mfma_f32_16x16x32_bf16 v[72:75], v[32:35], a[88:91], v[72:75]
  s_lshr_b32 s46, s58, 8
  v_mfma_f32_16x16x32_bf16 v[76:79], v[56:59], a[88:91], v[76:79]
  s_and_b32 s46, s46, 0x2000
  v_mfma_f32_16x16x32_bf16 v[72:75], v[36:39], a[92:95], v[72:75]
  s_xor_b32 s58, s58, s46
  s_waitcnt vmcnt(3)
  v_readfirstlane_b32 s56, v13
  v_mfma_f32_16x16x32_bf16 v[76:79], v[60:63], a[92:95], v[76:79]
  buffer_store_dword v8, v7, s[8:11], 0 offen sc1
  v_mfma_f32_16x16x32_bf16 v[64:67], v[16:19], a[96:99], 0
  s_cmp_lt_u32 s56, s57
  s_cbranch_scc1 u_slow
u_back:
  v_mfma_f32_16x16x32_bf16 v[68:71], v[40:43], a[96:99], 0
  s_add_u32 m0, s60, 0
  s_add_u32 s47, s54, 0
  buffer_load_dwordx4 v5, s[8:11], s47 offen sc1 lds
  v_mfma_f32_16x16x32_bf16 v[64:67], v[20:23], a[100:103], v[64:67]
  s_add_u32 m0, s60, 4096
  s_add_u32 s47, s54, 16777216
  buffer_load_dwordx4 v5, s[8:11], s47 offen sc1 lds
  v_cvt_pk_bf16_f32 v84, v72, v73
  v_mfma_f32_16x16x32_bf16 v[68:71], v[44:47], a[100:103], v[68:71]
  s_add_u32 m0, s60, 8192
  s_add_u32 s47, s54, 33554432
  buffer_load_dwordx4 v5, s[8:11], s47 offen sc1 lds
  v_cvt_pk_bf16_f32 v85, v74, v75
  v_mfma_f32_16x16x32_bf16 v[64:67], v[24:27], a[104:107], v[64:67]
  v_cvt_pk_bf16_f32 v86, v76, v77
  v_mfma_f32_16x16x32_bf16 v[68:71], v[48:51], a[104:107], v[68:71]
  v_cvt_pk_bf16_f32 v87, v78, v79
  v_mfma_f32_16x16x32_bf16 v[64:67], v[28:31], a[108:111], v[64:67]
  buffer_store_dwordx4 v[84:87], v5, s[8:11], s58 offen sc1
  v_mfma_f32_16x16x32_bf16 v[68:71], v[52:55], a[108:111], v[68:71]
  s_add_u32 s58, s55, 1048576
  v_mfma_f32_16x16x32_bf16 v[64:67], v[32:35], a[112:115], v[64:67]
  s_lshr_b32 s46, s58, 8
  v_mfma_f32_16x16x32_bf16 v[68:71], v[56:59], a[112:115], v[68:71]
  s_and_b32 s46, s46, 0x2000
  v_mfma_f32_16x16x32_bf16 v[64:67], v[36:39], a[116:119], v[64:67]
  s_xor_b32 s58, s58, s46
  v_mfma_f32_16x16x32_bf16 v[68:71], v[60:63], a[116:119], v[68:71]
  v_mfma_f32_16x16x32_bf16 v[72:75], v[16:19], a[120:123], 0
  v_mfma_f32_16x16x32_bf16 v[76:79], v[40:43], a[120:123], 0
  v_mfma_f32_16x16x32_bf16 v[72:75], v[20:23], a[124:127], v[72:75]
  v_cvt_pk_bf16_f32 v80, v64, v65
  v_mfma_f32_16x16x32_bf16 v[76:79], v[44:47], a[124:127], v[76:79]
  v_cvt_pk_bf16_f32 v81, v66, v67
  v_mfma_f32_16x16x32_bf16 v[72:75], v[24:27], a[128:131], v[72:75]
  v_cvt_pk_bf16_f32 v82, v68, v69
  v_mfma_f32_16x16x32_bf16 v[76:79], v[48:51], a[128:131], v[76:79]
  v_cvt_pk_bf16_f32 v83, v70, v71
  v_mfma_f32_16x16x32_bf16 v[72:75], v[28:31], a[132:135], v[72:75]
  buffer_store_dwordx4 v[80:83], v5, s[8:11], s58 offen sc1
  v_mfma_f32_16x16x32_bf16 v[76:79], v[52:55], a[132:135], v[76:79]
  s_add_u32 s58, s55, 1310720
  v_mfma_f32_16x16x32_bf16 v[72:75], v[32:35], a[136:139], v[72:75]
  s_lshr_b32 s46, s58, 8
  v_mfma_f32_16x16x32_bf16 v[76:79], v[56:59], a[136:139], v[76:79]
  s_and_b32 s46, s46, 0x2000
  v_mfma_f32_16x16x32_bf16 v[72:75], v[36:39], a[140:143], v[72:75]
  s_xor_b32 s58, s58, s46
  v_mfma_f32_16x16x32_bf16 v[76:79], v[60:63], a[140:143], v[76:79]
  v_mfma_f32_16x16x32_bf16 v[64:67], v[16:19], a[144:147], 0
  v_mfma_f32_16x16x32_bf16 v[68:71], v[40:43], a[144:147], 0
  v_mfma_f32_16x16x32_bf16 v[64:67], v[20:23], a[148:151], v[64:67]
  v_cvt_pk_bf16_f32 v84, v72, v73
  v_mfma_f32_16x16x32_bf16 v[68:71], v[44:47], a[148:151], v[68:71]
  v_cvt_pk_bf16_f32 v85, v74, v75
  v_mfma_f32_16x16x32_bf16 v[64:67], v[24:27], a[152:155], v[64:67]
  v_cvt_pk_bf16_f32 v86, v76, v77
  v_mfma_f32_16x16x32_bf16 v[68:71], v[48:51], a[152:155], v[68:71]
  v_cvt_pk_bf16_f32 v87, v78, v79
  v_mfma_f32_16x16x32_bf16 v[64:67], v[28:31], a[156:159], v[64:67]
  buffer_store_dwordx4 v[84:87], v5, s[8:11], s58 offen sc1
  v_mfma_f32_16x16x32_bf16 v[68:71], v[52:55], a[156:159], v[68:71]
  s_add_u32 s58, s55, 1572864
  v_mfma_f32_16x16x32_bf16 v[64:67], v[32:35], a[160:163], v[64:67]
  s_lshr_b32 s46, s58, 8
  v_mfma_f32_16x16x32_bf16 v[68:71], v[56:59], a[160:163], v[68:71]
  s_and_b32 s46, s46, 0x2000
  v_mfma_f32_16x16x32_bf16 v[64:67], v[36:39], a[164:167], v[64:67]
  s_xor_b32 s58, s58, s46
  v_mfma_f32_16x16x32_bf16 v[68:71], v[60:63], a[164:167], v[68:71]
  v_mfma_f32_16x16x32_bf16 v[72:75], v[16:19], a[168:171], 0
  v_mfma_f32_16x16x32_bf16 v[76:79], v[40:43], a[168:171], 0
  v_mfma_f32_16x16x32_bf16 v[72:75], v[20:23], a[172:175], v[72:75]
  v_cvt_pk_bf16_f32 v80, v64, v65
  v_mfma_f32_16x16x32_bf16 v[76:79], v[44:47], a[172:175], v[76:79]
  v_cvt_pk_bf16_f32 v81, v66, v67
  v_mfma_f32_16x16x32_bf16 v[72:75], v[24:27], a[176:179], v[72:75]
  v_cvt_pk_bf16_f32 v82, v68, v69
  v_mfma_f32_16x16x32_bf16 v[76:79], v[48:51], a[176:179], v[76:79]
  v_cvt_pk_bf16_f32 v83, v70, v71
  v_mfma_f32_16x16x32_bf16 v[72:75], v[28:31], a[180:183], v[72:75]
  buffer_store_dwordx4 v[80:83], v5, s[8:11], s58 offen sc1
  v_mfma_f32_16x16x32_bf16 v[76:79], v[52:55], a[180:183], v[76:79]
  s_add_u32 s58, s55, 1835008
  v_mfma_f32_16x16x32_bf16 v[72:75], v[32:35], a[184:187], v[72:75]
  s_lshr_b32 s46, s58, 8
  v_mfma_f32_16x16x32_bf16 v[76:79], v[56:59], a[184:187], v[76:79]
  s_and_b32 s46, s46, 0x2000
  v_mfma_f32_16x16x32_bf16 v[72:75], v[36:39], a[188:191], v[72:75]
  s_xor_b32 s58, s58, s46
  v_mfma_f32_16x16x32_bf16 v[76:79], v[60:63], a[188:191], v[76:79]
  v_mfma_f32_16x16x32_bf16 v[64:67], v[16:19], a[192:195], 0
  v_mfma_f32_16x16x32_bf16 v[68:71], v[40:43], a[192:195], 0
  v_mfma_f32_16x16x32_bf16 v[64:67], v[20:23], a[196:199], v[64:67]
  v_cvt_pk_bf16_f32 v84, v72, v73
  v_mfma_f32_16x16x32_bf16 v[68:71], v[44:47], a[196:199], v[68:71]
  v_cvt_pk_bf16_f32 v85, v74, v75
  v_mfma_f32_16x16x32_bf16 v[64:67], v[24:27], a[200:203], v[64:67]
  v_cvt_pk_bf16_f32 v86, v76, v77
  v_mfma_f32_16x16x32_bf16 v[68:71], v[48:51], a[200:203], v[68:71]
  v_cvt_pk_bf16_f32 v87, v78, v79
  v_mfma_f32_16x16x32_bf16 v[64:67], v[28:31], a[204:207], v[64:67]
  buffer_store_dwordx4 v[84:87], v5, s[8:11], s58 offen sc1
  v_mfma_f32_16x16x32_bf16 v[68:71], v[52:55], a[204:207], v[68:71]
  s_add_u32 s58, s55, 2097152
  v_mfma_f32_16x16x32_bf16 v[64:67], v[32:35], a[208:211], v[64:67]
  s_lshr_b32 s46, s58, 8
  v_mfma_f32_16x16x32_bf16 v[68:71], v[56:59], a[208:211], v[68:71]
  s_and_b32 s46, s46, 0x2000
  v_mfma_f32_16x16x32_bf16 v[64:67], v[36:39], a[212:215], v[64:67]
  s_xor_b32 s58, s58, s46
  s_waitcnt vmcnt(5)
  s_barrier
  v_mfma_f32_16x16x32_bf16 v[68:71], v[60:63], a[212:215], v[68:71]
  s_add_u32 s55, s55, 2621440
  v_mfma_f32_16x16x32_bf16 v[72:75], v[16:19], a[216:219], 0
  ds_read_b128 v[16:19], v12 offset:0
  v_mfma_f32_16x16x32_bf16 v[76:79], v[40:43], a[216:219], 0
  ds_read_b128 v[40:43], v12 offset:2048
  v_mfma_f32_16x16x32_bf16 v[72:75], v[20:23], a[220:223], v[72:75]
  ds_read_b128 v[20:23], v12 offset:1024
  v_cvt_pk_bf16_f32 v80, v64, v65
  v_mfma_f32_16x16x32_bf16 v[76:79], v[44:47], a[220:223], v[76:79]
  ds_read_b128 v[44:47], v12 offset:3072
  v_cvt_pk_bf16_f32 v81, v66, v67
  v_mfma_f32_16x16x32_bf16 v[72:75], v[24:27], a[224:227], v[72:75]
  ds_read_b128 v[24:27], v12 offset:4096
  v_cvt_pk_bf16_f32 v82, v68, v69
  v_mfma_f32_16x16x32_bf16 v[76:79], v[48:51], a[224:227], v[76:79]
  ds_read_b128 v[48:51], v12 offset:6144
  v_cvt_pk_bf16_f32 v83, v70, v71
  v_mfma_f32_16x16x32_bf16 v[72:75], v[28:31], a[228:231], v[72:75]
  buffer_store_dwordx4 v[80:83], v5, s[8:11], s58 offen sc1
  ds_read_b128 v[28:31], v12 offset:5120
  v_mfma_f32_16x16x32_bf16 v[76:79], v[52:55], a[228:231], v[76:79]
  ds_read_b128 v[52:55], v12 offset:7168
  s_cmp_ge_u32 s55, 165675008
  s_cselect_b32 s46, 83886080, 0
  v_mfma_f32_16x16x32_bf16 v[72:75], v[32:35], a[232:235], v[72:75]
  ds_read_b128 v[32:35], v12 offset:8192
  s_sub_u32 s55, s55, s46
  v_mfma_f32_16x16x32_bf16 v[76:79], v[56:59], a[232:235], v[76:79]
  ds_read_b128 v[56:59], v12 offset:10240
  s_add_u32 s52, s52, 1
  v_mfma_f32_16x16x32_bf16 v[72:75], v[36:39], a[236:239], v[72:75]
  ds_read_b128 v[36:39], v12 offset:9216
  s_cmp_lt_u32 s52, 64
  v_mfma_f32_16x16x32_bf16 v[76:79], v[60:63], a[236:239], v[76:79]
  ds_read_b128 v[60:63], v12 offset:11264
  s_cbranch_scc1 u_loop
  s_nop 2
  v_cvt_pk_bf16_f32 v84, v72, v73
  v_cvt_pk_bf16_f32 v85, v74, v75
  s_nop 0
  v_cvt_pk_bf16_f32 v86, v76, v77
  v_cvt_pk_bf16_f32 v87, v78, v79
  buffer_store_dwordx4 v[84:87], v5, s[8:11], s59 offen sc1
  v_mov_b32 v8, s52
  s_waitcnt vmcnt(0) lgkmcnt(0)
  buffer_store_dword v8, v7, s[8:11], 0 offen sc1
  s_branch u_done
u_slow:
  s_cmp_ge_u32 s56, s57
  s_cbranch_scc1 wf_done_12
  s_mov_b32 s50, 0
wf_loop_13:
  buffer_load_dword v13, v6, s[8:11], 0 offen sc1
  s_add_u32 s50, s50, 1
  s_cmp_gt_u32 s50, 131072
  s_cbranch_scc1 L_fail
  s_waitcnt vmcnt(0)
  v_readfirstlane_b32 s56, v13
  s_nop 0
  s_cmp_ge_u32 s56, s57
  s_cbranch_scc1 wf_done_12
  s_sleep 2
  s_branch wf_loop_13
wf_done_12:
  s_branch u_back
u_done:
L_parta:
  s_barrier
  s_lshl_b32 s65, s44, 2
  s_add_u32 s65, s65, s43
  s_sub_u32 s65, s65, 4
  s_cmp_ge_u32 s65, 120
  s_cbranch_scc1 pa_att
  s_mov_b32 s4, s18
  s_mov_b32 s5, s19
  s_mov_b32 s6, 2457600
  s_mov_b32 s7, 0x20000
  s_mov_b32 s12, s16
  s_mov_b32 s13, s17
  s_mov_b32 s14, 2621440
  s_mov_b32 s15, 0x20000
  s_mul_i32 s46, s65, 205
  s_lshr_b32 s46, s46, 11
  s_mul_i32 s47, s46, 10
  s_sub_u32 s47, s65, s47
  s_mul_i32 s60, s47, 384
  s_lshl_b32 s67, s47, 6
  s_mov_b32 s63, 176168960
  s_mul_i32 s61, s46, 6
  s_add_u32 s62, s61, 6
  s_mul_i32 s48, s46, 3
  s_add_u32 s49, s48, 31
  s_add_u32 s48, s48, 28
  s_min_u32 s61, s61, s48
  s_min_u32 s62, s62, s49
  s_add_u32 s67, s67, s61
  s_lshl_b32 s64, s65, 7
  s_add_u32 s64, s64, 1081344
  v_lshrrev_b32 v10, 3, v0
  v_lshrrev_b32 v11, 2, v10
  v_lshlrev_b32 v11, 3, v11
  v_and_b32 v1, 3, v10
  v_add_u32 v1, v1, v11
  s_and_b32 s46, s42, 1
  s_lshl_b32 s46, s46, 2
  s_lshr_b32 s47, s42, 1
  s_lshl_b32 s47, s47, 4
  s_add_u32 s46, s46, s47
  v_add_u32 v1, s46, v1
  v_mul_u32_u24 v1, 3840, v1
  v_lshrrev_b32 v10, 1, v10
  v_bfe_u32 v11, v0, 1, 2
  v_xor_b32 v10, v10, v11
  v_lshlrev_b32 v10, 5, v10
  v_and_b32 v11, 1, v0
  v_lshlrev_b32 v11, 4, v11
  v_add3_u32 v1, v1, v10, v11
  v_lshrrev_b32 v10, 5, v0
  v_lshlrev_b32 v2, 11, v10
  v_bfe_u32 v10, v0, 2, 3
  v_lshl_add_u32 v2, v10, 7, v2
  v_lshrrev_b32 v10, 1, v10
  v_xor_b32 v10, s42, v10
  v_lshl_add_u32 v2, v10, 5, v2
  v_and_b32 v10, 3, v0
  v_lshl_add_u32 v2, v10, 3, v2
  v_add_u32 v3, 0x10000, v2
  v_add_u32 v4, 0x20000, v2
  v_lshrrev_b32 v10, 3, v0
  s_lshl_b32 s46, s42, 3
  v_add_u32 v10, s46, v10
  v_mul_u32_u24 v5, 1280, v10
  v_bfe_u32 v10, v10, 1, 3
  v_and_b32 v11, 7, v0
  v_xor_b32 v10, v10, v11
  v_lshl_add_u32 v5, v10, 4, v5
  v_and_b32 v10, 15, v0
  v_lshlrev_b32 v6, 7, v10
  v_lshrrev_b32 v10, 1, v10
  v_lshrrev_b32 v11, 4, v0
  v_xor_b32 v10, v10, v11
  v_lshl_add_u32 v6, v10, 4, v6
  v_add_u32 v6, 122880, v6
  v_xor_b32 v7, 64, v6
  v_and_b32 v10, 15, v0
  v_lshlrev_b32 v8, 4, v10
  v_bfe_u32 v10, v0, 4, 1
  v_lshlrev_b32 v10, 11, v10
  v_lshrrev_b32 v11, 5, v0
  v_lshlrev_b32 v11, 8, v11
  v_add3_u32 v8, v8, v10, v11
  s_lshl_b32 s46, s42, 9
  v_add_u32 v8, s46, v8
  v_mov_b32 v9, s64
  v_mov_b32 v10, 2146435072
  s_cmp_eq_u32 s42, 0
  s_cselect_b64 vcc, 1, 0
  v_cndmask_b32 v9, v10, v9, vcc
  s_lshl_b32 s46, s43, 7
  s_add_u32 s46, s46, 1076736
  v_mov_b32 v14, s46
  s_mov_b32 s68, 0
  s_lshr_b32 s70, s44, 5
  s_add_u32 s70, s70, 8
  s_mov_b32 s52, s61
  s_mul_i32 s53, s52, 40960
  s_add_u32 s54, s51, 122880
  s_add_u32 m0, s54, 0
  s_nop 0
  buffer_load_dwordx4 v5, s[12:15], s53 offen offset:0 lds
  s_add_u32 m0, s54, 3968
  s_nop 0
  buffer_load_dwordx4 v5, s[12:15], s53 offen offset:128 lds
  s_add_u32 m0, s54, 7936
  s_nop 0
  buffer_load_dwordx4 v5, s[12:15], s53 offen offset:256 lds
  s_add_u32 m0, s54, 11904
  s_nop 0
  buffer_load_dwordx4 v5, s[12:15], s53 offen offset:384 lds
  s_add_u32 m0, s54, 15872
  s_nop 0
  buffer_load_dwordx4 v5, s[12:15], s53 offen offset:512 lds
  s_add_u32 m0, s54, 19840
  s_nop 0
  buffer_load_dwordx4 v5, s[12:15], s53 offen offset:640 lds
  s_add_u32 m0, s54, 23808
  s_nop 0
  buffer_load_dwordx4 v5, s[12:15], s53 offen offset:768 lds
  s_add_u32 m0, s54, 27776
  s_nop 0
  buffer_load_dwordx4 v5, s[12:15], s53 offen offset:896 lds
  s_add_u32 m0, s54, 31744
  s_nop 0
  buffer_load_dwordx4 v5, s[12:15], s53 offen offset:1024 lds
  s_add_u32 m0, s54, 35712
  s_nop 0
  buffer_load_dwordx4 v5, s[12:15], s53 offen offset:1152 lds
  s_add_u32 m0, s51, 0
  s_add_u32 s46, s60, 0
  buffer_load_dwordx4 v1, s[4:7], s46 offen  lds
  s_add_u32 m0, s51, 4096
  s_add_u32 s46, s60, 128
  buffer_load_dwordx4 v1, s[4:7], s46 offen  lds
  s_add_u32 m0, s51, 8192
  s_add_u32 s46, s60, 256
  buffer_load_dwordx4 v1, s[4:7], s46 offen  lds
  s_add_u32 m0, s51, 12288
  s_add_u32 s46, s60, 122880
  buffer_load_dwordx4 v1, s[4:7], s46 offen  lds
  s_add_u32 m0, s51, 16384
  s_add_u32 s46, s60, 123008
  buffer_load_dwordx4 v1, s[4:7], s46 offen  lds
  s_add_u32 m0, s51, 20480
  s_add_u32 s46, s60, 123136
  buffer_load_dwordx4 v1, s[4:7], s46 offen  lds
  s_add_u32 m0, s51, 24576
  s_add_u32 s46, s60, 245760
  buffer_load_dwordx4 v1, s[4:7], s46 offen  lds
  s_add_u32 m0, s51, 28672
  s_add_u32 s46, s60, 245888
  buffer_load_dwordx4 v1, s[4:7], s46 offen  lds
  s_add_u32 m0, s51, 32768
  s_add_u32 s46, s60, 246016
  buffer_load_dwordx4 v1, s[4:7], s46 offen  lds
  s_add_u32 m0, s51, 36864
  s_add_u32 s46, s60, 368640
  buffer_load_dwordx4 v1, s[4:7], s46 offen  lds
  s_add_u32 m0, s51, 40960
  s_add_u32 s46, s60, 368768
  buffer_load_dwordx4 v1, s[4:7], s46 offen  lds
  s_add_u32 m0, s51, 45056
  s_add_u32 s46, s60, 368896
  buffer_load_dwordx4 v1, s[4:7], s46 offen  lds
  s_add_u32 m0, s51, 49152
  s_add_u32 s46, s60, 491520
  buffer_load_dwordx4 v1, s[4:7], s46 offen  lds
  s_add_u32 m0, s51, 53248
  s_add_u32 s46, s60, 491648
  buffer_load_dwordx4 v1, s[4:7], s46 offen  lds
  s_add_u32 m0, s51, 57344
  s_add_u32 s46, s60, 491776
  buffer_load_dwordx4 v1, s[4:7], s46 offen  lds
  s_add_u32 m0, s51, 61440
  s_add_u32 s46, s60, 614400
  buffer_load_dwordx4 v1, s[4:7], s46 offen  lds
  s_add_u32 m0, s51, 65536
  s_add_u32 s46, s60, 614528
  buffer_load_dwordx4 v1, s[4:7], s46 offen  lds
  s_add_u32 m0, s51, 69632
  s_add_u32 s46, s60, 614656
  buffer_load_dwordx4 v1, s[4:7], s46 offen  lds
  s_add_u32 m0, s51, 73728
  s_add_u32 s46, s60, 737280
  buffer_load_dwordx4 v1, s[4:7], s46 offen  lds
  s_add_u32 m0, s51, 77824
  s_add_u32 s46, s60, 737408
  buffer_load_dwordx4 v1, s[4:7], s46 offen  lds
  s_add_u32 m0, s51, 81920
  s_add_u32 s46, s60, 737536
  buffer_load_dwordx4 v1, s[4:7], s46 offen  lds
  s_add_u32 m0, s51, 86016
  s_add_u32 s46, s60, 860160
  buffer_load_dwordx4 v1, s[4:7], s46 offen  lds
  s_add_u32 m0, s51, 90112
  s_add_u32 s46, s60, 860288
  buffer_load_dwordx4 v1, s[4:7], s46 offen  lds
  s_add_u32 m0, s51, 94208
  s_add_u32 s46, s60, 860416
  buffer_load_dwordx4 v1, s[4:7], s46 offen  lds
  s_waitcnt vmcnt(18)
  s_barrier
  s_add_u32 m0, s51, 98304
  s_add_u32 s46, s60, 983040
  buffer_load_dwordx4 v1, s[4:7], s46 offen  lds
  s_add_u32 m0, s51, 102400
  s_add_u32 s46, s60, 983168
  buffer_load_dwordx4 v1, s[4:7], s46 offen  lds
  s_add_u32 m0, s51, 106496
  s_add_u32 s46, s60, 983296
  buffer_load_dwordx4 v1, s[4:7], s46 offen  lds
  s_add_u32 m0, s51, 110592
  s_add_u32 s46, s60, 1105920
  buffer_load_dwordx4 v1, s[4:7], s46 offen  lds
  s_add_u32 m0, s51, 114688
  s_add_u32 s46, s60, 1106048
  buffer_load_dwordx4 v1, s[4:7], s46 offen  lds
  s_add_u32 m0, s51, 118784
  s_add_u32 s46, s60, 1106176
  buffer_load_dwordx4 v1, s[4:7], s46 offen  lds
  ds_read_b64_tr_b16 a[0:1], v2 offset:0
  ds_read_b64_tr_b16 a[2:3], v2 offset:1024
  ds_read_b64_tr_b16 a[4:5], v2 offset:4096
  ds_read_b64_tr_b16 a[6:7], v2 offset:5120
  ds_read_b64_tr_b16 a[8:9], v2 offset:8192
  ds_read_b64_tr_b16 a[10:11], v2 offset:9216
  ds_read_b64_tr_b16 a[12:13], v2 offset:12288
  ds_read_b64_tr_b16 a[14:15], v2 offset:13312
  ds_read_b64_tr_b16 a[16:17], v2 offset:16384
  ds_read_b64_tr_b16 a[18:19], v2 offset:17408
  ds_read_b64_tr_b16 a[20:21], v2 offset:20480
  ds_read_b64_tr_b16 a[22:23], v2 offset:21504
  s_waitcnt lgkmcnt(0)
  s_waitcnt vmcnt(18)
  s_barrier
  s_add_u32 m0, s51, 0
  s_add_u32 s46, s60, 1228800
  buffer_load_dwordx4 v1, s[4:7], s46 offen  lds
  s_add_u32 m0, s51, 4096
  s_add_u32 s46, s60, 1228928
  buffer_load_dwordx4 v1, s[4:7], s46 offen  lds
  s_add_u32 m0, s51, 8192
  s_add_u32 s46, s60, 1229056
  buffer_load_dwordx4 v1, s[4:7], s46 offen  lds
  s_add_u32 m0, s51, 12288
  s_add_u32 s46, s60, 1351680
  buffer_load_dwordx4 v1, s[4:7], s46 offen  lds
  s_add_u32 m0, s51, 16384
  s_add_u32 s46, s60, 1351808
  buffer_load_dwordx4 v1, s[4:7], s46 offen  lds
  s_add_u32 m0, s51, 20480
  s_add_u32 s46, s60, 1351936
  buffer_load_dwordx4 v1, s[4:7], s46 offen  lds
  ds_read_b64_tr_b16 a[24:25], v2 offset:24576
  ds_read_b64_tr_b16 a[26:27], v2 offset:25600
  ds_read_b64_tr_b16 a[28:29], v2 offset:28672
  ds_read_b64_tr_b16 a[30:31], v2 offset:29696
  ds_read_b64_tr_b16 a[32:33], v2 offset:32768
  ds_read_b64_tr_b16 a[34:35], v2 offset:33792
  ds_read_b64_tr_b16 a[36:37], v2 offset:36864
  ds_read_b64_tr_b16 a[38:39], v2 offset:37888
  ds_read_b64_tr_b16 a[40:41], v2 offset:40960
  ds_read_b64_tr_b16 a[42:43], v2 offset:41984
  ds_read_b64_tr_b16 a[44:45], v2 offset:45056
  ds_read_b64_tr_b16 a[46:47], v2 offset:46080
  s_waitcnt lgkmcnt(0)
  s_waitcnt vmcnt(18)
  s_barrier
  s_add_u32 m0, s51, 24576
  s_add_u32 s46, s60, 1474560
  buffer_load_dwordx4 v1, s[4:7], s46 offen  lds
  s_add_u32 m0, s51, 28672
  s_add_u32 s46, s60, 1474688
  buffer_load_dwordx4 v1, s[4:7], s46 offen  lds
  s_add_u32 m0, s51, 32768
  s_add_u32 s46, s60, 1474816
  buffer_load_dwordx4 v1, s[4:7], s46 offen  lds
  s_add_u32 m0, s51, 36864
  s_add_u32 s46, s60, 1597440
  buffer_load_dwordx4 v1, s[4:7], s46 offen  lds
  s_add_u32 m0, s51, 40960
  s_add_u32 s46, s60, 1597568
  buffer_load_dwordx4 v1, s[4:7], s46 offen  lds
  s_add_u32 m0, s51, 45056
  s_add_u32 s46, s60, 1597696
  buffer_load_dwordx4 v1, s[4:7], s46 offen  lds
  ds_read_b64_tr_b16 a[48:49], v2 offset:49152
  ds_read_b64_tr_b16 a[50:51], v2 offset:50176
  ds_read_b64_tr_b16 a[52:53], v2 offset:53248
  ds_read_b64_tr_b16 a[54:55], v2 offset:54272
  ds_read_b64_tr_b16 a[56:57], v2 offset:57344
  ds_read_b64_tr_b16 a[58:59], v2 offset:58368
  ds_read_b64_tr_b16 a[60:61], v2 offset:61440
  ds_read_b64_tr_b16 a[62:63], v2 offset:62464
  ds_read_b64_tr_b16 a[64:65], v3 offset:0
  ds_read_b64_tr_b16 a[66:67], v3 offset:1024
  ds_read_b64_tr_b16 a[68:69], v3 offset:4096
  ds_read_b64_tr_b16 a[70:71], v3 offset:5120
  s_waitcnt lgkmcnt(0)
  s_waitcnt vmcnt(18)
  s_barrier
  s_add_u32 m0, s51, 49152
  s_add_u32 s46, s60, 1720320
  buffer_load_dwordx4 v1, s[4:7], s46 offen  lds
  s_add_u32 m0, s51, 53248
  s_add_u32 s46, s60, 1720448
  buffer_load_dwordx4 v1, s[4:7], s46 offen  lds
  s_add_u32 m0, s51, 57344
  s_add_u32 s46, s60, 1720576
  buffer_load_dwordx4 v1, s[4:7], s46 offen  lds
  s_add_u32 m0, s51, 61440
  s_add_u32 s46, s60, 1843200
  buffer_load_dwordx4 v1, s[4:7], s46 offen  lds
  s_add_u32 m0, s51, 65536
  s_add_u32 s46, s60, 1843328
  buffer_load_dwordx4 v1, s[4:7], s46 offen  lds
  s_add_u32 m0, s51, 69632
  s_add_u32 s46, s60, 1843456
  buffer_load_dwordx4 v1, s[4:7], s46 offen  lds
  ds_read_b64_tr_b16 a[72:73], v3 offset:8192
  ds_read_b64_tr_b16 a[74:75], v3 offset:9216
  ds_read_b64_tr_b16 a[76:77], v3 offset:12288
  ds_read_b64_tr_b16 a[78:79], v3 offset:13312
  ds_read_b64_tr_b16 a[80:81], v3 offset:16384
  ds_read_b64_tr_b16 a[82:83], v3 offset:17408
  ds_read_b64_tr_b16 a[84:85], v3 offset:20480
  ds_read_b64_tr_b16 a[86:87], v3 offset:21504
  ds_read_b64_tr_b16 a[88:89], v3 offset:24576
  ds_read_b64_tr_b16 a[90:91], v3 offset:25600
  ds_read_b64_tr_b16 a[92:93], v3 offset:28672
  ds_read_b64_tr_b16 a[94:95], v3 offset:29696
  s_waitcnt lgkmcnt(0)
  s_waitcnt vmcnt(18)
  s_barrier
  s_add_u32 m0, s51, 73728
  s_add_u32 s46, s60, 1966080
  buffer_load_dwordx4 v1, s[4:7], s46 offen  lds
  s_add_u32 m0, s51, 77824
  s_add_u32 s46, s60, 1966208
  buffer_load_dwordx4 v1, s[4:7], s46 offen  lds
  s_add_u32 m0, s51, 81920
  s_add_u32 s46, s60, 1966336
  buffer_load_dwordx4 v1, s[4:7], s46 offen  lds
  s_add_u32 m0, s51, 86016
  s_add_u32 s46, s60, 2088960
  buffer_load_dwordx4 v1, s[4:7], s46 offen  lds
  s_add_u32 m0, s51, 90112
  s_add_u32 s46, s60, 2089088
  buffer_load_dwordx4 v1, s[4:7], s46 offen  lds
  s_add_u32 m0, s51, 94208
  s_add_u32 s46, s60, 2089216
  buffer_load_dwordx4 v1, s[4:7], s46 offen  lds
  ds_read_b64_tr_b16 a[96:97], v3 offset:32768
  ds_read_b64_tr_b16 a[98:99], v3 offset:33792
  ds_read_b64_tr_b16 a[100:101], v3 offset:36864
  ds_read_b64_tr_b16 a[102:103], v3 offset:37888
  ds_read_b64_tr_b16 a[104:105], v3 offset:40960
  ds_read_b64_tr_b16 a[106:107], v3 offset:41984
  ds_read_b64_tr_b16 a[108:109], v3 offset:45056
  ds_read_b64_tr_b16 a[110:111], v3 offset:46080
  ds_read_b64_tr_b16 a[112:113], v3 offset:49152
  ds_read_b64_tr_b16 a[114:115], v3 offset:50176
  ds_read_b64_tr_b16 a[116:117], v3 offset:53248
  ds_read_b64_tr_b16 a[118:119], v3 offset:54272
  s_waitcnt lgkmcnt(0)
  s_waitcnt vmcnt(18)
  s_barrier
  s_add_u32 m0, s51, 98304
  s_add_u32 s46, s60, 2211840
  buffer_load_dwordx4 v1, s[4:7], s46 offen  lds
  s_add_u32 m0, s51, 102400
  s_add_u32 s46, s60, 2211968
  buffer_load_dwordx4 v1, s[4:7], s46 offen  lds
  s_add_u32 m0, s51, 106496
  s_add_u32 s46, s60, 2212096
  buffer_load_dwordx4 v1, s[4:7], s46 offen  lds
  s_add_u32 m0, s51, 110592
  s_add_u32 s46, s60, 2334720
  buffer_load_dwordx4 v1, s[4:7], s46 offen  lds
  s_add_u32 m0, s51, 114688
  s_add_u32 s46, s60, 2334848
  buffer_load_dwordx4 v1, s[4:7], s46 offen  lds
  s_add_u32 m0, s51, 118784
  s_add_u32 s46, s60, 2334976
  buffer_load_dwordx4 v1, s[4:7], s46 offen  lds
  ds_read_b64_tr_b16 a[120:121], v2 offset:0
  ds_read_b64_tr_b16 a[122:123], v2 offset:1024
  ds_read_b64_tr_b16 a[124:125], v2 offset:4096
  ds_read_b64_tr_b16 a[126:127], v2 offset:5120
  ds_read_b64_tr_b16 a[128:129], v2 offset:8192
  ds_read_b64_tr_b16 a[130:131], v2 offset:9216
  ds_read_b64_tr_b16 a[132:133], v2 offset:12288
  ds_read_b64_tr_b16 a[134:135], v2 offset:13312
  ds_read_b64_tr_b16 a[136:137], v2 offset:16384
  ds_read_b64_tr_b16 a[138:139], v2 offset:17408
  ds_read_b64_tr_b16 a[140:141], v2 offset:20480
  ds_read_b64_tr_b16 a[142:143], v2 offset:21504
  s_waitcnt lgkmcnt(0)
  s_waitcnt vmcnt(18)
  s_barrier
  ds_read_b64_tr_b16 a[144:145], v2 offset:24576
  ds_read_b64_tr_b16 a[146:147], v2 offset:25600
  ds_read_b64_tr_b16 a[148:149], v2 offset:28672
  ds_read_b64_tr_b16 a[150:151], v2 offset:29696
  ds_read_b64_tr_b16 a[152:153], v2 offset:32768
  ds_read_b64_tr_b16 a[154:155], v2 offset:33792
  ds_read_b64_tr_b16 a[156:157], v2 offset:36864
  ds_read_b64_tr_b16 a[158:159], v2 offset:37888
  ds_read_b64_tr_b16 a[160:161], v2 offset:40960
  ds_read_b64_tr_b16 a[162:163], v2 offset:41984
  ds_read_b64_tr_b16 a[164:165], v2 offset:45056
  ds_read_b64_tr_b16 a[166:167], v2 offset:46080
  s_waitcnt lgkmcnt(0)
  s_waitcnt vmcnt(12)
  s_barrier
  ds_read_b64_tr_b16 a[168:169], v2 offset:49152
  ds_read_b64_tr_b16 a[170:171], v2 offset:50176
  ds_read_b64_tr_b16 a[172:173], v2 offset:53248
  ds_read_b64_tr_b16 a[174:175], v2 offset:54272
  ds_read_b64_tr_b16 a[176:177], v2 offset:57344
  ds_read_b64_tr_b16 a[178:179], v2 offset:58368
  ds_read_b64_tr_b16 a[180:181], v2 offset:61440
  ds_read_b64_tr_b16 a[182:183], v2 offset:62464
  ds_read_b64_tr_b16 a[184:185], v3 offset:0
  ds_read_b64_tr_b16 a[186:187], v3 offset:1024
  ds_read_b64_tr_b16 a[188:189], v3 offset:4096
  ds_read_b64_tr_b16 a[190:191], v3 offset:5120
  s_waitcnt lgkmcnt(0)
  s_waitcnt vmcnt(6)
  s_barrier
  ds_read_b64_tr_b16 a[192:193], v3 offset:8192
  ds_read_b64_tr_b16 a[194:195], v3 offset:9216
  ds_read_b64_tr_b16 a[196:197], v3 offset:12288
  ds_read_b64_tr_b16 a[198:199], v3 offset:13312
  ds_read_b64_tr_b16 a[200:201], v3 offset:16384
  ds_read_b64_tr_b16 a[202:203], v3 offset:17408
  ds_read_b64_tr_b16 a[204:205], v3 offset:20480
  ds_read_b64_tr_b16 a[206:207], v3 offset:21504
  ds_read_b64_tr_b16 a[208:209], v3 offset:24576
  ds_read_b64_tr_b16 a[210:211], v3 offset:25600
  ds_read_b64_tr_b16 a[212:213], v3 offset:28672
  ds_read_b64_tr_b16 a[214:215], v3 offset:29696
  s_waitcnt lgkmcnt(0)
  s_waitcnt vmcnt(0)
  s_barrier
  ds_read_b64_tr_b16 a[216:217], v3 offset:32768
  ds_read_b64_tr_b16 a[218:219], v3 offset:33792
  ds_read_b64_tr_b16 a[220:221], v3 offset:36864
  ds_read_b64_tr_b16 a[222:223], v3 offset:37888
  ds_read_b64_tr_b16 a[224:225], v3 offset:40960
  ds_read_b64_tr_b16 a[226:227], v3 offset:41984
  ds_read_b64_tr_b16 a[228:229], v3 offset:45056
  ds_read_b64_tr_b16 a[230:231], v3 offset:46080
  ds_read_b64_tr_b16 a[232:233], v3 offset:49152
  ds_read_b64_tr_b16 a[234:235], v3 offset:50176
  ds_read_b64_tr_b16 a[236:237], v3 offset:53248
  ds_read_b64_tr_b16 a[238:239], v3 offset:54272
  s_waitcnt lgkmcnt(0)
  s_barrier
  s_mov_b32 s54, s51
  s_add_u32 s53, s53, 40960
  s_add_u32 m0, s54, 0
  s_nop 0
  buffer_load_dwordx4 v5, s[12:15], s53 offen offset:0 lds
  s_add_u32 m0, s54, 3968
  s_nop 0
  buffer_load_dwordx4 v5, s[12:15], s53 offen offset:128 lds
  s_add_u32 m0, s54, 7936
  s_nop 0
  buffer_load_dwordx4 v5, s[12:15], s53 offen offset:256 lds
  s_add_u32 m0, s54, 11904
  s_nop 0
  buffer_load_dwordx4 v5, s[12:15], s53 offen offset:384 lds
  s_add_u32 m0, s54, 15872
  s_nop 0
  buffer_load_dwordx4 v5, s[12:15], s53 offen offset:512 lds
  s_add_u32 m0, s54, 19840
  s_nop 0
  buffer_load_dwordx4 v5, s[12:15], s53 offen offset:640 lds
  s_add_u32 m0, s54, 23808
  s_nop 0
  buffer_load_dwordx4 v5, s[12:15], s53 offen offset:768 lds
  s_add_u32 m0, s54, 27776
  s_nop 0
  buffer_load_dwordx4 v5, s[12:15], s53 offen offset:896 lds
  s_add_u32 m0, s54, 31744
  s_nop 0
  buffer_load_dwordx4 v5, s[12:15], s53 offen offset:1024 lds
  s_add_u32 m0, s54, 35712
  s_nop 0
  buffer_load_dwordx4 v5, s[12:15], s53 offen offset:1152 lds
  s_mov_b32 s55, 2146435072
  s_mov_b32 s56, 2146435072
  s_mov_b32 s57, 2146435072
  s_xor_b32 s63, s63, s3
  s_mov_b32 s58, 122880
  ds_read_b128 v[16:19], v6 offset:0
  ds_read_b128 v[20:23], v7 offset:0
  ds_read_b128 v[24:27], v6 offset:4096
  ds_read_b128 v[28:31], v7 offset:4096
  s_waitcnt lgkmcnt(3)
pa_loop_14:
  v_mfma_f32_16x16x32_bf16 v[40:43], a[0:3], v[16:19], 0
  ds_read_b128 v[32:35], v6 offset:8192
  v_mfma_f32_16x16x32_bf16 v[48:51], a[4:7], v[16:19], 0
  v_mfma_f32_16x16x32_bf16 v[56:59], a[8:11], v[16:19], 0
  s_waitcnt lgkmcnt(3)
  v_cvt_pk_bf16_f32 v66, v44, v45
  v_mfma_f32_16x16x32_bf16 v[40:43], a[12:15], v[20:23], v[40:43]
  ds_read_b128 v[16:19], v7 offset:8192
  v_cvt_pk_bf16_f32 v67, v46, v47
  v_mfma_f32_16x16x32_bf16 v[48:51], a[16:19], v[20:23], v[48:51]
  v_cvt_pk_bf16_f32 v70, v52, v53
  v_mfma_f32_16x16x32_bf16 v[56:59], a[20:23], v[20:23], v[56:59]
  s_waitcnt lgkmcnt(3)
  v_cvt_pk_bf16_f32 v71, v54, v55
  v_mfma_f32_16x16x32_bf16 v[40:43], a[24:27], v[24:27], v[40:43]
  ds_read_b128 v[20:23], v6 offset:12288
  v_cvt_pk_bf16_f32 v74, v60, v61
  v_mfma_f32_16x16x32_bf16 v[48:51], a[28:31], v[24:27], v[48:51]
  v_cvt_pk_bf16_f32 v75, v62, v63
  v_mfma_f32_16x16x32_bf16 v[56:59], a[32:35], v[24:27], v[56:59]
  s_waitcnt lgkmcnt(3)
  v_mfma_f32_16x16x32_bf16 v[40:43], a[36:39], v[28:31], v[40:43]
  ds_read_b128 v[24:27], v7 offset:12288
  v_permlane16_swap_b32 v64, v66
  v_mfma_f32_16x16x32_bf16 v[48:51], a[40:43], v[28:31], v[48:51]
  v_permlane16_swap_b32 v65, v67
  v_mfma_f32_16x16x32_bf16 v[56:59], a[44:47], v[28:31], v[56:59]
  buffer_store_dwordx4 v[64:67], v8, s[8:11], s55 offen sc1
  s_waitcnt lgkmcnt(3)
  v_mfma_f32_16x16x32_bf16 v[40:43], a[48:51], v[32:35], v[40:43]
  ds_read_b128 v[28:31], v6 offset:16384
  v_permlane16_swap_b32 v68, v70
  v_mfma_f32_16x16x32_bf16 v[48:51], a[52:55], v[32:35], v[48:51]
  v_permlane16_swap_b32 v69, v71
  v_mfma_f32_16x16x32_bf16 v[56:59], a[56:59], v[32:35], v[56:59]
  buffer_store_dwordx4 v[68:71], v8, s[8:11], s56 offen sc1
  s_waitcnt lgkmcnt(3)
  v_mfma_f32_16x16x32_bf16 v[40:43], a[60:63], v[16:19], v[40:43]
  ds_read_b128 v[32:35], v7 offset:16384
  v_permlane16_swap_b32 v72, v74
  v_mfma_f32_16x16x32_bf16 v[48:51], a[64:67], v[16:19], v[48:51]
  v_permlane16_swap_b32 v73, v75
  v_mfma_f32_16x16x32_bf16 v[56:59], a[68:71], v[16:19], v[56:59]
  buffer_store_dwordx4 v[72:75], v8, s[8:11], s57 offen sc1
  s_waitcnt lgkmcnt(3)
  v_mfma_f32_16x16x32_bf16 v[40:43], a[72:75], v[20:23], v[40:43]
  ds_read_b128 v[16:19], v6 offset:20480
  v_mfma_f32_16x16x32_bf16 v[48:51], a[76:79], v[20:23], v[48:51]
  v_mfma_f32_16x16x32_bf16 v[56:59], a[80:83], v[20:23], v[56:59]
  s_waitcnt lgkmcnt(3)
  v_mfma_f32_16x16x32_bf16 v[40:43], a[84:87], v[24:27], v[40:43]
  ds_read_b128 v[20:23], v7 offset:20480
  v_mfma_f32_16x16x32_bf16 v[48:51], a[88:91], v[24:27], v[48:51]
  v_mov_b32 v10, s52
  v_mfma_f32_16x16x32_bf16 v[56:59], a[92:95], v[24:27], v[56:59]
  s_waitcnt lgkmcnt(3)
  v_mfma_f32_16x16x32_bf16 v[40:43], a[96:99], v[28:31], v[40:43]
  ds_read_b128 v[24:27], v6 offset:24576
  v_mfma_f32_16x16x32_bf16 v[48:51], a[100:103], v[28:31], v[48:51]
  s_add_u32 s53, s53, 40960
  s_add_u32 s54, s54, 40960
  v_mfma_f32_16x16x32_bf16 v[56:59], a[104:107], v[28:31], v[56:59]
  s_waitcnt lgkmcnt(3)
  v_mfma_f32_16x16x32_bf16 v[40:43], a[108:111], v[32:35], v[40:43]
  ds_read_b128 v[28:31], v7 offset:24576
  v_mfma_f32_16x16x32_bf16 v[48:51], a[112:115], v[32:35], v[48:51]
  s_cmp_ge_u32 s54, 163840
  s_cselect_b32 s54, s51, s54
  v_mfma_f32_16x16x32_bf16 v[56:59], a[116:119], v[32:35], v[56:59]
  s_waitcnt lgkmcnt(3)
  v_mfma_f32_16x16x32_bf16 v[40:43], a[120:123], v[16:19], v[40:43]
  ds_read_b128 v[32:35], v6 offset:28672
  v_mfma_f32_16x16x32_bf16 v[48:51], a[124:127], v[16:19], v[48:51]
  s_cmp_eq_u32 s58, 122880
  s_cselect_b32 s59, 163840, 0
  v_mfma_f32_16x16x32_bf16 v[56:59], a[128:131], v[16:19], v[56:59]
  s_waitcnt lgkmcnt(3)
  v_mfma_f32_16x16x32_bf16 v[40:43], a[132:135], v[20:23], v[40:43]
  ds_read_b128 v[16:19], v7 offset:28672
  v_mfma_f32_16x16x32_bf16 v[48:51], a[136:139], v[20:23], v[48:51]
  s_sub_u32 s59, 40960, s59
  s_add_u32 s58, s58, s59
  v_mfma_f32_16x16x32_bf16 v[56:59], a[140:143], v[20:23], v[56:59]
  s_waitcnt lgkmcnt(3)
  v_mfma_f32_16x16x32_bf16 v[40:43], a[144:147], v[24:27], v[40:43]
  ds_read_b128 v[20:23], v6 offset:32768
  v_mfma_f32_16x16x32_bf16 v[48:51], a[148:151], v[24:27], v[48:51]
  s_lshr_b32 s55, s67, 1
  v_mfma_f32_16x16x32_bf16 v[56:59], a[152:155], v[24:27], v[56:59]
  s_lshl_b32 s55, s55, 14
  s_waitcnt lgkmcnt(3)
  v_mfma_f32_16x16x32_bf16 v[40:43], a[156:159], v[28:31], v[40:43]
  ds_read_b128 v[24:27], v7 offset:32768
  v_mfma_f32_16x16x32_bf16 v[48:51], a[160:163], v[28:31], v[48:51]
  s_and_b32 s56, s67, 1
  v_mfma_f32_16x16x32_bf16 v[56:59], a[164:167], v[28:31], v[56:59]
  s_lshl_b32 s56, s56, 12
  s_waitcnt lgkmcnt(3)
  v_mfma_f32_16x16x32_bf16 v[40:43], a[168:171], v[32:35], v[40:43]
  ds_read_b128 v[28:31], v6 offset:36864
  v_mfma_f32_16x16x32_bf16 v[48:51], a[172:175], v[32:35], v[48:51]
  s_add_u32 s55, s55, s56
  v_mfma_f32_16x16x32_bf16 v[56:59], a[176:179], v[32:35], v[56:59]
  s_add_u32 s55, s55, s63
  s_waitcnt lgkmcnt(3)
  v_mfma_f32_16x16x32_bf16 v[40:43], a[180:183], v[16:19], v[40:43]
  ds_read_b128 v[32:35], v7 offset:36864
  v_mfma_f32_16x16x32_bf16 v[48:51], a[184:187], v[16:19], v[48:51]
  s_lshr_b32 s56, s55, 8
  v_mfma_f32_16x16x32_bf16 v[56:59], a[188:191], v[16:19], v[56:59]
  s_and_b32 s56, s56, 0x2000
  s_waitcnt lgkmcnt(3)
  v_mfma_f32_16x16x32_bf16 v[40:43], a[192:195], v[20:23], v[40:43]
  ds_read_b128 v[16:19], v6 offset:2048
  v_mfma_f32_16x16x32_bf16 v[48:51], a[196:199], v[20:23], v[48:51]
  s_xor_b32 s55, s55, s56
  v_mfma_f32_16x16x32_bf16 v[56:59], a[200:203], v[20:23], v[56:59]
  s_add_u32 s67, s67, 1
  s_waitcnt lgkmcnt(3)
  v_mfma_f32_16x16x32_bf16 v[40:43], a[204:207], v[24:27], v[40:43]
  ds_read_b128 v[20:23], v7 offset:2048
  v_mfma_f32_16x16x32_bf16 v[48:51], a[208:211], v[24:27], v[48:51]
  s_add_u32 s56, s55, 16777216
  v_mfma_f32_16x16x32_bf16 v[56:59], a[212:215], v[24:27], v[56:59]
  s_add_u32 s57, s55, 33554432
  s_waitcnt lgkmcnt(3)
  v_mfma_f32_16x16x32_bf16 v[40:43], a[216:219], v[28:31], v[40:43]
  ds_read_b128 v[24:27], v6 offset:6144
  v_mfma_f32_16x16x32_bf16 v[48:51], a[220:223], v[28:31], v[48:51]
  v_mfma_f32_16x16x32_bf16 v[56:59], a[224:227], v[28:31], v[56:59]
  s_waitcnt lgkmcnt(3)
  v_mfma_f32_16x16x32_bf16 v[40:43], a[228:231], v[32:35], v[40:43]
  ds_read_b128 v[28:31], v7 offset:6144
  v_mfma_f32_16x16x32_bf16 v[48:51], a[232:235], v[32:35], v[48:51]
  v_mfma_f32_16x16x32_bf16 v[56:59], a[236:239], v[32:35], v[56:59]
  s_waitcnt lgkmcnt(3)
  v_mfma_f32_16x16x32_bf16 v[44:47], a[0:3], v[16:19], 0
  ds_read_b128 v[32:35], v6 offset:10240
  v_mfma_f32_16x16x32_bf16 v[52:55], a[4:7], v[16:19], 0
  v_mfma_f32_16x16x32_bf16 v[60:63], a[8:11], v[16:19], 0
  s_waitcnt lgkmcnt(3)
  v_cvt_pk_bf16_f32 v64, v40, v41
  v_mfma_f32_16x16x32_bf16 v[44:47], a[12:15], v[20:23], v[44:47]
  ds_read_b128 v[16:19], v7 offset:10240
  v_cvt_pk_bf16_f32 v65, v42, v43
  v_mfma_f32_16x16x32_bf16 v[52:55], a[16:19], v[20:23], v[52:55]
  v_cvt_pk_bf16_f32 v68, v48, v49
  v_mfma_f32_16x16x32_bf16 v[60:63], a[20:23], v[20:23], v[60:63]
  s_waitcnt lgkmcnt(3)
  v_cvt_pk_bf16_f32 v69, v50, v51
  v_mfma_f32_16x16x32_bf16 v[44:47], a[24:27], v[24:27], v[44:47]
  ds_read_b128 v[20:23], v6 offset:14336
  v_cvt_pk_bf16_f32 v72, v56, v57
  v_mfma_f32_16x16x32_bf16 v[52:55], a[28:31], v[24:27], v[52:55]
  v_cvt_pk_bf16_f32 v73, v58, v59
  v_mfma_f32_16x16x32_bf16 v[60:63], a[32:35], v[24:27], v[60:63]
  s_waitcnt lgkmcnt(3)
  v_mfma_f32_16x16x32_bf16 v[44:47], a[36:39], v[28:31], v[44:47]
  ds_read_b128 v[24:27], v7 offset:14336
  v_mfma_f32_16x16x32_bf16 v[52:55], a[40:43], v[28:31], v[52:55]
  s_waitcnt vmcnt(0)
  s_barrier
  v_mfma_f32_16x16x32_bf16 v[60:63], a[44:47], v[28:31], v[60:63]
  buffer_store_dword v10, v9, s[8:11], 0 offen sc1
  s_waitcnt lgkmcnt(3)
  v_mfma_f32_16x16x32_bf16 v[44:47], a[48:51], v[32:35], v[44:47]
  ds_read_b128 v[28:31], v6 offset:18432
  s_add_u32 m0, s54, 0
  v_mfma_f32_16x16x32_bf16 v[52:55], a[52:55], v[32:35], v[52:55]
  buffer_load_dwordx4 v5, s[12:15], s53 offen offset:0 lds
  v_mfma_f32_16x16x32_bf16 v[60:63], a[56:59], v[32:35], v[60:63]
  s_waitcnt lgkmcnt(3)
  v_mfma_f32_16x16x32_bf16 v[44:47], a[60:63], v[16:19], v[44:47]
  ds_read_b128 v[32:35], v7 offset:18432
  s_add_u32 m0, s54, 3968
  v_mfma_f32_16x16x32_bf16 v[52:55], a[64:67], v[16:19], v[52:55]
  buffer_load_dwordx4 v5, s[12:15], s53 offen offset:128 lds
  v_mfma_f32_16x16x32_bf16 v[60:63], a[68:71], v[16:19], v[60:63]
  s_waitcnt lgkmcnt(3)
  v_mfma_f32_16x16x32_bf16 v[44:47], a[72:75], v[20:23], v[44:47]
  ds_read_b128 v[16:19], v6 offset:22528
  s_add_u32 m0, s54, 7936
  v_mfma_f32_16x16x32_bf16 v[52:55], a[76:79], v[20:23], v[52:55]
  buffer_load_dwordx4 v5, s[12:15], s53 offen offset:256 lds
  v_mfma_f32_16x16x32_bf16 v[60:63], a[80:83], v[20:23], v[60:63]
  s_waitcnt lgkmcnt(3)
  v_mfma_f32_16x16x32_bf16 v[44:47], a[84:87], v[24:27], v[44:47]
  ds_read_b128 v[20:23], v7 offset:22528
  s_add_u32 m0, s54, 11904
  v_mfma_f32_16x16x32_bf16 v[52:55], a[88:91], v[24:27], v[52:55]
  buffer_load_dwordx4 v5, s[12:15], s53 offen offset:384 lds
  v_mfma_f32_16x16x32_bf16 v[60:63], a[92:95], v[24:27], v[60:63]
  s_waitcnt lgkmcnt(3)
  v_mfma_f32_16x16x32_bf16 v[44:47], a[96:99], v[28:31], v[44:47]
  ds_read_b128 v[24:27], v6 offset:26624
  s_add_u32 m0, s54, 15872
  v_mfma_f32_16x16x32_bf16 v[52:55], a[100:103], v[28:31], v[52:55]
  buffer_load_dwordx4 v5, s[12:15], s53 offen offset:512 lds
  v_mfma_f32_16x16x32_bf16 v[60:63], a[104:107], v[28:31], v[60:63]
  s_waitcnt lgkmcnt(3)
  v_mfma_f32_16x16x32_bf16 v[44:47], a[108:111], v[32:35], v[44:47]
  ds_read_b128 v[28:31], v7 offset:26624
  s_add_u32 m0, s54, 19840
  v_mfma_f32_16x16x32_bf16 v[52:55], a[112:115], v[32:35], v[52:55]
  buffer_load_dwordx4 v5, s[12:15], s53 offen offset:640 lds
  v_mfma_f32_16x16x32_bf16 v[60:63], a[116:119], v[32:35], v[60:63]
  s_waitcnt lgkmcnt(3)
  v_mfma_f32_16x16x32_bf16 v[44:47], a[120:123], v[16:19], v[44:47]
  ds_read_b128 v[32:35], v6 offset:30720
  s_add_u32 m0, s54, 23808
  v_mfma_f32_16x16x32_bf16 v[52:55], a[124:127], v[16:19], v[52:55]
  buffer_load_dwordx4 v5, s[12:15], s53 offen offset:768 lds
  v_mfma_f32_16x16x32_bf16 v[60:63], a[128:131], v[16:19], v[60:63]
  s_waitcnt lgkmcnt(3)
  v_mfma_f32_16x16x32_bf16 v[44:47], a[132:135], v[20:23], v[44:47]
  ds_read_b128 v[16:19], v7 offset:30720
  s_add_u32 m0, s54, 27776
  v_mfma_f32_16x16x32_bf16 v[52:55], a[136:139], v[20:23], v[52:55]
  buffer_load_dwordx4 v5, s[12:15], s53 offen offset:896 lds
  v_mfma_f32_16x16x32_bf16 v[60:63], a[140:143], v[20:23], v[60:63]
  s_waitcnt lgkmcnt(3)
  v_mfma_f32_16x16x32_bf16 v[44:47], a[144:147], v[24:27], v[44:47]
  ds_read_b128 v[20:23], v6 offset:34816
  s_add_u32 m0, s54, 31744
  v_mfma_f32_16x16x32_bf16 v[52:55], a[148:151], v[24:27], v[52:55]
  buffer_load_dwordx4 v5, s[12:15], s53 offen offset:1024 lds
  v_mfma_f32_16x16x32_bf16 v[60:63], a[152:155], v[24:27], v[60:63]
  s_waitcnt lgkmcnt(3)
  v_mfma_f32_16x16x32_bf16 v[44:47], a[156:159], v[28:31], v[44:47]
  ds_read_b128 v[24:27], v7 offset:34816
  s_add_u32 m0, s54, 35712
  v_mfma_f32_16x16x32_bf16 v[52:55], a[160:163], v[28:31], v[52:55]
  buffer_load_dwordx4 v5, s[12:15], s53 offen offset:1152 lds
  v_mfma_f32_16x16x32_bf16 v[60:63], a[164:167], v[28:31], v[60:63]
  s_waitcnt lgkmcnt(3)
  v_mfma_f32_16x16x32_bf16 v[44:47], a[168:171], v[32:35], v[44:47]
  ds_read_b128 v[28:31], v6 offset:38912
  v_mfma_f32_16x16x32_bf16 v[52:55], a[172:175], v[32:35], v[52:55]
  v_mfma_f32_16x16x32_bf16 v[60:63], a[176:179], v[32:35], v[60:63]
  s_waitcnt lgkmcnt(3)
  v_mfma_f32_16x16x32_bf16 v[44:47], a[180:183], v[16:19], v[44:47]
  ds_read_b128 v[32:35], v7 offset:38912
  v_mfma_f32_16x16x32_bf16 v[52:55], a[184:187], v[16:19], v[52:55]
  v_add_u32 v6, s59, v6
  v_add_u32 v7, s59, v7
  v_mfma_f32_16x16x32_bf16 v[60:63], a[188:191], v[16:19], v[60:63]
  s_waitcnt lgkmcnt(3)
  v_mfma_f32_16x16x32_bf16 v[44:47], a[192:195], v[20:23], v[44:47]
  ds_read_b128 v[16:19], v6 offset:0
  v_mfma_f32_16x16x32_bf16 v[52:55], a[196:199], v[20:23], v[52:55]
  v_mfma_f32_16x16x32_bf16 v[60:63], a[200:203], v[20:23], v[60:63]
  s_waitcnt lgkmcnt(3)
  v_mfma_f32_16x16x32_bf16 v[44:47], a[204:207], v[24:27], v[44:47]
  ds_read_b128 v[20:23], v7 offset:0
  v_mfma_f32_16x16x32_bf16 v[52:55], a[208:211], v[24:27], v[52:55]
  s_add_u32 s52, s52, 1
  v_mfma_f32_16x16x32_bf16 v[60:63], a[212:215], v[24:27], v[60:63]
  s_waitcnt lgkmcnt(3)
  v_mfma_f32_16x16x32_bf16 v[44:47], a[216:219], v[28:31], v[44:47]
  ds_read_b128 v[24:27], v6 offset:4096
  v_mfma_f32_16x16x32_bf16 v[52:55], a[220:223], v[28:31], v[52:55]
  v_mfma_f32_16x16x32_bf16 v[60:63], a[224:227], v[28:31], v[60:63]
  s_waitcnt lgkmcnt(3)
  v_mfma_f32_16x16x32_bf16 v[44:47], a[228:231], v[32:35], v[44:47]
  ds_read_b128 v[28:31], v7 offset:4096
  v_mfma_f32_16x16x32_bf16 v[52:55], a[232:235], v[32:35], v[52:55]
  s_cmp_lt_u32 s52, s62
  v_mfma_f32_16x16x32_bf16 v[60:63], a[236:239], v[32:35], v[60:63]
  s_waitcnt lgkmcnt(3)
  s_cbranch_scc1 pa_loop_14
  v_cvt_pk_bf16_f32 v66, v44, v45
  v_cvt_pk_bf16_f32 v67, v46, v47
  s_nop 1
  v_cvt_pk_bf16_f32 v70, v52, v53
  v_cvt_pk_bf16_f32 v71, v54, v55
  v_cvt_pk_bf16_f32 v74, v60, v61
  v_cvt_pk_bf16_f32 v75, v62, v63
  v_permlane16_swap_b32 v64, v66
  v_permlane16_swap_b32 v65, v67
  v_permlane16_swap_b32 v68, v70
  v_permlane16_swap_b32 v69, v71
  v_permlane16_swap_b32 v72, v74
  v_permlane16_swap_b32 v73, v75
  buffer_store_dwordx4 v[64:67], v8, s[8:11], s55 offen sc1
  buffer_store_dwordx4 v[68:71], v8, s[8:11], s56 offen sc1
  buffer_store_dwordx4 v[72:75], v8, s[8:11], s57 offen sc1
  v_mov_b32 v10, s52
  s_waitcnt vmcnt(0) lgkmcnt(0)
  s_barrier
  buffer_store_dword v10, v9, s[8:11], 0 offen sc1
pa_att:
  v_min_u32 v1, 19, v0
  v_cmp_lt_u32 vcc, 9, v1
  s_lshl_b32 s46, s65, 4
  s_max_u32 s47, s46, 14
  s_sub_u32 s47, s47, 14
  s_lshr_b32 s47, s47, 5
  s_lshr_b32 s48, s46, 5
  v_mov_b32 v2, s47
  v_mov_b32 v3, s48
  v_cndmask_b32 v2, v2, v3, vcc
  v_subrev_u32 v3, 10, v1
  v_cndmask_b32 v1, v1, v3, vcc
  v_mul_u32_u24 v3, 171, v2
  v_lshrrev_b32 v3, 10, v3
  v_max_u32 v4, 28, v2
  v_subrev_u32 v4, 28, v4
  v_mul_u32_u24 v4, 171, v4
  v_lshrrev_b32 v4, 9, v4
  v_max_u32 v3, v3, v4
  v_mul_u32_u24 v3, 10, v3
  v_add_u32 v1, v1, v3
  v_lshlrev_b32 v1, 7, v1
  v_add_u32 v1, 1081344, v1
  v_lshrrev_b32 v3, 4, v0
  s_lshl_b32 s47, s42, 2
  v_add_u32 v3, s47, v3
  v_mul_u32_u24 v3, 5, v3
  s_xor_b32 s47, s3, 176168960
  v_add_u32 v8, 0, v3
  v_mul_u32_u24 v4, 171, v8
  v_lshrrev_b32 v4, 12, v4
  v_mul_u32_u24 v5, 3, v4
  v_lshrrev_b32 v6, 3, v8
  v_sub_u32 v5, v6, v5
  v_and_b32 v8, 7, v8
  v_lshl_add_u32 v8, v8, 8, s47
  v_lshl_add_u32 v8, v4, 19, v8
  v_lshl_add_u32 v8, v5, 24, v8
  v_lshrrev_b32 v4, 8, v8
  v_and_b32 v4, 0x2000, v4
  v_xor_b32 v8, v8, v4
  v_add_u32 v9, 1, v3
  v_mul_u32_u24 v4, 171, v9
  v_lshrrev_b32 v4, 12, v4
  v_mul_u32_u24 v5, 3, v4
  v_lshrrev_b32 v6, 3, v9
  v_sub_u32 v5, v6, v5
  v_and_b32 v9, 7, v9
  v_lshl_add_u32 v9, v9, 8, s47
  v_lshl_add_u32 v9, v4, 19, v9
  v_lshl_add_u32 v9, v5, 24, v9
  v_lshrrev_b32 v4, 8, v9
  v_and_b32 v4, 0x2000, v4
  v_xor_b32 v9, v9, v4
  v_add_u32 v10, 2, v3
  v_mul_u32_u24 v4, 171, v10
  v_lshrrev_b32 v4, 12, v4
  v_mul_u32_u24 v5, 3, v4
  v_lshrrev_b32 v6, 3, v10
  v_sub_u32 v5, v6, v5
  v_and_b32 v10, 7, v10
  v_lshl_add_u32 v10, v10, 8, s47
  v_lshl_add_u32 v10, v4, 19, v10
  v_lshl_add_u32 v10, v5, 24, v10
  v_lshrrev_b32 v4, 8, v10
  v_and_b32 v4, 0x2000, v4
  v_xor_b32 v10, v10, v4
  v_add_u32 v11, 3, v3
  v_mul_u32_u24 v4, 171, v11
  v_lshrrev_b32 v4, 12, v4
  v_mul_u32_u24 v5, 3, v4
  v_lshrrev_b32 v6, 3, v11
  v_sub_u32 v5, v6, v5
  v_and_b32 v11, 7, v11
  v_lshl_add_u32 v11, v11, 8, s47
  v_lshl_add_u32 v11, v4, 19, v11
  v_lshl_add_u32 v11, v5, 24, v11
  v_lshrrev_b32 v4, 8, v11
  v_and_b32 v4, 0x2000, v4
  v_xor_b32 v11, v11, v4
  v_add_u32 v12, 4, v3
  v_mul_u32_u24 v4, 171, v12
  v_lshrrev_b32 v4, 12, v4
  v_mul_u32_u24 v5, 3, v4
  v_lshrrev_b32 v6, 3, v12
  v_sub_u32 v5, v6, v5
  v_and_b32 v12, 7, v12
  v_lshl_add_u32 v12, v12, 8, s47
  v_lshl_add_u32 v12, v4, 19, v12
  v_lshl_add_u32 v12, v5, 24, v12
  v_lshrrev_b32 v4, 8, v12
  v_and_b32 v4, 0x2000, v4
  v_xor_b32 v12, v12, v4
  v_add_u32 v13, 80, v3
  v_mul_u32_u24 v4, 171, v13
  v_lshrrev_b32 v4, 12, v4
  v_mul_u32_u24 v5, 3, v4
  v_lshrrev_b32 v6, 3, v13
  v_sub_u32 v5, v6, v5
  v_and_b32 v13, 7, v13
  v_lshl_add_u32 v13, v13, 8, s47
  v_lshl_add_u32 v13, v4, 19, v13
  v_lshl_add_u32 v13, v5, 24, v13
  v_lshrrev_b32 v4, 8, v13
  v_and_b32 v4, 0x2000, v4
  v_xor_b32 v13, v13, v4
  v_add_u32 v14, 81, v3
  v_mul_u32_u24 v4, 171, v14
  v_lshrrev_b32 v4, 12, v4
  v_mul_u32_u24 v5, 3, v4
  v_lshrrev_b32 v6, 3, v14
  v_sub_u32 v5, v6, v5
  v_and_b32 v14, 7, v14
  v_lshl_add_u32 v14, v14, 8, s47
  v_lshl_add_u32 v14, v4, 19, v14
  v_lshl_add_u32 v14, v5, 24, v14
  v_lshrrev_b32 v4, 8, v14
  v_and_b32 v4, 0x2000, v4
  v_xor_b32 v14, v14, v4
  v_add_u32 v15, 82, v3
  v_mul_u32_u24 v4, 171, v15
  v_lshrrev_b32 v4, 12, v4
  v_mul_u32_u24 v5, 3, v4
  v_lshrrev_b32 v6, 3, v15
  v_sub_u32 v5, v6, v5
  v_and_b32 v15, 7, v15
  v_lshl_add_u32 v15, v15, 8, s47
  v_lshl_add_u32 v15, v4, 19, v15
  v_lshl_add_u32 v15, v5, 24, v15
  v_lshrrev_b32 v4, 8, v15
  v_and_b32 v4, 0x2000, v4
  v_xor_b32 v15, v15, v4
  v_add_u32 v16, 83, v3
  v_mul_u32_u24 v4, 171, v16
  v_lshrrev_b32 v4, 12, v4
  v_mul_u32_u24 v5, 3, v4
  v_lshrrev_b32 v6, 3, v16
  v_sub_u32 v5, v6, v5
  v_and_b32 v16, 7, v16
  v_lshl_add_u32 v16, v16, 8, s47
  v_lshl_add_u32 v16, v4, 19, v16
  v_lshl_add_u32 v16, v5, 24, v16
  v_lshrrev_b32 v4, 8, v16
  v_and_b32 v4, 0x2000, v4
  v_xor_b32 v16, v16, v4
  v_add_u32 v17, 84, v3
  v_mul_u32_u24 v4, 171, v17
  v_lshrrev_b32 v4, 12, v4
  v_mul_u32_u24 v5, 3, v4
  v_lshrrev_b32 v6, 3, v17
  v_sub_u32 v5, v6, v5
  v_and_b32 v17, 7, v17
  v_lshl_add_u32 v17, v17, 8, s47
  v_lshl_add_u32 v17, v4, 19, v17
  v_lshl_add_u32 v17, v5, 24, v17
  v_lshrrev_b32 v4, 8, v17
  v_and_b32 v4, 0x2000, v4
  v_xor_b32 v17, v17, v4
  v_add_u32 v18, 160, v3
  v_mul_u32_u24 v4, 171, v18
  v_lshrrev_b32 v4, 12, v4
  v_mul_u32_u24 v5, 3, v4
  v_lshrrev_b32 v6, 3, v18
  v_sub_u32 v5, v6, v5
  v_and_b32 v18, 7, v18
  v_lshl_add_u32 v18, v18, 8, s47
  v_lshl_add_u32 v18, v4, 19, v18
  v_lshl_add_u32 v18, v5, 24, v18
  v_lshrrev_b32 v4, 8, v18
  v_and_b32 v4, 0x2000, v4
  v_xor_b32 v18, v18, v4
  v_add_u32 v19, 161, v3
  v_mul_u32_u24 v4, 171, v19
  v_lshrrev_b32 v4, 12, v4
  v_mul_u32_u24 v5, 3, v4
  v_lshrrev_b32 v6, 3, v19
  v_sub_u32 v5, v6, v5
  v_and_b32 v19, 7, v19
  v_lshl_add_u32 v19, v19, 8, s47
  v_lshl_add_u32 v19, v4, 19, v19
  v_lshl_add_u32 v19, v5, 24, v19
  v_lshrrev_b32 v4, 8, v19
  v_and_b32 v4, 0x2000, v4
  v_xor_b32 v19, v19, v4
  v_add_u32 v20, 162, v3
  v_mul_u32_u24 v4, 171, v20
  v_lshrrev_b32 v4, 12, v4
  v_mul_u32_u24 v5, 3, v4
  v_lshrrev_b32 v6, 3, v20
  v_sub_u32 v5, v6, v5
  v_and_b32 v20, 7, v20
  v_lshl_add_u32 v20, v20, 8, s47
  v_lshl_add_u32 v20, v4, 19, v20
  v_lshl_add_u32 v20, v5, 24, v20
  v_lshrrev_b32 v4, 8, v20
  v_and_b32 v4, 0x2000, v4
  v_xor_b32 v20, v20, v4
  v_add_u32 v21, 163, v3
  v_mul_u32_u24 v4, 171, v21
  v_lshrrev_b32 v4, 12, v4
  v_mul_u32_u24 v5, 3, v4
  v_lshrrev_b32 v6, 3, v21
  v_sub_u32 v5, v6, v5
  v_and_b32 v21, 7, v21
  v_lshl_add_u32 v21, v21, 8, s47
  v_lshl_add_u32 v21, v4, 19, v21
  v_lshl_add_u32 v21, v5, 24, v21
  v_lshrrev_b32 v4, 8, v21
  v_and_b32 v4, 0x2000, v4
  v_xor_b32 v21, v21, v4
  v_add_u32 v22, 164, v3
  v_mul_u32_u24 v4, 171, v22
  v_lshrrev_b32 v4, 12, v4
  v_mul_u32_u24 v5, 3, v4
  v_lshrrev_b32 v6, 3, v22
  v_sub_u32 v5, v6, v5
  v_and_b32 v22, 7, v22
  v_lshl_add_u32 v22, v22, 8, s47
  v_lshl_add_u32 v22, v4, 19, v22
  v_lshl_add_u32 v22, v5, 24, v22
  v_lshrrev_b32 v4, 8, v22
  v_and_b32 v4, 0x2000, v4
  v_xor_b32 v22, v22, v4
  v_and_b32 v5, 15, v0
  v_add_u32 v6, s46, v5
  v_subrev_u32 v4, 0, v6
  v_max_i32 v4, 0, v4
  v_and_b32 v23, 15, v4
  v_lshlrev_b32 v23, 4, v23
  v_bfe_u32 v7, v4, 4, 2
  v_lshl_add_u32 v23, v7, 11, v23
  v_lshrrev_b32 v4, 6, v4
  v_lshl_add_u32 v23, v4, 14, v23
  v_cmp_gt_u32 s[72:73], 0, v6
  v_subrev_u32 v4, 2, v6
  v_max_i32 v4, 0, v4
  v_and_b32 v24, 15, v4
  v_lshlrev_b32 v24, 4, v24
  v_bfe_u32 v7, v4, 4, 2
  v_lshl_add_u32 v24, v7, 11, v24
  v_lshrrev_b32 v4, 6, v4
  v_lshl_add_u32 v24, v4, 14, v24
  v_cmp_gt_u32 s[74:75], 2, v6
  v_subrev_u32 v4, 4, v6
  v_max_i32 v4, 0, v4
  v_and_b32 v25, 15, v4
  v_lshlrev_b32 v25, 4, v25
  v_bfe_u32 v7, v4, 4, 2
  v_lshl_add_u32 v25, v7, 11, v25
  v_lshrrev_b32 v4, 6, v4
  v_lshl_add_u32 v25, v4, 14, v25
  v_cmp_gt_u32 s[76:77], 4, v6
  v_subrev_u32 v4, 6, v6
  v_max_i32 v4, 0, v4
  v_and_b32 v26, 15, v4
  v_lshlrev_b32 v26, 4, v26
  v_bfe_u32 v7, v4, 4, 2
  v_lshl_add_u32 v26, v7, 11, v26
  v_lshrrev_b32 v4, 6, v4
  v_lshl_add_u32 v26, v4, 14, v26
  v_cmp_gt_u32 s[78:79], 6, v6
  v_subrev_u32 v4, 8, v6
  v_max_i32 v4, 0, v4
  v_and_b32 v27, 15, v4
  v_lshlrev_b32 v27, 4, v27
  v_bfe_u32 v7, v4, 4, 2
  v_lshl_add_u32 v27, v7, 11, v27
  v_lshrrev_b32 v4, 6, v4
  v_lshl_add_u32 v27, v4, 14, v27
  v_cmp_gt_u32 s[80:81], 8, v6
  v_subrev_u32 v4, 10, v6
  v_max_i32 v4, 0, v4
  v_and_b32 v28, 15, v4
  v_lshlrev_b32 v28, 4, v28
  v_bfe_u32 v7, v4, 4, 2
  v_lshl_add_u32 v28, v7, 11, v28
  v_lshrrev_b32 v4, 6, v4
  v_lshl_add_u32 v28, v4, 14, v28
  v_cmp_gt_u32 s[82:83], 10, v6
  v_subrev_u32 v4, 12, v6
  v_max_i32 v4, 0, v4
  v_and_b32 v29, 15, v4
  v_lshlrev_b32 v29, 4, v29
  v_bfe_u32 v7, v4, 4, 2
  v_lshl_add_u32 v29, v7, 11, v29
  v_lshrrev_b32 v4, 6, v4
  v_lshl_add_u32 v29, v4, 14, v29
  v_cmp_gt_u32 s[84:85], 12, v6
  v_subrev_u32 v4, 14, v6
  v_max_i32 v4, 0, v4
  v_and_b32 v30, 15, v4
  v_lshlrev_b32 v30, 4, v30
  v_bfe_u32 v7, v4, 4, 2
  v_lshl_add_u32 v30, v7, 11, v30
  v_lshrrev_b32 v4, 6, v4
  v_lshl_add_u32 v30, v4, 14, v30
  v_cmp_gt_u32 s[86:87], 14, v6
  s_mov_b32 s50, 0
  s_mov_b32 s66, 0
pa_wait:
  buffer_load_dword v4, v1, s[8:11], 0 offen sc1
  s_add_u32 s50, s50, 1
  s_cmp_gt_u32 s50, 131072
  s_cbranch_scc1 L_fail
  s_waitcnt vmcnt(0)
  v_cmp_le_u32 vcc, v4, v2
  s_cbranch_vccnz pa_wait
  v_add_u32 v232, v8, v23
  buffer_load_dwordx4 v[32:35], v232, s[8:11], s66 offen sc1
  v_add_u32 v233, v9, v23
  buffer_load_dwordx4 v[36:39], v233, s[8:11], s66 offen sc1
  v_add_u32 v234, v10, v23
  buffer_load_dwordx4 v[40:43], v234, s[8:11], s66 offen sc1
  v_add_u32 v235, v11, v23
  buffer_load_dwordx4 v[44:47], v235, s[8:11], s66 offen sc1
  v_add_u32 v236, v12, v23
  buffer_load_dwordx4 v[48:51], v236, s[8:11], s66 offen sc1
  v_add_u32 v232, v13, v23
  buffer_load_dwordx4 v[72:75], v232, s[8:11], s66 offen sc1
  v_add_u32 v233, v14, v23
  buffer_load_dwordx4 v[76:79], v233, s[8:11], s66 offen sc1
  v_add_u32 v234, v15, v23
  buffer_load_dwordx4 v[80:83], v234, s[8:11], s66 offen sc1
  v_add_u32 v235, v16, v23
  buffer_load_dwordx4 v[84:87], v235, s[8:11], s66 offen sc1
  v_add_u32 v236, v17, v23
  buffer_load_dwordx4 v[88:91], v236, s[8:11], s66 offen sc1
  v_add_u32 v232, v13, v24
  buffer_load_dwordx4 v[92:95], v232, s[8:11], s66 offen sc1
  v_add_u32 v233, v14, v24
  buffer_load_dwordx4 v[96:99], v233, s[8:11], s66 offen sc1
  v_add_u32 v234, v15, v24
  buffer_load_dwordx4 v[100:103], v234, s[8:11], s66 offen sc1
  v_add_u32 v235, v16, v24
  buffer_load_dwordx4 v[104:107], v235, s[8:11], s66 offen sc1
  v_add_u32 v236, v17, v24
  buffer_load_dwordx4 v[108:111], v236, s[8:11], s66 offen sc1
  v_add_u32 v232, v13, v25
  buffer_load_dwordx4 v[112:115], v232, s[8:11], s66 offen sc1
  v_add_u32 v233, v14, v25
  buffer_load_dwordx4 v[116:119], v233, s[8:11], s66 offen sc1
  v_add_u32 v234, v15, v25
  buffer_load_dwordx4 v[120:123], v234, s[8:11], s66 offen sc1
  v_add_u32 v235, v16, v25
  buffer_load_dwordx4 v[124:127], v235, s[8:11], s66 offen sc1
  v_add_u32 v236, v17, v25
  buffer_load_dwordx4 v[128:131], v236, s[8:11], s66 offen sc1
  v_add_u32 v232, v13, v26
  buffer_load_dwordx4 v[132:135], v232, s[8:11], s66 offen sc1
  v_add_u32 v233, v14, v26
  buffer_load_dwordx4 v[136:139], v233, s[8:11], s66 offen sc1
  v_add_u32 v234, v15, v26
  buffer_load_dwordx4 v[140:143], v234, s[8:11], s66 offen sc1
  v_add_u32 v235, v16, v26
  buffer_load_dwordx4 v[144:147], v235, s[8:11], s66 offen sc1
  v_add_u32 v236, v17, v26
  buffer_load_dwordx4 v[148:151], v236, s[8:11], s66 offen sc1
  v_add_u32 v232, v13, v27
  buffer_load_dwordx4 v[152:155], v232, s[8:11], s66 offen sc1
  v_add_u32 v233, v14, v27
  buffer_load_dwordx4 v[156:159], v233, s[8:11], s66 offen sc1
  v_add_u32 v234, v15, v27
  buffer_load_dwordx4 v[160:163], v234, s[8:11], s66 offen sc1
  v_add_u32 v235, v16, v27
  buffer_load_dwordx4 v[164:167], v235, s[8:11], s66 offen sc1
  v_add_u32 v236, v17, v27
  buffer_load_dwordx4 v[168:171], v236, s[8:11], s66 offen sc1
  v_add_u32 v232, v13, v28
  buffer_load_dwordx4 v[172:175], v232, s[8:11], s66 offen sc1
  v_add_u32 v233, v14, v28
  buffer_load_dwordx4 v[176:179], v233, s[8:11], s66 offen sc1
  v_add_u32 v234, v15, v28
  buffer_load_dwordx4 v[180:183], v234, s[8:11], s66 offen sc1
  v_add_u32 v235, v16, v28
  buffer_load_dwordx4 v[184:187], v235, s[8:11], s66 offen sc1
  v_add_u32 v236, v17, v28
  buffer_load_dwordx4 v[188:191], v236, s[8:11], s66 offen sc1
  v_add_u32 v232, v13, v29
  buffer_load_dwordx4 v[192:195], v232, s[8:11], s66 offen sc1
  v_add_u32 v233, v14, v29
  buffer_load_dwordx4 v[196:199], v233, s[8:11], s66 offen sc1
  v_add_u32 v234, v15, v29
  buffer_load_dwordx4 v[200:203], v234, s[8:11], s66 offen sc1
  v_add_u32 v235, v16, v29
  buffer_load_dwordx4 v[204:207], v235, s[8:11], s66 offen sc1
  v_add_u32 v236, v17, v29
  buffer_load_dwordx4 v[208:211], v236, s[8:11], s66 offen sc1
  v_add_u32 v232, v13, v30
  buffer_load_dwordx4 v[212:215], v232, s[8:11], s66 offen sc1
  v_add_u32 v233, v14, v30
  buffer_load_dwordx4 v[216:219], v233, s[8:11], s66 offen sc1
  v_add_u32 v234, v15, v30
  buffer_load_dwordx4 v[220:223], v234, s[8:11], s66 offen sc1
  v_add_u32 v235, v16, v30
  buffer_load_dwordx4 v[224:227], v235, s[8:11], s66 offen sc1
  v_add_u32 v236, v17, v30
  buffer_load_dwordx4 v[228:231], v236, s[8:11], s66 offen sc1
  s_waitcnt vmcnt(35)
  v_dot2_f32_bf16 v52, v32, v72, 0
  v_dot2_f32_bf16 v60, v42, v82, 0
  v_dot2_f32_bf16 v52, v33, v73, v52
  v_dot2_f32_bf16 v60, v43, v83, v60
  v_dot2_f32_bf16 v52, v34, v74, v52
  v_dot2_f32_bf16 v60, v44, v84, v60
  v_dot2_f32_bf16 v52, v35, v75, v52
  v_dot2_f32_bf16 v60, v45, v85, v60
  v_dot2_f32_bf16 v52, v36, v76, v52
  v_dot2_f32_bf16 v60, v46, v86, v60
  v_dot2_f32_bf16 v52, v37, v77, v52
  v_dot2_f32_bf16 v60, v47, v87, v60
  v_dot2_f32_bf16 v52, v38, v78, v52
  v_dot2_f32_bf16 v60, v48, v88, v60
  v_dot2_f32_bf16 v52, v39, v79, v52
  v_dot2_f32_bf16 v60, v49, v89, v60
  v_dot2_f32_bf16 v52, v40, v80, v52
  v_dot2_f32_bf16 v60, v50, v90, v60
  v_dot2_f32_bf16 v52, v41, v81, v52
  v_dot2_f32_bf16 v60, v51, v91, v60
  v_add_u32 v232, v18, v23
  buffer_load_dwordx4 v[72:75], v232, s[8:11], s66 offen sc1
  v_add_u32 v233, v19, v23
  buffer_load_dwordx4 v[76:79], v233, s[8:11], s66 offen sc1
  v_add_u32 v234, v20, v23
  buffer_load_dwordx4 v[80:83], v234, s[8:11], s66 offen sc1
  v_add_u32 v235, v21, v23
  buffer_load_dwordx4 v[84:87], v235, s[8:11], s66 offen sc1
  v_add_u32 v236, v22, v23
  buffer_load_dwordx4 v[88:91], v236, s[8:11], s66 offen sc1
  s_waitcnt vmcnt(35)
  v_dot2_f32_bf16 v53, v32, v92, 0
  v_dot2_f32_bf16 v61, v42, v102, 0
  v_dot2_f32_bf16 v53, v33, v93, v53
  v_dot2_f32_bf16 v61, v43, v103, v61
  v_dot2_f32_bf16 v53, v34, v94, v53
  v_dot2_f32_bf16 v61, v44, v104, v61
  v_dot2_f32_bf16 v53, v35, v95, v53
  v_dot2_f32_bf16 v61, v45, v105, v61
  v_dot2_f32_bf16 v53, v36, v96, v53
  v_dot2_f32_bf16 v61, v46, v106, v61
  v_dot2_f32_bf16 v53, v37, v97, v53
  v_dot2_f32_bf16 v61, v47, v107, v61
  v_dot2_f32_bf16 v53, v38, v98, v53
  v_dot2_f32_bf16 v61, v48, v108, v61
  v_dot2_f32_bf16 v53, v39, v99, v53
  v_dot2_f32_bf16 v61, v49, v109, v61
  v_dot2_f32_bf16 v53, v40, v100, v53
  v_dot2_f32_bf16 v61, v50, v110, v61
  v_dot2_f32_bf16 v53, v41, v101, v53
  v_dot2_f32_bf16 v61, v51, v111, v61
  v_add_u32 v232, v18, v24
  buffer_load_dwordx4 v[92:95], v232, s[8:11], s66 offen sc1
  v_add_u32 v233, v19, v24
  buffer_load_dwordx4 v[96:99], v233, s[8:11], s66 offen sc1
  v_add_u32 v234, v20, v24
  buffer_load_dwordx4 v[100:103], v234, s[8:11], s66 offen sc1
  v_add_u32 v235, v21, v24
  buffer_load_dwordx4 v[104:107], v235, s[8:11], s66 offen sc1
  v_add_u32 v236, v22, v24
  buffer_load_dwordx4 v[108:111], v236, s[8:11], s66 offen sc1
  s_waitcnt vmcnt(35)
  v_dot2_f32_bf16 v54, v32, v112, 0
  v_dot2_f32_bf16 v62, v42, v122, 0
  v_dot2_f32_bf16 v54, v33, v113, v54
  v_dot2_f32_bf16 v62, v43, v123, v62
  v_dot2_f32_bf16 v54, v34, v114, v54
  v_dot2_f32_bf16 v62, v44, v124, v62
  v_dot2_f32_bf16 v54, v35, v115, v54
  v_dot2_f32_bf16 v62, v45, v125, v62
  v_dot2_f32_bf16 v54, v36, v116, v54
  v_dot2_f32_bf16 v62, v46, v126, v62
  v_dot2_f32_bf16 v54, v37, v117, v54
  v_dot2_f32_bf16 v62, v47, v127, v62
  v_dot2_f32_bf16 v54, v38, v118, v54
  v_dot2_f32_bf16 v62, v48, v128, v62
  v_dot2_f32_bf16 v54, v39, v119, v54
  v_dot2_f32_bf16 v62, v49, v129, v62
  v_dot2_f32_bf16 v54, v40, v120, v54
  v_dot2_f32_bf16 v62, v50, v130, v62
  v_dot2_f32_bf16 v54, v41, v121, v54
  v_dot2_f32_bf16 v62, v51, v131, v62
  v_add_u32 v232, v18, v25
  buffer_load_dwordx4 v[112:115], v232, s[8:11], s66 offen sc1
  v_add_u32 v233, v19, v25
  buffer_load_dwordx4 v[116:119], v233, s[8:11], s66 offen sc1
  v_add_u32 v234, v20, v25
  buffer_load_dwordx4 v[120:123], v234, s[8:11], s66 offen sc1
  v_add_u32 v235, v21, v25
  buffer_load_dwordx4 v[124:127], v235, s[8:11], s66 offen sc1
  v_add_u32 v236, v22, v25
  buffer_load_dwordx4 v[128:131], v236, s[8:11], s66 offen sc1
  s_waitcnt vmcnt(35)
  v_dot2_f32_bf16 v55, v32, v132, 0
  v_dot2_f32_bf16 v63, v42, v142, 0
  v_dot2_f32_bf16 v55, v33, v133, v55
  v_dot2_f32_bf16 v63, v43, v143, v63
  v_dot2_f32_bf16 v55, v34, v134, v55
  v_dot2_f32_bf16 v63, v44, v144, v63
  v_dot2_f32_bf16 v55, v35, v135, v55
  v_dot2_f32_bf16 v63, v45, v145, v63
  v_dot2_f32_bf16 v55, v36, v136, v55
  v_dot2_f32_bf16 v63, v46, v146, v63
  v_dot2_f32_bf16 v55, v37, v137, v55
  v_dot2_f32_bf16 v63, v47, v147, v63
  v_dot2_f32_bf16 v55, v38, v138, v55
  v_dot2_f32_bf16 v63, v48, v148, v63
  v_dot2_f32_bf16 v55, v39, v139, v55
  v_dot2_f32_bf16 v63, v49, v149, v63
  v_dot2_f32_bf16 v55, v40, v140, v55
  v_dot2_f32_bf16 v63, v50, v150, v63
  v_dot2_f32_bf16 v55, v41, v141, v55
  v_dot2_f32_bf16 v63, v51, v151, v63
  v_add_u32 v232, v18, v26
  buffer_load_dwordx4 v[132:135], v232, s[8:11], s66 offen sc1
  v_add_u32 v233, v19, v26
  buffer_load_dwordx4 v[136:139], v233, s[8:11], s66 offen sc1
  v_add_u32 v234, v20, v26
  buffer_load_dwordx4 v[140:143], v234, s[8:11], s66 offen sc1
  v_add_u32 v235, v21, v26
  buffer_load_dwordx4 v[144:147], v235, s[8:11], s66 offen sc1
  v_add_u32 v236, v22, v26
  buffer_load_dwordx4 v[148:151], v236, s[8:11], s66 offen sc1
  s_waitcnt vmcnt(35)
  v_dot2_f32_bf16 v56, v32, v152, 0
  v_dot2_f32_bf16 v64, v42, v162, 0
  v_dot2_f32_bf16 v56, v33, v153, v56
  v_dot2_f32_bf16 v64, v43, v163, v64
  v_dot2_f32_bf16 v56, v34, v154, v56
  v_dot2_f32_bf16 v64, v44, v164, v64
  v_dot2_f32_bf16 v56, v35, v155, v56
  v_dot2_f32_bf16 v64, v45, v165, v64
  v_dot2_f32_bf16 v56, v36, v156, v56
  v_dot2_f32_bf16 v64, v46, v166, v64
  v_dot2_f32_bf16 v56, v37, v157, v56
  v_dot2_f32_bf16 v64, v47, v167, v64
  v_dot2_f32_bf16 v56, v38, v158, v56
  v_dot2_f32_bf16 v64, v48, v168, v64
  v_dot2_f32_bf16 v56, v39, v159, v56
  v_dot2_f32_bf16 v64, v49, v169, v64
  v_dot2_f32_bf16 v56, v40, v160, v56
  v_dot2_f32_bf16 v64, v50, v170, v64
  v_dot2_f32_bf16 v56, v41, v161, v56
  v_dot2_f32_bf16 v64, v51, v171, v64
  v_add_u32 v232, v18, v27
  buffer_load_dwordx4 v[152:155], v232, s[8:11], s66 offen sc1
  v_add_u32 v233, v19, v27
  buffer_load_dwordx4 v[156:159], v233, s[8:11], s66 offen sc1
  v_add_u32 v234, v20, v27
  buffer_load_dwordx4 v[160:163], v234, s[8:11], s66 offen sc1
  v_add_u32 v235, v21, v27
  buffer_load_dwordx4 v[164:167], v235, s[8:11], s66 offen sc1
  v_add_u32 v236, v22, v27
  buffer_load_dwordx4 v[168:171], v236, s[8:11], s66 offen sc1
  s_waitcnt vmcnt(35)
  v_dot2_f32_bf16 v57, v32, v172, 0
  v_dot2_f32_bf16 v65, v42, v182, 0
  v_dot2_f32_bf16 v57, v33, v173, v57
  v_dot2_f32_bf16 v65, v43, v183, v65
  v_dot2_f32_bf16 v57, v34, v174, v57
  v_dot2_f32_bf16 v65, v44, v184, v65
  v_dot2_f32_bf16 v57, v35, v175, v57
  v_dot2_f32_bf16 v65, v45, v185, v65
  v_dot2_f32_bf16 v57, v36, v176, v57
  v_dot2_f32_bf16 v65, v46, v186, v65
  v_dot2_f32_bf16 v57, v37, v177, v57
  v_dot2_f32_bf16 v65, v47, v187, v65
  v_dot2_f32_bf16 v57, v38, v178, v57
  v_dot2_f32_bf16 v65, v48, v188, v65
  v_dot2_f32_bf16 v57, v39, v179, v57
  v_dot2_f32_bf16 v65, v49, v189, v65
  v_dot2_f32_bf16 v57, v40, v180, v57
  v_dot2_f32_bf16 v65, v50, v190, v65
  v_dot2_f32_bf16 v57, v41, v181, v57
  v_dot2_f32_bf16 v65, v51, v191, v65
  v_add_u32 v232, v18, v28
  buffer_load_dwordx4 v[172:175], v232, s[8:11], s66 offen sc1
  v_add_u32 v233, v19, v28
  buffer_load_dwordx4 v[176:179], v233, s[8:11], s66 offen sc1
  v_add_u32 v234, v20, v28
  buffer_load_dwordx4 v[180:183], v234, s[8:11], s66 offen sc1
  v_add_u32 v235, v21, v28
  buffer_load_dwordx4 v[184:187], v235, s[8:11], s66 offen sc1
  v_add_u32 v236, v22, v28
  buffer_load_dwordx4 v[188:191], v236, s[8:11], s66 offen sc1
  s_waitcnt vmcnt(35)
  v_dot2_f32_bf16 v58, v32, v192, 0
  v_dot2_f32_bf16 v66, v42, v202, 0
  v_dot2_f32_bf16 v58, v33, v193, v58
  v_dot2_f32_bf16 v66, v43, v203, v66
  v_dot2_f32_bf16 v58, v34, v194, v58
  v_dot2_f32_bf16 v66, v44, v204, v66
  v_dot2_f32_bf16 v58, v35, v195, v58
  v_dot2_f32_bf16 v66, v45, v205, v66
  v_dot2_f32_bf16 v58, v36, v196, v58
  v_dot2_f32_bf16 v66, v46, v206, v66
  v_dot2_f32_bf16 v58, v37, v197, v58
  v_dot2_f32_bf16 v66, v47, v207, v66
  v_dot2_f32_bf16 v58, v38, v198, v58
  v_dot2_f32_bf16 v66, v48, v208, v66
  v_dot2_f32_bf16 v58, v39, v199, v58
  v_dot2_f32_bf16 v66, v49, v209, v66
  v_dot2_f32_bf16 v58, v40, v200, v58
  v_dot2_f32_bf16 v66, v50, v210, v66
  v_dot2_f32_bf16 v58, v41, v201, v58
  v_dot2_f32_bf16 v66, v51, v211, v66
  v_add_u32 v232, v18, v29
  buffer_load_dwordx4 v[192:195], v232, s[8:11], s66 offen sc1
  v_add_u32 v233, v19, v29
  buffer_load_dwordx4 v[196:199], v233, s[8:11], s66 offen sc1
  v_add_u32 v234, v20, v29
  buffer_load_dwordx4 v[200:203], v234, s[8:11], s66 offen sc1
  v_add_u32 v235, v21, v29
  buffer_load_dwordx4 v[204:207], v235, s[8:11], s66 offen sc1
  v_add_u32 v236, v22, v29
  buffer_load_dwordx4 v[208:211], v236, s[8:11], s66 offen sc1
  s_waitcnt vmcnt(35)
  v_dot2_f32_bf16 v59, v32, v212, 0
  v_dot2_f32_bf16 v67, v42, v222, 0
  v_dot2_f32_bf16 v59, v33, v213, v59
  v_dot2_f32_bf16 v67, v43, v223, v67
  v_dot2_f32_bf16 v59, v34, v214, v59
  v_dot2_f32_bf16 v67, v44, v224, v67
  v_dot2_f32_bf16 v59, v35, v215, v59
  v_dot2_f32_bf16 v67, v45, v225, v67
  v_dot2_f32_bf16 v59, v36, v216, v59
  v_dot2_f32_bf16 v67, v46, v226, v67
  v_dot2_f32_bf16 v59, v37, v217, v59
  v_dot2_f32_bf16 v67, v47, v227, v67
  v_dot2_f32_bf16 v59, v38, v218, v59
  v_dot2_f32_bf16 v67, v48, v228, v67
  v_dot2_f32_bf16 v59, v39, v219, v59
  v_dot2_f32_bf16 v67, v49, v229, v67
  v_dot2_f32_bf16 v59, v40, v220, v59
  v_dot2_f32_bf16 v67, v50, v230, v67
  v_dot2_f32_bf16 v59, v41, v221, v59
  v_dot2_f32_bf16 v67, v51, v231, v67
  v_add_u32 v232, v18, v30
  buffer_load_dwordx4 v[212:215], v232, s[8:11], s66 offen sc1
  v_add_u32 v233, v19, v30
  buffer_load_dwordx4 v[216:219], v233, s[8:11], s66 offen sc1
  v_add_u32 v234, v20, v30
  buffer_load_dwordx4 v[220:223], v234, s[8:11], s66 offen sc1
  v_add_u32 v235, v21, v30
  buffer_load_dwordx4 v[224:227], v235, s[8:11], s66 offen sc1
  v_add_u32 v236, v22, v30
  buffer_load_dwordx4 v[228:231], v236, s[8:11], s66 offen sc1
  s_mov_b32 s46, 1051011932
  v_mov_b32 v232, 3481618353
  v_cndmask_b32 v53, v53, v232, s[74:75]
  v_cndmask_b32 v54, v54, v232, s[76:77]
  v_cndmask_b32 v55, v55, v232, s[78:79]
  v_cndmask_b32 v56, v56, v232, s[80:81]
  v_cndmask_b32 v57, v57, v232, s[82:83]
  v_cndmask_b32 v58, v58, v232, s[84:85]
  v_cndmask_b32 v59, v59, v232, s[86:87]
  v_max_f32 v233, v52, v53
  v_max3_f32 v233, v233, v54, v55
  v_max3_f32 v233, v233, v56, v57
  v_max3_f32 v233, v233, v58, v59
  v_mul_f32 v233, s46, v233
  v_fma_f32 v52, v52, s46, -v233
  v_fma_f32 v53, v53, s46, -v233
  v_fma_f32 v54, v54, s46, -v233
  v_fma_f32 v55, v55, s46, -v233
  v_fma_f32 v56, v56, s46, -v233
  v_fma_f32 v57, v57, s46, -v233
  v_fma_f32 v58, v58, s46, -v233
  v_fma_f32 v59, v59, s46, -v233
  v_exp_f32 v52, v52
  v_exp_f32 v53, v53
  v_exp_f32 v54, v54
  v_exp_f32 v55, v55
  v_exp_f32 v56, v56
  v_exp_f32 v57, v57
  v_exp_f32 v58, v58
  v_exp_f32 v59, v59
  v_add_f32 v233, v52, v53
  v_add_f32 v233, v233, v54
  v_add_f32 v233, v233, v55
  v_add_f32 v233, v233, v56
  v_add_f32 v233, v233, v57
  v_add_f32 v233, v233, v58
  v_add_f32 v233, v233, v59
  v_rcp_f32 v233, v233
  s_nop 0
  v_mul_f32 v52, v52, v233
  v_mul_f32 v53, v53, v233
  v_mul_f32 v54, v54, v233
  v_mul_f32 v55, v55, v233
  v_mul_f32 v56, v56, v233
  v_mul_f32 v57, v57, v233
  v_mul_f32 v58, v58, v233
  v_mul_f32 v59, v59, v233
  v_cndmask_b32 v61, v61, v232, s[74:75]
  v_cndmask_b32 v62, v62, v232, s[76:77]
  v_cndmask_b32 v63, v63, v232, s[78:79]
  v_cndmask_b32 v64, v64, v232, s[80:81]
  v_cndmask_b32 v65, v65, v232, s[82:83]
  v_cndmask_b32 v66, v66, v232, s[84:85]
  v_cndmask_b32 v67, v67, v232, s[86:87]
  v_max_f32 v233, v60, v61
  v_max3_f32 v233, v233, v62, v63
  v_max3_f32 v233, v233, v64, v65
  v_max3_f32 v233, v233, v66, v67
  v_mul_f32 v233, s46, v233
  v_fma_f32 v60, v60, s46, -v233
  v_fma_f32 v61, v61, s46, -v233
  v_fma_f32 v62, v62, s46, -v233
  v_fma_f32 v63, v63, s46, -v233
  v_fma_f32 v64, v64, s46, -v233
  v_fma_f32 v65, v65, s46, -v233
  v_fma_f32 v66, v66, s46, -v233
  v_fma_f32 v67, v67, s46, -v233
  v_exp_f32 v60, v60
  v_exp_f32 v61, v61
  v_exp_f32 v62, v62
  v_exp_f32 v63, v63
  v_exp_f32 v64, v64
  v_exp_f32 v65, v65
  v_exp_f32 v66, v66
  v_exp_f32 v67, v67
  v_add_f32 v233, v60, v61
  v_add_f32 v233, v233, v62
  v_add_f32 v233, v233, v63
  v_add_f32 v233, v233, v64
  v_add_f32 v233, v233, v65
  v_add_f32 v233, v233, v66
  v_add_f32 v233, v233, v67
  v_rcp_f32 v233, v233
  s_nop 0
  v_mul_f32 v60, v60, v233
  v_mul_f32 v61, v61, v233
  v_mul_f32 v62, v62, v233
  v_mul_f32 v63, v63, v233
  v_mul_f32 v64, v64, v233
  v_mul_f32 v65, v65, v233
  v_mul_f32 v66, v66, v233
  v_mul_f32 v67, v67, v233
  v_cvt_pk_bf16_f32 v52, v52, 0
  v_lshlrev_b32 v236, 16, v52
  v_cvt_pk_bf16_f32 v53, v53, 0
  v_lshlrev_b32 v237, 16, v53
  v_cvt_pk_bf16_f32 v54, v54, 0
  v_lshlrev_b32 v238, 16, v54
  v_cvt_pk_bf16_f32 v55, v55, 0
  v_lshlrev_b32 v239, 16, v55
  v_cvt_pk_bf16_f32 v56, v56, 0
  v_lshlrev_b32 v240, 16, v56
  v_cvt_pk_bf16_f32 v57, v57, 0
  v_lshlrev_b32 v241, 16, v57
  v_cvt_pk_bf16_f32 v58, v58, 0
  v_lshlrev_b32 v242, 16, v58
  v_cvt_pk_bf16_f32 v59, v59, 0
  v_lshlrev_b32 v243, 16, v59
  v_cvt_pk_bf16_f32 v60, v60, 0
  v_lshlrev_b32 v244, 16, v60
  v_cvt_pk_bf16_f32 v61, v61, 0
  v_lshlrev_b32 v245, 16, v61
  v_cvt_pk_bf16_f32 v62, v62, 0
  v_lshlrev_b32 v246, 16, v62
  v_cvt_pk_bf16_f32 v63, v63, 0
  v_lshlrev_b32 v247, 16, v63
  v_cvt_pk_bf16_f32 v64, v64, 0
  v_lshlrev_b32 v248, 16, v64
  v_cvt_pk_bf16_f32 v65, v65, 0
  v_lshlrev_b32 v249, 16, v65
  v_cvt_pk_bf16_f32 v66, v66, 0
  v_lshlrev_b32 v250, 16, v66
  v_cvt_pk_bf16_f32 v67, v67, 0
  v_lshlrev_b32 v251, 16, v67
  s_waitcnt vmcnt(35)
  v_dot2_f32_bf16 v8, v72, v52, 0
  v_dot2_f32_bf16 v9, v72, v236, 0
  v_dot2_f32_bf16 v10, v73, v52, 0
  v_dot2_f32_bf16 v11, v73, v236, 0
  v_dot2_f32_bf16 v12, v74, v52, 0
  v_dot2_f32_bf16 v13, v74, v236, 0
  v_dot2_f32_bf16 v14, v75, v52, 0
  v_dot2_f32_bf16 v15, v75, v236, 0
  v_dot2_f32_bf16 v16, v76, v52, 0
  v_dot2_f32_bf16 v17, v76, v236, 0
  v_dot2_f32_bf16 v18, v77, v52, 0
  v_dot2_f32_bf16 v19, v77, v236, 0
  v_dot2_f32_bf16 v20, v78, v52, 0
  v_dot2_f32_bf16 v21, v78, v236, 0
  v_dot2_f32_bf16 v22, v79, v52, 0
  v_dot2_f32_bf16 v23, v79, v236, 0
  v_dot2_f32_bf16 v24, v80, v52, 0
  v_dot2_f32_bf16 v25, v80, v236, 0
  v_dot2_f32_bf16 v26, v81, v52, 0
  v_dot2_f32_bf16 v27, v81, v236, 0
  v_dot2_f32_bf16 v28, v82, v60, 0
  v_dot2_f32_bf16 v29, v82, v244, 0
  v_dot2_f32_bf16 v30, v83, v60, 0
  v_dot2_f32_bf16 v31, v83, v244, 0
  v_dot2_f32_bf16 v32, v84, v60, 0
  v_dot2_f32_bf16 v33, v84, v244, 0
  v_dot2_f32_bf16 v34, v85, v60, 0
  v_dot2_f32_bf16 v35, v85, v244, 0
  v_dot2_f32_bf16 v36, v86, v60, 0
  v_dot2_f32_bf16 v37, v86, v244, 0
  v_dot2_f32_bf16 v38, v87, v60, 0
  v_dot2_f32_bf16 v39, v87, v244, 0
  v_dot2_f32_bf16 v40, v88, v60, 0
  v_dot2_f32_bf16 v41, v88, v244, 0
  v_dot2_f32_bf16 v42, v89, v60, 0
  v_dot2_f32_bf16 v43, v89, v244, 0
  v_dot2_f32_bf16 v44, v90, v60, 0
  v_dot2_f32_bf16 v45, v90, v244, 0
  v_dot2_f32_bf16 v46, v91, v60, 0
  v_dot2_f32_bf16 v47, v91, v244, 0
  s_waitcnt vmcnt(30)
  v_dot2_f32_bf16 v8, v92, v53, v8
  v_dot2_f32_bf16 v9, v92, v237, v9
  v_dot2_f32_bf16 v10, v93, v53, v10
  v_dot2_f32_bf16 v11, v93, v237, v11
  v_dot2_f32_bf16 v12, v94, v53, v12
  v_dot2_f32_bf16 v13, v94, v237, v13
  v_dot2_f32_bf16 v14, v95, v53, v14
  v_dot2_f32_bf16 v15, v95, v237, v15
  v_dot2_f32_bf16 v16, v96, v53, v16
  v_dot2_f32_bf16 v17, v96, v237, v17
  v_dot2_f32_bf16 v18, v97, v53, v18
  v_dot2_f32_bf16 v19, v97, v237, v19
  v_dot2_f32_bf16 v20, v98, v53, v20
  v_dot2_f32_bf16 v21, v98, v237, v21
  v_dot2_f32_bf16 v22, v99, v53, v22
  v_dot2_f32_bf16 v23, v99, v237, v23
  v_dot2_f32_bf16 v24, v100, v53, v24
  v_dot2_f32_bf16 v25, v100, v237, v25
  v_dot2_f32_bf16 v26, v101, v53, v26
  v_dot2_f32_bf16 v27, v101, v237, v27
  v_dot2_f32_bf16 v28, v102, v61, v28
  v_dot2_f32_bf16 v29, v102, v245, v29
  v_dot2_f32_bf16 v30, v103, v61, v30
  v_dot2_f32_bf16 v31, v103, v245, v31
  v_dot2_f32_bf16 v32, v104, v61, v32
  v_dot2_f32_bf16 v33, v104, v245, v33
  v_dot2_f32_bf16 v34, v105, v61, v34
  v_dot2_f32_bf16 v35, v105, v245, v35
  v_dot2_f32_bf16 v36, v106, v61, v36
  v_dot2_f32_bf16 v37, v106, v245, v37
  v_dot2_f32_bf16 v38, v107, v61, v38
  v_dot2_f32_bf16 v39, v107, v245, v39
  v_dot2_f32_bf16 v40, v108, v61, v40
  v_dot2_f32_bf16 v41, v108, v245, v41
  v_dot2_f32_bf16 v42, v109, v61, v42
  v_dot2_f32_bf16 v43, v109, v245, v43
  v_dot2_f32_bf16 v44, v110, v61, v44
  v_dot2_f32_bf16 v45, v110, v245, v45
  v_dot2_f32_bf16 v46, v111, v61, v46
  v_dot2_f32_bf16 v47, v111, v245, v47
  s_waitcnt vmcnt(25)
  v_dot2_f32_bf16 v8, v112, v54, v8
  v_dot2_f32_bf16 v9, v112, v238, v9
  v_dot2_f32_bf16 v10, v113, v54, v10
  v_dot2_f32_bf16 v11, v113, v238, v11
  v_dot2_f32_bf16 v12, v114, v54, v12
  v_dot2_f32_bf16 v13, v114, v238, v13
  v_dot2_f32_bf16 v14, v115, v54, v14
  v_dot2_f32_bf16 v15, v115, v238, v15
  v_dot2_f32_bf16 v16, v116, v54, v16
  v_dot2_f32_bf16 v17, v116, v238, v17
  v_dot2_f32_bf16 v18, v117, v54, v18
  v_dot2_f32_bf16 v19, v117, v238, v19
  v_dot2_f32_bf16 v20, v118, v54, v20
  v_dot2_f32_bf16 v21, v118, v238, v21
  v_dot2_f32_bf16 v22, v119, v54, v22
  v_dot2_f32_bf16 v23, v119, v238, v23
  v_dot2_f32_bf16 v24, v120, v54, v24
  v_dot2_f32_bf16 v25, v120, v238, v25
  v_dot2_f32_bf16 v26, v121, v54, v26
  v_dot2_f32_bf16 v27, v121, v238, v27
  v_dot2_f32_bf16 v28, v122, v62, v28
  v_dot2_f32_bf16 v29, v122, v246, v29
  v_dot2_f32_bf16 v30, v123, v62, v30
  v_dot2_f32_bf16 v31, v123, v246, v31
  v_dot2_f32_bf16 v32, v124, v62, v32
  v_dot2_f32_bf16 v33, v124, v246, v33
  v_dot2_f32_bf16 v34, v125, v62, v34
  v_dot2_f32_bf16 v35, v125, v246, v35
  v_dot2_f32_bf16 v36, v126, v62, v36
  v_dot2_f32_bf16 v37, v126, v246, v37
  v_dot2_f32_bf16 v38, v127, v62, v38
  v_dot2_f32_bf16 v39, v127, v246, v39
  v_dot2_f32_bf16 v40, v128, v62, v40
  v_dot2_f32_bf16 v41, v128, v246, v41
  v_dot2_f32_bf16 v42, v129, v62, v42
  v_dot2_f32_bf16 v43, v129, v246, v43
  v_dot2_f32_bf16 v44, v130, v62, v44
  v_dot2_f32_bf16 v45, v130, v246, v45
  v_dot2_f32_bf16 v46, v131, v62, v46
  v_dot2_f32_bf16 v47, v131, v246, v47
  s_waitcnt vmcnt(20)
  v_dot2_f32_bf16 v8, v132, v55, v8
  v_dot2_f32_bf16 v9, v132, v239, v9
  v_dot2_f32_bf16 v10, v133, v55, v10
  v_dot2_f32_bf16 v11, v133, v239, v11
  v_dot2_f32_bf16 v12, v134, v55, v12
  v_dot2_f32_bf16 v13, v134, v239, v13
  v_dot2_f32_bf16 v14, v135, v55, v14
  v_dot2_f32_bf16 v15, v135, v239, v15
  v_dot2_f32_bf16 v16, v136, v55, v16
  v_dot2_f32_bf16 v17, v136, v239, v17
  v_dot2_f32_bf16 v18, v137, v55, v18
  v_dot2_f32_bf16 v19, v137, v239, v19
  v_dot2_f32_bf16 v20, v138, v55, v20
  v_dot2_f32_bf16 v21, v138, v239, v21
  v_dot2_f32_bf16 v22, v139, v55, v22
  v_dot2_f32_bf16 v23, v139, v239, v23
  v_dot2_f32_bf16 v24, v140, v55, v24
  v_dot2_f32_bf16 v25, v140, v239, v25
  v_dot2_f32_bf16 v26, v141, v55, v26
  v_dot2_f32_bf16 v27, v141, v239, v27
  v_dot2_f32_bf16 v28, v142, v63, v28
  v_dot2_f32_bf16 v29, v142, v247, v29
  v_dot2_f32_bf16 v30, v143, v63, v30
  v_dot2_f32_bf16 v31, v143, v247, v31
  v_dot2_f32_bf16 v32, v144, v63, v32
  v_dot2_f32_bf16 v33, v144, v247, v33
  v_dot2_f32_bf16 v34, v145, v63, v34
  v_dot2_f32_bf16 v35, v145, v247, v35
  v_dot2_f32_bf16 v36, v146, v63, v36
  v_dot2_f32_bf16 v37, v146, v247, v37
  v_dot2_f32_bf16 v38, v147, v63, v38
  v_dot2_f32_bf16 v39, v147, v247, v39
  v_dot2_f32_bf16 v40, v148, v63, v40
  v_dot2_f32_bf16 v41, v148, v247, v41
  v_dot2_f32_bf16 v42, v149, v63, v42
  v_dot2_f32_bf16 v43, v149, v247, v43
  v_dot2_f32_bf16 v44, v150, v63, v44
  v_dot2_f32_bf16 v45, v150, v247, v45
  v_dot2_f32_bf16 v46, v151, v63, v46
  v_dot2_f32_bf16 v47, v151, v247, v47
  s_waitcnt vmcnt(15)
  v_dot2_f32_bf16 v8, v152, v56, v8
  v_dot2_f32_bf16 v9, v152, v240, v9
  v_dot2_f32_bf16 v10, v153, v56, v10
  v_dot2_f32_bf16 v11, v153, v240, v11
  v_dot2_f32_bf16 v12, v154, v56, v12
  v_dot2_f32_bf16 v13, v154, v240, v13
  v_dot2_f32_bf16 v14, v155, v56, v14
  v_dot2_f32_bf16 v15, v155, v240, v15
  v_dot2_f32_bf16 v16, v156, v56, v16
  v_dot2_f32_bf16 v17, v156, v240, v17
  v_dot2_f32_bf16 v18, v157, v56, v18
  v_dot2_f32_bf16 v19, v157, v240, v19
  v_dot2_f32_bf16 v20, v158, v56, v20
  v_dot2_f32_bf16 v21, v158, v240, v21
  v_dot2_f32_bf16 v22, v159, v56, v22
  v_dot2_f32_bf16 v23, v159, v240, v23
  v_dot2_f32_bf16 v24, v160, v56, v24
  v_dot2_f32_bf16 v25, v160, v240, v25
  v_dot2_f32_bf16 v26, v161, v56, v26
  v_dot2_f32_bf16 v27, v161, v240, v27
  v_dot2_f32_bf16 v28, v162, v64, v28
  v_dot2_f32_bf16 v29, v162, v248, v29
  v_dot2_f32_bf16 v30, v163, v64, v30
  v_dot2_f32_bf16 v31, v163, v248, v31
  v_dot2_f32_bf16 v32, v164, v64, v32
  v_dot2_f32_bf16 v33, v164, v248, v33
  v_dot2_f32_bf16 v34, v165, v64, v34
  v_dot2_f32_bf16 v35, v165, v248, v35
  v_dot2_f32_bf16 v36, v166, v64, v36
  v_dot2_f32_bf16 v37, v166, v248, v37
  v_dot2_f32_bf16 v38, v167, v64, v38
  v_dot2_f32_bf16 v39, v167, v248, v39
  v_dot2_f32_bf16 v40, v168, v64, v40
  v_dot2_f32_bf16 v41, v168, v248, v41
  v_dot2_f32_bf16 v42, v169, v64, v42
  v_dot2_f32_bf16 v43, v169, v248, v43
  v_dot2_f32_bf16 v44, v170, v64, v44
  v_dot2_f32_bf16 v45, v170, v248, v45
  v_dot2_f32_bf16 v46, v171, v64, v46
  v_dot2_f32_bf16 v47, v171, v248, v47
  s_waitcnt vmcnt(10)
  v_dot2_f32_bf16 v8, v172, v57, v8
  v_dot2_f32_bf16 v9, v172, v241, v9
  v_dot2_f32_bf16 v10, v173, v57, v10
  v_dot2_f32_bf16 v11, v173, v241, v11
  v_dot2_f32_bf16 v12, v174, v57, v12
  v_dot2_f32_bf16 v13, v174, v241, v13
  v_dot2_f32_bf16 v14, v175, v57, v14
  v_dot2_f32_bf16 v15, v175, v241, v15
  v_dot2_f32_bf16 v16, v176, v57, v16
  v_dot2_f32_bf16 v17, v176, v241, v17
  v_dot2_f32_bf16 v18, v177, v57, v18
  v_dot2_f32_bf16 v19, v177, v241, v19
  v_dot2_f32_bf16 v20, v178, v57, v20
  v_dot2_f32_bf16 v21, v178, v241, v21
  v_dot2_f32_bf16 v22, v179, v57, v22
  v_dot2_f32_bf16 v23, v179, v241, v23
  v_dot2_f32_bf16 v24, v180, v57, v24
  v_dot2_f32_bf16 v25, v180, v241, v25
  v_dot2_f32_bf16 v26, v181, v57, v26
  v_dot2_f32_bf16 v27, v181, v241, v27
  v_dot2_f32_bf16 v28, v182, v65, v28
  v_dot2_f32_bf16 v29, v182, v249, v29
  v_dot2_f32_bf16 v30, v183, v65, v30
  v_dot2_f32_bf16 v31, v183, v249, v31
  v_dot2_f32_bf16 v32, v184, v65, v32
  v_dot2_f32_bf16 v33, v184, v249, v33
  v_dot2_f32_bf16 v34, v185, v65, v34
  v_dot2_f32_bf16 v35, v185, v249, v35
  v_dot2_f32_bf16 v36, v186, v65, v36
  v_dot2_f32_bf16 v37, v186, v249, v37
  v_dot2_f32_bf16 v38, v187, v65, v38
  v_dot2_f32_bf16 v39, v187, v249, v39
  v_dot2_f32_bf16 v40, v188, v65, v40
  v_dot2_f32_bf16 v41, v188, v249, v41
  v_dot2_f32_bf16 v42, v189, v65, v42
  v_dot2_f32_bf16 v43, v189, v249, v43
  v_dot2_f32_bf16 v44, v190, v65, v44
  v_dot2_f32_bf16 v45, v190, v249, v45
  v_dot2_f32_bf16 v46, v191, v65, v46
  v_dot2_f32_bf16 v47, v191, v249, v47
  s_waitcnt vmcnt(5)
  v_dot2_f32_bf16 v8, v192, v58, v8
  v_dot2_f32_bf16 v9, v192, v242, v9
  v_dot2_f32_bf16 v10, v193, v58, v10
  v_dot2_f32_bf16 v11, v193, v242, v11
  v_dot2_f32_bf16 v12, v194, v58, v12
  v_dot2_f32_bf16 v13, v194, v242, v13
  v_dot2_f32_bf16 v14, v195, v58, v14
  v_dot2_f32_bf16 v15, v195, v242, v15
  v_dot2_f32_bf16 v16, v196, v58, v16
  v_dot2_f32_bf16 v17, v196, v242, v17
  v_dot2_f32_bf16 v18, v197, v58, v18
  v_dot2_f32_bf16 v19, v197, v242, v19
  v_dot2_f32_bf16 v20, v198, v58, v20
  v_dot2_f32_bf16 v21, v198, v242, v21
  v_dot2_f32_bf16 v22, v199, v58, v22
  v_dot2_f32_bf16 v23, v199, v242, v23
  v_dot2_f32_bf16 v24, v200, v58, v24
  v_dot2_f32_bf16 v25, v200, v242, v25
  v_dot2_f32_bf16 v26, v201, v58, v26
  v_dot2_f32_bf16 v27, v201, v242, v27
  v_dot2_f32_bf16 v28, v202, v66, v28
  v_dot2_f32_bf16 v29, v202, v250, v29
  v_dot2_f32_bf16 v30, v203, v66, v30
  v_dot2_f32_bf16 v31, v203, v250, v31
  v_dot2_f32_bf16 v32, v204, v66, v32
  v_dot2_f32_bf16 v33, v204, v250, v33
  v_dot2_f32_bf16 v34, v205, v66, v34
  v_dot2_f32_bf16 v35, v205, v250, v35
  v_dot2_f32_bf16 v36, v206, v66, v36
  v_dot2_f32_bf16 v37, v206, v250, v37
  v_dot2_f32_bf16 v38, v207, v66, v38
  v_dot2_f32_bf16 v39, v207, v250, v39
  v_dot2_f32_bf16 v40, v208, v66, v40
  v_dot2_f32_bf16 v41, v208, v250, v41
  v_dot2_f32_bf16 v42, v209, v66, v42
  v_dot2_f32_bf16 v43, v209, v250, v43
  v_dot2_f32_bf16 v44, v210, v66, v44
  v_dot2_f32_bf16 v45, v210, v250, v45
  v_dot2_f32_bf16 v46, v211, v66, v46
  v_dot2_f32_bf16 v47, v211, v250, v47
  s_waitcnt vmcnt(0)
  v_dot2_f32_bf16 v8, v212, v59, v8
  v_dot2_f32_bf16 v9, v212, v243, v9
  v_dot2_f32_bf16 v10, v213, v59, v10
  v_dot2_f32_bf16 v11, v213, v243, v11
  v_dot2_f32_bf16 v12, v214, v59, v12
  v_dot2_f32_bf16 v13, v214, v243, v13
  v_dot2_f32_bf16 v14, v215, v59, v14
  v_dot2_f32_bf16 v15, v215, v243, v15
  v_dot2_f32_bf16 v16, v216, v59, v16
  v_dot2_f32_bf16 v17, v216, v243, v17
  v_dot2_f32_bf16 v18, v217, v59, v18
  v_dot2_f32_bf16 v19, v217, v243, v19
  v_dot2_f32_bf16 v20, v218, v59, v20
  v_dot2_f32_bf16 v21, v218, v243, v21
  v_dot2_f32_bf16 v22, v219, v59, v22
  v_dot2_f32_bf16 v23, v219, v243, v23
  v_dot2_f32_bf16 v24, v220, v59, v24
  v_dot2_f32_bf16 v25, v220, v243, v25
  v_dot2_f32_bf16 v26, v221, v59, v26
  v_dot2_f32_bf16 v27, v221, v243, v27
  v_dot2_f32_bf16 v28, v222, v67, v28
  v_dot2_f32_bf16 v29, v222, v251, v29
  v_dot2_f32_bf16 v30, v223, v67, v30
  v_dot2_f32_bf16 v31, v223, v251, v31
  v_dot2_f32_bf16 v32, v224, v67, v32
  v_dot2_f32_bf16 v33, v224, v251, v33
  v_dot2_f32_bf16 v34, v225, v67, v34
  v_dot2_f32_bf16 v35, v225, v251, v35
  v_dot2_f32_bf16 v36, v226, v67, v36
  v_dot2_f32_bf16 v37, v226, v251, v37
  v_dot2_f32_bf16 v38, v227, v67, v38
  v_dot2_f32_bf16 v39, v227, v251, v39
  v_dot2_f32_bf16 v40, v228, v67, v40
  v_dot2_f32_bf16 v41, v228, v251, v41
  v_dot2_f32_bf16 v42, v229, v67, v42
  v_dot2_f32_bf16 v43, v229, v251, v43
  v_dot2_f32_bf16 v44, v230, v67, v44
  v_dot2_f32_bf16 v45, v230, v251, v45
  v_dot2_f32_bf16 v46, v231, v67, v46
  v_dot2_f32_bf16 v47, v231, v251, v47
  v_cvt_pk_bf16_f32 v72, v8, v9
  v_cvt_pk_bf16_f32 v73, v10, v11
  v_cvt_pk_bf16_f32 v74, v12, v13
  v_cvt_pk_bf16_f32 v75, v14, v15
  v_cvt_pk_bf16_f32 v76, v16, v17
  v_cvt_pk_bf16_f32 v77, v18, v19
  v_cvt_pk_bf16_f32 v78, v20, v21
  v_cvt_pk_bf16_f32 v79, v22, v23
  v_cvt_pk_bf16_f32 v80, v24, v25
  v_cvt_pk_bf16_f32 v81, v26, v27
  v_cvt_pk_bf16_f32 v82, v28, v29
  v_cvt_pk_bf16_f32 v83, v30, v31
  v_cvt_pk_bf16_f32 v84, v32, v33
  v_cvt_pk_bf16_f32 v85, v34, v35
  v_cvt_pk_bf16_f32 v86, v36, v37
  v_cvt_pk_bf16_f32 v87, v38, v39
  v_cvt_pk_bf16_f32 v88, v40, v41
  v_cvt_pk_bf16_f32 v89, v42, v43
  v_cvt_pk_bf16_f32 v90, v44, v45
  v_cvt_pk_bf16_f32 v91, v46, v47
  v_lshlrev_b32 v3, 8, v3
  v_lshl_add_u32 v3, v5, 4, v3
  v_add_u32 v3, 122880, v3
  ds_write_b128 v3, v[72:75] offset:0
  ds_write_b128 v3, v[76:79] offset:256
  ds_write_b128 v3, v[80:83] offset:512
  ds_write_b128 v3, v[84:87] offset:768
  ds_write_b128 v3, v[88:91] offset:1024
  s_waitcnt lgkmcnt(0)
  s_barrier
  v_lshlrev_b32 v13, 4, v0
  v_add_u32 v13, 122880, v13
  ds_read_b128 v[20:23], v13 offset:0
  ds_read_b128 v[24:27], v13 offset:1024
  ds_read_b128 v[28:31], v13 offset:2048
  ds_read_b128 v[32:35], v13 offset:3072
  ds_read_b128 v[36:39], v13 offset:4096
  ds_read_b128 v[40:43], v13 offset:5120
  ds_read_b128 v[44:47], v13 offset:6144
  ds_read_b128 v[48:51], v13 offset:7168
  ds_read_b128 v[52:55], v13 offset:8192
  ds_read_b128 v[56:59], v13 offset:9216
  ds_read_b128 v[60:63], v13 offset:10240
  ds_read_b128 v[64:67], v13 offset:11264
  s_waitcnt lgkmcnt(4)
  ds_read_b128 v[68:71], v13 offset:12288
  ds_read_b128 v[72:75], v13 offset:13312
  ds_read_b128 v[76:79], v13 offset:14336
  ds_read_b128 v[80:83], v13 offset:15360
  ds_read_b128 v[84:87], v13 offset:16384
  ds_read_b128 v[88:91], v13 offset:17408
  ds_read_b128 v[92:95], v13 offset:18432
  ds_read_b128 v[96:99], v13 offset:19456
  s_mov_b32 s4, s20
  s_mov_b32 s5, s21
  s_mov_b32 s6, 819200
  s_mov_b32 s7, 0x20000
  s_mov_b32 s12, s36
  s_mov_b32 s13, s37
  s_mov_b32 s14, 5242880
  s_mov_b32 s15, 0x20000
  v_mul_u32_u24 v12, 2560, v6
  v_lshrrev_b32 v14, 4, v0
  v_lshl_add_u32 v12, v14, 3, v12
  s_lshl_b32 s46, s42, 5
  v_add_u32 v12, s46, v12
  s_mov_b32 s66, 0
  s_waitcnt lgkmcnt(0)
  v_lshrrev_b32 v13, 3, v0
  v_lshrrev_b32 v14, 2, v13
  v_lshlrev_b32 v14, 3, v14
  v_and_b32 v8, 3, v13
  v_add_u32 v8, v8, v14
  s_and_b32 s46, s42, 1
  s_lshl_b32 s46, s46, 2
  s_lshr_b32 s47, s42, 1
  s_lshl_b32 s47, s47, 4
  s_add_u32 s46, s46, s47
  v_add_u32 v8, s46, v8
  v_mul_u32_u24 v8, 1280, v8
  v_lshrrev_b32 v13, 1, v13
  v_bfe_u32 v14, v0, 1, 2
  v_xor_b32 v13, v13, v14
  v_lshlrev_b32 v13, 5, v13
  v_and_b32 v14, 1, v0
  v_lshlrev_b32 v14, 4, v14
  v_add3_u32 v8, v8, v13, v14
  v_lshrrev_b32 v13, 5, v0
  v_lshlrev_b32 v9, 11, v13
  v_bfe_u32 v13, v0, 2, 3
  v_lshl_add_u32 v9, v13, 7, v9
  v_lshrrev_b32 v13, 1, v13
  v_xor_b32 v13, s42, v13
  v_lshl_add_u32 v9, v13, 5, v9
  v_and_b32 v13, 3, v0
  v_lshl_add_u32 v9, v13, 3, v9
  v_add_u32 v10, 0x10000, v9
  v_add_u32 v11, 0x20000, v9
  s_add_u32 m0, s51, 0
  s_add_u32 s46, s66, 0
  buffer_load_dwordx4 v8, s[4:7], s46 offen  lds
  s_add_u32 m0, s51, 4096
  s_add_u32 s46, s66, 128
  buffer_load_dwordx4 v8, s[4:7], s46 offen  lds
  s_add_u32 m0, s51, 8192
  s_add_u32 s46, s66, 256
  buffer_load_dwordx4 v8, s[4:7], s46 offen  lds
  s_add_u32 m0, s51, 12288
  s_add_u32 s46, s66, 384
  buffer_load_dwordx4 v8, s[4:7], s46 offen  lds
  s_add_u32 m0, s51, 16384
  s_add_u32 s46, s66, 512
  buffer_load_dwordx4 v8, s[4:7], s46 offen  lds
  s_add_u32 m0, s51, 20480
  s_add_u32 s46, s66, 640
  buffer_load_dwordx4 v8, s[4:7], s46 offen  lds
  s_add_u32 m0, s51, 24576
  s_add_u32 s46, s66, 768
  buffer_load_dwordx4 v8, s[4:7], s46 offen  lds
  s_add_u32 m0, s51, 28672
  s_add_u32 s46, s66, 896
  buffer_load_dwordx4 v8, s[4:7], s46 offen  lds
  s_add_u32 m0, s51, 32768
  s_add_u32 s46, s66, 1024
  buffer_load_dwordx4 v8, s[4:7], s46 offen  lds
  s_add_u32 m0, s51, 36864
  s_add_u32 s46, s66, 1152
  buffer_load_dwordx4 v8, s[4:7], s46 offen  lds
  s_add_u32 m0, s51, 40960
  s_add_u32 s46, s66, 40960
  buffer_load_dwordx4 v8, s[4:7], s46 offen  lds
  s_add_u32 m0, s51, 45056
  s_add_u32 s46, s66, 41088
  buffer_load_dwordx4 v8, s[4:7], s46 offen  lds
  s_add_u32 m0, s51, 49152
  s_add_u32 s46, s66, 41216
  buffer_load_dwordx4 v8, s[4:7], s46 offen  lds
  s_add_u32 m0, s51, 53248
  s_add_u32 s46, s66, 41344
  buffer_load_dwordx4 v8, s[4:7], s46 offen  lds
  s_add_u32 m0, s51, 57344
  s_add_u32 s46, s66, 41472
  buffer_load_dwordx4 v8, s[4:7], s46 offen  lds
  s_add_u32 m0, s51, 61440
  s_add_u32 s46, s66, 41600
  buffer_load_dwordx4 v8, s[4:7], s46 offen  lds
  s_add_u32 m0, s51, 65536
  s_add_u32 s46, s66, 41728
  buffer_load_dwordx4 v8, s[4:7], s46 offen  lds
  s_add_u32 m0, s51, 69632
  s_add_u32 s46, s66, 41856
  buffer_load_dwordx4 v8, s[4:7], s46 offen  lds
  s_add_u32 m0, s51, 73728
  s_add_u32 s46, s66, 41984
  buffer_load_dwordx4 v8, s[4:7], s46 offen  lds
  s_add_u32 m0, s51, 77824
  s_add_u32 s46, s66, 42112
  buffer_load_dwordx4 v8, s[4:7], s46 offen  lds
  s_add_u32 m0, s51, 81920
  s_add_u32 s46, s66, 81920
  buffer_load_dwordx4 v8, s[4:7], s46 offen  lds
  s_add_u32 m0, s51, 86016
  s_add_u32 s46, s66, 82048
  buffer_load_dwordx4 v8, s[4:7], s46 offen  lds
  s_add_u32 m0, s51, 90112
  s_add_u32 s46, s66, 82176
  buffer_load_dwordx4 v8, s[4:7], s46 offen  lds
  s_add_u32 m0, s51, 94208
  s_add_u32 s46, s66, 82304
  buffer_load_dwordx4 v8, s[4:7], s46 offen  lds
  s_add_u32 m0, s51, 98304
  s_add_u32 s46, s66, 82432
  buffer_load_dwordx4 v8, s[4:7], s46 offen  lds
  s_waitcnt vmcnt(20)
  s_barrier
  s_add_u32 m0, s51, 102400
  s_add_u32 s46, s66, 82560
  buffer_load_dwordx4 v8, s[4:7], s46 offen  lds
  s_add_u32 m0, s51, 106496
  s_add_u32 s46, s66, 82688
  buffer_load_dwordx4 v8, s[4:7], s46 offen  lds
  s_add_u32 m0, s51, 110592
  s_add_u32 s46, s66, 82816
  buffer_load_dwordx4 v8, s[4:7], s46 offen  lds
  s_add_u32 m0, s51, 114688
  s_add_u32 s46, s66, 82944
  buffer_load_dwordx4 v8, s[4:7], s46 offen  lds
  s_add_u32 m0, s51, 118784
  s_add_u32 s46, s66, 83072
  buffer_load_dwordx4 v8, s[4:7], s46 offen  lds
  ds_read_b64_tr_b16 v[100:101], v9 offset:0
  ds_read_b64_tr_b16 v[102:103], v9 offset:1024
  ds_read_b64_tr_b16 v[104:105], v9 offset:4096
  ds_read_b64_tr_b16 v[106:107], v9 offset:5120
  ds_read_b64_tr_b16 v[108:109], v9 offset:8192
  ds_read_b64_tr_b16 v[110:111], v9 offset:9216
  ds_read_b64_tr_b16 v[112:113], v9 offset:12288
  ds_read_b64_tr_b16 v[114:115], v9 offset:13312
  ds_read_b64_tr_b16 v[116:117], v9 offset:16384
  ds_read_b64_tr_b16 v[118:119], v9 offset:17408
  s_waitcnt lgkmcnt(0)
  v_mfma_f32_16x16x32_bf16 v[140:143], v[100:103], v[20:23], 0
  v_mfma_f32_16x16x32_bf16 v[144:147], v[104:107], v[20:23], 0
  v_mfma_f32_16x16x32_bf16 v[148:151], v[108:111], v[20:23], 0
  v_mfma_f32_16x16x32_bf16 v[152:155], v[112:115], v[20:23], 0
  v_mfma_f32_16x16x32_bf16 v[156:159], v[116:119], v[20:23], 0
  s_waitcnt vmcnt(20)
  s_barrier
  s_add_u32 m0, s51, 0
  s_add_u32 s46, s66, 122880
  buffer_load_dwordx4 v8, s[4:7], s46 offen  lds
  s_add_u32 m0, s51, 4096
  s_add_u32 s46, s66, 123008
  buffer_load_dwordx4 v8, s[4:7], s46 offen  lds
  s_add_u32 m0, s51, 8192
  s_add_u32 s46, s66, 123136
  buffer_load_dwordx4 v8, s[4:7], s46 offen  lds
  s_add_u32 m0, s51, 12288
  s_add_u32 s46, s66, 123264
  buffer_load_dwordx4 v8, s[4:7], s46 offen  lds
  s_add_u32 m0, s51, 16384
  s_add_u32 s46, s66, 123392
  buffer_load_dwordx4 v8, s[4:7], s46 offen  lds
  ds_read_b64_tr_b16 v[120:121], v9 offset:20480
  ds_read_b64_tr_b16 v[122:123], v9 offset:21504
  ds_read_b64_tr_b16 v[124:125], v9 offset:24576
  ds_read_b64_tr_b16 v[126:127], v9 offset:25600
  ds_read_b64_tr_b16 v[128:129], v9 offset:28672
  ds_read_b64_tr_b16 v[130:131], v9 offset:29696
  ds_read_b64_tr_b16 v[132:133], v9 offset:32768
  ds_read_b64_tr_b16 v[134:135], v9 offset:33792
  ds_read_b64_tr_b16 v[136:137], v9 offset:36864
  ds_read_b64_tr_b16 v[138:139], v9 offset:37888
  s_waitcnt lgkmcnt(0)
  v_mfma_f32_16x16x32_bf16 v[160:163], v[120:123], v[20:23], 0
  v_mfma_f32_16x16x32_bf16 v[164:167], v[124:127], v[20:23], 0
  v_mfma_f32_16x16x32_bf16 v[168:171], v[128:131], v[20:23], 0
  v_mfma_f32_16x16x32_bf16 v[172:175], v[132:135], v[20:23], 0
  v_mfma_f32_16x16x32_bf16 v[176:179], v[136:139], v[20:23], 0
  s_waitcnt vmcnt(20)
  s_barrier
  s_add_u32 m0, s51, 20480
  s_add_u32 s46, s66, 123520
  buffer_load_dwordx4 v8, s[4:7], s46 offen  lds
  s_add_u32 m0, s51, 24576
  s_add_u32 s46, s66, 123648
  buffer_load_dwordx4 v8, s[4:7], s46 offen  lds
  s_add_u32 m0, s51, 28672
  s_add_u32 s46, s66, 123776
  buffer_load_dwordx4 v8, s[4:7], s46 offen  lds
  s_add_u32 m0, s51, 32768
  s_add_u32 s46, s66, 123904
  buffer_load_dwordx4 v8, s[4:7], s46 offen  lds
  s_add_u32 m0, s51, 36864
  s_add_u32 s46, s66, 124032
  buffer_load_dwordx4 v8, s[4:7], s46 offen  lds
  ds_read_b64_tr_b16 v[100:101], v9 offset:40960
  ds_read_b64_tr_b16 v[102:103], v9 offset:41984
  ds_read_b64_tr_b16 v[104:105], v9 offset:45056
  ds_read_b64_tr_b16 v[106:107], v9 offset:46080
  ds_read_b64_tr_b16 v[108:109], v9 offset:49152
  ds_read_b64_tr_b16 v[110:111], v9 offset:50176
  ds_read_b64_tr_b16 v[112:113], v9 offset:53248
  ds_read_b64_tr_b16 v[114:115], v9 offset:54272
  ds_read_b64_tr_b16 v[116:117], v9 offset:57344
  ds_read_b64_tr_b16 v[118:119], v9 offset:58368
  s_waitcnt lgkmcnt(0)
  v_mfma_f32_16x16x32_bf16 v[140:143], v[100:103], v[24:27], v[140:143]
  v_mfma_f32_16x16x32_bf16 v[144:147], v[104:107], v[24:27], v[144:147]
  v_mfma_f32_16x16x32_bf16 v[148:151], v[108:111], v[24:27], v[148:151]
  v_mfma_f32_16x16x32_bf16 v[152:155], v[112:115], v[24:27], v[152:155]
  v_mfma_f32_16x16x32_bf16 v[156:159], v[116:119], v[24:27], v[156:159]
  s_waitcnt vmcnt(20)
  s_barrier
  s_add_u32 m0, s51, 40960
  s_add_u32 s46, s66, 163840
  buffer_load_dwordx4 v8, s[4:7], s46 offen  lds
  s_add_u32 m0, s51, 45056
  s_add_u32 s46, s66, 163968
  buffer_load_dwordx4 v8, s[4:7], s46 offen  lds
  s_add_u32 m0, s51, 49152
  s_add_u32 s46, s66, 164096
  buffer_load_dwordx4 v8, s[4:7], s46 offen  lds
  s_add_u32 m0, s51, 53248
  s_add_u32 s46, s66, 164224
  buffer_load_dwordx4 v8, s[4:7], s46 offen  lds
  s_add_u32 m0, s51, 57344
  s_add_u32 s46, s66, 164352
  buffer_load_dwordx4 v8, s[4:7], s46 offen  lds
  ds_read_b64_tr_b16 v[120:121], v9 offset:61440
  ds_read_b64_tr_b16 v[122:123], v9 offset:62464
  ds_read_b64_tr_b16 v[124:125], v10 offset:0
  ds_read_b64_tr_b16 v[126:127], v10 offset:1024
  ds_read_b64_tr_b16 v[128:129], v10 offset:4096
  ds_read_b64_tr_b16 v[130:131], v10 offset:5120
  ds_read_b64_tr_b16 v[132:133], v10 offset:8192
  ds_read_b64_tr_b16 v[134:135], v10 offset:9216
  ds_read_b64_tr_b16 v[136:137], v10 offset:12288
  ds_read_b64_tr_b16 v[138:139], v10 offset:13312
  s_waitcnt lgkmcnt(0)
  v_mfma_f32_16x16x32_bf16 v[160:163], v[120:123], v[24:27], v[160:163]
  v_mfma_f32_16x16x32_bf16 v[164:167], v[124:127], v[24:27], v[164:167]
  v_mfma_f32_16x16x32_bf16 v[168:171], v[128:131], v[24:27], v[168:171]
  v_mfma_f32_16x16x32_bf16 v[172:175], v[132:135], v[24:27], v[172:175]
  v_mfma_f32_16x16x32_bf16 v[176:179], v[136:139], v[24:27], v[176:179]
  s_waitcnt vmcnt(20)
  s_barrier
  s_add_u32 m0, s51, 61440
  s_add_u32 s46, s66, 164480
  buffer_load_dwordx4 v8, s[4:7], s46 offen  lds
  s_add_u32 m0, s51, 65536
  s_add_u32 s46, s66, 164608
  buffer_load_dwordx4 v8, s[4:7], s46 offen  lds
  s_add_u32 m0, s51, 69632
  s_add_u32 s46, s66, 164736
  buffer_load_dwordx4 v8, s[4:7], s46 offen  lds
  s_add_u32 m0, s51, 73728
  s_add_u32 s46, s66, 164864
  buffer_load_dwordx4 v8, s[4:7], s46 offen  lds
  s_add_u32 m0, s51, 77824
  s_add_u32 s46, s66, 164992
  buffer_load_dwordx4 v8, s[4:7], s46 offen  lds
  ds_read_b64_tr_b16 v[100:101], v10 offset:16384
  ds_read_b64_tr_b16 v[102:103], v10 offset:17408
  ds_read_b64_tr_b16 v[104:105], v10 offset:20480
  ds_read_b64_tr_b16 v[106:107], v10 offset:21504
  ds_read_b64_tr_b16 v[108:109], v10 offset:24576
  ds_read_b64_tr_b16 v[110:111], v10 offset:25600
  ds_read_b64_tr_b16 v[112:113], v10 offset:28672
  ds_read_b64_tr_b16 v[114:115], v10 offset:29696
  ds_read_b64_tr_b16 v[116:117], v10 offset:32768
  ds_read_b64_tr_b16 v[118:119], v10 offset:33792
  s_waitcnt lgkmcnt(0)
  v_mfma_f32_16x16x32_bf16 v[140:143], v[100:103], v[28:31], v[140:143]
  v_mfma_f32_16x16x32_bf16 v[144:147], v[104:107], v[28:31], v[144:147]
  v_mfma_f32_16x16x32_bf16 v[148:151], v[108:111], v[28:31], v[148:151]
  v_mfma_f32_16x16x32_bf16 v[152:155], v[112:115], v[28:31], v[152:155]
  v_mfma_f32_16x16x32_bf16 v[156:159], v[116:119], v[28:31], v[156:159]
  s_waitcnt vmcnt(20)
  s_barrier
  s_add_u32 m0, s51, 81920
  s_add_u32 s46, s66, 204800
  buffer_load_dwordx4 v8, s[4:7], s46 offen  lds
  s_add_u32 m0, s51, 86016
  s_add_u32 s46, s66, 204928
  buffer_load_dwordx4 v8, s[4:7], s46 offen  lds
  s_add_u32 m0, s51, 90112
  s_add_u32 s46, s66, 205056
  buffer_load_dwordx4 v8, s[4:7], s46 offen  lds
  s_add_u32 m0, s51, 94208
  s_add_u32 s46, s66, 205184
  buffer_load_dwordx4 v8, s[4:7], s46 offen  lds
  s_add_u32 m0, s51, 98304
  s_add_u32 s46, s66, 205312
  buffer_load_dwordx4 v8, s[4:7], s46 offen  lds
  ds_read_b64_tr_b16 v[120:121], v10 offset:36864
  ds_read_b64_tr_b16 v[122:123], v10 offset:37888
  ds_read_b64_tr_b16 v[124:125], v10 offset:40960
  ds_read_b64_tr_b16 v[126:127], v10 offset:41984
  ds_read_b64_tr_b16 v[128:129], v10 offset:45056
  ds_read_b64_tr_b16 v[130:131], v10 offset:46080
  ds_read_b64_tr_b16 v[132:133], v10 offset:49152
  ds_read_b64_tr_b16 v[134:135], v10 offset:50176
  ds_read_b64_tr_b16 v[136:137], v10 offset:53248
  ds_read_b64_tr_b16 v[138:139], v10 offset:54272
  s_waitcnt lgkmcnt(0)
  v_mfma_f32_16x16x32_bf16 v[160:163], v[120:123], v[28:31], v[160:163]
  v_mfma_f32_16x16x32_bf16 v[164:167], v[124:127], v[28:31], v[164:167]
  v_mfma_f32_16x16x32_bf16 v[168:171], v[128:131], v[28:31], v[168:171]
  v_mfma_f32_16x16x32_bf16 v[172:175], v[132:135], v[28:31], v[172:175]
  v_mfma_f32_16x16x32_bf16 v[176:179], v[136:139], v[28:31], v[176:179]
  s_waitcnt vmcnt(20)
  s_barrier
  s_add_u32 m0, s51, 102400
  s_add_u32 s46, s66, 205440
  buffer_load_dwordx4 v8, s[4:7], s46 offen  lds
  s_add_u32 m0, s51, 106496
  s_add_u32 s46, s66, 205568
  buffer_load_dwordx4 v8, s[4:7], s46 offen  lds
  s_add_u32 m0, s51, 110592
  s_add_u32 s46, s66, 205696
  buffer_load_dwordx4 v8, s[4:7], s46 offen  lds
  s_add_u32 m0, s51, 114688
  s_add_u32 s46, s66, 205824
  buffer_load_dwordx4 v8, s[4:7], s46 offen  lds
  s_add_u32 m0, s51, 118784
  s_add_u32 s46, s66, 205952
  buffer_load_dwordx4 v8, s[4:7], s46 offen  lds
  ds_read_b64_tr_b16 v[100:101], v9 offset:0
  ds_read_b64_tr_b16 v[102:103], v9 offset:1024
  ds_read_b64_tr_b16 v[104:105], v9 offset:4096
  ds_read_b64_tr_b16 v[106:107], v9 offset:5120
  ds_read_b64_tr_b16 v[108:109], v9 offset:8192
  ds_read_b64_tr_b16 v[110:111], v9 offset:9216
  ds_read_b64_tr_b16 v[112:113], v9 offset:12288
  ds_read_b64_tr_b16 v[114:115], v9 offset:13312
  ds_read_b64_tr_b16 v[116:117], v9 offset:16384
  ds_read_b64_tr_b16 v[118:119], v9 offset:17408
  s_waitcnt lgkmcnt(0)
  v_mfma_f32_16x16x32_bf16 v[140:143], v[100:103], v[32:35], v[140:143]
  v_mfma_f32_16x16x32_bf16 v[144:147], v[104:107], v[32:35], v[144:147]
  v_mfma_f32_16x16x32_bf16 v[148:151], v[108:111], v[32:35], v[148:151]
  v_mfma_f32_16x16x32_bf16 v[152:155], v[112:115], v[32:35], v[152:155]
  v_mfma_f32_16x16x32_bf16 v[156:159], v[116:119], v[32:35], v[156:159]
  s_waitcnt vmcnt(20)
  s_barrier
  s_add_u32 m0, s51, 0
  s_add_u32 s46, s66, 245760
  buffer_load_dwordx4 v8, s[4:7], s46 offen  lds
  s_add_u32 m0, s51, 4096
  s_add_u32 s46, s66, 245888
  buffer_load_dwordx4 v8, s[4:7], s46 offen  lds
  s_add_u32 m0, s51, 8192
  s_add_u32 s46, s66, 246016
  buffer_load_dwordx4 v8, s[4:7], s46 offen  lds
  s_add_u32 m0, s51, 12288
  s_add_u32 s46, s66, 246144
  buffer_load_dwordx4 v8, s[4:7], s46 offen  lds
  s_add_u32 m0, s51, 16384
  s_add_u32 s46, s66, 246272
  buffer_load_dwordx4 v8, s[4:7], s46 offen  lds
  ds_read_b64_tr_b16 v[120:121], v9 offset:20480
  ds_read_b64_tr_b16 v[122:123], v9 offset:21504
  ds_read_b64_tr_b16 v[124:125], v9 offset:24576
  ds_read_b64_tr_b16 v[126:127], v9 offset:25600
  ds_read_b64_tr_b16 v[128:129], v9 offset:28672
  ds_read_b64_tr_b16 v[130:131], v9 offset:29696
  ds_read_b64_tr_b16 v[132:133], v9 offset:32768
  ds_read_b64_tr_b16 v[134:135], v9 offset:33792
  ds_read_b64_tr_b16 v[136:137], v9 offset:36864
  ds_read_b64_tr_b16 v[138:139], v9 offset:37888
  s_waitcnt lgkmcnt(0)
  v_mfma_f32_16x16x32_bf16 v[160:163], v[120:123], v[32:35], v[160:163]
  v_mfma_f32_16x16x32_bf16 v[164:167], v[124:127], v[32:35], v[164:167]
  v_mfma_f32_16x16x32_bf16 v[168:171], v[128:131], v[32:35], v[168:171]
  v_mfma_f32_16x16x32_bf16 v[172:175], v[132:135], v[32:35], v[172:175]
  v_mfma_f32_16x16x32_bf16 v[176:179], v[136:139], v[32:35], v[176:179]
  s_waitcnt vmcnt(20)
  s_barrier
  s_add_u32 m0, s51, 20480
  s_add_u32 s46, s66, 246400
  buffer_load_dwordx4 v8, s[4:7], s46 offen  lds
  s_add_u32 m0, s51, 24576
  s_add_u32 s46, s66, 246528
  buffer_load_dwordx4 v8, s[4:7], s46 offen  lds
  s_add_u32 m0, s51, 28672
  s_add_u32 s46, s66, 246656
  buffer_load_dwordx4 v8, s[4:7], s46 offen  lds
  s_add_u32 m0, s51, 32768
  s_add_u32 s46, s66, 246784
  buffer_load_dwordx4 v8, s[4:7], s46 offen  lds
  s_add_u32 m0, s51, 36864
  s_add_u32 s46, s66, 246912
  buffer_load_dwordx4 v8, s[4:7], s46 offen  lds
  ds_read_b64_tr_b16 v[100:101], v9 offset:40960
  ds_read_b64_tr_b16 v[102:103], v9 offset:41984
  ds_read_b64_tr_b16 v[104:105], v9 offset:45056
  ds_read_b64_tr_b16 v[106:107], v9 offset:46080
  ds_read_b64_tr_b16 v[108:109], v9 offset:49152
  ds_read_b64_tr_b16 v[110:111], v9 offset:50176
  ds_read_b64_tr_b16 v[112:113], v9 offset:53248
  ds_read_b64_tr_b16 v[114:115], v9 offset:54272
  ds_read_b64_tr_b16 v[116:117], v9 offset:57344
  ds_read_b64_tr_b16 v[118:119], v9 offset:58368
  s_waitcnt lgkmcnt(0)
  v_mfma_f32_16x16x32_bf16 v[140:143], v[100:103], v[36:39], v[140:143]
  v_mfma_f32_16x16x32_bf16 v[144:147], v[104:107], v[36:39], v[144:147]
  v_mfma_f32_16x16x32_bf16 v[148:151], v[108:111], v[36:39], v[148:151]
  v_mfma_f32_16x16x32_bf16 v[152:155], v[112:115], v[36:39], v[152:155]
  v_mfma_f32_16x16x32_bf16 v[156:159], v[116:119], v[36:39], v[156:159]
  s_waitcnt vmcnt(20)
  s_barrier
  s_add_u32 m0, s51, 40960
  s_add_u32 s46, s66, 286720
  buffer_load_dwordx4 v8, s[4:7], s46 offen  lds
  s_add_u32 m0, s51, 45056
  s_add_u32 s46, s66, 286848
  buffer_load_dwordx4 v8, s[4:7], s46 offen  lds
  s_add_u32 m0, s51, 49152
  s_add_u32 s46, s66, 286976
  buffer_load_dwordx4 v8, s[4:7], s46 offen  lds
  s_add_u32 m0, s51, 53248
  s_add_u32 s46, s66, 287104
  buffer_load_dwordx4 v8, s[4:7], s46 offen  lds
  s_add_u32 m0, s51, 57344
  s_add_u32 s46, s66, 287232
  buffer_load_dwordx4 v8, s[4:7], s46 offen  lds
  ds_read_b64_tr_b16 v[120:121], v9 offset:61440
  ds_read_b64_tr_b16 v[122:123], v9 offset:62464
  ds_read_b64_tr_b16 v[124:125], v10 offset:0
  ds_read_b64_tr_b16 v[126:127], v10 offset:1024
  ds_read_b64_tr_b16 v[128:129], v10 offset:4096
  ds_read_b64_tr_b16 v[130:131], v10 offset:5120
  ds_read_b64_tr_b16 v[132:133], v10 offset:8192
  ds_read_b64_tr_b16 v[134:135], v10 offset:9216
  ds_read_b64_tr_b16 v[136:137], v10 offset:12288
  ds_read_b64_tr_b16 v[138:139], v10 offset:13312
  s_waitcnt lgkmcnt(0)
  v_mfma_f32_16x16x32_bf16 v[160:163], v[120:123], v[36:39], v[160:163]
  v_mfma_f32_16x16x32_bf16 v[164:167], v[124:127], v[36:39], v[164:167]
  v_mfma_f32_16x16x32_bf16 v[168:171], v[128:131], v[36:39], v[168:171]
  v_mfma_f32_16x16x32_bf16 v[172:175], v[132:135], v[36:39], v[172:175]
  v_mfma_f32_16x16x32_bf16 v[176:179], v[136:139], v[36:39], v[176:179]
  s_waitcnt vmcnt(20)
  s_barrier
  s_add_u32 m0, s51, 61440
  s_add_u32 s46, s66, 287360
  buffer_load_dwordx4 v8, s[4:7], s46 offen  lds
  s_add_u32 m0, s51, 65536
  s_add_u32 s46, s66, 287488
  buffer_load_dwordx4 v8, s[4:7], s46 offen  lds
  s_add_u32 m0, s51, 69632
  s_add_u32 s46, s66, 287616
  buffer_load_dwordx4 v8, s[4:7], s46 offen  lds
  s_add_u32 m0, s51, 73728
  s_add_u32 s46, s66, 287744
  buffer_load_dwordx4 v8, s[4:7], s46 offen  lds
  s_add_u32 m0, s51, 77824
  s_add_u32 s46, s66, 287872
  buffer_load_dwordx4 v8, s[4:7], s46 offen  lds
  ds_read_b64_tr_b16 v[100:101], v10 offset:16384
  ds_read_b64_tr_b16 v[102:103], v10 offset:17408
  ds_read_b64_tr_b16 v[104:105], v10 offset:20480
  ds_read_b64_tr_b16 v[106:107], v10 offset:21504
  ds_read_b64_tr_b16 v[108:109], v10 offset:24576
  ds_read_b64_tr_b16 v[110:111], v10 offset:25600
  ds_read_b64_tr_b16 v[112:113], v10 offset:28672
  ds_read_b64_tr_b16 v[114:115], v10 offset:29696
  ds_read_b64_tr_b16 v[116:117], v10 offset:32768
  ds_read_b64_tr_b16 v[118:119], v10 offset:33792
  s_waitcnt lgkmcnt(0)
  v_mfma_f32_16x16x32_bf16 v[140:143], v[100:103], v[40:43], v[140:143]
  v_mfma_f32_16x16x32_bf16 v[144:147], v[104:107], v[40:43], v[144:147]
  v_mfma_f32_16x16x32_bf16 v[148:151], v[108:111], v[40:43], v[148:151]
  v_mfma_f32_16x16x32_bf16 v[152:155], v[112:115], v[40:43], v[152:155]
  v_mfma_f32_16x16x32_bf16 v[156:159], v[116:119], v[40:43], v[156:159]
  s_waitcnt vmcnt(20)
  s_barrier
  s_add_u32 m0, s51, 81920
  s_add_u32 s46, s66, 327680
  buffer_load_dwordx4 v8, s[4:7], s46 offen  lds
  s_add_u32 m0, s51, 86016
  s_add_u32 s46, s66, 327808
  buffer_load_dwordx4 v8, s[4:7], s46 offen  lds
  s_add_u32 m0, s51, 90112
  s_add_u32 s46, s66, 327936
  buffer_load_dwordx4 v8, s[4:7], s46 offen  lds
  s_add_u32 m0, s51, 94208
  s_add_u32 s46, s66, 328064
  buffer_load_dwordx4 v8, s[4:7], s46 offen  lds
  s_add_u32 m0, s51, 98304
  s_add_u32 s46, s66, 328192
  buffer_load_dwordx4 v8, s[4:7], s46 offen  lds
  ds_read_b64_tr_b16 v[120:121], v10 offset:36864
  ds_read_b64_tr_b16 v[122:123], v10 offset:37888
  ds_read_b64_tr_b16 v[124:125], v10 offset:40960
  ds_read_b64_tr_b16 v[126:127], v10 offset:41984
  ds_read_b64_tr_b16 v[128:129], v10 offset:45056
  ds_read_b64_tr_b16 v[130:131], v10 offset:46080
  ds_read_b64_tr_b16 v[132:133], v10 offset:49152
  ds_read_b64_tr_b16 v[134:135], v10 offset:50176
  ds_read_b64_tr_b16 v[136:137], v10 offset:53248
  ds_read_b64_tr_b16 v[138:139], v10 offset:54272
  s_waitcnt lgkmcnt(0)
  v_mfma_f32_16x16x32_bf16 v[160:163], v[120:123], v[40:43], v[160:163]
  v_mfma_f32_16x16x32_bf16 v[164:167], v[124:127], v[40:43], v[164:167]
  v_mfma_f32_16x16x32_bf16 v[168:171], v[128:131], v[40:43], v[168:171]
  v_mfma_f32_16x16x32_bf16 v[172:175], v[132:135], v[40:43], v[172:175]
  v_mfma_f32_16x16x32_bf16 v[176:179], v[136:139], v[40:43], v[176:179]
  s_waitcnt vmcnt(20)
  s_barrier
  s_add_u32 m0, s51, 102400
  s_add_u32 s46, s66, 328320
  buffer_load_dwordx4 v8, s[4:7], s46 offen  lds
  s_add_u32 m0, s51, 106496
  s_add_u32 s46, s66, 328448
  buffer_load_dwordx4 v8, s[4:7], s46 offen  lds
  s_add_u32 m0, s51, 110592
  s_add_u32 s46, s66, 328576
  buffer_load_dwordx4 v8, s[4:7], s46 offen  lds
  s_add_u32 m0, s51, 114688
  s_add_u32 s46, s66, 328704
  buffer_load_dwordx4 v8, s[4:7], s46 offen  lds
  s_add_u32 m0, s51, 118784
  s_add_u32 s46, s66, 328832
  buffer_load_dwordx4 v8, s[4:7], s46 offen  lds
  ds_read_b64_tr_b16 v[100:101], v9 offset:0
  ds_read_b64_tr_b16 v[102:103], v9 offset:1024
  ds_read_b64_tr_b16 v[104:105], v9 offset:4096
  ds_read_b64_tr_b16 v[106:107], v9 offset:5120
  ds_read_b64_tr_b16 v[108:109], v9 offset:8192
  ds_read_b64_tr_b16 v[110:111], v9 offset:9216
  ds_read_b64_tr_b16 v[112:113], v9 offset:12288
  ds_read_b64_tr_b16 v[114:115], v9 offset:13312
  ds_read_b64_tr_b16 v[116:117], v9 offset:16384
  ds_read_b64_tr_b16 v[118:119], v9 offset:17408
  s_waitcnt lgkmcnt(0)
  v_mfma_f32_16x16x32_bf16 v[140:143], v[100:103], v[44:47], v[140:143]
  v_mfma_f32_16x16x32_bf16 v[144:147], v[104:107], v[44:47], v[144:147]
  v_mfma_f32_16x16x32_bf16 v[148:151], v[108:111], v[44:47], v[148:151]
  v_mfma_f32_16x16x32_bf16 v[152:155], v[112:115], v[44:47], v[152:155]
  v_mfma_f32_16x16x32_bf16 v[156:159], v[116:119], v[44:47], v[156:159]
  s_waitcnt vmcnt(20)
  s_barrier
  s_add_u32 m0, s51, 0
  s_add_u32 s46, s66, 368640
  buffer_load_dwordx4 v8, s[4:7], s46 offen  lds
  s_add_u32 m0, s51, 4096
  s_add_u32 s46, s66, 368768
  buffer_load_dwordx4 v8, s[4:7], s46 offen  lds
  s_add_u32 m0, s51, 8192
  s_add_u32 s46, s66, 368896
  buffer_load_dwordx4 v8, s[4:7], s46 offen  lds
  s_add_u32 m0, s51, 12288
  s_add_u32 s46, s66, 369024
  buffer_load_dwordx4 v8, s[4:7], s46 offen  lds
  s_add_u32 m0, s51, 16384
  s_add_u32 s46, s66, 369152
  buffer_load_dwordx4 v8, s[4:7], s46 offen  lds
  ds_read_b64_tr_b16 v[120:121], v9 offset:20480
  ds_read_b64_tr_b16 v[122:123], v9 offset:21504
  ds_read_b64_tr_b16 v[124:125], v9 offset:24576
  ds_read_b64_tr_b16 v[126:127], v9 offset:25600
  ds_read_b64_tr_b16 v[128:129], v9 offset:28672
  ds_read_b64_tr_b16 v[130:131], v9 offset:29696
  ds_read_b64_tr_b16 v[132:133], v9 offset:32768
  ds_read_b64_tr_b16 v[134:135], v9 offset:33792
  ds_read_b64_tr_b16 v[136:137], v9 offset:36864
  ds_read_b64_tr_b16 v[138:139], v9 offset:37888
  s_waitcnt lgkmcnt(0)
  v_mfma_f32_16x16x32_bf16 v[160:163], v[120:123], v[44:47], v[160:163]
  v_mfma_f32_16x16x32_bf16 v[164:167], v[124:127], v[44:47], v[164:167]
  v_mfma_f32_16x16x32_bf16 v[168:171], v[128:131], v[44:47], v[168:171]
  v_mfma_f32_16x16x32_bf16 v[172:175], v[132:135], v[44:47], v[172:175]
  v_mfma_f32_16x16x32_bf16 v[176:179], v[136:139], v[44:47], v[176:179]
  s_waitcnt vmcnt(20)
  s_barrier
  s_add_u32 m0, s51, 20480
  s_add_u32 s46, s66, 369280
  buffer_load_dwordx4 v8, s[4:7], s46 offen  lds
  s_add_u32 m0, s51, 24576
  s_add_u32 s46, s66, 369408
  buffer_load_dwordx4 v8, s[4:7], s46 offen  lds
  s_add_u32 m0, s51, 28672
  s_add_u32 s46, s66, 369536
  buffer_load_dwordx4 v8, s[4:7], s46 offen  lds
  s_add_u32 m0, s51, 32768
  s_add_u32 s46, s66, 369664
  buffer_load_dwordx4 v8, s[4:7], s46 offen  lds
  s_add_u32 m0, s51, 36864
  s_add_u32 s46, s66, 369792
  buffer_load_dwordx4 v8, s[4:7], s46 offen  lds
  ds_read_b64_tr_b16 v[100:101], v9 offset:40960
  ds_read_b64_tr_b16 v[102:103], v9 offset:41984
  ds_read_b64_tr_b16 v[104:105], v9 offset:45056
  ds_read_b64_tr_b16 v[106:107], v9 offset:46080
  ds_read_b64_tr_b16 v[108:109], v9 offset:49152
  ds_read_b64_tr_b16 v[110:111], v9 offset:50176
  ds_read_b64_tr_b16 v[112:113], v9 offset:53248
  ds_read_b64_tr_b16 v[114:115], v9 offset:54272
  ds_read_b64_tr_b16 v[116:117], v9 offset:57344
  ds_read_b64_tr_b16 v[118:119], v9 offset:58368
  s_waitcnt lgkmcnt(0)
  v_mfma_f32_16x16x32_bf16 v[140:143], v[100:103], v[48:51], v[140:143]
  v_mfma_f32_16x16x32_bf16 v[144:147], v[104:107], v[48:51], v[144:147]
  v_mfma_f32_16x16x32_bf16 v[148:151], v[108:111], v[48:51], v[148:151]
  v_mfma_f32_16x16x32_bf16 v[152:155], v[112:115], v[48:51], v[152:155]
  v_mfma_f32_16x16x32_bf16 v[156:159], v[116:119], v[48:51], v[156:159]
  s_waitcnt vmcnt(20)
  s_barrier
  s_add_u32 m0, s51, 40960
  s_add_u32 s46, s66, 409600
  buffer_load_dwordx4 v8, s[4:7], s46 offen  lds
  s_add_u32 m0, s51, 45056
  s_add_u32 s46, s66, 409728
  buffer_load_dwordx4 v8, s[4:7], s46 offen  lds
  s_add_u32 m0, s51, 49152
  s_add_u32 s46, s66, 409856
  buffer_load_dwordx4 v8, s[4:7], s46 offen  lds
  s_add_u32 m0, s51, 53248
  s_add_u32 s46, s66, 409984
  buffer_load_dwordx4 v8, s[4:7], s46 offen  lds
  s_add_u32 m0, s51, 57344
  s_add_u32 s46, s66, 410112
  buffer_load_dwordx4 v8, s[4:7], s46 offen  lds
  ds_read_b64_tr_b16 v[120:121], v9 offset:61440
  ds_read_b64_tr_b16 v[122:123], v9 offset:62464
  ds_read_b64_tr_b16 v[124:125], v10 offset:0
  ds_read_b64_tr_b16 v[126:127], v10 offset:1024
  ds_read_b64_tr_b16 v[128:129], v10 offset:4096
  ds_read_b64_tr_b16 v[130:131], v10 offset:5120
  ds_read_b64_tr_b16 v[132:133], v10 offset:8192
  ds_read_b64_tr_b16 v[134:135], v10 offset:9216
  ds_read_b64_tr_b16 v[136:137], v10 offset:12288
  ds_read_b64_tr_b16 v[138:139], v10 offset:13312
  s_waitcnt lgkmcnt(0)
  v_mfma_f32_16x16x32_bf16 v[160:163], v[120:123], v[48:51], v[160:163]
  v_mfma_f32_16x16x32_bf16 v[164:167], v[124:127], v[48:51], v[164:167]
  v_mfma_f32_16x16x32_bf16 v[168:171], v[128:131], v[48:51], v[168:171]
  v_mfma_f32_16x16x32_bf16 v[172:175], v[132:135], v[48:51], v[172:175]
  v_mfma_f32_16x16x32_bf16 v[176:179], v[136:139], v[48:51], v[176:179]
  s_waitcnt vmcnt(20)
  s_barrier
  s_add_u32 m0, s51, 61440
  s_add_u32 s46, s66, 410240
  buffer_load_dwordx4 v8, s[4:7], s46 offen  lds
  s_add_u32 m0, s51, 65536
  s_add_u32 s46, s66, 410368
  buffer_load_dwordx4 v8, s[4:7], s46 offen  lds
  s_add_u32 m0, s51, 69632
  s_add_u32 s46, s66, 410496
  buffer_load_dwordx4 v8, s[4:7], s46 offen  lds
  s_add_u32 m0, s51, 73728
  s_add_u32 s46, s66, 410624
  buffer_load_dwordx4 v8, s[4:7], s46 offen  lds
  s_add_u32 m0, s51, 77824
  s_add_u32 s46, s66, 410752
  buffer_load_dwordx4 v8, s[4:7], s46 offen  lds
  ds_read_b64_tr_b16 v[100:101], v10 offset:16384
  ds_read_b64_tr_b16 v[102:103], v10 offset:17408
  ds_read_b64_tr_b16 v[104:105], v10 offset:20480
  ds_read_b64_tr_b16 v[106:107], v10 offset:21504
  ds_read_b64_tr_b16 v[108:109], v10 offset:24576
  ds_read_b64_tr_b16 v[110:111], v10 offset:25600
  ds_read_b64_tr_b16 v[112:113], v10 offset:28672
  ds_read_b64_tr_b16 v[114:115], v10 offset:29696
  ds_read_b64_tr_b16 v[116:117], v10 offset:32768
  ds_read_b64_tr_b16 v[118:119], v10 offset:33792
  s_waitcnt lgkmcnt(0)
  v_mfma_f32_16x16x32_bf16 v[140:143], v[100:103], v[52:55], v[140:143]
  v_mfma_f32_16x16x32_bf16 v[144:147], v[104:107], v[52:55], v[144:147]
  v_mfma_f32_16x16x32_bf16 v[148:151], v[108:111], v[52:55], v[148:151]
  v_mfma_f32_16x16x32_bf16 v[152:155], v[112:115], v[52:55], v[152:155]
  v_mfma_f32_16x16x32_bf16 v[156:159], v[116:119], v[52:55], v[156:159]
  s_waitcnt vmcnt(20)
  s_barrier
  s_add_u32 m0, s51, 81920
  s_add_u32 s46, s66, 450560
  buffer_load_dwordx4 v8, s[4:7], s46 offen  lds
  s_add_u32 m0, s51, 86016
  s_add_u32 s46, s66, 450688
  buffer_load_dwordx4 v8, s[4:7], s46 offen  lds
  s_add_u32 m0, s51, 90112
  s_add_u32 s46, s66, 450816
  buffer_load_dwordx4 v8, s[4:7], s46 offen  lds
  s_add_u32 m0, s51, 94208
  s_add_u32 s46, s66, 450944
  buffer_load_dwordx4 v8, s[4:7], s46 offen  lds
  s_add_u32 m0, s51, 98304
  s_add_u32 s46, s66, 451072
  buffer_load_dwordx4 v8, s[4:7], s46 offen  lds
  ds_read_b64_tr_b16 v[120:121], v10 offset:36864
  ds_read_b64_tr_b16 v[122:123], v10 offset:37888
  ds_read_b64_tr_b16 v[124:125], v10 offset:40960
  ds_read_b64_tr_b16 v[126:127], v10 offset:41984
  ds_read_b64_tr_b16 v[128:129], v10 offset:45056
  ds_read_b64_tr_b16 v[130:131], v10 offset:46080
  ds_read_b64_tr_b16 v[132:133], v10 offset:49152
  ds_read_b64_tr_b16 v[134:135], v10 offset:50176
  ds_read_b64_tr_b16 v[136:137], v10 offset:53248
  ds_read_b64_tr_b16 v[138:139], v10 offset:54272
  s_waitcnt lgkmcnt(0)
  v_mfma_f32_16x16x32_bf16 v[160:163], v[120:123], v[52:55], v[160:163]
  v_mfma_f32_16x16x32_bf16 v[164:167], v[124:127], v[52:55], v[164:167]
  v_mfma_f32_16x16x32_bf16 v[168:171], v[128:131], v[52:55], v[168:171]
  v_mfma_f32_16x16x32_bf16 v[172:175], v[132:135], v[52:55], v[172:175]
  v_mfma_f32_16x16x32_bf16 v[176:179], v[136:139], v[52:55], v[176:179]
  s_waitcnt vmcnt(20)
  s_barrier
  s_add_u32 m0, s51, 102400
  s_add_u32 s46, s66, 451200
  buffer_load_dwordx4 v8, s[4:7], s46 offen  lds
  s_add_u32 m0, s51, 106496
  s_add_u32 s46, s66, 451328
  buffer_load_dwordx4 v8, s[4:7], s46 offen  lds
  s_add_u32 m0, s51, 110592
  s_add_u32 s46, s66, 451456
  buffer_load_dwordx4 v8, s[4:7], s46 offen  lds
  s_add_u32 m0, s51, 114688
  s_add_u32 s46, s66, 451584
  buffer_load_dwordx4 v8, s[4:7], s46 offen  lds
  s_add_u32 m0, s51, 118784
  s_add_u32 s46, s66, 451712
  buffer_load_dwordx4 v8, s[4:7], s46 offen  lds
  ds_read_b64_tr_b16 v[100:101], v9 offset:0
  ds_read_b64_tr_b16 v[102:103], v9 offset:1024
  ds_read_b64_tr_b16 v[104:105], v9 offset:4096
  ds_read_b64_tr_b16 v[106:107], v9 offset:5120
  ds_read_b64_tr_b16 v[108:109], v9 offset:8192
  ds_read_b64_tr_b16 v[110:111], v9 offset:9216
  ds_read_b64_tr_b16 v[112:113], v9 offset:12288
  ds_read_b64_tr_b16 v[114:115], v9 offset:13312
  ds_read_b64_tr_b16 v[116:117], v9 offset:16384
  ds_read_b64_tr_b16 v[118:119], v9 offset:17408
  s_waitcnt lgkmcnt(0)
  v_mfma_f32_16x16x32_bf16 v[140:143], v[100:103], v[56:59], v[140:143]
  v_mfma_f32_16x16x32_bf16 v[144:147], v[104:107], v[56:59], v[144:147]
  v_mfma_f32_16x16x32_bf16 v[148:151], v[108:111], v[56:59], v[148:151]
  v_mfma_f32_16x16x32_bf16 v[152:155], v[112:115], v[56:59], v[152:155]
  v_mfma_f32_16x16x32_bf16 v[156:159], v[116:119], v[56:59], v[156:159]
  s_waitcnt vmcnt(20)
  s_barrier
  s_add_u32 m0, s51, 0
  s_add_u32 s46, s66, 491520
  buffer_load_dwordx4 v8, s[4:7], s46 offen  lds
  s_add_u32 m0, s51, 4096
  s_add_u32 s46, s66, 491648
  buffer_load_dwordx4 v8, s[4:7], s46 offen  lds
  s_add_u32 m0, s51, 8192
  s_add_u32 s46, s66, 491776
  buffer_load_dwordx4 v8, s[4:7], s46 offen  lds
  s_add_u32 m0, s51, 12288
  s_add_u32 s46, s66, 491904
  buffer_load_dwordx4 v8, s[4:7], s46 offen  lds
  s_add_u32 m0, s51, 16384
  s_add_u32 s46, s66, 492032
  buffer_load_dwordx4 v8, s[4:7], s46 offen  lds
  ds_read_b64_tr_b16 v[120:121], v9 offset:20480
  ds_read_b64_tr_b16 v[122:123], v9 offset:21504
  ds_read_b64_tr_b16 v[124:125], v9 offset:24576
  ds_read_b64_tr_b16 v[126:127], v9 offset:25600
  ds_read_b64_tr_b16 v[128:129], v9 offset:28672
  ds_read_b64_tr_b16 v[130:131], v9 offset:29696
  ds_read_b64_tr_b16 v[132:133], v9 offset:32768
  ds_read_b64_tr_b16 v[134:135], v9 offset:33792
  ds_read_b64_tr_b16 v[136:137], v9 offset:36864
  ds_read_b64_tr_b16 v[138:139], v9 offset:37888
  s_waitcnt lgkmcnt(0)
  v_mfma_f32_16x16x32_bf16 v[160:163], v[120:123], v[56:59], v[160:163]
  v_mfma_f32_16x16x32_bf16 v[164:167], v[124:127], v[56:59], v[164:167]
  v_mfma_f32_16x16x32_bf16 v[168:171], v[128:131], v[56:59], v[168:171]
  v_mfma_f32_16x16x32_bf16 v[172:175], v[132:135], v[56:59], v[172:175]
  v_mfma_f32_16x16x32_bf16 v[176:179], v[136:139], v[56:59], v[176:179]
  s_waitcnt vmcnt(20)
  s_barrier
  s_add_u32 m0, s51, 20480
  s_add_u32 s46, s66, 492160
  buffer_load_dwordx4 v8, s[4:7], s46 offen  lds
  s_add_u32 m0, s51, 24576
  s_add_u32 s46, s66, 492288
  buffer_load_dwordx4 v8, s[4:7], s46 offen  lds
  s_add_u32 m0, s51, 28672
  s_add_u32 s46, s66, 492416
  buffer_load_dwordx4 v8, s[4:7], s46 offen  lds
  s_add_u32 m0, s51, 32768
  s_add_u32 s46, s66, 492544
  buffer_load_dwordx4 v8, s[4:7], s46 offen  lds
  s_add_u32 m0, s51, 36864
  s_add_u32 s46, s66, 492672
  buffer_load_dwordx4 v8, s[4:7], s46 offen  lds
  ds_read_b64_tr_b16 v[100:101], v9 offset:40960
  ds_read_b64_tr_b16 v[102:103], v9 offset:41984
  ds_read_b64_tr_b16 v[104:105], v9 offset:45056
  ds_read_b64_tr_b16 v[106:107], v9 offset:46080
  ds_read_b64_tr_b16 v[108:109], v9 offset:49152
  ds_read_b64_tr_b16 v[110:111], v9 offset:50176
  ds_read_b64_tr_b16 v[112:113], v9 offset:53248
  ds_read_b64_tr_b16 v[114:115], v9 offset:54272
  ds_read_b64_tr_b16 v[116:117], v9 offset:57344
  ds_read_b64_tr_b16 v[118:119], v9 offset:58368
  s_waitcnt lgkmcnt(0)
  v_mfma_f32_16x16x32_bf16 v[140:143], v[100:103], v[60:63], v[140:143]
  v_mfma_f32_16x16x32_bf16 v[144:147], v[104:107], v[60:63], v[144:147]
  v_mfma_f32_16x16x32_bf16 v[148:151], v[108:111], v[60:63], v[148:151]
  v_mfma_f32_16x16x32_bf16 v[152:155], v[112:115], v[60:63], v[152:155]
  v_mfma_f32_16x16x32_bf16 v[156:159], v[116:119], v[60:63], v[156:159]
  s_waitcnt vmcnt(20)
  s_barrier
  s_add_u32 m0, s51, 40960
  s_add_u32 s46, s66, 532480
  buffer_load_dwordx4 v8, s[4:7], s46 offen  lds
  s_add_u32 m0, s51, 45056
  s_add_u32 s46, s66, 532608
  buffer_load_dwordx4 v8, s[4:7], s46 offen  lds
  s_add_u32 m0, s51, 49152
  s_add_u32 s46, s66, 532736
  buffer_load_dwordx4 v8, s[4:7], s46 offen  lds
  s_add_u32 m0, s51, 53248
  s_add_u32 s46, s66, 532864
  buffer_load_dwordx4 v8, s[4:7], s46 offen  lds
  s_add_u32 m0, s51, 57344
  s_add_u32 s46, s66, 532992
  buffer_load_dwordx4 v8, s[4:7], s46 offen  lds
  ds_read_b64_tr_b16 v[120:121], v9 offset:61440
  ds_read_b64_tr_b16 v[122:123], v9 offset:62464
  ds_read_b64_tr_b16 v[124:125], v10 offset:0
  ds_read_b64_tr_b16 v[126:127], v10 offset:1024
  ds_read_b64_tr_b16 v[128:129], v10 offset:4096
  ds_read_b64_tr_b16 v[130:131], v10 offset:5120
  ds_read_b64_tr_b16 v[132:133], v10 offset:8192
  ds_read_b64_tr_b16 v[134:135], v10 offset:9216
  ds_read_b64_tr_b16 v[136:137], v10 offset:12288
  ds_read_b64_tr_b16 v[138:139], v10 offset:13312
  s_waitcnt lgkmcnt(0)
  v_mfma_f32_16x16x32_bf16 v[160:163], v[120:123], v[60:63], v[160:163]
  v_mfma_f32_16x16x32_bf16 v[164:167], v[124:127], v[60:63], v[164:167]
  v_mfma_f32_16x16x32_bf16 v[168:171], v[128:131], v[60:63], v[168:171]
  v_mfma_f32_16x16x32_bf16 v[172:175], v[132:135], v[60:63], v[172:175]
  v_mfma_f32_16x16x32_bf16 v[176:179], v[136:139], v[60:63], v[176:179]
  s_waitcnt vmcnt(20)
  s_barrier
  s_add_u32 m0, s51, 61440
  s_add_u32 s46, s66, 533120
  buffer_load_dwordx4 v8, s[4:7], s46 offen  lds
  s_add_u32 m0, s51, 65536
  s_add_u32 s46, s66, 533248
  buffer_load_dwordx4 v8, s[4:7], s46 offen  lds
  s_add_u32 m0, s51, 69632
  s_add_u32 s46, s66, 533376
  buffer_load_dwordx4 v8, s[4:7], s46 offen  lds
  s_add_u32 m0, s51, 73728
  s_add_u32 s46, s66, 533504
  buffer_load_dwordx4 v8, s[4:7], s46 offen  lds
  s_add_u32 m0, s51, 77824
  s_add_u32 s46, s66, 533632
  buffer_load_dwordx4 v8, s[4:7], s46 offen  lds
  ds_read_b64_tr_b16 v[100:101], v10 offset:16384
  ds_read_b64_tr_b16 v[102:103], v10 offset:17408
  ds_read_b64_tr_b16 v[104:105], v10 offset:20480
  ds_read_b64_tr_b16 v[106:107], v10 offset:21504
  ds_read_b64_tr_b16 v[108:109], v10 offset:24576
  ds_read_b64_tr_b16 v[110:111], v10 offset:25600
  ds_read_b64_tr_b16 v[112:113], v10 offset:28672
  ds_read_b64_tr_b16 v[114:115], v10 offset:29696
  ds_read_b64_tr_b16 v[116:117], v10 offset:32768
  ds_read_b64_tr_b16 v[118:119], v10 offset:33792
  s_waitcnt lgkmcnt(0)
  v_mfma_f32_16x16x32_bf16 v[140:143], v[100:103], v[64:67], v[140:143]
  v_mfma_f32_16x16x32_bf16 v[144:147], v[104:107], v[64:67], v[144:147]
  v_mfma_f32_16x16x32_bf16 v[148:151], v[108:111], v[64:67], v[148:151]
  v_mfma_f32_16x16x32_bf16 v[152:155], v[112:115], v[64:67], v[152:155]
  v_mfma_f32_16x16x32_bf16 v[156:159], v[116:119], v[64:67], v[156:159]
  s_waitcnt vmcnt(20)
  s_barrier
  s_add_u32 m0, s51, 81920
  s_add_u32 s46, s66, 573440
  buffer_load_dwordx4 v8, s[4:7], s46 offen  lds
  s_add_u32 m0, s51, 86016
  s_add_u32 s46, s66, 573568
  buffer_load_dwordx4 v8, s[4:7], s46 offen  lds
  s_add_u32 m0, s51, 90112
  s_add_u32 s46, s66, 573696
  buffer_load_dwordx4 v8, s[4:7], s46 offen  lds
  s_add_u32 m0, s51, 94208
  s_add_u32 s46, s66, 573824
  buffer_load_dwordx4 v8, s[4:7], s46 offen  lds
  s_add_u32 m0, s51, 98304
  s_add_u32 s46, s66, 573952
  buffer_load_dwordx4 v8, s[4:7], s46 offen  lds
  ds_read_b64_tr_b16 v[120:121], v10 offset:36864
  ds_read_b64_tr_b16 v[122:123], v10 offset:37888
  ds_read_b64_tr_b16 v[124:125], v10 offset:40960
  ds_read_b64_tr_b16 v[126:127], v10 offset:41984
  ds_read_b64_tr_b16 v[128:129], v10 offset:45056
  ds_read_b64_tr_b16 v[130:131], v10 offset:46080
  ds_read_b64_tr_b16 v[132:133], v10 offset:49152
  ds_read_b64_tr_b16 v[134:135], v10 offset:50176
  ds_read_b64_tr_b16 v[136:137], v10 offset:53248
  ds_read_b64_tr_b16 v[138:139], v10 offset:54272
  s_waitcnt lgkmcnt(0)
  v_mfma_f32_16x16x32_bf16 v[160:163], v[120:123], v[64:67], v[160:163]
  v_mfma_f32_16x16x32_bf16 v[164:167], v[124:127], v[64:67], v[164:167]
  v_mfma_f32_16x16x32_bf16 v[168:171], v[128:131], v[64:67], v[168:171]
  v_mfma_f32_16x16x32_bf16 v[172:175], v[132:135], v[64:67], v[172:175]
  v_mfma_f32_16x16x32_bf16 v[176:179], v[136:139], v[64:67], v[176:179]
  s_waitcnt vmcnt(20)
  s_barrier
  s_add_u32 m0, s51, 102400
  s_add_u32 s46, s66, 574080
  buffer_load_dwordx4 v8, s[4:7], s46 offen  lds
  s_add_u32 m0, s51, 106496
  s_add_u32 s46, s66, 574208
  buffer_load_dwordx4 v8, s[4:7], s46 offen  lds
  s_add_u32 m0, s51, 110592
  s_add_u32 s46, s66, 574336
  buffer_load_dwordx4 v8, s[4:7], s46 offen  lds
  s_add_u32 m0, s51, 114688
  s_add_u32 s46, s66, 574464
  buffer_load_dwordx4 v8, s[4:7], s46 offen  lds
  s_add_u32 m0, s51, 118784
  s_add_u32 s46, s66, 574592
  buffer_load_dwordx4 v8, s[4:7], s46 offen  lds
  ds_read_b64_tr_b16 v[100:101], v9 offset:0
  ds_read_b64_tr_b16 v[102:103], v9 offset:1024
  ds_read_b64_tr_b16 v[104:105], v9 offset:4096
  ds_read_b64_tr_b16 v[106:107], v9 offset:5120
  ds_read_b64_tr_b16 v[108:109], v9 offset:8192
  ds_read_b64_tr_b16 v[110:111], v9 offset:9216
  ds_read_b64_tr_b16 v[112:113], v9 offset:12288
  ds_read_b64_tr_b16 v[114:115], v9 offset:13312
  ds_read_b64_tr_b16 v[116:117], v9 offset:16384
  ds_read_b64_tr_b16 v[118:119], v9 offset:17408
  s_waitcnt lgkmcnt(0)
  v_mfma_f32_16x16x32_bf16 v[140:143], v[100:103], v[68:71], v[140:143]
  v_mfma_f32_16x16x32_bf16 v[144:147], v[104:107], v[68:71], v[144:147]
  v_mfma_f32_16x16x32_bf16 v[148:151], v[108:111], v[68:71], v[148:151]
  v_mfma_f32_16x16x32_bf16 v[152:155], v[112:115], v[68:71], v[152:155]
  v_mfma_f32_16x16x32_bf16 v[156:159], v[116:119], v[68:71], v[156:159]
  s_waitcnt vmcnt(20)
  s_barrier
  s_add_u32 m0, s51, 0
  s_add_u32 s46, s66, 614400
  buffer_load_dwordx4 v8, s[4:7], s46 offen  lds
  s_add_u32 m0, s51, 4096
  s_add_u32 s46, s66, 614528
  buffer_load_dwordx4 v8, s[4:7], s46 offen  lds
  s_add_u32 m0, s51, 8192
  s_add_u32 s46, s66, 614656
  buffer_load_dwordx4 v8, s[4:7], s46 offen  lds
  s_add_u32 m0, s51, 12288
  s_add_u32 s46, s66, 614784
  buffer_load_dwordx4 v8, s[4:7], s46 offen  lds
  s_add_u32 m0, s51, 16384
  s_add_u32 s46, s66, 614912
  buffer_load_dwordx4 v8, s[4:7], s46 offen  lds
  ds_read_b64_tr_b16 v[120:121], v9 offset:20480
  ds_read_b64_tr_b16 v[122:123], v9 offset:21504
  ds_read_b64_tr_b16 v[124:125], v9 offset:24576
  ds_read_b64_tr_b16 v[126:127], v9 offset:25600
  ds_read_b64_tr_b16 v[128:129], v9 offset:28672
  ds_read_b64_tr_b16 v[130:131], v9 offset:29696
  ds_read_b64_tr_b16 v[132:133], v9 offset:32768
  ds_read_b64_tr_b16 v[134:135], v9 offset:33792
  ds_read_b64_tr_b16 v[136:137], v9 offset:36864
  ds_read_b64_tr_b16 v[138:139], v9 offset:37888
  s_waitcnt lgkmcnt(0)
  v_mfma_f32_16x16x32_bf16 v[160:163], v[120:123], v[68:71], v[160:163]
  v_mfma_f32_16x16x32_bf16 v[164:167], v[124:127], v[68:71], v[164:167]
  v_mfma_f32_16x16x32_bf16 v[168:171], v[128:131], v[68:71], v[168:171]
  v_mfma_f32_16x16x32_bf16 v[172:175], v[132:135], v[68:71], v[172:175]
  v_mfma_f32_16x16x32_bf16 v[176:179], v[136:139], v[68:71], v[176:179]
  s_waitcnt vmcnt(20)
  s_barrier
  s_add_u32 m0, s51, 20480
  s_add_u32 s46, s66, 615040
  buffer_load_dwordx4 v8, s[4:7], s46 offen  lds
  s_add_u32 m0, s51, 24576
  s_add_u32 s46, s66, 615168
  buffer_load_dwordx4 v8, s[4:7], s46 offen  lds
  s_add_u32 m0, s51, 28672
  s_add_u32 s46, s66, 615296
  buffer_load_dwordx4 v8, s[4:7], s46 offen  lds
  s_add_u32 m0, s51, 32768
  s_add_u32 s46, s66, 615424
  buffer_load_dwordx4 v8, s[4:7], s46 offen  lds
  s_add_u32 m0, s51, 36864
  s_add_u32 s46, s66, 615552
  buffer_load_dwordx4 v8, s[4:7], s46 offen  lds
  ds_read_b64_tr_b16 v[100:101], v9 offset:40960
  ds_read_b64_tr_b16 v[102:103], v9 offset:41984
  ds_read_b64_tr_b16 v[104:105], v9 offset:45056
  ds_read_b64_tr_b16 v[106:107], v9 offset:46080
  ds_read_b64_tr_b16 v[108:109], v9 offset:49152
  ds_read_b64_tr_b16 v[110:111], v9 offset:50176
  ds_read_b64_tr_b16 v[112:113], v9 offset:53248
  ds_read_b64_tr_b16 v[114:115], v9 offset:54272
  ds_read_b64_tr_b16 v[116:117], v9 offset:57344
  ds_read_b64_tr_b16 v[118:119], v9 offset:58368
  s_waitcnt lgkmcnt(0)
  v_mfma_f32_16x16x32_bf16 v[140:143], v[100:103], v[72:75], v[140:143]
  v_mfma_f32_16x16x32_bf16 v[144:147], v[104:107], v[72:75], v[144:147]
  v_mfma_f32_16x16x32_bf16 v[148:151], v[108:111], v[72:75], v[148:151]
  v_mfma_f32_16x16x32_bf16 v[152:155], v[112:115], v[72:75], v[152:155]
  v_mfma_f32_16x16x32_bf16 v[156:159], v[116:119], v[72:75], v[156:159]
  s_waitcnt vmcnt(20)
  s_barrier
  s_add_u32 m0, s51, 40960
  s_add_u32 s46, s66, 655360
  buffer_load_dwordx4 v8, s[4:7], s46 offen  lds
  s_add_u32 m0, s51, 45056
  s_add_u32 s46, s66, 655488
  buffer_load_dwordx4 v8, s[4:7], s46 offen  lds
  s_add_u32 m0, s51, 49152
  s_add_u32 s46, s66, 655616
  buffer_load_dwordx4 v8, s[4:7], s46 offen  lds
  s_add_u32 m0, s51, 53248
  s_add_u32 s46, s66, 655744
  buffer_load_dwordx4 v8, s[4:7], s46 offen  lds
  s_add_u32 m0, s51, 57344
  s_add_u32 s46, s66, 655872
  buffer_load_dwordx4 v8, s[4:7], s46 offen  lds
  ds_read_b64_tr_b16 v[120:121], v9 offset:61440
  ds_read_b64_tr_b16 v[122:123], v9 offset:62464
  ds_read_b64_tr_b16 v[124:125], v10 offset:0
  ds_read_b64_tr_b16 v[126:127], v10 offset:1024
  ds_read_b64_tr_b16 v[128:129], v10 offset:4096
  ds_read_b64_tr_b16 v[130:131], v10 offset:5120
  ds_read_b64_tr_b16 v[132:133], v10 offset:8192
  ds_read_b64_tr_b16 v[134:135], v10 offset:9216
  ds_read_b64_tr_b16 v[136:137], v10 offset:12288
  ds_read_b64_tr_b16 v[138:139], v10 offset:13312
  s_waitcnt lgkmcnt(0)
  v_mfma_f32_16x16x32_bf16 v[160:163], v[120:123], v[72:75], v[160:163]
  v_mfma_f32_16x16x32_bf16 v[164:167], v[124:127], v[72:75], v[164:167]
  v_mfma_f32_16x16x32_bf16 v[168:171], v[128:131], v[72:75], v[168:171]
  v_mfma_f32_16x16x32_bf16 v[172:175], v[132:135], v[72:75], v[172:175]
  v_mfma_f32_16x16x32_bf16 v[176:179], v[136:139], v[72:75], v[176:179]
  s_waitcnt vmcnt(20)
  s_barrier
  s_add_u32 m0, s51, 61440
  s_add_u32 s46, s66, 656000
  buffer_load_dwordx4 v8, s[4:7], s46 offen  lds
  s_add_u32 m0, s51, 65536
  s_add_u32 s46, s66, 656128
  buffer_load_dwordx4 v8, s[4:7], s46 offen  lds
  s_add_u32 m0, s51, 69632
  s_add_u32 s46, s66, 656256
  buffer_load_dwordx4 v8, s[4:7], s46 offen  lds
  s_add_u32 m0, s51, 73728
  s_add_u32 s46, s66, 656384
  buffer_load_dwordx4 v8, s[4:7], s46 offen  lds
  s_add_u32 m0, s51, 77824
  s_add_u32 s46, s66, 656512
  buffer_load_dwordx4 v8, s[4:7], s46 offen  lds
  ds_read_b64_tr_b16 v[100:101], v10 offset:16384
  ds_read_b64_tr_b16 v[102:103], v10 offset:17408
  ds_read_b64_tr_b16 v[104:105], v10 offset:20480
  ds_read_b64_tr_b16 v[106:107], v10 offset:21504
  ds_read_b64_tr_b16 v[108:109], v10 offset:24576
  ds_read_b64_tr_b16 v[110:111], v10 offset:25600
  ds_read_b64_tr_b16 v[112:113], v10 offset:28672
  ds_read_b64_tr_b16 v[114:115], v10 offset:29696
  ds_read_b64_tr_b16 v[116:117], v10 offset:32768
  ds_read_b64_tr_b16 v[118:119], v10 offset:33792
  s_waitcnt lgkmcnt(0)
  v_mfma_f32_16x16x32_bf16 v[140:143], v[100:103], v[76:79], v[140:143]
  v_mfma_f32_16x16x32_bf16 v[144:147], v[104:107], v[76:79], v[144:147]
  v_mfma_f32_16x16x32_bf16 v[148:151], v[108:111], v[76:79], v[148:151]
  v_mfma_f32_16x16x32_bf16 v[152:155], v[112:115], v[76:79], v[152:155]
  v_mfma_f32_16x16x32_bf16 v[156:159], v[116:119], v[76:79], v[156:159]
  s_waitcnt vmcnt(20)
  s_barrier
  s_add_u32 m0, s51, 81920
  s_add_u32 s46, s66, 696320
  buffer_load_dwordx4 v8, s[4:7], s46 offen  lds
  s_add_u32 m0, s51, 86016
  s_add_u32 s46, s66, 696448
  buffer_load_dwordx4 v8, s[4:7], s46 offen  lds
  s_add_u32 m0, s51, 90112
  s_add_u32 s46, s66, 696576
  buffer_load_dwordx4 v8, s[4:7], s46 offen  lds
  s_add_u32 m0, s51, 94208
  s_add_u32 s46, s66, 696704
  buffer_load_dwordx4 v8, s[4:7], s46 offen  lds
  s_add_u32 m0, s51, 98304
  s_add_u32 s46, s66, 696832
  buffer_load_dwordx4 v8, s[4:7], s46 offen  lds
  ds_read_b64_tr_b16 v[120:121], v10 offset:36864
  ds_read_b64_tr_b16 v[122:123], v10 offset:37888
  ds_read_b64_tr_b16 v[124:125], v10 offset:40960
  ds_read_b64_tr_b16 v[126:127], v10 offset:41984
  ds_read_b64_tr_b16 v[128:129], v10 offset:45056
  ds_read_b64_tr_b16 v[130:131], v10 offset:46080
  ds_read_b64_tr_b16 v[132:133], v10 offset:49152
  ds_read_b64_tr_b16 v[134:135], v10 offset:50176
  ds_read_b64_tr_b16 v[136:137], v10 offset:53248
  ds_read_b64_tr_b16 v[138:139], v10 offset:54272
  s_waitcnt lgkmcnt(0)
  v_mfma_f32_16x16x32_bf16 v[160:163], v[120:123], v[76:79], v[160:163]
  v_mfma_f32_16x16x32_bf16 v[164:167], v[124:127], v[76:79], v[164:167]
  v_mfma_f32_16x16x32_bf16 v[168:171], v[128:131], v[76:79], v[168:171]
  v_mfma_f32_16x16x32_bf16 v[172:175], v[132:135], v[76:79], v[172:175]
  v_mfma_f32_16x16x32_bf16 v[176:179], v[136:139], v[76:79], v[176:179]
  s_waitcnt vmcnt(20)
  s_barrier
  s_add_u32 m0, s51, 102400
  s_add_u32 s46, s66, 696960
  buffer_load_dwordx4 v8, s[4:7], s46 offen  lds
  s_add_u32 m0, s51, 106496
  s_add_u32 s46, s66, 697088
  buffer_load_dwordx4 v8, s[4:7], s46 offen  lds
  s_add_u32 m0, s51, 110592
  s_add_u32 s46, s66, 697216
  buffer_load_dwordx4 v8, s[4:7], s46 offen  lds
  s_add_u32 m0, s51, 114688
  s_add_u32 s46, s66, 697344
  buffer_load_dwordx4 v8, s[4:7], s46 offen  lds
  s_add_u32 m0, s51, 118784
  s_add_u32 s46, s66, 697472
  buffer_load_dwordx4 v8, s[4:7], s46 offen  lds
  ds_read_b64_tr_b16 v[100:101], v9 offset:0
  ds_read_b64_tr_b16 v[102:103], v9 offset:1024
  ds_read_b64_tr_b16 v[104:105], v9 offset:4096
  ds_read_b64_tr_b16 v[106:107], v9 offset:5120
  ds_read_b64_tr_b16 v[108:109], v9 offset:8192
  ds_read_b64_tr_b16 v[110:111], v9 offset:9216
  ds_read_b64_tr_b16 v[112:113], v9 offset:12288
  ds_read_b64_tr_b16 v[114:115], v9 offset:13312
  ds_read_b64_tr_b16 v[116:117], v9 offset:16384
  ds_read_b64_tr_b16 v[118:119], v9 offset:17408
  s_waitcnt lgkmcnt(0)
  v_mfma_f32_16x16x32_bf16 v[140:143], v[100:103], v[80:83], v[140:143]
  v_mfma_f32_16x16x32_bf16 v[144:147], v[104:107], v[80:83], v[144:147]
  v_mfma_f32_16x16x32_bf16 v[148:151], v[108:111], v[80:83], v[148:151]
  v_mfma_f32_16x16x32_bf16 v[152:155], v[112:115], v[80:83], v[152:155]
  v_mfma_f32_16x16x32_bf16 v[156:159], v[116:119], v[80:83], v[156:159]
  s_waitcnt vmcnt(20)
  s_barrier
  s_add_u32 m0, s51, 0
  s_add_u32 s46, s66, 737280
  buffer_load_dwordx4 v8, s[4:7], s46 offen  lds
  s_add_u32 m0, s51, 4096
  s_add_u32 s46, s66, 737408
  buffer_load_dwordx4 v8, s[4:7], s46 offen  lds
  s_add_u32 m0, s51, 8192
  s_add_u32 s46, s66, 737536
  buffer_load_dwordx4 v8, s[4:7], s46 offen  lds
  s_add_u32 m0, s51, 12288
  s_add_u32 s46, s66, 737664
  buffer_load_dwordx4 v8, s[4:7], s46 offen  lds
  s_add_u32 m0, s51, 16384
  s_add_u32 s46, s66, 737792
  buffer_load_dwordx4 v8, s[4:7], s46 offen  lds
  ds_read_b64_tr_b16 v[120:121], v9 offset:20480
  ds_read_b64_tr_b16 v[122:123], v9 offset:21504
  ds_read_b64_tr_b16 v[124:125], v9 offset:24576
  ds_read_b64_tr_b16 v[126:127], v9 offset:25600
  ds_read_b64_tr_b16 v[128:129], v9 offset:28672
  ds_read_b64_tr_b16 v[130:131], v9 offset:29696
  ds_read_b64_tr_b16 v[132:133], v9 offset:32768
  ds_read_b64_tr_b16 v[134:135], v9 offset:33792
  ds_read_b64_tr_b16 v[136:137], v9 offset:36864
  ds_read_b64_tr_b16 v[138:139], v9 offset:37888
  s_waitcnt lgkmcnt(0)
  v_mfma_f32_16x16x32_bf16 v[160:163], v[120:123], v[80:83], v[160:163]
  v_mfma_f32_16x16x32_bf16 v[164:167], v[124:127], v[80:83], v[164:167]
  v_mfma_f32_16x16x32_bf16 v[168:171], v[128:131], v[80:83], v[168:171]
  v_mfma_f32_16x16x32_bf16 v[172:175], v[132:135], v[80:83], v[172:175]
  v_mfma_f32_16x16x32_bf16 v[176:179], v[136:139], v[80:83], v[176:179]
  s_waitcnt vmcnt(20)
  s_barrier
  s_add_u32 m0, s51, 20480
  s_add_u32 s46, s66, 737920
  buffer_load_dwordx4 v8, s[4:7], s46 offen  lds
  s_add_u32 m0, s51, 24576
  s_add_u32 s46, s66, 738048
  buffer_load_dwordx4 v8, s[4:7], s46 offen  lds
  s_add_u32 m0, s51, 28672
  s_add_u32 s46, s66, 738176
  buffer_load_dwordx4 v8, s[4:7], s46 offen  lds
  s_add_u32 m0, s51, 32768
  s_add_u32 s46, s66, 738304
  buffer_load_dwordx4 v8, s[4:7], s46 offen  lds
  s_add_u32 m0, s51, 36864
  s_add_u32 s46, s66, 738432
  buffer_load_dwordx4 v8, s[4:7], s46 offen  lds
  ds_read_b64_tr_b16 v[100:101], v9 offset:40960
  ds_read_b64_tr_b16 v[102:103], v9 offset:41984
  ds_read_b64_tr_b16 v[104:105], v9 offset:45056
  ds_read_b64_tr_b16 v[106:107], v9 offset:46080
  ds_read_b64_tr_b16 v[108:109], v9 offset:49152
  ds_read_b64_tr_b16 v[110:111], v9 offset:50176
  ds_read_b64_tr_b16 v[112:113], v9 offset:53248
  ds_read_b64_tr_b16 v[114:115], v9 offset:54272
  ds_read_b64_tr_b16 v[116:117], v9 offset:57344
  ds_read_b64_tr_b16 v[118:119], v9 offset:58368
  s_waitcnt lgkmcnt(0)
  v_mfma_f32_16x16x32_bf16 v[140:143], v[100:103], v[84:87], v[140:143]
  v_mfma_f32_16x16x32_bf16 v[144:147], v[104:107], v[84:87], v[144:147]
  v_mfma_f32_16x16x32_bf16 v[148:151], v[108:111], v[84:87], v[148:151]
  v_mfma_f32_16x16x32_bf16 v[152:155], v[112:115], v[84:87], v[152:155]
  v_mfma_f32_16x16x32_bf16 v[156:159], v[116:119], v[84:87], v[156:159]
  s_waitcnt vmcnt(20)
  s_barrier
  s_add_u32 m0, s51, 40960
  s_add_u32 s46, s66, 778240
  buffer_load_dwordx4 v8, s[4:7], s46 offen  lds
  s_add_u32 m0, s51, 45056
  s_add_u32 s46, s66, 778368
  buffer_load_dwordx4 v8, s[4:7], s46 offen  lds
  s_add_u32 m0, s51, 49152
  s_add_u32 s46, s66, 778496
  buffer_load_dwordx4 v8, s[4:7], s46 offen  lds
  s_add_u32 m0, s51, 53248
  s_add_u32 s46, s66, 778624
  buffer_load_dwordx4 v8, s[4:7], s46 offen  lds
  s_add_u32 m0, s51, 57344
  s_add_u32 s46, s66, 778752
  buffer_load_dwordx4 v8, s[4:7], s46 offen  lds
  ds_read_b64_tr_b16 v[120:121], v9 offset:61440
  ds_read_b64_tr_b16 v[122:123], v9 offset:62464
  ds_read_b64_tr_b16 v[124:125], v10 offset:0
  ds_read_b64_tr_b16 v[126:127], v10 offset:1024
  ds_read_b64_tr_b16 v[128:129], v10 offset:4096
  ds_read_b64_tr_b16 v[130:131], v10 offset:5120
  ds_read_b64_tr_b16 v[132:133], v10 offset:8192
  ds_read_b64_tr_b16 v[134:135], v10 offset:9216
  ds_read_b64_tr_b16 v[136:137], v10 offset:12288
  ds_read_b64_tr_b16 v[138:139], v10 offset:13312
  s_waitcnt lgkmcnt(0)
  v_mfma_f32_16x16x32_bf16 v[160:163], v[120:123], v[84:87], v[160:163]
  v_mfma_f32_16x16x32_bf16 v[164:167], v[124:127], v[84:87], v[164:167]
  v_mfma_f32_16x16x32_bf16 v[168:171], v[128:131], v[84:87], v[168:171]
  v_mfma_f32_16x16x32_bf16 v[172:175], v[132:135], v[84:87], v[172:175]
  v_mfma_f32_16x16x32_bf16 v[176:179], v[136:139], v[84:87], v[176:179]
  s_waitcnt vmcnt(20)
  s_barrier
  s_add_u32 m0, s51, 61440
  s_add_u32 s46, s66, 778880
  buffer_load_dwordx4 v8, s[4:7], s46 offen  lds
  s_add_u32 m0, s51, 65536
  s_add_u32 s46, s66, 779008
  buffer_load_dwordx4 v8, s[4:7], s46 offen  lds
  s_add_u32 m0, s51, 69632
  s_add_u32 s46, s66, 779136
  buffer_load_dwordx4 v8, s[4:7], s46 offen  lds
  s_add_u32 m0, s51, 73728
  s_add_u32 s46, s66, 779264
  buffer_load_dwordx4 v8, s[4:7], s46 offen  lds
  s_add_u32 m0, s51, 77824
  s_add_u32 s46, s66, 779392
  buffer_load_dwordx4 v8, s[4:7], s46 offen  lds
  ds_read_b64_tr_b16 v[100:101], v10 offset:16384
  ds_read_b64_tr_b16 v[102:103], v10 offset:17408
  ds_read_b64_tr_b16 v[104:105], v10 offset:20480
  ds_read_b64_tr_b16 v[106:107], v10 offset:21504
  ds_read_b64_tr_b16 v[108:109], v10 offset:24576
  ds_read_b64_tr_b16 v[110:111], v10 offset:25600
  ds_read_b64_tr_b16 v[112:113], v10 offset:28672
  ds_read_b64_tr_b16 v[114:115], v10 offset:29696
  ds_read_b64_tr_b16 v[116:117], v10 offset:32768
  ds_read_b64_tr_b16 v[118:119], v10 offset:33792
  s_waitcnt lgkmcnt(0)
  v_mfma_f32_16x16x32_bf16 v[140:143], v[100:103], v[88:91], v[140:143]
  v_mfma_f32_16x16x32_bf16 v[144:147], v[104:107], v[88:91], v[144:147]
  v_mfma_f32_16x16x32_bf16 v[148:151], v[108:111], v[88:91], v[148:151]
  v_mfma_f32_16x16x32_bf16 v[152:155], v[112:115], v[88:91], v[152:155]
  v_mfma_f32_16x16x32_bf16 v[156:159], v[116:119], v[88:91], v[156:159]
  s_waitcnt vmcnt(20)
  s_barrier
  ds_read_b64_tr_b16 v[120:121], v10 offset:36864
  ds_read_b64_tr_b16 v[122:123], v10 offset:37888
  ds_read_b64_tr_b16 v[124:125], v10 offset:40960
  ds_read_b64_tr_b16 v[126:127], v10 offset:41984
  ds_read_b64_tr_b16 v[128:129], v10 offset:45056
  ds_read_b64_tr_b16 v[130:131], v10 offset:46080
  ds_read_b64_tr_b16 v[132:133], v10 offset:49152
  ds_read_b64_tr_b16 v[134:135], v10 offset:50176
  ds_read_b64_tr_b16 v[136:137], v10 offset:53248
  ds_read_b64_tr_b16 v[138:139], v10 offset:54272
  s_waitcnt lgkmcnt(0)
  v_mfma_f32_16x16x32_bf16 v[160:163], v[120:123], v[88:91], v[160:163]
  v_mfma_f32_16x16x32_bf16 v[164:167], v[124:127], v[88:91], v[164:167]
  v_mfma_f32_16x16x32_bf16 v[168:171], v[128:131], v[88:91], v[168:171]
  v_mfma_f32_16x16x32_bf16 v[172:175], v[132:135], v[88:91], v[172:175]
  v_mfma_f32_16x16x32_bf16 v[176:179], v[136:139], v[88:91], v[176:179]
  s_waitcnt vmcnt(15)
  s_barrier
  ds_read_b64_tr_b16 v[100:101], v9 offset:0
  ds_read_b64_tr_b16 v[102:103], v9 offset:1024
  ds_read_b64_tr_b16 v[104:105], v9 offset:4096
  ds_read_b64_tr_b16 v[106:107], v9 offset:5120
  ds_read_b64_tr_b16 v[108:109], v9 offset:8192
  ds_read_b64_tr_b16 v[110:111], v9 offset:9216
  ds_read_b64_tr_b16 v[112:113], v9 offset:12288
  ds_read_b64_tr_b16 v[114:115], v9 offset:13312
  ds_read_b64_tr_b16 v[116:117], v9 offset:16384
  ds_read_b64_tr_b16 v[118:119], v9 offset:17408
  s_waitcnt lgkmcnt(0)
  v_mfma_f32_16x16x32_bf16 v[140:143], v[100:103], v[92:95], v[140:143]
  v_mfma_f32_16x16x32_bf16 v[144:147], v[104:107], v[92:95], v[144:147]
  v_mfma_f32_16x16x32_bf16 v[148:151], v[108:111], v[92:95], v[148:151]
  v_mfma_f32_16x16x32_bf16 v[152:155], v[112:115], v[92:95], v[152:155]
  v_mfma_f32_16x16x32_bf16 v[156:159], v[116:119], v[92:95], v[156:159]
  s_waitcnt vmcnt(10)
  s_barrier
  ds_read_b64_tr_b16 v[120:121], v9 offset:20480
  ds_read_b64_tr_b16 v[122:123], v9 offset:21504
  ds_read_b64_tr_b16 v[124:125], v9 offset:24576
  ds_read_b64_tr_b16 v[126:127], v9 offset:25600
  ds_read_b64_tr_b16 v[128:129], v9 offset:28672
  ds_read_b64_tr_b16 v[130:131], v9 offset:29696
  ds_read_b64_tr_b16 v[132:133], v9 offset:32768
  ds_read_b64_tr_b16 v[134:135], v9 offset:33792
  ds_read_b64_tr_b16 v[136:137], v9 offset:36864
  ds_read_b64_tr_b16 v[138:139], v9 offset:37888
  s_waitcnt lgkmcnt(0)
  v_mfma_f32_16x16x32_bf16 v[160:163], v[120:123], v[92:95], v[160:163]
  v_mfma_f32_16x16x32_bf16 v[164:167], v[124:127], v[92:95], v[164:167]
  v_mfma_f32_16x16x32_bf16 v[168:171], v[128:131], v[92:95], v[168:171]
  v_mfma_f32_16x16x32_bf16 v[172:175], v[132:135], v[92:95], v[172:175]
  v_mfma_f32_16x16x32_bf16 v[176:179], v[136:139], v[92:95], v[176:179]
  s_waitcnt vmcnt(5)
  s_barrier
  ds_read_b64_tr_b16 v[100:101], v9 offset:40960
  ds_read_b64_tr_b16 v[102:103], v9 offset:41984
  ds_read_b64_tr_b16 v[104:105], v9 offset:45056
  ds_read_b64_tr_b16 v[106:107], v9 offset:46080
  ds_read_b64_tr_b16 v[108:109], v9 offset:49152
  ds_read_b64_tr_b16 v[110:111], v9 offset:50176
  ds_read_b64_tr_b16 v[112:113], v9 offset:53248
  ds_read_b64_tr_b16 v[114:115], v9 offset:54272
  ds_read_b64_tr_b16 v[116:117], v9 offset:57344
  ds_read_b64_tr_b16 v[118:119], v9 offset:58368
  s_waitcnt lgkmcnt(0)
  v_mfma_f32_16x16x32_bf16 v[140:143], v[100:103], v[96:99], v[140:143]
  v_mfma_f32_16x16x32_bf16 v[144:147], v[104:107], v[96:99], v[144:147]
  v_mfma_f32_16x16x32_bf16 v[148:151], v[108:111], v[96:99], v[148:151]
  v_mfma_f32_16x16x32_bf16 v[152:155], v[112:115], v[96:99], v[152:155]
  v_mfma_f32_16x16x32_bf16 v[156:159], v[116:119], v[96:99], v[156:159]
  s_waitcnt vmcnt(0)
  s_barrier
  ds_read_b64_tr_b16 v[120:121], v9 offset:61440
  ds_read_b64_tr_b16 v[122:123], v9 offset:62464
  ds_read_b64_tr_b16 v[124:125], v10 offset:0
  ds_read_b64_tr_b16 v[126:127], v10 offset:1024
  ds_read_b64_tr_b16 v[128:129], v10 offset:4096
  ds_read_b64_tr_b16 v[130:131], v10 offset:5120
  ds_read_b64_tr_b16 v[132:133], v10 offset:8192
  ds_read_b64_tr_b16 v[134:135], v10 offset:9216
  ds_read_b64_tr_b16 v[136:137], v10 offset:12288
  ds_read_b64_tr_b16 v[138:139], v10 offset:13312
  s_waitcnt lgkmcnt(0)
  v_mfma_f32_16x16x32_bf16 v[160:163], v[120:123], v[96:99], v[160:163]
  v_mfma_f32_16x16x32_bf16 v[164:167], v[124:127], v[96:99], v[164:167]
  v_mfma_f32_16x16x32_bf16 v[168:171], v[128:131], v[96:99], v[168:171]
  v_mfma_f32_16x16x32_bf16 v[172:175], v[132:135], v[96:99], v[172:175]
  v_mfma_f32_16x16x32_bf16 v[176:179], v[136:139], v[96:99], v[176:179]
  s_barrier
  v_cvt_pk_bf16_f32 v140, v140, v141
  v_cvt_pk_bf16_f32 v141, v142, v143
  buffer_store_dwordx2 v[140:141], v12, s[12:15], 0 offen offset:0
  v_cvt_pk_bf16_f32 v144, v144, v145
  v_cvt_pk_bf16_f32 v145, v146, v147
  buffer_store_dwordx2 v[144:145], v12, s[12:15], 0 offen offset:128
  v_cvt_pk_bf16_f32 v148, v148, v149
  v_cvt_pk_bf16_f32 v149, v150, v151
  buffer_store_dwordx2 v[148:149], v12, s[12:15], 0 offen offset:256
  v_cvt_pk_bf16_f32 v152, v152, v153
  v_cvt_pk_bf16_f32 v153, v154, v155
  buffer_store_dwordx2 v[152:153], v12, s[12:15], 0 offen offset:384
  v_cvt_pk_bf16_f32 v156, v156, v157
  v_cvt_pk_bf16_f32 v157, v158, v159
  buffer_store_dwordx2 v[156:157], v12, s[12:15], 0 offen offset:512
  v_cvt_pk_bf16_f32 v160, v160, v161
  v_cvt_pk_bf16_f32 v161, v162, v163
  buffer_store_dwordx2 v[160:161], v12, s[12:15], 0 offen offset:640
  v_cvt_pk_bf16_f32 v164, v164, v165
  v_cvt_pk_bf16_f32 v165, v166, v167
  buffer_store_dwordx2 v[164:165], v12, s[12:15], 0 offen offset:768
  v_cvt_pk_bf16_f32 v168, v168, v169
  v_cvt_pk_bf16_f32 v169, v170, v171
  buffer_store_dwordx2 v[168:169], v12, s[12:15], 0 offen offset:896
  v_cvt_pk_bf16_f32 v172, v172, v173
  v_cvt_pk_bf16_f32 v173, v174, v175
  buffer_store_dwordx2 v[172:173], v12, s[12:15], 0 offen offset:1024
  v_cvt_pk_bf16_f32 v176, v176, v177
  v_cvt_pk_bf16_f32 v177, v178, v179
  buffer_store_dwordx2 v[176:177], v12, s[12:15], 0 offen offset:1152
  s_endpgm
L_recur:
  s_cmp_lt_u32 s44, 8
  s_cbranch_scc1 L_score
  s_cmp_lt_u32 s44, 16
  s_cbranch_scc1 L_value
  s_cmp_lt_u32 s44, 28
  s_cbranch_scc1 rc_nowarm
  s_lshl_b32 s46, s44, 2
  s_add_u32 s46, s46, s43
  s_lshl_b32 s46, s46, 2
  s_add_u32 s46, s46, s42
  s_sub_u32 s46, s46, 448
  s_lshl_b32 s46, s46, 13
  v_lshlrev_b32 v1, 7, v0
  s_add_u32 s47, s46, 0
  buffer_load_dword v250, v1, s[12:15], s47 offen
  s_add_u32 s47, s46, 524288
  buffer_load_dword v250, v1, s[12:15], s47 offen
  s_add_u32 s47, s46, 1048576
  buffer_load_dword v250, v1, s[12:15], s47 offen
  s_add_u32 s47, s46, 1572864
  buffer_load_dword v250, v1, s[12:15], s47 offen
  s_add_u32 s47, s46, 2097152
  buffer_load_dword v250, v1, s[12:15], s47 offen
rc_nowarm:
  s_mov_b32 s50, 0
ss_15:
  v_and_b32 v3, 3, v0
  v_lshlrev_b32 v3, 2, v3
  global_load_dword v2, v3, s[38:39] sc1
  s_add_u32 s50, s50, 1
  s_cmp_gt_u32 s50, 131072
  s_cbranch_scc1 L_fail
  s_waitcnt vmcnt(0)
ss_15_in:
  v_readlane_b32 s46, v2, 0
  v_readlane_b32 s47, v2, 0
  v_readlane_b32 s48, v2, 0
  s_nop 0
  s_min_u32 s47, s47, s48
  s_cmp_lg_u32 s46, 0
  s_cselect_b32 s48, 7, 0
  s_add_u32 s46, s46, s2
  s_xor_b32 s49, s46, s43
  s_and_b32 s49, s49, s48
  s_cbranch_scc1 L_reroll
  s_cmp_lg_u32 s47, 0
  s_cbranch_scc1 ss_ok_16
  s_sleep 6
  s_branch ss_15
ss_ok_16:
  s_cmp_lt_u32 s44, 26
  s_cbranch_scc1 L_owner
  s_branch L_xowner
L_score:
  s_mov_b32 s4, s26
  s_mov_b32 s5, s27
  s_mov_b32 s6, 7864320
  s_mov_b32 s7, 0x20000
  s_mov_b32 s12, s28
  s_mov_b32 s13, s29
  s_mov_b32 s14, 7864320
  s_mov_b32 s15, 0x20000
  v_lshrrev_b32 v136, 3, v0
  v_lshrrev_b32 v137, 2, v136
  v_lshlrev_b32 v137, 3, v137
  v_and_b32 v64, 3, v136
  v_add_u32 v64, v64, v137
  s_and_b32 s46, s42, 1
  s_lshl_b32 s46, s46, 2
  s_lshr_b32 s47, s42, 1
  s_lshl_b32 s47, s47, 4
  s_add_u32 s46, s46, s47
  v_add_u32 v64, s46, v64
  v_mul_u32_u24 v64, 12288, v64
  v_lshrrev_b32 v136, 1, v136
  v_bfe_u32 v137, v0, 1, 2
  v_xor_b32 v136, v136, v137
  v_lshlrev_b32 v136, 5, v136
  v_and_b32 v137, 1, v0
  v_lshlrev_b32 v137, 4, v137
  v_add3_u32 v64, v64, v136, v137
  v_lshrrev_b32 v136, 5, v0
  v_lshlrev_b32 v65, 11, v136
  v_bfe_u32 v136, v0, 2, 3
  v_lshl_add_u32 v65, v136, 7, v65
  v_lshrrev_b32 v136, 1, v136
  v_xor_b32 v136, s42, v136
  v_lshl_add_u32 v65, v136, 5, v65
  v_and_b32 v136, 3, v0
  v_lshl_add_u32 v65, v136, 3, v65
  v_add_u32 v66, 0x10000, v65
  v_add_u32 v67, 0x20000, v65
  v_lshlrev_b32 v1, 4, v0
  v_add_u32 v2, s51, v1
  v_add_u32 v3, 0x10000, v2
  s_mul_i32 s62, s45, 384
  s_mov_b32 s24, 4096
  s_mov_b32 s25, 49152
  s_add_u32 m0, s51, 73728
  s_add_u32 s46, s62, 786432
  buffer_load_dwordx4 v64, s[12:15], s46 offen  lds
  s_add_u32 m0, s51, 77824
  s_add_u32 s46, s62, 1179648
  buffer_load_dwordx4 v64, s[12:15], s46 offen  lds
  s_add_u32 m0, s51, 81920
  s_add_u32 s46, s62, 786560
  buffer_load_dwordx4 v64, s[12:15], s46 offen  lds
  s_add_u32 m0, s51, 86016
  s_add_u32 s46, s62, 1179776
  buffer_load_dwordx4 v64, s[12:15], s46 offen  lds
  s_add_u32 m0, s51, 90112
  s_add_u32 s46, s62, 786688
  buffer_load_dwordx4 v64, s[12:15], s46 offen  lds
  s_add_u32 m0, s51, 94208
  s_add_u32 s46, s62, 1179904
  buffer_load_dwordx4 v64, s[12:15], s46 offen  lds
  s_add_u32 m0, s51, 98304
  s_add_u32 s46, s62, 1572864
  buffer_load_dwordx4 v64, s[12:15], s46 offen  lds
  s_add_u32 m0, s51, 102400
  s_add_u32 s46, s62, 1966080
  buffer_load_dwordx4 v64, s[12:15], s46 offen  lds
  s_add_u32 m0, s51, 106496
  s_add_u32 s46, s62, 1572992
  buffer_load_dwordx4 v64, s[12:15], s46 offen  lds
  s_add_u32 m0, s51, 110592
  s_add_u32 s46, s62, 1966208
  buffer_load_dwordx4 v64, s[12:15], s46 offen  lds
  s_add_u32 m0, s51, 114688
  s_add_u32 s46, s62, 1573120
  buffer_load_dwordx4 v64, s[12:15], s46 offen  lds
  s_add_u32 m0, s51, 118784
  s_add_u32 s46, s62, 1966336
  buffer_load_dwordx4 v64, s[12:15], s46 offen  lds
  s_add_u32 m0, s51, 122880
  s_add_u32 s46, s62, 2359296
  buffer_load_dwordx4 v64, s[12:15], s46 offen  lds
  s_add_u32 m0, s51, 126976
  s_add_u32 s46, s62, 2752512
  buffer_load_dwordx4 v64, s[12:15], s46 offen  lds
  s_add_u32 m0, s51, 131072
  s_add_u32 s46, s62, 2359424
  buffer_load_dwordx4 v64, s[12:15], s46 offen  lds
  s_add_u32 m0, s51, 135168
  s_add_u32 s46, s62, 2752640
  buffer_load_dwordx4 v64, s[12:15], s46 offen  lds
  s_add_u32 m0, s51, 139264
  s_add_u32 s46, s62, 2359552
  buffer_load_dwordx4 v64, s[12:15], s46 offen  lds
  s_add_u32 m0, s51, 143360
  s_add_u32 s46, s62, 2752768
  buffer_load_dwordx4 v64, s[12:15], s46 offen  lds
  s_add_u32 m0, s51, 0
  s_add_u32 s46, s62, 3145728
  buffer_load_dwordx4 v64, s[12:15], s46 offen  lds
  s_add_u32 m0, s51, 4096
  s_add_u32 s46, s62, 3538944
  buffer_load_dwordx4 v64, s[12:15], s46 offen  lds
  s_add_u32 m0, s51, 8192
  s_add_u32 s46, s62, 3145856
  buffer_load_dwordx4 v64, s[12:15], s46 offen  lds
  s_add_u32 m0, s51, 12288
  s_add_u32 s46, s62, 3539072
  buffer_load_dwordx4 v64, s[12:15], s46 offen  lds
  s_add_u32 m0, s51, 16384
  s_add_u32 s46, s62, 3145984
  buffer_load_dwordx4 v64, s[12:15], s46 offen  lds
  s_add_u32 m0, s51, 20480
  s_add_u32 s46, s62, 3539200
  buffer_load_dwordx4 v64, s[12:15], s46 offen  lds
  s_add_u32 m0, s51, 24576
  s_add_u32 s46, s62, 4718592
  buffer_load_dwordx4 v64, s[12:15], s46 offen  lds
  s_add_u32 m0, s51, 28672
  s_add_u32 s46, s62, 5111808
  buffer_load_dwordx4 v64, s[12:15], s46 offen  lds
  s_add_u32 m0, s51, 32768
  s_add_u32 s46, s62, 4718720
  buffer_load_dwordx4 v64, s[12:15], s46 offen  lds
  s_add_u32 m0, s51, 36864
  s_add_u32 s46, s62, 5111936
  buffer_load_dwordx4 v64, s[12:15], s46 offen  lds
  s_add_u32 m0, s51, 40960
  s_add_u32 s46, s62, 4718848
  buffer_load_dwordx4 v64, s[12:15], s46 offen  lds
  s_add_u32 m0, s51, 45056
  s_add_u32 s46, s62, 5112064
  buffer_load_dwordx4 v64, s[12:15], s46 offen  lds
  s_waitcnt vmcnt(24)
  s_barrier
  s_add_u32 m0, s51, 49152
  s_add_u32 s46, s62, 5505024
  buffer_load_dwordx4 v64, s[12:15], s46 offen  lds
  s_add_u32 m0, s51, 53248
  s_add_u32 s46, s62, 5898240
  buffer_load_dwordx4 v64, s[12:15], s46 offen  lds
  s_add_u32 m0, s51, 57344
  s_add_u32 s46, s62, 5505152
  buffer_load_dwordx4 v64, s[12:15], s46 offen  lds
  s_add_u32 m0, s51, 61440
  s_add_u32 s46, s62, 5898368
  buffer_load_dwordx4 v64, s[12:15], s46 offen  lds
  s_add_u32 m0, s51, 65536
  s_add_u32 s46, s62, 5505280
  buffer_load_dwordx4 v64, s[12:15], s46 offen  lds
  s_add_u32 m0, s51, 69632
  s_add_u32 s46, s62, 5898496
  buffer_load_dwordx4 v64, s[12:15], s46 offen  lds
  ds_read_b64_tr_b16 a[0:1], v66 offset:8192
  ds_read_b64_tr_b16 a[2:3], v66 offset:9216
  ds_read_b64_tr_b16 a[4:5], v66 offset:12288
  ds_read_b64_tr_b16 a[6:7], v66 offset:13312
  ds_read_b64_tr_b16 a[8:9], v66 offset:16384
  ds_read_b64_tr_b16 a[10:11], v66 offset:17408
  ds_read_b64_tr_b16 a[12:13], v66 offset:20480
  ds_read_b64_tr_b16 a[14:15], v66 offset:21504
  ds_read_b64_tr_b16 a[16:17], v66 offset:24576
  ds_read_b64_tr_b16 a[18:19], v66 offset:25600
  ds_read_b64_tr_b16 a[20:21], v66 offset:28672
  ds_read_b64_tr_b16 a[22:23], v66 offset:29696
  s_waitcnt lgkmcnt(0)
  s_waitcnt vmcnt(24)
  s_barrier
  s_add_u32 m0, s51, 73728
  s_add_u32 s46, s62, 6291456
  buffer_load_dwordx4 v64, s[12:15], s46 offen  lds
  s_add_u32 m0, s51, 77824
  s_add_u32 s46, s62, 6684672
  buffer_load_dwordx4 v64, s[12:15], s46 offen  lds
  s_add_u32 m0, s51, 81920
  s_add_u32 s46, s62, 6291584
  buffer_load_dwordx4 v64, s[12:15], s46 offen  lds
  s_add_u32 m0, s51, 86016
  s_add_u32 s46, s62, 6684800
  buffer_load_dwordx4 v64, s[12:15], s46 offen  lds
  s_add_u32 m0, s51, 90112
  s_add_u32 s46, s62, 6291712
  buffer_load_dwordx4 v64, s[12:15], s46 offen  lds
  s_add_u32 m0, s51, 94208
  s_add_u32 s46, s62, 6684928
  buffer_load_dwordx4 v64, s[12:15], s46 offen  lds
  ds_read_b64_tr_b16 a[24:25], v66 offset:32768
  ds_read_b64_tr_b16 a[26:27], v66 offset:33792
  ds_read_b64_tr_b16 a[28:29], v66 offset:36864
  ds_read_b64_tr_b16 a[30:31], v66 offset:37888
  ds_read_b64_tr_b16 a[32:33], v66 offset:40960
  ds_read_b64_tr_b16 a[34:35], v66 offset:41984
  ds_read_b64_tr_b16 a[36:37], v66 offset:45056
  ds_read_b64_tr_b16 a[38:39], v66 offset:46080
  ds_read_b64_tr_b16 a[40:41], v66 offset:49152
  ds_read_b64_tr_b16 a[42:43], v66 offset:50176
  ds_read_b64_tr_b16 a[44:45], v66 offset:53248
  ds_read_b64_tr_b16 a[46:47], v66 offset:54272
  s_waitcnt lgkmcnt(0)
  s_waitcnt vmcnt(24)
  s_barrier
  s_add_u32 m0, s51, 98304
  s_add_u32 s46, s62, 7077888
  buffer_load_dwordx4 v64, s[12:15], s46 offen  lds
  s_add_u32 m0, s51, 102400
  s_add_u32 s46, s62, 7471104
  buffer_load_dwordx4 v64, s[12:15], s46 offen  lds
  s_add_u32 m0, s51, 106496
  s_add_u32 s46, s62, 7078016
  buffer_load_dwordx4 v64, s[12:15], s46 offen  lds
  s_add_u32 m0, s51, 110592
  s_add_u32 s46, s62, 7471232
  buffer_load_dwordx4 v64, s[12:15], s46 offen  lds
  s_add_u32 m0, s51, 114688
  s_add_u32 s46, s62, 7078144
  buffer_load_dwordx4 v64, s[12:15], s46 offen  lds
  s_add_u32 m0, s51, 118784
  s_add_u32 s46, s62, 7471360
  buffer_load_dwordx4 v64, s[12:15], s46 offen  lds
  ds_read_b64_tr_b16 a[48:49], v66 offset:57344
  ds_read_b64_tr_b16 a[50:51], v66 offset:58368
  ds_read_b64_tr_b16 a[52:53], v66 offset:61440
  ds_read_b64_tr_b16 a[54:55], v66 offset:62464
  ds_read_b64_tr_b16 a[56:57], v67 offset:0
  ds_read_b64_tr_b16 a[58:59], v67 offset:1024
  ds_read_b64_tr_b16 a[60:61], v67 offset:4096
  ds_read_b64_tr_b16 a[62:63], v67 offset:5120
  ds_read_b64_tr_b16 a[64:65], v67 offset:8192
  ds_read_b64_tr_b16 a[66:67], v67 offset:9216
  ds_read_b64_tr_b16 a[68:69], v67 offset:12288
  ds_read_b64_tr_b16 a[70:71], v67 offset:13312
  s_waitcnt lgkmcnt(0)
  s_waitcnt vmcnt(24)
  s_barrier
  s_add_u32 m0, s51, 122880
  s_add_u32 s46, s62, 0
  buffer_load_dwordx4 v64, s[4:7], s46 offen  lds
  s_add_u32 m0, s51, 126976
  s_add_u32 s46, s62, 393216
  buffer_load_dwordx4 v64, s[4:7], s46 offen  lds
  s_add_u32 m0, s51, 131072
  s_add_u32 s46, s62, 128
  buffer_load_dwordx4 v64, s[4:7], s46 offen  lds
  s_add_u32 m0, s51, 135168
  s_add_u32 s46, s62, 393344
  buffer_load_dwordx4 v64, s[4:7], s46 offen  lds
  s_add_u32 m0, s51, 139264
  s_add_u32 s46, s62, 256
  buffer_load_dwordx4 v64, s[4:7], s46 offen  lds
  s_add_u32 m0, s51, 143360
  s_add_u32 s46, s62, 393472
  buffer_load_dwordx4 v64, s[4:7], s46 offen  lds
  ds_read_b64_tr_b16 a[72:73], v65 offset:0
  ds_read_b64_tr_b16 a[74:75], v65 offset:1024
  ds_read_b64_tr_b16 a[76:77], v65 offset:4096
  ds_read_b64_tr_b16 a[78:79], v65 offset:5120
  ds_read_b64_tr_b16 a[80:81], v65 offset:8192
  ds_read_b64_tr_b16 a[82:83], v65 offset:9216
  ds_read_b64_tr_b16 a[84:85], v65 offset:12288
  ds_read_b64_tr_b16 a[86:87], v65 offset:13312
  ds_read_b64_tr_b16 a[88:89], v65 offset:16384
  ds_read_b64_tr_b16 a[90:91], v65 offset:17408
  ds_read_b64_tr_b16 a[92:93], v65 offset:20480
  ds_read_b64_tr_b16 a[94:95], v65 offset:21504
  s_waitcnt lgkmcnt(0)
  s_waitcnt vmcnt(24)
  s_barrier
  s_add_u32 m0, s51, 0
  s_add_u32 s46, s62, 786432
  buffer_load_dwordx4 v64, s[4:7], s46 offen  lds
  s_add_u32 m0, s51, 4096
  s_add_u32 s46, s62, 1179648
  buffer_load_dwordx4 v64, s[4:7], s46 offen  lds
  s_add_u32 m0, s51, 8192
  s_add_u32 s46, s62, 786560
  buffer_load_dwordx4 v64, s[4:7], s46 offen  lds
  s_add_u32 m0, s51, 12288
  s_add_u32 s46, s62, 1179776
  buffer_load_dwordx4 v64, s[4:7], s46 offen  lds
  s_add_u32 m0, s51, 16384
  s_add_u32 s46, s62, 786688
  buffer_load_dwordx4 v64, s[4:7], s46 offen  lds
  s_add_u32 m0, s51, 20480
  s_add_u32 s46, s62, 1179904
  buffer_load_dwordx4 v64, s[4:7], s46 offen  lds
  ds_read_b64_tr_b16 a[96:97], v65 offset:24576
  ds_read_b64_tr_b16 a[98:99], v65 offset:25600
  ds_read_b64_tr_b16 a[100:101], v65 offset:28672
  ds_read_b64_tr_b16 a[102:103], v65 offset:29696
  ds_read_b64_tr_b16 a[104:105], v65 offset:32768
  ds_read_b64_tr_b16 a[106:107], v65 offset:33792
  ds_read_b64_tr_b16 a[108:109], v65 offset:36864
  ds_read_b64_tr_b16 a[110:111], v65 offset:37888
  ds_read_b64_tr_b16 a[112:113], v65 offset:40960
  ds_read_b64_tr_b16 a[114:115], v65 offset:41984
  ds_read_b64_tr_b16 a[116:117], v65 offset:45056
  ds_read_b64_tr_b16 a[118:119], v65 offset:46080
  s_waitcnt lgkmcnt(0)
  s_waitcnt vmcnt(24)
  s_barrier
  s_add_u32 m0, s51, 24576
  s_add_u32 s46, s62, 1572864
  buffer_load_dwordx4 v64, s[4:7], s46 offen  lds
  s_add_u32 m0, s51, 28672
  s_add_u32 s46, s62, 1966080
  buffer_load_dwordx4 v64, s[4:7], s46 offen  lds
  s_add_u32 m0, s51, 32768
  s_add_u32 s46, s62, 1572992
  buffer_load_dwordx4 v64, s[4:7], s46 offen  lds
  s_add_u32 m0, s51, 36864
  s_add_u32 s46, s62, 1966208
  buffer_load_dwordx4 v64, s[4:7], s46 offen  lds
  s_add_u32 m0, s51, 40960
  s_add_u32 s46, s62, 1573120
  buffer_load_dwordx4 v64, s[4:7], s46 offen  lds
  s_add_u32 m0, s51, 45056
  s_add_u32 s46, s62, 1966336
  buffer_load_dwordx4 v64, s[4:7], s46 offen  lds
  ds_read_b64_tr_b16 a[120:121], v65 offset:49152
  ds_read_b64_tr_b16 a[122:123], v65 offset:50176
  ds_read_b64_tr_b16 a[124:125], v65 offset:53248
  ds_read_b64_tr_b16 a[126:127], v65 offset:54272
  ds_read_b64_tr_b16 a[128:129], v65 offset:57344
  ds_read_b64_tr_b16 a[130:131], v65 offset:58368
  ds_read_b64_tr_b16 a[132:133], v65 offset:61440
  ds_read_b64_tr_b16 a[134:135], v65 offset:62464
  ds_read_b64_tr_b16 a[136:137], v66 offset:0
  ds_read_b64_tr_b16 a[138:139], v66 offset:1024
  ds_read_b64_tr_b16 a[140:141], v66 offset:4096
  ds_read_b64_tr_b16 a[142:143], v66 offset:5120
  s_waitcnt lgkmcnt(0)
  s_waitcnt vmcnt(24)
  s_barrier
  s_add_u32 m0, s51, 49152
  s_add_u32 s46, s62, 3145728
  buffer_load_dwordx4 v64, s[4:7], s46 offen  lds
  s_add_u32 m0, s51, 53248
  s_add_u32 s46, s62, 3538944
  buffer_load_dwordx4 v64, s[4:7], s46 offen  lds
  s_add_u32 m0, s51, 57344
  s_add_u32 s46, s62, 3145856
  buffer_load_dwordx4 v64, s[4:7], s46 offen  lds
  s_add_u32 m0, s51, 61440
  s_add_u32 s46, s62, 3539072
  buffer_load_dwordx4 v64, s[4:7], s46 offen  lds
  s_add_u32 m0, s51, 65536
  s_add_u32 s46, s62, 3145984
  buffer_load_dwordx4 v64, s[4:7], s46 offen  lds
  s_add_u32 m0, s51, 69632
  s_add_u32 s46, s62, 3539200
  buffer_load_dwordx4 v64, s[4:7], s46 offen  lds
  ds_read_b64_tr_b16 a[144:145], v66 offset:8192
  ds_read_b64_tr_b16 a[146:147], v66 offset:9216
  ds_read_b64_tr_b16 a[148:149], v66 offset:12288
  ds_read_b64_tr_b16 a[150:151], v66 offset:13312
  ds_read_b64_tr_b16 a[152:153], v66 offset:16384
  ds_read_b64_tr_b16 a[154:155], v66 offset:17408
  ds_read_b64_tr_b16 a[156:157], v66 offset:20480
  ds_read_b64_tr_b16 a[158:159], v66 offset:21504
  ds_read_b64_tr_b16 a[160:161], v66 offset:24576
  ds_read_b64_tr_b16 a[162:163], v66 offset:25600
  ds_read_b64_tr_b16 a[164:165], v66 offset:28672
  ds_read_b64_tr_b16 a[166:167], v66 offset:29696
  s_waitcnt lgkmcnt(0)
  s_waitcnt vmcnt(24)
  s_barrier
  s_add_u32 m0, s51, 73728
  s_add_u32 s46, s62, 3932160
  buffer_load_dwordx4 v64, s[4:7], s46 offen  lds
  s_add_u32 m0, s51, 77824
  s_add_u32 s46, s62, 4325376
  buffer_load_dwordx4 v64, s[4:7], s46 offen  lds
  s_add_u32 m0, s51, 81920
  s_add_u32 s46, s62, 3932288
  buffer_load_dwordx4 v64, s[4:7], s46 offen  lds
  s_add_u32 m0, s51, 86016
  s_add_u32 s46, s62, 4325504
  buffer_load_dwordx4 v64, s[4:7], s46 offen  lds
  s_add_u32 m0, s51, 90112
  s_add_u32 s46, s62, 3932416
  buffer_load_dwordx4 v64, s[4:7], s46 offen  lds
  s_add_u32 m0, s51, 94208
  s_add_u32 s46, s62, 4325632
  buffer_load_dwordx4 v64, s[4:7], s46 offen  lds
  ds_read_b64_tr_b16 a[168:169], v66 offset:32768
  ds_read_b64_tr_b16 a[170:171], v66 offset:33792
  ds_read_b64_tr_b16 a[172:173], v66 offset:36864
  ds_read_b64_tr_b16 a[174:175], v66 offset:37888
  ds_read_b64_tr_b16 a[176:177], v66 offset:40960
  ds_read_b64_tr_b16 a[178:179], v66 offset:41984
  ds_read_b64_tr_b16 a[180:181], v66 offset:45056
  ds_read_b64_tr_b16 a[182:183], v66 offset:46080
  ds_read_b64_tr_b16 a[184:185], v66 offset:49152
  ds_read_b64_tr_b16 a[186:187], v66 offset:50176
  ds_read_b64_tr_b16 a[188:189], v66 offset:53248
  ds_read_b64_tr_b16 a[190:191], v66 offset:54272
  s_waitcnt lgkmcnt(0)
  s_waitcnt vmcnt(24)
  s_barrier
  s_add_u32 m0, s51, 98304
  s_add_u32 s46, s62, 5505024
  buffer_load_dwordx4 v64, s[4:7], s46 offen  lds
  s_add_u32 m0, s51, 102400
  s_add_u32 s46, s62, 5898240
  buffer_load_dwordx4 v64, s[4:7], s46 offen  lds
  s_add_u32 m0, s51, 106496
  s_add_u32 s46, s62, 5505152
  buffer_load_dwordx4 v64, s[4:7], s46 offen  lds
  s_add_u32 m0, s51, 110592
  s_add_u32 s46, s62, 5898368
  buffer_load_dwordx4 v64, s[4:7], s46 offen  lds
  s_add_u32 m0, s51, 114688
  s_add_u32 s46, s62, 5505280
  buffer_load_dwordx4 v64, s[4:7], s46 offen  lds
  s_add_u32 m0, s51, 118784
  s_add_u32 s46, s62, 5898496
  buffer_load_dwordx4 v64, s[4:7], s46 offen  lds
  ds_read_b64_tr_b16 a[192:193], v66 offset:57344
  ds_read_b64_tr_b16 a[194:195], v66 offset:58368
  ds_read_b64_tr_b16 a[196:197], v66 offset:61440
  ds_read_b64_tr_b16 a[198:199], v66 offset:62464
  ds_read_b64_tr_b16 a[200:201], v67 offset:0
  ds_read_b64_tr_b16 a[202:203], v67 offset:1024
  ds_read_b64_tr_b16 a[204:205], v67 offset:4096
  ds_read_b64_tr_b16 a[206:207], v67 offset:5120
  ds_read_b64_tr_b16 a[208:209], v67 offset:8192
  ds_read_b64_tr_b16 a[210:211], v67 offset:9216
  ds_read_b64_tr_b16 a[212:213], v67 offset:12288
  ds_read_b64_tr_b16 a[214:215], v67 offset:13312
  s_waitcnt lgkmcnt(0)
  s_waitcnt vmcnt(24)
  s_barrier
  v_and_b32 v137, 3, v0
  v_lshlrev_b32 v137, 2, v137
  global_load_dword v136, v137, s[38:39] sc1
  s_add_u32 m0, s51, 122880
  s_add_u32 s46, s62, 6291456
  buffer_load_dwordx4 v64, s[4:7], s46 offen  lds
  s_add_u32 m0, s51, 126976
  s_add_u32 s46, s62, 6684672
  buffer_load_dwordx4 v64, s[4:7], s46 offen  lds
  s_add_u32 m0, s51, 131072
  s_add_u32 s46, s62, 6291584
  buffer_load_dwordx4 v64, s[4:7], s46 offen  lds
  s_add_u32 m0, s51, 135168
  s_add_u32 s46, s62, 6684800
  buffer_load_dwordx4 v64, s[4:7], s46 offen  lds
  s_add_u32 m0, s51, 139264
  s_add_u32 s46, s62, 6291712
  buffer_load_dwordx4 v64, s[4:7], s46 offen  lds
  s_add_u32 m0, s51, 143360
  s_add_u32 s46, s62, 6684928
  buffer_load_dwordx4 v64, s[4:7], s46 offen  lds
  ds_read_b64_tr_b16 a[216:217], v65 offset:0
  ds_read_b64_tr_b16 a[218:219], v65 offset:1024
  ds_read_b64_tr_b16 a[220:221], v65 offset:4096
  ds_read_b64_tr_b16 a[222:223], v65 offset:5120
  ds_read_b64_tr_b16 a[224:225], v65 offset:8192
  ds_read_b64_tr_b16 a[226:227], v65 offset:9216
  ds_read_b64_tr_b16 a[228:229], v65 offset:12288
  ds_read_b64_tr_b16 a[230:231], v65 offset:13312
  ds_read_b64_tr_b16 a[232:233], v65 offset:16384
  ds_read_b64_tr_b16 a[234:235], v65 offset:17408
  ds_read_b64_tr_b16 a[236:237], v65 offset:20480
  ds_read_b64_tr_b16 a[238:239], v65 offset:21504
  s_waitcnt lgkmcnt(0)
  s_waitcnt vmcnt(25)
  s_barrier
  s_add_u32 m0, s51, 0
  s_add_u32 s46, s62, 0
  buffer_load_dwordx4 v64, s[12:15], s46 offen  lds
  s_add_u32 m0, s51, 4096
  s_add_u32 s46, s62, 393216
  buffer_load_dwordx4 v64, s[12:15], s46 offen  lds
  s_add_u32 m0, s51, 8192
  s_add_u32 s46, s62, 128
  buffer_load_dwordx4 v64, s[12:15], s46 offen  lds
  s_add_u32 m0, s51, 12288
  s_add_u32 s46, s62, 393344
  buffer_load_dwordx4 v64, s[12:15], s46 offen  lds
  s_add_u32 m0, s51, 16384
  s_add_u32 s46, s62, 256
  buffer_load_dwordx4 v64, s[12:15], s46 offen  lds
  s_add_u32 m0, s51, 20480
  s_add_u32 s46, s62, 393472
  buffer_load_dwordx4 v64, s[12:15], s46 offen  lds
  ds_read_b64_tr_b16 a[240:241], v65 offset:24576
  ds_read_b64_tr_b16 a[242:243], v65 offset:25600
  ds_read_b64_tr_b16 a[244:245], v65 offset:28672
  ds_read_b64_tr_b16 a[246:247], v65 offset:29696
  ds_read_b64_tr_b16 a[248:249], v65 offset:32768
  ds_read_b64_tr_b16 a[250:251], v65 offset:33792
  ds_read_b64_tr_b16 a[252:253], v65 offset:36864
  ds_read_b64_tr_b16 a[254:255], v65 offset:37888
  ds_read_b64_tr_b16 v[152:153], v65 offset:40960
  ds_read_b64_tr_b16 v[154:155], v65 offset:41984
  ds_read_b64_tr_b16 v[156:157], v65 offset:45056
  ds_read_b64_tr_b16 v[158:159], v65 offset:46080
  s_waitcnt lgkmcnt(0)
  s_waitcnt vmcnt(25)
  s_barrier
  s_add_u32 m0, s51, 24576
  s_add_u32 s46, s62, 3932160
  buffer_load_dwordx4 v64, s[12:15], s46 offen  lds
  s_add_u32 m0, s51, 28672
  s_add_u32 s46, s62, 4325376
  buffer_load_dwordx4 v64, s[12:15], s46 offen  lds
  s_add_u32 m0, s51, 32768
  s_add_u32 s46, s62, 3932288
  buffer_load_dwordx4 v64, s[12:15], s46 offen  lds
  s_add_u32 m0, s51, 36864
  s_add_u32 s46, s62, 4325504
  buffer_load_dwordx4 v64, s[12:15], s46 offen  lds
  s_add_u32 m0, s51, 40960
  s_add_u32 s46, s62, 3932416
  buffer_load_dwordx4 v64, s[12:15], s46 offen  lds
  s_add_u32 m0, s51, 45056
  s_add_u32 s46, s62, 4325632
  buffer_load_dwordx4 v64, s[12:15], s46 offen  lds
  ds_read_b64_tr_b16 v[160:161], v65 offset:49152
  ds_read_b64_tr_b16 v[162:163], v65 offset:50176
  ds_read_b64_tr_b16 v[164:165], v65 offset:53248
  ds_read_b64_tr_b16 v[166:167], v65 offset:54272
  ds_read_b64_tr_b16 v[168:169], v65 offset:57344
  ds_read_b64_tr_b16 v[170:171], v65 offset:58368
  ds_read_b64_tr_b16 v[172:173], v65 offset:61440
  ds_read_b64_tr_b16 v[174:175], v65 offset:62464
  ds_read_b64_tr_b16 v[176:177], v66 offset:0
  ds_read_b64_tr_b16 v[178:179], v66 offset:1024
  ds_read_b64_tr_b16 v[180:181], v66 offset:4096
  ds_read_b64_tr_b16 v[182:183], v66 offset:5120
  s_waitcnt lgkmcnt(0)
  s_waitcnt vmcnt(25)
  s_barrier
  s_add_u32 m0, s51, 49152
  s_add_u32 s46, s62, 2359296
  buffer_load_dwordx4 v64, s[4:7], s46 offen  lds
  s_add_u32 m0, s51, 53248
  s_add_u32 s46, s62, 2752512
  buffer_load_dwordx4 v64, s[4:7], s46 offen  lds
  s_add_u32 m0, s51, 57344
  s_add_u32 s46, s62, 2359424
  buffer_load_dwordx4 v64, s[4:7], s46 offen  lds
  s_add_u32 m0, s51, 61440
  s_add_u32 s46, s62, 2752640
  buffer_load_dwordx4 v64, s[4:7], s46 offen  lds
  s_add_u32 m0, s51, 65536
  s_add_u32 s46, s62, 2359552
  buffer_load_dwordx4 v64, s[4:7], s46 offen  lds
  s_add_u32 m0, s51, 69632
  s_add_u32 s46, s62, 2752768
  buffer_load_dwordx4 v64, s[4:7], s46 offen  lds
  ds_read_b64_tr_b16 v[184:185], v66 offset:8192
  ds_read_b64_tr_b16 v[186:187], v66 offset:9216
  ds_read_b64_tr_b16 v[188:189], v66 offset:12288
  ds_read_b64_tr_b16 v[190:191], v66 offset:13312
  ds_read_b64_tr_b16 v[192:193], v66 offset:16384
  ds_read_b64_tr_b16 v[194:195], v66 offset:17408
  ds_read_b64_tr_b16 v[196:197], v66 offset:20480
  ds_read_b64_tr_b16 v[198:199], v66 offset:21504
  ds_read_b64_tr_b16 v[200:201], v66 offset:24576
  ds_read_b64_tr_b16 v[202:203], v66 offset:25600
  ds_read_b64_tr_b16 v[204:205], v66 offset:28672
  ds_read_b64_tr_b16 v[206:207], v66 offset:29696
  s_waitcnt lgkmcnt(0)
  s_waitcnt vmcnt(25)
  s_barrier
  s_add_u32 m0, s51, 73728
  s_add_u32 s46, s62, 4718592
  buffer_load_dwordx4 v64, s[4:7], s46 offen  lds
  s_add_u32 m0, s51, 77824
  s_add_u32 s46, s62, 5111808
  buffer_load_dwordx4 v64, s[4:7], s46 offen  lds
  s_add_u32 m0, s51, 81920
  s_add_u32 s46, s62, 4718720
  buffer_load_dwordx4 v64, s[4:7], s46 offen  lds
  s_add_u32 m0, s51, 86016
  s_add_u32 s46, s62, 5111936
  buffer_load_dwordx4 v64, s[4:7], s46 offen  lds
  s_add_u32 m0, s51, 90112
  s_add_u32 s46, s62, 4718848
  buffer_load_dwordx4 v64, s[4:7], s46 offen  lds
  s_add_u32 m0, s51, 94208
  s_add_u32 s46, s62, 5112064
  buffer_load_dwordx4 v64, s[4:7], s46 offen  lds
  ds_read_b64_tr_b16 v[208:209], v66 offset:32768
  ds_read_b64_tr_b16 v[210:211], v66 offset:33792
  ds_read_b64_tr_b16 v[212:213], v66 offset:36864
  ds_read_b64_tr_b16 v[214:215], v66 offset:37888
  ds_read_b64_tr_b16 v[216:217], v66 offset:40960
  ds_read_b64_tr_b16 v[218:219], v66 offset:41984
  ds_read_b64_tr_b16 v[220:221], v66 offset:45056
  ds_read_b64_tr_b16 v[222:223], v66 offset:46080
  ds_read_b64_tr_b16 v[224:225], v66 offset:49152
  ds_read_b64_tr_b16 v[226:227], v66 offset:50176
  ds_read_b64_tr_b16 v[228:229], v66 offset:53248
  ds_read_b64_tr_b16 v[230:231], v66 offset:54272
  s_waitcnt lgkmcnt(0)
  s_waitcnt vmcnt(24)
  s_barrier
  s_add_u32 m0, s51, 98304
  s_add_u32 s46, s62, 7077888
  buffer_load_dwordx4 v64, s[4:7], s46 offen  lds
  s_add_u32 m0, s51, 102400
  s_add_u32 s46, s62, 7471104
  buffer_load_dwordx4 v64, s[4:7], s46 offen  lds
  s_add_u32 m0, s51, 106496
  s_add_u32 s46, s62, 7078016
  buffer_load_dwordx4 v64, s[4:7], s46 offen  lds
  s_add_u32 m0, s51, 110592
  s_add_u32 s46, s62, 7471232
  buffer_load_dwordx4 v64, s[4:7], s46 offen  lds
  s_add_u32 m0, s51, 114688
  s_add_u32 s46, s62, 7078144
  buffer_load_dwordx4 v64, s[4:7], s46 offen  lds
  s_add_u32 m0, s51, 118784
  s_add_u32 s46, s62, 7471360
  buffer_load_dwordx4 v64, s[4:7], s46 offen  lds
  ds_read_b64_tr_b16 v[232:233], v66 offset:57344
  ds_read_b64_tr_b16 v[234:235], v66 offset:58368
  ds_read_b64_tr_b16 v[236:237], v66 offset:61440
  ds_read_b64_tr_b16 v[238:239], v66 offset:62464
  ds_read_b64_tr_b16 v[240:241], v67 offset:0
  ds_read_b64_tr_b16 v[242:243], v67 offset:1024
  ds_read_b64_tr_b16 v[244:245], v67 offset:4096
  ds_read_b64_tr_b16 v[246:247], v67 offset:5120
  ds_read_b64_tr_b16 v[248:249], v67 offset:8192
  ds_read_b64_tr_b16 v[250:251], v67 offset:9216
  ds_read_b64_tr_b16 v[252:253], v67 offset:12288
  ds_read_b64_tr_b16 v[254:255], v67 offset:13312
  s_waitcnt lgkmcnt(0)
  s_mov_b32 s50, 0
  s_branch ss_17_in
ss_17:
  v_and_b32 v137, 3, v0
  v_lshlrev_b32 v137, 2, v137
  global_load_dword v136, v137, s[38:39] sc1
  s_add_u32 s50, s50, 1
  s_cmp_gt_u32 s50, 131072
  s_cbranch_scc1 L_fail
  s_waitcnt vmcnt(0)
ss_17_in:
  v_readlane_b32 s46, v136, 0
  v_readlane_b32 s47, v136, 2
  v_readlane_b32 s48, v136, 1
  s_nop 0
  s_min_u32 s47, s47, s48
  s_cmp_lg_u32 s46, 0
  s_cselect_b32 s48, 7, 0
  s_add_u32 s46, s46, s2
  s_xor_b32 s49, s46, s43
  s_and_b32 s49, s49, s48
  s_cbranch_scc1 L_reroll
  s_cmp_lg_u32 s47, 0
  s_cbranch_scc1 ss_ok_18
  s_sleep 6
  s_branch ss_17
ss_ok_18:
  v_readlane_b32 s3, v136, 1
  s_nop 0
  s_and_b32 s3, s3, 0x2000
  s_lshr_b32 s46, s44, 4
  s_lshl_b32 s46, s46, 7
  s_lshl_b32 s47, s43, 4
  s_add_u32 s46, s46, s47
  s_and_b32 s47, s44, 15
  s_add_u32 s46, s46, s47
  s_lshl_b32 s46, s46, 7
  s_add_u32 s46, s46, s3
  s_add_u32 s46, s46, 13369344
  s_add_u32 s40, s8, s46
  s_addc_u32 s41, s9, 0
  s_sub_u32 s47, s44, 0
  s_lshl_b32 s46, s47, 11
  s_lshl_b32 s48, s43, 2
  s_add_u32 s46, s46, s48
  s_add_u32 s46, s46, s3
  s_add_u32 s46, s46, 13385728
  v_lshl_add_u32 v11, v0, 7, s46
  v_mov_b32 v136, 2146435072
  s_cmp_lt_u32 s47, 4
  s_cselect_b32 vcc_lo, 1023, 0
  s_mov_b32 vcc_hi, 0
  v_cndmask_b32 v11, v136, v11, vcc
  v_mov_b32 v7, 0x44444444
  v_mov_b32 v136, 0xeeeeeeee
  v_and_b32 v137, 2, v0
  v_cmp_ne_u32 vcc, 0, v137
  s_nop 1
  v_cndmask_b32 v7, v7, v136, vcc
  s_mov_b32 s68, 1037384597
  s_mov_b32 s70, 3494803967
  v_and_b32 v136, 15, v0
  v_lshrrev_b32 v138, 4, v0
  v_lshlrev_b32 v4, 4, v136
  v_lshl_add_u32 v4, v138, 2, v4
  s_lshl_b32 s46, s42, 8
  s_add_u32 s46, s46, 147456
  v_add_u32 v4, s46, v4
  v_lshlrev_b32 v5, 7, v138
  v_bfe_u32 v137, v0, 2, 2
  v_lshl_add_u32 v5, v137, 4, v5
  v_and_b32 v137, 1, v0
  v_lshl_add_u32 v5, v137, 3, v5
  v_add_u32 v5, 147456, v5
  v_add_u32 v13, 122880, v1
  v_add_u32 v149, 153600, v1
  v_bfe_u32 v140, v0, 1, 2
  v_lshl_add_u32 v140, v140, 2, v137
  v_bfe_u32 v137, v0, 3, 1
  v_lshl_add_u32 v140, v137, 1, v140
  v_cmp_eq_u32 s[18:19], 1, v137
  s_add_u32 s46, s3, 12582912
  s_lshr_b32 s47, s45, 4
  s_add_u32 s47, s47, 1
  s_lshl_b32 s47, s47, 14
  s_and_b32 s48, s45, 15
  s_lshl_b32 s48, s48, 9
  s_add_u32 s47, s47, s48
  s_add_u32 s47, s47, s46
  v_lshrrev_b32 v137, 1, v138
  v_and_b32 v139, 1, v138
  v_lshl_add_u32 v8, v137, 4, v140
  v_lshlrev_b32 v8, 4, v8
  v_lshl_add_u32 v8, v139, 3, v8
  v_add_u32 v8, s47, v8
  s_lshl_b32 s47, s45, 7
  s_and_b32 s48, s45, 1
  s_mul_i32 s48, s48, 120
  s_sub_u32 s47, s47, s48
  s_add_u32 s47, s47, s46
  s_add_u32 s47, s47, 51200
  v_lshlrev_b32 v9, 4, v140
  v_lshl_add_u32 v9, v139, 2, v9
  v_add_u32 v9, s47, v9
  v_lshl_add_u32 v9, v137, 30, v9
  v_lshlrev_b32 v14, 4, v136
  v_lshl_add_u32 v14, v139, 3, v14
  v_lshl_add_u32 v14, v137, 2, v14
  s_lshl_b32 s47, s45, 8
  s_add_u32 s47, s47, 65536
  v_add_u32 v14, s47, v14
  s_lshl_b32 s47, s42, 4
  v_add_u32 v136, s47, v136
  v_lshlrev_b32 v138, 2, v138
  v_sub_u32 v136, v136, v138
  v_cmp_gt_i32 s[72:73], 0, v136
  v_cmp_gt_i32 s[74:75], 1, v136
  v_cmp_gt_i32 s[76:77], 2, v136
  v_cmp_gt_i32 s[78:79], 3, v136
  v_cmp_gt_i32 s[80:81], 16, v136
  v_cmp_gt_i32 s[82:83], 17, v136
  v_cmp_gt_i32 s[84:85], 18, v136
  v_cmp_gt_i32 s[86:87], 19, v136
  s_lshl_b32 s46, s45, 7
  s_lshl_b32 s47, s42, 2
  s_add_u32 s47, s47, s46
  s_add_u32 s47, s47, 1069056
  v_mov_b32 v15, s47
  s_cmp_lg_u32 s42, 2
  s_cbranch_scc1 sc_fl
  v_and_b32 v15, 1, v0
  v_lshlrev_b32 v15, 12, v15
  s_add_u32 s46, s46, 1048576
  v_add_u32 v15, s46, v15
sc_fl:
  s_mov_b32 s23, s45
  s_lshl_b32 s20, s42, 24
  s_add_u32 s20, s20, s3
  s_add_u32 s20, s20, 31457280
  s_xor_b32 s20, s20, 0
  s_lshl_b32 s26, s42, 11
  s_lshl_b32 s46, s42, 24
  s_sub_u32 s26, s26, s46
  s_cmp_eq_u32 s42, 2
  s_cselect_b32 s26, 2012217344, s26
  s_lshl_b32 s21, s42, 12
  s_add_u32 s21, s21, 122880
  s_mov_b32 s22, 12288
  s_mul_i32 s64, s42, 81920
  s_add_u32 s64, s64, s3
  s_add_u32 s64, s64, 14680064
  s_lshr_b32 s27, s45, 3
  s_lshl_b32 s27, s27, 14
  s_and_b32 s46, s45, 7
  s_lshl_b32 s46, s46, 10
  s_add_u32 s27, s27, s46
  s_mov_b32 s61, 0
  s_mov_b32 s52, 0
  s_mov_b32 s58, 0
  v_mov_b32 v150, -1
  v_mov_b32 v151, -1
  s_mov_b32 s65, 524288
  s_mov_b32 s100, 0
  s_add_u32 s46, s42, 3
  s_lshl_b32 s31, s46, 10
  s_cmp_ge_u32 s46, 8
  s_cselect_b32 s47, 40960, 0
  s_add_u32 s31, s31, s47
  s_cmp_ge_u32 s46, 10
  s_cselect_b32 s31, 2146435072, s31
  s_add_u32 s46, s42, 7
  s_lshl_b32 s32, s46, 10
  s_cmp_ge_u32 s46, 8
  s_cselect_b32 s47, 40960, 0
  s_add_u32 s32, s32, s47
  s_cmp_ge_u32 s46, 10
  s_cselect_b32 s32, 2146435072, s32
  s_waitcnt vmcnt(24)
  s_barrier
  ds_read_b64_tr_b16 v[40:41], v65 offset:0
  ds_read_b64_tr_b16 v[42:43], v65 offset:1024
  ds_read_b64_tr_b16 v[44:45], v65 offset:4096
  ds_read_b64_tr_b16 v[46:47], v65 offset:5120
  ds_read_b64_tr_b16 v[48:49], v65 offset:8192
  ds_read_b64_tr_b16 v[50:51], v65 offset:9216
  ds_read_b64_tr_b16 v[52:53], v65 offset:12288
  ds_read_b64_tr_b16 v[54:55], v65 offset:13312
  ds_read_b64_tr_b16 v[56:57], v65 offset:16384
  ds_read_b64_tr_b16 v[58:59], v65 offset:17408
  ds_read_b64_tr_b16 v[60:61], v65 offset:20480
  ds_read_b64_tr_b16 v[62:63], v65 offset:21504
  s_waitcnt lgkmcnt(0)
  s_waitcnt vmcnt(18)
  s_barrier
  ds_write_b128 v2, v[40:43] offset:0
  ds_write_b128 v2, v[44:47] offset:4096
  ds_write_b128 v2, v[48:51] offset:8192
  ds_write_b128 v2, v[52:55] offset:12288
  ds_write_b128 v2, v[56:59] offset:16384
  ds_write_b128 v2, v[60:63] offset:20480
  ds_read_b64_tr_b16 v[16:17], v65 offset:24576
  ds_read_b64_tr_b16 v[18:19], v65 offset:25600
  ds_read_b64_tr_b16 v[20:21], v65 offset:28672
  ds_read_b64_tr_b16 v[22:23], v65 offset:29696
  ds_read_b64_tr_b16 v[24:25], v65 offset:32768
  ds_read_b64_tr_b16 v[26:27], v65 offset:33792
  ds_read_b64_tr_b16 v[28:29], v65 offset:36864
  ds_read_b64_tr_b16 v[30:31], v65 offset:37888
  ds_read_b64_tr_b16 v[32:33], v65 offset:40960
  ds_read_b64_tr_b16 v[34:35], v65 offset:41984
  ds_read_b64_tr_b16 v[36:37], v65 offset:45056
  ds_read_b64_tr_b16 v[38:39], v65 offset:46080
  s_waitcnt lgkmcnt(0)
  s_waitcnt vmcnt(12)
  s_barrier
  ds_write_b128 v2, v[16:19] offset:24576
  ds_write_b128 v2, v[20:23] offset:28672
  ds_write_b128 v2, v[24:27] offset:32768
  ds_write_b128 v2, v[28:31] offset:36864
  ds_write_b128 v2, v[32:35] offset:40960
  ds_write_b128 v2, v[36:39] offset:45056
  ds_read_b64_tr_b16 v[40:41], v65 offset:49152
  ds_read_b64_tr_b16 v[42:43], v65 offset:50176
  ds_read_b64_tr_b16 v[44:45], v65 offset:53248
  ds_read_b64_tr_b16 v[46:47], v65 offset:54272
  ds_read_b64_tr_b16 v[48:49], v65 offset:57344
  ds_read_b64_tr_b16 v[50:51], v65 offset:58368
  ds_read_b64_tr_b16 v[52:53], v65 offset:61440
  ds_read_b64_tr_b16 v[54:55], v65 offset:62464
  ds_read_b64_tr_b16 v[56:57], v66 offset:0
  ds_read_b64_tr_b16 v[58:59], v66 offset:1024
  ds_read_b64_tr_b16 v[60:61], v66 offset:4096
  ds_read_b64_tr_b16 v[62:63], v66 offset:5120
  s_waitcnt lgkmcnt(0)
  s_waitcnt vmcnt(6)
  s_barrier
  ds_write_b128 v2, v[40:43] offset:49152
  ds_write_b128 v2, v[44:47] offset:53248
  ds_write_b128 v2, v[48:51] offset:57344
  ds_write_b128 v2, v[52:55] offset:61440
  ds_write_b128 v3, v[56:59] offset:0
  ds_write_b128 v3, v[60:63] offset:4096
  ds_read_b64_tr_b16 v[16:17], v66 offset:8192
  ds_read_b64_tr_b16 v[18:19], v66 offset:9216
  ds_read_b64_tr_b16 v[20:21], v66 offset:12288
  ds_read_b64_tr_b16 v[22:23], v66 offset:13312
  ds_read_b64_tr_b16 v[24:25], v66 offset:16384
  ds_read_b64_tr_b16 v[26:27], v66 offset:17408
  ds_read_b64_tr_b16 v[28:29], v66 offset:20480
  ds_read_b64_tr_b16 v[30:31], v66 offset:21504
  ds_read_b64_tr_b16 v[32:33], v66 offset:24576
  ds_read_b64_tr_b16 v[34:35], v66 offset:25600
  ds_read_b64_tr_b16 v[36:37], v66 offset:28672
  ds_read_b64_tr_b16 v[38:39], v66 offset:29696
  s_waitcnt lgkmcnt(0)
  s_waitcnt vmcnt(0)
  s_barrier
  ds_write_b128 v3, v[16:19] offset:8192
  ds_write_b128 v3, v[20:23] offset:12288
  ds_write_b128 v3, v[24:27] offset:16384
  ds_write_b128 v3, v[28:31] offset:20480
  ds_write_b128 v3, v[32:35] offset:24576
  ds_write_b128 v3, v[36:39] offset:28672
  ds_read_b64_tr_b16 v[40:41], v66 offset:32768
  ds_read_b64_tr_b16 v[42:43], v66 offset:33792
  ds_read_b64_tr_b16 v[44:45], v66 offset:36864
  ds_read_b64_tr_b16 v[46:47], v66 offset:37888
  ds_read_b64_tr_b16 v[48:49], v66 offset:40960
  ds_read_b64_tr_b16 v[50:51], v66 offset:41984
  ds_read_b64_tr_b16 v[52:53], v66 offset:45056
  ds_read_b64_tr_b16 v[54:55], v66 offset:46080
  ds_read_b64_tr_b16 v[56:57], v66 offset:49152
  ds_read_b64_tr_b16 v[58:59], v66 offset:50176
  ds_read_b64_tr_b16 v[60:61], v66 offset:53248
  ds_read_b64_tr_b16 v[62:63], v66 offset:54272
  s_waitcnt lgkmcnt(0)
  s_barrier
  ds_write_b128 v3, v[40:43] offset:32768
  ds_write_b128 v3, v[44:47] offset:36864
  ds_write_b128 v3, v[48:51] offset:40960
  ds_write_b128 v3, v[52:55] offset:45056
  ds_write_b128 v3, v[56:59] offset:49152
  ds_write_b128 v3, v[60:63] offset:53248
  s_waitcnt lgkmcnt(0)
  s_cmp_lg_u32 s42, 2
  s_cbranch_scc1 sc_k0
  s_mov_b32 s53, 1
  s_cmp_ge_u32 s61, s53
  s_cbranch_scc1 wf_done_19
  s_mov_b32 s50, 0
wf_loop_20:
  buffer_load_dword v136, v15, s[8:11], 0 offen sc1
  s_add_u32 s50, s50, 1
  s_cmp_gt_u32 s50, 131072
  s_cbranch_scc1 L_fail
  s_waitcnt vmcnt(0)
  v_lshrrev_b32 v137, 6, v136
  v_not_b32 v138, v0
  v_or_b32 v137, v137, v138
  v_and_b32 v137, 1, v137
  v_add_u32 v136, v136, v137
  s_nop 1
  v_min_u32_dpp v136, v136, v136 row_ror:8 row_mask:0xf bank_mask:0xf
  s_nop 1
  v_min_u32_dpp v136, v136, v136 row_ror:4 row_mask:0xf bank_mask:0xf
  s_nop 1
  v_min_u32_dpp v136, v136, v136 row_ror:2 row_mask:0xf bank_mask:0xf
  s_nop 1
  v_min_u32_dpp v136, v136, v136 row_ror:1 row_mask:0xf bank_mask:0xf
  v_mov_b32 v137, v136
  s_nop 1
  v_permlane16_swap_b32 v137, v136
  v_min_u32 v136, v136, v137
  v_mov_b32 v137, v136
  s_nop 1
  v_permlane32_swap_b32 v137, v136
  v_min_u32 v136, v136, v137
  s_nop 0
  v_readfirstlane_b32 s61, v136
  s_nop 0
  s_cmp_ge_u32 s61, s53
  s_cbranch_scc1 wf_done_19
  s_sleep 2
  s_branch wf_loop_20
wf_done_19:
sc_k0:
  s_barrier
  s_cmp_eq_u32 s42, 3
  s_cbranch_scc1 scs_loop
  s_mov_b32 m0, s21
  s_lshr_b32 s63, s23, 1
  s_lshl_b32 s63, s63, 14
  s_and_b32 s46, s23, 1
  s_lshl_b32 s46, s46, 12
  s_add_u32 s63, s63, s46
  s_add_u32 s63, s63, s20
  s_lshr_b32 s46, s63, 8
  s_and_b32 s46, s46, 0x2000
  s_xor_b32 s63, s63, s46
  buffer_load_dwordx4 v1, s[8:11], s63 offen offset:0 sc1 lds
  buffer_load_dwordx4 v1, s[8:11], s63 offen offset:1024 sc1 lds
  buffer_load_dwordx4 v1, s[8:11], s63 offen offset:2048 sc1 lds
  buffer_load_dwordx4 v1, s[8:11], s63 offen offset:3072 sc1 lds
  s_waitcnt vmcnt(0)
  s_branch sch_loop
scs_loop:
  s_add_u32 s53, s52, 1
  s_lshl_b32 s56, s58, 2
  s_add_u32 s56, s56, s43
  s_lshl_b32 s56, s56, 16
  s_add_u32 s56, s56, s3
  s_add_u32 s56, s56, 12582912
  v_add_u32 v12, s56, v1
  s_lshl_b32 s66, s58, 18
  s_mov_b64 s[16:17], -1
  s_mov_b32 s71, 0
  ds_read_b128 v[56:59], v2 offset:0
  ds_read_b128 v[60:63], v2 offset:4096
  ds_read_b128 v[64:67], v2 offset:8192
  ds_read_b128 v[68:71], v2 offset:12288
  ds_read_b128 v[72:75], v2 offset:16384
  ds_read_b128 v[76:79], v2 offset:20480
  ds_read_b128 v[80:83], v2 offset:49152
  ds_read_b128 v[84:87], v2 offset:53248
  v_mov_b32 v88, 0
  v_mov_b32 v89, 0
  v_mov_b32 v90, 0
  v_mov_b32 v91, 0
  v_mov_b32 v92, 0
  v_mov_b32 v93, 0
  v_mov_b32 v94, 0
  v_mov_b32 v95, 0
  v_mov_b32 v96, 0
  v_mov_b32 v97, 0
  v_mov_b32 v98, 0
  v_mov_b32 v99, 0
  v_mov_b32 v100, 0
  v_mov_b32 v101, 0
  v_mov_b32 v102, 0
  v_mov_b32 v103, 0
  v_mov_b32 v104, 0
  v_mov_b32 v105, 0
  v_mov_b32 v106, 0
  v_mov_b32 v107, 0
  v_mov_b32 v108, 0
  v_mov_b32 v109, 0
  v_mov_b32 v110, 0
  v_mov_b32 v111, 0
  v_mov_b32 v6, s53
  s_waitcnt lgkmcnt(0)
  s_mov_b32 s50, 0
scs_top:
  s_barrier
  buffer_load_dwordx4 v[16:19], v12, s[8:11], 0 offen offset:0 sc1
  s_add_u32 m0, s51, 153600
  s_barrier
  buffer_load_dwordx4 v[20:23], v12, s[8:11], 0 offen offset:1024 sc1
  s_barrier
  buffer_load_dwordx4 v[24:27], v12, s[8:11], 0 offen offset:2048 sc1
  s_barrier
  buffer_load_dwordx4 v12, s[8:11], s31 offen sc1 lds
  s_add_u32 m0, s51, 157696
  s_barrier
  buffer_load_dwordx4 v12, s[8:11], s32 offen sc1 lds
  s_waitcnt vmcnt(4)
scs_go:
  v_smfmac_f32_16x16x64_bf16 v[88:91], v[16:19], a[192:199], v7
  v_smfmac_f32_16x16x64_bf16 v[92:95], v[16:19], a[200:207], v7
  v_smfmac_f32_16x16x64_bf16 v[96:99], v[16:19], a[208:215], v7
  v_smfmac_f32_16x16x64_bf16 v[100:103], v[16:19], v[56:63], v7
  v_smfmac_f32_16x16x64_bf16 v[104:107], v[16:19], v[64:71], v7
  ds_read_b128 v[56:59], v2 offset:57344
  v_smfmac_f32_16x16x64_bf16 v[108:111], v[16:19], v[72:79], v7
  s_waitcnt vmcnt(3)
  ds_read_b128 v[60:63], v2 offset:61440
  v_smfmac_f32_16x16x64_bf16 v[88:91], v[20:23], a[216:223], v7
  ds_read_b128 v[64:67], v3 offset:0
  v_smfmac_f32_16x16x64_bf16 v[92:95], v[20:23], a[224:231], v7
  ds_read_b128 v[68:71], v3 offset:4096
  v_smfmac_f32_16x16x64_bf16 v[96:99], v[20:23], a[232:239], v7
  s_waitcnt vmcnt(2)
  v_max3_u32 v136, v16, v20, v24
  v_smfmac_f32_16x16x64_bf16 v[100:103], v[20:23], a[0:7], v7
  ds_read_b128 v[72:75], v3 offset:8192
  v_cmp_eq_u32 vcc, -1, v136
  v_smfmac_f32_16x16x64_bf16 v[104:107], v[20:23], a[8:15], v7
  ds_read_b128 v[76:79], v3 offset:12288
  v_smfmac_f32_16x16x64_bf16 v[108:111], v[20:23], a[16:23], v7
  s_cbranch_vccnz scs_ha
  v_smfmac_f32_16x16x64_bf16 v[88:91], v[24:27], a[240:247], v7
  s_waitcnt vmcnt(1)
  s_barrier
  ds_read_b128 v[28:31], v149 offset:0
  v_smfmac_f32_16x16x64_bf16 v[92:95], v[24:27], a[248:255], v7
  ds_read_b128 v[32:35], v149 offset:1024
  v_smfmac_f32_16x16x64_bf16 v[96:99], v[24:27], v[152:159], v7
  ds_read_b128 v[36:39], v149 offset:2048
  v_smfmac_f32_16x16x64_bf16 v[100:103], v[24:27], a[24:31], v7
  ds_read_b128 v[40:43], v149 offset:3072
  v_smfmac_f32_16x16x64_bf16 v[104:107], v[24:27], a[32:39], v7
  v_smfmac_f32_16x16x64_bf16 v[108:111], v[24:27], a[40:47], v7
  s_waitcnt vmcnt(0)
  s_barrier
  s_waitcnt lgkmcnt(3)
  v_smfmac_f32_16x16x64_bf16 v[88:91], v[28:31], v[80:87], v7
  ds_read_b128 v[44:47], v149 offset:4096
  v_smfmac_f32_16x16x64_bf16 v[92:95], v[28:31], v[56:63], v7
  ds_read_b128 v[48:51], v149 offset:5120
  v_smfmac_f32_16x16x64_bf16 v[96:99], v[28:31], v[64:71], v7
  ds_read_b128 v[52:55], v149 offset:6144
  s_waitcnt lgkmcnt(3)
  v_smfmac_f32_16x16x64_bf16 v[88:91], v[32:35], v[160:167], v7
  ds_read_b128 v[80:83], v3 offset:32768
  ds_read_b128 v[16:19], v13 offset:8192
  v_smfmac_f32_16x16x64_bf16 v[92:95], v[32:35], v[168:175], v7
  ds_read_b128 v[84:87], v3 offset:36864
  ds_read_b128 v[20:23], v13 offset:10240
  v_smfmac_f32_16x16x64_bf16 v[96:99], v[32:35], v[176:183], v7
  ds_read_b128 v[56:59], v3 offset:16384
  ds_read_b128 v[24:27], v13 offset:9216
  v_smfmac_f32_16x16x64_bf16 v[88:91], v[36:39], v[184:191], v7
  s_waitcnt lgkmcnt(6)
  v_max3_u32 v136, v28, v32, v36
  v_smfmac_f32_16x16x64_bf16 v[92:95], v[36:39], v[192:199], v7
  ds_read_b128 v[60:63], v3 offset:20480
  v_max3_u32 v136, v136, v40, v44
  v_smfmac_f32_16x16x64_bf16 v[96:99], v[36:39], v[200:207], v7
  ds_read_b128 v[64:67], v3 offset:40960
  v_max3_u32 v136, v136, v48, v52
  v_smfmac_f32_16x16x64_bf16 v[88:91], v[44:47], v[208:215], v7
  ds_read_b128 v[68:71], v3 offset:45056
  v_cmp_eq_u32 vcc, -1, v136
  v_smfmac_f32_16x16x64_bf16 v[88:91], v[48:51], v[232:239], v7
  v_smfmac_f32_16x16x64_bf16 v[88:91], v[40:43], v[72:79], v7
  s_cbranch_vccnz scs_hb
  s_waitcnt lgkmcnt(3)
  v_smfmac_f32_16x16x64_bf16 v[88:91], v[52:55], v[80:87], v7
  ds_read_b128 v[72:75], v3 offset:24576
scs_join:
  v_smfmac_f32_16x16x64_bf16 v[92:95], v[44:47], v[216:223], v7
  ds_read_b128 v[76:79], v3 offset:28672
  buffer_store_dwordx2 v[150:151], v8, s[8:11], s65 offen sc1
  v_smfmac_f32_16x16x64_bf16 v[92:95], v[48:51], v[240:247], v7
  ds_read_b128 v[80:83], v3 offset:49152
  s_waitcnt lgkmcnt(3)
  v_add_f32 v88, v88, v90
  v_smfmac_f32_16x16x64_bf16 v[92:95], v[40:43], v[56:63], v7
  ds_read_b128 v[84:87], v3 offset:53248
  v_add_f32 v89, v89, v91
  v_smfmac_f32_16x16x64_bf16 v[92:95], v[52:55], v[64:71], v7
  ds_read_b128 v[56:59], v2 offset:24576
  v_cmp_u_f32 vcc, v88, v89
  v_smfmac_f32_16x16x64_bf16 v[96:99], v[44:47], v[224:231], v7
  ds_read_b128 v[60:63], v2 offset:28672
  buffer_store_dword v150, v9, s[8:11], s65 offen sc1
  v_cvt_pk_bf16_f32 v136, v88, v89
  v_smfmac_f32_16x16x64_bf16 v[96:99], v[48:51], v[248:255], v7
  s_and_b64 vcc, vcc, s[16:17]
  s_cbranch_scc1 scs_redo
  s_waitcnt lgkmcnt(4)
  v_add_f32 v92, v92, v94
  v_smfmac_f32_16x16x64_bf16 v[96:99], v[40:43], v[72:79], v7
  ds_read_b128 v[64:67], v2 offset:32768
  s_waitcnt lgkmcnt(3)
  v_add_f32 v93, v93, v95
  v_smfmac_f32_16x16x64_bf16 v[96:99], v[52:55], v[80:87], v7
  ds_read_b128 v[68:71], v2 offset:36864
  v_cvt_pk_bf16_f32 v137, v92, v93
  v_smfmac_f32_16x16x64_bf16 v[100:103], v[28:31], a[48:55], v7
  ds_write2st64_b32 v4, v136, v137 offset0:0 offset1:4
  v_smfmac_f32_16x16x64_bf16 v[100:103], v[32:35], a[72:79], v7
  ds_read_b128 v[72:75], v2 offset:40960
  v_add_f32 v96, v96, v98
  v_smfmac_f32_16x16x64_bf16 v[100:103], v[40:43], a[96:103], v7
  ds_read_b128 v[76:79], v2 offset:45056
  s_waitcnt lgkmcnt(5)
  v_add_f32 v97, v97, v99
  v_smfmac_f32_16x16x64_bf16 v[100:103], v[36:39], v[56:63], v7
  ds_read_b128 v[80:83], v13 offset:5120
  v_cvt_pk_bf16_f32 v138, v96, v97
  v_smfmac_f32_16x16x64_bf16 v[100:103], v[44:47], a[120:127], v7
  ds_write_b32 v4, v138 offset:2048
  v_smfmac_f32_16x16x64_bf16 v[100:103], v[48:51], a[144:151], v7
  ds_read_b128 v[84:87], v13 offset:7168
  ds_read_b128 v[56:59], v13 offset:0
  s_waitcnt lgkmcnt(6)
  v_smfmac_f32_16x16x64_bf16 v[104:107], v[36:39], v[64:71], v7
  ds_read_b128 v[60:63], v13 offset:2048
  s_waitcnt lgkmcnt(5)
  v_smfmac_f32_16x16x64_bf16 v[108:111], v[36:39], v[72:79], v7
  ds_read_b128 v[64:67], v13 offset:1024
  ds_read_b128 v[68:71], v13 offset:3072
  v_smfmac_f32_16x16x64_bf16 v[100:103], v[52:55], a[168:175], v7
  s_waitcnt lgkmcnt(5)
  s_barrier
  v_smfmac_f32_16x16x64_bf16 v[104:107], v[28:31], a[56:63], v7
  ds_read_b64_tr_b16 v[112:113], v5 offset:0
  ds_read_b64_tr_b16 v[114:115], v5 offset:64
  v_smfmac_f32_16x16x64_bf16 v[104:107], v[32:35], a[80:87], v7
  ds_read_b64_tr_b16 v[116:117], v5 offset:512
  ds_read_b64_tr_b16 v[118:119], v5 offset:576
  v_smfmac_f32_16x16x64_bf16 v[104:107], v[40:43], a[104:111], v7
  ds_read_b64_tr_b16 v[120:121], v5 offset:1024
  ds_read_b64_tr_b16 v[122:123], v5 offset:1088
  buffer_store_dword v6, v11, s[8:11], 0 offen sc1
  v_smfmac_f32_16x16x64_bf16 v[104:107], v[44:47], a[128:135], v7
  ds_read_b64_tr_b16 v[124:125], v5 offset:1536
  ds_read_b64_tr_b16 v[126:127], v5 offset:1600
  v_smfmac_f32_16x16x64_bf16 v[104:107], v[48:51], a[152:159], v7
  ds_read_b64_tr_b16 v[128:129], v5 offset:2048
  ds_read_b64_tr_b16 v[130:131], v5 offset:2112
  v_smfmac_f32_16x16x64_bf16 v[104:107], v[52:55], a[176:183], v7
  ds_read_b64_tr_b16 v[132:133], v5 offset:2560
  ds_read_b64_tr_b16 v[134:135], v5 offset:2624
  v_smfmac_f32_16x16x64_bf16 v[108:111], v[28:31], a[64:71], v7
  ds_read_b128 v[72:75], v13 offset:4096
  v_add_f32 v100, v100, v102
  v_smfmac_f32_16x16x64_bf16 v[108:111], v[32:35], a[88:95], v7
  ds_read_b128 v[76:79], v13 offset:6144
  v_add_f32 v101, v101, v103
  v_smfmac_f32_16x16x64_bf16 v[108:111], v[40:43], a[112:119], v7
  ds_read_b128 v[36:39], v13 offset:11264
  v_cvt_pk_bf16_f32 v139, v100, v101
  v_smfmac_f32_16x16x64_bf16 v[108:111], v[44:47], a[136:143], v7
  v_add_f32 v104, v104, v106
  v_smfmac_f32_16x16x64_bf16 v[108:111], v[48:51], a[160:167], v7
  v_add_f32 v105, v105, v107
  v_smfmac_f32_16x16x64_bf16 v[108:111], v[52:55], a[184:191], v7
  s_waitcnt lgkmcnt(2)
  v_cvt_pk_bf16_f32 v140, v104, v105
  v_mfma_f32_16x16x32_bf16 v[88:91], v[56:59], v[112:115], 0
  ds_write2st64_b32 v4, v139, v140 offset0:12 offset1:16
  v_mfma_f32_16x16x32_bf16 v[92:95], v[60:63], v[112:115], 0
  v_add_f32 v108, v108, v110
  v_add_f32 v109, v109, v111
  v_mfma_f32_16x16x32_bf16 v[88:91], v[64:67], v[116:119], v[88:91]
  v_cvt_pk_bf16_f32 v141, v108, v109
  v_mfma_f32_16x16x32_bf16 v[92:95], v[68:71], v[116:119], v[92:95]
  ds_write_b32 v4, v141 offset:5120
  v_mfma_f32_16x16x32_bf16 v[88:91], v[72:75], v[120:123], v[88:91]
  s_waitcnt lgkmcnt(1)
  s_barrier
  v_mfma_f32_16x16x32_bf16 v[92:95], v[76:79], v[120:123], v[92:95]
  ds_read_b64_tr_b16 v[28:29], v5 offset:3072
  ds_read_b64_tr_b16 v[30:31], v5 offset:3136
  v_mfma_f32_16x16x32_bf16 v[88:91], v[80:83], v[124:127], v[88:91]
  ds_read_b64_tr_b16 v[32:33], v5 offset:3584
  ds_read_b64_tr_b16 v[34:35], v5 offset:3648
  v_mfma_f32_16x16x32_bf16 v[92:95], v[84:87], v[124:127], v[92:95]
  s_waitcnt lgkmcnt(4)
  s_barrier
  v_mfma_f32_16x16x32_bf16 v[88:91], v[16:19], v[128:131], v[88:91]
  ds_read_b64_tr_b16 v[40:41], v5 offset:4096
  ds_read_b64_tr_b16 v[42:43], v5 offset:4160
  v_mfma_f32_16x16x32_bf16 v[92:95], v[20:23], v[128:131], v[92:95]
  ds_read_b64_tr_b16 v[44:45], v5 offset:4608
  ds_read_b64_tr_b16 v[46:47], v5 offset:4672
  v_mfma_f32_16x16x32_bf16 v[88:91], v[24:27], v[132:135], v[88:91]
  ds_read_b64_tr_b16 v[48:49], v5 offset:5120
  ds_read_b64_tr_b16 v[50:51], v5 offset:5184
  v_mfma_f32_16x16x32_bf16 v[92:95], v[36:39], v[132:135], v[92:95]
  ds_read_b64_tr_b16 v[52:53], v5 offset:5632
  s_waitcnt lgkmcnt(7)
  v_mfma_f32_16x16x32_bf16 v[96:99], v[28:31], v[112:115], 0
  ds_read_b64_tr_b16 v[54:55], v5 offset:5696
  v_mfma_f32_16x16x32_bf16 v[96:99], v[32:35], v[116:119], v[96:99]
  s_waitcnt lgkmcnt(6)
  v_max3_f32 v142, v88, v89, v90
  v_max3_f32 v142, v142, v91, v92
  v_mfma_f32_16x16x32_bf16 v[96:99], v[40:43], v[120:123], v[96:99]
  s_waitcnt lgkmcnt(4)
  v_max3_f32 v142, v142, v93, v94
  v_max_f32 v142, v142, v95
  v_mfma_f32_16x16x32_bf16 v[96:99], v[44:47], v[124:127], v[96:99]
  s_waitcnt lgkmcnt(2)
  v_mov_b32 v143, v142
  v_cndmask_b32 v136, v88, v90, s[18:19]
  v_mfma_f32_16x16x32_bf16 v[96:99], v[48:51], v[128:131], v[96:99]
  s_waitcnt lgkmcnt(0)
  v_permlane32_swap_b32 v143, v142
  v_mfma_f32_16x16x32_bf16 v[96:99], v[52:55], v[132:135], v[96:99]
  s_barrier
  v_max_f32 v142, v142, v143
  v_cndmask_b32 v137, v89, v91, s[18:19]
  v_cndmask_b32 v138, v92, v94, s[18:19]
  v_cndmask_b32 v139, v93, v95, s[18:19]
  s_nop 2
  v_max3_f32 v142, v142, v96, v97
  v_max3_f32 v142, v142, v98, v99
  v_mov_b32 v143, v142
  v_cndmask_b32 v140, v96, v98, s[18:19]
  v_cndmask_b32 v141, v97, v99, s[18:19]
  v_permlane16_swap_b32 v143, v142
  v_max_f32 v142, v142, v143
  v_mul_f32 v142, s68, v142
  v_pk_fma_f32 v[136:137], v[136:137], s[68:69], v[142:143] op_sel_hi:[1,0,0] neg_lo:[0,0,1] neg_hi:[0,0,1]
  v_pk_fma_f32 v[138:139], v[138:139], s[68:69], v[142:143] op_sel_hi:[1,0,0] neg_lo:[0,0,1] neg_hi:[0,0,1]
  v_pk_fma_f32 v[140:141], v[140:141], s[68:69], v[142:143] op_sel_hi:[1,0,0] neg_lo:[0,0,1] neg_hi:[0,0,1]
  v_exp_f32 v136, v136
  v_exp_f32 v137, v137
  v_exp_f32 v138, v138
  v_exp_f32 v139, v139
  v_exp_f32 v140, v140
  v_pk_add_f32 v[144:145], v[136:137], v[138:139]
  v_add_f32 v142, v144, v145
  v_add_f32 v143, v144, v145
  v_exp_f32 v141, v141
  s_nop 0
  v_permlane32_swap_b32 v143, v142
  v_pk_add_f32 v[142:143], v[142:143], v[140:141]
  v_add_f32 v142, v142, v143
  s_nop 1
  v_add_f32_dpp v142, v142, v142 row_ror:8 row_mask:0xf bank_mask:0xf
  v_mov_b32 v143, v142
  s_nop 1
  v_permlane16_swap_b32 v143, v142
  v_add_f32 v142, v142, v143
  v_rcp_f32 v142, v142
  s_nop 0
  v_pk_mul_f32 v[136:137], v[136:137], v[142:143] op_sel_hi:[1,0]
  v_pk_mul_f32 v[138:139], v[138:139], v[142:143] op_sel_hi:[1,0]
  v_pk_mul_f32 v[140:141], v[140:141], v[142:143] op_sel_hi:[1,0]
  v_cvt_pk_bf16_f32 v146, v136, v137
  v_cvt_pk_bf16_f32 v147, v138, v139
  v_cvt_pk_bf16_f32 v148, v140, v141
  buffer_store_dwordx2 v[146:147], v8, s[8:11], s66 offen sc1
  buffer_store_dword v148, v9, s[8:11], s66 offen sc1
  s_mov_b32 s65, s66
  v_add_u32 v13, s22, v13
  s_sub_u32 s22, 0, s22
  s_add_u32 s58, s58, 1
  s_cmp_eq_u32 s58, 3
  s_cselect_b32 s58, 0, s58
  s_mov_b32 s52, s53
  s_cmp_lt_u32 s52, 64
  s_cbranch_scc1 scs_loop
  s_endpgm
sch_loop:
  s_add_u32 s53, s52, 1
  s_lshl_b32 s56, s58, 2
  s_add_u32 s56, s56, s43
  s_lshl_b32 s56, s56, 16
  s_add_u32 s56, s56, s3
  s_add_u32 s56, s56, 12582912
  v_add_u32 v12, s56, v1
  s_lshl_b32 s66, s58, 18
  s_mov_b64 s[16:17], -1
  s_mov_b32 s71, 0
  ds_read_b128 v[56:59], v2 offset:0
  ds_read_b128 v[60:63], v2 offset:4096
  ds_read_b128 v[64:67], v2 offset:8192
  ds_read_b128 v[68:71], v2 offset:12288
  ds_read_b128 v[72:75], v2 offset:16384
  ds_read_b128 v[76:79], v2 offset:20480
  ds_read_b128 v[80:83], v2 offset:49152
  ds_read_b128 v[84:87], v2 offset:53248
  v_mov_b32 v88, 0
  v_mov_b32 v89, 0
  v_mov_b32 v90, 0
  v_mov_b32 v91, 0
  v_mov_b32 v92, 0
  v_mov_b32 v93, 0
  v_mov_b32 v94, 0
  v_mov_b32 v95, 0
  v_mov_b32 v96, 0
  v_mov_b32 v97, 0
  v_mov_b32 v98, 0
  v_mov_b32 v99, 0
  v_mov_b32 v100, 0
  v_mov_b32 v101, 0
  v_mov_b32 v102, 0
  v_mov_b32 v103, 0
  v_mov_b32 v104, 0
  v_mov_b32 v105, 0
  v_mov_b32 v106, 0
  v_mov_b32 v107, 0
  v_mov_b32 v108, 0
  v_mov_b32 v109, 0
  v_mov_b32 v110, 0
  v_mov_b32 v111, 0
  s_xor_b32 s28, s63, 0x2000
  s_add_u32 s28, s28, s26
  s_add_u32 s29, s28, 16777216
  s_add_u32 s30, s28, 33554432
  s_add_u32 s23, s23, 32
  s_cmp_ge_u32 s23, 1024
  s_cselect_b32 s46, 1024, 0
  s_sub_u32 s23, s23, s46
  s_lshr_b32 s63, s23, 1
  s_lshl_b32 s63, s63, 14
  s_and_b32 s46, s23, 1
  s_lshl_b32 s46, s46, 12
  s_add_u32 s63, s63, s46
  s_add_u32 s63, s63, s20
  s_lshr_b32 s46, s63, 8
  s_and_b32 s46, s46, 0x2000
  s_xor_b32 s63, s63, s46
  s_add_u32 s21, s21, s22
  s_waitcnt vmcnt(0) lgkmcnt(0)
  s_cmp_lg_u32 s42, 2
  s_cbranch_scc1 sc_nobell
  s_add_u32 s49, s52, 2
  s_cmp_ge_u32 s61, s49
  s_cbranch_scc1 wf_done_21
  s_mov_b32 s50, 0
wf_loop_22:
  buffer_load_dword v136, v15, s[8:11], 0 offen sc1
  s_add_u32 s50, s50, 1
  s_cmp_gt_u32 s50, 131072
  s_cbranch_scc1 L_fail
  s_waitcnt vmcnt(0)
  v_lshrrev_b32 v137, 6, v136
  v_not_b32 v138, v0
  v_or_b32 v137, v137, v138
  v_and_b32 v137, 1, v137
  v_add_u32 v136, v136, v137
  s_nop 1
  v_min_u32_dpp v136, v136, v136 row_ror:8 row_mask:0xf bank_mask:0xf
  s_nop 1
  v_min_u32_dpp v136, v136, v136 row_ror:4 row_mask:0xf bank_mask:0xf
  s_nop 1
  v_min_u32_dpp v136, v136, v136 row_ror:2 row_mask:0xf bank_mask:0xf
  s_nop 1
  v_min_u32_dpp v136, v136, v136 row_ror:1 row_mask:0xf bank_mask:0xf
  v_mov_b32 v137, v136
  s_nop 1
  v_permlane16_swap_b32 v137, v136
  v_min_u32 v136, v136, v137
  v_mov_b32 v137, v136
  s_nop 1
  v_permlane32_swap_b32 v137, v136
  v_min_u32 v136, v136, v137
  s_nop 0
  v_readfirstlane_b32 s61, v136
  s_nop 0
  s_cmp_ge_u32 s61, s49
  s_cbranch_scc1 wf_done_21
  s_sleep 2
  s_branch wf_loop_22
wf_done_21:
  s_mov_b32 s50, 0
  s_waitcnt lgkmcnt(0)
  s_mov_b64 s[80:81], 0
  s_mov_b64 s[82:83], 0
  s_cmp_eq_u32 s53, 1
  s_cbranch_scc1 bell_x_24
bell_23:
  s_load_dwordx4 s[80:83], s[40:41], 0 glc
  s_min_u32 s46, s80, s81
  s_min_u32 s47, s82, s83
  s_min_u32 s46, s46, s47
  s_cmp_ge_u32 s46, s53
  s_cbranch_scc1 bell_x_24
  s_min_u32 s46, s80, s81
  s_min_u32 s47, s82, s83
  s_min_u32 s46, s46, s47
  s_cmp_ge_u32 s46, s53
  s_cbranch_scc1 bell_x_24
  s_min_u32 s46, s80, s81
  s_min_u32 s47, s82, s83
  s_min_u32 s46, s46, s47
  s_cmp_ge_u32 s46, s53
  s_cbranch_scc1 bell_x_24
  s_min_u32 s46, s80, s81
  s_min_u32 s47, s82, s83
  s_min_u32 s46, s46, s47
  s_cmp_ge_u32 s46, s53
  s_cbranch_scc1 bell_x_24
  s_min_u32 s46, s80, s81
  s_min_u32 s47, s82, s83
  s_min_u32 s46, s46, s47
  s_cmp_ge_u32 s46, s53
  s_cbranch_scc1 bell_x_24
  s_min_u32 s46, s80, s81
  s_min_u32 s47, s82, s83
  s_min_u32 s46, s46, s47
  s_cmp_ge_u32 s46, s53
  s_cbranch_scc1 bell_x_24
  s_min_u32 s46, s80, s81
  s_min_u32 s47, s82, s83
  s_min_u32 s46, s46, s47
  s_cmp_ge_u32 s46, s53
  s_cbranch_scc1 bell_x_24
  s_min_u32 s46, s80, s81
  s_min_u32 s47, s82, s83
  s_min_u32 s46, s46, s47
  s_cmp_ge_u32 s46, s53
  s_cbranch_scc1 bell_x_24
  s_min_u32 s46, s80, s81
  s_min_u32 s47, s82, s83
  s_min_u32 s46, s46, s47
  s_cmp_ge_u32 s46, s53
  s_cbranch_scc1 bell_x_24
  s_min_u32 s46, s80, s81
  s_min_u32 s47, s82, s83
  s_min_u32 s46, s46, s47
  s_cmp_ge_u32 s46, s53
  s_cbranch_scc1 bell_x_24
  s_add_u32 s50, s50, 1
  s_cmp_lt_u32 s50, 524288
  s_cbranch_scc1 bell_23
  s_branch L_fail
bell_x_24:
sc_nobell:
  s_mov_b32 s50, 0
sch_top:
  s_barrier
  buffer_load_dwordx4 v[16:19], v12, s[8:11], 0 offen offset:0 sc1
  s_add_u32 m0, s51, 153600
  s_barrier
  buffer_load_dwordx4 v[20:23], v12, s[8:11], 0 offen offset:1024 sc1
  s_barrier
  buffer_load_dwordx4 v[24:27], v12, s[8:11], 0 offen offset:2048 sc1
  s_barrier
  buffer_load_dwordx4 v12, s[8:11], s31 offen sc1 lds
  s_add_u32 m0, s51, 157696
  s_barrier
  buffer_load_dwordx4 v12, s[8:11], s32 offen sc1 lds
  s_waitcnt vmcnt(4)
sch_go:
  v_smfmac_f32_16x16x64_bf16 v[88:91], v[16:19], a[192:199], v7
  v_smfmac_f32_16x16x64_bf16 v[92:95], v[16:19], a[200:207], v7
  v_smfmac_f32_16x16x64_bf16 v[96:99], v[16:19], a[208:215], v7
  v_smfmac_f32_16x16x64_bf16 v[100:103], v[16:19], v[56:63], v7
  v_smfmac_f32_16x16x64_bf16 v[104:107], v[16:19], v[64:71], v7
  ds_read_b128 v[56:59], v2 offset:57344
  v_smfmac_f32_16x16x64_bf16 v[108:111], v[16:19], v[72:79], v7
  s_waitcnt vmcnt(3)
  ds_read_b128 v[60:63], v2 offset:61440
  v_smfmac_f32_16x16x64_bf16 v[88:91], v[20:23], a[216:223], v7
  ds_read_b128 v[64:67], v3 offset:0
  v_smfmac_f32_16x16x64_bf16 v[92:95], v[20:23], a[224:231], v7
  ds_read_b128 v[68:71], v3 offset:4096
  v_smfmac_f32_16x16x64_bf16 v[96:99], v[20:23], a[232:239], v7
  s_waitcnt vmcnt(2)
  v_max3_u32 v136, v16, v20, v24
  v_smfmac_f32_16x16x64_bf16 v[100:103], v[20:23], a[0:7], v7
  ds_read_b128 v[72:75], v3 offset:8192
  v_cmp_eq_u32 vcc, -1, v136
  v_smfmac_f32_16x16x64_bf16 v[104:107], v[20:23], a[8:15], v7
  ds_read_b128 v[76:79], v3 offset:12288
  v_smfmac_f32_16x16x64_bf16 v[108:111], v[20:23], a[16:23], v7
  s_cbranch_vccnz sch_ha
  v_smfmac_f32_16x16x64_bf16 v[88:91], v[24:27], a[240:247], v7
  s_waitcnt vmcnt(1)
  s_barrier
  ds_read_b128 v[28:31], v149 offset:0
  v_smfmac_f32_16x16x64_bf16 v[92:95], v[24:27], a[248:255], v7
  ds_read_b128 v[32:35], v149 offset:1024
  v_smfmac_f32_16x16x64_bf16 v[96:99], v[24:27], v[152:159], v7
  ds_read_b128 v[36:39], v149 offset:2048
  v_smfmac_f32_16x16x64_bf16 v[100:103], v[24:27], a[24:31], v7
  ds_read_b128 v[40:43], v149 offset:3072
  v_smfmac_f32_16x16x64_bf16 v[104:107], v[24:27], a[32:39], v7
  v_smfmac_f32_16x16x64_bf16 v[108:111], v[24:27], a[40:47], v7
  s_waitcnt vmcnt(0)
  s_barrier
  s_waitcnt lgkmcnt(3)
  v_smfmac_f32_16x16x64_bf16 v[88:91], v[28:31], v[80:87], v7
  ds_read_b128 v[44:47], v149 offset:4096
  v_smfmac_f32_16x16x64_bf16 v[92:95], v[28:31], v[56:63], v7
  ds_read_b128 v[48:51], v149 offset:5120
  v_smfmac_f32_16x16x64_bf16 v[96:99], v[28:31], v[64:71], v7
  ds_read_b128 v[52:55], v149 offset:6144
  s_waitcnt lgkmcnt(3)
  v_smfmac_f32_16x16x64_bf16 v[88:91], v[32:35], v[160:167], v7
  ds_read_b128 v[80:83], v3 offset:32768
  v_smfmac_f32_16x16x64_bf16 v[92:95], v[32:35], v[168:175], v7
  ds_read_b128 v[84:87], v3 offset:36864
  v_smfmac_f32_16x16x64_bf16 v[96:99], v[32:35], v[176:183], v7
  ds_read_b128 v[56:59], v3 offset:16384
  v_smfmac_f32_16x16x64_bf16 v[88:91], v[36:39], v[184:191], v7
  s_waitcnt lgkmcnt(3)
  v_max3_u32 v136, v28, v32, v36
  v_smfmac_f32_16x16x64_bf16 v[92:95], v[36:39], v[192:199], v7
  ds_read_b128 v[60:63], v3 offset:20480
  v_max3_u32 v136, v136, v40, v44
  v_smfmac_f32_16x16x64_bf16 v[96:99], v[36:39], v[200:207], v7
  ds_read_b128 v[64:67], v3 offset:40960
  v_max3_u32 v136, v136, v48, v52
  v_smfmac_f32_16x16x64_bf16 v[88:91], v[44:47], v[208:215], v7
  ds_read_b128 v[68:71], v3 offset:45056
  v_cmp_eq_u32 vcc, -1, v136
  v_smfmac_f32_16x16x64_bf16 v[88:91], v[48:51], v[232:239], v7
  v_smfmac_f32_16x16x64_bf16 v[88:91], v[40:43], v[72:79], v7
  s_cbranch_vccnz sch_hb
  s_waitcnt lgkmcnt(3)
  v_smfmac_f32_16x16x64_bf16 v[88:91], v[52:55], v[80:87], v7
  ds_read_b128 v[72:75], v3 offset:24576
  s_mov_b32 m0, s21
sch_join:
  v_smfmac_f32_16x16x64_bf16 v[92:95], v[44:47], v[216:223], v7
  ds_read_b128 v[76:79], v3 offset:28672
  buffer_load_dwordx4 v[112:115], v1, s[8:11], s28 offen offset:0 sc1
  v_smfmac_f32_16x16x64_bf16 v[92:95], v[48:51], v[240:247], v7
  ds_read_b128 v[80:83], v3 offset:49152
  s_waitcnt lgkmcnt(3)
  v_add_f32 v88, v88, v90
  v_smfmac_f32_16x16x64_bf16 v[92:95], v[40:43], v[56:63], v7
  ds_read_b128 v[84:87], v3 offset:53248
  v_add_f32 v89, v89, v91
  v_smfmac_f32_16x16x64_bf16 v[92:95], v[52:55], v[64:71], v7
  ds_read_b128 v[56:59], v2 offset:24576
  buffer_load_dwordx4 v[116:119], v1, s[8:11], s28 offen offset:1024 sc1
  v_cmp_u_f32 vcc, v88, v89
  v_smfmac_f32_16x16x64_bf16 v[96:99], v[44:47], v[224:231], v7
  ds_read_b128 v[60:63], v2 offset:28672
  v_cvt_pk_bf16_f32 v136, v88, v89
  v_smfmac_f32_16x16x64_bf16 v[96:99], v[48:51], v[248:255], v7
  s_and_b64 vcc, vcc, s[16:17]
  s_cbranch_scc1 sch_redo
  s_waitcnt lgkmcnt(4)
  v_add_f32 v92, v92, v94
  v_smfmac_f32_16x16x64_bf16 v[96:99], v[40:43], v[72:79], v7
  ds_read_b128 v[64:67], v2 offset:32768
  buffer_load_dwordx4 v[120:123], v1, s[8:11], s29 offen offset:0 sc1
  s_waitcnt lgkmcnt(3)
  v_add_f32 v93, v93, v95
  v_smfmac_f32_16x16x64_bf16 v[96:99], v[52:55], v[80:87], v7
  ds_read_b128 v[68:71], v2 offset:36864
  v_cvt_pk_bf16_f32 v137, v92, v93
  v_smfmac_f32_16x16x64_bf16 v[100:103], v[28:31], a[48:55], v7
  ds_write2st64_b32 v4, v136, v137 offset0:0 offset1:4
  v_smfmac_f32_16x16x64_bf16 v[100:103], v[32:35], a[72:79], v7
  ds_read_b128 v[72:75], v2 offset:40960
  buffer_load_dwordx4 v[124:127], v1, s[8:11], s29 offen offset:1024 sc1
  v_add_f32 v96, v96, v98
  v_smfmac_f32_16x16x64_bf16 v[100:103], v[40:43], a[96:103], v7
  ds_read_b128 v[76:79], v2 offset:45056
  s_waitcnt lgkmcnt(5)
  v_add_f32 v97, v97, v99
  v_smfmac_f32_16x16x64_bf16 v[100:103], v[36:39], v[56:63], v7
  v_cvt_pk_bf16_f32 v138, v96, v97
  v_smfmac_f32_16x16x64_bf16 v[100:103], v[44:47], a[120:127], v7
  ds_write_b32 v4, v138 offset:2048
  buffer_load_dwordx4 v[128:131], v1, s[8:11], s30 offen offset:0 sc1
  v_smfmac_f32_16x16x64_bf16 v[100:103], v[48:51], a[144:151], v7
  s_waitcnt lgkmcnt(3)
  v_smfmac_f32_16x16x64_bf16 v[104:107], v[36:39], v[64:71], v7
  s_waitcnt lgkmcnt(1)
  v_smfmac_f32_16x16x64_bf16 v[108:111], v[36:39], v[72:79], v7
  buffer_load_dwordx4 v[132:135], v1, s[8:11], s30 offen offset:1024 sc1
  v_smfmac_f32_16x16x64_bf16 v[100:103], v[52:55], a[168:175], v7
  s_waitcnt lgkmcnt(0)
  s_barrier
  v_smfmac_f32_16x16x64_bf16 v[104:107], v[28:31], a[56:63], v7
  v_smfmac_f32_16x16x64_bf16 v[104:107], v[32:35], a[80:87], v7
  buffer_load_dwordx4 v1, s[8:11], s63 offen offset:0 sc1 lds
  v_add_f32 v100, v100, v102
  v_smfmac_f32_16x16x64_bf16 v[104:107], v[40:43], a[104:111], v7
  v_add_f32 v101, v101, v103
  v_smfmac_f32_16x16x64_bf16 v[104:107], v[44:47], a[128:135], v7
  v_cvt_pk_bf16_f32 v139, v100, v101
  v_smfmac_f32_16x16x64_bf16 v[104:107], v[48:51], a[152:159], v7
  buffer_load_dwordx4 v1, s[8:11], s63 offen offset:1024 sc1 lds
  v_smfmac_f32_16x16x64_bf16 v[104:107], v[52:55], a[176:183], v7
  v_smfmac_f32_16x16x64_bf16 v[108:111], v[28:31], a[64:71], v7
  v_smfmac_f32_16x16x64_bf16 v[108:111], v[32:35], a[88:95], v7
  buffer_load_dwordx4 v1, s[8:11], s63 offen offset:2048 sc1 lds
  v_add_f32 v104, v104, v106
  v_smfmac_f32_16x16x64_bf16 v[108:111], v[40:43], a[112:119], v7
  v_add_f32 v105, v105, v107
  v_smfmac_f32_16x16x64_bf16 v[108:111], v[44:47], a[136:143], v7
  v_cvt_pk_bf16_f32 v140, v104, v105
  v_smfmac_f32_16x16x64_bf16 v[108:111], v[48:51], a[160:167], v7
  ds_write2st64_b32 v4, v139, v140 offset0:12 offset1:16
  buffer_load_dwordx4 v1, s[8:11], s63 offen offset:3072 sc1 lds
  v_smfmac_f32_16x16x64_bf16 v[108:111], v[52:55], a[184:191], v7
  s_nop 7
  v_add_f32 v108, v108, v110
  v_add_f32 v109, v109, v111
  v_cvt_pk_bf16_f32 v141, v108, v109
  ds_write_b32 v4, v141 offset:5120
  s_waitcnt lgkmcnt(1)
  s_barrier
  s_waitcnt lgkmcnt(0)
  s_barrier
  s_barrier
  s_cmp_ge_u32 s42, 2
  s_cbranch_scc1 sc_nox
  ds_read_b128 v[56:59], v13 offset:0
  ds_read_b128 v[60:63], v13 offset:2048
  ds_read_b128 v[64:67], v13 offset:1024
  ds_read_b128 v[68:71], v13 offset:3072
  ds_read_b128 v[72:75], v13 offset:4096
  ds_read_b128 v[76:79], v13 offset:6144
  ds_read_b128 v[80:83], v13 offset:5120
  ds_read_b128 v[84:87], v13 offset:7168
  ds_read_b128 v[16:19], v13 offset:8192
  ds_read_b128 v[20:23], v13 offset:10240
  ds_read_b128 v[24:27], v13 offset:9216
  ds_read_b128 v[36:39], v13 offset:11264
  s_waitcnt vmcnt(4)
  s_waitcnt lgkmcnt(11)
  v_mfma_f32_16x16x32_bf16 v[88:91], v[56:59], v[112:115], 0
  ds_read_b64_tr_b16 v[28:29], v5 offset:3072
  s_waitcnt lgkmcnt(11)
  v_mfma_f32_16x16x32_bf16 v[92:95], v[60:63], v[112:115], 0
  ds_read_b64_tr_b16 v[30:31], v5 offset:3136
  s_waitcnt lgkmcnt(11)
  v_mfma_f32_16x16x32_bf16 v[88:91], v[64:67], v[116:119], v[88:91]
  ds_read_b64_tr_b16 v[32:33], v5 offset:3584
  s_waitcnt lgkmcnt(11)
  v_mfma_f32_16x16x32_bf16 v[92:95], v[68:71], v[116:119], v[92:95]
  ds_read_b64_tr_b16 v[34:35], v5 offset:3648
  s_waitcnt lgkmcnt(11)
  v_mfma_f32_16x16x32_bf16 v[88:91], v[72:75], v[120:123], v[88:91]
  ds_read_b64_tr_b16 v[40:41], v5 offset:4096
  s_waitcnt lgkmcnt(5)
  v_mfma_f32_16x16x32_bf16 v[92:95], v[76:79], v[120:123], v[92:95]
  ds_read_b64_tr_b16 v[42:43], v5 offset:4160
  v_mfma_f32_16x16x32_bf16 v[88:91], v[80:83], v[124:127], v[88:91]
  ds_read_b64_tr_b16 v[44:45], v5 offset:4608
  v_mfma_f32_16x16x32_bf16 v[92:95], v[84:87], v[124:127], v[92:95]
  ds_read_b64_tr_b16 v[46:47], v5 offset:4672
  v_mfma_f32_16x16x32_bf16 v[88:91], v[16:19], v[128:131], v[88:91]
  ds_read_b64_tr_b16 v[48:49], v5 offset:5120
  v_mfma_f32_16x16x32_bf16 v[92:95], v[20:23], v[128:131], v[92:95]
  ds_read_b64_tr_b16 v[50:51], v5 offset:5184
  v_mfma_f32_16x16x32_bf16 v[88:91], v[24:27], v[132:135], v[88:91]
  ds_read_b64_tr_b16 v[52:53], v5 offset:5632
  v_mfma_f32_16x16x32_bf16 v[92:95], v[36:39], v[132:135], v[92:95]
  ds_read_b64_tr_b16 v[54:55], v5 offset:5696
  s_waitcnt lgkmcnt(5)
  v_mfma_f32_16x16x32_bf16 v[96:99], v[28:31], v[112:115], 0
  v_mfma_f32_16x16x32_bf16 v[96:99], v[32:35], v[116:119], v[96:99]
  v_mfma_f32_16x16x32_bf16 v[96:99], v[40:43], v[120:123], v[96:99]
  s_waitcnt lgkmcnt(2)
  v_mfma_f32_16x16x32_bf16 v[96:99], v[44:47], v[124:127], v[96:99]
  v_mfma_f32_16x16x32_bf16 v[96:99], v[48:51], v[128:131], v[96:99]
  s_waitcnt lgkmcnt(0)
  v_mfma_f32_16x16x32_bf16 v[96:99], v[52:55], v[132:135], v[96:99]
  v_mov_b32 v143, s70
  v_cndmask_b32 v88, v88, v143, s[72:73]
  v_cndmask_b32 v89, v89, v143, s[74:75]
  v_cndmask_b32 v90, v90, v143, s[76:77]
  v_cndmask_b32 v91, v91, v143, s[78:79]
  v_cndmask_b32 v92, v92, v143, s[80:81]
  v_cndmask_b32 v93, v93, v143, s[82:83]
  v_cndmask_b32 v94, v94, v143, s[84:85]
  v_cndmask_b32 v95, v95, v143, s[86:87]
  s_mov_b32 vcc_lo, 0
  s_mov_b32 vcc_hi, -1
  v_cndmask_b32 v96, v96, v98, vcc
  v_cndmask_b32 v97, v97, v99, vcc
  v_max_f32 v142, v88, v89
  v_max3_f32 v142, v142, v90, v91
  v_max3_f32 v142, v142, v92, v93
  v_max3_f32 v142, v142, v94, v95
  v_max3_f32 v142, v142, v96, v97
  v_mov_b32 v143, v142
  s_nop 1
  v_permlane16_swap_b32 v143, v142
  v_max_f32 v142, v142, v143
  v_mov_b32 v143, v142
  s_nop 1
  v_permlane32_swap_b32 v143, v142
  v_max_f32 v142, v142, v143
  v_mul_f32 v142, s68, v142
  v_fma_f32 v88, v88, s68, -v142
  v_fma_f32 v89, v89, s68, -v142
  v_fma_f32 v90, v90, s68, -v142
  v_fma_f32 v91, v91, s68, -v142
  v_fma_f32 v92, v92, s68, -v142
  v_fma_f32 v93, v93, s68, -v142
  v_fma_f32 v94, v94, s68, -v142
  v_fma_f32 v95, v95, s68, -v142
  v_fma_f32 v96, v96, s68, -v142
  v_fma_f32 v97, v97, s68, -v142
  v_exp_f32 v88, v88
  v_exp_f32 v89, v89
  v_exp_f32 v90, v90
  v_exp_f32 v91, v91
  v_exp_f32 v92, v92
  v_exp_f32 v93, v93
  v_exp_f32 v94, v94
  v_exp_f32 v95, v95
  v_exp_f32 v96, v96
  v_exp_f32 v97, v97
  v_add_f32 v142, v88, v89
  v_add_f32 v142, v142, v90
  v_add_f32 v142, v142, v91
  v_add_f32 v142, v142, v92
  v_add_f32 v142, v142, v93
  v_add_f32 v142, v142, v94
  v_add_f32 v142, v142, v95
  v_add_f32 v142, v142, v96
  v_add_f32 v142, v142, v97
  v_mov_b32 v143, v142
  s_nop 1
  v_permlane16_swap_b32 v143, v142
  v_add_f32 v142, v142, v143
  v_mov_b32 v143, v142
  s_nop 1
  v_permlane32_swap_b32 v143, v142
  v_add_f32 v142, v142, v143
  v_rcp_f32 v142, v142
  s_nop 0
  v_mul_f32 v88, v88, v142
  v_mul_f32 v89, v89, v142
  v_mul_f32 v90, v90, v142
  v_mul_f32 v91, v91, v142
  v_mul_f32 v92, v92, v142
  v_mul_f32 v93, v93, v142
  v_mul_f32 v94, v94, v142
  v_mul_f32 v95, v95, v142
  v_mul_f32 v96, v96, v142
  v_mul_f32 v97, v97, v142
  v_cvt_pk_bf16_f32 v144, v88, v89
  v_cvt_pk_bf16_f32 v145, v90, v91
  v_cvt_pk_bf16_f32 v146, v92, v93
  v_cvt_pk_bf16_f32 v147, v94, v95
  v_cvt_pk_bf16_f32 v148, v96, v97
  s_mov_b32 s47, s64
  s_lshr_b32 s46, s47, 8
  s_and_b32 s46, s46, 0x2000
  s_xor_b32 s47, s47, s46
  s_add_u32 s46, s47, s27
  buffer_store_dwordx4 v[144:147], v1, s[8:11], s46 offen sc1
  buffer_store_dword v148, v14, s[8:11], s47 offen sc1
  s_add_u32 s64, s64, 262144
  s_cmp_ge_u32 s64, 16777216
  s_cselect_b32 s46, 2097152, 0
  s_sub_u32 s64, s64, s46
sc_nox:
  v_add_u32 v13, s22, v13
  s_sub_u32 s22, 0, s22
  s_add_u32 s58, s58, 1
  s_cmp_eq_u32 s58, 3
  s_cselect_b32 s58, 0, s58
  s_mov_b32 s52, s53
  s_cmp_lt_u32 s52, 64
  s_cbranch_scc1 sch_loop
  s_waitcnt vmcnt(0)
  s_cmp_ge_u32 s42, 2
  s_cbranch_scc1 L_end
  v_mov_b32 v136, s52
  s_mov_b64 exec, 1
  buffer_store_dword v136, v15, s[8:11], 0 offen sc1
  s_mov_b64 exec, -1
  s_endpgm
scs_ha:
  s_waitcnt lgkmcnt(0)
  ds_read_b128 v[56:59], v2 offset:0
  ds_read_b128 v[60:63], v2 offset:4096
  ds_read_b128 v[64:67], v2 offset:8192
  ds_read_b128 v[68:71], v2 offset:12288
  ds_read_b128 v[72:75], v2 offset:16384
  ds_read_b128 v[76:79], v2 offset:20480
  ds_read_b128 v[80:83], v2 offset:49152
  ds_read_b128 v[84:87], v2 offset:53248
  v_mov_b32 v88, 0
  v_mov_b32 v89, 0
  v_mov_b32 v90, 0
  v_mov_b32 v91, 0
  v_mov_b32 v92, 0
  v_mov_b32 v93, 0
  v_mov_b32 v94, 0
  v_mov_b32 v95, 0
  v_mov_b32 v96, 0
  v_mov_b32 v97, 0
  v_mov_b32 v98, 0
  v_mov_b32 v99, 0
  v_mov_b32 v100, 0
  v_mov_b32 v101, 0
  v_mov_b32 v102, 0
  v_mov_b32 v103, 0
  v_mov_b32 v104, 0
  v_mov_b32 v105, 0
  v_mov_b32 v106, 0
  v_mov_b32 v107, 0
  v_mov_b32 v108, 0
  v_mov_b32 v109, 0
  v_mov_b32 v110, 0
  v_mov_b32 v111, 0
scs_ra:
  buffer_load_dwordx4 v[16:19], v12, s[8:11], 0 offen offset:0 sc1
  buffer_load_dwordx4 v[20:23], v12, s[8:11], 0 offen offset:1024 sc1
  buffer_load_dwordx4 v[24:27], v12, s[8:11], 0 offen offset:2048 sc1
  s_add_u32 s50, s50, 1
  s_cmp_gt_u32 s50, 131072
  s_cbranch_scc1 L_fail
  s_waitcnt vmcnt(0) lgkmcnt(0)
  v_max3_u32 v136, v16, v20, v24
  v_cmp_eq_u32 vcc, -1, v136
  s_cbranch_vccnz scs_ra
  s_branch scs_go
scs_hb:
  s_waitcnt lgkmcnt(0)
  s_add_u32 s50, s50, 1
  s_cmp_gt_u32 s50, 131072
  s_cbranch_scc1 L_fail
  ds_read_b128 v[56:59], v2 offset:0
  ds_read_b128 v[60:63], v2 offset:4096
  ds_read_b128 v[64:67], v2 offset:8192
  ds_read_b128 v[68:71], v2 offset:12288
  ds_read_b128 v[72:75], v2 offset:16384
  ds_read_b128 v[76:79], v2 offset:20480
  ds_read_b128 v[80:83], v2 offset:49152
  ds_read_b128 v[84:87], v2 offset:53248
  v_mov_b32 v88, 0
  v_mov_b32 v89, 0
  v_mov_b32 v90, 0
  v_mov_b32 v91, 0
  v_mov_b32 v92, 0
  v_mov_b32 v93, 0
  v_mov_b32 v94, 0
  v_mov_b32 v95, 0
  v_mov_b32 v96, 0
  v_mov_b32 v97, 0
  v_mov_b32 v98, 0
  v_mov_b32 v99, 0
  v_mov_b32 v100, 0
  v_mov_b32 v101, 0
  v_mov_b32 v102, 0
  v_mov_b32 v103, 0
  v_mov_b32 v104, 0
  v_mov_b32 v105, 0
  v_mov_b32 v106, 0
  v_mov_b32 v107, 0
  v_mov_b32 v108, 0
  v_mov_b32 v109, 0
  v_mov_b32 v110, 0
  v_mov_b32 v111, 0
  s_waitcnt lgkmcnt(0)
  s_branch scs_top
scs_redo:
  s_waitcnt lgkmcnt(0)
  s_mov_b32 s50, 0
scs_poll:
  buffer_load_dwordx4 v[16:19], v12, s[8:11], 0 offen offset:0 sc1
  buffer_load_dwordx4 v[20:23], v12, s[8:11], 0 offen offset:1024 sc1
  buffer_load_dwordx4 v[24:27], v12, s[8:11], 0 offen offset:2048 sc1
  buffer_load_dwordx4 v[28:31], v12, s[8:11], 0 offen offset:3072 sc1
  buffer_load_dwordx4 v[32:35], v12, s[8:11], s24 offen offset:0 sc1
  buffer_load_dwordx4 v[36:39], v12, s[8:11], s24 offen offset:1024 sc1
  buffer_load_dwordx4 v[40:43], v12, s[8:11], s24 offen offset:2048 sc1
  buffer_load_dwordx4 v[44:47], v12, s[8:11], s24 offen offset:3072 sc1
  buffer_load_dwordx4 v[48:51], v12, s[8:11], s25 offen offset:0 sc1
  buffer_load_dwordx4 v[52:55], v12, s[8:11], s25 offen offset:1024 sc1
  s_add_u32 s50, s50, 1
  s_cmp_gt_u32 s50, 131072
  s_cbranch_scc1 L_fail
  s_waitcnt vmcnt(0) lgkmcnt(0)
  v_max_u32 v136, v16, v17
  v_max3_u32 v136, v18, v19, v136
  v_max3_u32 v136, v20, v21, v136
  v_max3_u32 v136, v22, v23, v136
  v_max3_u32 v136, v24, v25, v136
  v_max3_u32 v136, v26, v27, v136
  v_max3_u32 v136, v28, v29, v136
  v_max3_u32 v136, v30, v31, v136
  v_max3_u32 v136, v32, v33, v136
  v_max3_u32 v136, v34, v35, v136
  v_max3_u32 v136, v36, v37, v136
  v_max3_u32 v136, v38, v39, v136
  v_max3_u32 v136, v40, v41, v136
  v_max3_u32 v136, v42, v43, v136
  v_max3_u32 v136, v44, v45, v136
  v_max3_u32 v136, v46, v47, v136
  v_max3_u32 v136, v48, v49, v136
  v_max3_u32 v136, v50, v51, v136
  v_max3_u32 v136, v52, v53, v136
  v_max3_u32 v136, v54, v55, v136
  v_cmp_eq_u32 vcc, -1, v136
  s_cbranch_vccnz scs_poll
  s_mov_b64 s[16:17], 0
  ds_read_b128 v[56:59], v2 offset:0
  ds_read_b128 v[60:63], v2 offset:4096
  ds_read_b128 v[64:67], v2 offset:8192
  ds_read_b128 v[68:71], v2 offset:12288
  ds_read_b128 v[72:75], v2 offset:16384
  ds_read_b128 v[76:79], v2 offset:20480
  ds_read_b128 v[80:83], v2 offset:49152
  ds_read_b128 v[84:87], v2 offset:53248
  v_mov_b32 v88, 0
  v_mov_b32 v89, 0
  v_mov_b32 v90, 0
  v_mov_b32 v91, 0
  v_mov_b32 v92, 0
  v_mov_b32 v93, 0
  v_mov_b32 v94, 0
  v_mov_b32 v95, 0
  v_mov_b32 v96, 0
  v_mov_b32 v97, 0
  v_mov_b32 v98, 0
  v_mov_b32 v99, 0
  v_mov_b32 v100, 0
  v_mov_b32 v101, 0
  v_mov_b32 v102, 0
  v_mov_b32 v103, 0
  v_mov_b32 v104, 0
  v_mov_b32 v105, 0
  v_mov_b32 v106, 0
  v_mov_b32 v107, 0
  v_mov_b32 v108, 0
  v_mov_b32 v109, 0
  v_mov_b32 v110, 0
  v_mov_b32 v111, 0
  s_waitcnt lgkmcnt(0)
  v_smfmac_f32_16x16x64_bf16 v[88:91], v[16:19], a[192:199], v7
  v_smfmac_f32_16x16x64_bf16 v[92:95], v[16:19], a[200:207], v7
  v_smfmac_f32_16x16x64_bf16 v[96:99], v[16:19], a[208:215], v7
  v_smfmac_f32_16x16x64_bf16 v[100:103], v[16:19], v[56:63], v7
  v_smfmac_f32_16x16x64_bf16 v[104:107], v[16:19], v[64:71], v7
  ds_read_b128 v[56:59], v2 offset:57344
  v_smfmac_f32_16x16x64_bf16 v[108:111], v[16:19], v[72:79], v7
  ds_read_b128 v[60:63], v2 offset:61440
  v_smfmac_f32_16x16x64_bf16 v[88:91], v[20:23], a[216:223], v7
  ds_read_b128 v[64:67], v3 offset:0
  v_smfmac_f32_16x16x64_bf16 v[92:95], v[20:23], a[224:231], v7
  ds_read_b128 v[68:71], v3 offset:4096
  v_smfmac_f32_16x16x64_bf16 v[96:99], v[20:23], a[232:239], v7
  v_smfmac_f32_16x16x64_bf16 v[100:103], v[20:23], a[0:7], v7
  ds_read_b128 v[72:75], v3 offset:8192
  v_smfmac_f32_16x16x64_bf16 v[104:107], v[20:23], a[8:15], v7
  ds_read_b128 v[76:79], v3 offset:12288
  v_smfmac_f32_16x16x64_bf16 v[108:111], v[20:23], a[16:23], v7
  v_smfmac_f32_16x16x64_bf16 v[88:91], v[24:27], a[240:247], v7
  v_smfmac_f32_16x16x64_bf16 v[92:95], v[24:27], a[248:255], v7
  v_smfmac_f32_16x16x64_bf16 v[96:99], v[24:27], v[152:159], v7
  v_smfmac_f32_16x16x64_bf16 v[100:103], v[24:27], a[24:31], v7
  v_smfmac_f32_16x16x64_bf16 v[104:107], v[24:27], a[32:39], v7
  v_smfmac_f32_16x16x64_bf16 v[108:111], v[24:27], a[40:47], v7
  v_smfmac_f32_16x16x64_bf16 v[88:91], v[28:31], v[80:87], v7
  s_waitcnt lgkmcnt(0)
  v_smfmac_f32_16x16x64_bf16 v[92:95], v[28:31], v[56:63], v7
  v_smfmac_f32_16x16x64_bf16 v[96:99], v[28:31], v[64:71], v7
  v_smfmac_f32_16x16x64_bf16 v[88:91], v[32:35], v[160:167], v7
  ds_read_b128 v[80:83], v3 offset:32768
  ds_read_b128 v[16:19], v13 offset:8192
  v_smfmac_f32_16x16x64_bf16 v[92:95], v[32:35], v[168:175], v7
  ds_read_b128 v[84:87], v3 offset:36864
  ds_read_b128 v[20:23], v13 offset:10240
  v_smfmac_f32_16x16x64_bf16 v[96:99], v[32:35], v[176:183], v7
  ds_read_b128 v[56:59], v3 offset:16384
  ds_read_b128 v[24:27], v13 offset:9216
  v_smfmac_f32_16x16x64_bf16 v[88:91], v[36:39], v[184:191], v7
  v_smfmac_f32_16x16x64_bf16 v[92:95], v[36:39], v[192:199], v7
  ds_read_b128 v[60:63], v3 offset:20480
  v_smfmac_f32_16x16x64_bf16 v[96:99], v[36:39], v[200:207], v7
  ds_read_b128 v[64:67], v3 offset:40960
  v_smfmac_f32_16x16x64_bf16 v[88:91], v[44:47], v[208:215], v7
  ds_read_b128 v[68:71], v3 offset:45056
  v_smfmac_f32_16x16x64_bf16 v[88:91], v[48:51], v[232:239], v7
  v_smfmac_f32_16x16x64_bf16 v[88:91], v[40:43], v[72:79], v7
  s_waitcnt lgkmcnt(3)
  v_smfmac_f32_16x16x64_bf16 v[88:91], v[52:55], v[80:87], v7
  ds_read_b128 v[72:75], v3 offset:24576
  s_waitcnt lgkmcnt(0)
  s_branch scs_join
sch_ha:
  s_waitcnt lgkmcnt(0)
  ds_read_b128 v[56:59], v2 offset:0
  ds_read_b128 v[60:63], v2 offset:4096
  ds_read_b128 v[64:67], v2 offset:8192
  ds_read_b128 v[68:71], v2 offset:12288
  ds_read_b128 v[72:75], v2 offset:16384
  ds_read_b128 v[76:79], v2 offset:20480
  ds_read_b128 v[80:83], v2 offset:49152
  ds_read_b128 v[84:87], v2 offset:53248
  v_mov_b32 v88, 0
  v_mov_b32 v89, 0
  v_mov_b32 v90, 0
  v_mov_b32 v91, 0
  v_mov_b32 v92, 0
  v_mov_b32 v93, 0
  v_mov_b32 v94, 0
  v_mov_b32 v95, 0
  v_mov_b32 v96, 0
  v_mov_b32 v97, 0
  v_mov_b32 v98, 0
  v_mov_b32 v99, 0
  v_mov_b32 v100, 0
  v_mov_b32 v101, 0
  v_mov_b32 v102, 0
  v_mov_b32 v103, 0
  v_mov_b32 v104, 0
  v_mov_b32 v105, 0
  v_mov_b32 v106, 0
  v_mov_b32 v107, 0
  v_mov_b32 v108, 0
  v_mov_b32 v109, 0
  v_mov_b32 v110, 0
  v_mov_b32 v111, 0
sch_ra:
  buffer_load_dwordx4 v[16:19], v12, s[8:11], 0 offen offset:0 sc1
  buffer_load_dwordx4 v[20:23], v12, s[8:11], 0 offen offset:1024 sc1
  buffer_load_dwordx4 v[24:27], v12, s[8:11], 0 offen offset:2048 sc1
  s_add_u32 s50, s50, 1
  s_cmp_gt_u32 s50, 131072
  s_cbranch_scc1 L_fail
  s_waitcnt vmcnt(0) lgkmcnt(0)
  v_max3_u32 v136, v16, v20, v24
  v_cmp_eq_u32 vcc, -1, v136
  s_cbranch_vccnz sch_ra
  s_branch sch_go
sch_hb:
  s_waitcnt lgkmcnt(0)
  s_add_u32 s50, s50, 1
  s_cmp_gt_u32 s50, 131072
  s_cbranch_scc1 L_fail
  ds_read_b128 v[56:59], v2 offset:0
  ds_read_b128 v[60:63], v2 offset:4096
  ds_read_b128 v[64:67], v2 offset:8192
  ds_read_b128 v[68:71], v2 offset:12288
  ds_read_b128 v[72:75], v2 offset:16384
  ds_read_b128 v[76:79], v2 offset:20480
  ds_read_b128 v[80:83], v2 offset:49152
  ds_read_b128 v[84:87], v2 offset:53248
  v_mov_b32 v88, 0
  v_mov_b32 v89, 0
  v_mov_b32 v90, 0
  v_mov_b32 v91, 0
  v_mov_b32 v92, 0
  v_mov_b32 v93, 0
  v_mov_b32 v94, 0
  v_mov_b32 v95, 0
  v_mov_b32 v96, 0
  v_mov_b32 v97, 0
  v_mov_b32 v98, 0
  v_mov_b32 v99, 0
  v_mov_b32 v100, 0
  v_mov_b32 v101, 0
  v_mov_b32 v102, 0
  v_mov_b32 v103, 0
  v_mov_b32 v104, 0
  v_mov_b32 v105, 0
  v_mov_b32 v106, 0
  v_mov_b32 v107, 0
  v_mov_b32 v108, 0
  v_mov_b32 v109, 0
  v_mov_b32 v110, 0
  v_mov_b32 v111, 0
  s_waitcnt lgkmcnt(0)
  s_branch sch_top
sch_redo:
  s_waitcnt lgkmcnt(0)
  s_mov_b32 s50, 0
sch_poll:
  buffer_load_dwordx4 v[16:19], v12, s[8:11], 0 offen offset:0 sc1
  buffer_load_dwordx4 v[20:23], v12, s[8:11], 0 offen offset:1024 sc1
  buffer_load_dwordx4 v[24:27], v12, s[8:11], 0 offen offset:2048 sc1
  buffer_load_dwordx4 v[28:31], v12, s[8:11], 0 offen offset:3072 sc1
  buffer_load_dwordx4 v[32:35], v12, s[8:11], s24 offen offset:0 sc1
  buffer_load_dwordx4 v[36:39], v12, s[8:11], s24 offen offset:1024 sc1
  buffer_load_dwordx4 v[40:43], v12, s[8:11], s24 offen offset:2048 sc1
  buffer_load_dwordx4 v[44:47], v12, s[8:11], s24 offen offset:3072 sc1
  buffer_load_dwordx4 v[48:51], v12, s[8:11], s25 offen offset:0 sc1
  buffer_load_dwordx4 v[52:55], v12, s[8:11], s25 offen offset:1024 sc1
  s_add_u32 s50, s50, 1
  s_cmp_gt_u32 s50, 131072
  s_cbranch_scc1 L_fail
  s_waitcnt vmcnt(0) lgkmcnt(0)
  v_max_u32 v136, v16, v17
  v_max3_u32 v136, v18, v19, v136
  v_max3_u32 v136, v20, v21, v136
  v_max3_u32 v136, v22, v23, v136
  v_max3_u32 v136, v24, v25, v136
  v_max3_u32 v136, v26, v27, v136
  v_max3_u32 v136, v28, v29, v136
  v_max3_u32 v136, v30, v31, v136
  v_max3_u32 v136, v32, v33, v136
  v_max3_u32 v136, v34, v35, v136
  v_max3_u32 v136, v36, v37, v136
  v_max3_u32 v136, v38, v39, v136
  v_max3_u32 v136, v40, v41, v136
  v_max3_u32 v136, v42, v43, v136
  v_max3_u32 v136, v44, v45, v136
  v_max3_u32 v136, v46, v47, v136
  v_max3_u32 v136, v48, v49, v136
  v_max3_u32 v136, v50, v51, v136
  v_max3_u32 v136, v52, v53, v136
  v_max3_u32 v136, v54, v55, v136
  v_cmp_eq_u32 vcc, -1, v136
  s_cbranch_vccnz sch_poll
  s_mov_b64 s[16:17], 0
  ds_read_b128 v[56:59], v2 offset:0
  ds_read_b128 v[60:63], v2 offset:4096
  ds_read_b128 v[64:67], v2 offset:8192
  ds_read_b128 v[68:71], v2 offset:12288
  ds_read_b128 v[72:75], v2 offset:16384
  ds_read_b128 v[76:79], v2 offset:20480
  ds_read_b128 v[80:83], v2 offset:49152
  ds_read_b128 v[84:87], v2 offset:53248
  v_mov_b32 v88, 0
  v_mov_b32 v89, 0
  v_mov_b32 v90, 0
  v_mov_b32 v91, 0
  v_mov_b32 v92, 0
  v_mov_b32 v93, 0
  v_mov_b32 v94, 0
  v_mov_b32 v95, 0
  v_mov_b32 v96, 0
  v_mov_b32 v97, 0
  v_mov_b32 v98, 0
  v_mov_b32 v99, 0
  v_mov_b32 v100, 0
  v_mov_b32 v101, 0
  v_mov_b32 v102, 0
  v_mov_b32 v103, 0
  v_mov_b32 v104, 0
  v_mov_b32 v105, 0
  v_mov_b32 v106, 0
  v_mov_b32 v107, 0
  v_mov_b32 v108, 0
  v_mov_b32 v109, 0
  v_mov_b32 v110, 0
  v_mov_b32 v111, 0
  s_waitcnt lgkmcnt(0)
  v_smfmac_f32_16x16x64_bf16 v[88:91], v[16:19], a[192:199], v7
  v_smfmac_f32_16x16x64_bf16 v[92:95], v[16:19], a[200:207], v7
  v_smfmac_f32_16x16x64_bf16 v[96:99], v[16:19], a[208:215], v7
  v_smfmac_f32_16x16x64_bf16 v[100:103], v[16:19], v[56:63], v7
  v_smfmac_f32_16x16x64_bf16 v[104:107], v[16:19], v[64:71], v7
  ds_read_b128 v[56:59], v2 offset:57344
  v_smfmac_f32_16x16x64_bf16 v[108:111], v[16:19], v[72:79], v7
  ds_read_b128 v[60:63], v2 offset:61440
  v_smfmac_f32_16x16x64_bf16 v[88:91], v[20:23], a[216:223], v7
  ds_read_b128 v[64:67], v3 offset:0
  v_smfmac_f32_16x16x64_bf16 v[92:95], v[20:23], a[224:231], v7
  ds_read_b128 v[68:71], v3 offset:4096
  v_smfmac_f32_16x16x64_bf16 v[96:99], v[20:23], a[232:239], v7
  v_smfmac_f32_16x16x64_bf16 v[100:103], v[20:23], a[0:7], v7
  ds_read_b128 v[72:75], v3 offset:8192
  v_smfmac_f32_16x16x64_bf16 v[104:107], v[20:23], a[8:15], v7
  ds_read_b128 v[76:79], v3 offset:12288
  v_smfmac_f32_16x16x64_bf16 v[108:111], v[20:23], a[16:23], v7
  v_smfmac_f32_16x16x64_bf16 v[88:91], v[24:27], a[240:247], v7
  v_smfmac_f32_16x16x64_bf16 v[92:95], v[24:27], a[248:255], v7
  v_smfmac_f32_16x16x64_bf16 v[96:99], v[24:27], v[152:159], v7
  v_smfmac_f32_16x16x64_bf16 v[100:103], v[24:27], a[24:31], v7
  v_smfmac_f32_16x16x64_bf16 v[104:107], v[24:27], a[32:39], v7
  v_smfmac_f32_16x16x64_bf16 v[108:111], v[24:27], a[40:47], v7
  v_smfmac_f32_16x16x64_bf16 v[88:91], v[28:31], v[80:87], v7
  s_waitcnt lgkmcnt(0)
  v_smfmac_f32_16x16x64_bf16 v[92:95], v[28:31], v[56:63], v7
  v_smfmac_f32_16x16x64_bf16 v[96:99], v[28:31], v[64:71], v7
  v_smfmac_f32_16x16x64_bf16 v[88:91], v[32:35], v[160:167], v7
  ds_read_b128 v[80:83], v3 offset:32768
  v_smfmac_f32_16x16x64_bf16 v[92:95], v[32:35], v[168:175], v7
  ds_read_b128 v[84:87], v3 offset:36864
  v_smfmac_f32_16x16x64_bf16 v[96:99], v[32:35], v[176:183], v7
  ds_read_b128 v[56:59], v3 offset:16384
  v_smfmac_f32_16x16x64_bf16 v[88:91], v[36:39], v[184:191], v7
  v_smfmac_f32_16x16x64_bf16 v[92:95], v[36:39], v[192:199], v7
  ds_read_b128 v[60:63], v3 offset:20480
  v_smfmac_f32_16x16x64_bf16 v[96:99], v[36:39], v[200:207], v7
  ds_read_b128 v[64:67], v3 offset:40960
  v_smfmac_f32_16x16x64_bf16 v[88:91], v[44:47], v[208:215], v7
  ds_read_b128 v[68:71], v3 offset:45056
  v_smfmac_f32_16x16x64_bf16 v[88:91], v[48:51], v[232:239], v7
  v_smfmac_f32_16x16x64_bf16 v[88:91], v[40:43], v[72:79], v7
  s_waitcnt lgkmcnt(3)
  v_smfmac_f32_16x16x64_bf16 v[88:91], v[52:55], v[80:87], v7
  ds_read_b128 v[72:75], v3 offset:24576
  s_mov_b32 m0, s21
  s_waitcnt lgkmcnt(0)
  s_branch sch_join
L_value:
  s_mov_b32 s4, s30
  s_mov_b32 s5, s31
  s_mov_b32 s6, 7864320
  s_mov_b32 s7, 0x20000
  s_mov_b32 s12, s32
  s_mov_b32 s13, s33
  s_mov_b32 s14, 7864320
  s_mov_b32 s15, 0x20000
  v_lshrrev_b32 v148, 3, v0
  v_lshrrev_b32 v149, 2, v148
  v_lshlrev_b32 v149, 3, v149
  v_and_b32 v64, 3, v148
  v_add_u32 v64, v64, v149
  s_and_b32 s46, s42, 1
  s_lshl_b32 s46, s46, 2
  s_lshr_b32 s47, s42, 1
  s_lshl_b32 s47, s47, 4
  s_add_u32 s46, s46, s47
  v_add_u32 v64, s46, v64
  v_mul_u32_u24 v64, 12288, v64
  v_lshrrev_b32 v148, 1, v148
  v_bfe_u32 v149, v0, 1, 2
  v_xor_b32 v148, v148, v149
  v_lshlrev_b32 v148, 5, v148
  v_and_b32 v149, 1, v0
  v_lshlrev_b32 v149, 4, v149
  v_add3_u32 v64, v64, v148, v149
  v_lshrrev_b32 v148, 3, v0
  v_lshrrev_b32 v149, 2, v148
  v_lshlrev_b32 v149, 3, v149
  v_and_b32 v65, 3, v148
  v_add_u32 v65, v65, v149
  s_and_b32 s46, s42, 1
  s_lshl_b32 s46, s46, 2
  s_lshr_b32 s47, s42, 1
  s_lshl_b32 s47, s47, 4
  s_add_u32 s46, s46, s47
  v_add_u32 v65, s46, v65
  v_mul_u32_u24 v65, 1280, v65
  v_lshrrev_b32 v148, 1, v148
  v_bfe_u32 v149, v0, 1, 2
  v_xor_b32 v148, v148, v149
  v_lshlrev_b32 v148, 5, v148
  v_and_b32 v149, 1, v0
  v_lshlrev_b32 v149, 4, v149
  v_add3_u32 v65, v65, v148, v149
  v_lshrrev_b32 v148, 5, v0
  v_lshlrev_b32 v66, 11, v148
  v_bfe_u32 v148, v0, 2, 3
  v_lshl_add_u32 v66, v148, 7, v66
  v_lshrrev_b32 v148, 1, v148
  v_xor_b32 v148, s42, v148
  v_lshl_add_u32 v66, v148, 5, v66
  v_and_b32 v148, 3, v0
  v_lshl_add_u32 v66, v148, 3, v66
  v_add_u32 v67, 0x10000, v66
  v_add_u32 v68, 0x20000, v66
  v_lshlrev_b32 v1, 4, v0
  v_add_u32 v2, s51, v1
  v_add_u32 v3, 0x10000, v2
  s_mul_i32 s62, s45, 384
  s_mul_i32 s63, s45, 245760
  s_mov_b32 s24, 4096
  s_mov_b32 s25, 49152
  s_add_u32 m0, s51, 73728
  s_add_u32 s46, s62, 786432
  buffer_load_dwordx4 v64, s[4:7], s46 offen  lds
  s_add_u32 m0, s51, 77824
  s_add_u32 s46, s62, 1179648
  buffer_load_dwordx4 v64, s[4:7], s46 offen  lds
  s_add_u32 m0, s51, 81920
  s_add_u32 s46, s62, 786560
  buffer_load_dwordx4 v64, s[4:7], s46 offen  lds
  s_add_u32 m0, s51, 86016
  s_add_u32 s46, s62, 1179776
  buffer_load_dwordx4 v64, s[4:7], s46 offen  lds
  s_add_u32 m0, s51, 90112
  s_add_u32 s46, s62, 786688
  buffer_load_dwordx4 v64, s[4:7], s46 offen  lds
  s_add_u32 m0, s51, 94208
  s_add_u32 s46, s62, 1179904
  buffer_load_dwordx4 v64, s[4:7], s46 offen  lds
  s_add_u32 m0, s51, 98304
  s_add_u32 s46, s62, 1572864
  buffer_load_dwordx4 v64, s[4:7], s46 offen  lds
  s_add_u32 m0, s51, 102400
  s_add_u32 s46, s62, 1966080
  buffer_load_dwordx4 v64, s[4:7], s46 offen  lds
  s_add_u32 m0, s51, 106496
  s_add_u32 s46, s62, 1572992
  buffer_load_dwordx4 v64, s[4:7], s46 offen  lds
  s_add_u32 m0, s51, 110592
  s_add_u32 s46, s62, 1966208
  buffer_load_dwordx4 v64, s[4:7], s46 offen  lds
  s_add_u32 m0, s51, 114688
  s_add_u32 s46, s62, 1573120
  buffer_load_dwordx4 v64, s[4:7], s46 offen  lds
  s_add_u32 m0, s51, 118784
  s_add_u32 s46, s62, 1966336
  buffer_load_dwordx4 v64, s[4:7], s46 offen  lds
  s_add_u32 m0, s51, 122880
  s_add_u32 s46, s62, 2359296
  buffer_load_dwordx4 v64, s[4:7], s46 offen  lds
  s_add_u32 m0, s51, 126976
  s_add_u32 s46, s62, 2752512
  buffer_load_dwordx4 v64, s[4:7], s46 offen  lds
  s_add_u32 m0, s51, 131072
  s_add_u32 s46, s62, 2359424
  buffer_load_dwordx4 v64, s[4:7], s46 offen  lds
  s_add_u32 m0, s51, 135168
  s_add_u32 s46, s62, 2752640
  buffer_load_dwordx4 v64, s[4:7], s46 offen  lds
  s_add_u32 m0, s51, 139264
  s_add_u32 s46, s62, 2359552
  buffer_load_dwordx4 v64, s[4:7], s46 offen  lds
  s_add_u32 m0, s51, 143360
  s_add_u32 s46, s62, 2752768
  buffer_load_dwordx4 v64, s[4:7], s46 offen  lds
  s_add_u32 m0, s51, 0
  s_add_u32 s46, s62, 3932160
  buffer_load_dwordx4 v64, s[4:7], s46 offen  lds
  s_add_u32 m0, s51, 4096
  s_add_u32 s46, s62, 4325376
  buffer_load_dwordx4 v64, s[4:7], s46 offen  lds
  s_add_u32 m0, s51, 8192
  s_add_u32 s46, s62, 3932288
  buffer_load_dwordx4 v64, s[4:7], s46 offen  lds
  s_add_u32 m0, s51, 12288
  s_add_u32 s46, s62, 4325504
  buffer_load_dwordx4 v64, s[4:7], s46 offen  lds
  s_add_u32 m0, s51, 16384
  s_add_u32 s46, s62, 3932416
  buffer_load_dwordx4 v64, s[4:7], s46 offen  lds
  s_add_u32 m0, s51, 20480
  s_add_u32 s46, s62, 4325632
  buffer_load_dwordx4 v64, s[4:7], s46 offen  lds
  s_add_u32 m0, s51, 24576
  s_add_u32 s46, s62, 4718592
  buffer_load_dwordx4 v64, s[4:7], s46 offen  lds
  s_add_u32 m0, s51, 28672
  s_add_u32 s46, s62, 5111808
  buffer_load_dwordx4 v64, s[4:7], s46 offen  lds
  s_add_u32 m0, s51, 32768
  s_add_u32 s46, s62, 4718720
  buffer_load_dwordx4 v64, s[4:7], s46 offen  lds
  s_add_u32 m0, s51, 36864
  s_add_u32 s46, s62, 5111936
  buffer_load_dwordx4 v64, s[4:7], s46 offen  lds
  s_add_u32 m0, s51, 40960
  s_add_u32 s46, s62, 4718848
  buffer_load_dwordx4 v64, s[4:7], s46 offen  lds
  s_add_u32 m0, s51, 45056
  s_add_u32 s46, s62, 5112064
  buffer_load_dwordx4 v64, s[4:7], s46 offen  lds
  s_waitcnt vmcnt(24)
  s_barrier
  s_add_u32 m0, s51, 49152
  s_add_u32 s46, s62, 5505024
  buffer_load_dwordx4 v64, s[4:7], s46 offen  lds
  s_add_u32 m0, s51, 53248
  s_add_u32 s46, s62, 5898240
  buffer_load_dwordx4 v64, s[4:7], s46 offen  lds
  s_add_u32 m0, s51, 57344
  s_add_u32 s46, s62, 5505152
  buffer_load_dwordx4 v64, s[4:7], s46 offen  lds
  s_add_u32 m0, s51, 61440
  s_add_u32 s46, s62, 5898368
  buffer_load_dwordx4 v64, s[4:7], s46 offen  lds
  s_add_u32 m0, s51, 65536
  s_add_u32 s46, s62, 5505280
  buffer_load_dwordx4 v64, s[4:7], s46 offen  lds
  s_add_u32 m0, s51, 69632
  s_add_u32 s46, s62, 5898496
  buffer_load_dwordx4 v64, s[4:7], s46 offen  lds
  ds_read_b64_tr_b16 a[0:1], v67 offset:8192
  ds_read_b64_tr_b16 a[2:3], v67 offset:9216
  ds_read_b64_tr_b16 a[4:5], v67 offset:12288
  ds_read_b64_tr_b16 a[6:7], v67 offset:13312
  ds_read_b64_tr_b16 a[8:9], v67 offset:16384
  ds_read_b64_tr_b16 a[10:11], v67 offset:17408
  ds_read_b64_tr_b16 a[12:13], v67 offset:20480
  ds_read_b64_tr_b16 a[14:15], v67 offset:21504
  ds_read_b64_tr_b16 a[16:17], v67 offset:24576
  ds_read_b64_tr_b16 a[18:19], v67 offset:25600
  ds_read_b64_tr_b16 a[20:21], v67 offset:28672
  ds_read_b64_tr_b16 a[22:23], v67 offset:29696
  s_waitcnt lgkmcnt(0)
  s_waitcnt vmcnt(24)
  s_barrier
  s_add_u32 m0, s51, 73728
  s_add_u32 s46, s62, 7077888
  buffer_load_dwordx4 v64, s[4:7], s46 offen  lds
  s_add_u32 m0, s51, 77824
  s_add_u32 s46, s62, 7471104
  buffer_load_dwordx4 v64, s[4:7], s46 offen  lds
  s_add_u32 m0, s51, 81920
  s_add_u32 s46, s62, 7078016
  buffer_load_dwordx4 v64, s[4:7], s46 offen  lds
  s_add_u32 m0, s51, 86016
  s_add_u32 s46, s62, 7471232
  buffer_load_dwordx4 v64, s[4:7], s46 offen  lds
  s_add_u32 m0, s51, 90112
  s_add_u32 s46, s62, 7078144
  buffer_load_dwordx4 v64, s[4:7], s46 offen  lds
  s_add_u32 m0, s51, 94208
  s_add_u32 s46, s62, 7471360
  buffer_load_dwordx4 v64, s[4:7], s46 offen  lds
  ds_read_b64_tr_b16 a[24:25], v67 offset:32768
  ds_read_b64_tr_b16 a[26:27], v67 offset:33792
  ds_read_b64_tr_b16 a[28:29], v67 offset:36864
  ds_read_b64_tr_b16 a[30:31], v67 offset:37888
  ds_read_b64_tr_b16 a[32:33], v67 offset:40960
  ds_read_b64_tr_b16 a[34:35], v67 offset:41984
  ds_read_b64_tr_b16 a[36:37], v67 offset:45056
  ds_read_b64_tr_b16 a[38:39], v67 offset:46080
  ds_read_b64_tr_b16 a[40:41], v67 offset:49152
  ds_read_b64_tr_b16 a[42:43], v67 offset:50176
  ds_read_b64_tr_b16 a[44:45], v67 offset:53248
  ds_read_b64_tr_b16 a[46:47], v67 offset:54272
  s_waitcnt lgkmcnt(0)
  s_waitcnt vmcnt(24)
  s_barrier
  s_add_u32 m0, s51, 98304
  s_add_u32 s46, s63, 0
  buffer_load_dwordx4 v65, s[12:15], s46 offen  lds
  s_add_u32 m0, s51, 102400
  s_add_u32 s46, s63, 40960
  buffer_load_dwordx4 v65, s[12:15], s46 offen  lds
  s_add_u32 m0, s51, 106496
  s_add_u32 s46, s63, 81920
  buffer_load_dwordx4 v65, s[12:15], s46 offen  lds
  s_add_u32 m0, s51, 110592
  s_add_u32 s46, s63, 122880
  buffer_load_dwordx4 v65, s[12:15], s46 offen  lds
  s_add_u32 m0, s51, 114688
  s_add_u32 s46, s63, 163840
  buffer_load_dwordx4 v65, s[12:15], s46 offen  lds
  s_add_u32 m0, s51, 118784
  s_add_u32 s46, s63, 204800
  buffer_load_dwordx4 v65, s[12:15], s46 offen  lds
  ds_read_b64_tr_b16 a[48:49], v67 offset:57344
  ds_read_b64_tr_b16 a[50:51], v67 offset:58368
  ds_read_b64_tr_b16 a[52:53], v67 offset:61440
  ds_read_b64_tr_b16 a[54:55], v67 offset:62464
  ds_read_b64_tr_b16 a[56:57], v68 offset:0
  ds_read_b64_tr_b16 a[58:59], v68 offset:1024
  ds_read_b64_tr_b16 a[60:61], v68 offset:4096
  ds_read_b64_tr_b16 a[62:63], v68 offset:5120
  ds_read_b64_tr_b16 a[64:65], v68 offset:8192
  ds_read_b64_tr_b16 a[66:67], v68 offset:9216
  ds_read_b64_tr_b16 a[68:69], v68 offset:12288
  ds_read_b64_tr_b16 a[70:71], v68 offset:13312
  s_waitcnt lgkmcnt(0)
  s_waitcnt vmcnt(24)
  s_barrier
  s_add_u32 m0, s51, 122880
  s_add_u32 s46, s63, 128
  buffer_load_dwordx4 v65, s[12:15], s46 offen  lds
  s_add_u32 m0, s51, 126976
  s_add_u32 s46, s63, 41088
  buffer_load_dwordx4 v65, s[12:15], s46 offen  lds
  s_add_u32 m0, s51, 131072
  s_add_u32 s46, s63, 82048
  buffer_load_dwordx4 v65, s[12:15], s46 offen  lds
  s_add_u32 m0, s51, 135168
  s_add_u32 s46, s63, 123008
  buffer_load_dwordx4 v65, s[12:15], s46 offen  lds
  s_add_u32 m0, s51, 139264
  s_add_u32 s46, s63, 163968
  buffer_load_dwordx4 v65, s[12:15], s46 offen  lds
  s_add_u32 m0, s51, 143360
  s_add_u32 s46, s63, 204928
  buffer_load_dwordx4 v65, s[12:15], s46 offen  lds
  ds_read_b64_tr_b16 a[72:73], v66 offset:0
  ds_read_b64_tr_b16 a[74:75], v66 offset:1024
  ds_read_b64_tr_b16 a[76:77], v66 offset:4096
  ds_read_b64_tr_b16 a[78:79], v66 offset:5120
  ds_read_b64_tr_b16 a[80:81], v66 offset:8192
  ds_read_b64_tr_b16 a[82:83], v66 offset:9216
  ds_read_b64_tr_b16 a[84:85], v66 offset:12288
  ds_read_b64_tr_b16 a[86:87], v66 offset:13312
  ds_read_b64_tr_b16 a[88:89], v66 offset:16384
  ds_read_b64_tr_b16 a[90:91], v66 offset:17408
  ds_read_b64_tr_b16 a[92:93], v66 offset:20480
  ds_read_b64_tr_b16 a[94:95], v66 offset:21504
  s_waitcnt lgkmcnt(0)
  s_waitcnt vmcnt(24)
  s_barrier
  s_add_u32 m0, s51, 0
  s_add_u32 s46, s63, 256
  buffer_load_dwordx4 v65, s[12:15], s46 offen  lds
  s_add_u32 m0, s51, 4096
  s_add_u32 s46, s63, 41216
  buffer_load_dwordx4 v65, s[12:15], s46 offen  lds
  s_add_u32 m0, s51, 8192
  s_add_u32 s46, s63, 82176
  buffer_load_dwordx4 v65, s[12:15], s46 offen  lds
  s_add_u32 m0, s51, 12288
  s_add_u32 s46, s63, 123136
  buffer_load_dwordx4 v65, s[12:15], s46 offen  lds
  s_add_u32 m0, s51, 16384
  s_add_u32 s46, s63, 164096
  buffer_load_dwordx4 v65, s[12:15], s46 offen  lds
  s_add_u32 m0, s51, 20480
  s_add_u32 s46, s63, 205056
  buffer_load_dwordx4 v65, s[12:15], s46 offen  lds
  ds_read_b64_tr_b16 a[96:97], v66 offset:24576
  ds_read_b64_tr_b16 a[98:99], v66 offset:25600
  ds_read_b64_tr_b16 a[100:101], v66 offset:28672
  ds_read_b64_tr_b16 a[102:103], v66 offset:29696
  ds_read_b64_tr_b16 a[104:105], v66 offset:32768
  ds_read_b64_tr_b16 a[106:107], v66 offset:33792
  ds_read_b64_tr_b16 a[108:109], v66 offset:36864
  ds_read_b64_tr_b16 a[110:111], v66 offset:37888
  ds_read_b64_tr_b16 a[112:113], v66 offset:40960
  ds_read_b64_tr_b16 a[114:115], v66 offset:41984
  ds_read_b64_tr_b16 a[116:117], v66 offset:45056
  ds_read_b64_tr_b16 a[118:119], v66 offset:46080
  s_waitcnt lgkmcnt(0)
  s_waitcnt vmcnt(24)
  s_barrier
  s_add_u32 m0, s51, 24576
  s_add_u32 s46, s63, 512
  buffer_load_dwordx4 v65, s[12:15], s46 offen  lds
  s_add_u32 m0, s51, 28672
  s_add_u32 s46, s63, 41472
  buffer_load_dwordx4 v65, s[12:15], s46 offen  lds
  s_add_u32 m0, s51, 32768
  s_add_u32 s46, s63, 82432
  buffer_load_dwordx4 v65, s[12:15], s46 offen  lds
  s_add_u32 m0, s51, 36864
  s_add_u32 s46, s63, 123392
  buffer_load_dwordx4 v65, s[12:15], s46 offen  lds
  s_add_u32 m0, s51, 40960
  s_add_u32 s46, s63, 164352
  buffer_load_dwordx4 v65, s[12:15], s46 offen  lds
  s_add_u32 m0, s51, 45056
  s_add_u32 s46, s63, 205312
  buffer_load_dwordx4 v65, s[12:15], s46 offen  lds
  ds_read_b64_tr_b16 a[120:121], v66 offset:49152
  ds_read_b64_tr_b16 a[122:123], v66 offset:50176
  ds_read_b64_tr_b16 a[124:125], v66 offset:53248
  ds_read_b64_tr_b16 a[126:127], v66 offset:54272
  ds_read_b64_tr_b16 a[128:129], v66 offset:57344
  ds_read_b64_tr_b16 a[130:131], v66 offset:58368
  ds_read_b64_tr_b16 a[132:133], v66 offset:61440
  ds_read_b64_tr_b16 a[134:135], v66 offset:62464
  ds_read_b64_tr_b16 a[136:137], v67 offset:0
  ds_read_b64_tr_b16 a[138:139], v67 offset:1024
  ds_read_b64_tr_b16 a[140:141], v67 offset:4096
  ds_read_b64_tr_b16 a[142:143], v67 offset:5120
  s_waitcnt lgkmcnt(0)
  s_waitcnt vmcnt(24)
  s_barrier
  s_add_u32 m0, s51, 49152
  s_add_u32 s46, s63, 640
  buffer_load_dwordx4 v65, s[12:15], s46 offen  lds
  s_add_u32 m0, s51, 53248
  s_add_u32 s46, s63, 41600
  buffer_load_dwordx4 v65, s[12:15], s46 offen  lds
  s_add_u32 m0, s51, 57344
  s_add_u32 s46, s63, 82560
  buffer_load_dwordx4 v65, s[12:15], s46 offen  lds
  s_add_u32 m0, s51, 61440
  s_add_u32 s46, s63, 123520
  buffer_load_dwordx4 v65, s[12:15], s46 offen  lds
  s_add_u32 m0, s51, 65536
  s_add_u32 s46, s63, 164480
  buffer_load_dwordx4 v65, s[12:15], s46 offen  lds
  s_add_u32 m0, s51, 69632
  s_add_u32 s46, s63, 205440
  buffer_load_dwordx4 v65, s[12:15], s46 offen  lds
  ds_read_b64_tr_b16 a[144:145], v67 offset:8192
  ds_read_b64_tr_b16 a[146:147], v67 offset:9216
  ds_read_b64_tr_b16 a[148:149], v67 offset:12288
  ds_read_b64_tr_b16 a[150:151], v67 offset:13312
  ds_read_b64_tr_b16 a[152:153], v67 offset:16384
  ds_read_b64_tr_b16 a[154:155], v67 offset:17408
  ds_read_b64_tr_b16 a[156:157], v67 offset:20480
  ds_read_b64_tr_b16 a[158:159], v67 offset:21504
  ds_read_b64_tr_b16 a[160:161], v67 offset:24576
  ds_read_b64_tr_b16 a[162:163], v67 offset:25600
  ds_read_b64_tr_b16 a[164:165], v67 offset:28672
  ds_read_b64_tr_b16 a[166:167], v67 offset:29696
  s_waitcnt lgkmcnt(0)
  s_waitcnt vmcnt(24)
  s_barrier
  s_add_u32 m0, s51, 73728
  s_add_u32 s46, s63, 768
  buffer_load_dwordx4 v65, s[12:15], s46 offen  lds
  s_add_u32 m0, s51, 77824
  s_add_u32 s46, s63, 41728
  buffer_load_dwordx4 v65, s[12:15], s46 offen  lds
  s_add_u32 m0, s51, 81920
  s_add_u32 s46, s63, 82688
  buffer_load_dwordx4 v65, s[12:15], s46 offen  lds
  s_add_u32 m0, s51, 86016
  s_add_u32 s46, s63, 123648
  buffer_load_dwordx4 v65, s[12:15], s46 offen  lds
  s_add_u32 m0, s51, 90112
  s_add_u32 s46, s63, 164608
  buffer_load_dwordx4 v65, s[12:15], s46 offen  lds
  s_add_u32 m0, s51, 94208
  s_add_u32 s46, s63, 205568
  buffer_load_dwordx4 v65, s[12:15], s46 offen  lds
  ds_read_b64_tr_b16 a[168:169], v67 offset:32768
  ds_read_b64_tr_b16 a[170:171], v67 offset:33792
  ds_read_b64_tr_b16 a[172:173], v67 offset:36864
  ds_read_b64_tr_b16 a[174:175], v67 offset:37888
  ds_read_b64_tr_b16 a[176:177], v67 offset:40960
  ds_read_b64_tr_b16 a[178:179], v67 offset:41984
  ds_read_b64_tr_b16 a[180:181], v67 offset:45056
  ds_read_b64_tr_b16 a[182:183], v67 offset:46080
  ds_read_b64_tr_b16 a[184:185], v67 offset:49152
  ds_read_b64_tr_b16 a[186:187], v67 offset:50176
  ds_read_b64_tr_b16 a[188:189], v67 offset:53248
  ds_read_b64_tr_b16 a[190:191], v67 offset:54272
  s_waitcnt lgkmcnt(0)
  s_waitcnt vmcnt(24)
  s_barrier
  s_add_u32 m0, s51, 98304
  s_add_u32 s46, s63, 896
  buffer_load_dwordx4 v65, s[12:15], s46 offen  lds
  s_add_u32 m0, s51, 102400
  s_add_u32 s46, s63, 41856
  buffer_load_dwordx4 v65, s[12:15], s46 offen  lds
  s_add_u32 m0, s51, 106496
  s_add_u32 s46, s63, 82816
  buffer_load_dwordx4 v65, s[12:15], s46 offen  lds
  s_add_u32 m0, s51, 110592
  s_add_u32 s46, s63, 123776
  buffer_load_dwordx4 v65, s[12:15], s46 offen  lds
  s_add_u32 m0, s51, 114688
  s_add_u32 s46, s63, 164736
  buffer_load_dwordx4 v65, s[12:15], s46 offen  lds
  s_add_u32 m0, s51, 118784
  s_add_u32 s46, s63, 205696
  buffer_load_dwordx4 v65, s[12:15], s46 offen  lds
  ds_read_b64_tr_b16 a[192:193], v67 offset:57344
  ds_read_b64_tr_b16 a[194:195], v67 offset:58368
  ds_read_b64_tr_b16 a[196:197], v67 offset:61440
  ds_read_b64_tr_b16 a[198:199], v67 offset:62464
  ds_read_b64_tr_b16 a[200:201], v68 offset:0
  ds_read_b64_tr_b16 a[202:203], v68 offset:1024
  ds_read_b64_tr_b16 a[204:205], v68 offset:4096
  ds_read_b64_tr_b16 a[206:207], v68 offset:5120
  ds_read_b64_tr_b16 a[208:209], v68 offset:8192
  ds_read_b64_tr_b16 a[210:211], v68 offset:9216
  ds_read_b64_tr_b16 a[212:213], v68 offset:12288
  ds_read_b64_tr_b16 a[214:215], v68 offset:13312
  s_waitcnt lgkmcnt(0)
  s_waitcnt vmcnt(24)
  s_barrier
  v_and_b32 v149, 3, v0
  v_lshlrev_b32 v149, 2, v149
  global_load_dword v148, v149, s[38:39] sc1
  s_add_u32 m0, s51, 122880
  s_add_u32 s46, s63, 1152
  buffer_load_dwordx4 v65, s[12:15], s46 offen  lds
  s_add_u32 m0, s51, 126976
  s_add_u32 s46, s63, 42112
  buffer_load_dwordx4 v65, s[12:15], s46 offen  lds
  s_add_u32 m0, s51, 131072
  s_add_u32 s46, s63, 83072
  buffer_load_dwordx4 v65, s[12:15], s46 offen  lds
  s_add_u32 m0, s51, 135168
  s_add_u32 s46, s63, 124032
  buffer_load_dwordx4 v65, s[12:15], s46 offen  lds
  s_add_u32 m0, s51, 139264
  s_add_u32 s46, s63, 164992
  buffer_load_dwordx4 v65, s[12:15], s46 offen  lds
  s_add_u32 m0, s51, 143360
  s_add_u32 s46, s63, 205952
  buffer_load_dwordx4 v65, s[12:15], s46 offen  lds
  ds_read_b64_tr_b16 a[216:217], v66 offset:0
  ds_read_b64_tr_b16 a[218:219], v66 offset:1024
  ds_read_b64_tr_b16 a[220:221], v66 offset:4096
  ds_read_b64_tr_b16 a[222:223], v66 offset:5120
  ds_read_b64_tr_b16 a[224:225], v66 offset:8192
  ds_read_b64_tr_b16 a[226:227], v66 offset:9216
  ds_read_b64_tr_b16 a[228:229], v66 offset:12288
  ds_read_b64_tr_b16 a[230:231], v66 offset:13312
  ds_read_b64_tr_b16 a[232:233], v66 offset:16384
  ds_read_b64_tr_b16 a[234:235], v66 offset:17408
  ds_read_b64_tr_b16 a[236:237], v66 offset:20480
  ds_read_b64_tr_b16 a[238:239], v66 offset:21504
  s_waitcnt lgkmcnt(0)
  s_waitcnt vmcnt(25)
  s_barrier
  s_add_u32 m0, s51, 0
  s_add_u32 s46, s62, 0
  buffer_load_dwordx4 v64, s[4:7], s46 offen  lds
  s_add_u32 m0, s51, 4096
  s_add_u32 s46, s62, 393216
  buffer_load_dwordx4 v64, s[4:7], s46 offen  lds
  s_add_u32 m0, s51, 8192
  s_add_u32 s46, s62, 128
  buffer_load_dwordx4 v64, s[4:7], s46 offen  lds
  s_add_u32 m0, s51, 12288
  s_add_u32 s46, s62, 393344
  buffer_load_dwordx4 v64, s[4:7], s46 offen  lds
  s_add_u32 m0, s51, 16384
  s_add_u32 s46, s62, 256
  buffer_load_dwordx4 v64, s[4:7], s46 offen  lds
  s_add_u32 m0, s51, 20480
  s_add_u32 s46, s62, 393472
  buffer_load_dwordx4 v64, s[4:7], s46 offen  lds
  ds_read_b64_tr_b16 a[240:241], v66 offset:24576
  ds_read_b64_tr_b16 a[242:243], v66 offset:25600
  ds_read_b64_tr_b16 a[244:245], v66 offset:28672
  ds_read_b64_tr_b16 a[246:247], v66 offset:29696
  ds_read_b64_tr_b16 a[248:249], v66 offset:32768
  ds_read_b64_tr_b16 a[250:251], v66 offset:33792
  ds_read_b64_tr_b16 a[252:253], v66 offset:36864
  ds_read_b64_tr_b16 a[254:255], v66 offset:37888
  ds_read_b64_tr_b16 v[152:153], v66 offset:40960
  ds_read_b64_tr_b16 v[154:155], v66 offset:41984
  ds_read_b64_tr_b16 v[156:157], v66 offset:45056
  ds_read_b64_tr_b16 v[158:159], v66 offset:46080
  s_waitcnt lgkmcnt(0)
  s_waitcnt vmcnt(25)
  s_barrier
  s_add_u32 m0, s51, 24576
  s_add_u32 s46, s62, 3145728
  buffer_load_dwordx4 v64, s[4:7], s46 offen  lds
  s_add_u32 m0, s51, 28672
  s_add_u32 s46, s62, 3538944
  buffer_load_dwordx4 v64, s[4:7], s46 offen  lds
  s_add_u32 m0, s51, 32768
  s_add_u32 s46, s62, 3145856
  buffer_load_dwordx4 v64, s[4:7], s46 offen  lds
  s_add_u32 m0, s51, 36864
  s_add_u32 s46, s62, 3539072
  buffer_load_dwordx4 v64, s[4:7], s46 offen  lds
  s_add_u32 m0, s51, 40960
  s_add_u32 s46, s62, 3145984
  buffer_load_dwordx4 v64, s[4:7], s46 offen  lds
  s_add_u32 m0, s51, 45056
  s_add_u32 s46, s62, 3539200
  buffer_load_dwordx4 v64, s[4:7], s46 offen  lds
  ds_read_b64_tr_b16 v[160:161], v66 offset:49152
  ds_read_b64_tr_b16 v[162:163], v66 offset:50176
  ds_read_b64_tr_b16 v[164:165], v66 offset:53248
  ds_read_b64_tr_b16 v[166:167], v66 offset:54272
  ds_read_b64_tr_b16 v[168:169], v66 offset:57344
  ds_read_b64_tr_b16 v[170:171], v66 offset:58368
  ds_read_b64_tr_b16 v[172:173], v66 offset:61440
  ds_read_b64_tr_b16 v[174:175], v66 offset:62464
  ds_read_b64_tr_b16 v[176:177], v67 offset:0
  ds_read_b64_tr_b16 v[178:179], v67 offset:1024
  ds_read_b64_tr_b16 v[180:181], v67 offset:4096
  ds_read_b64_tr_b16 v[182:183], v67 offset:5120
  s_waitcnt lgkmcnt(0)
  s_waitcnt vmcnt(25)
  s_barrier
  s_add_u32 m0, s51, 49152
  s_add_u32 s46, s62, 6291456
  buffer_load_dwordx4 v64, s[4:7], s46 offen  lds
  s_add_u32 m0, s51, 53248
  s_add_u32 s46, s62, 6684672
  buffer_load_dwordx4 v64, s[4:7], s46 offen  lds
  s_add_u32 m0, s51, 57344
  s_add_u32 s46, s62, 6291584
  buffer_load_dwordx4 v64, s[4:7], s46 offen  lds
  s_add_u32 m0, s51, 61440
  s_add_u32 s46, s62, 6684800
  buffer_load_dwordx4 v64, s[4:7], s46 offen  lds
  s_add_u32 m0, s51, 65536
  s_add_u32 s46, s62, 6291712
  buffer_load_dwordx4 v64, s[4:7], s46 offen  lds
  s_add_u32 m0, s51, 69632
  s_add_u32 s46, s62, 6684928
  buffer_load_dwordx4 v64, s[4:7], s46 offen  lds
  ds_read_b64_tr_b16 v[184:185], v67 offset:8192
  ds_read_b64_tr_b16 v[186:187], v67 offset:9216
  ds_read_b64_tr_b16 v[188:189], v67 offset:12288
  ds_read_b64_tr_b16 v[190:191], v67 offset:13312
  ds_read_b64_tr_b16 v[192:193], v67 offset:16384
  ds_read_b64_tr_b16 v[194:195], v67 offset:17408
  ds_read_b64_tr_b16 v[196:197], v67 offset:20480
  ds_read_b64_tr_b16 v[198:199], v67 offset:21504
  ds_read_b64_tr_b16 v[200:201], v67 offset:24576
  ds_read_b64_tr_b16 v[202:203], v67 offset:25600
  ds_read_b64_tr_b16 v[204:205], v67 offset:28672
  ds_read_b64_tr_b16 v[206:207], v67 offset:29696
  s_waitcnt lgkmcnt(0)
  s_waitcnt vmcnt(25)
  s_barrier
  s_add_u32 m0, s51, 73728
  s_add_u32 s46, s63, 384
  buffer_load_dwordx4 v65, s[12:15], s46 offen  lds
  s_add_u32 m0, s51, 77824
  s_add_u32 s46, s63, 41344
  buffer_load_dwordx4 v65, s[12:15], s46 offen  lds
  s_add_u32 m0, s51, 81920
  s_add_u32 s46, s63, 82304
  buffer_load_dwordx4 v65, s[12:15], s46 offen  lds
  s_add_u32 m0, s51, 86016
  s_add_u32 s46, s63, 123264
  buffer_load_dwordx4 v65, s[12:15], s46 offen  lds
  s_add_u32 m0, s51, 90112
  s_add_u32 s46, s63, 164224
  buffer_load_dwordx4 v65, s[12:15], s46 offen  lds
  s_add_u32 m0, s51, 94208
  s_add_u32 s46, s63, 205184
  buffer_load_dwordx4 v65, s[12:15], s46 offen  lds
  ds_read_b64_tr_b16 v[208:209], v67 offset:32768
  ds_read_b64_tr_b16 v[210:211], v67 offset:33792
  ds_read_b64_tr_b16 v[212:213], v67 offset:36864
  ds_read_b64_tr_b16 v[214:215], v67 offset:37888
  ds_read_b64_tr_b16 v[216:217], v67 offset:40960
  ds_read_b64_tr_b16 v[218:219], v67 offset:41984
  ds_read_b64_tr_b16 v[220:221], v67 offset:45056
  ds_read_b64_tr_b16 v[222:223], v67 offset:46080
  ds_read_b64_tr_b16 v[224:225], v67 offset:49152
  ds_read_b64_tr_b16 v[226:227], v67 offset:50176
  ds_read_b64_tr_b16 v[228:229], v67 offset:53248
  ds_read_b64_tr_b16 v[230:231], v67 offset:54272
  s_waitcnt lgkmcnt(0)
  s_waitcnt vmcnt(24)
  s_barrier
  s_add_u32 m0, s51, 98304
  s_add_u32 s46, s63, 1024
  buffer_load_dwordx4 v65, s[12:15], s46 offen  lds
  s_add_u32 m0, s51, 102400
  s_add_u32 s46, s63, 41984
  buffer_load_dwordx4 v65, s[12:15], s46 offen  lds
  s_add_u32 m0, s51, 106496
  s_add_u32 s46, s63, 82944
  buffer_load_dwordx4 v65, s[12:15], s46 offen  lds
  s_add_u32 m0, s51, 110592
  s_add_u32 s46, s63, 123904
  buffer_load_dwordx4 v65, s[12:15], s46 offen  lds
  s_add_u32 m0, s51, 114688
  s_add_u32 s46, s63, 164864
  buffer_load_dwordx4 v65, s[12:15], s46 offen  lds
  s_add_u32 m0, s51, 118784
  s_add_u32 s46, s63, 205824
  buffer_load_dwordx4 v65, s[12:15], s46 offen  lds
  ds_read_b64_tr_b16 v[232:233], v67 offset:57344
  ds_read_b64_tr_b16 v[234:235], v67 offset:58368
  ds_read_b64_tr_b16 v[236:237], v67 offset:61440
  ds_read_b64_tr_b16 v[238:239], v67 offset:62464
  ds_read_b64_tr_b16 v[240:241], v68 offset:0
  ds_read_b64_tr_b16 v[242:243], v68 offset:1024
  ds_read_b64_tr_b16 v[244:245], v68 offset:4096
  ds_read_b64_tr_b16 v[246:247], v68 offset:5120
  ds_read_b64_tr_b16 v[248:249], v68 offset:8192
  ds_read_b64_tr_b16 v[250:251], v68 offset:9216
  ds_read_b64_tr_b16 v[252:253], v68 offset:12288
  ds_read_b64_tr_b16 v[254:255], v68 offset:13312
  s_waitcnt lgkmcnt(0)
  s_mov_b32 s50, 0
  s_branch ss_25_in
ss_25:
  v_and_b32 v149, 3, v0
  v_lshlrev_b32 v149, 2, v149
  global_load_dword v148, v149, s[38:39] sc1
  s_add_u32 s50, s50, 1
  s_cmp_gt_u32 s50, 131072
  s_cbranch_scc1 L_fail
  s_waitcnt vmcnt(0)
ss_25_in:
  v_readlane_b32 s46, v148, 0
  v_readlane_b32 s47, v148, 2
  v_readlane_b32 s48, v148, 1
  s_nop 0
  s_min_u32 s47, s47, s48
  s_cmp_lg_u32 s46, 0
  s_cselect_b32 s48, 7, 0
  s_add_u32 s46, s46, s2
  s_xor_b32 s49, s46, s43
  s_and_b32 s49, s49, s48
  s_cbranch_scc1 L_reroll
  s_cmp_lg_u32 s47, 0
  s_cbranch_scc1 ss_ok_26
  s_sleep 6
  s_branch ss_25
ss_ok_26:
  v_readlane_b32 s3, v148, 1
  s_nop 0
  s_and_b32 s3, s3, 0x2000
  s_add_u32 s46, s42, 1
  s_lshl_b32 s31, s46, 10
  s_cmp_ge_u32 s46, 8
  s_cselect_b32 s47, 40960, 0
  s_add_u32 s31, s31, s47
  s_cmp_ge_u32 s46, 10
  s_cselect_b32 s31, 2146435072, s31
  s_add_u32 s46, s42, 5
  s_lshl_b32 s32, s46, 10
  s_cmp_ge_u32 s46, 8
  s_cselect_b32 s47, 40960, 0
  s_add_u32 s32, s32, s47
  s_cmp_ge_u32 s46, 10
  s_cselect_b32 s32, 2146435072, s32
  s_add_u32 s46, s42, 9
  s_lshl_b32 s33, s46, 10
  s_cmp_ge_u32 s46, 8
  s_cselect_b32 s47, 40960, 0
  s_add_u32 s33, s33, s47
  s_cmp_ge_u32 s46, 10
  s_cselect_b32 s33, 2146435072, s33
  v_add_u32 v9, 126976, v1
  s_lshr_b32 s46, s44, 4
  s_lshl_b32 s46, s46, 7
  s_lshl_b32 s47, s43, 4
  s_add_u32 s46, s46, s47
  s_and_b32 s47, s44, 15
  s_add_u32 s46, s46, s47
  s_lshl_b32 s46, s46, 7
  s_add_u32 s46, s46, s3
  s_add_u32 s46, s46, 13369344
  s_add_u32 s40, s8, s46
  s_addc_u32 s41, s9, 0
  v_mov_b32 v7, 0x44444444
  v_mov_b32 v148, 0xeeeeeeee
  v_and_b32 v149, 2, v0
  v_cmp_ne_u32 vcc, 0, v149
  s_nop 1
  v_cndmask_b32 v7, v7, v148, vcc
  v_and_b32 v148, 15, v0
  v_lshrrev_b32 v149, 4, v0
  v_lshlrev_b32 v8, 4, v148
  v_lshrrev_b32 v150, 2, v148
  v_lshlrev_b32 v4, 6, v150
  v_and_b32 v150, 1, v148
  v_lshl_add_u32 v4, v150, 5, v4
  v_lshl_add_u32 v4, v149, 3, v4
  v_bfe_u32 v150, v148, 1, 1
  v_lshl_add_u32 v4, v150, 2, v4
  s_and_b32 s46, s42, 1
  s_lshl_b32 s46, s46, 7
  v_xor_b32 v4, s46, v4
  s_lshl_b32 s46, s42, 8
  s_add_u32 s46, s46, 122880
  v_add_u32 v4, s46, v4
  s_lshl_b32 s46, s45, 8
  s_lshl_b32 s47, s42, 14
  s_add_u32 s47, s47, s46
  v_lshl_add_u32 v8, v149, 16, v8
  v_add_u32 v8, s47, v8
  v_lshrrev_b32 v150, 1, v149
  v_lshl_add_u32 v13, v150, 30, v8
  v_mul_u32_u24 v150, 131064, v150
  v_sub_u32 v8, v8, v150
  v_lshlrev_b32 v5, 8, v149
  v_and_b32 v150, 1, v149
  v_lshl_add_u32 v5, v150, 7, v5
  v_lshl_add_u32 v5, v148, 3, v5
  v_xor_b32 v6, 0x80, v5
  v_add_u32 v5, 122880, v5
  v_add_u32 v6, 122880, v6
  s_lshl_b32 s46, s45, 7
  s_lshl_b32 s47, s42, 2
  s_add_u32 s47, s47, s46
  s_add_u32 s47, s47, 1064960
  v_mov_b32 v15, s47
  s_mov_b32 s52, 0
  s_mov_b32 s58, 0
  s_mov_b32 s54, 0
  s_mov_b32 s100, 0
  s_waitcnt vmcnt(24)
  s_barrier
  ds_read_b64_tr_b16 v[40:41], v66 offset:0
  ds_read_b64_tr_b16 v[42:43], v66 offset:1024
  ds_read_b64_tr_b16 v[44:45], v66 offset:4096
  ds_read_b64_tr_b16 v[46:47], v66 offset:5120
  ds_read_b64_tr_b16 v[48:49], v66 offset:8192
  ds_read_b64_tr_b16 v[50:51], v66 offset:9216
  ds_read_b64_tr_b16 v[52:53], v66 offset:12288
  ds_read_b64_tr_b16 v[54:55], v66 offset:13312
  ds_read_b64_tr_b16 v[56:57], v66 offset:16384
  ds_read_b64_tr_b16 v[58:59], v66 offset:17408
  ds_read_b64_tr_b16 v[60:61], v66 offset:20480
  ds_read_b64_tr_b16 v[62:63], v66 offset:21504
  s_waitcnt lgkmcnt(0)
  s_waitcnt vmcnt(18)
  s_barrier
  ds_write_b128 v2, v[40:43] offset:0
  ds_write_b128 v2, v[44:47] offset:4096
  ds_write_b128 v2, v[48:51] offset:8192
  ds_write_b128 v2, v[52:55] offset:12288
  ds_write_b128 v2, v[56:59] offset:16384
  ds_write_b128 v2, v[60:63] offset:20480
  ds_read_b64_tr_b16 v[16:17], v66 offset:24576
  ds_read_b64_tr_b16 v[18:19], v66 offset:25600
  ds_read_b64_tr_b16 v[20:21], v66 offset:28672
  ds_read_b64_tr_b16 v[22:23], v66 offset:29696
  ds_read_b64_tr_b16 v[24:25], v66 offset:32768
  ds_read_b64_tr_b16 v[26:27], v66 offset:33792
  ds_read_b64_tr_b16 v[28:29], v66 offset:36864
  ds_read_b64_tr_b16 v[30:31], v66 offset:37888
  ds_read_b64_tr_b16 v[32:33], v66 offset:40960
  ds_read_b64_tr_b16 v[34:35], v66 offset:41984
  ds_read_b64_tr_b16 v[36:37], v66 offset:45056
  ds_read_b64_tr_b16 v[38:39], v66 offset:46080
  s_waitcnt lgkmcnt(0)
  s_waitcnt vmcnt(12)
  s_barrier
  ds_write_b128 v2, v[16:19] offset:24576
  ds_write_b128 v2, v[20:23] offset:28672
  ds_write_b128 v2, v[24:27] offset:32768
  ds_write_b128 v2, v[28:31] offset:36864
  ds_write_b128 v2, v[32:35] offset:40960
  ds_write_b128 v2, v[36:39] offset:45056
  ds_read_b64_tr_b16 v[40:41], v66 offset:49152
  ds_read_b64_tr_b16 v[42:43], v66 offset:50176
  ds_read_b64_tr_b16 v[44:45], v66 offset:53248
  ds_read_b64_tr_b16 v[46:47], v66 offset:54272
  ds_read_b64_tr_b16 v[48:49], v66 offset:57344
  ds_read_b64_tr_b16 v[50:51], v66 offset:58368
  ds_read_b64_tr_b16 v[52:53], v66 offset:61440
  ds_read_b64_tr_b16 v[54:55], v66 offset:62464
  ds_read_b64_tr_b16 v[56:57], v67 offset:0
  ds_read_b64_tr_b16 v[58:59], v67 offset:1024
  ds_read_b64_tr_b16 v[60:61], v67 offset:4096
  ds_read_b64_tr_b16 v[62:63], v67 offset:5120
  s_waitcnt lgkmcnt(0)
  s_waitcnt vmcnt(6)
  s_barrier
  ds_write_b128 v2, v[40:43] offset:49152
  ds_write_b128 v2, v[44:47] offset:53248
  ds_write_b128 v2, v[48:51] offset:57344
  ds_write_b128 v2, v[52:55] offset:61440
  ds_write_b128 v3, v[56:59] offset:0
  ds_write_b128 v3, v[60:63] offset:4096
  ds_read_b64_tr_b16 v[16:17], v67 offset:8192
  ds_read_b64_tr_b16 v[18:19], v67 offset:9216
  ds_read_b64_tr_b16 v[20:21], v67 offset:12288
  ds_read_b64_tr_b16 v[22:23], v67 offset:13312
  ds_read_b64_tr_b16 v[24:25], v67 offset:16384
  ds_read_b64_tr_b16 v[26:27], v67 offset:17408
  ds_read_b64_tr_b16 v[28:29], v67 offset:20480
  ds_read_b64_tr_b16 v[30:31], v67 offset:21504
  ds_read_b64_tr_b16 v[32:33], v67 offset:24576
  ds_read_b64_tr_b16 v[34:35], v67 offset:25600
  ds_read_b64_tr_b16 v[36:37], v67 offset:28672
  ds_read_b64_tr_b16 v[38:39], v67 offset:29696
  s_waitcnt lgkmcnt(0)
  s_waitcnt vmcnt(0)
  s_barrier
  ds_write_b128 v3, v[16:19] offset:8192
  ds_write_b128 v3, v[20:23] offset:12288
  ds_write_b128 v3, v[24:27] offset:16384
  ds_write_b128 v3, v[28:31] offset:20480
  ds_write_b128 v3, v[32:35] offset:24576
  ds_write_b128 v3, v[36:39] offset:28672
  ds_read_b64_tr_b16 v[40:41], v67 offset:32768
  ds_read_b64_tr_b16 v[42:43], v67 offset:33792
  ds_read_b64_tr_b16 v[44:45], v67 offset:36864
  ds_read_b64_tr_b16 v[46:47], v67 offset:37888
  ds_read_b64_tr_b16 v[48:49], v67 offset:40960
  ds_read_b64_tr_b16 v[50:51], v67 offset:41984
  ds_read_b64_tr_b16 v[52:53], v67 offset:45056
  ds_read_b64_tr_b16 v[54:55], v67 offset:46080
  ds_read_b64_tr_b16 v[56:57], v67 offset:49152
  ds_read_b64_tr_b16 v[58:59], v67 offset:50176
  ds_read_b64_tr_b16 v[60:61], v67 offset:53248
  ds_read_b64_tr_b16 v[62:63], v67 offset:54272
  s_waitcnt lgkmcnt(0)
  s_barrier
  ds_write_b128 v3, v[40:43] offset:32768
  ds_write_b128 v3, v[44:47] offset:36864
  ds_write_b128 v3, v[48:51] offset:40960
  ds_write_b128 v3, v[52:55] offset:45056
  ds_write_b128 v3, v[56:59] offset:49152
  ds_write_b128 v3, v[60:63] offset:53248
  s_waitcnt lgkmcnt(0)
va_loop:
  s_add_u32 s53, s52, 1
  s_lshl_b32 s56, s58, 2
  s_add_u32 s56, s56, s43
  s_lshl_b32 s56, s56, 16
  s_add_u32 s56, s56, s3
  s_add_u32 s56, s56, 12582912
  s_lshl_b32 s72, s54, 21
  s_mul_i32 s46, s58, 655360
  s_add_u32 s72, s72, s46
  s_add_u32 s72, s72, s3
  s_add_u32 s72, s72, 4194304
  s_lshr_b32 s46, s72, 8
  s_and_b32 s46, s46, 0x2000
  s_xor_b32 s72, s72, s46
  s_add_u32 s73, s72, 131072
  s_add_u32 s74, s72, 262144
  s_add_u32 s75, s72, 393216
  s_add_u32 s76, s72, 524288
  v_add_u32 v11, s56, v1
  s_mov_b64 s[16:17], -1
  s_mov_b32 s71, 0
  ds_read_b128 v[56:59], v2 offset:0
  ds_read_b128 v[60:63], v2 offset:4096
  ds_read_b128 v[64:67], v2 offset:8192
  ds_read_b128 v[68:71], v2 offset:12288
  ds_read_b128 v[72:75], v2 offset:16384
  ds_read_b128 v[76:79], v2 offset:20480
  ds_read_b128 v[80:83], v2 offset:24576
  ds_read_b128 v[84:87], v2 offset:28672
  v_mov_b32 v88, 0
  v_mov_b32 v89, 0
  v_mov_b32 v90, 0
  v_mov_b32 v91, 0
  v_mov_b32 v92, 0
  v_mov_b32 v93, 0
  v_mov_b32 v94, 0
  v_mov_b32 v95, 0
  v_mov_b32 v96, 0
  v_mov_b32 v97, 0
  v_mov_b32 v98, 0
  v_mov_b32 v99, 0
  v_mov_b32 v100, 0
  v_mov_b32 v101, 0
  v_mov_b32 v102, 0
  v_mov_b32 v103, 0
  v_mov_b32 v104, 0
  v_mov_b32 v105, 0
  v_mov_b32 v106, 0
  v_mov_b32 v107, 0
  v_mov_b32 v108, 0
  v_mov_b32 v109, 0
  v_mov_b32 v110, 0
  v_mov_b32 v111, 0
  v_mov_b32 v112, 0
  v_mov_b32 v113, 0
  v_mov_b32 v114, 0
  v_mov_b32 v115, 0
  v_mov_b32 v128, 0
  v_mov_b32 v129, 0
  v_mov_b32 v130, 0
  v_mov_b32 v131, 0
  v_mov_b32 v132, 0
  v_mov_b32 v133, 0
  v_mov_b32 v134, 0
  v_mov_b32 v135, 0
  v_mov_b32 v136, 0
  v_mov_b32 v137, 0
  v_mov_b32 v138, 0
  v_mov_b32 v139, 0
  v_mov_b32 v140, 0
  v_mov_b32 v141, 0
  v_mov_b32 v142, 0
  v_mov_b32 v143, 0
  v_mov_b32 v144, 0
  v_mov_b32 v145, 0
  v_mov_b32 v146, 0
  v_mov_b32 v147, 0
  s_waitcnt lgkmcnt(0)
  s_cmp_lg_u32 s42, 3
  s_cbranch_scc1 va_nobell
  s_mov_b32 s50, 0
  s_waitcnt lgkmcnt(0)
  s_mov_b64 s[80:81], 0
  s_mov_b64 s[82:83], 0
  s_cmp_eq_u32 s53, 1
  s_cbranch_scc1 bell_x_28
bell_27:
  s_load_dwordx4 s[80:83], s[40:41], 0 glc
  s_min_u32 s46, s80, s81
  s_min_u32 s47, s82, s83
  s_min_u32 s46, s46, s47
  s_cmp_ge_u32 s46, s53
  s_cbranch_scc1 bell_x_28
  s_min_u32 s46, s80, s81
  s_min_u32 s47, s82, s83
  s_min_u32 s46, s46, s47
  s_cmp_ge_u32 s46, s53
  s_cbranch_scc1 bell_x_28
  s_min_u32 s46, s80, s81
  s_min_u32 s47, s82, s83
  s_min_u32 s46, s46, s47
  s_cmp_ge_u32 s46, s53
  s_cbranch_scc1 bell_x_28
  s_min_u32 s46, s80, s81
  s_min_u32 s47, s82, s83
  s_min_u32 s46, s46, s47
  s_cmp_ge_u32 s46, s53
  s_cbranch_scc1 bell_x_28
  s_min_u32 s46, s80, s81
  s_min_u32 s47, s82, s83
  s_min_u32 s46, s46, s47
  s_cmp_ge_u32 s46, s53
  s_cbranch_scc1 bell_x_28
  s_min_u32 s46, s80, s81
  s_min_u32 s47, s82, s83
  s_min_u32 s46, s46, s47
  s_cmp_ge_u32 s46, s53
  s_cbranch_scc1 bell_x_28
  s_min_u32 s46, s80, s81
  s_min_u32 s47, s82, s83
  s_min_u32 s46, s46, s47
  s_cmp_ge_u32 s46, s53
  s_cbranch_scc1 bell_x_28
  s_min_u32 s46, s80, s81
  s_min_u32 s47, s82, s83
  s_min_u32 s46, s46, s47
  s_cmp_ge_u32 s46, s53
  s_cbranch_scc1 bell_x_28
  s_min_u32 s46, s80, s81
  s_min_u32 s47, s82, s83
  s_min_u32 s46, s46, s47
  s_cmp_ge_u32 s46, s53
  s_cbranch_scc1 bell_x_28
  s_min_u32 s46, s80, s81
  s_min_u32 s47, s82, s83
  s_min_u32 s46, s46, s47
  s_cmp_ge_u32 s46, s53
  s_cbranch_scc1 bell_x_28
  s_add_u32 s50, s50, 1
  s_cmp_lt_u32 s50, 524288
  s_cbranch_scc1 bell_27
  s_branch L_fail
bell_x_28:
va_nobell:
  s_mov_b32 s50, 0
va_top:
  s_add_u32 m0, s51, 126976
  s_barrier
  buffer_load_dwordx4 v11, s[8:11], s31 offen sc1 lds
  s_add_u32 m0, s51, 131072
  s_barrier
  buffer_load_dwordx4 v[16:19], v11, s[8:11], 0 offen offset:0 sc1
  s_barrier
  buffer_load_dwordx4 v11, s[8:11], s32 offen sc1 lds
  s_add_u32 m0, s51, 135168
  s_nop 0
  buffer_load_dwordx4 v11, s[8:11], s33 offen sc1 lds
  s_waitcnt vmcnt(3)
  s_barrier
  ds_read_b128 v[20:23], v9 offset:0
  ds_read_b128 v[24:27], v9 offset:1024
  s_waitcnt vmcnt(2)
va_go:
  v_smfmac_f32_16x16x64_bf16 v[104:107], v[16:19], v[56:63], v7
  ds_read_b128 v[28:31], v9 offset:2048
  v_smfmac_f32_16x16x64_bf16 v[108:111], v[16:19], v[64:71], v7
  ds_read_b128 v[32:35], v9 offset:3072
  v_smfmac_f32_16x16x64_bf16 v[112:115], v[16:19], v[72:79], v7
  ds_read_b128 v[56:59], v2 offset:49152
  s_waitcnt lgkmcnt(4)
  v_smfmac_f32_16x16x64_bf16 v[104:107], v[20:23], a[0:7], v7
  ds_read_b128 v[60:63], v2 offset:53248
  v_cmp_eq_u32 vcc, -1, v16
  v_smfmac_f32_16x16x64_bf16 v[108:111], v[20:23], a[8:15], v7
  ds_read_b128 v[64:67], v2 offset:32768
  v_smfmac_f32_16x16x64_bf16 v[112:115], v[20:23], a[16:23], v7
  s_cbranch_vccnz va_ha
  s_waitcnt lgkmcnt(4)
  v_smfmac_f32_16x16x64_bf16 v[104:107], v[24:27], a[24:31], v7
  s_waitcnt vmcnt(0)
  s_barrier
  ds_read_b128 v[36:39], v9 offset:4096
  v_smfmac_f32_16x16x64_bf16 v[108:111], v[24:27], a[32:39], v7
  ds_read_b128 v[40:43], v9 offset:5120
  v_smfmac_f32_16x16x64_bf16 v[112:115], v[24:27], a[40:47], v7
  ds_read_b128 v[44:47], v9 offset:6144
  v_mov_b32 v16, 0
  v_smfmac_f32_16x16x64_bf16 v[104:107], v[28:31], a[48:55], v7
  ds_read_b128 v[48:51], v9 offset:7168
  s_waitcnt lgkmcnt(4)
  v_smfmac_f32_16x16x64_bf16 v[104:107], v[32:35], v[80:87], v7
  ds_read_b128 v[52:55], v9 offset:8192
  s_waitcnt lgkmcnt(4)
  v_smfmac_f32_16x16x64_bf16 v[104:107], v[36:39], a[72:79], v7
  ds_read_b128 v[68:71], v2 offset:36864
  s_waitcnt lgkmcnt(4)
  v_max3_u32 v12, v20, v24, v28
  v_smfmac_f32_16x16x64_bf16 v[104:107], v[40:43], a[96:103], v7
  s_waitcnt lgkmcnt(3)
  v_max3_u32 v12, v12, v32, v36
  v_smfmac_f32_16x16x64_bf16 v[104:107], v[44:47], a[120:127], v7
  s_waitcnt lgkmcnt(2)
  v_max3_u32 v12, v12, v40, v44
  v_smfmac_f32_16x16x64_bf16 v[104:107], v[48:51], v[56:63], v7
  s_waitcnt lgkmcnt(1)
  v_max3_u32 v12, v12, v48, v52
  v_smfmac_f32_16x16x64_bf16 v[104:107], v[52:55], a[144:151], v7
  ds_read_b128 v[72:75], v2 offset:57344
  v_cmp_eq_u32 vcc, -1, v12
  v_smfmac_f32_16x16x64_bf16 v[108:111], v[28:31], a[56:63], v7
  ds_read_b128 v[76:79], v2 offset:61440
  s_waitcnt lgkmcnt(2)
  v_smfmac_f32_16x16x64_bf16 v[108:111], v[32:35], v[64:71], v7
  s_cbranch_vccnz va_hb
  v_mov_b32 v17, 0
va_join:
  v_smfmac_f32_16x16x64_bf16 v[108:111], v[36:39], a[80:87], v7
  ds_read_b128 v[80:83], v2 offset:40960
  v_add_f32 v104, v104, v106
  v_smfmac_f32_16x16x64_bf16 v[108:111], v[40:43], a[104:111], v7
  ds_read_b128 v[84:87], v2 offset:45056
  v_add_f32 v105, v105, v107
  v_smfmac_f32_16x16x64_bf16 v[108:111], v[44:47], a[128:135], v7
  ds_read_b128 v[56:59], v3 offset:0
  s_waitcnt lgkmcnt(3)
  v_cvt_pk_bf16_f32 v106, v104, v105
  v_smfmac_f32_16x16x64_bf16 v[108:111], v[48:51], v[72:79], v7
  ds_write_b32 v4, v106 offset:0
  v_smfmac_f32_16x16x64_bf16 v[108:111], v[52:55], a[152:159], v7
  ds_read_b128 v[60:63], v3 offset:4096
  v_cmp_u_f32 vcc, v104, v105
  v_smfmac_f32_16x16x64_bf16 v[112:115], v[28:31], a[64:71], v7
  ds_read_b128 v[64:67], v3 offset:8192
  s_waitcnt lgkmcnt(4)
  v_smfmac_f32_16x16x64_bf16 v[112:115], v[32:35], v[80:87], v7
  s_and_b64 vcc, vcc, s[16:17]
  s_cbranch_scc1 va_redo
  v_add_f32 v108, v108, v110
  v_smfmac_f32_16x16x64_bf16 v[112:115], v[36:39], a[88:95], v7
  s_waitcnt lgkmcnt(2)
  s_barrier
  v_add_f32 v109, v109, v111
  v_smfmac_f32_16x16x64_bf16 v[112:115], v[40:43], a[112:119], v7
  ds_read_b64_tr_b16 v[116:117], v5 offset:0
  ds_read_b64_tr_b16 v[118:119], v6 offset:0
  v_smfmac_f32_16x16x64_bf16 v[112:115], v[44:47], a[136:143], v7
  ds_read_b128 v[68:71], v3 offset:12288
  s_waitcnt lgkmcnt(4)
  v_cvt_pk_bf16_f32 v110, v108, v109
  v_smfmac_f32_16x16x64_bf16 v[112:115], v[48:51], v[56:63], v7
  ds_write_b32 v4, v110 offset:1024
  v_smfmac_f32_16x16x64_bf16 v[112:115], v[52:55], a[160:167], v7
  ds_read_b128 v[72:75], v3 offset:32768
  s_waitcnt lgkmcnt(3)
  v_smfmac_f32_16x16x64_bf16 v[128:131], v[116:119], a[168:175], v7
  ds_read_b128 v[76:79], v3 offset:36864
  v_mov_b32 v18, 0
  v_smfmac_f32_16x16x64_bf16 v[132:135], v[116:119], a[192:199], v7
  ds_read_b128 v[80:83], v3 offset:16384
  v_add_f32 v112, v112, v114
  v_smfmac_f32_16x16x64_bf16 v[136:139], v[116:119], a[216:223], v7
  s_waitcnt lgkmcnt(3)
  s_barrier
  v_add_f32 v113, v113, v115
  v_smfmac_f32_16x16x64_bf16 v[140:143], v[116:119], v[64:71], v7
  ds_read_b128 v[84:87], v3 offset:20480
  v_cvt_pk_bf16_f32 v114, v112, v113
  v_smfmac_f32_16x16x64_bf16 v[144:147], v[116:119], a[240:247], v7
  ds_write_b32 v4, v114 offset:2048
  v_smfmac_f32_16x16x64_bf16 v[88:91], v[116:119], v[160:167], v7
  ds_read_b64_tr_b16 v[120:121], v5 offset:1024
  ds_read_b64_tr_b16 v[122:123], v6 offset:1024
  v_smfmac_f32_16x16x64_bf16 v[92:95], v[116:119], v[184:191], v7
  ds_read_b128 v[56:59], v3 offset:24576
  v_mov_b32 v19, 0
  v_smfmac_f32_16x16x64_bf16 v[96:99], v[116:119], v[208:215], v7
  ds_read_b128 v[60:63], v3 offset:28672
  s_waitcnt lgkmcnt(6)
  v_smfmac_f32_16x16x64_bf16 v[100:103], v[116:119], v[72:79], v7
  s_waitcnt lgkmcnt(4)
  s_barrier
  v_smfmac_f32_16x16x64_bf16 v[16:19], v[116:119], v[232:239], v7
  ds_read_b64_tr_b16 v[124:125], v5 offset:2048
  ds_read_b64_tr_b16 v[126:127], v6 offset:2048
  s_waitcnt lgkmcnt(4)
  v_smfmac_f32_16x16x64_bf16 v[128:131], v[120:123], a[176:183], v7
  ds_read_b128 v[64:67], v3 offset:40960
  v_smfmac_f32_16x16x64_bf16 v[132:135], v[120:123], a[200:207], v7
  ds_read_b128 v[68:71], v3 offset:45056
  v_smfmac_f32_16x16x64_bf16 v[136:139], v[120:123], a[224:231], v7
  ds_read_b128 v[72:75], v3 offset:49152
  v_smfmac_f32_16x16x64_bf16 v[140:143], v[120:123], v[80:87], v7
  ds_read_b128 v[76:79], v3 offset:53248
  s_waitcnt lgkmcnt(4)
  v_smfmac_f32_16x16x64_bf16 v[128:131], v[124:127], a[184:191], v7
  v_smfmac_f32_16x16x64_bf16 v[132:135], v[124:127], a[208:215], v7
  v_smfmac_f32_16x16x64_bf16 v[136:139], v[124:127], a[232:239], v7
  v_add_f32 v128, v128, v130
  v_add_f32 v129, v129, v131
  v_cvt_pk_bf16_f32 v128, v128, v129
  v_smfmac_f32_16x16x64_bf16 v[140:143], v[124:127], v[56:63], v7
  v_add_f32 v132, v132, v134
  v_add_f32 v133, v133, v135
  v_cvt_pk_bf16_f32 v129, v132, v133
  v_smfmac_f32_16x16x64_bf16 v[144:147], v[120:123], a[248:255], v7
  v_add_f32 v136, v136, v138
  v_add_f32 v137, v137, v139
  v_permlane16_swap_b32 v128, v129
  v_smfmac_f32_16x16x64_bf16 v[144:147], v[124:127], v[152:159], v7
  buffer_store_dwordx2 v[128:129], v8, s[8:11], s72 offen sc1
  v_cvt_pk_bf16_f32 v136, v136, v137
  v_smfmac_f32_16x16x64_bf16 v[88:91], v[120:123], v[168:175], v7
  v_add_f32 v140, v140, v142
  v_add_f32 v141, v141, v143
  v_smfmac_f32_16x16x64_bf16 v[88:91], v[124:127], v[176:183], v7
  v_cvt_pk_bf16_f32 v137, v140, v141
  v_add_f32 v144, v144, v146
  v_smfmac_f32_16x16x64_bf16 v[92:95], v[120:123], v[192:199], v7
  v_add_f32 v145, v145, v147
  v_permlane16_swap_b32 v136, v137
  v_smfmac_f32_16x16x64_bf16 v[92:95], v[124:127], v[200:207], v7
  buffer_store_dwordx2 v[136:137], v8, s[8:11], s73 offen sc1
  v_cvt_pk_bf16_f32 v144, v144, v145
  v_add_f32 v88, v88, v90
  v_smfmac_f32_16x16x64_bf16 v[96:99], v[120:123], v[216:223], v7
  v_add_f32 v89, v89, v91
  v_cvt_pk_bf16_f32 v145, v88, v89
  v_smfmac_f32_16x16x64_bf16 v[96:99], v[124:127], v[224:231], v7
  s_waitcnt lgkmcnt(0)
  v_add_f32 v92, v92, v94
  v_add_f32 v93, v93, v95
  v_permlane16_swap_b32 v144, v145
  v_smfmac_f32_16x16x64_bf16 v[100:103], v[120:123], v[64:71], v7
  buffer_store_dwordx2 v[144:145], v8, s[8:11], s74 offen sc1
  v_cvt_pk_bf16_f32 v92, v92, v93
  v_smfmac_f32_16x16x64_bf16 v[100:103], v[124:127], v[72:79], v7
  v_add_f32 v96, v96, v98
  v_add_f32 v97, v97, v99
  v_cvt_pk_bf16_f32 v93, v96, v97
  v_smfmac_f32_16x16x64_bf16 v[16:19], v[120:123], v[240:247], v7
  v_smfmac_f32_16x16x64_bf16 v[16:19], v[124:127], v[248:255], v7
  v_add_f32 v100, v100, v102
  v_add_f32 v101, v101, v103
  v_permlane16_swap_b32 v92, v93
  buffer_store_dwordx2 v[92:93], v8, s[8:11], s75 offen sc1
  v_cvt_pk_bf16_f32 v100, v100, v101
  s_nop 2
  v_add_f32 v16, v16, v18
  v_add_f32 v17, v17, v19
  v_cvt_pk_bf16_f32 v101, v16, v17
  s_nop 1
  v_permlane16_swap_b32 v100, v101
  buffer_store_dwordx2 v[100:101], v8, s[8:11], s76 offen sc1
  s_add_u32 s58, s58, 1
  s_cmp_eq_u32 s58, 3
  s_cselect_b32 s58, 0, s58
  s_cmp_eq_u32 s58, 0
  s_addc_u32 s54, s54, 0
  s_cmp_eq_u32 s54, 3
  s_cselect_b32 s54, 0, s54
  s_mov_b32 s52, s53
  s_cmp_lt_u32 s52, 64
  s_cbranch_scc1 va_loop
  s_waitcnt vmcnt(0)
  v_mov_b32 v148, s52
  s_mov_b64 exec, 1
  buffer_store_dword v148, v15, s[8:11], 0 offen sc1
  s_mov_b64 exec, -1
  s_endpgm
va_ha:
  s_waitcnt lgkmcnt(0)
  ds_read_b128 v[56:59], v2 offset:0
  ds_read_b128 v[60:63], v2 offset:4096
  ds_read_b128 v[64:67], v2 offset:8192
  ds_read_b128 v[68:71], v2 offset:12288
  ds_read_b128 v[72:75], v2 offset:16384
  ds_read_b128 v[76:79], v2 offset:20480
  ds_read_b128 v[80:83], v2 offset:24576
  ds_read_b128 v[84:87], v2 offset:28672
  v_mov_b32 v88, 0
  v_mov_b32 v89, 0
  v_mov_b32 v90, 0
  v_mov_b32 v91, 0
  v_mov_b32 v92, 0
  v_mov_b32 v93, 0
  v_mov_b32 v94, 0
  v_mov_b32 v95, 0
  v_mov_b32 v96, 0
  v_mov_b32 v97, 0
  v_mov_b32 v98, 0
  v_mov_b32 v99, 0
  v_mov_b32 v100, 0
  v_mov_b32 v101, 0
  v_mov_b32 v102, 0
  v_mov_b32 v103, 0
  v_mov_b32 v104, 0
  v_mov_b32 v105, 0
  v_mov_b32 v106, 0
  v_mov_b32 v107, 0
  v_mov_b32 v108, 0
  v_mov_b32 v109, 0
  v_mov_b32 v110, 0
  v_mov_b32 v111, 0
  v_mov_b32 v112, 0
  v_mov_b32 v113, 0
  v_mov_b32 v114, 0
  v_mov_b32 v115, 0
  v_mov_b32 v128, 0
  v_mov_b32 v129, 0
  v_mov_b32 v130, 0
  v_mov_b32 v131, 0
  v_mov_b32 v132, 0
  v_mov_b32 v133, 0
  v_mov_b32 v134, 0
  v_mov_b32 v135, 0
  v_mov_b32 v136, 0
  v_mov_b32 v137, 0
  v_mov_b32 v138, 0
  v_mov_b32 v139, 0
  v_mov_b32 v140, 0
  v_mov_b32 v141, 0
  v_mov_b32 v142, 0
  v_mov_b32 v143, 0
  v_mov_b32 v144, 0
  v_mov_b32 v145, 0
  v_mov_b32 v146, 0
  v_mov_b32 v147, 0
va_ra:
  buffer_load_dwordx4 v[16:19], v11, s[8:11], 0 offen offset:0 sc1
  s_add_u32 s50, s50, 1
  s_cmp_gt_u32 s50, 131072
  s_cbranch_scc1 L_fail
  s_waitcnt vmcnt(0) lgkmcnt(0)
  v_cmp_eq_u32 vcc, -1, v16
  s_cbranch_vccnz va_ra
  s_branch va_go
va_hb:
  s_waitcnt lgkmcnt(0)
  s_add_u32 s50, s50, 1
  s_cmp_gt_u32 s50, 131072
  s_cbranch_scc1 L_fail
  ds_read_b128 v[56:59], v2 offset:0
  ds_read_b128 v[60:63], v2 offset:4096
  ds_read_b128 v[64:67], v2 offset:8192
  ds_read_b128 v[68:71], v2 offset:12288
  ds_read_b128 v[72:75], v2 offset:16384
  ds_read_b128 v[76:79], v2 offset:20480
  ds_read_b128 v[80:83], v2 offset:24576
  ds_read_b128 v[84:87], v2 offset:28672
  v_mov_b32 v88, 0
  v_mov_b32 v89, 0
  v_mov_b32 v90, 0
  v_mov_b32 v91, 0
  v_mov_b32 v92, 0
  v_mov_b32 v93, 0
  v_mov_b32 v94, 0
  v_mov_b32 v95, 0
  v_mov_b32 v96, 0
  v_mov_b32 v97, 0
  v_mov_b32 v98, 0
  v_mov_b32 v99, 0
  v_mov_b32 v100, 0
  v_mov_b32 v101, 0
  v_mov_b32 v102, 0
  v_mov_b32 v103, 0
  v_mov_b32 v104, 0
  v_mov_b32 v105, 0
  v_mov_b32 v106, 0
  v_mov_b32 v107, 0
  v_mov_b32 v108, 0
  v_mov_b32 v109, 0
  v_mov_b32 v110, 0
  v_mov_b32 v111, 0
  v_mov_b32 v112, 0
  v_mov_b32 v113, 0
  v_mov_b32 v114, 0
  v_mov_b32 v115, 0
  v_mov_b32 v128, 0
  v_mov_b32 v129, 0
  v_mov_b32 v130, 0
  v_mov_b32 v131, 0
  v_mov_b32 v132, 0
  v_mov_b32 v133, 0
  v_mov_b32 v134, 0
  v_mov_b32 v135, 0
  v_mov_b32 v136, 0
  v_mov_b32 v137, 0
  v_mov_b32 v138, 0
  v_mov_b32 v139, 0
  v_mov_b32 v140, 0
  v_mov_b32 v141, 0
  v_mov_b32 v142, 0
  v_mov_b32 v143, 0
  v_mov_b32 v144, 0
  v_mov_b32 v145, 0
  v_mov_b32 v146, 0
  v_mov_b32 v147, 0
  s_waitcnt lgkmcnt(0)
  s_branch va_top
va_redo:
  s_waitcnt lgkmcnt(0)
  s_mov_b32 s50, 0
va_poll:
  buffer_load_dwordx4 v[16:19], v11, s[8:11], 0 offen offset:0 sc1
  buffer_load_dwordx4 v[20:23], v11, s[8:11], 0 offen offset:1024 sc1
  buffer_load_dwordx4 v[24:27], v11, s[8:11], 0 offen offset:2048 sc1
  buffer_load_dwordx4 v[28:31], v11, s[8:11], 0 offen offset:3072 sc1
  buffer_load_dwordx4 v[32:35], v11, s[8:11], s24 offen offset:0 sc1
  buffer_load_dwordx4 v[36:39], v11, s[8:11], s24 offen offset:1024 sc1
  buffer_load_dwordx4 v[40:43], v11, s[8:11], s24 offen offset:2048 sc1
  buffer_load_dwordx4 v[44:47], v11, s[8:11], s24 offen offset:3072 sc1
  buffer_load_dwordx4 v[48:51], v11, s[8:11], s25 offen offset:0 sc1
  buffer_load_dwordx4 v[52:55], v11, s[8:11], s25 offen offset:1024 sc1
  s_add_u32 s50, s50, 1
  s_cmp_gt_u32 s50, 131072
  s_cbranch_scc1 L_fail
  s_waitcnt vmcnt(0) lgkmcnt(0)
  v_max_u32 v12, v16, v17
  v_max3_u32 v12, v18, v19, v12
  v_max3_u32 v12, v20, v21, v12
  v_max3_u32 v12, v22, v23, v12
  v_max3_u32 v12, v24, v25, v12
  v_max3_u32 v12, v26, v27, v12
  v_max3_u32 v12, v28, v29, v12
  v_max3_u32 v12, v30, v31, v12
  v_max3_u32 v12, v32, v33, v12
  v_max3_u32 v12, v34, v35, v12
  v_max3_u32 v12, v36, v37, v12
  v_max3_u32 v12, v38, v39, v12
  v_max3_u32 v12, v40, v41, v12
  v_max3_u32 v12, v42, v43, v12
  v_max3_u32 v12, v44, v45, v12
  v_max3_u32 v12, v46, v47, v12
  v_max3_u32 v12, v48, v49, v12
  v_max3_u32 v12, v50, v51, v12
  v_max3_u32 v12, v52, v53, v12
  v_max3_u32 v12, v54, v55, v12
  v_cmp_eq_u32 vcc, -1, v12
  s_cbranch_vccnz va_poll
  s_mov_b64 s[16:17], 0
  ds_read_b128 v[56:59], v2 offset:0
  ds_read_b128 v[60:63], v2 offset:4096
  ds_read_b128 v[64:67], v2 offset:8192
  ds_read_b128 v[68:71], v2 offset:12288
  ds_read_b128 v[72:75], v2 offset:16384
  ds_read_b128 v[76:79], v2 offset:20480
  ds_read_b128 v[80:83], v2 offset:24576
  ds_read_b128 v[84:87], v2 offset:28672
  v_mov_b32 v88, 0
  v_mov_b32 v89, 0
  v_mov_b32 v90, 0
  v_mov_b32 v91, 0
  v_mov_b32 v92, 0
  v_mov_b32 v93, 0
  v_mov_b32 v94, 0
  v_mov_b32 v95, 0
  v_mov_b32 v96, 0
  v_mov_b32 v97, 0
  v_mov_b32 v98, 0
  v_mov_b32 v99, 0
  v_mov_b32 v100, 0
  v_mov_b32 v101, 0
  v_mov_b32 v102, 0
  v_mov_b32 v103, 0
  v_mov_b32 v104, 0
  v_mov_b32 v105, 0
  v_mov_b32 v106, 0
  v_mov_b32 v107, 0
  v_mov_b32 v108, 0
  v_mov_b32 v109, 0
  v_mov_b32 v110, 0
  v_mov_b32 v111, 0
  v_mov_b32 v112, 0
  v_mov_b32 v113, 0
  v_mov_b32 v114, 0
  v_mov_b32 v115, 0
  v_mov_b32 v128, 0
  v_mov_b32 v129, 0
  v_mov_b32 v130, 0
  v_mov_b32 v131, 0
  v_mov_b32 v132, 0
  v_mov_b32 v133, 0
  v_mov_b32 v134, 0
  v_mov_b32 v135, 0
  v_mov_b32 v136, 0
  v_mov_b32 v137, 0
  v_mov_b32 v138, 0
  v_mov_b32 v139, 0
  v_mov_b32 v140, 0
  v_mov_b32 v141, 0
  v_mov_b32 v142, 0
  v_mov_b32 v143, 0
  v_mov_b32 v144, 0
  v_mov_b32 v145, 0
  v_mov_b32 v146, 0
  v_mov_b32 v147, 0
  s_waitcnt lgkmcnt(0)
  v_smfmac_f32_16x16x64_bf16 v[104:107], v[16:19], v[56:63], v7
  v_smfmac_f32_16x16x64_bf16 v[108:111], v[16:19], v[64:71], v7
  v_smfmac_f32_16x16x64_bf16 v[112:115], v[16:19], v[72:79], v7
  ds_read_b128 v[56:59], v2 offset:49152
  v_smfmac_f32_16x16x64_bf16 v[104:107], v[20:23], a[0:7], v7
  ds_read_b128 v[60:63], v2 offset:53248
  v_smfmac_f32_16x16x64_bf16 v[108:111], v[20:23], a[8:15], v7
  ds_read_b128 v[64:67], v2 offset:32768
  v_smfmac_f32_16x16x64_bf16 v[112:115], v[20:23], a[16:23], v7
  v_smfmac_f32_16x16x64_bf16 v[104:107], v[24:27], a[24:31], v7
  v_smfmac_f32_16x16x64_bf16 v[108:111], v[24:27], a[32:39], v7
  v_smfmac_f32_16x16x64_bf16 v[112:115], v[24:27], a[40:47], v7
  v_mov_b32 v16, 0
  v_smfmac_f32_16x16x64_bf16 v[104:107], v[28:31], a[48:55], v7
  v_smfmac_f32_16x16x64_bf16 v[104:107], v[32:35], v[80:87], v7
  v_smfmac_f32_16x16x64_bf16 v[104:107], v[36:39], a[72:79], v7
  ds_read_b128 v[68:71], v2 offset:36864
  v_smfmac_f32_16x16x64_bf16 v[104:107], v[40:43], a[96:103], v7
  v_smfmac_f32_16x16x64_bf16 v[104:107], v[44:47], a[120:127], v7
  s_waitcnt lgkmcnt(1)
  v_smfmac_f32_16x16x64_bf16 v[104:107], v[48:51], v[56:63], v7
  v_smfmac_f32_16x16x64_bf16 v[104:107], v[52:55], a[144:151], v7
  ds_read_b128 v[72:75], v2 offset:57344
  v_smfmac_f32_16x16x64_bf16 v[108:111], v[28:31], a[56:63], v7
  ds_read_b128 v[76:79], v2 offset:61440
  s_waitcnt lgkmcnt(2)
  v_smfmac_f32_16x16x64_bf16 v[108:111], v[32:35], v[64:71], v7
  v_mov_b32 v17, 0
  s_waitcnt lgkmcnt(0)
  s_branch va_join
L_owner:
  s_cmp_ge_u32 s42, 2
  s_cbranch_scc1 L_end
  s_mul_i32 s62, s43, 10
  s_add_u32 s62, s62, s44
  s_sub_u32 s62, s62, 16
  s_mov_b32 s12, s24
  s_mov_b32 s13, s25
  s_mov_b32 s14, 10240
  s_mov_b32 s15, 0x20000
  v_mov_b32 v20, -1
  v_mov_b32 v24, 0
  v_mov_b32 v21, -1
  v_mov_b32 v25, 0
  v_mov_b32 v22, -1
  v_mov_b32 v26, 0
  v_mov_b32 v23, -1
  v_mov_b32 v27, 0
  s_lshl_b32 s48, s42, 13
  s_lshl_b32 s46, s62, 8
  s_cmp_ge_u32 s62, 32
  s_cselect_b32 s47, 40960, 0
  s_add_u32 s46, s46, s47
  s_add_u32 s46, s46, s48
  s_add_u32 s46, s46, 12582912
  v_and_b32 v13, 15, v0
  v_lshlrev_b32 v13, 4, v13
  v_lshrrev_b32 v12, 4, v0
  v_lshl_add_u32 v13, v12, 16, v13
  buffer_store_dwordx4 v[20:23], v13, s[8:11], s46 offen sc1
  s_add_u32 s46, s46, 262144
  buffer_store_dwordx4 v[20:23], v13, s[8:11], s46 offen sc1
  s_add_u32 s46, s46, 262144
  buffer_store_dwordx4 v[20:23], v13, s[8:11], s46 offen sc1
  s_add_u32 s46, s46, 262144
  s_lshl_b32 s46, s62, 9
  s_cmp_ge_u32 s62, 16
  s_cselect_b32 s47, 8192, 0
  s_add_u32 s46, s46, s47
  s_cmp_ge_u32 s62, 32
  s_cselect_b32 s47, 10240, 0
  s_add_u32 s46, s46, s47
  s_add_u32 s46, s46, s48
  s_add_u32 s46, s46, 12599296
  v_lshlrev_b32 v13, 3, v0
  buffer_store_dwordx2 v[20:21], v13, s[8:11], s46 offen sc1
  s_add_u32 s46, s46, 262144
  buffer_store_dwordx2 v[20:21], v13, s[8:11], s46 offen sc1
  s_add_u32 s46, s46, 262144
  buffer_store_dwordx2 v[20:21], v13, s[8:11], s46 offen sc1
  s_add_u32 s46, s46, 262144
  v_min_u32 v13, 4, v0
  v_lshlrev_b32 v13, 7, v13
  s_lshl_b32 s46, s62, 1
  s_add_u32 s46, s46, s42
  s_mul_i32 s46, s46, 640
  s_add_u32 s46, s46, 1048576
  buffer_store_dwordx4 v[24:27], v13, s[8:11], s46 offen sc1
  s_and_b32 s46, s62, 31
  s_lshl_b32 s46, s46, 8
  s_add_u32 s46, s46, s48
  s_add_u32 s46, s46, 13369344
  v_and_b32 v13, 1, v0
  v_lshlrev_b32 v13, 7, v13
  v_bfe_u32 v12, v0, 1, 1
  v_lshl_add_u32 v13, v12, 14, v13
  buffer_store_dwordx4 v[24:27], v13, s[8:11], s46 offen sc1
  v_mov_b32 v13, 192
  v_mov_b32 v14, 1
  s_waitcnt vmcnt(0)
  s_mov_b64 exec, 1
  global_atomic_add v12, v13, v14, s[38:39] sc0 sc1
  s_waitcnt vmcnt(0)
  v_readfirstlane_b32 s46, v12
  s_nop 0
  s_cmp_lg_u32 s46, 79
  s_cbranch_scc1 ow_notlast
  v_mov_b32 v13, 8
  global_store_dword v13, v14, s[38:39] sc1
ow_notlast:
  s_mov_b64 exec, -1
  s_mov_b32 s50, 0
ss_29:
  v_and_b32 v11, 3, v0
  v_lshlrev_b32 v11, 2, v11
  global_load_dword v10, v11, s[38:39] sc1
  s_add_u32 s50, s50, 1
  s_cmp_gt_u32 s50, 131072
  s_cbranch_scc1 L_fail
  s_waitcnt vmcnt(0)
ss_29_in:
  v_readlane_b32 s46, v10, 0
  v_readlane_b32 s47, v10, 2
  v_readlane_b32 s48, v10, 1
  s_nop 0
  s_min_u32 s47, s47, s48
  s_cmp_lg_u32 s46, 0
  s_cselect_b32 s48, 7, 0
  s_add_u32 s46, s46, s2
  s_xor_b32 s49, s46, s43
  s_and_b32 s49, s49, s48
  s_cbranch_scc1 L_reroll
  s_cmp_lg_u32 s47, 0
  s_cbranch_scc1 ss_ok_30
  s_sleep 6
  s_branch ss_29
ss_ok_30:
  v_readlane_b32 s3, v10, 1
  s_nop 0
  s_and_b32 s3, s3, 0x2000
  s_lshr_b32 s46, s44, 4
  s_lshl_b32 s46, s46, 7
  s_lshl_b32 s47, s43, 4
  s_add_u32 s46, s46, s47
  s_and_b32 s47, s44, 15
  s_add_u32 s46, s46, s47
  s_lshl_b32 s46, s46, 7
  s_add_u32 s46, s46, s3
  s_add_u32 s46, s46, 13369344
  s_add_u32 s40, s8, s46
  s_addc_u32 s41, s9, 0
  s_sub_u32 s47, s44, 16
  s_lshl_b32 s46, s47, 11
  s_lshl_b32 s48, s43, 2
  s_add_u32 s46, s46, s48
  s_add_u32 s46, s46, s3
  s_add_u32 s46, s46, 13369344
  v_lshl_add_u32 v7, v0, 7, s46
  v_mov_b32 v10, 2146435072
  s_cmp_lt_u32 s47, 4
  s_cselect_b32 vcc_lo, 65535, 0
  s_mov_b32 vcc_hi, 0
  v_cndmask_b32 v7, v10, v7, vcc
  v_mov_b32 v17, 0
  v_lshlrev_b32 v9, 7, v0
  s_and_b32 s46, s62, 3
  s_lshl_b32 s46, s46, 2
  s_add_u32 s46, s46, 1060864
  v_add_u32 v9, s46, v9
  v_and_b32 v18, 3, v0
  v_min_u32 v18, 2, v18
  v_lshlrev_b32 v18, 8, v18
  s_mul_i32 s46, s43, 768
  s_cmp_ge_u32 s44, 21
  s_cselect_b32 s47, 128, 0
  s_add_u32 s46, s46, s47
  s_add_u32 s46, s46, 1073152
  v_add_u32 v18, s46, v18
  v_cmp_lt_u32 vcc, 31, v0
  s_nop 1
  v_cndmask_b32 v9, v9, v18, vcc
  s_cmp_eq_u32 s42, 0
  s_cbranch_scc1 ow_main
  v_mov_b32 v14, 2146435072
  s_lshl_b32 s46, s43, 11
  s_add_u32 s46, s46, s3
  s_add_u32 s46, s46, 13387008
  v_lshl_add_u32 v19, v0, 7, s46
  s_lshl_b32 s46, s43, 7
  s_add_u32 s46, s46, 1077248
  v_writelane_b32 v19, s46, 6
  s_cmp_eq_u32 s44, 20
  s_cselect_b32 vcc_lo, 127, 0
  s_mov_b32 vcc_hi, 0
  v_cndmask_b32 v19, v14, v19, vcc
  s_mov_b32 s53, 1
  v_mov_b32 v15, 0
ow_listen:
  s_add_u32 s46, s53, 2
  s_min_u32 s46, s46, 64
  v_cmp_gt_u32 vcc, s46, v15
  s_nop 0
  s_and_saveexec_b64 s[64:65], vcc
  s_cbranch_execz ow_fresh
  buffer_load_dword v15, v9, s[8:11], 0 offen sc1
ow_fresh:
  s_mov_b64 exec, -1
  s_add_u32 s46, s53, 1
  v_mov_b32 v16, s46
  s_mov_b32 s50, 0
  s_waitcnt lgkmcnt(0)
  s_mov_b64 s[80:81], 0
  s_mov_b64 s[82:83], 0
bell_31:
  s_load_dwordx4 s[80:83], s[40:41], 0 glc
  s_min_u32 s46, s80, s81
  s_min_u32 s47, s82, s83
  s_min_u32 s46, s46, s47
  s_cmp_ge_u32 s46, s53
  s_cbranch_scc1 bell_x_32
  s_min_u32 s46, s80, s81
  s_min_u32 s47, s82, s83
  s_min_u32 s46, s46, s47
  s_cmp_ge_u32 s46, s53
  s_cbranch_scc1 bell_x_32
  s_min_u32 s46, s80, s81
  s_min_u32 s47, s82, s83
  s_min_u32 s46, s46, s47
  s_cmp_ge_u32 s46, s53
  s_cbranch_scc1 bell_x_32
  s_min_u32 s46, s80, s81
  s_min_u32 s47, s82, s83
  s_min_u32 s46, s46, s47
  s_cmp_ge_u32 s46, s53
  s_cbranch_scc1 bell_x_32
  s_min_u32 s46, s80, s81
  s_min_u32 s47, s82, s83
  s_min_u32 s46, s46, s47
  s_cmp_ge_u32 s46, s53
  s_cbranch_scc1 bell_x_32
  s_min_u32 s46, s80, s81
  s_min_u32 s47, s82, s83
  s_min_u32 s46, s46, s47
  s_cmp_ge_u32 s46, s53
  s_cbranch_scc1 bell_x_32
  s_min_u32 s46, s80, s81
  s_min_u32 s47, s82, s83
  s_min_u32 s46, s46, s47
  s_cmp_ge_u32 s46, s53
  s_cbranch_scc1 bell_x_32
  s_min_u32 s46, s80, s81
  s_min_u32 s47, s82, s83
  s_min_u32 s46, s46, s47
  s_cmp_ge_u32 s46, s53
  s_cbranch_scc1 bell_x_32
  s_min_u32 s46, s80, s81
  s_min_u32 s47, s82, s83
  s_min_u32 s46, s46, s47
  s_cmp_ge_u32 s46, s53
  s_cbranch_scc1 bell_x_32
  s_min_u32 s46, s80, s81
  s_min_u32 s47, s82, s83
  s_min_u32 s46, s46, s47
  s_cmp_ge_u32 s46, s53
  s_cbranch_scc1 bell_x_32
  s_add_u32 s50, s50, 1
  s_cmp_lt_u32 s50, 524288
  s_cbranch_scc1 bell_31
  s_branch L_fail
bell_x_32:
  s_barrier
  s_waitcnt vmcnt(0)
  v_mov_b32 v12, v15
  s_nop 1
  v_min_u32_dpp v12, v12, v12 row_ror:8 row_mask:0xf bank_mask:0xf
  s_nop 1
  v_min_u32_dpp v12, v12, v12 row_ror:4 row_mask:0xf bank_mask:0xf
  s_nop 1
  v_min_u32_dpp v12, v12, v12 row_ror:2 row_mask:0xf bank_mask:0xf
  s_nop 1
  v_min_u32_dpp v12, v12, v12 row_ror:1 row_mask:0xf bank_mask:0xf
  v_mov_b32 v13, v12
  s_nop 1
  v_permlane16_swap_b32 v13, v12
  v_min_u32 v12, v12, v13
  v_mov_b32 v13, v12
  s_nop 1
  v_permlane32_swap_b32 v13, v12
  v_min_u32 v12, v12, v13
  ds_write_b32 v17, v12
  s_sub_u32 s46, s53, 1
  s_waitcnt lgkmcnt(0)
  v_mov_b32 v12, s46
  s_barrier
  s_sleep 0
  buffer_store_dword v12, v19, s[8:11], 0 offen sc1
  s_sleep 8
  s_add_u32 s53, s53, 1
  s_cmp_lt_u32 s53, 64
  s_cbranch_scc1 ow_listen
  s_endpgm
ow_main:
  v_mov_b32 v5, 0x44444444
  v_mov_b32 v10, 0xeeeeeeee
  v_and_b32 v11, 2, v0
  v_cmp_ne_u32 vcc, 0, v11
  s_nop 1
  v_cndmask_b32 v5, v5, v10, vcc
  v_lshlrev_b32 v1, 4, v0
  v_and_b32 v10, 15, v0
  v_lshrrev_b32 v11, 4, v0
  v_lshlrev_b32 v2, 3, v10
  v_lshl_add_u32 v2, v11, 8, v2
  v_and_b32 v13, 1, v10
  v_lshl_add_u32 v12, v11, 1, v13
  v_mov_b32 v4, 0x05040100
  v_mov_b32 v14, 0x03020706
  v_cmp_eq_u32 vcc, 1, v13
  s_nop 1
  v_cndmask_b32 v4, v4, v14, vcc
  v_and_b32 v13, 3, v10
  v_lshl_add_u32 v3, v11, 2, v13
  v_lshlrev_b32 v3, 4, v3
  v_lshrrev_b32 v13, 2, v10
  v_lshl_add_u32 v3, v13, 2, v3
  s_lshl_b32 s46, s62, 8
  s_cmp_ge_u32 s62, 32
  s_cselect_b32 s47, 40960, 0
  s_add_u32 s46, s46, s47
  s_add_u32 s46, s46, s3
  s_add_u32 s46, s46, 12582912
  v_add_u32 v3, s46, v3
  v_mul_u32_u24 v12, 1280, v12
  v_and_b32 v13, 14, v10
  v_lshl_add_u32 v12, v13, 1, v12
  s_lshl_b32 s46, s62, 5
  buffer_load_dword v15, v12, s[12:15], s46 offen
  s_lshl_b32 s63, s62, 16
  s_add_u32 s63, s63, s3
  s_add_u32 s63, s63, 81788928
  s_mov_b32 s61, 0
  s_mov_b32 s52, 0
  s_mov_b32 s58, 0
  s_mov_b32 s54, 0
  s_mov_b32 s100, 0
  s_mov_b32 s49, 1
  s_cmp_ge_u32 s61, s49
  s_cbranch_scc1 wf_done_33
  s_mov_b32 s50, 0
wf_loop_34:
  buffer_load_dword v12, v18, s[8:11], 0 offen sc1
  s_add_u32 s50, s50, 1
  s_cmp_gt_u32 s50, 131072
  s_cbranch_scc1 L_fail
  s_waitcnt vmcnt(0)
  v_min_u32_dpp v12, v12, v12 row_ror:8 row_mask:0xf bank_mask:0xf
  s_nop 1
  v_min_u32_dpp v12, v12, v12 row_ror:4 row_mask:0xf bank_mask:0xf
  s_nop 1
  v_min_u32_dpp v12, v12, v12 row_ror:2 row_mask:0xf bank_mask:0xf
  s_nop 1
  v_min_u32_dpp v12, v12, v12 row_ror:1 row_mask:0xf bank_mask:0xf
  v_mov_b32 v13, v12
  s_nop 1
  v_permlane16_swap_b32 v13, v12
  v_min_u32 v12, v12, v13
  v_mov_b32 v13, v12
  s_nop 1
  v_permlane32_swap_b32 v13, v12
  v_min_u32 v12, v12, v13
  s_nop 0
  v_readfirstlane_b32 s61, v12
  s_nop 0
  s_cmp_ge_u32 s61, s49
  s_cbranch_scc1 wf_done_33
  s_sleep 2
  s_branch wf_loop_34
wf_done_33:
  s_mov_b32 s61, 0
  v_min_u32 v15, -2, v15
  s_mov_b32 s46, 0
  buffer_store_dword v15, v3, s[8:11], s46 offen sc1
  s_mov_b32 s46, 65536
  buffer_store_dword v15, v3, s[8:11], s46 offen sc1
  s_mov_b32 s46, 131072
  buffer_store_dword v15, v3, s[8:11], s46 offen sc1
  s_mov_b32 s46, 196608
  buffer_store_dword v15, v3, s[8:11], s46 offen sc1
  v_mov_b32 v16, 1
  buffer_store_dword v16, v7, s[8:11], 0 offen sc1
  s_mov_b32 s49, 1
  s_cmp_ge_u32 s61, s49
  s_cbranch_scc1 wf_done_35
  s_mov_b32 s50, 0
wf_loop_36:
  buffer_load_dword v12, v9, s[8:11], 0 offen sc1
  s_add_u32 s50, s50, 1
  s_cmp_gt_u32 s50, 131072
  s_cbranch_scc1 L_fail
  s_waitcnt vmcnt(0)
  v_min_u32_dpp v12, v12, v12 row_ror:8 row_mask:0xf bank_mask:0xf
  s_nop 1
  v_min_u32_dpp v12, v12, v12 row_ror:4 row_mask:0xf bank_mask:0xf
  s_nop 1
  v_min_u32_dpp v12, v12, v12 row_ror:2 row_mask:0xf bank_mask:0xf
  s_nop 1
  v_min_u32_dpp v12, v12, v12 row_ror:1 row_mask:0xf bank_mask:0xf
  v_mov_b32 v13, v12
  s_nop 1
  v_permlane16_swap_b32 v13, v12
  v_min_u32 v12, v12, v13
  v_mov_b32 v13, v12
  s_nop 1
  v_permlane32_swap_b32 v13, v12
  v_min_u32 v12, v12, v13
  s_nop 0
  v_readfirstlane_b32 s61, v12
  s_nop 0
  s_cmp_ge_u32 s61, s49
  s_cbranch_scc1 wf_done_35
  s_sleep 2
  s_branch wf_loop_36
wf_done_35:
  s_mov_b32 s65, s63
  s_lshr_b32 s46, s65, 8
  s_and_b32 s46, s46, 0x2000
  s_xor_b32 s65, s65, s46
  s_add_u32 s63, s63, 2621440
  s_cmp_ge_u32 s63, 165675008
  s_cselect_b32 s46, 83886080, 0
  s_sub_u32 s63, s63, s46
  s_add_u32 s46, s65, 0
  s_xor_b32 s46, s46, 0x2000
  buffer_load_dwordx4 a[0:3], v1, s[8:11], s46 offen offset:0 sc1
  buffer_load_dwordx4 a[4:7], v1, s[8:11], s46 offen offset:1024 sc1
  buffer_load_dwordx4 a[8:11], v1, s[8:11], s46 offen offset:2048 sc1
  buffer_load_dwordx4 a[12:15], v1, s[8:11], s46 offen offset:3072 sc1
  s_add_u32 s46, s65, 4096
  s_xor_b32 s46, s46, 0x2000
  buffer_load_dwordx4 a[16:19], v1, s[8:11], s46 offen offset:0 sc1
  buffer_load_dwordx4 a[20:23], v1, s[8:11], s46 offen offset:1024 sc1
  buffer_load_dwordx4 a[24:27], v1, s[8:11], s46 offen offset:2048 sc1
  buffer_load_dwordx4 a[28:31], v1, s[8:11], s46 offen offset:3072 sc1
  s_add_u32 s46, s65, 16384
  buffer_load_dwordx4 a[32:35], v1, s[8:11], s46 offen offset:0 sc1
  buffer_load_dwordx4 a[36:39], v1, s[8:11], s46 offen offset:1024 sc1
  buffer_load_dwordx4 a[40:43], v1, s[8:11], s46 offen offset:2048 sc1
  buffer_load_dwordx4 a[44:47], v1, s[8:11], s46 offen offset:3072 sc1
  s_add_u32 s46, s65, 20480
  buffer_load_dwordx4 a[48:51], v1, s[8:11], s46 offen offset:0 sc1
  buffer_load_dwordx4 a[52:55], v1, s[8:11], s46 offen offset:1024 sc1
  buffer_load_dwordx4 a[56:59], v1, s[8:11], s46 offen offset:2048 sc1
  buffer_load_dwordx4 a[60:63], v1, s[8:11], s46 offen offset:3072 sc1
  s_add_u32 s46, s65, 32768
  buffer_load_dwordx4 a[64:67], v1, s[8:11], s46 offen offset:0 sc1
  buffer_load_dwordx4 a[68:71], v1, s[8:11], s46 offen offset:1024 sc1
  buffer_load_dwordx4 a[72:75], v1, s[8:11], s46 offen offset:2048 sc1
  buffer_load_dwordx4 a[76:79], v1, s[8:11], s46 offen offset:3072 sc1
  s_add_u32 s46, s65, 36864
  buffer_load_dwordx4 a[80:83], v1, s[8:11], s46 offen offset:0 sc1
  buffer_load_dwordx4 a[84:87], v1, s[8:11], s46 offen offset:1024 sc1
  buffer_load_dwordx4 a[88:91], v1, s[8:11], s46 offen offset:2048 sc1
  buffer_load_dwordx4 a[92:95], v1, s[8:11], s46 offen offset:3072 sc1
  s_add_u32 s46, s65, 49152
  buffer_load_dwordx4 a[96:99], v1, s[8:11], s46 offen offset:0 sc1
  buffer_load_dwordx4 a[100:103], v1, s[8:11], s46 offen offset:1024 sc1
  buffer_load_dwordx4 a[104:107], v1, s[8:11], s46 offen offset:2048 sc1
  buffer_load_dwordx4 a[108:111], v1, s[8:11], s46 offen offset:3072 sc1
  s_add_u32 s46, s65, 53248
  buffer_load_dwordx4 a[112:115], v1, s[8:11], s46 offen offset:0 sc1
  buffer_load_dwordx4 a[116:119], v1, s[8:11], s46 offen offset:1024 sc1
  buffer_load_dwordx4 a[120:123], v1, s[8:11], s46 offen offset:2048 sc1
  buffer_load_dwordx4 a[124:127], v1, s[8:11], s46 offen offset:3072 sc1
ow_loop:
  s_add_u32 s53, s52, 1
  s_lshl_b32 s56, s58, 2
  s_add_u32 s56, s56, s43
  s_lshl_b32 s56, s56, 16
  s_add_u32 s56, s56, s3
  s_add_u32 s56, s56, 12582912
  s_add_u32 s66, s58, 1
  s_cmp_eq_u32 s66, 3
  s_cselect_b32 s66, 0, s66
  s_lshl_b32 s72, s54, 21
  s_mul_i32 s46, s58, 655360
  s_add_u32 s72, s72, s46
  s_add_u32 s72, s72, s3
  s_add_u32 s72, s72, 4194304
  s_lshr_b32 s46, s72, 8
  s_and_b32 s46, s46, 0x2000
  s_xor_b32 s72, s72, s46
  s_lshl_b32 s46, s62, 14
  s_add_u32 s72, s72, s46
  s_add_u32 s73, s72, 4096
  s_and_b32 s46, s43, 3
  s_lshl_b32 s46, s46, 16
  s_sub_u32 s56, s56, s46
  s_add_u32 s74, s56, 16384
  s_add_u32 s75, s56, 20480
  s_add_u32 s76, s56, 32768
  s_add_u32 s77, s56, 36864
  s_add_u32 s78, s56, 51200
  s_lshl_b32 s80, s66, 18
  s_add_u32 s81, s80, 65536
  s_add_u32 s82, s80, 131072
  s_add_u32 s83, s80, 196608
  s_cmp_lg_u32 s52, 0
  s_addc_u32 s64, s52, 1
  v_mov_b32 v16, s64
  s_mov_b64 s[16:17], -1
  s_mov_b32 s71, 0
  v_mov_b32 v20, 0
  v_mov_b32 v21, 0
  v_mov_b32 v22, 0
  v_mov_b32 v23, 0
  s_waitcnt vmcnt(0)
  s_barrier
  buffer_load_dwordx4 v[24:27], v1, s[8:11], s72 offen offset:0 sc1
  buffer_load_dwordx4 v[28:31], v1, s[8:11], s72 offen offset:1024 sc1
  buffer_load_dwordx4 v[32:35], v1, s[8:11], s72 offen offset:2048 sc1
  buffer_load_dwordx4 v[36:39], v1, s[8:11], s72 offen offset:3072 sc1
  buffer_load_dwordx4 v[40:43], v1, s[8:11], s73 offen offset:0 sc1
  buffer_load_dwordx4 v[44:47], v1, s[8:11], s73 offen offset:1024 sc1
  buffer_load_dwordx4 v[48:51], v1, s[8:11], s73 offen offset:2048 sc1
  buffer_load_dwordx4 v[52:55], v1, s[8:11], s73 offen offset:3072 sc1
  buffer_load_dwordx4 v[72:75], v1, s[8:11], s74 offen offset:0 sc1
  buffer_load_dwordx4 v[76:79], v1, s[8:11], s74 offen offset:1024 sc1
  buffer_load_dwordx4 v[80:83], v1, s[8:11], s74 offen offset:2048 sc1
  buffer_load_dwordx4 v[84:87], v1, s[8:11], s74 offen offset:3072 sc1
  buffer_load_dwordx4 v[88:91], v1, s[8:11], s75 offen offset:0 sc1
  buffer_load_dwordx4 v[92:95], v1, s[8:11], s75 offen offset:1024 sc1
  buffer_load_dwordx4 v[96:99], v1, s[8:11], s75 offen offset:2048 sc1
  buffer_load_dwordx4 v[100:103], v1, s[8:11], s75 offen offset:3072 sc1
  buffer_load_dwordx4 v[104:107], v1, s[8:11], s76 offen offset:0 sc1
  buffer_load_dwordx4 v[108:111], v1, s[8:11], s76 offen offset:1024 sc1
  buffer_load_dwordx4 v[112:115], v1, s[8:11], s76 offen offset:2048 sc1
  buffer_load_dwordx4 v[116:119], v1, s[8:11], s76 offen offset:3072 sc1
  buffer_load_dwordx4 v[120:123], v1, s[8:11], s77 offen offset:0 sc1
  buffer_load_dwordx4 v[124:127], v1, s[8:11], s77 offen offset:1024 sc1
  buffer_load_dwordx4 v[128:131], v1, s[8:11], s77 offen offset:2048 sc1
  buffer_load_dwordx4 v[132:135], v1, s[8:11], s77 offen offset:3072 sc1
  buffer_load_dwordx4 v[56:59], v1, s[8:11], s78 offen offset:0 sc1
  buffer_load_dwordx4 v[60:63], v1, s[8:11], s78 offen offset:1024 sc1
  buffer_load_dwordx4 v[64:67], v1, s[8:11], s78 offen offset:2048 sc1
  buffer_load_dwordx4 v[68:71], v1, s[8:11], s78 offen offset:3072 sc1
ow_go:
  s_waitcnt vmcnt(22)
  buffer_store_dword v16, v7, s[8:11], 0 offen sc1
  s_waitcnt vmcnt(20)
  v_smfmac_f32_16x16x64_bf16 v[20:23], v[72:75], a[0:7], v5
  s_waitcnt vmcnt(19)
  v_smfmac_f32_16x16x64_bf16 v[20:23], v[76:79], a[8:15], v5
  s_waitcnt vmcnt(18)
  v_smfmac_f32_16x16x64_bf16 v[20:23], v[80:83], a[16:23], v5
  s_waitcnt vmcnt(17)
  v_smfmac_f32_16x16x64_bf16 v[20:23], v[84:87], a[24:31], v5
  s_waitcnt vmcnt(16)
  v_smfmac_f32_16x16x64_bf16 v[20:23], v[88:91], a[32:39], v5
  s_waitcnt vmcnt(15)
  v_smfmac_f32_16x16x64_bf16 v[20:23], v[92:95], a[40:47], v5
  s_waitcnt vmcnt(14)
  v_smfmac_f32_16x16x64_bf16 v[20:23], v[96:99], a[48:55], v5
  s_waitcnt vmcnt(13)
  v_smfmac_f32_16x16x64_bf16 v[20:23], v[100:103], a[56:63], v5
  s_waitcnt vmcnt(12)
  v_smfmac_f32_16x16x64_bf16 v[20:23], v[104:107], a[64:71], v5
  s_waitcnt vmcnt(11)
  v_smfmac_f32_16x16x64_bf16 v[20:23], v[108:111], a[72:79], v5
  s_waitcnt vmcnt(10)
  v_smfmac_f32_16x16x64_bf16 v[20:23], v[112:115], a[80:87], v5
  s_waitcnt vmcnt(9)
  v_smfmac_f32_16x16x64_bf16 v[20:23], v[116:119], a[88:95], v5
  s_waitcnt vmcnt(8)
  v_smfmac_f32_16x16x64_bf16 v[20:23], v[120:123], a[96:103], v5
  s_waitcnt vmcnt(7)
  v_smfmac_f32_16x16x64_bf16 v[20:23], v[124:127], a[104:111], v5
  s_waitcnt vmcnt(6)
  v_smfmac_f32_16x16x64_bf16 v[20:23], v[128:131], a[112:119], v5
  s_waitcnt vmcnt(5)
  v_smfmac_f32_16x16x64_bf16 v[20:23], v[132:135], a[120:127], v5
  s_waitcnt vmcnt(4)
  v_smfmac_f32_16x16x64_bf16 v[20:23], v[56:59], v[24:31], v5
  s_waitcnt vmcnt(3)
  v_smfmac_f32_16x16x64_bf16 v[20:23], v[60:63], v[32:39], v5
  s_waitcnt vmcnt(2)
  v_smfmac_f32_16x16x64_bf16 v[20:23], v[64:67], v[40:47], v5
  s_waitcnt vmcnt(1)
  v_smfmac_f32_16x16x64_bf16 v[20:23], v[68:71], v[48:55], v5
  s_nop 7
  v_pk_add_f32 v[20:21], v[20:21], v[22:23]
  v_cmp_u_f32 vcc, v20, v21
  v_cvt_pk_bf16_f32 v10, v20, v21
  s_nop 1
  v_mov_b32_dpp v11, v10 quad_perm:[1,0,3,2] row_mask:0xf bank_mask:0xf
  v_perm_b32 v10, v11, v10, v4
  s_and_b64 vcc, vcc, s[16:17]
  s_cbranch_scc1 ow_redo
  buffer_store_dword v10, v3, s[8:11], s80 offen sc1
  buffer_store_dword v10, v3, s[8:11], s81 offen sc1
  buffer_store_dword v10, v3, s[8:11], s82 offen sc1
  buffer_store_dword v10, v3, s[8:11], s83 offen sc1
  s_barrier
  s_add_u32 s49, s52, 2
  s_cmp_lg_u32 s52, 0
  s_cbranch_scc1 ow_rung
  v_mov_b32 v16, 2
  buffer_store_dword v16, v7, s[8:11], 0 offen sc1
ow_rung:
  s_waitcnt vmcnt(0)
  ds_read_b32 v12, v17
  s_waitcnt lgkmcnt(0)
  v_readfirstlane_b32 s46, v12
  s_nop 0
  s_max_u32 s61, s61, s46
  s_cmp_ge_u32 s61, s49
  s_cbranch_scc1 wf_done_37
  s_mov_b32 s50, 0
wf_loop_38:
  buffer_load_dword v12, v9, s[8:11], 0 offen sc1
  s_add_u32 s50, s50, 1
  s_cmp_gt_u32 s50, 131072
  s_cbranch_scc1 L_fail
  s_waitcnt vmcnt(0)
  v_min_u32_dpp v12, v12, v12 row_ror:8 row_mask:0xf bank_mask:0xf
  s_nop 1
  v_min_u32_dpp v12, v12, v12 row_ror:4 row_mask:0xf bank_mask:0xf
  s_nop 1
  v_min_u32_dpp v12, v12, v12 row_ror:2 row_mask:0xf bank_mask:0xf
  s_nop 1
  v_min_u32_dpp v12, v12, v12 row_ror:1 row_mask:0xf bank_mask:0xf
  v_mov_b32 v13, v12
  s_nop 1
  v_permlane16_swap_b32 v13, v12
  v_min_u32 v12, v12, v13
  v_mov_b32 v13, v12
  s_nop 1
  v_permlane32_swap_b32 v13, v12
  v_min_u32 v12, v12, v13
  s_nop 0
  v_readfirstlane_b32 s61, v12
  s_nop 0
  s_cmp_ge_u32 s61, s49
  s_cbranch_scc1 wf_done_37
  s_sleep 2
  s_branch wf_loop_38
wf_done_37:
  s_mov_b32 s65, s63
  s_lshr_b32 s46, s65, 8
  s_and_b32 s46, s46, 0x2000
  s_xor_b32 s65, s65, s46
  s_add_u32 s63, s63, 2621440
  s_cmp_ge_u32 s63, 165675008
  s_cselect_b32 s46, 83886080, 0
  s_sub_u32 s63, s63, s46
  s_add_u32 s46, s65, 0
  s_xor_b32 s46, s46, 0x2000
  buffer_load_dwordx4 a[0:3], v1, s[8:11], s46 offen offset:0 sc1
  buffer_load_dwordx4 a[4:7], v1, s[8:11], s46 offen offset:1024 sc1
  buffer_load_dwordx4 a[8:11], v1, s[8:11], s46 offen offset:2048 sc1
  buffer_load_dwordx4 a[12:15], v1, s[8:11], s46 offen offset:3072 sc1
  s_add_u32 s46, s65, 4096
  s_xor_b32 s46, s46, 0x2000
  buffer_load_dwordx4 a[16:19], v1, s[8:11], s46 offen offset:0 sc1
  buffer_load_dwordx4 a[20:23], v1, s[8:11], s46 offen offset:1024 sc1
  buffer_load_dwordx4 a[24:27], v1, s[8:11], s46 offen offset:2048 sc1
  buffer_load_dwordx4 a[28:31], v1, s[8:11], s46 offen offset:3072 sc1
  s_add_u32 s46, s65, 16384
  buffer_load_dwordx4 a[32:35], v1, s[8:11], s46 offen offset:0 sc1
  buffer_load_dwordx4 a[36:39], v1, s[8:11], s46 offen offset:1024 sc1
  buffer_load_dwordx4 a[40:43], v1, s[8:11], s46 offen offset:2048 sc1
  buffer_load_dwordx4 a[44:47], v1, s[8:11], s46 offen offset:3072 sc1
  s_add_u32 s46, s65, 20480
  buffer_load_dwordx4 a[48:51], v1, s[8:11], s46 offen offset:0 sc1
  buffer_load_dwordx4 a[52:55], v1, s[8:11], s46 offen offset:1024 sc1
  buffer_load_dwordx4 a[56:59], v1, s[8:11], s46 offen offset:2048 sc1
  buffer_load_dwordx4 a[60:63], v1, s[8:11], s46 offen offset:3072 sc1
  s_add_u32 s46, s65, 32768
  buffer_load_dwordx4 a[64:67], v1, s[8:11], s46 offen offset:0 sc1
  buffer_load_dwordx4 a[68:71], v1, s[8:11], s46 offen offset:1024 sc1
  buffer_load_dwordx4 a[72:75], v1, s[8:11], s46 offen offset:2048 sc1
  buffer_load_dwordx4 a[76:79], v1, s[8:11], s46 offen offset:3072 sc1
  s_add_u32 s46, s65, 36864
  buffer_load_dwordx4 a[80:83], v1, s[8:11], s46 offen offset:0 sc1
  buffer_load_dwordx4 a[84:87], v1, s[8:11], s46 offen offset:1024 sc1
  buffer_load_dwordx4 a[88:91], v1, s[8:11], s46 offen offset:2048 sc1
  buffer_load_dwordx4 a[92:95], v1, s[8:11], s46 offen offset:3072 sc1
  s_add_u32 s46, s65, 49152
  buffer_load_dwordx4 a[96:99], v1, s[8:11], s46 offen offset:0 sc1
  buffer_load_dwordx4 a[100:103], v1, s[8:11], s46 offen offset:1024 sc1
  buffer_load_dwordx4 a[104:107], v1, s[8:11], s46 offen offset:2048 sc1
  buffer_load_dwordx4 a[108:111], v1, s[8:11], s46 offen offset:3072 sc1
  s_add_u32 s46, s65, 53248
  buffer_load_dwordx4 a[112:115], v1, s[8:11], s46 offen offset:0 sc1
  buffer_load_dwordx4 a[116:119], v1, s[8:11], s46 offen offset:1024 sc1
  buffer_load_dwordx4 a[120:123], v1, s[8:11], s46 offen offset:2048 sc1
  buffer_load_dwordx4 a[124:127], v1, s[8:11], s46 offen offset:3072 sc1
  v_mov_b32 v11, -1
  s_lshl_b32 s47, s58, 18
  s_add_u32 s46, s47, 0
  buffer_store_dword v11, v3, s[8:11], s46 offen sc1
  s_add_u32 s46, s47, 65536
  buffer_store_dword v11, v3, s[8:11], s46 offen sc1
  s_add_u32 s46, s47, 131072
  buffer_store_dword v11, v3, s[8:11], s46 offen sc1
  s_add_u32 s46, s47, 196608
  buffer_store_dword v11, v3, s[8:11], s46 offen sc1
  s_mov_b32 s58, s66
  s_cmp_eq_u32 s58, 0
  s_addc_u32 s54, s54, 0
  s_cmp_eq_u32 s54, 3
  s_cselect_b32 s54, 0, s54
  s_mov_b32 s52, s53
  s_cmp_lt_u32 s52, 63
  s_cbranch_scc1 ow_loop
  s_endpgm
ow_redo:
  s_mov_b32 s50, 0
ow_poll:
  buffer_load_dwordx4 v[24:27], v1, s[8:11], s72 offen offset:0 sc1
  buffer_load_dwordx4 v[28:31], v1, s[8:11], s72 offen offset:1024 sc1
  buffer_load_dwordx4 v[32:35], v1, s[8:11], s72 offen offset:2048 sc1
  buffer_load_dwordx4 v[36:39], v1, s[8:11], s72 offen offset:3072 sc1
  buffer_load_dwordx4 v[40:43], v1, s[8:11], s73 offen offset:0 sc1
  buffer_load_dwordx4 v[44:47], v1, s[8:11], s73 offen offset:1024 sc1
  buffer_load_dwordx4 v[48:51], v1, s[8:11], s73 offen offset:2048 sc1
  buffer_load_dwordx4 v[52:55], v1, s[8:11], s73 offen offset:3072 sc1
  buffer_load_dwordx4 v[72:75], v1, s[8:11], s74 offen offset:0 sc1
  buffer_load_dwordx4 v[76:79], v1, s[8:11], s74 offen offset:1024 sc1
  buffer_load_dwordx4 v[80:83], v1, s[8:11], s74 offen offset:2048 sc1
  buffer_load_dwordx4 v[84:87], v1, s[8:11], s74 offen offset:3072 sc1
  buffer_load_dwordx4 v[88:91], v1, s[8:11], s75 offen offset:0 sc1
  buffer_load_dwordx4 v[92:95], v1, s[8:11], s75 offen offset:1024 sc1
  buffer_load_dwordx4 v[96:99], v1, s[8:11], s75 offen offset:2048 sc1
  buffer_load_dwordx4 v[100:103], v1, s[8:11], s75 offen offset:3072 sc1
  buffer_load_dwordx4 v[104:107], v1, s[8:11], s76 offen offset:0 sc1
  buffer_load_dwordx4 v[108:111], v1, s[8:11], s76 offen offset:1024 sc1
  buffer_load_dwordx4 v[112:115], v1, s[8:11], s76 offen offset:2048 sc1
  buffer_load_dwordx4 v[116:119], v1, s[8:11], s76 offen offset:3072 sc1
  buffer_load_dwordx4 v[120:123], v1, s[8:11], s77 offen offset:0 sc1
  buffer_load_dwordx4 v[124:127], v1, s[8:11], s77 offen offset:1024 sc1
  buffer_load_dwordx4 v[128:131], v1, s[8:11], s77 offen offset:2048 sc1
  buffer_load_dwordx4 v[132:135], v1, s[8:11], s77 offen offset:3072 sc1
  buffer_load_dwordx4 v[56:59], v1, s[8:11], s78 offen offset:0 sc1
  buffer_load_dwordx4 v[60:63], v1, s[8:11], s78 offen offset:1024 sc1
  buffer_load_dwordx4 v[64:67], v1, s[8:11], s78 offen offset:2048 sc1
  buffer_load_dwordx4 v[68:71], v1, s[8:11], s78 offen offset:3072 sc1
  s_add_u32 s71, s71, 1
  s_cmp_le_u32 s71, 2
  s_cbranch_scc1 ow_again
  s_add_u32 s50, s50, 1
  s_cmp_gt_u32 s50, 131072
  s_cbranch_scc1 L_fail
  s_waitcnt vmcnt(0)
  v_max_u32 v8, v24, v25
  v_max3_u32 v8, v26, v27, v8
  v_max3_u32 v8, v28, v29, v8
  v_max3_u32 v8, v30, v31, v8
  v_max3_u32 v8, v32, v33, v8
  v_max3_u32 v8, v34, v35, v8
  v_max3_u32 v8, v36, v37, v8
  v_max3_u32 v8, v38, v39, v8
  v_max3_u32 v8, v40, v41, v8
  v_max3_u32 v8, v42, v43, v8
  v_max3_u32 v8, v44, v45, v8
  v_max3_u32 v8, v46, v47, v8
  v_max3_u32 v8, v48, v49, v8
  v_max3_u32 v8, v50, v51, v8
  v_max3_u32 v8, v52, v53, v8
  v_max3_u32 v8, v54, v55, v8
  v_max3_u32 v8, v56, v57, v8
  v_max3_u32 v8, v58, v59, v8
  v_max3_u32 v8, v60, v61, v8
  v_max3_u32 v8, v62, v63, v8
  v_max3_u32 v8, v64, v65, v8
  v_max3_u32 v8, v66, v67, v8
  v_max3_u32 v8, v68, v69, v8
  v_max3_u32 v8, v70, v71, v8
  v_max3_u32 v8, v72, v73, v8
  v_max3_u32 v8, v74, v75, v8
  v_max3_u32 v8, v76, v77, v8
  v_max3_u32 v8, v78, v79, v8
  v_max3_u32 v8, v80, v81, v8
  v_max3_u32 v8, v82, v83, v8
  v_max3_u32 v8, v84, v85, v8
  v_max3_u32 v8, v86, v87, v8
  v_max3_u32 v8, v88, v89, v8
  v_max3_u32 v8, v90, v91, v8
  v_max3_u32 v8, v92, v93, v8
  v_max3_u32 v8, v94, v95, v8
  v_max3_u32 v8, v96, v97, v8
  v_max3_u32 v8, v98, v99, v8
  v_max3_u32 v8, v100, v101, v8
  v_max3_u32 v8, v102, v103, v8
  v_max3_u32 v8, v104, v105, v8
  v_max3_u32 v8, v106, v107, v8
  v_max3_u32 v8, v108, v109, v8
  v_max3_u32 v8, v110, v111, v8
  v_max3_u32 v8, v112, v113, v8
  v_max3_u32 v8, v114, v115, v8
  v_max3_u32 v8, v116, v117, v8
  v_max3_u32 v8, v118, v119, v8
  v_max3_u32 v8, v120, v121, v8
  v_max3_u32 v8, v122, v123, v8
  v_max3_u32 v8, v124, v125, v8
  v_max3_u32 v8, v126, v127, v8
  v_max3_u32 v8, v128, v129, v8
  v_max3_u32 v8, v130, v131, v8
  v_max3_u32 v8, v132, v133, v8
  v_max3_u32 v8, v134, v135, v8
  v_cmp_eq_u32 vcc, -1, v8
  s_cbranch_vccnz ow_poll
  s_mov_b64 s[16:17], 0
ow_again:
  v_mov_b32 v20, 0
  v_mov_b32 v21, 0
  v_mov_b32 v22, 0
  v_mov_b32 v23, 0
  s_branch ow_go
L_xowner:
  s_mov_b32 s12, s36
  s_mov_b32 s13, s37
  s_mov_b32 s14, 5242880
  s_mov_b32 s15, 0x20000
  s_mov_b32 s50, 0
ss_39:
  v_and_b32 v11, 3, v0
  v_lshlrev_b32 v11, 2, v11
  global_load_dword v10, v11, s[38:39] sc1
  s_add_u32 s50, s50, 1
  s_cmp_gt_u32 s50, 131072
  s_cbranch_scc1 L_fail
  s_waitcnt vmcnt(0)
ss_39_in:
  v_readlane_b32 s46, v10, 0
  v_readlane_b32 s47, v10, 1
  v_readlane_b32 s48, v10, 0
  s_nop 0
  s_min_u32 s47, s47, s48
  s_cmp_lg_u32 s46, 0
  s_cselect_b32 s48, 7, 0
  s_add_u32 s46, s46, s2
  s_xor_b32 s49, s46, s43
  s_and_b32 s49, s49, s48
  s_cbranch_scc1 L_reroll
  s_cmp_lg_u32 s47, 0
  s_cbranch_scc1 ss_ok_40
  s_sleep 6
  s_branch ss_39
ss_ok_40:
  v_readlane_b32 s3, v10, 1
  s_nop 0
  s_and_b32 s3, s3, 0x2000
  s_lshr_b32 s46, s44, 4
  s_lshl_b32 s46, s46, 7
  s_lshl_b32 s47, s43, 4
  s_add_u32 s46, s46, s47
  s_and_b32 s47, s44, 15
  s_add_u32 s46, s46, s47
  s_lshl_b32 s46, s46, 7
  s_add_u32 s46, s46, s3
  s_add_u32 s46, s46, 13369344
  s_add_u32 s40, s8, s46
  s_addc_u32 s41, s9, 0
  s_sub_u32 s48, s44, 26
  s_and_b32 s46, s48, 1
  s_mul_i32 s46, s46, 5
  s_mul_i32 s62, s43, 10
  s_add_u32 s62, s62, s46
  s_lshr_b32 s52, s48, 1
  v_lshlrev_b32 v1, 4, v0
  v_and_b32 v10, 7, v0
  v_lshlrev_b32 v10, 7, v10
  v_add_u32 v10, s51, v10
  v_bfe_u32 v11, v0, 3, 2
  v_lshl_add_u32 v2, v11, 2, v10
  v_add_u32 v3, 1064960, v2
  v_add_u32 v2, 1060864, v2
  v_bfe_u32 v11, v0, 3, 1
  v_lshl_add_u32 v4, v11, 2, v10
  v_add_u32 v4, 1069056, v4
  v_cmp_lt_u32 vcc, 31, v0
  s_nop 1
  v_cndmask_b32 v3, v3, v4, vcc
  s_mul_i32 s46, s43, 6
  s_add_u32 s46, s46, s48
  s_lshl_b32 s46, s46, 7
  s_add_u32 s46, s46, 1073152
  v_mov_b32 v15, s46
  v_mov_b32 v11, 2146435072
  s_cmp_eq_u32 s42, 0
  s_cselect_b64 vcc, 1, 0
  v_cndmask_b32 v15, v11, v15, vcc
  s_mul_i32 s46, s42, 10240
  v_add_u32 v5, s46, v1
  v_add_u32 v6, s51, v1
  s_mul_i32 s63, s52, 40
  s_add_u32 s63, s63, s62
  s_lshl_b32 s63, s63, 16
  s_lshl_b32 s46, s42, 14
  s_add_u32 s63, s63, s46
  s_add_u32 s63, s63, s3
  s_add_u32 s63, s63, 81788928
  s_lshr_b32 s46, 1, s42
  s_and_b32 s46, s46, 1
  s_lshl_b32 s46, s46, 13
  s_xor_b32 s63, s63, s46
  s_lshl_b32 s65, s52, 18
  s_add_u32 s65, s65, s3
  s_add_u32 s65, s65, 14680064
  s_lshl_b32 s67, s62, 14
  s_lshl_b32 s46, s42, 11
  s_add_u32 s67, s67, s46
  s_mov_b32 s58, s52
  s_mul_i32 s66, s52, 81920
  v_and_b32 v10, 15, v0
  v_mul_u32_u24 v10, 2560, v10
  v_lshrrev_b32 v11, 4, v0
  v_lshl_add_u32 v10, v11, 3, v10
  s_add_u32 s46, s42, 0
  s_cmp_ge_u32 s46, 5
  s_cselect_b32 s47, 40800, 0
  s_add_u32 s48, s46, s62
  s_lshl_b32 s48, s48, 5
  s_add_u32 s47, s47, s48
  s_add_u32 s47, s47, 1280
  s_cmp_ge_u32 s46, 10
  s_cselect_b32 s47, 2146435072, s47
  v_add_u32 v7, s47, v10
  s_add_u32 s46, s42, 4
  s_cmp_ge_u32 s46, 5
  s_cselect_b32 s47, 40800, 0
  s_add_u32 s48, s46, s62
  s_lshl_b32 s48, s48, 5
  s_add_u32 s47, s47, s48
  s_add_u32 s47, s47, 1280
  s_cmp_ge_u32 s46, 10
  s_cselect_b32 s47, 2146435072, s47
  v_add_u32 v8, s47, v10
  s_add_u32 s46, s42, 8
  s_cmp_ge_u32 s46, 5
  s_cselect_b32 s47, 40800, 0
  s_add_u32 s48, s46, s62
  s_lshl_b32 s48, s48, 5
  s_add_u32 s47, s47, s48
  s_add_u32 s47, s47, 1280
  s_cmp_ge_u32 s46, 10
  s_cselect_b32 s47, 2146435072, s47
  v_add_u32 v9, s47, v10
  v_mov_b32 v224, -1
  v_mov_b32 v225, -1
  v_mov_b32 v226, -1
  v_mov_b32 v227, -1
  s_cmp_lg_u32 s42, 0
  s_cbranch_scc1 xo_clr
  s_mov_b32 s54, 0
xo_clr0:
  s_lshl_b32 s64, s54, 21
  s_mul_i32 s46, s58, 655360
  s_add_u32 s64, s64, s46
  s_add_u32 s64, s64, s3
  s_add_u32 s64, s64, 4194304
  s_lshr_b32 s46, s64, 8
  s_and_b32 s46, s46, 0x2000
  s_xor_b32 s64, s64, s46
  s_add_u32 s64, s64, s67
  s_add_u32 s46, s64, 0
  buffer_store_dwordx4 v[224:227], v1, s[8:11], s46 offen offset:0 sc1
  buffer_store_dwordx4 v[224:227], v1, s[8:11], s46 offen offset:1024 sc1
  buffer_store_dwordx4 v[224:227], v1, s[8:11], s46 offen offset:2048 sc1
  buffer_store_dwordx4 v[224:227], v1, s[8:11], s46 offen offset:3072 sc1
  s_add_u32 s46, s64, 4096
  buffer_store_dwordx4 v[224:227], v1, s[8:11], s46 offen offset:0 sc1
  buffer_store_dwordx4 v[224:227], v1, s[8:11], s46 offen offset:1024 sc1
  buffer_store_dwordx4 v[224:227], v1, s[8:11], s46 offen offset:2048 sc1
  buffer_store_dwordx4 v[224:227], v1, s[8:11], s46 offen offset:3072 sc1
  s_add_u32 s46, s64, 16384
  buffer_store_dwordx4 v[224:227], v1, s[8:11], s46 offen offset:0 sc1
  buffer_store_dwordx4 v[224:227], v1, s[8:11], s46 offen offset:1024 sc1
  buffer_store_dwordx4 v[224:227], v1, s[8:11], s46 offen offset:2048 sc1
  buffer_store_dwordx4 v[224:227], v1, s[8:11], s46 offen offset:3072 sc1
  s_add_u32 s46, s64, 20480
  buffer_store_dwordx4 v[224:227], v1, s[8:11], s46 offen offset:0 sc1
  buffer_store_dwordx4 v[224:227], v1, s[8:11], s46 offen offset:1024 sc1
  buffer_store_dwordx4 v[224:227], v1, s[8:11], s46 offen offset:2048 sc1
  buffer_store_dwordx4 v[224:227], v1, s[8:11], s46 offen offset:3072 sc1
  s_add_u32 s46, s64, 32768
  buffer_store_dwordx4 v[224:227], v1, s[8:11], s46 offen offset:0 sc1
  buffer_store_dwordx4 v[224:227], v1, s[8:11], s46 offen offset:1024 sc1
  buffer_store_dwordx4 v[224:227], v1, s[8:11], s46 offen offset:2048 sc1
  buffer_store_dwordx4 v[224:227], v1, s[8:11], s46 offen offset:3072 sc1
  s_add_u32 s46, s64, 36864
  buffer_store_dwordx4 v[224:227], v1, s[8:11], s46 offen offset:0 sc1
  buffer_store_dwordx4 v[224:227], v1, s[8:11], s46 offen offset:1024 sc1
  buffer_store_dwordx4 v[224:227], v1, s[8:11], s46 offen offset:2048 sc1
  buffer_store_dwordx4 v[224:227], v1, s[8:11], s46 offen offset:3072 sc1
  s_add_u32 s46, s64, 49152
  buffer_store_dwordx4 v[224:227], v1, s[8:11], s46 offen offset:0 sc1
  buffer_store_dwordx4 v[224:227], v1, s[8:11], s46 offen offset:1024 sc1
  buffer_store_dwordx4 v[224:227], v1, s[8:11], s46 offen offset:2048 sc1
  buffer_store_dwordx4 v[224:227], v1, s[8:11], s46 offen offset:3072 sc1
  s_add_u32 s46, s64, 53248
  buffer_store_dwordx4 v[224:227], v1, s[8:11], s46 offen offset:0 sc1
  buffer_store_dwordx4 v[224:227], v1, s[8:11], s46 offen offset:1024 sc1
  buffer_store_dwordx4 v[224:227], v1, s[8:11], s46 offen offset:2048 sc1
  buffer_store_dwordx4 v[224:227], v1, s[8:11], s46 offen offset:3072 sc1
  s_add_u32 s46, s64, 65536
  buffer_store_dwordx4 v[224:227], v1, s[8:11], s46 offen offset:0 sc1
  buffer_store_dwordx4 v[224:227], v1, s[8:11], s46 offen offset:1024 sc1
  buffer_store_dwordx4 v[224:227], v1, s[8:11], s46 offen offset:2048 sc1
  buffer_store_dwordx4 v[224:227], v1, s[8:11], s46 offen offset:3072 sc1
  s_add_u32 s46, s64, 69632
  buffer_store_dwordx4 v[224:227], v1, s[8:11], s46 offen offset:0 sc1
  buffer_store_dwordx4 v[224:227], v1, s[8:11], s46 offen offset:1024 sc1
  buffer_store_dwordx4 v[224:227], v1, s[8:11], s46 offen offset:2048 sc1
  buffer_store_dwordx4 v[224:227], v1, s[8:11], s46 offen offset:3072 sc1
  s_waitcnt vmcnt(20)
  s_add_u32 s54, s54, 1
  s_cmp_lt_u32 s54, 3
  s_cbranch_scc1 xo_clr0
xo_clr:
  s_mov_b32 s50, 0
ss_41:
  v_and_b32 v11, 3, v0
  v_lshlrev_b32 v11, 2, v11
  global_load_dword v10, v11, s[38:39] sc1
  s_add_u32 s50, s50, 1
  s_cmp_gt_u32 s50, 131072
  s_cbranch_scc1 L_fail
  s_waitcnt vmcnt(0)
ss_41_in:
  v_readlane_b32 s46, v10, 0
  v_readlane_b32 s47, v10, 2
  v_readlane_b32 s48, v10, 1
  s_nop 0
  s_min_u32 s47, s47, s48
  s_cmp_lg_u32 s46, 0
  s_cselect_b32 s48, 7, 0
  s_add_u32 s46, s46, s2
  s_xor_b32 s49, s46, s43
  s_and_b32 s49, s49, s48
  s_cbranch_scc1 L_reroll
  s_cmp_lg_u32 s47, 0
  s_cbranch_scc1 ss_ok_42
  s_sleep 6
  s_branch ss_41
ss_ok_42:
  v_readlane_b32 s3, v10, 1
  s_nop 0
  s_and_b32 s3, s3, 0x2000
  s_add_u32 s46, s52, 6
  v_mov_b32 v10, s46
  s_waitcnt vmcnt(0)
  buffer_store_dword v10, v15, s[8:11], 0 offen sc1
  s_mov_b32 s60, 0
  s_mov_b32 s61, 0
  s_mov_b32 s54, 0
  v_lshlrev_b32 v228, 7, v0
xo_loop:
  s_add_u32 s53, s52, 1
  s_cmp_ge_u32 s60, s53
  s_cbranch_scc1 wf_done_43
  s_mov_b32 s50, 0
wf_loop_44:
  buffer_load_dword v10, v2, s[8:11], 0 offen sc1
  s_add_u32 s50, s50, 1
  s_cmp_gt_u32 s50, 131072
  s_cbranch_scc1 L_fail
  s_waitcnt vmcnt(0)
  v_min_u32_dpp v10, v10, v10 row_ror:8 row_mask:0xf bank_mask:0xf
  s_nop 1
  v_min_u32_dpp v10, v10, v10 row_ror:4 row_mask:0xf bank_mask:0xf
  s_nop 1
  v_min_u32_dpp v10, v10, v10 row_ror:2 row_mask:0xf bank_mask:0xf
  s_nop 1
  v_min_u32_dpp v10, v10, v10 row_ror:1 row_mask:0xf bank_mask:0xf
  v_mov_b32 v11, v10
  s_nop 1
  v_permlane16_swap_b32 v11, v10
  v_min_u32 v10, v10, v11
  v_mov_b32 v11, v10
  s_nop 1
  v_permlane32_swap_b32 v11, v10
  v_min_u32 v10, v10, v11
  s_nop 0
  v_readfirstlane_b32 s60, v10
  s_nop 0
  s_cmp_ge_u32 s60, s53
  s_cbranch_scc1 wf_done_43
  s_sleep 2
  s_branch wf_loop_44
wf_done_43:
  s_add_u32 s46, s63, 0
  s_lshr_b32 s47, s46, 8
  s_and_b32 s47, s47, 0x2000
  s_xor_b32 s46, s46, s47
  buffer_load_dwordx4 a[0:3], v1, s[8:11], s46 offen offset:0 sc1
  buffer_load_dwordx4 a[4:7], v1, s[8:11], s46 offen offset:1024 sc1
  buffer_load_dwordx4 a[8:11], v1, s[8:11], s46 offen offset:2048 sc1
  buffer_load_dwordx4 a[12:15], v1, s[8:11], s46 offen offset:3072 sc1
  s_add_u32 s46, s46, 4096
  buffer_load_dwordx4 a[16:19], v1, s[8:11], s46 offen offset:0 sc1
  buffer_load_dwordx4 a[20:23], v1, s[8:11], s46 offen offset:1024 sc1
  buffer_load_dwordx4 a[24:27], v1, s[8:11], s46 offen offset:2048 sc1
  buffer_load_dwordx4 a[28:31], v1, s[8:11], s46 offen offset:3072 sc1
  s_add_u32 s46, s63, 65536
  s_lshr_b32 s47, s46, 8
  s_and_b32 s47, s47, 0x2000
  s_xor_b32 s46, s46, s47
  buffer_load_dwordx4 a[32:35], v1, s[8:11], s46 offen offset:0 sc1
  buffer_load_dwordx4 a[36:39], v1, s[8:11], s46 offen offset:1024 sc1
  buffer_load_dwordx4 a[40:43], v1, s[8:11], s46 offen offset:2048 sc1
  buffer_load_dwordx4 a[44:47], v1, s[8:11], s46 offen offset:3072 sc1
  s_add_u32 s46, s46, 4096
  buffer_load_dwordx4 a[48:51], v1, s[8:11], s46 offen offset:0 sc1
  buffer_load_dwordx4 a[52:55], v1, s[8:11], s46 offen offset:1024 sc1
  buffer_load_dwordx4 a[56:59], v1, s[8:11], s46 offen offset:2048 sc1
  buffer_load_dwordx4 a[60:63], v1, s[8:11], s46 offen offset:3072 sc1
  s_add_u32 s46, s63, 131072
  s_lshr_b32 s47, s46, 8
  s_and_b32 s47, s47, 0x2000
  s_xor_b32 s46, s46, s47
  buffer_load_dwordx4 a[64:67], v1, s[8:11], s46 offen offset:0 sc1
  buffer_load_dwordx4 a[68:71], v1, s[8:11], s46 offen offset:1024 sc1
  buffer_load_dwordx4 a[72:75], v1, s[8:11], s46 offen offset:2048 sc1
  buffer_load_dwordx4 a[76:79], v1, s[8:11], s46 offen offset:3072 sc1
  s_add_u32 s46, s46, 4096
  buffer_load_dwordx4 a[80:83], v1, s[8:11], s46 offen offset:0 sc1
  buffer_load_dwordx4 a[84:87], v1, s[8:11], s46 offen offset:1024 sc1
  buffer_load_dwordx4 a[88:91], v1, s[8:11], s46 offen offset:2048 sc1
  buffer_load_dwordx4 a[92:95], v1, s[8:11], s46 offen offset:3072 sc1
  s_add_u32 s46, s63, 196608
  s_lshr_b32 s47, s46, 8
  s_and_b32 s47, s47, 0x2000
  s_xor_b32 s46, s46, s47
  buffer_load_dwordx4 a[96:99], v1, s[8:11], s46 offen offset:0 sc1
  buffer_load_dwordx4 a[100:103], v1, s[8:11], s46 offen offset:1024 sc1
  buffer_load_dwordx4 a[104:107], v1, s[8:11], s46 offen offset:2048 sc1
  buffer_load_dwordx4 a[108:111], v1, s[8:11], s46 offen offset:3072 sc1
  s_add_u32 s46, s46, 4096
  buffer_load_dwordx4 a[112:115], v1, s[8:11], s46 offen offset:0 sc1
  buffer_load_dwordx4 a[116:119], v1, s[8:11], s46 offen offset:1024 sc1
  buffer_load_dwordx4 a[120:123], v1, s[8:11], s46 offen offset:2048 sc1
  buffer_load_dwordx4 a[124:127], v1, s[8:11], s46 offen offset:3072 sc1
  s_add_u32 s46, s63, 262144
  s_lshr_b32 s47, s46, 8
  s_and_b32 s47, s47, 0x2000
  s_xor_b32 s46, s46, s47
  buffer_load_dwordx4 a[128:131], v1, s[8:11], s46 offen offset:0 sc1
  buffer_load_dwordx4 a[132:135], v1, s[8:11], s46 offen offset:1024 sc1
  buffer_load_dwordx4 a[136:139], v1, s[8:11], s46 offen offset:2048 sc1
  buffer_load_dwordx4 a[140:143], v1, s[8:11], s46 offen offset:3072 sc1
  s_add_u32 s46, s46, 4096
  buffer_load_dwordx4 a[144:147], v1, s[8:11], s46 offen offset:0 sc1
  buffer_load_dwordx4 a[148:151], v1, s[8:11], s46 offen offset:1024 sc1
  buffer_load_dwordx4 a[152:155], v1, s[8:11], s46 offen offset:2048 sc1
  buffer_load_dwordx4 a[156:159], v1, s[8:11], s46 offen offset:3072 sc1
  s_waitcnt vmcnt(24)
  s_cmp_ge_u32 s52, 62
  s_cbranch_scc1 xo_last
  s_cmp_lg_u32 s42, 0
  s_cbranch_scc1 xo_go
  s_mov_b32 s50, 0
box_45:
  s_load_dword s80, s[40:41], 0 glc
  s_add_u32 s50, s50, 1
  s_cmp_gt_u32 s50, 131072
  s_cbranch_scc1 L_fail
  s_waitcnt lgkmcnt(0)
  s_cmp_lt_u32 s80, s53
  s_cbranch_scc1 box_45
  s_branch xo_go
xo_last:
  s_mov_b32 s53, 64
  s_mov_b32 s61, 0
  s_cmp_ge_u32 s61, s53
  s_cbranch_scc1 wf_done_47
  s_mov_b32 s50, 0
wf_loop_48:
  buffer_load_dword v10, v3, s[8:11], 0 offen sc1
  s_add_u32 s50, s50, 1
  s_cmp_gt_u32 s50, 131072
  s_cbranch_scc1 L_fail
  s_waitcnt vmcnt(0)
  v_min_u32_dpp v10, v10, v10 row_ror:8 row_mask:0xf bank_mask:0xf
  s_nop 1
  v_min_u32_dpp v10, v10, v10 row_ror:4 row_mask:0xf bank_mask:0xf
  s_nop 1
  v_min_u32_dpp v10, v10, v10 row_ror:2 row_mask:0xf bank_mask:0xf
  s_nop 1
  v_min_u32_dpp v10, v10, v10 row_ror:1 row_mask:0xf bank_mask:0xf
  v_mov_b32 v11, v10
  s_nop 1
  v_permlane16_swap_b32 v11, v10
  v_min_u32 v10, v10, v11
  v_mov_b32 v11, v10
  s_nop 1
  v_permlane32_swap_b32 v11, v10
  v_min_u32 v10, v10, v11
  s_nop 0
  v_readfirstlane_b32 s61, v10
  s_nop 0
  s_cmp_ge_u32 s61, s53
  s_cbranch_scc1 wf_done_47
  s_sleep 2
  s_branch wf_loop_48
wf_done_47:
xo_go:
  s_barrier
  s_lshl_b32 s64, s54, 21
  s_mul_i32 s46, s58, 655360
  s_add_u32 s64, s64, s46
  s_add_u32 s64, s64, s3
  s_add_u32 s64, s64, 4194304
  s_lshr_b32 s46, s64, 8
  s_and_b32 s46, s46, 0x2000
  s_xor_b32 s64, s64, s46
  s_add_u32 s64, s64, s67
  s_mov_b32 s49, s65
  s_lshr_b32 s46, s49, 8
  s_and_b32 s46, s46, 0x2000
  s_xor_b32 s49, s49, s46
  s_lshl_b32 s47, s42, 14
  s_add_u32 s47, s47, s49
  s_lshl_b32 s48, s42, 11
  s_add_u32 s48, s48, s49
  s_add_u32 s46, s47, 0
  buffer_load_dwordx4 v[56:59], v1, s[8:11], s46 offen sc1
  s_add_u32 s46, s47, 81920
  buffer_load_dwordx4 v[60:63], v1, s[8:11], s46 offen sc1
  s_add_u32 s46, s47, 1024
  buffer_load_dwordx4 v[64:67], v1, s[8:11], s46 offen sc1
  s_add_u32 s46, s47, 82944
  buffer_load_dwordx4 v[68:71], v1, s[8:11], s46 offen sc1
  s_add_u32 s46, s47, 2048
  buffer_load_dwordx4 v[72:75], v1, s[8:11], s46 offen sc1
  s_add_u32 s46, s47, 83968
  buffer_load_dwordx4 v[76:79], v1, s[8:11], s46 offen sc1
  s_add_u32 s46, s47, 3072
  buffer_load_dwordx4 v[80:83], v1, s[8:11], s46 offen sc1
  s_add_u32 s46, s47, 84992
  buffer_load_dwordx4 v[84:87], v1, s[8:11], s46 offen sc1
  s_add_u32 s46, s47, 4096
  buffer_load_dwordx4 v[88:91], v1, s[8:11], s46 offen sc1
  s_add_u32 s46, s47, 86016
  buffer_load_dwordx4 v[92:95], v1, s[8:11], s46 offen sc1
  s_add_u32 s46, s47, 5120
  buffer_load_dwordx4 v[96:99], v1, s[8:11], s46 offen sc1
  s_add_u32 s46, s47, 87040
  buffer_load_dwordx4 v[100:103], v1, s[8:11], s46 offen sc1
  s_add_u32 s46, s47, 6144
  buffer_load_dwordx4 v[104:107], v1, s[8:11], s46 offen sc1
  s_add_u32 s46, s47, 88064
  buffer_load_dwordx4 v[108:111], v1, s[8:11], s46 offen sc1
  s_add_u32 s46, s47, 7168
  buffer_load_dwordx4 v[112:115], v1, s[8:11], s46 offen sc1
  s_add_u32 s46, s47, 89088
  buffer_load_dwordx4 v[116:119], v1, s[8:11], s46 offen sc1
  s_add_u32 s46, s48, 65536
  buffer_load_dwordx4 v[120:123], v1, s[8:11], s46 offen sc1
  s_add_u32 s46, s48, 147456
  buffer_load_dwordx4 v[124:127], v1, s[8:11], s46 offen sc1
  s_add_u32 s46, s48, 66560
  buffer_load_dwordx4 v[128:131], v1, s[8:11], s46 offen sc1
  s_add_u32 s46, s48, 148480
  buffer_load_dwordx4 v[132:135], v1, s[8:11], s46 offen sc1
  s_add_u32 s46, s64, 0
  buffer_load_dwordx4 v[16:19], v1, s[8:11], s46 offen offset:0 sc1
  buffer_load_dwordx4 v[20:23], v1, s[8:11], s46 offen offset:1024 sc1
  s_add_u32 s46, s64, 16384
  buffer_load_dwordx4 v[24:27], v1, s[8:11], s46 offen offset:0 sc1
  buffer_load_dwordx4 v[28:31], v1, s[8:11], s46 offen offset:1024 sc1
  s_add_u32 s46, s64, 32768
  buffer_load_dwordx4 v[32:35], v1, s[8:11], s46 offen offset:0 sc1
  buffer_load_dwordx4 v[36:39], v1, s[8:11], s46 offen offset:1024 sc1
  s_add_u32 s46, s64, 49152
  buffer_load_dwordx4 v[40:43], v1, s[8:11], s46 offen offset:0 sc1
  buffer_load_dwordx4 v[44:47], v1, s[8:11], s46 offen offset:1024 sc1
  s_add_u32 s46, s64, 65536
  buffer_load_dwordx4 v[48:51], v1, s[8:11], s46 offen offset:0 sc1
  buffer_load_dwordx4 v[52:55], v1, s[8:11], s46 offen offset:1024 sc1
  s_waitcnt vmcnt(29)
  v_mfma_f32_16x16x32_bf16 v[136:139], a[0:3], v[56:59], 0
  v_mfma_f32_16x16x32_bf16 v[140:143], a[32:35], v[56:59], 0
  v_mfma_f32_16x16x32_bf16 v[144:147], a[64:67], v[56:59], 0
  v_mfma_f32_16x16x32_bf16 v[148:151], a[96:99], v[56:59], 0
  v_mfma_f32_16x16x32_bf16 v[152:155], a[128:131], v[56:59], 0
  s_waitcnt vmcnt(28)
  v_mfma_f32_16x16x32_bf16 v[156:159], a[0:3], v[60:63], 0
  v_mfma_f32_16x16x32_bf16 v[160:163], a[32:35], v[60:63], 0
  v_mfma_f32_16x16x32_bf16 v[164:167], a[64:67], v[60:63], 0
  v_mfma_f32_16x16x32_bf16 v[168:171], a[96:99], v[60:63], 0
  v_mfma_f32_16x16x32_bf16 v[172:175], a[128:131], v[60:63], 0
  s_waitcnt vmcnt(27)
  v_mfma_f32_16x16x32_bf16 v[136:139], a[4:7], v[64:67], v[136:139]
  v_mfma_f32_16x16x32_bf16 v[140:143], a[36:39], v[64:67], v[140:143]
  v_mfma_f32_16x16x32_bf16 v[144:147], a[68:71], v[64:67], v[144:147]
  v_mfma_f32_16x16x32_bf16 v[148:151], a[100:103], v[64:67], v[148:151]
  v_mfma_f32_16x16x32_bf16 v[152:155], a[132:135], v[64:67], v[152:155]
  s_waitcnt vmcnt(26)
  v_mfma_f32_16x16x32_bf16 v[156:159], a[4:7], v[68:71], v[156:159]
  v_mfma_f32_16x16x32_bf16 v[160:163], a[36:39], v[68:71], v[160:163]
  v_mfma_f32_16x16x32_bf16 v[164:167], a[68:71], v[68:71], v[164:167]
  v_mfma_f32_16x16x32_bf16 v[168:171], a[100:103], v[68:71], v[168:171]
  v_mfma_f32_16x16x32_bf16 v[172:175], a[132:135], v[68:71], v[172:175]
  s_waitcnt vmcnt(25)
  v_mfma_f32_16x16x32_bf16 v[136:139], a[8:11], v[72:75], v[136:139]
  v_mfma_f32_16x16x32_bf16 v[140:143], a[40:43], v[72:75], v[140:143]
  v_mfma_f32_16x16x32_bf16 v[144:147], a[72:75], v[72:75], v[144:147]
  v_mfma_f32_16x16x32_bf16 v[148:151], a[104:107], v[72:75], v[148:151]
  v_mfma_f32_16x16x32_bf16 v[152:155], a[136:139], v[72:75], v[152:155]
  s_waitcnt vmcnt(24)
  v_mfma_f32_16x16x32_bf16 v[156:159], a[8:11], v[76:79], v[156:159]
  v_mfma_f32_16x16x32_bf16 v[160:163], a[40:43], v[76:79], v[160:163]
  v_mfma_f32_16x16x32_bf16 v[164:167], a[72:75], v[76:79], v[164:167]
  v_mfma_f32_16x16x32_bf16 v[168:171], a[104:107], v[76:79], v[168:171]
  v_mfma_f32_16x16x32_bf16 v[172:175], a[136:139], v[76:79], v[172:175]
  s_waitcnt vmcnt(23)
  v_mfma_f32_16x16x32_bf16 v[136:139], a[12:15], v[80:83], v[136:139]
  v_mfma_f32_16x16x32_bf16 v[140:143], a[44:47], v[80:83], v[140:143]
  v_mfma_f32_16x16x32_bf16 v[144:147], a[76:79], v[80:83], v[144:147]
  v_mfma_f32_16x16x32_bf16 v[148:151], a[108:111], v[80:83], v[148:151]
  v_mfma_f32_16x16x32_bf16 v[152:155], a[140:143], v[80:83], v[152:155]
  s_waitcnt vmcnt(22)
  v_mfma_f32_16x16x32_bf16 v[156:159], a[12:15], v[84:87], v[156:159]
  v_mfma_f32_16x16x32_bf16 v[160:163], a[44:47], v[84:87], v[160:163]
  v_mfma_f32_16x16x32_bf16 v[164:167], a[76:79], v[84:87], v[164:167]
  v_mfma_f32_16x16x32_bf16 v[168:171], a[108:111], v[84:87], v[168:171]
  v_mfma_f32_16x16x32_bf16 v[172:175], a[140:143], v[84:87], v[172:175]
  s_waitcnt vmcnt(21)
  v_mfma_f32_16x16x32_bf16 v[136:139], a[16:19], v[88:91], v[136:139]
  v_mfma_f32_16x16x32_bf16 v[140:143], a[48:51], v[88:91], v[140:143]
  v_mfma_f32_16x16x32_bf16 v[144:147], a[80:83], v[88:91], v[144:147]
  v_mfma_f32_16x16x32_bf16 v[148:151], a[112:115], v[88:91], v[148:151]
  v_mfma_f32_16x16x32_bf16 v[152:155], a[144:147], v[88:91], v[152:155]
  s_waitcnt vmcnt(20)
  v_mfma_f32_16x16x32_bf16 v[156:159], a[16:19], v[92:95], v[156:159]
  v_mfma_f32_16x16x32_bf16 v[160:163], a[48:51], v[92:95], v[160:163]
  v_mfma_f32_16x16x32_bf16 v[164:167], a[80:83], v[92:95], v[164:167]
  v_mfma_f32_16x16x32_bf16 v[168:171], a[112:115], v[92:95], v[168:171]
  v_mfma_f32_16x16x32_bf16 v[172:175], a[144:147], v[92:95], v[172:175]
  s_waitcnt vmcnt(19)
  v_mfma_f32_16x16x32_bf16 v[136:139], a[20:23], v[96:99], v[136:139]
  v_mfma_f32_16x16x32_bf16 v[140:143], a[52:55], v[96:99], v[140:143]
  v_mfma_f32_16x16x32_bf16 v[144:147], a[84:87], v[96:99], v[144:147]
  v_mfma_f32_16x16x32_bf16 v[148:151], a[116:119], v[96:99], v[148:151]
  v_mfma_f32_16x16x32_bf16 v[152:155], a[148:151], v[96:99], v[152:155]
  s_waitcnt vmcnt(18)
  v_mfma_f32_16x16x32_bf16 v[156:159], a[20:23], v[100:103], v[156:159]
  v_mfma_f32_16x16x32_bf16 v[160:163], a[52:55], v[100:103], v[160:163]
  v_mfma_f32_16x16x32_bf16 v[164:167], a[84:87], v[100:103], v[164:167]
  v_mfma_f32_16x16x32_bf16 v[168:171], a[116:119], v[100:103], v[168:171]
  v_mfma_f32_16x16x32_bf16 v[172:175], a[148:151], v[100:103], v[172:175]
  s_waitcnt vmcnt(17)
  v_mfma_f32_16x16x32_bf16 v[136:139], a[24:27], v[104:107], v[136:139]
  v_mfma_f32_16x16x32_bf16 v[140:143], a[56:59], v[104:107], v[140:143]
  v_mfma_f32_16x16x32_bf16 v[144:147], a[88:91], v[104:107], v[144:147]
  v_mfma_f32_16x16x32_bf16 v[148:151], a[120:123], v[104:107], v[148:151]
  v_mfma_f32_16x16x32_bf16 v[152:155], a[152:155], v[104:107], v[152:155]
  s_waitcnt vmcnt(16)
  v_mfma_f32_16x16x32_bf16 v[156:159], a[24:27], v[108:111], v[156:159]
  v_mfma_f32_16x16x32_bf16 v[160:163], a[56:59], v[108:111], v[160:163]
  v_mfma_f32_16x16x32_bf16 v[164:167], a[88:91], v[108:111], v[164:167]
  v_mfma_f32_16x16x32_bf16 v[168:171], a[120:123], v[108:111], v[168:171]
  v_mfma_f32_16x16x32_bf16 v[172:175], a[152:155], v[108:111], v[172:175]
  s_waitcnt vmcnt(15)
  v_mfma_f32_16x16x32_bf16 v[136:139], a[28:31], v[112:115], v[136:139]
  v_mfma_f32_16x16x32_bf16 v[140:143], a[60:63], v[112:115], v[140:143]
  v_mfma_f32_16x16x32_bf16 v[144:147], a[92:95], v[112:115], v[144:147]
  v_mfma_f32_16x16x32_bf16 v[148:151], a[124:127], v[112:115], v[148:151]
  v_mfma_f32_16x16x32_bf16 v[152:155], a[156:159], v[112:115], v[152:155]
  s_waitcnt vmcnt(14)
  v_mfma_f32_16x16x32_bf16 v[156:159], a[28:31], v[116:119], v[156:159]
  v_mfma_f32_16x16x32_bf16 v[160:163], a[60:63], v[116:119], v[160:163]
  v_mfma_f32_16x16x32_bf16 v[164:167], a[92:95], v[116:119], v[164:167]
  v_mfma_f32_16x16x32_bf16 v[168:171], a[124:127], v[116:119], v[168:171]
  v_mfma_f32_16x16x32_bf16 v[172:175], a[156:159], v[116:119], v[172:175]
  s_waitcnt vmcnt(8)
  v_mfma_f32_16x16x32_bf16 v[136:139], v[16:19], v[120:123], v[136:139]
  v_mfma_f32_16x16x32_bf16 v[156:159], v[16:19], v[124:127], v[156:159]
  v_mfma_f32_16x16x32_bf16 v[136:139], v[20:23], v[128:131], v[136:139]
  v_mfma_f32_16x16x32_bf16 v[156:159], v[20:23], v[132:135], v[156:159]
  s_waitcnt vmcnt(6)
  v_mfma_f32_16x16x32_bf16 v[140:143], v[24:27], v[120:123], v[140:143]
  v_mfma_f32_16x16x32_bf16 v[160:163], v[24:27], v[124:127], v[160:163]
  v_mfma_f32_16x16x32_bf16 v[140:143], v[28:31], v[128:131], v[140:143]
  v_mfma_f32_16x16x32_bf16 v[160:163], v[28:31], v[132:135], v[160:163]
  s_waitcnt vmcnt(4)
  v_mfma_f32_16x16x32_bf16 v[144:147], v[32:35], v[120:123], v[144:147]
  v_mfma_f32_16x16x32_bf16 v[164:167], v[32:35], v[124:127], v[164:167]
  v_mfma_f32_16x16x32_bf16 v[144:147], v[36:39], v[128:131], v[144:147]
  v_mfma_f32_16x16x32_bf16 v[164:167], v[36:39], v[132:135], v[164:167]
  s_waitcnt vmcnt(2)
  v_mfma_f32_16x16x32_bf16 v[148:151], v[40:43], v[120:123], v[148:151]
  v_mfma_f32_16x16x32_bf16 v[168:171], v[40:43], v[124:127], v[168:171]
  v_mfma_f32_16x16x32_bf16 v[148:151], v[44:47], v[128:131], v[148:151]
  v_mfma_f32_16x16x32_bf16 v[168:171], v[44:47], v[132:135], v[168:171]
  s_waitcnt vmcnt(0)
  v_mfma_f32_16x16x32_bf16 v[152:155], v[48:51], v[120:123], v[152:155]
  v_mfma_f32_16x16x32_bf16 v[172:175], v[48:51], v[124:127], v[172:175]
  v_mfma_f32_16x16x32_bf16 v[152:155], v[52:55], v[128:131], v[152:155]
  v_mfma_f32_16x16x32_bf16 v[172:175], v[52:55], v[132:135], v[172:175]
  s_cmp_ge_u32 s52, 55
  s_cbranch_scc1 xo_nop
  s_add_u32 s46, s64, 0
  buffer_store_dwordx4 v[224:227], v1, s[8:11], s46 offen offset:0 sc1
  buffer_store_dwordx4 v[224:227], v1, s[8:11], s46 offen offset:1024 sc1
  s_add_u32 s46, s64, 16384
  buffer_store_dwordx4 v[224:227], v1, s[8:11], s46 offen offset:0 sc1
  buffer_store_dwordx4 v[224:227], v1, s[8:11], s46 offen offset:1024 sc1
  s_add_u32 s46, s64, 32768
  buffer_store_dwordx4 v[224:227], v1, s[8:11], s46 offen offset:0 sc1
  buffer_store_dwordx4 v[224:227], v1, s[8:11], s46 offen offset:1024 sc1
  s_add_u32 s46, s64, 49152
  buffer_store_dwordx4 v[224:227], v1, s[8:11], s46 offen offset:0 sc1
  buffer_store_dwordx4 v[224:227], v1, s[8:11], s46 offen offset:1024 sc1
  s_add_u32 s46, s64, 65536
  buffer_store_dwordx4 v[224:227], v1, s[8:11], s46 offen offset:0 sc1
  buffer_store_dwordx4 v[224:227], v1, s[8:11], s46 offen offset:1024 sc1
xo_nop:
  ds_write_b128 v5, v[136:139] offset:0
  ds_write_b128 v5, v[140:143] offset:1024
  ds_write_b128 v5, v[144:147] offset:2048
  ds_write_b128 v5, v[148:151] offset:3072
  s_nop 0
  ds_write_b128 v5, v[152:155] offset:4096
  ds_write_b128 v5, v[156:159] offset:5120
  ds_write_b128 v5, v[160:163] offset:6144
  ds_write_b128 v5, v[164:167] offset:7168
  ds_write_b128 v5, v[168:171] offset:8192
  ds_write_b128 v5, v[172:175] offset:9216
  s_waitcnt lgkmcnt(0)
  s_barrier
  ds_read_b128 v[176:179], v6 offset:0
  ds_read_b128 v[180:183], v6 offset:10240
  ds_read_b128 v[184:187], v6 offset:20480
  ds_read_b128 v[188:191], v6 offset:30720
  ds_read_b128 v[192:195], v6 offset:4096
  ds_read_b128 v[196:199], v6 offset:14336
  ds_read_b128 v[200:203], v6 offset:24576
  ds_read_b128 v[204:207], v6 offset:34816
  ds_read_b128 v[208:211], v6 offset:8192
  ds_read_b128 v[212:215], v6 offset:18432
  ds_read_b128 v[216:219], v6 offset:28672
  ds_read_b128 v[220:223], v6 offset:38912
  s_waitcnt lgkmcnt(8)
  v_add_f32 v176, v176, v180
  v_add_f32 v184, v184, v188
  v_add_f32 v176, v176, v184
  v_add_f32 v177, v177, v181
  v_add_f32 v185, v185, v189
  v_add_f32 v177, v177, v185
  v_add_f32 v178, v178, v182
  v_add_f32 v186, v186, v190
  v_add_f32 v178, v178, v186
  v_add_f32 v179, v179, v183
  v_add_f32 v187, v187, v191
  v_add_f32 v179, v179, v187
  v_cvt_pk_bf16_f32 v176, v176, v177
  v_cvt_pk_bf16_f32 v177, v178, v179
  buffer_store_dwordx2 v[176:177], v7, s[12:15], s66 offen
  s_waitcnt lgkmcnt(4)
  v_add_f32 v192, v192, v196
  v_add_f32 v200, v200, v204
  v_add_f32 v192, v192, v200
  v_add_f32 v193, v193, v197
  v_add_f32 v201, v201, v205
  v_add_f32 v193, v193, v201
  v_add_f32 v194, v194, v198
  v_add_f32 v202, v202, v206
  v_add_f32 v194, v194, v202
  v_add_f32 v195, v195, v199
  v_add_f32 v203, v203, v207
  v_add_f32 v195, v195, v203
  v_cvt_pk_bf16_f32 v192, v192, v193
  v_cvt_pk_bf16_f32 v193, v194, v195
  buffer_store_dwordx2 v[192:193], v8, s[12:15], s66 offen
  s_waitcnt lgkmcnt(0)
  v_add_f32 v208, v208, v212
  v_add_f32 v216, v216, v220
  v_add_f32 v208, v208, v216
  v_add_f32 v209, v209, v213
  v_add_f32 v217, v217, v221
  v_add_f32 v209, v209, v217
  v_add_f32 v210, v210, v214
  v_add_f32 v218, v218, v222
  v_add_f32 v210, v210, v218
  v_add_f32 v211, v211, v215
  v_add_f32 v219, v219, v223
  v_add_f32 v211, v211, v219
  v_cvt_pk_bf16_f32 v208, v208, v209
  v_cvt_pk_bf16_f32 v209, v210, v211
  buffer_store_dwordx2 v[208:209], v9, s[12:15], s66 offen
  s_cmp_ge_u32 s52, 61
  s_cbranch_scc1 xo_end
  s_add_u32 s46, s52, 9
  v_mov_b32 v10, s46
  s_waitcnt vmcnt(0)
  s_barrier
  buffer_store_dword v10, v15, s[8:11], 0 offen sc1
  s_add_u32 s54, s54, 1
  s_cmp_eq_u32 s54, 3
  s_cselect_b32 s54, 0, s54
  s_add_u32 s63, s63, 7864320
  s_cmp_ge_u32 s63, 165675008
  s_cselect_b32 s46, 83886080, 0
  s_sub_u32 s63, s63, s46
  s_add_u32 s65, s65, 786432
  s_cmp_ge_u32 s65, 16777216
  s_cselect_b32 s46, 2097152, 0
  s_sub_u32 s65, s65, s46
  s_add_u32 s66, s66, 245760
  s_add_u32 s52, s52, 3
  s_cmp_lt_u32 s52, 64
  s_cbranch_scc1 xo_loop
xo_end:
  s_endpgm
L_end:
  s_endpgm
L_fail:
  s_mov_b32 s4, s38
  s_mov_b32 s5, s39
  s_mov_b32 s6, 256
  s_mov_b32 s7, 0x20000
  s_lshl_b32 s46, s43, 8
  s_or_b32 s46, s46, s44
  s_or_b32 s46, s46, 0x10000
  v_mov_b32 v1, 32
  v_mov_b32 v2, s46
  s_mov_b64 exec, 1
  buffer_store_dword v2, v1, s[4:7], 0 offen sc1
  s_waitcnt vmcnt(0)
  s_endpgm
.section .rodata,"a"
.p2align 6
.amdhsa_kernel concat_heads__sliding_local_dilated__memory_aug_recurrent_mem_tr__prompt_kernel
  .amdhsa_next_free_vgpr 512
  .amdhsa_next_free_sgpr 102
  .amdhsa_accum_offset 256
  .amdhsa_group_segment_fixed_size 0
  .amdhsa_kernarg_size 104
  .amdhsa_user_sgpr_count 2
  .amdhsa_user_sgpr_kernarg_segment_ptr 1
  .amdhsa_system_sgpr_workgroup_id_x 1
.end_amdhsa_kernel
```

```asm
; @launch kernel=concat_heads__sliding_local_dilated__memory_aug_recurrent_mem_tr__prompt_kernel grid=(256,1,1) block=(256,1,1) lds=163840
.amdgcn_target "amdgcn-amd-amdhsa--gfx950"
.text
.globl concat_heads__sliding_local_dilated__memory_aug_recurrent_mem_tr__prompt_kernel
.p2align 8
.type concat_heads__sliding_local_dilated__memory_aug_recurrent_mem_tr__prompt_kernel,@function
concat_heads__sliding_local_dilated__memory_aug_recurrent_mem_tr__prompt_kernel:
  s_cmp_ge_u32 s2, 256
  s_cbranch_scc1 L_end
  v_lshrrev_b32 v1, 6, v0
  v_and_b32 v0, 63, v0
  v_readfirstlane_b32 s42, v1
  s_getreg_b32 s46, hwreg(HW_REG_XCC_ID)
  s_lshr_b32 s44, s2, 3
  s_lshl_b32 s51, s42, 10
  s_mov_b32 s3, 0
  s_mov_b32 s50, -1
  s_branch L_first
L_reroll:
  s_waitcnt vmcnt(0) lgkmcnt(0)
  s_barrier
L_first:
  s_load_dwordx16 s[16:31], s[0:1], 0
  s_load_dwordx8 s[32:39], s[0:1], 64
  s_load_dwordx2 s[40:41], s[0:1], 96
  s_and_b32 s43, s46, 7
  s_and_b32 s46, s44, 7
  s_lshl_b32 s46, s46, 0
  s_and_b32 s47, s43, 3
  s_lshl_b32 s47, s47, 3
  s_add_u32 s45, s46, s47
  s_waitcnt lgkmcnt(0)
  s_add_u32 s8, s40, 0xffffff
  s_addc_u32 s9, s41, 0
  s_and_b32 s8, s8, 0xff000000
  s_mov_b32 s10, 251658240
  s_mov_b32 s11, 0x20000
  s_mov_b32 s4, s38
  s_mov_b32 s5, s39
  s_mov_b32 s6, 256
  s_mov_b32 s7, 0x20000
  s_mov_b32 s12, s22
  s_mov_b32 s13, s23
  s_mov_b32 s14, 2621440
  s_mov_b32 s15, 0x20000
  s_or_b32 s46, s2, s42
  s_cbranch_scc1 L_norot
  v_mov_b32 v1, 0
  s_or_b32 s46, s43, 8
  v_mov_b32 v2, s46
  buffer_store_dword v2, v1, s[4:7], 0 offen sc1
L_norot:
  s_cmp_lg_u32 s50, -1
  s_cbranch_scc1 pr_skip
  s_lshr_b32 s46, s2, 4
  s_cmp_lg_u32 s46, 13
  s_cbranch_scc1 pr_skip
  s_cmp_lg_u32 s42, 0
  s_cbranch_scc1 pr_skip
  v_lshlrev_b32 v1, 2, v0
  s_mov_b32 s66, 0x10000
  s_cmp_ge_u32 s43, 4
  s_cbranch_scc1 pr_report
  s_lshl_b32 s62, s43, 14
  s_and_b32 s46, s44, 1
  s_lshl_b32 s46, s46, 12
  s_add_u32 s62, s62, s46
  s_add_u32 s62, s62, 6160384
  s_add_u32 s65, s62, 8192
  buffer_store_dword v1, v1, s[8:11], s62 offen sc1
  buffer_store_dword v1, v1, s[8:11], s65 offen sc1
  s_mov_b32 s63, -1
  s_mov_b32 s64, -1
  s_waitcnt vmcnt(0)
  s_memtime s[72:73]
  s_waitcnt lgkmcnt(0)
  buffer_store_dword v1, v1, s[8:11], s62 offen sc1
  s_waitcnt vmcnt(0)
  s_memtime s[74:75]
  s_waitcnt lgkmcnt(0)
  s_sub_u32 s46, s74, s72
  s_min_u32 s63, s63, s46
  s_memtime s[72:73]
  s_waitcnt lgkmcnt(0)
  buffer_store_dword v1, v1, s[8:11], s65 offen sc1
  s_waitcnt vmcnt(0)
  s_memtime s[74:75]
  s_waitcnt lgkmcnt(0)
  s_sub_u32 s46, s74, s72
  s_min_u32 s64, s64, s46
  s_memtime s[72:73]
  s_waitcnt lgkmcnt(0)
  buffer_store_dword v1, v1, s[8:11], s62 offen sc1
  s_waitcnt vmcnt(0)
  s_memtime s[74:75]
  s_waitcnt lgkmcnt(0)
  s_sub_u32 s46, s74, s72
  s_min_u32 s63, s63, s46
  s_memtime s[72:73]
  s_waitcnt lgkmcnt(0)
  buffer_store_dword v1, v1, s[8:11], s65 offen sc1
  s_waitcnt vmcnt(0)
  s_memtime s[74:75]
  s_waitcnt lgkmcnt(0)
  s_sub_u32 s46, s74, s72
  s_min_u32 s64, s64, s46
  s_memtime s[72:73]
  s_waitcnt lgkmcnt(0)
  buffer_store_dword v1, v1, s[8:11], s62 offen sc1
  s_waitcnt vmcnt(0)
  s_memtime s[74:75]
  s_waitcnt lgkmcnt(0)
  s_sub_u32 s46, s74, s72
  s_min_u32 s63, s63, s46
  s_memtime s[72:73]
  s_waitcnt lgkmcnt(0)
  buffer_store_dword v1, v1, s[8:11], s65 offen sc1
  s_waitcnt vmcnt(0)
  s_memtime s[74:75]
  s_waitcnt lgkmcnt(0)
  s_sub_u32 s46, s74, s72
  s_min_u32 s64, s64, s46
  s_cmp_lt_u32 s64, s63
  s_cselect_b32 s46, 0x100, 1
  s_min_u32 s47, s63, s64
  s_cmp_lt_u32 s47, 600
  s_cselect_b32 s47, 4, 0
  s_lshl_b32 s46, s46, s47
  s_add_u32 s66, s66, s46
pr_report:
  v_mov_b32 v3, s66
  s_mov_b64 exec, 1
  global_atomic_add v2, v1, v3, s[38:39] offset:128 sc0 sc1
  s_waitcnt vmcnt(0)
  v_readfirstlane_b32 s46, v2
  s_nop 0
  s_add_u32 s46, s46, s66
  s_cmp_lt_u32 s46, 0x100000
  s_cbranch_scc1 pr_done
  s_bfe_u32 s47, s46, 0x80008
  s_and_b32 s46, s46, 0xff
  s_cmp_gt_u32 s47, s46
  s_cselect_b32 s46, 0x2001, 1
  v_mov_b32 v2, s46
  global_store_dword v1, v2, s[38:39] offset:4 sc1
pr_done:
  s_mov_b64 exec, -1
pr_skip:
  s_cmp_lt_u32 s43, 4
  s_cbranch_scc1 L_recur
  s_cmp_ge_u32 s44, 24
  s_cbranch_scc1 L_uw
  s_lshr_b32 s48, s44, 3
  s_cmp_eq_u32 s48, 0
  s_cselect_b32 s4, s26, s28
  s_cselect_b32 s5, s27, s29
  s_cmp_eq_u32 s48, 2
  s_cselect_b32 s4, s30, s4
  s_cselect_b32 s5, s31, s5
  s_mov_b32 s6, 7864320
  s_mul_i32 s60, s45, 384
  s_mov_b32 s61, 0
  s_mov_b32 s62, 64
  s_cselect_b32 s63, 50331648, 0
  s_add_u32 s63, s63, 16777216
  s_cmp_lg_u32 s48, 1
  s_cselect_b32 s46, 0x2000, 0
  s_add_u32 s63, s63, s46
  s_mov_b32 s67, s45
  s_lshl_b32 s64, s48, 5
  s_add_u32 s64, s64, s45
  s_lshl_b32 s64, s64, 7
  s_and_b32 s46, s64, 0x2000
  s_add_u32 s64, s64, s46
  s_add_u32 s64, s64, 13639680
  v_lshrrev_b32 v10, 3, v0
  v_lshrrev_b32 v11, 2, v10
  v_lshlrev_b32 v11, 3, v11
  v_and_b32 v1, 3, v10
  v_add_u32 v1, v1, v11
  s_and_b32 s46, s42, 1
  s_lshl_b32 s46, s46, 2
  s_lshr_b32 s47, s42, 1
  s_lshl_b32 s47, s47, 4
  s_add_u32 s46, s46, s47
  v_add_u32 v1, s46, v1
  v_mul_u32_u24 v1, 12288, v1
  v_lshrrev_b32 v10, 1, v10
  v_bfe_u32 v11, v0, 1, 2
  v_xor_b32 v10, v10, v11
  v_lshlrev_b32 v10, 5, v10
  v_and_b32 v11, 1, v0
  v_lshlrev_b32 v11, 4, v11
  v_add3_u32 v1, v1, v10, v11
  v_lshrrev_b32 v10, 5, v0
  v_lshlrev_b32 v2, 11, v10
  v_bfe_u32 v10, v0, 2, 3
  v_lshl_add_u32 v2, v10, 7, v2
  v_lshrrev_b32 v10, 1, v10
  v_xor_b32 v10, s42, v10
  v_lshl_add_u32 v2, v10, 5, v2
  v_and_b32 v10, 3, v0
  v_lshl_add_u32 v2, v10, 3, v2
  v_add_u32 v3, 0x10000, v2
  v_add_u32 v4, 0x20000, v2
  v_lshrrev_b32 v10, 3, v0
  s_lshl_b32 s46, s42, 3
  v_add_u32 v10, s46, v10
  v_mul_u32_u24 v5, 1280, v10
  v_bfe_u32 v10, v10, 1, 3
  v_and_b32 v11, 7, v0
  v_xor_b32 v10, v10, v11
  v_lshl_add_u32 v5, v10, 4, v5
  v_and_b32 v10, 15, v0
  v_lshlrev_b32 v6, 7, v10
  v_lshrrev_b32 v10, 1, v10
  v_lshrrev_b32 v11, 4, v0
  v_xor_b32 v10, v10, v11
  v_lshl_add_u32 v6, v10, 4, v6
  v_add_u32 v6, 122880, v6
  v_xor_b32 v7, 64, v6
  v_and_b32 v10, 15, v0
  v_lshlrev_b32 v8, 4, v10
  v_bfe_u32 v10, v0, 4, 1
  v_lshlrev_b32 v10, 11, v10
  v_lshrrev_b32 v11, 5, v0
  v_lshlrev_b32 v11, 8, v11
  v_add3_u32 v8, v8, v10, v11
  s_lshl_b32 s46, s42, 9
  v_add_u32 v8, s46, v8
  v_mov_b32 v9, s64
  v_mov_b32 v10, 2146435072
  s_cmp_eq_u32 s42, 0
  s_cselect_b64 vcc, 1, 0
  v_cndmask_b32 v9, v10, v9, vcc
  s_lshl_b32 s46, s43, 7
  s_add_u32 s46, s46, 13662720
  v_mov_b32 v14, s46
  s_mov_b32 s68, 0
  s_lshr_b32 s70, s44, 5
  s_add_u32 s70, s70, 4
  s_mov_b32 s52, s61
  s_mul_i32 s53, s52, 40960
  s_add_u32 s54, s51, 122880
  s_add_u32 m0, s54, 0
  s_nop 0
  buffer_load_dwordx4 v5, s[12:15], s53 offen offset:0 lds
  s_add_u32 m0, s54, 3968
  s_nop 0
  buffer_load_dwordx4 v5, s[12:15], s53 offen offset:128 lds
  s_add_u32 m0, s54, 7936
  s_nop 0
  buffer_load_dwordx4 v5, s[12:15], s53 offen offset:256 lds
  s_add_u32 m0, s54, 11904
  s_nop 0
  buffer_load_dwordx4 v5, s[12:15], s53 offen offset:384 lds
  s_add_u32 m0, s54, 15872
  s_nop 0
  buffer_load_dwordx4 v5, s[12:15], s53 offen offset:512 lds
  s_add_u32 m0, s54, 19840
  s_nop 0
  buffer_load_dwordx4 v5, s[12:15], s53 offen offset:640 lds
  s_add_u32 m0, s54, 23808
  s_nop 0
  buffer_load_dwordx4 v5, s[12:15], s53 offen offset:768 lds
  s_add_u32 m0, s54, 27776
  s_nop 0
  buffer_load_dwordx4 v5, s[12:15], s53 offen offset:896 lds
  s_add_u32 m0, s54, 31744
  s_nop 0
  buffer_load_dwordx4 v5, s[12:15], s53 offen offset:1024 lds
  s_add_u32 m0, s54, 35712
  s_nop 0
  buffer_load_dwordx4 v5, s[12:15], s53 offen offset:1152 lds
  s_add_u32 m0, s51, 0
  s_add_u32 s46, s60, 0
  buffer_load_dwordx4 v1, s[4:7], s46 offen  lds
  s_add_u32 m0, s51, 4096
  s_add_u32 s46, s60, 128
  buffer_load_dwordx4 v1, s[4:7], s46 offen  lds
  s_add_u32 m0, s51, 8192
  s_add_u32 s46, s60, 256
  buffer_load_dwordx4 v1, s[4:7], s46 offen  lds
  s_add_u32 m0, s51, 12288
  s_add_u32 s46, s60, 393216
  buffer_load_dwordx4 v1, s[4:7], s46 offen  lds
  s_add_u32 m0, s51, 16384
  s_add_u32 s46, s60, 393344
  buffer_load_dwordx4 v1, s[4:7], s46 offen  lds
  s_add_u32 m0, s51, 20480
  s_add_u32 s46, s60, 393472
  buffer_load_dwordx4 v1, s[4:7], s46 offen  lds
  s_add_u32 m0, s51, 24576
  s_add_u32 s46, s60, 786432
  buffer_load_dwordx4 v1, s[4:7], s46 offen  lds
  s_add_u32 m0, s51, 28672
  s_add_u32 s46, s60, 786560
  buffer_load_dwordx4 v1, s[4:7], s46 offen  lds
  s_add_u32 m0, s51, 32768
  s_add_u32 s46, s60, 786688
  buffer_load_dwordx4 v1, s[4:7], s46 offen  lds
  s_add_u32 m0, s51, 36864
  s_add_u32 s46, s60, 1179648
  buffer_load_dwordx4 v1, s[4:7], s46 offen  lds
  s_add_u32 m0, s51, 40960
  s_add_u32 s46, s60, 1179776
  buffer_load_dwordx4 v1, s[4:7], s46 offen  lds
  s_add_u32 m0, s51, 45056
  s_add_u32 s46, s60, 1179904
  buffer_load_dwordx4 v1, s[4:7], s46 offen  lds
  s_add_u32 m0, s51, 49152
  s_add_u32 s46, s60, 1572864
  buffer_load_dwordx4 v1, s[4:7], s46 offen  lds
  s_add_u32 m0, s51, 53248
  s_add_u32 s46, s60, 1572992
  buffer_load_dwordx4 v1, s[4:7], s46 offen  lds
  s_add_u32 m0, s51, 57344
  s_add_u32 s46, s60, 1573120
  buffer_load_dwordx4 v1, s[4:7], s46 offen  lds
  s_add_u32 m0, s51, 61440
  s_add_u32 s46, s60, 1966080
  buffer_load_dwordx4 v1, s[4:7], s46 offen  lds
  s_add_u32 m0, s51, 65536
  s_add_u32 s46, s60, 1966208
  buffer_load_dwordx4 v1, s[4:7], s46 offen  lds
  s_add_u32 m0, s51, 69632
  s_add_u32 s46, s60, 1966336
  buffer_load_dwordx4 v1, s[4:7], s46 offen  lds
  s_add_u32 m0, s51, 73728
  s_add_u32 s46, s60, 2359296
  buffer_load_dwordx4 v1, s[4:7], s46 offen  lds
  s_add_u32 m0, s51, 77824
  s_add_u32 s46, s60, 2359424
  buffer_load_dwordx4 v1, s[4:7], s46 offen  lds
  s_add_u32 m0, s51, 81920
  s_add_u32 s46, s60, 2359552
  buffer_load_dwordx4 v1, s[4:7], s46 offen  lds
  s_add_u32 m0, s51, 86016
  s_add_u32 s46, s60, 2752512
  buffer_load_dwordx4 v1, s[4:7], s46 offen  lds
  s_add_u32 m0, s51, 90112
  s_add_u32 s46, s60, 2752640
  buffer_load_dwordx4 v1, s[4:7], s46 offen  lds
  s_add_u32 m0, s51, 94208
  s_add_u32 s46, s60, 2752768
  buffer_load_dwordx4 v1, s[4:7], s46 offen  lds
  s_waitcnt vmcnt(18)
  s_barrier
  s_add_u32 m0, s51, 98304
  s_add_u32 s46, s60, 3145728
  buffer_load_dwordx4 v1, s[4:7], s46 offen  lds
  s_add_u32 m0, s51, 102400
  s_add_u32 s46, s60, 3145856
  buffer_load_dwordx4 v1, s[4:7], s46 offen  lds
  s_add_u32 m0, s51, 106496
  s_add_u32 s46, s60, 3145984
  buffer_load_dwordx4 v1, s[4:7], s46 offen  lds
  s_add_u32 m0, s51, 110592
  s_add_u32 s46, s60, 3538944
  buffer_load_dwordx4 v1, s[4:7], s46 offen  lds
  s_add_u32 m0, s51, 114688
  s_add_u32 s46, s60, 3539072
  buffer_load_dwordx4 v1, s[4:7], s46 offen  lds
  s_add_u32 m0, s51, 118784
  s_add_u32 s46, s60, 3539200
  buffer_load_dwordx4 v1, s[4:7], s46 offen  lds
  ds_read_b64_tr_b16 a[0:1], v2 offset:0
  ds_read_b64_tr_b16 a[2:3], v2 offset:1024
  ds_read_b64_tr_b16 a[4:5], v2 offset:4096
  ds_read_b64_tr_b16 a[6:7], v2 offset:5120
  ds_read_b64_tr_b16 a[8:9], v2 offset:8192
  ds_read_b64_tr_b16 a[10:11], v2 offset:9216
  ds_read_b64_tr_b16 a[12:13], v2 offset:12288
  ds_read_b64_tr_b16 a[14:15], v2 offset:13312
  ds_read_b64_tr_b16 a[16:17], v2 offset:16384
  ds_read_b64_tr_b16 a[18:19], v2 offset:17408
  ds_read_b64_tr_b16 a[20:21], v2 offset:20480
  ds_read_b64_tr_b16 a[22:23], v2 offset:21504
  s_waitcnt lgkmcnt(0)
  s_waitcnt vmcnt(18)
  s_barrier
  s_add_u32 m0, s51, 0
  s_add_u32 s46, s60, 3932160
  buffer_load_dwordx4 v1, s[4:7], s46 offen  lds
  s_add_u32 m0, s51, 4096
  s_add_u32 s46, s60, 3932288
  buffer_load_dwordx4 v1, s[4:7], s46 offen  lds
  s_add_u32 m0, s51, 8192
  s_add_u32 s46, s60, 3932416
  buffer_load_dwordx4 v1, s[4:7], s46 offen  lds
  s_add_u32 m0, s51, 12288
  s_add_u32 s46, s60, 4325376
  buffer_load_dwordx4 v1, s[4:7], s46 offen  lds
  s_add_u32 m0, s51, 16384
  s_add_u32 s46, s60, 4325504
  buffer_load_dwordx4 v1, s[4:7], s46 offen  lds
  s_add_u32 m0, s51, 20480
  s_add_u32 s46, s60, 4325632
  buffer_load_dwordx4 v1, s[4:7], s46 offen  lds
  ds_read_b64_tr_b16 a[24:25], v2 offset:24576
  ds_read_b64_tr_b16 a[26:27], v2 offset:25600
  ds_read_b64_tr_b16 a[28:29], v2 offset:28672
  ds_read_b64_tr_b16 a[30:31], v2 offset:29696
  ds_read_b64_tr_b16 a[32:33], v2 offset:32768
  ds_read_b64_tr_b16 a[34:35], v2 offset:33792
  ds_read_b64_tr_b16 a[36:37], v2 offset:36864
  ds_read_b64_tr_b16 a[38:39], v2 offset:37888
  ds_read_b64_tr_b16 a[40:41], v2 offset:40960
  ds_read_b64_tr_b16 a[42:43], v2 offset:41984
  ds_read_b64_tr_b16 a[44:45], v2 offset:45056
  ds_read_b64_tr_b16 a[46:47], v2 offset:46080
  s_waitcnt lgkmcnt(0)
  s_waitcnt vmcnt(18)
  s_barrier
  s_add_u32 m0, s51, 24576
  s_add_u32 s46, s60, 4718592
  buffer_load_dwordx4 v1, s[4:7], s46 offen  lds
  s_add_u32 m0, s51, 28672
  s_add_u32 s46, s60, 4718720
  buffer_load_dwordx4 v1, s[4:7], s46 offen  lds
  s_add_u32 m0, s51, 32768
  s_add_u32 s46, s60, 4718848
  buffer_load_dwordx4 v1, s[4:7], s46 offen  lds
  s_add_u32 m0, s51, 36864
  s_add_u32 s46, s60, 5111808
  buffer_load_dwordx4 v1, s[4:7], s46 offen  lds
  s_add_u32 m0, s51, 40960
  s_add_u32 s46, s60, 5111936
  buffer_load_dwordx4 v1, s[4:7], s46 offen  lds
  s_add_u32 m0, s51, 45056
  s_add_u32 s46, s60, 5112064
  buffer_load_dwordx4 v1, s[4:7], s46 offen  lds
  ds_read_b64_tr_b16 a[48:49], v2 offset:49152
  ds_read_b64_tr_b16 a[50:51], v2 offset:50176
  ds_read_b64_tr_b16 a[52:53], v2 offset:53248
  ds_read_b64_tr_b16 a[54:55], v2 offset:54272
  ds_read_b64_tr_b16 a[56:57], v2 offset:57344
  ds_read_b64_tr_b16 a[58:59], v2 offset:58368
  ds_read_b64_tr_b16 a[60:61], v2 offset:61440
  ds_read_b64_tr_b16 a[62:63], v2 offset:62464
  ds_read_b64_tr_b16 a[64:65], v3 offset:0
  ds_read_b64_tr_b16 a[66:67], v3 offset:1024
  ds_read_b64_tr_b16 a[68:69], v3 offset:4096
  ds_read_b64_tr_b16 a[70:71], v3 offset:5120
  s_waitcnt lgkmcnt(0)
  s_waitcnt vmcnt(18)
  s_barrier
  s_add_u32 m0, s51, 49152
  s_add_u32 s46, s60, 5505024
  buffer_load_dwordx4 v1, s[4:7], s46 offen  lds
  s_add_u32 m0, s51, 53248
  s_add_u32 s46, s60, 5505152
  buffer_load_dwordx4 v1, s[4:7], s46 offen  lds
  s_add_u32 m0, s51, 57344
  s_add_u32 s46, s60, 5505280
  buffer_load_dwordx4 v1, s[4:7], s46 offen  lds
  s_add_u32 m0, s51, 61440
  s_add_u32 s46, s60, 5898240
  buffer_load_dwordx4 v1, s[4:7], s46 offen  lds
  s_add_u32 m0, s51, 65536
  s_add_u32 s46, s60, 5898368
  buffer_load_dwordx4 v1, s[4:7], s46 offen  lds
  s_add_u32 m0, s51, 69632
  s_add_u32 s46, s60, 5898496
  buffer_load_dwordx4 v1, s[4:7], s46 offen  lds
  ds_read_b64_tr_b16 a[72:73], v3 offset:8192
  ds_read_b64_tr_b16 a[74:75], v3 offset:9216
  ds_read_b64_tr_b16 a[76:77], v3 offset:12288
  ds_read_b64_tr_b16 a[78:79], v3 offset:13312
  ds_read_b64_tr_b16 a[80:81], v3 offset:16384
  ds_read_b64_tr_b16 a[82:83], v3 offset:17408
  ds_read_b64_tr_b16 a[84:85], v3 offset:20480
  ds_read_b64_tr_b16 a[86:87], v3 offset:21504
  ds_read_b64_tr_b16 a[88:89], v3 offset:24576
  ds_read_b64_tr_b16 a[90:91], v3 offset:25600
  ds_read_b64_tr_b16 a[92:93], v3 offset:28672
  ds_read_b64_tr_b16 a[94:95], v3 offset:29696
  s_waitcnt lgkmcnt(0)
  s_waitcnt vmcnt(18)
  s_barrier
  s_add_u32 m0, s51, 73728
  s_add_u32 s46, s60, 6291456
  buffer_load_dwordx4 v1, s[4:7], s46 offen  lds
  s_add_u32 m0, s51, 77824
  s_add_u32 s46, s60, 6291584
  buffer_load_dwordx4 v1, s[4:7], s46 offen  lds
  s_add_u32 m0, s51, 81920
  s_add_u32 s46, s60, 6291712
  buffer_load_dwordx4 v1, s[4:7], s46 offen  lds
  s_add_u32 m0, s51, 86016
  s_add_u32 s46, s60, 6684672
  buffer_load_dwordx4 v1, s[4:7], s46 offen  lds
  s_add_u32 m0, s51, 90112
  s_add_u32 s46, s60, 6684800
  buffer_load_dwordx4 v1, s[4:7], s46 offen  lds
  s_add_u32 m0, s51, 94208
  s_add_u32 s46, s60, 6684928
  buffer_load_dwordx4 v1, s[4:7], s46 offen  lds
  ds_read_b64_tr_b16 a[96:97], v3 offset:32768
  ds_read_b64_tr_b16 a[98:99], v3 offset:33792
  ds_read_b64_tr_b16 a[100:101], v3 offset:36864
  ds_read_b64_tr_b16 a[102:103], v3 offset:37888
  ds_read_b64_tr_b16 a[104:105], v3 offset:40960
  ds_read_b64_tr_b16 a[106:107], v3 offset:41984
  ds_read_b64_tr_b16 a[108:109], v3 offset:45056
  ds_read_b64_tr_b16 a[110:111], v3 offset:46080
  ds_read_b64_tr_b16 a[112:113], v3 offset:49152
  ds_read_b64_tr_b16 a[114:115], v3 offset:50176
  ds_read_b64_tr_b16 a[116:117], v3 offset:53248
  ds_read_b64_tr_b16 a[118:119], v3 offset:54272
  s_waitcnt lgkmcnt(0)
  s_waitcnt vmcnt(18)
  s_barrier
  v_and_b32 v11, 3, v0
  v_lshlrev_b32 v11, 2, v11
  global_load_dword v10, v11, s[38:39] sc1
  s_add_u32 m0, s51, 98304
  s_add_u32 s46, s60, 7077888
  buffer_load_dwordx4 v1, s[4:7], s46 offen  lds
  s_add_u32 m0, s51, 102400
  s_add_u32 s46, s60, 7078016
  buffer_load_dwordx4 v1, s[4:7], s46 offen  lds
  s_add_u32 m0, s51, 106496
  s_add_u32 s46, s60, 7078144
  buffer_load_dwordx4 v1, s[4:7], s46 offen  lds
  s_add_u32 m0, s51, 110592
  s_add_u32 s46, s60, 7471104
  buffer_load_dwordx4 v1, s[4:7], s46 offen  lds
  s_add_u32 m0, s51, 114688
  s_add_u32 s46, s60, 7471232
  buffer_load_dwordx4 v1, s[4:7], s46 offen  lds
  s_add_u32 m0, s51, 118784
  s_add_u32 s46, s60, 7471360
  buffer_load_dwordx4 v1, s[4:7], s46 offen  lds
  ds_read_b64_tr_b16 a[120:121], v2 offset:0
  ds_read_b64_tr_b16 a[122:123], v2 offset:1024
  ds_read_b64_tr_b16 a[124:125], v2 offset:4096
  ds_read_b64_tr_b16 a[126:127], v2 offset:5120
  ds_read_b64_tr_b16 a[128:129], v2 offset:8192
  ds_read_b64_tr_b16 a[130:131], v2 offset:9216
  ds_read_b64_tr_b16 a[132:133], v2 offset:12288
  ds_read_b64_tr_b16 a[134:135], v2 offset:13312
  ds_read_b64_tr_b16 a[136:137], v2 offset:16384
  ds_read_b64_tr_b16 a[138:139], v2 offset:17408
  ds_read_b64_tr_b16 a[140:141], v2 offset:20480
  ds_read_b64_tr_b16 a[142:143], v2 offset:21504
  s_waitcnt lgkmcnt(0)
  s_waitcnt vmcnt(19)
  s_barrier
  ds_read_b64_tr_b16 a[144:145], v2 offset:24576
  ds_read_b64_tr_b16 a[146:147], v2 offset:25600
  ds_read_b64_tr_b16 a[148:149], v2 offset:28672
  ds_read_b64_tr_b16 a[150:151], v2 offset:29696
  ds_read_b64_tr_b16 a[152:153], v2 offset:32768
  ds_read_b64_tr_b16 a[154:155], v2 offset:33792
  ds_read_b64_tr_b16 a[156:157], v2 offset:36864
  ds_read_b64_tr_b16 a[158:159], v2 offset:37888
  ds_read_b64_tr_b16 a[160:161], v2 offset:40960
  ds_read_b64_tr_b16 a[162:163], v2 offset:41984
  ds_read_b64_tr_b16 a[164:165], v2 offset:45056
  ds_read_b64_tr_b16 a[166:167], v2 offset:46080
  s_waitcnt lgkmcnt(0)
  s_waitcnt vmcnt(13)
  s_barrier
  ds_read_b64_tr_b16 a[168:169], v2 offset:49152
  ds_read_b64_tr_b16 a[170:171], v2 offset:50176
  ds_read_b64_tr_b16 a[172:173], v2 offset:53248
  ds_read_b64_tr_b16 a[174:175], v2 offset:54272
  ds_read_b64_tr_b16 a[176:177], v2 offset:57344
  ds_read_b64_tr_b16 a[178:179], v2 offset:58368
  ds_read_b64_tr_b16 a[180:181], v2 offset:61440
  ds_read_b64_tr_b16 a[182:183], v2 offset:62464
  ds_read_b64_tr_b16 a[184:185], v3 offset:0
  ds_read_b64_tr_b16 a[186:187], v3 offset:1024
  ds_read_b64_tr_b16 a[188:189], v3 offset:4096
  ds_read_b64_tr_b16 a[190:191], v3 offset:5120
  s_waitcnt lgkmcnt(0)
  s_waitcnt vmcnt(7)
  s_barrier
  ds_read_b64_tr_b16 a[192:193], v3 offset:8192
  ds_read_b64_tr_b16 a[194:195], v3 offset:9216
  ds_read_b64_tr_b16 a[196:197], v3 offset:12288
  ds_read_b64_tr_b16 a[198:199], v3 offset:13312
  ds_read_b64_tr_b16 a[200:201], v3 offset:16384
  ds_read_b64_tr_b16 a[202:203], v3 offset:17408
  ds_read_b64_tr_b16 a[204:205], v3 offset:20480
  ds_read_b64_tr_b16 a[206:207], v3 offset:21504
  ds_read_b64_tr_b16 a[208:209], v3 offset:24576
  ds_read_b64_tr_b16 a[210:211], v3 offset:25600
  ds_read_b64_tr_b16 a[212:213], v3 offset:28672
  ds_read_b64_tr_b16 a[214:215], v3 offset:29696
  s_waitcnt lgkmcnt(0)
  s_waitcnt vmcnt(0)
  s_barrier
  ds_read_b64_tr_b16 a[216:217], v3 offset:32768
  ds_read_b64_tr_b16 a[218:219], v3 offset:33792
  ds_read_b64_tr_b16 a[220:221], v3 offset:36864
  ds_read_b64_tr_b16 a[222:223], v3 offset:37888
  ds_read_b64_tr_b16 a[224:225], v3 offset:40960
  ds_read_b64_tr_b16 a[226:227], v3 offset:41984
  ds_read_b64_tr_b16 a[228:229], v3 offset:45056
  ds_read_b64_tr_b16 a[230:231], v3 offset:46080
  ds_read_b64_tr_b16 a[232:233], v3 offset:49152
  ds_read_b64_tr_b16 a[234:235], v3 offset:50176
  ds_read_b64_tr_b16 a[236:237], v3 offset:53248
  ds_read_b64_tr_b16 a[238:239], v3 offset:54272
  s_waitcnt lgkmcnt(0)
  s_mov_b32 s50, 0
  s_branch ss_1_in
ss_1:
  v_and_b32 v11, 3, v0
  v_lshlrev_b32 v11, 2, v11
  global_load_dword v10, v11, s[38:39] sc1
  s_add_u32 s50, s50, 1
  s_cmp_gt_u32 s50, 131072
  s_cbranch_scc1 L_fail
  s_waitcnt vmcnt(0)
ss_1_in:
  v_readlane_b32 s46, v10, 0
  v_readlane_b32 s47, v10, 2
  v_readlane_b32 s48, v10, 1
  s_nop 0
  s_min_u32 s47, s47, s48
  s_cmp_lg_u32 s46, 0
  s_cselect_b32 s48, 7, 0
  s_add_u32 s46, s46, s2
  s_xor_b32 s49, s46, s43
  s_and_b32 s49, s49, s48
  s_cbranch_scc1 L_reroll
  s_cmp_lg_u32 s47, 0
  s_cbranch_scc1 ss_ok_2
  s_sleep 6
  s_branch ss_1
ss_ok_2:
  v_readlane_b32 s3, v10, 1
  s_nop 0
  s_and_b32 s3, s3, 0x2000
  s_barrier
  s_mov_b32 s54, s51
  s_add_u32 s53, s53, 40960
  s_add_u32 m0, s54, 0
  s_nop 0
  buffer_load_dwordx4 v5, s[12:15], s53 offen offset:0 lds
  s_add_u32 m0, s54, 3968
  s_nop 0
  buffer_load_dwordx4 v5, s[12:15], s53 offen offset:128 lds
  s_add_u32 m0, s54, 7936
  s_nop 0
  buffer_load_dwordx4 v5, s[12:15], s53 offen offset:256 lds
  s_add_u32 m0, s54, 11904
  s_nop 0
  buffer_load_dwordx4 v5, s[12:15], s53 offen offset:384 lds
  s_add_u32 m0, s54, 15872
  s_nop 0
  buffer_load_dwordx4 v5, s[12:15], s53 offen offset:512 lds
  s_add_u32 m0, s54, 19840
  s_nop 0
  buffer_load_dwordx4 v5, s[12:15], s53 offen offset:640 lds
  s_add_u32 m0, s54, 23808
  s_nop 0
  buffer_load_dwordx4 v5, s[12:15], s53 offen offset:768 lds
  s_add_u32 m0, s54, 27776
  s_nop 0
  buffer_load_dwordx4 v5, s[12:15], s53 offen offset:896 lds
  s_add_u32 m0, s54, 31744
  s_nop 0
  buffer_load_dwordx4 v5, s[12:15], s53 offen offset:1024 lds
  s_add_u32 m0, s54, 35712
  s_nop 0
  buffer_load_dwordx4 v5, s[12:15], s53 offen offset:1152 lds
  s_mov_b32 s55, 2146435072
  s_mov_b32 s56, 2146435072
  s_mov_b32 s57, 2146435072
  s_xor_b32 s63, s63, s3
  v_xor_b32 v9, s3, v9
  v_xor_b32 v14, s3, v14
  s_mov_b32 s58, 122880
  ds_read_b128 v[16:19], v6 offset:0
  ds_read_b128 v[20:23], v7 offset:0
  ds_read_b128 v[24:27], v6 offset:4096
  ds_read_b128 v[28:31], v7 offset:4096
  s_waitcnt lgkmcnt(3)
pj_loop_3:
  v_mfma_f32_16x16x32_bf16 v[40:43], a[0:3], v[16:19], 0
  ds_read_b128 v[32:35], v6 offset:8192
  v_mfma_f32_16x16x32_bf16 v[48:51], a[4:7], v[16:19], 0
  v_mfma_f32_16x16x32_bf16 v[56:59], a[8:11], v[16:19], 0
  s_waitcnt lgkmcnt(3)
  v_cvt_pk_bf16_f32 v66, v44, v45
  v_mfma_f32_16x16x32_bf16 v[40:43], a[12:15], v[20:23], v[40:43]
  ds_read_b128 v[16:19], v7 offset:8192
  v_cvt_pk_bf16_f32 v67, v46, v47
  v_mfma_f32_16x16x32_bf16 v[48:51], a[16:19], v[20:23], v[48:51]
  v_cvt_pk_bf16_f32 v70, v52, v53
  v_mfma_f32_16x16x32_bf16 v[56:59], a[20:23], v[20:23], v[56:59]
  s_waitcnt lgkmcnt(3)
  v_cvt_pk_bf16_f32 v71, v54, v55
  v_mfma_f32_16x16x32_bf16 v[40:43], a[24:27], v[24:27], v[40:43]
  ds_read_b128 v[20:23], v6 offset:12288
  v_cvt_pk_bf16_f32 v74, v60, v61
  v_mfma_f32_16x16x32_bf16 v[48:51], a[28:31], v[24:27], v[48:51]
  v_cvt_pk_bf16_f32 v75, v62, v63
  v_mfma_f32_16x16x32_bf16 v[56:59], a[32:35], v[24:27], v[56:59]
  s_waitcnt lgkmcnt(3)
  v_mfma_f32_16x16x32_bf16 v[40:43], a[36:39], v[28:31], v[40:43]
  ds_read_b128 v[24:27], v7 offset:12288
  v_permlane16_swap_b32 v64, v66
  v_mfma_f32_16x16x32_bf16 v[48:51], a[40:43], v[28:31], v[48:51]
  v_permlane16_swap_b32 v65, v67
  v_mfma_f32_16x16x32_bf16 v[56:59], a[44:47], v[28:31], v[56:59]
  buffer_store_dwordx4 v[64:67], v8, s[8:11], s55 offen sc1
  s_waitcnt lgkmcnt(3)
  v_mfma_f32_16x16x32_bf16 v[40:43], a[48:51], v[32:35], v[40:43]
  ds_read_b128 v[28:31], v6 offset:16384
  v_permlane16_swap_b32 v68, v70
  v_mfma_f32_16x16x32_bf16 v[48:51], a[52:55], v[32:35], v[48:51]
  v_permlane16_swap_b32 v69, v71
  v_mfma_f32_16x16x32_bf16 v[56:59], a[56:59], v[32:35], v[56:59]
  buffer_store_dwordx4 v[68:71], v8, s[8:11], s56 offen sc1
  s_waitcnt lgkmcnt(3)
  v_mfma_f32_16x16x32_bf16 v[40:43], a[60:63], v[16:19], v[40:43]
  ds_read_b128 v[32:35], v7 offset:16384
  v_permlane16_swap_b32 v72, v74
  v_mfma_f32_16x16x32_bf16 v[48:51], a[64:67], v[16:19], v[48:51]
  v_permlane16_swap_b32 v73, v75
  v_mfma_f32_16x16x32_bf16 v[56:59], a[68:71], v[16:19], v[56:59]
  buffer_store_dwordx4 v[72:75], v8, s[8:11], s57 offen sc1
  s_waitcnt lgkmcnt(3)
  v_mfma_f32_16x16x32_bf16 v[40:43], a[72:75], v[20:23], v[40:43]
  ds_read_b128 v[16:19], v6 offset:20480
  v_mfma_f32_16x16x32_bf16 v[48:51], a[76:79], v[20:23], v[48:51]
  v_mfma_f32_16x16x32_bf16 v[56:59], a[80:83], v[20:23], v[56:59]
  s_waitcnt lgkmcnt(3)
  v_mfma_f32_16x16x32_bf16 v[40:43], a[84:87], v[24:27], v[40:43]
  ds_read_b128 v[20:23], v7 offset:20480
  v_mfma_f32_16x16x32_bf16 v[48:51], a[88:91], v[24:27], v[48:51]
  v_mov_b32 v10, s52
  v_mfma_f32_16x16x32_bf16 v[56:59], a[92:95], v[24:27], v[56:59]
  s_waitcnt lgkmcnt(3)
  v_mfma_f32_16x16x32_bf16 v[40:43], a[96:99], v[28:31], v[40:43]
  ds_read_b128 v[24:27], v6 offset:24576
  v_mfma_f32_16x16x32_bf16 v[48:51], a[100:103], v[28:31], v[48:51]
  s_add_u32 s53, s53, 40960
  s_add_u32 s54, s54, 40960
  v_mfma_f32_16x16x32_bf16 v[56:59], a[104:107], v[28:31], v[56:59]
  s_waitcnt lgkmcnt(3)
  v_mfma_f32_16x16x32_bf16 v[40:43], a[108:111], v[32:35], v[40:43]
  ds_read_b128 v[28:31], v7 offset:24576
  v_mfma_f32_16x16x32_bf16 v[48:51], a[112:115], v[32:35], v[48:51]
  s_cmp_ge_u32 s54, 163840
  s_cselect_b32 s54, s51, s54
  v_mfma_f32_16x16x32_bf16 v[56:59], a[116:119], v[32:35], v[56:59]
  s_waitcnt lgkmcnt(3)
  v_mfma_f32_16x16x32_bf16 v[40:43], a[120:123], v[16:19], v[40:43]
  ds_read_b128 v[32:35], v6 offset:28672
  v_mfma_f32_16x16x32_bf16 v[48:51], a[124:127], v[16:19], v[48:51]
  s_cmp_eq_u32 s58, 122880
  s_cselect_b32 s59, 163840, 0
  v_mfma_f32_16x16x32_bf16 v[56:59], a[128:131], v[16:19], v[56:59]
  s_waitcnt lgkmcnt(3)
  v_mfma_f32_16x16x32_bf16 v[40:43], a[132:135], v[20:23], v[40:43]
  ds_read_b128 v[16:19], v7 offset:28672
  v_mfma_f32_16x16x32_bf16 v[48:51], a[136:139], v[20:23], v[48:51]
  s_sub_u32 s59, 40960, s59
  s_add_u32 s58, s58, s59
  v_mfma_f32_16x16x32_bf16 v[56:59], a[140:143], v[20:23], v[56:59]
  s_cmp_eq_u32 s52, 1
  s_cbranch_scc1 pj_eager
pj_eback:
  s_waitcnt lgkmcnt(3)
  v_mfma_f32_16x16x32_bf16 v[40:43], a[144:147], v[24:27], v[40:43]
  ds_read_b128 v[20:23], v6 offset:32768
  v_mfma_f32_16x16x32_bf16 v[48:51], a[148:151], v[24:27], v[48:51]
  s_lshr_b32 s55, s67, 1
  v_mfma_f32_16x16x32_bf16 v[56:59], a[152:155], v[24:27], v[56:59]
  s_lshl_b32 s55, s55, 14
  s_waitcnt lgkmcnt(3)
  v_mfma_f32_16x16x32_bf16 v[40:43], a[156:159], v[28:31], v[40:43]
  ds_read_b128 v[24:27], v7 offset:32768
  v_mfma_f32_16x16x32_bf16 v[48:51], a[160:163], v[28:31], v[48:51]
  s_and_b32 s56, s67, 1
  v_mfma_f32_16x16x32_bf16 v[56:59], a[164:167], v[28:31], v[56:59]
  s_lshl_b32 s56, s56, 12
  s_waitcnt lgkmcnt(3)
  v_mfma_f32_16x16x32_bf16 v[40:43], a[168:171], v[32:35], v[40:43]
  ds_read_b128 v[28:31], v6 offset:36864
  v_mfma_f32_16x16x32_bf16 v[48:51], a[172:175], v[32:35], v[48:51]
  s_add_u32 s55, s55, s56
  v_mfma_f32_16x16x32_bf16 v[56:59], a[176:179], v[32:35], v[56:59]
  s_add_u32 s55, s55, s63
  s_waitcnt lgkmcnt(3)
  v_mfma_f32_16x16x32_bf16 v[40:43], a[180:183], v[16:19], v[40:43]
  ds_read_b128 v[32:35], v7 offset:36864
  v_mfma_f32_16x16x32_bf16 v[48:51], a[184:187], v[16:19], v[48:51]
  s_lshr_b32 s56, s55, 8
  v_mfma_f32_16x16x32_bf16 v[56:59], a[188:191], v[16:19], v[56:59]
  s_and_b32 s56, s56, 0x2000
  s_waitcnt lgkmcnt(3)
  v_mfma_f32_16x16x32_bf16 v[40:43], a[192:195], v[20:23], v[40:43]
  ds_read_b128 v[16:19], v6 offset:2048
  v_mfma_f32_16x16x32_bf16 v[48:51], a[196:199], v[20:23], v[48:51]
  s_xor_b32 s55, s55, s56
  v_mfma_f32_16x16x32_bf16 v[56:59], a[200:203], v[20:23], v[56:59]
  s_add_u32 s67, s67, 32
  s_waitcnt lgkmcnt(3)
  v_mfma_f32_16x16x32_bf16 v[40:43], a[204:207], v[24:27], v[40:43]
  ds_read_b128 v[20:23], v7 offset:2048
  v_mfma_f32_16x16x32_bf16 v[48:51], a[208:211], v[24:27], v[48:51]
  s_cmp_ge_u32 s67, 1024
  s_cselect_b32 s56, 1024, 0
  v_mfma_f32_16x16x32_bf16 v[56:59], a[212:215], v[24:27], v[56:59]
  s_sub_u32 s67, s67, s56
  s_waitcnt lgkmcnt(3)
  v_mfma_f32_16x16x32_bf16 v[40:43], a[216:219], v[28:31], v[40:43]
  ds_read_b128 v[24:27], v6 offset:6144
  v_mfma_f32_16x16x32_bf16 v[48:51], a[220:223], v[28:31], v[48:51]
  s_add_u32 s56, s55, 16777216
  v_mfma_f32_16x16x32_bf16 v[56:59], a[224:227], v[28:31], v[56:59]
  s_add_u32 s57, s55, 33554432
  s_waitcnt lgkmcnt(3)
  v_mfma_f32_16x16x32_bf16 v[40:43], a[228:231], v[32:35], v[40:43]
  ds_read_b128 v[28:31], v7 offset:6144
  v_mfma_f32_16x16x32_bf16 v[48:51], a[232:235], v[32:35], v[48:51]
  v_mfma_f32_16x16x32_bf16 v[56:59], a[236:239], v[32:35], v[56:59]
  s_waitcnt lgkmcnt(3)
  v_mfma_f32_16x16x32_bf16 v[44:47], a[0:3], v[16:19], 0
  ds_read_b128 v[32:35], v6 offset:10240
  v_mfma_f32_16x16x32_bf16 v[52:55], a[4:7], v[16:19], 0
  v_mfma_f32_16x16x32_bf16 v[60:63], a[8:11], v[16:19], 0
  s_waitcnt lgkmcnt(3)
  v_cvt_pk_bf16_f32 v64, v40, v41
  v_mfma_f32_16x16x32_bf16 v[44:47], a[12:15], v[20:23], v[44:47]
  ds_read_b128 v[16:19], v7 offset:10240
  v_cvt_pk_bf16_f32 v65, v42, v43
  v_mfma_f32_16x16x32_bf16 v[52:55], a[16:19], v[20:23], v[52:55]
  v_cvt_pk_bf16_f32 v68, v48, v49
  v_mfma_f32_16x16x32_bf16 v[60:63], a[20:23], v[20:23], v[60:63]
  s_waitcnt lgkmcnt(3)
  v_cvt_pk_bf16_f32 v69, v50, v51
  v_mfma_f32_16x16x32_bf16 v[44:47], a[24:27], v[24:27], v[44:47]
  ds_read_b128 v[20:23], v6 offset:14336
  v_cvt_pk_bf16_f32 v72, v56, v57
  v_mfma_f32_16x16x32_bf16 v[52:55], a[28:31], v[24:27], v[52:55]
  v_cvt_pk_bf16_f32 v73, v58, v59
  v_mfma_f32_16x16x32_bf16 v[60:63], a[32:35], v[24:27], v[60:63]
  s_waitcnt lgkmcnt(3)
  v_mfma_f32_16x16x32_bf16 v[44:47], a[36:39], v[28:31], v[44:47]
  ds_read_b128 v[24:27], v7 offset:14336
  v_mfma_f32_16x16x32_bf16 v[52:55], a[40:43], v[28:31], v[52:55]
  s_waitcnt vmcnt(0)
  s_barrier
  v_mfma_f32_16x16x32_bf16 v[60:63], a[44:47], v[28:31], v[60:63]
  buffer_store_dword v10, v9, s[8:11], 0 offen sc1
  s_waitcnt lgkmcnt(3)
  v_mfma_f32_16x16x32_bf16 v[44:47], a[48:51], v[32:35], v[44:47]
  ds_read_b128 v[28:31], v6 offset:18432
  s_add_u32 m0, s54, 0
  v_mfma_f32_16x16x32_bf16 v[52:55], a[52:55], v[32:35], v[52:55]
  buffer_load_dwordx4 v5, s[12:15], s53 offen offset:0 lds
  v_mfma_f32_16x16x32_bf16 v[60:63], a[56:59], v[32:35], v[60:63]
  s_waitcnt lgkmcnt(3)
  v_mfma_f32_16x16x32_bf16 v[44:47], a[60:63], v[16:19], v[44:47]
  ds_read_b128 v[32:35], v7 offset:18432
  s_add_u32 m0, s54, 3968
  v_mfma_f32_16x16x32_bf16 v[52:55], a[64:67], v[16:19], v[52:55]
  buffer_load_dwordx4 v5, s[12:15], s53 offen offset:128 lds
  v_mfma_f32_16x16x32_bf16 v[60:63], a[68:71], v[16:19], v[60:63]
  s_waitcnt lgkmcnt(3)
  v_mfma_f32_16x16x32_bf16 v[44:47], a[72:75], v[20:23], v[44:47]
  ds_read_b128 v[16:19], v6 offset:22528
  s_add_u32 m0, s54, 7936
  v_mfma_f32_16x16x32_bf16 v[52:55], a[76:79], v[20:23], v[52:55]
  buffer_load_dwordx4 v5, s[12:15], s53 offen offset:256 lds
  v_mfma_f32_16x16x32_bf16 v[60:63], a[80:83], v[20:23], v[60:63]
  s_waitcnt lgkmcnt(3)
  v_mfma_f32_16x16x32_bf16 v[44:47], a[84:87], v[24:27], v[44:47]
  ds_read_b128 v[20:23], v7 offset:22528
  s_add_u32 m0, s54, 11904
  v_mfma_f32_16x16x32_bf16 v[52:55], a[88:91], v[24:27], v[52:55]
  buffer_load_dwordx4 v5, s[12:15], s53 offen offset:384 lds
  v_mfma_f32_16x16x32_bf16 v[60:63], a[92:95], v[24:27], v[60:63]
  s_waitcnt lgkmcnt(3)
  v_mfma_f32_16x16x32_bf16 v[44:47], a[96:99], v[28:31], v[44:47]
  ds_read_b128 v[24:27], v6 offset:26624
  s_add_u32 m0, s54, 15872
  v_mfma_f32_16x16x32_bf16 v[52:55], a[100:103], v[28:31], v[52:55]
  buffer_load_dwordx4 v5, s[12:15], s53 offen offset:512 lds
  v_mfma_f32_16x16x32_bf16 v[60:63], a[104:107], v[28:31], v[60:63]
  s_waitcnt lgkmcnt(3)
  v_mfma_f32_16x16x32_bf16 v[44:47], a[108:111], v[32:35], v[44:47]
  ds_read_b128 v[28:31], v7 offset:26624
  s_add_u32 m0, s54, 19840
  v_mfma_f32_16x16x32_bf16 v[52:55], a[112:115], v[32:35], v[52:55]
  buffer_load_dwordx4 v5, s[12:15], s53 offen offset:640 lds
  v_mfma_f32_16x16x32_bf16 v[60:63], a[116:119], v[32:35], v[60:63]
  s_waitcnt lgkmcnt(3)
  v_mfma_f32_16x16x32_bf16 v[44:47], a[120:123], v[16:19], v[44:47]
  ds_read_b128 v[32:35], v6 offset:30720
  s_add_u32 m0, s54, 23808
  v_mfma_f32_16x16x32_bf16 v[52:55], a[124:127], v[16:19], v[52:55]
  buffer_load_dwordx4 v5, s[12:15], s53 offen offset:768 lds
  v_mfma_f32_16x16x32_bf16 v[60:63], a[128:131], v[16:19], v[60:63]
  s_waitcnt lgkmcnt(3)
  v_mfma_f32_16x16x32_bf16 v[44:47], a[132:135], v[20:23], v[44:47]
  ds_read_b128 v[16:19], v7 offset:30720
  s_add_u32 m0, s54, 27776
  v_mfma_f32_16x16x32_bf16 v[52:55], a[136:139], v[20:23], v[52:55]
  buffer_load_dwordx4 v5, s[12:15], s53 offen offset:896 lds
  v_mfma_f32_16x16x32_bf16 v[60:63], a[140:143], v[20:23], v[60:63]
  s_waitcnt lgkmcnt(3)
  v_mfma_f32_16x16x32_bf16 v[44:47], a[144:147], v[24:27], v[44:47]
  ds_read_b128 v[20:23], v6 offset:34816
  s_add_u32 m0, s54, 31744
  v_mfma_f32_16x16x32_bf16 v[52:55], a[148:151], v[24:27], v[52:55]
  buffer_load_dwordx4 v5, s[12:15], s53 offen offset:1024 lds
  v_mfma_f32_16x16x32_bf16 v[60:63], a[152:155], v[24:27], v[60:63]
  s_waitcnt lgkmcnt(3)
  v_mfma_f32_16x16x32_bf16 v[44:47], a[156:159], v[28:31], v[44:47]
  ds_read_b128 v[24:27], v7 offset:34816
  s_add_u32 m0, s54, 35712
  v_mfma_f32_16x16x32_bf16 v[52:55], a[160:163], v[28:31], v[52:55]
  buffer_load_dwordx4 v5, s[12:15], s53 offen offset:1152 lds
  v_mfma_f32_16x16x32_bf16 v[60:63], a[164:167], v[28:31], v[60:63]
  s_waitcnt lgkmcnt(3)
  v_mfma_f32_16x16x32_bf16 v[44:47], a[168:171], v[32:35], v[44:47]
  ds_read_b128 v[28:31], v6 offset:38912
  v_mfma_f32_16x16x32_bf16 v[52:55], a[172:175], v[32:35], v[52:55]
  s_max_u32 s69, s52, 25
  s_sub_u32 s69, s69, 25
  v_mfma_f32_16x16x32_bf16 v[60:63], a[176:179], v[32:35], v[60:63]
  s_cmp_eq_u32 s52, s70
  s_cbranch_scc1 pj_warm
pj_wback:
  s_waitcnt lgkmcnt(3)
  v_mfma_f32_16x16x32_bf16 v[44:47], a[180:183], v[16:19], v[44:47]
  ds_read_b128 v[32:35], v7 offset:38912
  v_mfma_f32_16x16x32_bf16 v[52:55], a[184:187], v[16:19], v[52:55]
  v_add_u32 v6, s59, v6
  v_add_u32 v7, s59, v7
  v_mfma_f32_16x16x32_bf16 v[60:63], a[188:191], v[16:19], v[60:63]
  s_waitcnt lgkmcnt(3)
  v_mfma_f32_16x16x32_bf16 v[44:47], a[192:195], v[20:23], v[44:47]
  ds_read_b128 v[16:19], v6 offset:0
  v_mfma_f32_16x16x32_bf16 v[52:55], a[196:199], v[20:23], v[52:55]
  s_cmp_lt_u32 s68, s69
  s_cbranch_scc1 pj_slow
pj_back:
  v_mfma_f32_16x16x32_bf16 v[60:63], a[200:203], v[20:23], v[60:63]
  s_waitcnt lgkmcnt(3)
  v_mfma_f32_16x16x32_bf16 v[44:47], a[204:207], v[24:27], v[44:47]
  ds_read_b128 v[20:23], v7 offset:0
  v_mfma_f32_16x16x32_bf16 v[52:55], a[208:211], v[24:27], v[52:55]
  s_add_u32 s52, s52, 1
  v_mfma_f32_16x16x32_bf16 v[60:63], a[212:215], v[24:27], v[60:63]
  s_waitcnt lgkmcnt(3)
  v_mfma_f32_16x16x32_bf16 v[44:47], a[216:219], v[28:31], v[44:47]
  ds_read_b128 v[24:27], v6 offset:4096
  v_mfma_f32_16x16x32_bf16 v[52:55], a[220:223], v[28:31], v[52:55]
  v_mfma_f32_16x16x32_bf16 v[60:63], a[224:227], v[28:31], v[60:63]
  s_waitcnt lgkmcnt(3)
  v_mfma_f32_16x16x32_bf16 v[44:47], a[228:231], v[32:35], v[44:47]
  ds_read_b128 v[28:31], v7 offset:4096
  v_mfma_f32_16x16x32_bf16 v[52:55], a[232:235], v[32:35], v[52:55]
  s_cmp_lt_u32 s52, s62
  v_mfma_f32_16x16x32_bf16 v[60:63], a[236:239], v[32:35], v[60:63]
  s_waitcnt lgkmcnt(3)
  s_cbranch_scc1 pj_loop_3
  v_cvt_pk_bf16_f32 v66, v44, v45
  v_cvt_pk_bf16_f32 v67, v46, v47
  s_nop 1
  v_cvt_pk_bf16_f32 v70, v52, v53
  v_cvt_pk_bf16_f32 v71, v54, v55
  v_cvt_pk_bf16_f32 v74, v60, v61
  v_cvt_pk_bf16_f32 v75, v62, v63
  v_permlane16_swap_b32 v64, v66
  v_permlane16_swap_b32 v65, v67
  v_permlane16_swap_b32 v68, v70
  v_permlane16_swap_b32 v69, v71
  v_permlane16_swap_b32 v72, v74
  v_permlane16_swap_b32 v73, v75
  buffer_store_dwordx4 v[64:67], v8, s[8:11], s55 offen sc1
  buffer_store_dwordx4 v[68:71], v8, s[8:11], s56 offen sc1
  buffer_store_dwordx4 v[72:75], v8, s[8:11], s57 offen sc1
  v_mov_b32 v10, s52
  s_waitcnt vmcnt(0) lgkmcnt(0)
  s_barrier
  buffer_store_dword v10, v9, s[8:11], 0 offen sc1
  s_branch pj_done
pj_slow:
  s_cmp_ge_u32 s68, s69
  s_cbranch_scc1 wf_done_4
  s_mov_b32 s50, 0
wf_loop_5:
  buffer_load_dword v11, v14, s[8:11], 0 offen sc1
  s_add_u32 s50, s50, 1
  s_cmp_gt_u32 s50, 131072
  s_cbranch_scc1 L_fail
  s_waitcnt vmcnt(0)
  v_readfirstlane_b32 s68, v11
  s_nop 0
  s_cmp_ge_u32 s68, s69
  s_cbranch_scc1 wf_done_4
  s_sleep 2
  s_branch wf_loop_5
wf_done_4:
  s_branch pj_back
pj_eager:
  s_waitcnt vmcnt(0)
  s_barrier
  buffer_store_dword v10, v9, s[8:11], 0 offen sc1
  s_branch pj_eback
pj_warm:
  s_lshl_b32 s46, s44, 2
  s_add_u32 s46, s46, s43
  s_sub_u32 s46, s46, 4
  s_lshl_b32 s46, s46, 2
  s_add_u32 s46, s46, s42
  s_lshl_b32 s46, s46, 13
  v_lshlrev_b32 v11, 7, v0
  s_mov_b32 s4, s16
  s_mov_b32 s5, s17
  s_mov_b32 s6, 2621440
  s_mov_b32 s7, 0x20000
  buffer_load_dword v12, v11, s[4:7], s46 offen
  s_mov_b32 s4, s18
  s_mov_b32 s5, s19
  s_mov_b32 s6, 2457600
  s_mov_b32 s7, 0x20000
  buffer_load_dword v12, v11, s[4:7], s46 offen
  s_mov_b32 s4, s20
  s_mov_b32 s5, s21
  s_mov_b32 s6, 819200
  s_mov_b32 s7, 0x20000
  buffer_load_dword v12, v11, s[4:7], s46 offen
  s_branch pj_wback
pj_done:
  s_branch L_parta
L_uw:
  s_mov_b32 s4, s32
  s_mov_b32 s5, s33
  s_mov_b32 s6, 7864320
  s_mov_b32 s7, 0x20000
  v_lshrrev_b32 v8, 3, v0
  v_lshrrev_b32 v9, 2, v8
  v_lshlrev_b32 v9, 3, v9
  v_and_b32 v1, 3, v8
  v_add_u32 v1, v1, v9
  s_and_b32 s46, s42, 1
  s_lshl_b32 s46, s46, 2
  s_lshr_b32 s47, s42, 1
  s_lshl_b32 s47, s47, 4
  s_add_u32 s46, s46, s47
  v_add_u32 v1, s46, v1
  v_mul_u32_u24 v1, 1280, v1
  v_lshrrev_b32 v8, 1, v8
  v_bfe_u32 v9, v0, 1, 2
  v_xor_b32 v8, v8, v9
  v_lshlrev_b32 v8, 5, v8
  v_and_b32 v9, 1, v0
  v_lshlrev_b32 v9, 4, v9
  v_add3_u32 v1, v1, v8, v9
  v_lshrrev_b32 v8, 5, v0
  v_lshlrev_b32 v2, 11, v8
  v_bfe_u32 v8, v0, 2, 3
  v_lshl_add_u32 v2, v8, 7, v2
  v_lshrrev_b32 v8, 1, v8
  v_xor_b32 v8, s42, v8
  v_lshl_add_u32 v2, v8, 5, v2
  v_and_b32 v8, 3, v0
  v_lshl_add_u32 v2, v8, 3, v2
  v_add_u32 v3, 0x10000, v2
  v_add_u32 v4, 0x20000, v2
  s_mul_i32 s53, s45, 245760
  v_lshlrev_b32 v5, 4, v0
  s_lshl_b32 s46, s45, 7
  s_add_u32 s47, s46, 13656064
  v_mov_b32 v6, s47
  s_lshr_b32 s46, s45, 3
  s_lshl_b32 s46, s46, 2
  s_add_u32 s46, s46, s42
  s_lshl_b32 s46, s46, 5
  s_and_b32 s47, s45, 7
  s_add_u32 s46, s46, s47
  s_lshl_b32 s46, s46, 2
  s_add_u32 s46, s46, 13688832
  v_lshl_add_u32 v7, v0, 11, s46
  v_mov_b32 v8, 2146435072
  v_cmp_gt_u32 vcc, 4, v0
  s_nop 1
  v_cndmask_b32 v7, v8, v7, vcc
  v_cmp_eq_u32 vcc, 0, v0
  s_nop 1
  v_cndmask_b32 v6, v8, v6, vcc
  s_mov_b32 s60, s51
  s_add_u32 s61, s51, 67117056
  s_mov_b32 s62, s45
  v_mov_b32 v12, v5
  s_lshr_b32 s55, s45, 3
  s_lshl_b32 s55, s55, 14
  s_and_b32 s46, s45, 7
  s_lshl_b32 s46, s46, 10
  s_add_u32 s55, s55, s46
  s_lshl_b32 s46, s42, 16
  s_add_u32 s55, s55, s46
  s_add_u32 s55, s55, 117440512
  s_mov_b32 s52, 0
  s_mov_b32 s56, 0
  s_add_u32 m0, s51, 0
  s_add_u32 s46, s53, 0
  buffer_load_dwordx4 v1, s[4:7], s46 offen  lds
  s_add_u32 m0, s51, 4096
  s_add_u32 s46, s53, 128
  buffer_load_dwordx4 v1, s[4:7], s46 offen  lds
  s_add_u32 m0, s51, 8192
  s_add_u32 s46, s53, 256
  buffer_load_dwordx4 v1, s[4:7], s46 offen  lds
  s_add_u32 m0, s51, 12288
  s_add_u32 s46, s53, 384
  buffer_load_dwordx4 v1, s[4:7], s46 offen  lds
  s_add_u32 m0, s51, 16384
  s_add_u32 s46, s53, 512
  buffer_load_dwordx4 v1, s[4:7], s46 offen  lds
  s_add_u32 m0, s51, 20480
  s_add_u32 s46, s53, 640
  buffer_load_dwordx4 v1, s[4:7], s46 offen  lds
  s_add_u32 m0, s51, 24576
  s_add_u32 s46, s53, 768
  buffer_load_dwordx4 v1, s[4:7], s46 offen  lds
  s_add_u32 m0, s51, 28672
  s_add_u32 s46, s53, 896
  buffer_load_dwordx4 v1, s[4:7], s46 offen  lds
  s_add_u32 m0, s51, 32768
  s_add_u32 s46, s53, 1024
  buffer_load_dwordx4 v1, s[4:7], s46 offen  lds
  s_add_u32 m0, s51, 36864
  s_add_u32 s46, s53, 1152
  buffer_load_dwordx4 v1, s[4:7], s46 offen  lds
  s_add_u32 m0, s51, 40960
  s_add_u32 s46, s53, 40960
  buffer_load_dwordx4 v1, s[4:7], s46 offen  lds
  s_add_u32 m0, s51, 45056
  s_add_u32 s46, s53, 41088
  buffer_load_dwordx4 v1, s[4:7], s46 offen  lds
  s_add_u32 m0, s51, 49152
  s_add_u32 s46, s53, 41216
  buffer_load_dwordx4 v1, s[4:7], s46 offen  lds
  s_add_u32 m0, s51, 53248
  s_add_u32 s46, s53, 41344
  buffer_load_dwordx4 v1, s[4:7], s46 offen  lds
  s_add_u32 m0, s51, 57344
  s_add_u32 s46, s53, 41472
  buffer_load_dwordx4 v1, s[4:7], s46 offen  lds
  s_add_u32 m0, s51, 61440
  s_add_u32 s46, s53, 41600
  buffer_load_dwordx4 v1, s[4:7], s46 offen  lds
  s_add_u32 m0, s51, 65536
  s_add_u32 s46, s53, 41728
  buffer_load_dwordx4 v1, s[4:7], s46 offen  lds
  s_add_u32 m0, s51, 69632
  s_add_u32 s46, s53, 41856
  buffer_load_dwordx4 v1, s[4:7], s46 offen  lds
  s_add_u32 m0, s51, 73728
  s_add_u32 s46, s53, 41984
  buffer_load_dwordx4 v1, s[4:7], s46 offen  lds
  s_add_u32 m0, s51, 77824
  s_add_u32 s46, s53, 42112
  buffer_load_dwordx4 v1, s[4:7], s46 offen  lds
  s_add_u32 m0, s51, 81920
  s_add_u32 s46, s53, 81920
  buffer_load_dwordx4 v1, s[4:7], s46 offen  lds
  s_add_u32 m0, s51, 86016
  s_add_u32 s46, s53, 82048
  buffer_load_dwordx4 v1, s[4:7], s46 offen  lds
  s_add_u32 m0, s51, 90112
  s_add_u32 s46, s53, 82176
  buffer_load_dwordx4 v1, s[4:7], s46 offen  lds
  s_add_u32 m0, s51, 94208
  s_add_u32 s46, s53, 82304
  buffer_load_dwordx4 v1, s[4:7], s46 offen  lds
  s_add_u32 m0, s51, 98304
  s_add_u32 s46, s53, 82432
  buffer_load_dwordx4 v1, s[4:7], s46 offen  lds
  s_add_u32 m0, s51, 102400
  s_add_u32 s46, s53, 82560
  buffer_load_dwordx4 v1, s[4:7], s46 offen  lds
  s_add_u32 m0, s51, 106496
  s_add_u32 s46, s53, 82688
  buffer_load_dwordx4 v1, s[4:7], s46 offen  lds
  s_add_u32 m0, s51, 110592
  s_add_u32 s46, s53, 82816
  buffer_load_dwordx4 v1, s[4:7], s46 offen  lds
  s_add_u32 m0, s51, 114688
  s_add_u32 s46, s53, 82944
  buffer_load_dwordx4 v1, s[4:7], s46 offen  lds
  s_add_u32 m0, s51, 118784
  s_add_u32 s46, s53, 83072
  buffer_load_dwordx4 v1, s[4:7], s46 offen  lds
  s_waitcnt vmcnt(24)
  s_barrier
  s_add_u32 m0, s51, 122880
  s_add_u32 s46, s53, 122880
  buffer_load_dwordx4 v1, s[4:7], s46 offen  lds
  s_add_u32 m0, s51, 126976
  s_add_u32 s46, s53, 123008
  buffer_load_dwordx4 v1, s[4:7], s46 offen  lds
  s_add_u32 m0, s51, 131072
  s_add_u32 s46, s53, 123136
  buffer_load_dwordx4 v1, s[4:7], s46 offen  lds
  s_add_u32 m0, s51, 135168
  s_add_u32 s46, s53, 123264
  buffer_load_dwordx4 v1, s[4:7], s46 offen  lds
  s_add_u32 m0, s51, 139264
  s_add_u32 s46, s53, 123392
  buffer_load_dwordx4 v1, s[4:7], s46 offen  lds
  s_add_u32 m0, s51, 143360
  s_add_u32 s46, s53, 123520
  buffer_load_dwordx4 v1, s[4:7], s46 offen  lds
  ds_read_b64_tr_b16 a[0:1], v2 offset:0
  ds_read_b64_tr_b16 a[2:3], v2 offset:1024
  ds_read_b64_tr_b16 a[24:25], v2 offset:4096
  ds_read_b64_tr_b16 a[26:27], v2 offset:5120
  ds_read_b64_tr_b16 a[48:49], v2 offset:8192
  ds_read_b64_tr_b16 a[50:51], v2 offset:9216
  ds_read_b64_tr_b16 a[72:73], v2 offset:12288
  ds_read_b64_tr_b16 a[74:75], v2 offset:13312
  ds_read_b64_tr_b16 a[96:97], v2 offset:16384
  ds_read_b64_tr_b16 a[98:99], v2 offset:17408
  ds_read_b64_tr_b16 a[120:121], v2 offset:20480
  ds_read_b64_tr_b16 a[122:123], v2 offset:21504
  s_waitcnt lgkmcnt(0)
  s_waitcnt vmcnt(24)
  s_barrier
  s_add_u32 m0, s51, 0
  s_add_u32 s46, s53, 123648
  buffer_load_dwordx4 v1, s[4:7], s46 offen  lds
  s_add_u32 m0, s51, 4096
  s_add_u32 s46, s53, 123776
  buffer_load_dwordx4 v1, s[4:7], s46 offen  lds
  s_add_u32 m0, s51, 8192
  s_add_u32 s46, s53, 123904
  buffer_load_dwordx4 v1, s[4:7], s46 offen  lds
  s_add_u32 m0, s51, 12288
  s_add_u32 s46, s53, 124032
  buffer_load_dwordx4 v1, s[4:7], s46 offen  lds
  s_add_u32 m0, s51, 16384
  s_add_u32 s46, s53, 163840
  buffer_load_dwordx4 v1, s[4:7], s46 offen  lds
  s_add_u32 m0, s51, 20480
  s_add_u32 s46, s53, 163968
  buffer_load_dwordx4 v1, s[4:7], s46 offen  lds
  ds_read_b64_tr_b16 a[144:145], v2 offset:24576
  ds_read_b64_tr_b16 a[146:147], v2 offset:25600
  ds_read_b64_tr_b16 a[168:169], v2 offset:28672
  ds_read_b64_tr_b16 a[170:171], v2 offset:29696
  ds_read_b64_tr_b16 a[192:193], v2 offset:32768
  ds_read_b64_tr_b16 a[194:195], v2 offset:33792
  ds_read_b64_tr_b16 a[216:217], v2 offset:36864
  ds_read_b64_tr_b16 a[218:219], v2 offset:37888
  ds_read_b64_tr_b16 a[4:5], v2 offset:40960
  ds_read_b64_tr_b16 a[6:7], v2 offset:41984
  ds_read_b64_tr_b16 a[28:29], v2 offset:45056
  ds_read_b64_tr_b16 a[30:31], v2 offset:46080
  s_waitcnt lgkmcnt(0)
  s_waitcnt vmcnt(24)
  s_barrier
  s_add_u32 m0, s51, 24576
  s_add_u32 s46, s53, 164096
  buffer_load_dwordx4 v1, s[4:7], s46 offen  lds
  s_add_u32 m0, s51, 28672
  s_add_u32 s46, s53, 164224
  buffer_load_dwordx4 v1, s[4:7], s46 offen  lds
  s_add_u32 m0, s51, 32768
  s_add_u32 s46, s53, 164352
  buffer_load_dwordx4 v1, s[4:7], s46 offen  lds
  s_add_u32 m0, s51, 36864
  s_add_u32 s46, s53, 164480
  buffer_load_dwordx4 v1, s[4:7], s46 offen  lds
  s_add_u32 m0, s51, 40960
  s_add_u32 s46, s53, 164608
  buffer_load_dwordx4 v1, s[4:7], s46 offen  lds
  s_add_u32 m0, s51, 45056
  s_add_u32 s46, s53, 164736
  buffer_load_dwordx4 v1, s[4:7], s46 offen  lds
  ds_read_b64_tr_b16 a[52:53], v2 offset:49152
  ds_read_b64_tr_b16 a[54:55], v2 offset:50176
  ds_read_b64_tr_b16 a[76:77], v2 offset:53248
  ds_read_b64_tr_b16 a[78:79], v2 offset:54272
  ds_read_b64_tr_b16 a[100:101], v2 offset:57344
  ds_read_b64_tr_b16 a[102:103], v2 offset:58368
  ds_read_b64_tr_b16 a[124:125], v2 offset:61440
  ds_read_b64_tr_b16 a[126:127], v2 offset:62464
  ds_read_b64_tr_b16 a[148:149], v3 offset:0
  ds_read_b64_tr_b16 a[150:151], v3 offset:1024
  ds_read_b64_tr_b16 a[172:173], v3 offset:4096
  ds_read_b64_tr_b16 a[174:175], v3 offset:5120
  s_waitcnt lgkmcnt(0)
  s_waitcnt vmcnt(24)
  s_barrier
  s_add_u32 m0, s51, 49152
  s_add_u32 s46, s53, 164864
  buffer_load_dwordx4 v1, s[4:7], s46 offen  lds
  s_add_u32 m0, s51, 53248
  s_add_u32 s46, s53, 164992
  buffer_load_dwordx4 v1, s[4:7], s46 offen  lds
  s_add_u32 m0, s51, 57344
  s_add_u32 s46, s53, 204800
  buffer_load_dwordx4 v1, s[4:7], s46 offen  lds
  s_add_u32 m0, s51, 61440
  s_add_u32 s46, s53, 204928
  buffer_load_dwordx4 v1, s[4:7], s46 offen  lds
  s_add_u32 m0, s51, 65536
  s_add_u32 s46, s53, 205056
  buffer_load_dwordx4 v1, s[4:7], s46 offen  lds
  s_add_u32 m0, s51, 69632
  s_add_u32 s46, s53, 205184
  buffer_load_dwordx4 v1, s[4:7], s46 offen  lds
  ds_read_b64_tr_b16 a[196:197], v3 offset:8192
  ds_read_b64_tr_b16 a[198:199], v3 offset:9216
  ds_read_b64_tr_b16 a[220:221], v3 offset:12288
  ds_read_b64_tr_b16 a[222:223], v3 offset:13312
  ds_read_b64_tr_b16 a[8:9], v3 offset:16384
  ds_read_b64_tr_b16 a[10:11], v3 offset:17408
  ds_read_b64_tr_b16 a[32:33], v3 offset:20480
  ds_read_b64_tr_b16 a[34:35], v3 offset:21504
  ds_read_b64_tr_b16 a[56:57], v3 offset:24576
  ds_read_b64_tr_b16 a[58:59], v3 offset:25600
  ds_read_b64_tr_b16 a[80:81], v3 offset:28672
  ds_read_b64_tr_b16 a[82:83], v3 offset:29696
  s_waitcnt lgkmcnt(0)
  s_waitcnt vmcnt(24)
  s_barrier
  v_and_b32 v9, 3, v0
  v_lshlrev_b32 v9, 2, v9
  global_load_dword v8, v9, s[38:39] sc1
  s_add_u32 m0, s51, 73728
  s_add_u32 s46, s53, 205312
  buffer_load_dwordx4 v1, s[4:7], s46 offen  lds
  s_add_u32 m0, s51, 77824
  s_add_u32 s46, s53, 205440
  buffer_load_dwordx4 v1, s[4:7], s46 offen  lds
  s_add_u32 m0, s51, 81920
  s_add_u32 s46, s53, 205568
  buffer_load_dwordx4 v1, s[4:7], s46 offen  lds
  s_add_u32 m0, s51, 86016
  s_add_u32 s46, s53, 205696
  buffer_load_dwordx4 v1, s[4:7], s46 offen  lds
  s_add_u32 m0, s51, 90112
  s_add_u32 s46, s53, 205824
  buffer_load_dwordx4 v1, s[4:7], s46 offen  lds
  s_add_u32 m0, s51, 94208
  s_add_u32 s46, s53, 205952
  buffer_load_dwordx4 v1, s[4:7], s46 offen  lds
  ds_read_b64_tr_b16 a[104:105], v3 offset:32768
  ds_read_b64_tr_b16 a[106:107], v3 offset:33792
  ds_read_b64_tr_b16 a[128:129], v3 offset:36864
  ds_read_b64_tr_b16 a[130:131], v3 offset:37888
  ds_read_b64_tr_b16 a[152:153], v3 offset:40960
  ds_read_b64_tr_b16 a[154:155], v3 offset:41984
  ds_read_b64_tr_b16 a[176:177], v3 offset:45056
  ds_read_b64_tr_b16 a[178:179], v3 offset:46080
  ds_read_b64_tr_b16 a[200:201], v3 offset:49152
  ds_read_b64_tr_b16 a[202:203], v3 offset:50176
  ds_read_b64_tr_b16 a[224:225], v3 offset:53248
  ds_read_b64_tr_b16 a[226:227], v3 offset:54272
  s_waitcnt lgkmcnt(0)
  s_waitcnt vmcnt(25)
  s_barrier
  ds_read_b64_tr_b16 a[12:13], v3 offset:57344
  ds_read_b64_tr_b16 a[14:15], v3 offset:58368
  ds_read_b64_tr_b16 a[36:37], v3 offset:61440
  ds_read_b64_tr_b16 a[38:39], v3 offset:62464
  ds_read_b64_tr_b16 a[60:61], v4 offset:0
  ds_read_b64_tr_b16 a[62:63], v4 offset:1024
  ds_read_b64_tr_b16 a[84:85], v4 offset:4096
  ds_read_b64_tr_b16 a[86:87], v4 offset:5120
  ds_read_b64_tr_b16 a[108:109], v4 offset:8192
  ds_read_b64_tr_b16 a[110:111], v4 offset:9216
  ds_read_b64_tr_b16 a[132:133], v4 offset:12288
  ds_read_b64_tr_b16 a[134:135], v4 offset:13312
  s_waitcnt lgkmcnt(0)
  s_waitcnt vmcnt(19)
  s_barrier
  ds_read_b64_tr_b16 a[156:157], v2 offset:0
  ds_read_b64_tr_b16 a[158:159], v2 offset:1024
  ds_read_b64_tr_b16 a[180:181], v2 offset:4096
  ds_read_b64_tr_b16 a[182:183], v2 offset:5120
  ds_read_b64_tr_b16 a[204:205], v2 offset:8192
  ds_read_b64_tr_b16 a[206:207], v2 offset:9216
  ds_read_b64_tr_b16 a[228:229], v2 offset:12288
  ds_read_b64_tr_b16 a[230:231], v2 offset:13312
  ds_read_b64_tr_b16 a[16:17], v2 offset:16384
  ds_read_b64_tr_b16 a[18:19], v2 offset:17408
  ds_read_b64_tr_b16 a[40:41], v2 offset:20480
  ds_read_b64_tr_b16 a[42:43], v2 offset:21504
  s_waitcnt lgkmcnt(0)
  s_waitcnt vmcnt(13)
  s_barrier
  ds_read_b64_tr_b16 a[64:65], v2 offset:24576
  ds_read_b64_tr_b16 a[66:67], v2 offset:25600
  ds_read_b64_tr_b16 a[88:89], v2 offset:28672
  ds_read_b64_tr_b16 a[90:91], v2 offset:29696
  ds_read_b64_tr_b16 a[112:113], v2 offset:32768
  ds_read_b64_tr_b16 a[114:115], v2 offset:33792
  ds_read_b64_tr_b16 a[136:137], v2 offset:36864
  ds_read_b64_tr_b16 a[138:139], v2 offset:37888
  ds_read_b64_tr_b16 a[160:161], v2 offset:40960
  ds_read_b64_tr_b16 a[162:163], v2 offset:41984
  ds_read_b64_tr_b16 a[184:185], v2 offset:45056
  ds_read_b64_tr_b16 a[186:187], v2 offset:46080
  s_waitcnt lgkmcnt(0)
  s_waitcnt vmcnt(7)
  s_barrier
  ds_read_b64_tr_b16 a[208:209], v2 offset:49152
  ds_read_b64_tr_b16 a[210:211], v2 offset:50176
  ds_read_b64_tr_b16 a[232:233], v2 offset:53248
  ds_read_b64_tr_b16 a[234:235], v2 offset:54272
  ds_read_b64_tr_b16 a[20:21], v2 offset:57344
  ds_read_b64_tr_b16 a[22:23], v2 offset:58368
  ds_read_b64_tr_b16 a[44:45], v2 offset:61440
  ds_read_b64_tr_b16 a[46:47], v2 offset:62464
  ds_read_b64_tr_b16 a[68:69], v3 offset:0
  ds_read_b64_tr_b16 a[70:71], v3 offset:1024
  ds_read_b64_tr_b16 a[92:93], v3 offset:4096
  ds_read_b64_tr_b16 a[94:95], v3 offset:5120
  s_waitcnt lgkmcnt(0)
  s_waitcnt vmcnt(0)
  s_barrier
  ds_read_b64_tr_b16 a[116:117], v3 offset:8192
  ds_read_b64_tr_b16 a[118:119], v3 offset:9216
  ds_read_b64_tr_b16 a[140:141], v3 offset:12288
  ds_read_b64_tr_b16 a[142:143], v3 offset:13312
  ds_read_b64_tr_b16 a[164:165], v3 offset:16384
  ds_read_b64_tr_b16 a[166:167], v3 offset:17408
  ds_read_b64_tr_b16 a[188:189], v3 offset:20480
  ds_read_b64_tr_b16 a[190:191], v3 offset:21504
  ds_read_b64_tr_b16 a[212:213], v3 offset:24576
  ds_read_b64_tr_b16 a[214:215], v3 offset:25600
  ds_read_b64_tr_b16 a[236:237], v3 offset:28672
  ds_read_b64_tr_b16 a[238:239], v3 offset:29696
  s_waitcnt lgkmcnt(0)
  s_mov_b32 s50, 0
  s_branch ss_6_in
ss_6:
  v_and_b32 v9, 3, v0
  v_lshlrev_b32 v9, 2, v9
  global_load_dword v8, v9, s[38:39] sc1
  s_add_u32 s50, s50, 1
  s_cmp_gt_u32 s50, 131072
  s_cbranch_scc1 L_fail
  s_waitcnt vmcnt(0)
ss_6_in:
  v_readlane_b32 s46, v8, 0
  v_readlane_b32 s47, v8, 2
  v_readlane_b32 s48, v8, 1
  s_nop 0
  s_min_u32 s47, s47, s48
  s_cmp_lg_u32 s46, 0
  s_cselect_b32 s48, 7, 0
  s_add_u32 s46, s46, s2
  s_xor_b32 s49, s46, s43
  s_and_b32 s49, s49, s48
  s_cbranch_scc1 L_reroll
  s_cmp_lg_u32 s47, 0
  s_cbranch_scc1 ss_ok_7
  s_sleep 6
  s_branch ss_6
ss_ok_7:
  v_readlane_b32 s3, v8, 1
  s_nop 0
  s_and_b32 s3, s3, 0x2000
  s_barrier
  s_xor_b32 s61, s61, s3
  v_xor_b32 v6, s3, v6
  v_xor_b32 v7, s3, v7
  s_xor_b32 s55, s55, s3
  s_lshr_b32 s46, s45, 3
  s_lshr_b32 s46, 1, s46
  s_and_b32 s46, s46, 1
  s_lshl_b32 s46, s46, 13
  s_xor_b32 s55, s55, s46
  s_mov_b32 s57, 1
  s_cmp_ge_u32 s56, s57
  s_cbranch_scc1 wf_done_8
  s_mov_b32 s50, 0
wf_loop_9:
  buffer_load_dword v13, v6, s[8:11], 0 offen sc1
  s_add_u32 s50, s50, 1
  s_cmp_gt_u32 s50, 131072
  s_cbranch_scc1 L_fail
  s_waitcnt vmcnt(0)
  v_readfirstlane_b32 s56, v13
  s_nop 0
  s_cmp_ge_u32 s56, s57
  s_cbranch_scc1 wf_done_8
  s_sleep 2
  s_branch wf_loop_9
wf_done_8:
  s_lshr_b32 s54, s62, 1
  s_lshl_b32 s54, s54, 14
  s_and_b32 s47, s62, 1
  s_lshl_b32 s47, s47, 12
  s_add_u32 s54, s54, s47
  s_add_u32 s54, s54, s61
  s_lshr_b32 s47, s54, 8
  s_and_b32 s47, s47, 0x2000
  s_xor_b32 s54, s54, s47
  s_add_u32 m0, s60, 0
  s_add_u32 s47, s54, 0
  buffer_load_dwordx4 v5, s[8:11], s47 offen sc1 lds
  s_add_u32 m0, s60, 4096
  s_add_u32 s47, s54, 16777216
  buffer_load_dwordx4 v5, s[8:11], s47 offen sc1 lds
  s_add_u32 m0, s60, 8192
  s_add_u32 s47, s54, 33554432
  buffer_load_dwordx4 v5, s[8:11], s47 offen sc1 lds
  s_mov_b32 s59, 2146435072
  s_waitcnt vmcnt(0)
  s_barrier
  ds_read_b128 v[16:19], v12 offset:0
  ds_read_b128 v[40:43], v12 offset:2048
  ds_read_b128 v[20:23], v12 offset:1024
  ds_read_b128 v[44:47], v12 offset:3072
  ds_read_b128 v[24:27], v12 offset:4096
  ds_read_b128 v[48:51], v12 offset:6144
  ds_read_b128 v[28:31], v12 offset:5120
  ds_read_b128 v[52:55], v12 offset:7168
  ds_read_b128 v[32:35], v12 offset:8192
  ds_read_b128 v[56:59], v12 offset:10240
  ds_read_b128 v[36:39], v12 offset:9216
  ds_read_b128 v[60:63], v12 offset:11264
u_loop:
  s_waitcnt lgkmcnt(8)
  v_mfma_f32_16x16x32_bf16 v[64:67], v[16:19], a[0:3], 0
  buffer_load_dword v13, v6, s[8:11], 0 offen sc1
  v_mfma_f32_16x16x32_bf16 v[68:71], v[40:43], a[0:3], 0
  v_mfma_f32_16x16x32_bf16 v[64:67], v[20:23], a[4:7], v[64:67]
  v_cvt_pk_bf16_f32 v84, v72, v73
  v_mfma_f32_16x16x32_bf16 v[68:71], v[44:47], a[4:7], v[68:71]
  s_waitcnt lgkmcnt(4)
  v_cvt_pk_bf16_f32 v85, v74, v75
  v_mfma_f32_16x16x32_bf16 v[64:67], v[24:27], a[8:11], v[64:67]
  v_cvt_pk_bf16_f32 v86, v76, v77
  v_mfma_f32_16x16x32_bf16 v[68:71], v[48:51], a[8:11], v[68:71]
  v_cvt_pk_bf16_f32 v87, v78, v79
  v_mfma_f32_16x16x32_bf16 v[64:67], v[28:31], a[12:15], v[64:67]
  buffer_store_dwordx4 v[84:87], v5, s[8:11], s59 offen sc1
  v_mfma_f32_16x16x32_bf16 v[68:71], v[52:55], a[12:15], v[68:71]
  s_add_u32 s58, s55, 0
  s_waitcnt lgkmcnt(0)
  v_mfma_f32_16x16x32_bf16 v[64:67], v[32:35], a[16:19], v[64:67]
  s_lshr_b32 s46, s58, 8
  v_mfma_f32_16x16x32_bf16 v[68:71], v[56:59], a[16:19], v[68:71]
  s_and_b32 s46, s46, 0x2000
  v_mfma_f32_16x16x32_bf16 v[64:67], v[36:39], a[20:23], v[64:67]
  s_xor_b32 s58, s58, s46
  v_mfma_f32_16x16x32_bf16 v[68:71], v[60:63], a[20:23], v[68:71]
  v_mfma_f32_16x16x32_bf16 v[72:75], v[16:19], a[24:27], 0
  s_add_u32 s59, s55, 2359296
  v_mfma_f32_16x16x32_bf16 v[76:79], v[40:43], a[24:27], 0
  s_lshr_b32 s46, s59, 8
  v_mfma_f32_16x16x32_bf16 v[72:75], v[20:23], a[28:31], v[72:75]
  s_and_b32 s46, s46, 0x2000
  v_cvt_pk_bf16_f32 v80, v64, v65
  v_mfma_f32_16x16x32_bf16 v[76:79], v[44:47], a[28:31], v[76:79]
  s_xor_b32 s59, s59, s46
  v_cvt_pk_bf16_f32 v81, v66, v67
  v_mfma_f32_16x16x32_bf16 v[72:75], v[24:27], a[32:35], v[72:75]
  v_cvt_pk_bf16_f32 v82, v68, v69
  v_mfma_f32_16x16x32_bf16 v[76:79], v[48:51], a[32:35], v[76:79]
  s_add_u32 s57, s52, 2
  s_min_u32 s57, s57, 64
  v_cvt_pk_bf16_f32 v83, v70, v71
  v_mfma_f32_16x16x32_bf16 v[72:75], v[28:31], a[36:39], v[72:75]
  buffer_store_dwordx4 v[80:83], v5, s[8:11], s58 offen sc1
  v_mfma_f32_16x16x32_bf16 v[76:79], v[52:55], a[36:39], v[76:79]
  s_add_u32 s58, s55, 262144
  v_mfma_f32_16x16x32_bf16 v[72:75], v[32:35], a[40:43], v[72:75]
  s_lshr_b32 s46, s58, 8
  v_mfma_f32_16x16x32_bf16 v[76:79], v[56:59], a[40:43], v[76:79]
  s_and_b32 s46, s46, 0x2000
  v_mfma_f32_16x16x32_bf16 v[72:75], v[36:39], a[44:47], v[72:75]
  s_xor_b32 s58, s58, s46
  v_mfma_f32_16x16x32_bf16 v[76:79], v[60:63], a[44:47], v[76:79]
  s_xor_b32 s60, s60, 0x4000
  v_mov_b32 v8, s52
  v_mfma_f32_16x16x32_bf16 v[64:67], v[16:19], a[48:51], 0
  s_add_u32 s62, s62, 32
  v_xor_b32 v12, 0x4000, v12
  v_mfma_f32_16x16x32_bf16 v[68:71], v[40:43], a[48:51], 0
  s_cmp_ge_u32 s62, 1024
  s_cselect_b32 s47, 1024, 0
  v_mfma_f32_16x16x32_bf16 v[64:67], v[20:23], a[52:55], v[64:67]
  s_sub_u32 s62, s62, s47
  v_cvt_pk_bf16_f32 v84, v72, v73
  v_mfma_f32_16x16x32_bf16 v[68:71], v[44:47], a[52:55], v[68:71]
  s_lshr_b32 s54, s62, 1
  v_cvt_pk_bf16_f32 v85, v74, v75
  v_mfma_f32_16x16x32_bf16 v[64:67], v[24:27], a[56:59], v[64:67]
  s_lshl_b32 s54, s54, 14
  v_cvt_pk_bf16_f32 v86, v76, v77
  v_mfma_f32_16x16x32_bf16 v[68:71], v[48:51], a[56:59], v[68:71]
  s_and_b32 s47, s62, 1
  v_cvt_pk_bf16_f32 v87, v78, v79
  v_mfma_f32_16x16x32_bf16 v[64:67], v[28:31], a[60:63], v[64:67]
  buffer_store_dwordx4 v[84:87], v5, s[8:11], s58 offen sc1
  s_lshl_b32 s47, s47, 12
  v_mfma_f32_16x16x32_bf16 v[68:71], v[52:55], a[60:63], v[68:71]
  s_add_u32 s58, s55, 524288
  s_add_u32 s54, s54, s47
  v_mfma_f32_16x16x32_bf16 v[64:67], v[32:35], a[64:67], v[64:67]
  s_lshr_b32 s46, s58, 8
  s_add_u32 s54, s54, s61
  v_mfma_f32_16x16x32_bf16 v[68:71], v[56:59], a[64:67], v[68:71]
  s_and_b32 s46, s46, 0x2000
  s_lshr_b32 s47, s54, 8
  v_mfma_f32_16x16x32_bf16 v[64:67], v[36:39], a[68:71], v[64:67]
  s_xor_b32 s58, s58, s46
  s_and_b32 s47, s47, 0x2000
  v_mfma_f32_16x16x32_bf16 v[68:71], v[60:63], a[68:71], v[68:71]
  s_xor_b32 s54, s54, s47
  v_mfma_f32_16x16x32_bf16 v[72:75], v[16:19], a[72:75], 0
  v_mfma_f32_16x16x32_bf16 v[76:79], v[40:43], a[72:75], 0
  v_mfma_f32_16x16x32_bf16 v[72:75], v[20:23], a[76:79], v[72:75]
  v_cvt_pk_bf16_f32 v80, v64, v65
  v_mfma_f32_16x16x32_bf16 v[76:79], v[44:47], a[76:79], v[76:79]
  v_cvt_pk_bf16_f32 v81, v66, v67
  v_mfma_f32_16x16x32_bf16 v[72:75], v[24:27], a[80:83], v[72:75]
  v_cvt_pk_bf16_f32 v82, v68, v69
  v_mfma_f32_16x16x32_bf16 v[76:79], v[48:51], a[80:83], v[76:79]
  v_cvt_pk_bf16_f32 v83, v70, v71
  v_mfma_f32_16x16x32_bf16 v[72:75], v[28:31], a[84:87], v[72:75]
  buffer_store_dwordx4 v[80:83], v5, s[8:11], s58 offen sc1
  v_mfma_f32_16x16x32_bf16 v[76:79], v[52:55], a[84:87], v[76:79]
  s_add_u32 s58, s55, 786432
  v_mfma_f32_16x16x32_bf16 v[72:75], v[32:35], a[88:91], v[72:75]
  s_lshr_b32 s46, s58, 8
  v_mfma_f32_16x16x32_bf16 v[76:79], v[56:59], a[88:91], v[76:79]
  s_and_b32 s46, s46, 0x2000
  v_mfma_f32_16x16x32_bf16 v[72:75], v[36:39], a[92:95], v[72:75]
  s_xor_b32 s58, s58, s46
  s_waitcnt vmcnt(3)
  v_readfirstlane_b32 s56, v13
  v_mfma_f32_16x16x32_bf16 v[76:79], v[60:63], a[92:95], v[76:79]
  buffer_store_dword v8, v7, s[8:11], 0 offen sc1
  v_mfma_f32_16x16x32_bf16 v[64:67], v[16:19], a[96:99], 0
  s_cmp_lt_u32 s56, s57
  s_cbranch_scc1 u_slow
u_back:
  v_mfma_f32_16x16x32_bf16 v[68:71], v[40:43], a[96:99], 0
  s_add_u32 m0, s60, 0
  s_add_u32 s47, s54, 0
  buffer_load_dwordx4 v5, s[8:11], s47 offen sc1 lds
  v_mfma_f32_16x16x32_bf16 v[64:67], v[20:23], a[100:103], v[64:67]
  s_add_u32 m0, s60, 4096
  s_add_u32 s47, s54, 16777216
  buffer_load_dwordx4 v5, s[8:11], s47 offen sc1 lds
  v_cvt_pk_bf16_f32 v84, v72, v73
  v_mfma_f32_16x16x32_bf16 v[68:71], v[44:47], a[100:103], v[68:71]
  s_add_u32 m0, s60, 8192
  s_add_u32 s47, s54, 33554432
  buffer_load_dwordx4 v5, s[8:11], s47 offen sc1 lds
  v_cvt_pk_bf16_f32 v85, v74, v75
  v_mfma_f32_16x16x32_bf16 v[64:67], v[24:27], a[104:107], v[64:67]
  v_cvt_pk_bf16_f32 v86, v76, v77
  v_mfma_f32_16x16x32_bf16 v[68:71], v[48:51], a[104:107], v[68:71]
  v_cvt_pk_bf16_f32 v87, v78, v79
  v_mfma_f32_16x16x32_bf16 v[64:67], v[28:31], a[108:111], v[64:67]
  buffer_store_dwordx4 v[84:87], v5, s[8:11], s58 offen sc1
  v_mfma_f32_16x16x32_bf16 v[68:71], v[52:55], a[108:111], v[68:71]
  s_add_u32 s58, s55, 1048576
  v_mfma_f32_16x16x32_bf16 v[64:67], v[32:35], a[112:115], v[64:67]
  s_lshr_b32 s46, s58, 8
  v_mfma_f32_16x16x32_bf16 v[68:71], v[56:59], a[112:115], v[68:71]
  s_and_b32 s46, s46, 0x2000
  v_mfma_f32_16x16x32_bf16 v[64:67], v[36:39], a[116:119], v[64:67]
  s_xor_b32 s58, s58, s46
  v_mfma_f32_16x16x32_bf16 v[68:71], v[60:63], a[116:119], v[68:71]
  v_mfma_f32_16x16x32_bf16 v[72:75], v[16:19], a[120:123], 0
  v_mfma_f32_16x16x32_bf16 v[76:79], v[40:43], a[120:123], 0
  v_mfma_f32_16x16x32_bf16 v[72:75], v[20:23], a[124:127], v[72:75]
  v_cvt_pk_bf16_f32 v80, v64, v65
  v_mfma_f32_16x16x32_bf16 v[76:79], v[44:47], a[124:127], v[76:79]
  v_cvt_pk_bf16_f32 v81, v66, v67
  v_mfma_f32_16x16x32_bf16 v[72:75], v[24:27], a[128:131], v[72:75]
  v_cvt_pk_bf16_f32 v82, v68, v69
  v_mfma_f32_16x16x32_bf16 v[76:79], v[48:51], a[128:131], v[76:79]
  v_cvt_pk_bf16_f32 v83, v70, v71
  v_mfma_f32_16x16x32_bf16 v[72:75], v[28:31], a[132:135], v[72:75]
  buffer_store_dwordx4 v[80:83], v5, s[8:11], s58 offen sc1
  v_mfma_f32_16x16x32_bf16 v[76:79], v[52:55], a[132:135], v[76:79]
  s_add_u32 s58, s55, 1310720
  v_mfma_f32_16x16x32_bf16 v[72:75], v[32:35], a[136:139], v[72:75]
  s_lshr_b32 s46, s58, 8
  v_mfma_f32_16x16x32_bf16 v[76:79], v[56:59], a[136:139], v[76:79]
  s_and_b32 s46, s46, 0x2000
  v_mfma_f32_16x16x32_bf16 v[72:75], v[36:39], a[140:143], v[72:75]
  s_xor_b32 s58, s58, s46
  v_mfma_f32_16x16x32_bf16 v[76:79], v[60:63], a[140:143], v[76:79]
  v_mfma_f32_16x16x32_bf16 v[64:67], v[16:19], a[144:147], 0
  v_mfma_f32_16x16x32_bf16 v[68:71], v[40:43], a[144:147], 0
  v_mfma_f32_16x16x32_bf16 v[64:67], v[20:23], a[148:151], v[64:67]
  v_cvt_pk_bf16_f32 v84, v72, v73
  v_mfma_f32_16x16x32_bf16 v[68:71], v[44:47], a[148:151], v[68:71]
  v_cvt_pk_bf16_f32 v85, v74, v75
  v_mfma_f32_16x16x32_bf16 v[64:67], v[24:27], a[152:155], v[64:67]
  v_cvt_pk_bf16_f32 v86, v76, v77
  v_mfma_f32_16x16x32_bf16 v[68:71], v[48:51], a[152:155], v[68:71]
  v_cvt_pk_bf16_f32 v87, v78, v79
  v_mfma_f32_16x16x32_bf16 v[64:67], v[28:31], a[156:159], v[64:67]
  buffer_store_dwordx4 v[84:87], v5, s[8:11], s58 offen sc1
  v_mfma_f32_16x16x32_bf16 v[68:71], v[52:55], a[156:159], v[68:71]
  s_add_u32 s58, s55, 1572864
  v_mfma_f32_16x16x32_bf16 v[64:67], v[32:35], a[160:163], v[64:67]
  s_lshr_b32 s46, s58, 8
  v_mfma_f32_16x16x32_bf16 v[68:71], v[56:59], a[160:163], v[68:71]
  s_and_b32 s46, s46, 0x2000
  v_mfma_f32_16x16x32_bf16 v[64:67], v[36:39], a[164:167], v[64:67]
  s_xor_b32 s58, s58, s46
  v_mfma_f32_16x16x32_bf16 v[68:71], v[60:63], a[164:167], v[68:71]
  v_mfma_f32_16x16x32_bf16 v[72:75], v[16:19], a[168:171], 0
  v_mfma_f32_16x16x32_bf16 v[76:79], v[40:43], a[168:171], 0
  v_mfma_f32_16x16x32_bf16 v[72:75], v[20:23], a[172:175], v[72:75]
  v_cvt_pk_bf16_f32 v80, v64, v65
  v_mfma_f32_16x16x32_bf16 v[76:79], v[44:47], a[172:175], v[76:79]
  v_cvt_pk_bf16_f32 v81, v66, v67
  v_mfma_f32_16x16x32_bf16 v[72:75], v[24:27], a[176:179], v[72:75]
  v_cvt_pk_bf16_f32 v82, v68, v69
  v_mfma_f32_16x16x32_bf16 v[76:79], v[48:51], a[176:179], v[76:79]
  v_cvt_pk_bf16_f32 v83, v70, v71
  v_mfma_f32_16x16x32_bf16 v[72:75], v[28:31], a[180:183], v[72:75]
  buffer_store_dwordx4 v[80:83], v5, s[8:11], s58 offen sc1
  v_mfma_f32_16x16x32_bf16 v[76:79], v[52:55], a[180:183], v[76:79]
  s_add_u32 s58, s55, 1835008
  v_mfma_f32_16x16x32_bf16 v[72:75], v[32:35], a[184:187], v[72:75]
  s_lshr_b32 s46, s58, 8
  v_mfma_f32_16x16x32_bf16 v[76:79], v[56:59], a[184:187], v[76:79]
  s_and_b32 s46, s46, 0x2000
  v_mfma_f32_16x16x32_bf16 v[72:75], v[36:39], a[188:191], v[72:75]
  s_xor_b32 s58, s58, s46
  v_mfma_f32_16x16x32_bf16 v[76:79], v[60:63], a[188:191], v[76:79]
  v_mfma_f32_16x16x32_bf16 v[64:67], v[16:19], a[192:195], 0
  v_mfma_f32_16x16x32_bf16 v[68:71], v[40:43], a[192:195], 0
  v_mfma_f32_16x16x32_bf16 v[64:67], v[20:23], a[196:199], v[64:67]
  v_cvt_pk_bf16_f32 v84, v72, v73
  v_mfma_f32_16x16x32_bf16 v[68:71], v[44:47], a[196:199], v[68:71]
  v_cvt_pk_bf16_f32 v85, v74, v75
  v_mfma_f32_16x16x32_bf16 v[64:67], v[24:27], a[200:203], v[64:67]
  v_cvt_pk_bf16_f32 v86, v76, v77
  v_mfma_f32_16x16x32_bf16 v[68:71], v[48:51], a[200:203], v[68:71]
  v_cvt_pk_bf16_f32 v87, v78, v79
  v_mfma_f32_16x16x32_bf16 v[64:67], v[28:31], a[204:207], v[64:67]
  buffer_store_dwordx4 v[84:87], v5, s[8:11], s58 offen sc1
  v_mfma_f32_16x16x32_bf16 v[68:71], v[52:55], a[204:207], v[68:71]
  s_add_u32 s58, s55, 2097152
  v_mfma_f32_16x16x32_bf16 v[64:67], v[32:35], a[208:211], v[64:67]
  s_lshr_b32 s46, s58, 8
  v_mfma_f32_16x16x32_bf16 v[68:71], v[56:59], a[208:211], v[68:71]
  s_and_b32 s46, s46, 0x2000
  v_mfma_f32_16x16x32_bf16 v[64:67], v[36:39], a[212:215], v[64:67]
  s_xor_b32 s58, s58, s46
  s_waitcnt vmcnt(5)
  s_barrier
  v_mfma_f32_16x16x32_bf16 v[68:71], v[60:63], a[212:215], v[68:71]
  s_add_u32 s55, s55, 2621440
  v_mfma_f32_16x16x32_bf16 v[72:75], v[16:19], a[216:219], 0
  ds_read_b128 v[16:19], v12 offset:0
  v_mfma_f32_16x16x32_bf16 v[76:79], v[40:43], a[216:219], 0
  ds_read_b128 v[40:43], v12 offset:2048
  v_mfma_f32_16x16x32_bf16 v[72:75], v[20:23], a[220:223], v[72:75]
  ds_read_b128 v[20:23], v12 offset:1024
  v_cvt_pk_bf16_f32 v80, v64, v65
  v_mfma_f32_16x16x32_bf16 v[76:79], v[44:47], a[220:223], v[76:79]
  ds_read_b128 v[44:47], v12 offset:3072
  v_cvt_pk_bf16_f32 v81, v66, v67
  v_mfma_f32_16x16x32_bf16 v[72:75], v[24:27], a[224:227], v[72:75]
  ds_read_b128 v[24:27], v12 offset:4096
  v_cvt_pk_bf16_f32 v82, v68, v69
  v_mfma_f32_16x16x32_bf16 v[76:79], v[48:51], a[224:227], v[76:79]
  ds_read_b128 v[48:51], v12 offset:6144
  v_cvt_pk_bf16_f32 v83, v70, v71
  v_mfma_f32_16x16x32_bf16 v[72:75], v[28:31], a[228:231], v[72:75]
  buffer_store_dwordx4 v[80:83], v5, s[8:11], s58 offen sc1
  ds_read_b128 v[28:31], v12 offset:5120
  v_mfma_f32_16x16x32_bf16 v[76:79], v[52:55], a[228:231], v[76:79]
  ds_read_b128 v[52:55], v12 offset:7168
  s_cmp_ge_u32 s55, 201326592
  s_cselect_b32 s46, 83886080, 0
  v_mfma_f32_16x16x32_bf16 v[72:75], v[32:35], a[232:235], v[72:75]
  ds_read_b128 v[32:35], v12 offset:8192
  s_sub_u32 s55, s55, s46
  v_mfma_f32_16x16x32_bf16 v[76:79], v[56:59], a[232:235], v[76:79]
  ds_read_b128 v[56:59], v12 offset:10240
  s_add_u32 s52, s52, 1
  v_mfma_f32_16x16x32_bf16 v[72:75], v[36:39], a[236:239], v[72:75]
  ds_read_b128 v[36:39], v12 offset:9216
  s_cmp_lt_u32 s52, 64
  v_mfma_f32_16x16x32_bf16 v[76:79], v[60:63], a[236:239], v[76:79]
  ds_read_b128 v[60:63], v12 offset:11264
  s_cbranch_scc1 u_loop
  s_nop 2
  v_cvt_pk_bf16_f32 v84, v72, v73
  v_cvt_pk_bf16_f32 v85, v74, v75
  s_nop 0
  v_cvt_pk_bf16_f32 v86, v76, v77
  v_cvt_pk_bf16_f32 v87, v78, v79
  buffer_store_dwordx4 v[84:87], v5, s[8:11], s59 offen sc1
  v_mov_b32 v8, s52
  s_waitcnt vmcnt(0) lgkmcnt(0)
  buffer_store_dword v8, v7, s[8:11], 0 offen sc1
  s_branch u_done
u_slow:
  s_cmp_ge_u32 s56, s57
  s_cbranch_scc1 wf_done_10
  s_mov_b32 s50, 0
wf_loop_11:
  buffer_load_dword v13, v6, s[8:11], 0 offen sc1
  s_add_u32 s50, s50, 1
  s_cmp_gt_u32 s50, 131072
  s_cbranch_scc1 L_fail
  s_waitcnt vmcnt(0)
  v_readfirstlane_b32 s56, v13
  s_nop 0
  s_cmp_ge_u32 s56, s57
  s_cbranch_scc1 wf_done_10
  s_sleep 2
  s_branch wf_loop_11
wf_done_10:
  s_branch u_back
u_done:
L_parta:
  s_barrier
  s_lshl_b32 s65, s44, 2
  s_add_u32 s65, s65, s43
  s_sub_u32 s65, s65, 4
  s_cmp_ge_u32 s65, 120
  s_cbranch_scc1 pa_att
  s_mov_b32 s4, s18
  s_mov_b32 s5, s19
  s_mov_b32 s6, 2457600
  s_mov_b32 s7, 0x20000
  s_mov_b32 s12, s16
  s_mov_b32 s13, s17
  s_mov_b32 s14, 2621440
  s_mov_b32 s15, 0x20000
  s_mul_i32 s46, s65, 205
  s_lshr_b32 s46, s46, 11
  s_mul_i32 s47, s46, 10
  s_sub_u32 s47, s65, s47
  s_mul_i32 s60, s47, 384
  s_lshl_b32 s67, s47, 6
  s_mov_b32 s63, 75505664
  s_mul_i32 s61, s46, 6
  s_add_u32 s62, s61, 6
  s_mul_i32 s48, s46, 3
  s_add_u32 s49, s48, 31
  s_add_u32 s48, s48, 28
  s_min_u32 s61, s61, s48
  s_min_u32 s62, s62, s49
  s_add_u32 s67, s67, s61
  s_lshl_b32 s64, s65, 7
  s_and_b32 s46, s64, 0x2000
  s_add_u32 s64, s64, s46
  s_add_u32 s64, s64, 13705216
  v_lshrrev_b32 v10, 3, v0
  v_lshrrev_b32 v11, 2, v10
  v_lshlrev_b32 v11, 3, v11
  v_and_b32 v1, 3, v10
  v_add_u32 v1, v1, v11
  s_and_b32 s46, s42, 1
  s_lshl_b32 s46, s46, 2
  s_lshr_b32 s47, s42, 1
  s_lshl_b32 s47, s47, 4
  s_add_u32 s46, s46, s47
  v_add_u32 v1, s46, v1
  v_mul_u32_u24 v1, 3840, v1
  v_lshrrev_b32 v10, 1, v10
  v_bfe_u32 v11, v0, 1, 2
  v_xor_b32 v10, v10, v11
  v_lshlrev_b32 v10, 5, v10
  v_and_b32 v11, 1, v0
  v_lshlrev_b32 v11, 4, v11
  v_add3_u32 v1, v1, v10, v11
  v_lshrrev_b32 v10, 5, v0
  v_lshlrev_b32 v2, 11, v10
  v_bfe_u32 v10, v0, 2, 3
  v_lshl_add_u32 v2, v10, 7, v2
  v_lshrrev_b32 v10, 1, v10
  v_xor_b32 v10, s42, v10
  v_lshl_add_u32 v2, v10, 5, v2
  v_and_b32 v10, 3, v0
  v_lshl_add_u32 v2, v10, 3, v2
  v_add_u32 v3, 0x10000, v2
  v_add_u32 v4, 0x20000, v2
  v_lshrrev_b32 v10, 3, v0
  s_lshl_b32 s46, s42, 3
  v_add_u32 v10, s46, v10
  v_mul_u32_u24 v5, 1280, v10
  v_bfe_u32 v10, v10, 1, 3
  v_and_b32 v11, 7, v0
  v_xor_b32 v10, v10, v11
  v_lshl_add_u32 v5, v10, 4, v5
  v_and_b32 v10, 15, v0
  v_lshlrev_b32 v6, 7, v10
  v_lshrrev_b32 v10, 1, v10
  v_lshrrev_b32 v11, 4, v0
  v_xor_b32 v10, v10, v11
  v_lshl_add_u32 v6, v10, 4, v6
  v_add_u32 v6, 122880, v6
  v_xor_b32 v7, 64, v6
  v_and_b32 v10, 15, v0
  v_lshlrev_b32 v8, 4, v10
  v_bfe_u32 v10, v0, 4, 1
  v_lshlrev_b32 v10, 11, v10
  v_lshrrev_b32 v11, 5, v0
  v_lshlrev_b32 v11, 8, v11
  v_add3_u32 v8, v8, v10, v11
  s_lshl_b32 s46, s42, 9
  v_add_u32 v8, s46, v8
  v_mov_b32 v9, s64
  v_mov_b32 v10, 2146435072
  s_cmp_eq_u32 s42, 0
  s_cselect_b64 vcc, 1, 0
  v_cndmask_b32 v9, v10, v9, vcc
  s_lshl_b32 s46, s43, 7
  s_add_u32 s46, s46, 13662720
  v_mov_b32 v14, s46
  s_mov_b32 s68, 0
  s_lshr_b32 s70, s44, 5
  s_add_u32 s70, s70, 4
  s_mov_b32 s52, s61
  s_mul_i32 s53, s52, 40960
  s_add_u32 s54, s51, 122880
  s_add_u32 m0, s54, 0
  s_nop 0
  buffer_load_dwordx4 v5, s[12:15], s53 offen offset:0 lds
  s_add_u32 m0, s54, 3968
  s_nop 0
  buffer_load_dwordx4 v5, s[12:15], s53 offen offset:128 lds
  s_add_u32 m0, s54, 7936
  s_nop 0
  buffer_load_dwordx4 v5, s[12:15], s53 offen offset:256 lds
  s_add_u32 m0, s54, 11904
  s_nop 0
  buffer_load_dwordx4 v5, s[12:15], s53 offen offset:384 lds
  s_add_u32 m0, s54, 15872
  s_nop 0
  buffer_load_dwordx4 v5, s[12:15], s53 offen offset:512 lds
  s_add_u32 m0, s54, 19840
  s_nop 0
  buffer_load_dwordx4 v5, s[12:15], s53 offen offset:640 lds
  s_add_u32 m0, s54, 23808
  s_nop 0
  buffer_load_dwordx4 v5, s[12:15], s53 offen offset:768 lds
  s_add_u32 m0, s54, 27776
  s_nop 0
  buffer_load_dwordx4 v5, s[12:15], s53 offen offset:896 lds
  s_add_u32 m0, s54, 31744
  s_nop 0
  buffer_load_dwordx4 v5, s[12:15], s53 offen offset:1024 lds
  s_add_u32 m0, s54, 35712
  s_nop 0
  buffer_load_dwordx4 v5, s[12:15], s53 offen offset:1152 lds
  s_add_u32 m0, s51, 0
  s_add_u32 s46, s60, 0
  buffer_load_dwordx4 v1, s[4:7], s46 offen  lds
  s_add_u32 m0, s51, 4096
  s_add_u32 s46, s60, 128
  buffer_load_dwordx4 v1, s[4:7], s46 offen  lds
  s_add_u32 m0, s51, 8192
  s_add_u32 s46, s60, 256
  buffer_load_dwordx4 v1, s[4:7], s46 offen  lds
  s_add_u32 m0, s51, 12288
  s_add_u32 s46, s60, 122880
  buffer_load_dwordx4 v1, s[4:7], s46 offen  lds
  s_add_u32 m0, s51, 16384
  s_add_u32 s46, s60, 123008
  buffer_load_dwordx4 v1, s[4:7], s46 offen  lds
  s_add_u32 m0, s51, 20480
  s_add_u32 s46, s60, 123136
  buffer_load_dwordx4 v1, s[4:7], s46 offen  lds
  s_add_u32 m0, s51, 24576
  s_add_u32 s46, s60, 245760
  buffer_load_dwordx4 v1, s[4:7], s46 offen  lds
  s_add_u32 m0, s51, 28672
  s_add_u32 s46, s60, 245888
  buffer_load_dwordx4 v1, s[4:7], s46 offen  lds
  s_add_u32 m0, s51, 32768
  s_add_u32 s46, s60, 246016
  buffer_load_dwordx4 v1, s[4:7], s46 offen  lds
  s_add_u32 m0, s51, 36864
  s_add_u32 s46, s60, 368640
  buffer_load_dwordx4 v1, s[4:7], s46 offen  lds
  s_add_u32 m0, s51, 40960
  s_add_u32 s46, s60, 368768
  buffer_load_dwordx4 v1, s[4:7], s46 offen  lds
  s_add_u32 m0, s51, 45056
  s_add_u32 s46, s60, 368896
  buffer_load_dwordx4 v1, s[4:7], s46 offen  lds
  s_add_u32 m0, s51, 49152
  s_add_u32 s46, s60, 491520
  buffer_load_dwordx4 v1, s[4:7], s46 offen  lds
  s_add_u32 m0, s51, 53248
  s_add_u32 s46, s60, 491648
  buffer_load_dwordx4 v1, s[4:7], s46 offen  lds
  s_add_u32 m0, s51, 57344
  s_add_u32 s46, s60, 491776
  buffer_load_dwordx4 v1, s[4:7], s46 offen  lds
  s_add_u32 m0, s51, 61440
  s_add_u32 s46, s60, 614400
  buffer_load_dwordx4 v1, s[4:7], s46 offen  lds
  s_add_u32 m0, s51, 65536
  s_add_u32 s46, s60, 614528
  buffer_load_dwordx4 v1, s[4:7], s46 offen  lds
  s_add_u32 m0, s51, 69632
  s_add_u32 s46, s60, 614656
  buffer_load_dwordx4 v1, s[4:7], s46 offen  lds
  s_add_u32 m0, s51, 73728
  s_add_u32 s46, s60, 737280
  buffer_load_dwordx4 v1, s[4:7], s46 offen  lds
  s_add_u32 m0, s51, 77824
  s_add_u32 s46, s60, 737408
  buffer_load_dwordx4 v1, s[4:7], s46 offen  lds
  s_add_u32 m0, s51, 81920
  s_add_u32 s46, s60, 737536
  buffer_load_dwordx4 v1, s[4:7], s46 offen  lds
  s_add_u32 m0, s51, 86016
  s_add_u32 s46, s60, 860160
  buffer_load_dwordx4 v1, s[4:7], s46 offen  lds
  s_add_u32 m0, s51, 90112
  s_add_u32 s46, s60, 860288
  buffer_load_dwordx4 v1, s[4:7], s46 offen  lds
  s_add_u32 m0, s51, 94208
  s_add_u32 s46, s60, 860416
  buffer_load_dwordx4 v1, s[4:7], s46 offen  lds
  s_waitcnt vmcnt(18)
  s_barrier
  s_add_u32 m0, s51, 98304
  s_add_u32 s46, s60, 983040
  buffer_load_dwordx4 v1, s[4:7], s46 offen  lds
  s_add_u32 m0, s51, 102400
  s_add_u32 s46, s60, 983168
  buffer_load_dwordx4 v1, s[4:7], s46 offen  lds
  s_add_u32 m0, s51, 106496
  s_add_u32 s46, s60, 983296
  buffer_load_dwordx4 v1, s[4:7], s46 offen  lds
  s_add_u32 m0, s51, 110592
  s_add_u32 s46, s60, 1105920
  buffer_load_dwordx4 v1, s[4:7], s46 offen  lds
  s_add_u32 m0, s51, 114688
  s_add_u32 s46, s60, 1106048
  buffer_load_dwordx4 v1, s[4:7], s46 offen  lds
  s_add_u32 m0, s51, 118784
  s_add_u32 s46, s60, 1106176
  buffer_load_dwordx4 v1, s[4:7], s46 offen  lds
  ds_read_b64_tr_b16 a[0:1], v2 offset:0
  ds_read_b64_tr_b16 a[2:3], v2 offset:1024
  ds_read_b64_tr_b16 a[4:5], v2 offset:4096
  ds_read_b64_tr_b16 a[6:7], v2 offset:5120
  ds_read_b64_tr_b16 a[8:9], v2 offset:8192
  ds_read_b64_tr_b16 a[10:11], v2 offset:9216
  ds_read_b64_tr_b16 a[12:13], v2 offset:12288
  ds_read_b64_tr_b16 a[14:15], v2 offset:13312
  ds_read_b64_tr_b16 a[16:17], v2 offset:16384
  ds_read_b64_tr_b16 a[18:19], v2 offset:17408
  ds_read_b64_tr_b16 a[20:21], v2 offset:20480
  ds_read_b64_tr_b16 a[22:23], v2 offset:21504
  s_waitcnt lgkmcnt(0)
  s_waitcnt vmcnt(18)
  s_barrier
  s_add_u32 m0, s51, 0
  s_add_u32 s46, s60, 1228800
  buffer_load_dwordx4 v1, s[4:7], s46 offen  lds
  s_add_u32 m0, s51, 4096
  s_add_u32 s46, s60, 1228928
  buffer_load_dwordx4 v1, s[4:7], s46 offen  lds
  s_add_u32 m0, s51, 8192
  s_add_u32 s46, s60, 1229056
  buffer_load_dwordx4 v1, s[4:7], s46 offen  lds
  s_add_u32 m0, s51, 12288
  s_add_u32 s46, s60, 1351680
  buffer_load_dwordx4 v1, s[4:7], s46 offen  lds
  s_add_u32 m0, s51, 16384
  s_add_u32 s46, s60, 1351808
  buffer_load_dwordx4 v1, s[4:7], s46 offen  lds
  s_add_u32 m0, s51, 20480
  s_add_u32 s46, s60, 1351936
  buffer_load_dwordx4 v1, s[4:7], s46 offen  lds
  ds_read_b64_tr_b16 a[24:25], v2 offset:24576
  ds_read_b64_tr_b16 a[26:27], v2 offset:25600
  ds_read_b64_tr_b16 a[28:29], v2 offset:28672
  ds_read_b64_tr_b16 a[30:31], v2 offset:29696
  ds_read_b64_tr_b16 a[32:33], v2 offset:32768
  ds_read_b64_tr_b16 a[34:35], v2 offset:33792
  ds_read_b64_tr_b16 a[36:37], v2 offset:36864
  ds_read_b64_tr_b16 a[38:39], v2 offset:37888
  ds_read_b64_tr_b16 a[40:41], v2 offset:40960
  ds_read_b64_tr_b16 a[42:43], v2 offset:41984
  ds_read_b64_tr_b16 a[44:45], v2 offset:45056
  ds_read_b64_tr_b16 a[46:47], v2 offset:46080
  s_waitcnt lgkmcnt(0)
  s_waitcnt vmcnt(18)
  s_barrier
  s_add_u32 m0, s51, 24576
  s_add_u32 s46, s60, 1474560
  buffer_load_dwordx4 v1, s[4:7], s46 offen  lds
  s_add_u32 m0, s51, 28672
  s_add_u32 s46, s60, 1474688
  buffer_load_dwordx4 v1, s[4:7], s46 offen  lds
  s_add_u32 m0, s51, 32768
  s_add_u32 s46, s60, 1474816
  buffer_load_dwordx4 v1, s[4:7], s46 offen  lds
  s_add_u32 m0, s51, 36864
  s_add_u32 s46, s60, 1597440
  buffer_load_dwordx4 v1, s[4:7], s46 offen  lds
  s_add_u32 m0, s51, 40960
  s_add_u32 s46, s60, 1597568
  buffer_load_dwordx4 v1, s[4:7], s46 offen  lds
  s_add_u32 m0, s51, 45056
  s_add_u32 s46, s60, 1597696
  buffer_load_dwordx4 v1, s[4:7], s46 offen  lds
  ds_read_b64_tr_b16 a[48:49], v2 offset:49152
  ds_read_b64_tr_b16 a[50:51], v2 offset:50176
  ds_read_b64_tr_b16 a[52:53], v2 offset:53248
  ds_read_b64_tr_b16 a[54:55], v2 offset:54272
  ds_read_b64_tr_b16 a[56:57], v2 offset:57344
  ds_read_b64_tr_b16 a[58:59], v2 offset:58368
  ds_read_b64_tr_b16 a[60:61], v2 offset:61440
  ds_read_b64_tr_b16 a[62:63], v2 offset:62464
  ds_read_b64_tr_b16 a[64:65], v3 offset:0
  ds_read_b64_tr_b16 a[66:67], v3 offset:1024
  ds_read_b64_tr_b16 a[68:69], v3 offset:4096
  ds_read_b64_tr_b16 a[70:71], v3 offset:5120
  s_waitcnt lgkmcnt(0)
  s_waitcnt vmcnt(18)
  s_barrier
  s_add_u32 m0, s51, 49152
  s_add_u32 s46, s60, 1720320
  buffer_load_dwordx4 v1, s[4:7], s46 offen  lds
  s_add_u32 m0, s51, 53248
  s_add_u32 s46, s60, 1720448
  buffer_load_dwordx4 v1, s[4:7], s46 offen  lds
  s_add_u32 m0, s51, 57344
  s_add_u32 s46, s60, 1720576
  buffer_load_dwordx4 v1, s[4:7], s46 offen  lds
  s_add_u32 m0, s51, 61440
  s_add_u32 s46, s60, 1843200
  buffer_load_dwordx4 v1, s[4:7], s46 offen  lds
  s_add_u32 m0, s51, 65536
  s_add_u32 s46, s60, 1843328
  buffer_load_dwordx4 v1, s[4:7], s46 offen  lds
  s_add_u32 m0, s51, 69632
  s_add_u32 s46, s60, 1843456
  buffer_load_dwordx4 v1, s[4:7], s46 offen  lds
  ds_read_b64_tr_b16 a[72:73], v3 offset:8192
  ds_read_b64_tr_b16 a[74:75], v3 offset:9216
  ds_read_b64_tr_b16 a[76:77], v3 offset:12288
  ds_read_b64_tr_b16 a[78:79], v3 offset:13312
  ds_read_b64_tr_b16 a[80:81], v3 offset:16384
  ds_read_b64_tr_b16 a[82:83], v3 offset:17408
  ds_read_b64_tr_b16 a[84:85], v3 offset:20480
  ds_read_b64_tr_b16 a[86:87], v3 offset:21504
  ds_read_b64_tr_b16 a[88:89], v3 offset:24576
  ds_read_b64_tr_b16 a[90:91], v3 offset:25600
  ds_read_b64_tr_b16 a[92:93], v3 offset:28672
  ds_read_b64_tr_b16 a[94:95], v3 offset:29696
  s_waitcnt lgkmcnt(0)
  s_waitcnt vmcnt(18)
  s_barrier
  s_add_u32 m0, s51, 73728
  s_add_u32 s46, s60, 1966080
  buffer_load_dwordx4 v1, s[4:7], s46 offen  lds
  s_add_u32 m0, s51, 77824
  s_add_u32 s46, s60, 1966208
  buffer_load_dwordx4 v1, s[4:7], s46 offen  lds
  s_add_u32 m0, s51, 81920
  s_add_u32 s46, s60, 1966336
  buffer_load_dwordx4 v1, s[4:7], s46 offen  lds
  s_add_u32 m0, s51, 86016
  s_add_u32 s46, s60, 2088960
  buffer_load_dwordx4 v1, s[4:7], s46 offen  lds
  s_add_u32 m0, s51, 90112
  s_add_u32 s46, s60, 2089088
  buffer_load_dwordx4 v1, s[4:7], s46 offen  lds
  s_add_u32 m0, s51, 94208
  s_add_u32 s46, s60, 2089216
  buffer_load_dwordx4 v1, s[4:7], s46 offen  lds
  ds_read_b64_tr_b16 a[96:97], v3 offset:32768
  ds_read_b64_tr_b16 a[98:99], v3 offset:33792
  ds_read_b64_tr_b16 a[100:101], v3 offset:36864
  ds_read_b64_tr_b16 a[102:103], v3 offset:37888
  ds_read_b64_tr_b16 a[104:105], v3 offset:40960
  ds_read_b64_tr_b16 a[106:107], v3 offset:41984
  ds_read_b64_tr_b16 a[108:109], v3 offset:45056
  ds_read_b64_tr_b16 a[110:111], v3 offset:46080
  ds_read_b64_tr_b16 a[112:113], v3 offset:49152
  ds_read_b64_tr_b16 a[114:115], v3 offset:50176
  ds_read_b64_tr_b16 a[116:117], v3 offset:53248
  ds_read_b64_tr_b16 a[118:119], v3 offset:54272
  s_waitcnt lgkmcnt(0)
  s_waitcnt vmcnt(18)
  s_barrier
  s_add_u32 m0, s51, 98304
  s_add_u32 s46, s60, 2211840
  buffer_load_dwordx4 v1, s[4:7], s46 offen  lds
  s_add_u32 m0, s51, 102400
  s_add_u32 s46, s60, 2211968
  buffer_load_dwordx4 v1, s[4:7], s46 offen  lds
  s_add_u32 m0, s51, 106496
  s_add_u32 s46, s60, 2212096
  buffer_load_dwordx4 v1, s[4:7], s46 offen  lds
  s_add_u32 m0, s51, 110592
  s_add_u32 s46, s60, 2334720
  buffer_load_dwordx4 v1, s[4:7], s46 offen  lds
  s_add_u32 m0, s51, 114688
  s_add_u32 s46, s60, 2334848
  buffer_load_dwordx4 v1, s[4:7], s46 offen  lds
  s_add_u32 m0, s51, 118784
  s_add_u32 s46, s60, 2334976
  buffer_load_dwordx4 v1, s[4:7], s46 offen  lds
  ds_read_b64_tr_b16 a[120:121], v2 offset:0
  ds_read_b64_tr_b16 a[122:123], v2 offset:1024
  ds_read_b64_tr_b16 a[124:125], v2 offset:4096
  ds_read_b64_tr_b16 a[126:127], v2 offset:5120
  ds_read_b64_tr_b16 a[128:129], v2 offset:8192
  ds_read_b64_tr_b16 a[130:131], v2 offset:9216
  ds_read_b64_tr_b16 a[132:133], v2 offset:12288
  ds_read_b64_tr_b16 a[134:135], v2 offset:13312
  ds_read_b64_tr_b16 a[136:137], v2 offset:16384
  ds_read_b64_tr_b16 a[138:139], v2 offset:17408
  ds_read_b64_tr_b16 a[140:141], v2 offset:20480
  ds_read_b64_tr_b16 a[142:143], v2 offset:21504
  s_waitcnt lgkmcnt(0)
  s_waitcnt vmcnt(18)
  s_barrier
  ds_read_b64_tr_b16 a[144:145], v2 offset:24576
  ds_read_b64_tr_b16 a[146:147], v2 offset:25600
  ds_read_b64_tr_b16 a[148:149], v2 offset:28672
  ds_read_b64_tr_b16 a[150:151], v2 offset:29696
  ds_read_b64_tr_b16 a[152:153], v2 offset:32768
  ds_read_b64_tr_b16 a[154:155], v2 offset:33792
  ds_read_b64_tr_b16 a[156:157], v2 offset:36864
  ds_read_b64_tr_b16 a[158:159], v2 offset:37888
  ds_read_b64_tr_b16 a[160:161], v2 offset:40960
  ds_read_b64_tr_b16 a[162:163], v2 offset:41984
  ds_read_b64_tr_b16 a[164:165], v2 offset:45056
  ds_read_b64_tr_b16 a[166:167], v2 offset:46080
  s_waitcnt lgkmcnt(0)
  s_waitcnt vmcnt(12)
  s_barrier
  ds_read_b64_tr_b16 a[168:169], v2 offset:49152
  ds_read_b64_tr_b16 a[170:171], v2 offset:50176
  ds_read_b64_tr_b16 a[172:173], v2 offset:53248
  ds_read_b64_tr_b16 a[174:175], v2 offset:54272
  ds_read_b64_tr_b16 a[176:177], v2 offset:57344
  ds_read_b64_tr_b16 a[178:179], v2 offset:58368
  ds_read_b64_tr_b16 a[180:181], v2 offset:61440
  ds_read_b64_tr_b16 a[182:183], v2 offset:62464
  ds_read_b64_tr_b16 a[184:185], v3 offset:0
  ds_read_b64_tr_b16 a[186:187], v3 offset:1024
  ds_read_b64_tr_b16 a[188:189], v3 offset:4096
  ds_read_b64_tr_b16 a[190:191], v3 offset:5120
  s_waitcnt lgkmcnt(0)
  s_waitcnt vmcnt(6)
  s_barrier
  ds_read_b64_tr_b16 a[192:193], v3 offset:8192
  ds_read_b64_tr_b16 a[194:195], v3 offset:9216
  ds_read_b64_tr_b16 a[196:197], v3 offset:12288
  ds_read_b64_tr_b16 a[198:199], v3 offset:13312
  ds_read_b64_tr_b16 a[200:201], v3 offset:16384
  ds_read_b64_tr_b16 a[202:203], v3 offset:17408
  ds_read_b64_tr_b16 a[204:205], v3 offset:20480
  ds_read_b64_tr_b16 a[206:207], v3 offset:21504
  ds_read_b64_tr_b16 a[208:209], v3 offset:24576
  ds_read_b64_tr_b16 a[210:211], v3 offset:25600
  ds_read_b64_tr_b16 a[212:213], v3 offset:28672
  ds_read_b64_tr_b16 a[214:215], v3 offset:29696
  s_waitcnt lgkmcnt(0)
  s_waitcnt vmcnt(0)
  s_barrier
  ds_read_b64_tr_b16 a[216:217], v3 offset:32768
  ds_read_b64_tr_b16 a[218:219], v3 offset:33792
  ds_read_b64_tr_b16 a[220:221], v3 offset:36864
  ds_read_b64_tr_b16 a[222:223], v3 offset:37888
  ds_read_b64_tr_b16 a[224:225], v3 offset:40960
  ds_read_b64_tr_b16 a[226:227], v3 offset:41984
  ds_read_b64_tr_b16 a[228:229], v3 offset:45056
  ds_read_b64_tr_b16 a[230:231], v3 offset:46080
  ds_read_b64_tr_b16 a[232:233], v3 offset:49152
  ds_read_b64_tr_b16 a[234:235], v3 offset:50176
  ds_read_b64_tr_b16 a[236:237], v3 offset:53248
  ds_read_b64_tr_b16 a[238:239], v3 offset:54272
  s_waitcnt lgkmcnt(0)
  s_barrier
  s_mov_b32 s54, s51
  s_add_u32 s53, s53, 40960
  s_add_u32 m0, s54, 0
  s_nop 0
  buffer_load_dwordx4 v5, s[12:15], s53 offen offset:0 lds
  s_add_u32 m0, s54, 3968
  s_nop 0
  buffer_load_dwordx4 v5, s[12:15], s53 offen offset:128 lds
  s_add_u32 m0, s54, 7936
  s_nop 0
  buffer_load_dwordx4 v5, s[12:15], s53 offen offset:256 lds
  s_add_u32 m0, s54, 11904
  s_nop 0
  buffer_load_dwordx4 v5, s[12:15], s53 offen offset:384 lds
  s_add_u32 m0, s54, 15872
  s_nop 0
  buffer_load_dwordx4 v5, s[12:15], s53 offen offset:512 lds
  s_add_u32 m0, s54, 19840
  s_nop 0
  buffer_load_dwordx4 v5, s[12:15], s53 offen offset:640 lds
  s_add_u32 m0, s54, 23808
  s_nop 0
  buffer_load_dwordx4 v5, s[12:15], s53 offen offset:768 lds
  s_add_u32 m0, s54, 27776
  s_nop 0
  buffer_load_dwordx4 v5, s[12:15], s53 offen offset:896 lds
  s_add_u32 m0, s54, 31744
  s_nop 0
  buffer_load_dwordx4 v5, s[12:15], s53 offen offset:1024 lds
  s_add_u32 m0, s54, 35712
  s_nop 0
  buffer_load_dwordx4 v5, s[12:15], s53 offen offset:1152 lds
  s_mov_b32 s55, 2146435072
  s_mov_b32 s56, 2146435072
  s_mov_b32 s57, 2146435072
  s_xor_b32 s63, s63, s3
  v_xor_b32 v9, s3, v9
  v_xor_b32 v14, s3, v14
  s_mov_b32 s58, 122880
  ds_read_b128 v[16:19], v6 offset:0
  ds_read_b128 v[20:23], v7 offset:0
  ds_read_b128 v[24:27], v6 offset:4096
  ds_read_b128 v[28:31], v7 offset:4096
  s_waitcnt lgkmcnt(3)
pa_loop_12:
  v_mfma_f32_16x16x32_bf16 v[40:43], a[0:3], v[16:19], 0
  ds_read_b128 v[32:35], v6 offset:8192
  v_mfma_f32_16x16x32_bf16 v[48:51], a[4:7], v[16:19], 0
  v_mfma_f32_16x16x32_bf16 v[56:59], a[8:11], v[16:19], 0
  s_waitcnt lgkmcnt(3)
  v_cvt_pk_bf16_f32 v66, v44, v45
  v_mfma_f32_16x16x32_bf16 v[40:43], a[12:15], v[20:23], v[40:43]
  ds_read_b128 v[16:19], v7 offset:8192
  v_cvt_pk_bf16_f32 v67, v46, v47
  v_mfma_f32_16x16x32_bf16 v[48:51], a[16:19], v[20:23], v[48:51]
  v_cvt_pk_bf16_f32 v70, v52, v53
  v_mfma_f32_16x16x32_bf16 v[56:59], a[20:23], v[20:23], v[56:59]
  s_waitcnt lgkmcnt(3)
  v_cvt_pk_bf16_f32 v71, v54, v55
  v_mfma_f32_16x16x32_bf16 v[40:43], a[24:27], v[24:27], v[40:43]
  ds_read_b128 v[20:23], v6 offset:12288
  v_cvt_pk_bf16_f32 v74, v60, v61
  v_mfma_f32_16x16x32_bf16 v[48:51], a[28:31], v[24:27], v[48:51]
  v_cvt_pk_bf16_f32 v75, v62, v63
  v_mfma_f32_16x16x32_bf16 v[56:59], a[32:35], v[24:27], v[56:59]
  s_waitcnt lgkmcnt(3)
  v_mfma_f32_16x16x32_bf16 v[40:43], a[36:39], v[28:31], v[40:43]
  ds_read_b128 v[24:27], v7 offset:12288
  v_permlane16_swap_b32 v64, v66
  v_mfma_f32_16x16x32_bf16 v[48:51], a[40:43], v[28:31], v[48:51]
  v_permlane16_swap_b32 v65, v67
  v_mfma_f32_16x16x32_bf16 v[56:59], a[44:47], v[28:31], v[56:59]
  buffer_store_dwordx4 v[64:67], v8, s[8:11], s55 offen sc1
  s_waitcnt lgkmcnt(3)
  v_mfma_f32_16x16x32_bf16 v[40:43], a[48:51], v[32:35], v[40:43]
  ds_read_b128 v[28:31], v6 offset:16384
  v_permlane16_swap_b32 v68, v70
  v_mfma_f32_16x16x32_bf16 v[48:51], a[52:55], v[32:35], v[48:51]
  v_permlane16_swap_b32 v69, v71
  v_mfma_f32_16x16x32_bf16 v[56:59], a[56:59], v[32:35], v[56:59]
  buffer_store_dwordx4 v[68:71], v8, s[8:11], s56 offen sc1
  s_waitcnt lgkmcnt(3)
  v_mfma_f32_16x16x32_bf16 v[40:43], a[60:63], v[16:19], v[40:43]
  ds_read_b128 v[32:35], v7 offset:16384
  v_permlane16_swap_b32 v72, v74
  v_mfma_f32_16x16x32_bf16 v[48:51], a[64:67], v[16:19], v[48:51]
  v_permlane16_swap_b32 v73, v75
  v_mfma_f32_16x16x32_bf16 v[56:59], a[68:71], v[16:19], v[56:59]
  buffer_store_dwordx4 v[72:75], v8, s[8:11], s57 offen sc1
  s_waitcnt lgkmcnt(3)
  v_mfma_f32_16x16x32_bf16 v[40:43], a[72:75], v[20:23], v[40:43]
  ds_read_b128 v[16:19], v6 offset:20480
  v_mfma_f32_16x16x32_bf16 v[48:51], a[76:79], v[20:23], v[48:51]
  v_mfma_f32_16x16x32_bf16 v[56:59], a[80:83], v[20:23], v[56:59]
  s_waitcnt lgkmcnt(3)
  v_mfma_f32_16x16x32_bf16 v[40:43], a[84:87], v[24:27], v[40:43]
  ds_read_b128 v[20:23], v7 offset:20480
  v_mfma_f32_16x16x32_bf16 v[48:51], a[88:91], v[24:27], v[48:51]
  v_mov_b32 v10, s52
  v_mfma_f32_16x16x32_bf16 v[56:59], a[92:95], v[24:27], v[56:59]
  s_waitcnt lgkmcnt(3)
  v_mfma_f32_16x16x32_bf16 v[40:43], a[96:99], v[28:31], v[40:43]
  ds_read_b128 v[24:27], v6 offset:24576
  v_mfma_f32_16x16x32_bf16 v[48:51], a[100:103], v[28:31], v[48:51]
  s_add_u32 s53, s53, 40960
  s_add_u32 s54, s54, 40960
  v_mfma_f32_16x16x32_bf16 v[56:59], a[104:107], v[28:31], v[56:59]
  s_waitcnt lgkmcnt(3)
  v_mfma_f32_16x16x32_bf16 v[40:43], a[108:111], v[32:35], v[40:43]
  ds_read_b128 v[28:31], v7 offset:24576
  v_mfma_f32_16x16x32_bf16 v[48:51], a[112:115], v[32:35], v[48:51]
  s_cmp_ge_u32 s54, 163840
  s_cselect_b32 s54, s51, s54
  v_mfma_f32_16x16x32_bf16 v[56:59], a[116:119], v[32:35], v[56:59]
  s_waitcnt lgkmcnt(3)
  v_mfma_f32_16x16x32_bf16 v[40:43], a[120:123], v[16:19], v[40:43]
  ds_read_b128 v[32:35], v6 offset:28672
  v_mfma_f32_16x16x32_bf16 v[48:51], a[124:127], v[16:19], v[48:51]
  s_cmp_eq_u32 s58, 122880
  s_cselect_b32 s59, 163840, 0
  v_mfma_f32_16x16x32_bf16 v[56:59], a[128:131], v[16:19], v[56:59]
  s_waitcnt lgkmcnt(3)
  v_mfma_f32_16x16x32_bf16 v[40:43], a[132:135], v[20:23], v[40:43]
  ds_read_b128 v[16:19], v7 offset:28672
  v_mfma_f32_16x16x32_bf16 v[48:51], a[136:139], v[20:23], v[48:51]
  s_sub_u32 s59, 40960, s59
  s_add_u32 s58, s58, s59
  v_mfma_f32_16x16x32_bf16 v[56:59], a[140:143], v[20:23], v[56:59]
  s_waitcnt lgkmcnt(3)
  v_mfma_f32_16x16x32_bf16 v[40:43], a[144:147], v[24:27], v[40:43]
  ds_read_b128 v[20:23], v6 offset:32768
  v_mfma_f32_16x16x32_bf16 v[48:51], a[148:151], v[24:27], v[48:51]
  s_lshr_b32 s55, s67, 1
  v_mfma_f32_16x16x32_bf16 v[56:59], a[152:155], v[24:27], v[56:59]
  s_lshl_b32 s55, s55, 14
  s_waitcnt lgkmcnt(3)
  v_mfma_f32_16x16x32_bf16 v[40:43], a[156:159], v[28:31], v[40:43]
  ds_read_b128 v[24:27], v7 offset:32768
  v_mfma_f32_16x16x32_bf16 v[48:51], a[160:163], v[28:31], v[48:51]
  s_and_b32 s56, s67, 1
  v_mfma_f32_16x16x32_bf16 v[56:59], a[164:167], v[28:31], v[56:59]
  s_lshl_b32 s56, s56, 12
  s_waitcnt lgkmcnt(3)
  v_mfma_f32_16x16x32_bf16 v[40:43], a[168:171], v[32:35], v[40:43]
  ds_read_b128 v[28:31], v6 offset:36864
  v_mfma_f32_16x16x32_bf16 v[48:51], a[172:175], v[32:35], v[48:51]
  s_add_u32 s55, s55, s56
  v_mfma_f32_16x16x32_bf16 v[56:59], a[176:179], v[32:35], v[56:59]
  s_add_u32 s55, s55, s63
  s_waitcnt lgkmcnt(3)
  v_mfma_f32_16x16x32_bf16 v[40:43], a[180:183], v[16:19], v[40:43]
  ds_read_b128 v[32:35], v7 offset:36864
  v_mfma_f32_16x16x32_bf16 v[48:51], a[184:187], v[16:19], v[48:51]
  s_lshr_b32 s56, s55, 8
  v_mfma_f32_16x16x32_bf16 v[56:59], a[188:191], v[16:19], v[56:59]
  s_and_b32 s56, s56, 0x2000
  s_waitcnt lgkmcnt(3)
  v_mfma_f32_16x16x32_bf16 v[40:43], a[192:195], v[20:23], v[40:43]
  ds_read_b128 v[16:19], v6 offset:2048
  v_mfma_f32_16x16x32_bf16 v[48:51], a[196:199], v[20:23], v[48:51]
  s_xor_b32 s55, s55, s56
  v_mfma_f32_16x16x32_bf16 v[56:59], a[200:203], v[20:23], v[56:59]
  s_add_u32 s67, s67, 1
  s_waitcnt lgkmcnt(3)
  v_mfma_f32_16x16x32_bf16 v[40:43], a[204:207], v[24:27], v[40:43]
  ds_read_b128 v[20:23], v7 offset:2048
  v_mfma_f32_16x16x32_bf16 v[48:51], a[208:211], v[24:27], v[48:51]
  s_add_u32 s56, s55, 16777216
  v_mfma_f32_16x16x32_bf16 v[56:59], a[212:215], v[24:27], v[56:59]
  s_add_u32 s57, s55, 33554432
  s_waitcnt lgkmcnt(3)
  v_mfma_f32_16x16x32_bf16 v[40:43], a[216:219], v[28:31], v[40:43]
  ds_read_b128 v[24:27], v6 offset:6144
  v_mfma_f32_16x16x32_bf16 v[48:51], a[220:223], v[28:31], v[48:51]
  v_mfma_f32_16x16x32_bf16 v[56:59], a[224:227], v[28:31], v[56:59]
  s_waitcnt lgkmcnt(3)
  v_mfma_f32_16x16x32_bf16 v[40:43], a[228:231], v[32:35], v[40:43]
  ds_read_b128 v[28:31], v7 offset:6144
  v_mfma_f32_16x16x32_bf16 v[48:51], a[232:235], v[32:35], v[48:51]
  v_mfma_f32_16x16x32_bf16 v[56:59], a[236:239], v[32:35], v[56:59]
  s_waitcnt lgkmcnt(3)
  v_mfma_f32_16x16x32_bf16 v[44:47], a[0:3], v[16:19], 0
  ds_read_b128 v[32:35], v6 offset:10240
  v_mfma_f32_16x16x32_bf16 v[52:55], a[4:7], v[16:19], 0
  v_mfma_f32_16x16x32_bf16 v[60:63], a[8:11], v[16:19], 0
  s_waitcnt lgkmcnt(3)
  v_cvt_pk_bf16_f32 v64, v40, v41
  v_mfma_f32_16x16x32_bf16 v[44:47], a[12:15], v[20:23], v[44:47]
  ds_read_b128 v[16:19], v7 offset:10240
  v_cvt_pk_bf16_f32 v65, v42, v43
  v_mfma_f32_16x16x32_bf16 v[52:55], a[16:19], v[20:23], v[52:55]
  v_cvt_pk_bf16_f32 v68, v48, v49
  v_mfma_f32_16x16x32_bf16 v[60:63], a[20:23], v[20:23], v[60:63]
  s_waitcnt lgkmcnt(3)
  v_cvt_pk_bf16_f32 v69, v50, v51
  v_mfma_f32_16x16x32_bf16 v[44:47], a[24:27], v[24:27], v[44:47]
  ds_read_b128 v[20:23], v6 offset:14336
  v_cvt_pk_bf16_f32 v72, v56, v57
  v_mfma_f32_16x16x32_bf16 v[52:55], a[28:31], v[24:27], v[52:55]
  v_cvt_pk_bf16_f32 v73, v58, v59
  v_mfma_f32_16x16x32_bf16 v[60:63], a[32:35], v[24:27], v[60:63]
  s_waitcnt lgkmcnt(3)
  v_mfma_f32_16x16x32_bf16 v[44:47], a[36:39], v[28:31], v[44:47]
  ds_read_b128 v[24:27], v7 offset:14336
  v_mfma_f32_16x16x32_bf16 v[52:55], a[40:43], v[28:31], v[52:55]
  s_waitcnt vmcnt(0)
  s_barrier
  v_mfma_f32_16x16x32_bf16 v[60:63], a[44:47], v[28:31], v[60:63]
  buffer_store_dword v10, v9, s[8:11], 0 offen sc1
  s_waitcnt lgkmcnt(3)
  v_mfma_f32_16x16x32_bf16 v[44:47], a[48:51], v[32:35], v[44:47]
  ds_read_b128 v[28:31], v6 offset:18432
  s_add_u32 m0, s54, 0
  v_mfma_f32_16x16x32_bf16 v[52:55], a[52:55], v[32:35], v[52:55]
  buffer_load_dwordx4 v5, s[12:15], s53 offen offset:0 lds
  v_mfma_f32_16x16x32_bf16 v[60:63], a[56:59], v[32:35], v[60:63]
  s_waitcnt lgkmcnt(3)
  v_mfma_f32_16x16x32_bf16 v[44:47], a[60:63], v[16:19], v[44:47]
  ds_read_b128 v[32:35], v7 offset:18432
  s_add_u32 m0, s54, 3968
  v_mfma_f32_16x16x32_bf16 v[52:55], a[64:67], v[16:19], v[52:55]
  buffer_load_dwordx4 v5, s[12:15], s53 offen offset:128 lds
  v_mfma_f32_16x16x32_bf16 v[60:63], a[68:71], v[16:19], v[60:63]
  s_waitcnt lgkmcnt(3)
  v_mfma_f32_16x16x32_bf16 v[44:47], a[72:75], v[20:23], v[44:47]
  ds_read_b128 v[16:19], v6 offset:22528
  s_add_u32 m0, s54, 7936
  v_mfma_f32_16x16x32_bf16 v[52:55], a[76:79], v[20:23], v[52:55]
  buffer_load_dwordx4 v5, s[12:15], s53 offen offset:256 lds
  v_mfma_f32_16x16x32_bf16 v[60:63], a[80:83], v[20:23], v[60:63]
  s_waitcnt lgkmcnt(3)
  v_mfma_f32_16x16x32_bf16 v[44:47], a[84:87], v[24:27], v[44:47]
  ds_read_b128 v[20:23], v7 offset:22528
  s_add_u32 m0, s54, 11904
  v_mfma_f32_16x16x32_bf16 v[52:55], a[88:91], v[24:27], v[52:55]
  buffer_load_dwordx4 v5, s[12:15], s53 offen offset:384 lds
  v_mfma_f32_16x16x32_bf16 v[60:63], a[92:95], v[24:27], v[60:63]
  s_waitcnt lgkmcnt(3)
  v_mfma_f32_16x16x32_bf16 v[44:47], a[96:99], v[28:31], v[44:47]
  ds_read_b128 v[24:27], v6 offset:26624
  s_add_u32 m0, s54, 15872
  v_mfma_f32_16x16x32_bf16 v[52:55], a[100:103], v[28:31], v[52:55]
  buffer_load_dwordx4 v5, s[12:15], s53 offen offset:512 lds
  v_mfma_f32_16x16x32_bf16 v[60:63], a[104:107], v[28:31], v[60:63]
  s_waitcnt lgkmcnt(3)
  v_mfma_f32_16x16x32_bf16 v[44:47], a[108:111], v[32:35], v[44:47]
  ds_read_b128 v[28:31], v7 offset:26624
  s_add_u32 m0, s54, 19840
  v_mfma_f32_16x16x32_bf16 v[52:55], a[112:115], v[32:35], v[52:55]
  buffer_load_dwordx4 v5, s[12:15], s53 offen offset:640 lds
  v_mfma_f32_16x16x32_bf16 v[60:63], a[116:119], v[32:35], v[60:63]
  s_waitcnt lgkmcnt(3)
  v_mfma_f32_16x16x32_bf16 v[44:47], a[120:123], v[16:19], v[44:47]
  ds_read_b128 v[32:35], v6 offset:30720
  s_add_u32 m0, s54, 23808
  v_mfma_f32_16x16x32_bf16 v[52:55], a[124:127], v[16:19], v[52:55]
  buffer_load_dwordx4 v5, s[12:15], s53 offen offset:768 lds
  v_mfma_f32_16x16x32_bf16 v[60:63], a[128:131], v[16:19], v[60:63]
  s_waitcnt lgkmcnt(3)
  v_mfma_f32_16x16x32_bf16 v[44:47], a[132:135], v[20:23], v[44:47]
  ds_read_b128 v[16:19], v7 offset:30720
  s_add_u32 m0, s54, 27776
  v_mfma_f32_16x16x32_bf16 v[52:55], a[136:139], v[20:23], v[52:55]
  buffer_load_dwordx4 v5, s[12:15], s53 offen offset:896 lds
  v_mfma_f32_16x16x32_bf16 v[60:63], a[140:143], v[20:23], v[60:63]
  s_waitcnt lgkmcnt(3)
  v_mfma_f32_16x16x32_bf16 v[44:47], a[144:147], v[24:27], v[44:47]
  ds_read_b128 v[20:23], v6 offset:34816
  s_add_u32 m0, s54, 31744
  v_mfma_f32_16x16x32_bf16 v[52:55], a[148:151], v[24:27], v[52:55]
  buffer_load_dwordx4 v5, s[12:15], s53 offen offset:1024 lds
  v_mfma_f32_16x16x32_bf16 v[60:63], a[152:155], v[24:27], v[60:63]
  s_waitcnt lgkmcnt(3)
  v_mfma_f32_16x16x32_bf16 v[44:47], a[156:159], v[28:31], v[44:47]
  ds_read_b128 v[24:27], v7 offset:34816
  s_add_u32 m0, s54, 35712
  v_mfma_f32_16x16x32_bf16 v[52:55], a[160:163], v[28:31], v[52:55]
  buffer_load_dwordx4 v5, s[12:15], s53 offen offset:1152 lds
  v_mfma_f32_16x16x32_bf16 v[60:63], a[164:167], v[28:31], v[60:63]
  s_waitcnt lgkmcnt(3)
  v_mfma_f32_16x16x32_bf16 v[44:47], a[168:171], v[32:35], v[44:47]
  ds_read_b128 v[28:31], v6 offset:38912
  v_mfma_f32_16x16x32_bf16 v[52:55], a[172:175], v[32:35], v[52:55]
  v_mfma_f32_16x16x32_bf16 v[60:63], a[176:179], v[32:35], v[60:63]
  s_waitcnt lgkmcnt(3)
  v_mfma_f32_16x16x32_bf16 v[44:47], a[180:183], v[16:19], v[44:47]
  ds_read_b128 v[32:35], v7 offset:38912
  v_mfma_f32_16x16x32_bf16 v[52:55], a[184:187], v[16:19], v[52:55]
  v_add_u32 v6, s59, v6
  v_add_u32 v7, s59, v7
  v_mfma_f32_16x16x32_bf16 v[60:63], a[188:191], v[16:19], v[60:63]
  s_waitcnt lgkmcnt(3)
  v_mfma_f32_16x16x32_bf16 v[44:47], a[192:195], v[20:23], v[44:47]
  ds_read_b128 v[16:19], v6 offset:0
  v_mfma_f32_16x16x32_bf16 v[52:55], a[196:199], v[20:23], v[52:55]
  v_mfma_f32_16x16x32_bf16 v[60:63], a[200:203], v[20:23], v[60:63]
  s_waitcnt lgkmcnt(3)
  v_mfma_f32_16x16x32_bf16 v[44:47], a[204:207], v[24:27], v[44:47]
  ds_read_b128 v[20:23], v7 offset:0
  v_mfma_f32_16x16x32_bf16 v[52:55], a[208:211], v[24:27], v[52:55]
  s_add_u32 s52, s52, 1
  v_mfma_f32_16x16x32_bf16 v[60:63], a[212:215], v[24:27], v[60:63]
  s_waitcnt lgkmcnt(3)
  v_mfma_f32_16x16x32_bf16 v[44:47], a[216:219], v[28:31], v[44:47]
  ds_read_b128 v[24:27], v6 offset:4096
  v_mfma_f32_16x16x32_bf16 v[52:55], a[220:223], v[28:31], v[52:55]
  v_mfma_f32_16x16x32_bf16 v[60:63], a[224:227], v[28:31], v[60:63]
  s_waitcnt lgkmcnt(3)
  v_mfma_f32_16x16x32_bf16 v[44:47], a[228:231], v[32:35], v[44:47]
  ds_read_b128 v[28:31], v7 offset:4096
  v_mfma_f32_16x16x32_bf16 v[52:55], a[232:235], v[32:35], v[52:55]
  s_cmp_lt_u32 s52, s62
  v_mfma_f32_16x16x32_bf16 v[60:63], a[236:239], v[32:35], v[60:63]
  s_waitcnt lgkmcnt(3)
  s_cbranch_scc1 pa_loop_12
  v_cvt_pk_bf16_f32 v66, v44, v45
  v_cvt_pk_bf16_f32 v67, v46, v47
  s_nop 1
  v_cvt_pk_bf16_f32 v70, v52, v53
  v_cvt_pk_bf16_f32 v71, v54, v55
  v_cvt_pk_bf16_f32 v74, v60, v61
  v_cvt_pk_bf16_f32 v75, v62, v63
  v_permlane16_swap_b32 v64, v66
  v_permlane16_swap_b32 v65, v67
  v_permlane16_swap_b32 v68, v70
  v_permlane16_swap_b32 v69, v71
  v_permlane16_swap_b32 v72, v74
  v_permlane16_swap_b32 v73, v75
  buffer_store_dwordx4 v[64:67], v8, s[8:11], s55 offen sc1
  buffer_store_dwordx4 v[68:71], v8, s[8:11], s56 offen sc1
  buffer_store_dwordx4 v[72:75], v8, s[8:11], s57 offen sc1
  v_mov_b32 v10, s52
  s_waitcnt vmcnt(0) lgkmcnt(0)
  s_barrier
  buffer_store_dword v10, v9, s[8:11], 0 offen sc1
pa_att:
  v_min_u32 v1, 19, v0
  v_cmp_lt_u32 vcc, 9, v1
  s_lshl_b32 s46, s65, 4
  s_max_u32 s47, s46, 14
  s_sub_u32 s47, s47, 14
  s_lshr_b32 s47, s47, 5
  s_lshr_b32 s48, s46, 5
  v_mov_b32 v2, s47
  v_mov_b32 v3, s48
  v_cndmask_b32 v2, v2, v3, vcc
  v_subrev_u32 v3, 10, v1
  v_cndmask_b32 v1, v1, v3, vcc
  v_mul_u32_u24 v3, 171, v2
  v_lshrrev_b32 v3, 10, v3
  v_max_u32 v4, 28, v2
  v_subrev_u32 v4, 28, v4
  v_mul_u32_u24 v4, 171, v4
  v_lshrrev_b32 v4, 9, v4
  v_max_u32 v3, v3, v4
  v_mul_u32_u24 v3, 10, v3
  v_add_u32 v1, v1, v3
  v_lshlrev_b32 v1, 7, v1
  v_and_b32 v3, 0x2000, v1
  v_add_u32 v1, v1, v3
  v_add_u32 v1, 13705216, v1
  v_xor_b32 v1, s3, v1
  v_lshrrev_b32 v3, 4, v0
  s_lshl_b32 s47, s42, 2
  v_add_u32 v3, s47, v3
  v_mul_u32_u24 v3, 5, v3
  s_xor_b32 s47, s3, 75505664
  v_add_u32 v8, 0, v3
  v_mul_u32_u24 v4, 171, v8
  v_lshrrev_b32 v4, 12, v4
  v_mul_u32_u24 v5, 3, v4
  v_lshrrev_b32 v6, 3, v8
  v_sub_u32 v5, v6, v5
  v_and_b32 v8, 7, v8
  v_lshl_add_u32 v8, v8, 8, s47
  v_lshl_add_u32 v8, v4, 19, v8
  v_lshl_add_u32 v8, v5, 24, v8
  v_lshrrev_b32 v4, 8, v8
  v_and_b32 v4, 0x2000, v4
  v_xor_b32 v8, v8, v4
  v_add_u32 v9, 1, v3
  v_mul_u32_u24 v4, 171, v9
  v_lshrrev_b32 v4, 12, v4
  v_mul_u32_u24 v5, 3, v4
  v_lshrrev_b32 v6, 3, v9
  v_sub_u32 v5, v6, v5
  v_and_b32 v9, 7, v9
  v_lshl_add_u32 v9, v9, 8, s47
  v_lshl_add_u32 v9, v4, 19, v9
  v_lshl_add_u32 v9, v5, 24, v9
  v_lshrrev_b32 v4, 8, v9
  v_and_b32 v4, 0x2000, v4
  v_xor_b32 v9, v9, v4
  v_add_u32 v10, 2, v3
  v_mul_u32_u24 v4, 171, v10
  v_lshrrev_b32 v4, 12, v4
  v_mul_u32_u24 v5, 3, v4
  v_lshrrev_b32 v6, 3, v10
  v_sub_u32 v5, v6, v5
  v_and_b32 v10, 7, v10
  v_lshl_add_u32 v10, v10, 8, s47
  v_lshl_add_u32 v10, v4, 19, v10
  v_lshl_add_u32 v10, v5, 24, v10
  v_lshrrev_b32 v4, 8, v10
  v_and_b32 v4, 0x2000, v4
  v_xor_b32 v10, v10, v4
  v_add_u32 v11, 3, v3
  v_mul_u32_u24 v4, 171, v11
  v_lshrrev_b32 v4, 12, v4
  v_mul_u32_u24 v5, 3, v4
  v_lshrrev_b32 v6, 3, v11
  v_sub_u32 v5, v6, v5
  v_and_b32 v11, 7, v11
  v_lshl_add_u32 v11, v11, 8, s47
  v_lshl_add_u32 v11, v4, 19, v11
  v_lshl_add_u32 v11, v5, 24, v11
  v_lshrrev_b32 v4, 8, v11
  v_and_b32 v4, 0x2000, v4
  v_xor_b32 v11, v11, v4
  v_add_u32 v12, 4, v3
  v_mul_u32_u24 v4, 171, v12
  v_lshrrev_b32 v4, 12, v4
  v_mul_u32_u24 v5, 3, v4
  v_lshrrev_b32 v6, 3, v12
  v_sub_u32 v5, v6, v5
  v_and_b32 v12, 7, v12
  v_lshl_add_u32 v12, v12, 8, s47
  v_lshl_add_u32 v12, v4, 19, v12
  v_lshl_add_u32 v12, v5, 24, v12
  v_lshrrev_b32 v4, 8, v12
  v_and_b32 v4, 0x2000, v4
  v_xor_b32 v12, v12, v4
  v_add_u32 v13, 80, v3
  v_mul_u32_u24 v4, 171, v13
  v_lshrrev_b32 v4, 12, v4
  v_mul_u32_u24 v5, 3, v4
  v_lshrrev_b32 v6, 3, v13
  v_sub_u32 v5, v6, v5
  v_and_b32 v13, 7, v13
  v_lshl_add_u32 v13, v13, 8, s47
  v_lshl_add_u32 v13, v4, 19, v13
  v_lshl_add_u32 v13, v5, 24, v13
  v_lshrrev_b32 v4, 8, v13
  v_and_b32 v4, 0x2000, v4
  v_xor_b32 v13, v13, v4
  v_add_u32 v14, 81, v3
  v_mul_u32_u24 v4, 171, v14
  v_lshrrev_b32 v4, 12, v4
  v_mul_u32_u24 v5, 3, v4
  v_lshrrev_b32 v6, 3, v14
  v_sub_u32 v5, v6, v5
  v_and_b32 v14, 7, v14
  v_lshl_add_u32 v14, v14, 8, s47
  v_lshl_add_u32 v14, v4, 19, v14
  v_lshl_add_u32 v14, v5, 24, v14
  v_lshrrev_b32 v4, 8, v14
  v_and_b32 v4, 0x2000, v4
  v_xor_b32 v14, v14, v4
  v_add_u32 v15, 82, v3
  v_mul_u32_u24 v4, 171, v15
  v_lshrrev_b32 v4, 12, v4
  v_mul_u32_u24 v5, 3, v4
  v_lshrrev_b32 v6, 3, v15
  v_sub_u32 v5, v6, v5
  v_and_b32 v15, 7, v15
  v_lshl_add_u32 v15, v15, 8, s47
  v_lshl_add_u32 v15, v4, 19, v15
  v_lshl_add_u32 v15, v5, 24, v15
  v_lshrrev_b32 v4, 8, v15
  v_and_b32 v4, 0x2000, v4
  v_xor_b32 v15, v15, v4
  v_add_u32 v16, 83, v3
  v_mul_u32_u24 v4, 171, v16
  v_lshrrev_b32 v4, 12, v4
  v_mul_u32_u24 v5, 3, v4
  v_lshrrev_b32 v6, 3, v16
  v_sub_u32 v5, v6, v5
  v_and_b32 v16, 7, v16
  v_lshl_add_u32 v16, v16, 8, s47
  v_lshl_add_u32 v16, v4, 19, v16
  v_lshl_add_u32 v16, v5, 24, v16
  v_lshrrev_b32 v4, 8, v16
  v_and_b32 v4, 0x2000, v4
  v_xor_b32 v16, v16, v4
  v_add_u32 v17, 84, v3
  v_mul_u32_u24 v4, 171, v17
  v_lshrrev_b32 v4, 12, v4
  v_mul_u32_u24 v5, 3, v4
  v_lshrrev_b32 v6, 3, v17
  v_sub_u32 v5, v6, v5
  v_and_b32 v17, 7, v17
  v_lshl_add_u32 v17, v17, 8, s47
  v_lshl_add_u32 v17, v4, 19, v17
  v_lshl_add_u32 v17, v5, 24, v17
  v_lshrrev_b32 v4, 8, v17
  v_and_b32 v4, 0x2000, v4
  v_xor_b32 v17, v17, v4
  v_add_u32 v18, 160, v3
  v_mul_u32_u24 v4, 171, v18
  v_lshrrev_b32 v4, 12, v4
  v_mul_u32_u24 v5, 3, v4
  v_lshrrev_b32 v6, 3, v18
  v_sub_u32 v5, v6, v5
  v_and_b32 v18, 7, v18
  v_lshl_add_u32 v18, v18, 8, s47
  v_lshl_add_u32 v18, v4, 19, v18
  v_lshl_add_u32 v18, v5, 24, v18
  v_lshrrev_b32 v4, 8, v18
  v_and_b32 v4, 0x2000, v4
  v_xor_b32 v18, v18, v4
  v_add_u32 v19, 161, v3
  v_mul_u32_u24 v4, 171, v19
  v_lshrrev_b32 v4, 12, v4
  v_mul_u32_u24 v5, 3, v4
  v_lshrrev_b32 v6, 3, v19
  v_sub_u32 v5, v6, v5
  v_and_b32 v19, 7, v19
  v_lshl_add_u32 v19, v19, 8, s47
  v_lshl_add_u32 v19, v4, 19, v19
  v_lshl_add_u32 v19, v5, 24, v19
  v_lshrrev_b32 v4, 8, v19
  v_and_b32 v4, 0x2000, v4
  v_xor_b32 v19, v19, v4
  v_add_u32 v20, 162, v3
  v_mul_u32_u24 v4, 171, v20
  v_lshrrev_b32 v4, 12, v4
  v_mul_u32_u24 v5, 3, v4
  v_lshrrev_b32 v6, 3, v20
  v_sub_u32 v5, v6, v5
  v_and_b32 v20, 7, v20
  v_lshl_add_u32 v20, v20, 8, s47
  v_lshl_add_u32 v20, v4, 19, v20
  v_lshl_add_u32 v20, v5, 24, v20
  v_lshrrev_b32 v4, 8, v20
  v_and_b32 v4, 0x2000, v4
  v_xor_b32 v20, v20, v4
  v_add_u32 v21, 163, v3
  v_mul_u32_u24 v4, 171, v21
  v_lshrrev_b32 v4, 12, v4
  v_mul_u32_u24 v5, 3, v4
  v_lshrrev_b32 v6, 3, v21
  v_sub_u32 v5, v6, v5
  v_and_b32 v21, 7, v21
  v_lshl_add_u32 v21, v21, 8, s47
  v_lshl_add_u32 v21, v4, 19, v21
  v_lshl_add_u32 v21, v5, 24, v21
  v_lshrrev_b32 v4, 8, v21
  v_and_b32 v4, 0x2000, v4
  v_xor_b32 v21, v21, v4
  v_add_u32 v22, 164, v3
  v_mul_u32_u24 v4, 171, v22
  v_lshrrev_b32 v4, 12, v4
  v_mul_u32_u24 v5, 3, v4
  v_lshrrev_b32 v6, 3, v22
  v_sub_u32 v5, v6, v5
  v_and_b32 v22, 7, v22
  v_lshl_add_u32 v22, v22, 8, s47
  v_lshl_add_u32 v22, v4, 19, v22
  v_lshl_add_u32 v22, v5, 24, v22
  v_lshrrev_b32 v4, 8, v22
  v_and_b32 v4, 0x2000, v4
  v_xor_b32 v22, v22, v4
  v_and_b32 v5, 15, v0
  v_add_u32 v6, s46, v5
  v_subrev_u32 v4, 0, v6
  v_max_i32 v4, 0, v4
  v_and_b32 v23, 15, v4
  v_lshlrev_b32 v23, 4, v23
  v_bfe_u32 v7, v4, 4, 2
  v_lshl_add_u32 v23, v7, 11, v23
  v_lshrrev_b32 v4, 6, v4
  v_lshl_add_u32 v23, v4, 14, v23
  v_cmp_gt_u32 s[72:73], 0, v6
  v_subrev_u32 v4, 2, v6
  v_max_i32 v4, 0, v4
  v_and_b32 v24, 15, v4
  v_lshlrev_b32 v24, 4, v24
  v_bfe_u32 v7, v4, 4, 2
  v_lshl_add_u32 v24, v7, 11, v24
  v_lshrrev_b32 v4, 6, v4
  v_lshl_add_u32 v24, v4, 14, v24
  v_cmp_gt_u32 s[74:75], 2, v6
  v_subrev_u32 v4, 4, v6
  v_max_i32 v4, 0, v4
  v_and_b32 v25, 15, v4
  v_lshlrev_b32 v25, 4, v25
  v_bfe_u32 v7, v4, 4, 2
  v_lshl_add_u32 v25, v7, 11, v25
  v_lshrrev_b32 v4, 6, v4
  v_lshl_add_u32 v25, v4, 14, v25
  v_cmp_gt_u32 s[76:77], 4, v6
  v_subrev_u32 v4, 6, v6
  v_max_i32 v4, 0, v4
  v_and_b32 v26, 15, v4
  v_lshlrev_b32 v26, 4, v26
  v_bfe_u32 v7, v4, 4, 2
  v_lshl_add_u32 v26, v7, 11, v26
  v_lshrrev_b32 v4, 6, v4
  v_lshl_add_u32 v26, v4, 14, v26
  v_cmp_gt_u32 s[78:79], 6, v6
  v_subrev_u32 v4, 8, v6
  v_max_i32 v4, 0, v4
  v_and_b32 v27, 15, v4
  v_lshlrev_b32 v27, 4, v27
  v_bfe_u32 v7, v4, 4, 2
  v_lshl_add_u32 v27, v7, 11, v27
  v_lshrrev_b32 v4, 6, v4
  v_lshl_add_u32 v27, v4, 14, v27
  v_cmp_gt_u32 s[80:81], 8, v6
  v_subrev_u32 v4, 10, v6
  v_max_i32 v4, 0, v4
  v_and_b32 v28, 15, v4
  v_lshlrev_b32 v28, 4, v28
  v_bfe_u32 v7, v4, 4, 2
  v_lshl_add_u32 v28, v7, 11, v28
  v_lshrrev_b32 v4, 6, v4
  v_lshl_add_u32 v28, v4, 14, v28
  v_cmp_gt_u32 s[82:83], 10, v6
  v_subrev_u32 v4, 12, v6
  v_max_i32 v4, 0, v4
  v_and_b32 v29, 15, v4
  v_lshlrev_b32 v29, 4, v29
  v_bfe_u32 v7, v4, 4, 2
  v_lshl_add_u32 v29, v7, 11, v29
  v_lshrrev_b32 v4, 6, v4
  v_lshl_add_u32 v29, v4, 14, v29
  v_cmp_gt_u32 s[84:85], 12, v6
  v_subrev_u32 v4, 14, v6
  v_max_i32 v4, 0, v4
  v_and_b32 v30, 15, v4
  v_lshlrev_b32 v30, 4, v30
  v_bfe_u32 v7, v4, 4, 2
  v_lshl_add_u32 v30, v7, 11, v30
  v_lshrrev_b32 v4, 6, v4
  v_lshl_add_u32 v30, v4, 14, v30
  v_cmp_gt_u32 s[86:87], 14, v6
  s_mov_b32 s50, 0
  s_mov_b32 s66, 0
pa_wait:
  buffer_load_dword v4, v1, s[8:11], 0 offen sc1
  s_add_u32 s50, s50, 1
  s_cmp_gt_u32 s50, 131072
  s_cbranch_scc1 L_fail
  s_waitcnt vmcnt(0)
  v_cmp_le_u32 vcc, v4, v2
  s_cbranch_vccnz pa_wait
  v_add_u32 v232, v8, v23
  buffer_load_dwordx4 v[32:35], v232, s[8:11], s66 offen sc1
  v_add_u32 v233, v9, v23
  buffer_load_dwordx4 v[36:39], v233, s[8:11], s66 offen sc1
  v_add_u32 v234, v10, v23
  buffer_load_dwordx4 v[40:43], v234, s[8:11], s66 offen sc1
  v_add_u32 v235, v11, v23
  buffer_load_dwordx4 v[44:47], v235, s[8:11], s66 offen sc1
  v_add_u32 v236, v12, v23
  buffer_load_dwordx4 v[48:51], v236, s[8:11], s66 offen sc1
  v_add_u32 v232, v13, v23
  buffer_load_dwordx4 v[72:75], v232, s[8:11], s66 offen sc1
  v_add_u32 v233, v14, v23
  buffer_load_dwordx4 v[76:79], v233, s[8:11], s66 offen sc1
  v_add_u32 v234, v15, v23
  buffer_load_dwordx4 v[80:83], v234, s[8:11], s66 offen sc1
  v_add_u32 v235, v16, v23
  buffer_load_dwordx4 v[84:87], v235, s[8:11], s66 offen sc1
  v_add_u32 v236, v17, v23
  buffer_load_dwordx4 v[88:91], v236, s[8:11], s66 offen sc1
  v_add_u32 v232, v13, v24
  buffer_load_dwordx4 v[92:95], v232, s[8:11], s66 offen sc1
  v_add_u32 v233, v14, v24
  buffer_load_dwordx4 v[96:99], v233, s[8:11], s66 offen sc1
  v_add_u32 v234, v15, v24
  buffer_load_dwordx4 v[100:103], v234, s[8:11], s66 offen sc1
  v_add_u32 v235, v16, v24
  buffer_load_dwordx4 v[104:107], v235, s[8:11], s66 offen sc1
  v_add_u32 v236, v17, v24
  buffer_load_dwordx4 v[108:111], v236, s[8:11], s66 offen sc1
  v_add_u32 v232, v13, v25
  buffer_load_dwordx4 v[112:115], v232, s[8:11], s66 offen sc1
  v_add_u32 v233, v14, v25
  buffer_load_dwordx4 v[116:119], v233, s[8:11], s66 offen sc1
  v_add_u32 v234, v15, v25
  buffer_load_dwordx4 v[120:123], v234, s[8:11], s66 offen sc1
  v_add_u32 v235, v16, v25
  buffer_load_dwordx4 v[124:127], v235, s[8:11], s66 offen sc1
  v_add_u32 v236, v17, v25
  buffer_load_dwordx4 v[128:131], v236, s[8:11], s66 offen sc1
  v_add_u32 v232, v13, v26
  buffer_load_dwordx4 v[132:135], v232, s[8:11], s66 offen sc1
  v_add_u32 v233, v14, v26
  buffer_load_dwordx4 v[136:139], v233, s[8:11], s66 offen sc1
  v_add_u32 v234, v15, v26
  buffer_load_dwordx4 v[140:143], v234, s[8:11], s66 offen sc1
  v_add_u32 v235, v16, v26
  buffer_load_dwordx4 v[144:147], v235, s[8:11], s66 offen sc1
  v_add_u32 v236, v17, v26
  buffer_load_dwordx4 v[148:151], v236, s[8:11], s66 offen sc1
  v_add_u32 v232, v13, v27
  buffer_load_dwordx4 v[152:155], v232, s[8:11], s66 offen sc1
  v_add_u32 v233, v14, v27
  buffer_load_dwordx4 v[156:159], v233, s[8:11], s66 offen sc1
  v_add_u32 v234, v15, v27
  buffer_load_dwordx4 v[160:163], v234, s[8:11], s66 offen sc1
  v_add_u32 v235, v16, v27
  buffer_load_dwordx4 v[164:167], v235, s[8:11], s66 offen sc1
  v_add_u32 v236, v17, v27
  buffer_load_dwordx4 v[168:171], v236, s[8:11], s66 offen sc1
  v_add_u32 v232, v13, v28
  buffer_load_dwordx4 v[172:175], v232, s[8:11], s66 offen sc1
  v_add_u32 v233, v14, v28
  buffer_load_dwordx4 v[176:179], v233, s[8:11], s66 offen sc1
  v_add_u32 v234, v15, v28
  buffer_load_dwordx4 v[180:183], v234, s[8:11], s66 offen sc1
  v_add_u32 v235, v16, v28
  buffer_load_dwordx4 v[184:187], v235, s[8:11], s66 offen sc1
  v_add_u32 v236, v17, v28
  buffer_load_dwordx4 v[188:191], v236, s[8:11], s66 offen sc1
  v_add_u32 v232, v13, v29
  buffer_load_dwordx4 v[192:195], v232, s[8:11], s66 offen sc1
  v_add_u32 v233, v14, v29
  buffer_load_dwordx4 v[196:199], v233, s[8:11], s66 offen sc1
  v_add_u32 v234, v15, v29
  buffer_load_dwordx4 v[200:203], v234, s[8:11], s66 offen sc1
  v_add_u32 v235, v16, v29
  buffer_load_dwordx4 v[204:207], v235, s[8:11], s66 offen sc1
  v_add_u32 v236, v17, v29
  buffer_load_dwordx4 v[208:211], v236, s[8:11], s66 offen sc1
  v_add_u32 v232, v13, v30
  buffer_load_dwordx4 v[212:215], v232, s[8:11], s66 offen sc1
  v_add_u32 v233, v14, v30
  buffer_load_dwordx4 v[216:219], v233, s[8:11], s66 offen sc1
  v_add_u32 v234, v15, v30
  buffer_load_dwordx4 v[220:223], v234, s[8:11], s66 offen sc1
  v_add_u32 v235, v16, v30
  buffer_load_dwordx4 v[224:227], v235, s[8:11], s66 offen sc1
  v_add_u32 v236, v17, v30
  buffer_load_dwordx4 v[228:231], v236, s[8:11], s66 offen sc1
  s_waitcnt vmcnt(35)
  v_dot2_f32_bf16 v52, v32, v72, 0
  v_dot2_f32_bf16 v60, v42, v82, 0
  v_dot2_f32_bf16 v52, v33, v73, v52
  v_dot2_f32_bf16 v60, v43, v83, v60
  v_dot2_f32_bf16 v52, v34, v74, v52
  v_dot2_f32_bf16 v60, v44, v84, v60
  v_dot2_f32_bf16 v52, v35, v75, v52
  v_dot2_f32_bf16 v60, v45, v85, v60
  v_dot2_f32_bf16 v52, v36, v76, v52
  v_dot2_f32_bf16 v60, v46, v86, v60
  v_dot2_f32_bf16 v52, v37, v77, v52
  v_dot2_f32_bf16 v60, v47, v87, v60
  v_dot2_f32_bf16 v52, v38, v78, v52
  v_dot2_f32_bf16 v60, v48, v88, v60
  v_dot2_f32_bf16 v52, v39, v79, v52
  v_dot2_f32_bf16 v60, v49, v89, v60
  v_dot2_f32_bf16 v52, v40, v80, v52
  v_dot2_f32_bf16 v60, v50, v90, v60
  v_dot2_f32_bf16 v52, v41, v81, v52
  v_dot2_f32_bf16 v60, v51, v91, v60
  v_add_u32 v232, v18, v23
  buffer_load_dwordx4 v[72:75], v232, s[8:11], s66 offen sc1
  v_add_u32 v233, v19, v23
  buffer_load_dwordx4 v[76:79], v233, s[8:11], s66 offen sc1
  v_add_u32 v234, v20, v23
  buffer_load_dwordx4 v[80:83], v234, s[8:11], s66 offen sc1
  v_add_u32 v235, v21, v23
  buffer_load_dwordx4 v[84:87], v235, s[8:11], s66 offen sc1
  v_add_u32 v236, v22, v23
  buffer_load_dwordx4 v[88:91], v236, s[8:11], s66 offen sc1
  s_waitcnt vmcnt(35)
  v_dot2_f32_bf16 v53, v32, v92, 0
  v_dot2_f32_bf16 v61, v42, v102, 0
  v_dot2_f32_bf16 v53, v33, v93, v53
  v_dot2_f32_bf16 v61, v43, v103, v61
  v_dot2_f32_bf16 v53, v34, v94, v53
  v_dot2_f32_bf16 v61, v44, v104, v61
  v_dot2_f32_bf16 v53, v35, v95, v53
  v_dot2_f32_bf16 v61, v45, v105, v61
  v_dot2_f32_bf16 v53, v36, v96, v53
  v_dot2_f32_bf16 v61, v46, v106, v61
  v_dot2_f32_bf16 v53, v37, v97, v53
  v_dot2_f32_bf16 v61, v47, v107, v61
  v_dot2_f32_bf16 v53, v38, v98, v53
  v_dot2_f32_bf16 v61, v48, v108, v61
  v_dot2_f32_bf16 v53, v39, v99, v53
  v_dot2_f32_bf16 v61, v49, v109, v61
  v_dot2_f32_bf16 v53, v40, v100, v53
  v_dot2_f32_bf16 v61, v50, v110, v61
  v_dot2_f32_bf16 v53, v41, v101, v53
  v_dot2_f32_bf16 v61, v51, v111, v61
  v_add_u32 v232, v18, v24
  buffer_load_dwordx4 v[92:95], v232, s[8:11], s66 offen sc1
  v_add_u32 v233, v19, v24
  buffer_load_dwordx4 v[96:99], v233, s[8:11], s66 offen sc1
  v_add_u32 v234, v20, v24
  buffer_load_dwordx4 v[100:103], v234, s[8:11], s66 offen sc1
  v_add_u32 v235, v21, v24
  buffer_load_dwordx4 v[104:107], v235, s[8:11], s66 offen sc1
  v_add_u32 v236, v22, v24
  buffer_load_dwordx4 v[108:111], v236, s[8:11], s66 offen sc1
  s_waitcnt vmcnt(35)
  v_dot2_f32_bf16 v54, v32, v112, 0
  v_dot2_f32_bf16 v62, v42, v122, 0
  v_dot2_f32_bf16 v54, v33, v113, v54
  v_dot2_f32_bf16 v62, v43, v123, v62
  v_dot2_f32_bf16 v54, v34, v114, v54
  v_dot2_f32_bf16 v62, v44, v124, v62
  v_dot2_f32_bf16 v54, v35, v115, v54
  v_dot2_f32_bf16 v62, v45, v125, v62
  v_dot2_f32_bf16 v54, v36, v116, v54
  v_dot2_f32_bf16 v62, v46, v126, v62
  v_dot2_f32_bf16 v54, v37, v117, v54
  v_dot2_f32_bf16 v62, v47, v127, v62
  v_dot2_f32_bf16 v54, v38, v118, v54
  v_dot2_f32_bf16 v62, v48, v128, v62
  v_dot2_f32_bf16 v54, v39, v119, v54
  v_dot2_f32_bf16 v62, v49, v129, v62
  v_dot2_f32_bf16 v54, v40, v120, v54
  v_dot2_f32_bf16 v62, v50, v130, v62
  v_dot2_f32_bf16 v54, v41, v121, v54
  v_dot2_f32_bf16 v62, v51, v131, v62
  v_add_u32 v232, v18, v25
  buffer_load_dwordx4 v[112:115], v232, s[8:11], s66 offen sc1
  v_add_u32 v233, v19, v25
  buffer_load_dwordx4 v[116:119], v233, s[8:11], s66 offen sc1
  v_add_u32 v234, v20, v25
  buffer_load_dwordx4 v[120:123], v234, s[8:11], s66 offen sc1
  v_add_u32 v235, v21, v25
  buffer_load_dwordx4 v[124:127], v235, s[8:11], s66 offen sc1
  v_add_u32 v236, v22, v25
  buffer_load_dwordx4 v[128:131], v236, s[8:11], s66 offen sc1
  s_waitcnt vmcnt(35)
  v_dot2_f32_bf16 v55, v32, v132, 0
  v_dot2_f32_bf16 v63, v42, v142, 0
  v_dot2_f32_bf16 v55, v33, v133, v55
  v_dot2_f32_bf16 v63, v43, v143, v63
  v_dot2_f32_bf16 v55, v34, v134, v55
  v_dot2_f32_bf16 v63, v44, v144, v63
  v_dot2_f32_bf16 v55, v35, v135, v55
  v_dot2_f32_bf16 v63, v45, v145, v63
  v_dot2_f32_bf16 v55, v36, v136, v55
  v_dot2_f32_bf16 v63, v46, v146, v63
  v_dot2_f32_bf16 v55, v37, v137, v55
  v_dot2_f32_bf16 v63, v47, v147, v63
  v_dot2_f32_bf16 v55, v38, v138, v55
  v_dot2_f32_bf16 v63, v48, v148, v63
  v_dot2_f32_bf16 v55, v39, v139, v55
  v_dot2_f32_bf16 v63, v49, v149, v63
  v_dot2_f32_bf16 v55, v40, v140, v55
  v_dot2_f32_bf16 v63, v50, v150, v63
  v_dot2_f32_bf16 v55, v41, v141, v55
  v_dot2_f32_bf16 v63, v51, v151, v63
  v_add_u32 v232, v18, v26
  buffer_load_dwordx4 v[132:135], v232, s[8:11], s66 offen sc1
  v_add_u32 v233, v19, v26
  buffer_load_dwordx4 v[136:139], v233, s[8:11], s66 offen sc1
  v_add_u32 v234, v20, v26
  buffer_load_dwordx4 v[140:143], v234, s[8:11], s66 offen sc1
  v_add_u32 v235, v21, v26
  buffer_load_dwordx4 v[144:147], v235, s[8:11], s66 offen sc1
  v_add_u32 v236, v22, v26
  buffer_load_dwordx4 v[148:151], v236, s[8:11], s66 offen sc1
  s_waitcnt vmcnt(35)
  v_dot2_f32_bf16 v56, v32, v152, 0
  v_dot2_f32_bf16 v64, v42, v162, 0
  v_dot2_f32_bf16 v56, v33, v153, v56
  v_dot2_f32_bf16 v64, v43, v163, v64
  v_dot2_f32_bf16 v56, v34, v154, v56
  v_dot2_f32_bf16 v64, v44, v164, v64
  v_dot2_f32_bf16 v56, v35, v155, v56
  v_dot2_f32_bf16 v64, v45, v165, v64
  v_dot2_f32_bf16 v56, v36, v156, v56
  v_dot2_f32_bf16 v64, v46, v166, v64
  v_dot2_f32_bf16 v56, v37, v157, v56
  v_dot2_f32_bf16 v64, v47, v167, v64
  v_dot2_f32_bf16 v56, v38, v158, v56
  v_dot2_f32_bf16 v64, v48, v168, v64
  v_dot2_f32_bf16 v56, v39, v159, v56
  v_dot2_f32_bf16 v64, v49, v169, v64
  v_dot2_f32_bf16 v56, v40, v160, v56
  v_dot2_f32_bf16 v64, v50, v170, v64
  v_dot2_f32_bf16 v56, v41, v161, v56
  v_dot2_f32_bf16 v64, v51, v171, v64
  v_add_u32 v232, v18, v27
  buffer_load_dwordx4 v[152:155], v232, s[8:11], s66 offen sc1
  v_add_u32 v233, v19, v27
  buffer_load_dwordx4 v[156:159], v233, s[8:11], s66 offen sc1
  v_add_u32 v234, v20, v27
  buffer_load_dwordx4 v[160:163], v234, s[8:11], s66 offen sc1
  v_add_u32 v235, v21, v27
  buffer_load_dwordx4 v[164:167], v235, s[8:11], s66 offen sc1
  v_add_u32 v236, v22, v27
  buffer_load_dwordx4 v[168:171], v236, s[8:11], s66 offen sc1
  s_waitcnt vmcnt(35)
  v_dot2_f32_bf16 v57, v32, v172, 0
  v_dot2_f32_bf16 v65, v42, v182, 0
  v_dot2_f32_bf16 v57, v33, v173, v57
  v_dot2_f32_bf16 v65, v43, v183, v65
  v_dot2_f32_bf16 v57, v34, v174, v57
  v_dot2_f32_bf16 v65, v44, v184, v65
  v_dot2_f32_bf16 v57, v35, v175, v57
  v_dot2_f32_bf16 v65, v45, v185, v65
  v_dot2_f32_bf16 v57, v36, v176, v57
  v_dot2_f32_bf16 v65, v46, v186, v65
  v_dot2_f32_bf16 v57, v37, v177, v57
  v_dot2_f32_bf16 v65, v47, v187, v65
  v_dot2_f32_bf16 v57, v38, v178, v57
  v_dot2_f32_bf16 v65, v48, v188, v65
  v_dot2_f32_bf16 v57, v39, v179, v57
  v_dot2_f32_bf16 v65, v49, v189, v65
  v_dot2_f32_bf16 v57, v40, v180, v57
  v_dot2_f32_bf16 v65, v50, v190, v65
  v_dot2_f32_bf16 v57, v41, v181, v57
  v_dot2_f32_bf16 v65, v51, v191, v65
  v_add_u32 v232, v18, v28
  buffer_load_dwordx4 v[172:175], v232, s[8:11], s66 offen sc1
  v_add_u32 v233, v19, v28
  buffer_load_dwordx4 v[176:179], v233, s[8:11], s66 offen sc1
  v_add_u32 v234, v20, v28
  buffer_load_dwordx4 v[180:183], v234, s[8:11], s66 offen sc1
  v_add_u32 v235, v21, v28
  buffer_load_dwordx4 v[184:187], v235, s[8:11], s66 offen sc1
  v_add_u32 v236, v22, v28
  buffer_load_dwordx4 v[188:191], v236, s[8:11], s66 offen sc1
  s_waitcnt vmcnt(35)
  v_dot2_f32_bf16 v58, v32, v192, 0
  v_dot2_f32_bf16 v66, v42, v202, 0
  v_dot2_f32_bf16 v58, v33, v193, v58
  v_dot2_f32_bf16 v66, v43, v203, v66
  v_dot2_f32_bf16 v58, v34, v194, v58
  v_dot2_f32_bf16 v66, v44, v204, v66
  v_dot2_f32_bf16 v58, v35, v195, v58
  v_dot2_f32_bf16 v66, v45, v205, v66
  v_dot2_f32_bf16 v58, v36, v196, v58
  v_dot2_f32_bf16 v66, v46, v206, v66
  v_dot2_f32_bf16 v58, v37, v197, v58
  v_dot2_f32_bf16 v66, v47, v207, v66
  v_dot2_f32_bf16 v58, v38, v198, v58
  v_dot2_f32_bf16 v66, v48, v208, v66
  v_dot2_f32_bf16 v58, v39, v199, v58
  v_dot2_f32_bf16 v66, v49, v209, v66
  v_dot2_f32_bf16 v58, v40, v200, v58
  v_dot2_f32_bf16 v66, v50, v210, v66
  v_dot2_f32_bf16 v58, v41, v201, v58
  v_dot2_f32_bf16 v66, v51, v211, v66
  v_add_u32 v232, v18, v29
  buffer_load_dwordx4 v[192:195], v232, s[8:11], s66 offen sc1
  v_add_u32 v233, v19, v29
  buffer_load_dwordx4 v[196:199], v233, s[8:11], s66 offen sc1
  v_add_u32 v234, v20, v29
  buffer_load_dwordx4 v[200:203], v234, s[8:11], s66 offen sc1
  v_add_u32 v235, v21, v29
  buffer_load_dwordx4 v[204:207], v235, s[8:11], s66 offen sc1
  v_add_u32 v236, v22, v29
  buffer_load_dwordx4 v[208:211], v236, s[8:11], s66 offen sc1
  s_waitcnt vmcnt(35)
  v_dot2_f32_bf16 v59, v32, v212, 0
  v_dot2_f32_bf16 v67, v42, v222, 0
  v_dot2_f32_bf16 v59, v33, v213, v59
  v_dot2_f32_bf16 v67, v43, v223, v67
  v_dot2_f32_bf16 v59, v34, v214, v59
  v_dot2_f32_bf16 v67, v44, v224, v67
  v_dot2_f32_bf16 v59, v35, v215, v59
  v_dot2_f32_bf16 v67, v45, v225, v67
  v_dot2_f32_bf16 v59, v36, v216, v59
  v_dot2_f32_bf16 v67, v46, v226, v67
  v_dot2_f32_bf16 v59, v37, v217, v59
  v_dot2_f32_bf16 v67, v47, v227, v67
  v_dot2_f32_bf16 v59, v38, v218, v59
  v_dot2_f32_bf16 v67, v48, v228, v67
  v_dot2_f32_bf16 v59, v39, v219, v59
  v_dot2_f32_bf16 v67, v49, v229, v67
  v_dot2_f32_bf16 v59, v40, v220, v59
  v_dot2_f32_bf16 v67, v50, v230, v67
  v_dot2_f32_bf16 v59, v41, v221, v59
  v_dot2_f32_bf16 v67, v51, v231, v67
  v_add_u32 v232, v18, v30
  buffer_load_dwordx4 v[212:215], v232, s[8:11], s66 offen sc1
  v_add_u32 v233, v19, v30
  buffer_load_dwordx4 v[216:219], v233, s[8:11], s66 offen sc1
  v_add_u32 v234, v20, v30
  buffer_load_dwordx4 v[220:223], v234, s[8:11], s66 offen sc1
  v_add_u32 v235, v21, v30
  buffer_load_dwordx4 v[224:227], v235, s[8:11], s66 offen sc1
  v_add_u32 v236, v22, v30
  buffer_load_dwordx4 v[228:231], v236, s[8:11], s66 offen sc1
  s_mov_b32 s46, 1051011932
  v_mov_b32 v232, 3481618353
  v_cndmask_b32 v53, v53, v232, s[74:75]
  v_cndmask_b32 v54, v54, v232, s[76:77]
  v_cndmask_b32 v55, v55, v232, s[78:79]
  v_cndmask_b32 v56, v56, v232, s[80:81]
  v_cndmask_b32 v57, v57, v232, s[82:83]
  v_cndmask_b32 v58, v58, v232, s[84:85]
  v_cndmask_b32 v59, v59, v232, s[86:87]
  v_max_f32 v233, v52, v53
  v_max3_f32 v233, v233, v54, v55
  v_max3_f32 v233, v233, v56, v57
  v_max3_f32 v233, v233, v58, v59
  v_mul_f32 v233, s46, v233
  v_fma_f32 v52, v52, s46, -v233
  v_fma_f32 v53, v53, s46, -v233
  v_fma_f32 v54, v54, s46, -v233
  v_fma_f32 v55, v55, s46, -v233
  v_fma_f32 v56, v56, s46, -v233
  v_fma_f32 v57, v57, s46, -v233
  v_fma_f32 v58, v58, s46, -v233
  v_fma_f32 v59, v59, s46, -v233
  v_exp_f32 v52, v52
  v_exp_f32 v53, v53
  v_exp_f32 v54, v54
  v_exp_f32 v55, v55
  v_exp_f32 v56, v56
  v_exp_f32 v57, v57
  v_exp_f32 v58, v58
  v_exp_f32 v59, v59
  v_add_f32 v233, v52, v53
  v_add_f32 v233, v233, v54
  v_add_f32 v233, v233, v55
  v_add_f32 v233, v233, v56
  v_add_f32 v233, v233, v57
  v_add_f32 v233, v233, v58
  v_add_f32 v233, v233, v59
  v_rcp_f32 v233, v233
  s_nop 0
  v_mul_f32 v52, v52, v233
  v_mul_f32 v53, v53, v233
  v_mul_f32 v54, v54, v233
  v_mul_f32 v55, v55, v233
  v_mul_f32 v56, v56, v233
  v_mul_f32 v57, v57, v233
  v_mul_f32 v58, v58, v233
  v_mul_f32 v59, v59, v233
  v_cndmask_b32 v61, v61, v232, s[74:75]
  v_cndmask_b32 v62, v62, v232, s[76:77]
  v_cndmask_b32 v63, v63, v232, s[78:79]
  v_cndmask_b32 v64, v64, v232, s[80:81]
  v_cndmask_b32 v65, v65, v232, s[82:83]
  v_cndmask_b32 v66, v66, v232, s[84:85]
  v_cndmask_b32 v67, v67, v232, s[86:87]
  v_max_f32 v233, v60, v61
  v_max3_f32 v233, v233, v62, v63
  v_max3_f32 v233, v233, v64, v65
  v_max3_f32 v233, v233, v66, v67
  v_mul_f32 v233, s46, v233
  v_fma_f32 v60, v60, s46, -v233
  v_fma_f32 v61, v61, s46, -v233
  v_fma_f32 v62, v62, s46, -v233
  v_fma_f32 v63, v63, s46, -v233
  v_fma_f32 v64, v64, s46, -v233
  v_fma_f32 v65, v65, s46, -v233
  v_fma_f32 v66, v66, s46, -v233
  v_fma_f32 v67, v67, s46, -v233
  v_exp_f32 v60, v60
  v_exp_f32 v61, v61
  v_exp_f32 v62, v62
  v_exp_f32 v63, v63
  v_exp_f32 v64, v64
  v_exp_f32 v65, v65
  v_exp_f32 v66, v66
  v_exp_f32 v67, v67
  v_add_f32 v233, v60, v61
  v_add_f32 v233, v233, v62
  v_add_f32 v233, v233, v63
  v_add_f32 v233, v233, v64
  v_add_f32 v233, v233, v65
  v_add_f32 v233, v233, v66
  v_add_f32 v233, v233, v67
  v_rcp_f32 v233, v233
  s_nop 0
  v_mul_f32 v60, v60, v233
  v_mul_f32 v61, v61, v233
  v_mul_f32 v62, v62, v233
  v_mul_f32 v63, v63, v233
  v_mul_f32 v64, v64, v233
  v_mul_f32 v65, v65, v233
  v_mul_f32 v66, v66, v233
  v_mul_f32 v67, v67, v233
  v_cvt_pk_bf16_f32 v52, v52, 0
  v_lshlrev_b32 v236, 16, v52
  v_cvt_pk_bf16_f32 v53, v53, 0
  v_lshlrev_b32 v237, 16, v53
  v_cvt_pk_bf16_f32 v54, v54, 0
  v_lshlrev_b32 v238, 16, v54
  v_cvt_pk_bf16_f32 v55, v55, 0
  v_lshlrev_b32 v239, 16, v55
  v_cvt_pk_bf16_f32 v56, v56, 0
  v_lshlrev_b32 v240, 16, v56
  v_cvt_pk_bf16_f32 v57, v57, 0
  v_lshlrev_b32 v241, 16, v57
  v_cvt_pk_bf16_f32 v58, v58, 0
  v_lshlrev_b32 v242, 16, v58
  v_cvt_pk_bf16_f32 v59, v59, 0
  v_lshlrev_b32 v243, 16, v59
  v_cvt_pk_bf16_f32 v60, v60, 0
  v_lshlrev_b32 v244, 16, v60
  v_cvt_pk_bf16_f32 v61, v61, 0
  v_lshlrev_b32 v245, 16, v61
  v_cvt_pk_bf16_f32 v62, v62, 0
  v_lshlrev_b32 v246, 16, v62
  v_cvt_pk_bf16_f32 v63, v63, 0
  v_lshlrev_b32 v247, 16, v63
  v_cvt_pk_bf16_f32 v64, v64, 0
  v_lshlrev_b32 v248, 16, v64
  v_cvt_pk_bf16_f32 v65, v65, 0
  v_lshlrev_b32 v249, 16, v65
  v_cvt_pk_bf16_f32 v66, v66, 0
  v_lshlrev_b32 v250, 16, v66
  v_cvt_pk_bf16_f32 v67, v67, 0
  v_lshlrev_b32 v251, 16, v67
  s_waitcnt vmcnt(35)
  v_dot2_f32_bf16 v8, v72, v52, 0
  v_dot2_f32_bf16 v9, v72, v236, 0
  v_dot2_f32_bf16 v10, v73, v52, 0
  v_dot2_f32_bf16 v11, v73, v236, 0
  v_dot2_f32_bf16 v12, v74, v52, 0
  v_dot2_f32_bf16 v13, v74, v236, 0
  v_dot2_f32_bf16 v14, v75, v52, 0
  v_dot2_f32_bf16 v15, v75, v236, 0
  v_dot2_f32_bf16 v16, v76, v52, 0
  v_dot2_f32_bf16 v17, v76, v236, 0
  v_dot2_f32_bf16 v18, v77, v52, 0
  v_dot2_f32_bf16 v19, v77, v236, 0
  v_dot2_f32_bf16 v20, v78, v52, 0
  v_dot2_f32_bf16 v21, v78, v236, 0
  v_dot2_f32_bf16 v22, v79, v52, 0
  v_dot2_f32_bf16 v23, v79, v236, 0
  v_dot2_f32_bf16 v24, v80, v52, 0
  v_dot2_f32_bf16 v25, v80, v236, 0
  v_dot2_f32_bf16 v26, v81, v52, 0
  v_dot2_f32_bf16 v27, v81, v236, 0
  v_dot2_f32_bf16 v28, v82, v60, 0
  v_dot2_f32_bf16 v29, v82, v244, 0
  v_dot2_f32_bf16 v30, v83, v60, 0
  v_dot2_f32_bf16 v31, v83, v244, 0
  v_dot2_f32_bf16 v32, v84, v60, 0
  v_dot2_f32_bf16 v33, v84, v244, 0
  v_dot2_f32_bf16 v34, v85, v60, 0
  v_dot2_f32_bf16 v35, v85, v244, 0
  v_dot2_f32_bf16 v36, v86, v60, 0
  v_dot2_f32_bf16 v37, v86, v244, 0
  v_dot2_f32_bf16 v38, v87, v60, 0
  v_dot2_f32_bf16 v39, v87, v244, 0
  v_dot2_f32_bf16 v40, v88, v60, 0
  v_dot2_f32_bf16 v41, v88, v244, 0
  v_dot2_f32_bf16 v42, v89, v60, 0
  v_dot2_f32_bf16 v43, v89, v244, 0
  v_dot2_f32_bf16 v44, v90, v60, 0
  v_dot2_f32_bf16 v45, v90, v244, 0
  v_dot2_f32_bf16 v46, v91, v60, 0
  v_dot2_f32_bf16 v47, v91, v244, 0
  s_waitcnt vmcnt(30)
  v_dot2_f32_bf16 v8, v92, v53, v8
  v_dot2_f32_bf16 v9, v92, v237, v9
  v_dot2_f32_bf16 v10, v93, v53, v10
  v_dot2_f32_bf16 v11, v93, v237, v11
  v_dot2_f32_bf16 v12, v94, v53, v12
  v_dot2_f32_bf16 v13, v94, v237, v13
  v_dot2_f32_bf16 v14, v95, v53, v14
  v_dot2_f32_bf16 v15, v95, v237, v15
  v_dot2_f32_bf16 v16, v96, v53, v16
  v_dot2_f32_bf16 v17, v96, v237, v17
  v_dot2_f32_bf16 v18, v97, v53, v18
  v_dot2_f32_bf16 v19, v97, v237, v19
  v_dot2_f32_bf16 v20, v98, v53, v20
  v_dot2_f32_bf16 v21, v98, v237, v21
  v_dot2_f32_bf16 v22, v99, v53, v22
  v_dot2_f32_bf16 v23, v99, v237, v23
  v_dot2_f32_bf16 v24, v100, v53, v24
  v_dot2_f32_bf16 v25, v100, v237, v25
  v_dot2_f32_bf16 v26, v101, v53, v26
  v_dot2_f32_bf16 v27, v101, v237, v27
  v_dot2_f32_bf16 v28, v102, v61, v28
  v_dot2_f32_bf16 v29, v102, v245, v29
  v_dot2_f32_bf16 v30, v103, v61, v30
  v_dot2_f32_bf16 v31, v103, v245, v31
  v_dot2_f32_bf16 v32, v104, v61, v32
  v_dot2_f32_bf16 v33, v104, v245, v33
  v_dot2_f32_bf16 v34, v105, v61, v34
  v_dot2_f32_bf16 v35, v105, v245, v35
  v_dot2_f32_bf16 v36, v106, v61, v36
  v_dot2_f32_bf16 v37, v106, v245, v37
  v_dot2_f32_bf16 v38, v107, v61, v38
  v_dot2_f32_bf16 v39, v107, v245, v39
  v_dot2_f32_bf16 v40, v108, v61, v40
  v_dot2_f32_bf16 v41, v108, v245, v41
  v_dot2_f32_bf16 v42, v109, v61, v42
  v_dot2_f32_bf16 v43, v109, v245, v43
  v_dot2_f32_bf16 v44, v110, v61, v44
  v_dot2_f32_bf16 v45, v110, v245, v45
  v_dot2_f32_bf16 v46, v111, v61, v46
  v_dot2_f32_bf16 v47, v111, v245, v47
  s_waitcnt vmcnt(25)
  v_dot2_f32_bf16 v8, v112, v54, v8
  v_dot2_f32_bf16 v9, v112, v238, v9
  v_dot2_f32_bf16 v10, v113, v54, v10
  v_dot2_f32_bf16 v11, v113, v238, v11
  v_dot2_f32_bf16 v12, v114, v54, v12
  v_dot2_f32_bf16 v13, v114, v238, v13
  v_dot2_f32_bf16 v14, v115, v54, v14
  v_dot2_f32_bf16 v15, v115, v238, v15
  v_dot2_f32_bf16 v16, v116, v54, v16
  v_dot2_f32_bf16 v17, v116, v238, v17
  v_dot2_f32_bf16 v18, v117, v54, v18
  v_dot2_f32_bf16 v19, v117, v238, v19
  v_dot2_f32_bf16 v20, v118, v54, v20
  v_dot2_f32_bf16 v21, v118, v238, v21
  v_dot2_f32_bf16 v22, v119, v54, v22
  v_dot2_f32_bf16 v23, v119, v238, v23
  v_dot2_f32_bf16 v24, v120, v54, v24
  v_dot2_f32_bf16 v25, v120, v238, v25
  v_dot2_f32_bf16 v26, v121, v54, v26
  v_dot2_f32_bf16 v27, v121, v238, v27
  v_dot2_f32_bf16 v28, v122, v62, v28
  v_dot2_f32_bf16 v29, v122, v246, v29
  v_dot2_f32_bf16 v30, v123, v62, v30
  v_dot2_f32_bf16 v31, v123, v246, v31
  v_dot2_f32_bf16 v32, v124, v62, v32
  v_dot2_f32_bf16 v33, v124, v246, v33
  v_dot2_f32_bf16 v34, v125, v62, v34
  v_dot2_f32_bf16 v35, v125, v246, v35
  v_dot2_f32_bf16 v36, v126, v62, v36
  v_dot2_f32_bf16 v37, v126, v246, v37
  v_dot2_f32_bf16 v38, v127, v62, v38
  v_dot2_f32_bf16 v39, v127, v246, v39
  v_dot2_f32_bf16 v40, v128, v62, v40
  v_dot2_f32_bf16 v41, v128, v246, v41
  v_dot2_f32_bf16 v42, v129, v62, v42
  v_dot2_f32_bf16 v43, v129, v246, v43
  v_dot2_f32_bf16 v44, v130, v62, v44
  v_dot2_f32_bf16 v45, v130, v246, v45
  v_dot2_f32_bf16 v46, v131, v62, v46
  v_dot2_f32_bf16 v47, v131, v246, v47
  s_waitcnt vmcnt(20)
  v_dot2_f32_bf16 v8, v132, v55, v8
  v_dot2_f32_bf16 v9, v132, v239, v9
  v_dot2_f32_bf16 v10, v133, v55, v10
  v_dot2_f32_bf16 v11, v133, v239, v11
  v_dot2_f32_bf16 v12, v134, v55, v12
  v_dot2_f32_bf16 v13, v134, v239, v13
  v_dot2_f32_bf16 v14, v135, v55, v14
  v_dot2_f32_bf16 v15, v135, v239, v15
  v_dot2_f32_bf16 v16, v136, v55, v16
  v_dot2_f32_bf16 v17, v136, v239, v17
  v_dot2_f32_bf16 v18, v137, v55, v18
  v_dot2_f32_bf16 v19, v137, v239, v19
  v_dot2_f32_bf16 v20, v138, v55, v20
  v_dot2_f32_bf16 v21, v138, v239, v21
  v_dot2_f32_bf16 v22, v139, v55, v22
  v_dot2_f32_bf16 v23, v139, v239, v23
  v_dot2_f32_bf16 v24, v140, v55, v24
  v_dot2_f32_bf16 v25, v140, v239, v25
  v_dot2_f32_bf16 v26, v141, v55, v26
  v_dot2_f32_bf16 v27, v141, v239, v27
  v_dot2_f32_bf16 v28, v142, v63, v28
  v_dot2_f32_bf16 v29, v142, v247, v29
  v_dot2_f32_bf16 v30, v143, v63, v30
  v_dot2_f32_bf16 v31, v143, v247, v31
  v_dot2_f32_bf16 v32, v144, v63, v32
  v_dot2_f32_bf16 v33, v144, v247, v33
  v_dot2_f32_bf16 v34, v145, v63, v34
  v_dot2_f32_bf16 v35, v145, v247, v35
  v_dot2_f32_bf16 v36, v146, v63, v36
  v_dot2_f32_bf16 v37, v146, v247, v37
  v_dot2_f32_bf16 v38, v147, v63, v38
  v_dot2_f32_bf16 v39, v147, v247, v39
  v_dot2_f32_bf16 v40, v148, v63, v40
  v_dot2_f32_bf16 v41, v148, v247, v41
  v_dot2_f32_bf16 v42, v149, v63, v42
  v_dot2_f32_bf16 v43, v149, v247, v43
  v_dot2_f32_bf16 v44, v150, v63, v44
  v_dot2_f32_bf16 v45, v150, v247, v45
  v_dot2_f32_bf16 v46, v151, v63, v46
  v_dot2_f32_bf16 v47, v151, v247, v47
  s_waitcnt vmcnt(15)
  v_dot2_f32_bf16 v8, v152, v56, v8
  v_dot2_f32_bf16 v9, v152, v240, v9
  v_dot2_f32_bf16 v10, v153, v56, v10
  v_dot2_f32_bf16 v11, v153, v240, v11
  v_dot2_f32_bf16 v12, v154, v56, v12
  v_dot2_f32_bf16 v13, v154, v240, v13
  v_dot2_f32_bf16 v14, v155, v56, v14
  v_dot2_f32_bf16 v15, v155, v240, v15
  v_dot2_f32_bf16 v16, v156, v56, v16
  v_dot2_f32_bf16 v17, v156, v240, v17
  v_dot2_f32_bf16 v18, v157, v56, v18
  v_dot2_f32_bf16 v19, v157, v240, v19
  v_dot2_f32_bf16 v20, v158, v56, v20
  v_dot2_f32_bf16 v21, v158, v240, v21
  v_dot2_f32_bf16 v22, v159, v56, v22
  v_dot2_f32_bf16 v23, v159, v240, v23
  v_dot2_f32_bf16 v24, v160, v56, v24
  v_dot2_f32_bf16 v25, v160, v240, v25
  v_dot2_f32_bf16 v26, v161, v56, v26
  v_dot2_f32_bf16 v27, v161, v240, v27
  v_dot2_f32_bf16 v28, v162, v64, v28
  v_dot2_f32_bf16 v29, v162, v248, v29
  v_dot2_f32_bf16 v30, v163, v64, v30
  v_dot2_f32_bf16 v31, v163, v248, v31
  v_dot2_f32_bf16 v32, v164, v64, v32
  v_dot2_f32_bf16 v33, v164, v248, v33
  v_dot2_f32_bf16 v34, v165, v64, v34
  v_dot2_f32_bf16 v35, v165, v248, v35
  v_dot2_f32_bf16 v36, v166, v64, v36
  v_dot2_f32_bf16 v37, v166, v248, v37
  v_dot2_f32_bf16 v38, v167, v64, v38
  v_dot2_f32_bf16 v39, v167, v248, v39
  v_dot2_f32_bf16 v40, v168, v64, v40
  v_dot2_f32_bf16 v41, v168, v248, v41
  v_dot2_f32_bf16 v42, v169, v64, v42
  v_dot2_f32_bf16 v43, v169, v248, v43
  v_dot2_f32_bf16 v44, v170, v64, v44
  v_dot2_f32_bf16 v45, v170, v248, v45
  v_dot2_f32_bf16 v46, v171, v64, v46
  v_dot2_f32_bf16 v47, v171, v248, v47
  s_waitcnt vmcnt(10)
  v_dot2_f32_bf16 v8, v172, v57, v8
  v_dot2_f32_bf16 v9, v172, v241, v9
  v_dot2_f32_bf16 v10, v173, v57, v10
  v_dot2_f32_bf16 v11, v173, v241, v11
  v_dot2_f32_bf16 v12, v174, v57, v12
  v_dot2_f32_bf16 v13, v174, v241, v13
  v_dot2_f32_bf16 v14, v175, v57, v14
  v_dot2_f32_bf16 v15, v175, v241, v15
  v_dot2_f32_bf16 v16, v176, v57, v16
  v_dot2_f32_bf16 v17, v176, v241, v17
  v_dot2_f32_bf16 v18, v177, v57, v18
  v_dot2_f32_bf16 v19, v177, v241, v19
  v_dot2_f32_bf16 v20, v178, v57, v20
  v_dot2_f32_bf16 v21, v178, v241, v21
  v_dot2_f32_bf16 v22, v179, v57, v22
  v_dot2_f32_bf16 v23, v179, v241, v23
  v_dot2_f32_bf16 v24, v180, v57, v24
  v_dot2_f32_bf16 v25, v180, v241, v25
  v_dot2_f32_bf16 v26, v181, v57, v26
  v_dot2_f32_bf16 v27, v181, v241, v27
  v_dot2_f32_bf16 v28, v182, v65, v28
  v_dot2_f32_bf16 v29, v182, v249, v29
  v_dot2_f32_bf16 v30, v183, v65, v30
  v_dot2_f32_bf16 v31, v183, v249, v31
  v_dot2_f32_bf16 v32, v184, v65, v32
  v_dot2_f32_bf16 v33, v184, v249, v33
  v_dot2_f32_bf16 v34, v185, v65, v34
  v_dot2_f32_bf16 v35, v185, v249, v35
  v_dot2_f32_bf16 v36, v186, v65, v36
  v_dot2_f32_bf16 v37, v186, v249, v37
  v_dot2_f32_bf16 v38, v187, v65, v38
  v_dot2_f32_bf16 v39, v187, v249, v39
  v_dot2_f32_bf16 v40, v188, v65, v40
  v_dot2_f32_bf16 v41, v188, v249, v41
  v_dot2_f32_bf16 v42, v189, v65, v42
  v_dot2_f32_bf16 v43, v189, v249, v43
  v_dot2_f32_bf16 v44, v190, v65, v44
  v_dot2_f32_bf16 v45, v190, v249, v45
  v_dot2_f32_bf16 v46, v191, v65, v46
  v_dot2_f32_bf16 v47, v191, v249, v47
  s_waitcnt vmcnt(5)
  v_dot2_f32_bf16 v8, v192, v58, v8
  v_dot2_f32_bf16 v9, v192, v242, v9
  v_dot2_f32_bf16 v10, v193, v58, v10
  v_dot2_f32_bf16 v11, v193, v242, v11
  v_dot2_f32_bf16 v12, v194, v58, v12
  v_dot2_f32_bf16 v13, v194, v242, v13
  v_dot2_f32_bf16 v14, v195, v58, v14
  v_dot2_f32_bf16 v15, v195, v242, v15
  v_dot2_f32_bf16 v16, v196, v58, v16
  v_dot2_f32_bf16 v17, v196, v242, v17
  v_dot2_f32_bf16 v18, v197, v58, v18
  v_dot2_f32_bf16 v19, v197, v242, v19
  v_dot2_f32_bf16 v20, v198, v58, v20
  v_dot2_f32_bf16 v21, v198, v242, v21
  v_dot2_f32_bf16 v22, v199, v58, v22
  v_dot2_f32_bf16 v23, v199, v242, v23
  v_dot2_f32_bf16 v24, v200, v58, v24
  v_dot2_f32_bf16 v25, v200, v242, v25
  v_dot2_f32_bf16 v26, v201, v58, v26
  v_dot2_f32_bf16 v27, v201, v242, v27
  v_dot2_f32_bf16 v28, v202, v66, v28
  v_dot2_f32_bf16 v29, v202, v250, v29
  v_dot2_f32_bf16 v30, v203, v66, v30
  v_dot2_f32_bf16 v31, v203, v250, v31
  v_dot2_f32_bf16 v32, v204, v66, v32
  v_dot2_f32_bf16 v33, v204, v250, v33
  v_dot2_f32_bf16 v34, v205, v66, v34
  v_dot2_f32_bf16 v35, v205, v250, v35
  v_dot2_f32_bf16 v36, v206, v66, v36
  v_dot2_f32_bf16 v37, v206, v250, v37
  v_dot2_f32_bf16 v38, v207, v66, v38
  v_dot2_f32_bf16 v39, v207, v250, v39
  v_dot2_f32_bf16 v40, v208, v66, v40
  v_dot2_f32_bf16 v41, v208, v250, v41
  v_dot2_f32_bf16 v42, v209, v66, v42
  v_dot2_f32_bf16 v43, v209, v250, v43
  v_dot2_f32_bf16 v44, v210, v66, v44
  v_dot2_f32_bf16 v45, v210, v250, v45
  v_dot2_f32_bf16 v46, v211, v66, v46
  v_dot2_f32_bf16 v47, v211, v250, v47
  s_waitcnt vmcnt(0)
  v_dot2_f32_bf16 v8, v212, v59, v8
  v_dot2_f32_bf16 v9, v212, v243, v9
  v_dot2_f32_bf16 v10, v213, v59, v10
  v_dot2_f32_bf16 v11, v213, v243, v11
  v_dot2_f32_bf16 v12, v214, v59, v12
  v_dot2_f32_bf16 v13, v214, v243, v13
  v_dot2_f32_bf16 v14, v215, v59, v14
  v_dot2_f32_bf16 v15, v215, v243, v15
  v_dot2_f32_bf16 v16, v216, v59, v16
  v_dot2_f32_bf16 v17, v216, v243, v17
  v_dot2_f32_bf16 v18, v217, v59, v18
  v_dot2_f32_bf16 v19, v217, v243, v19
  v_dot2_f32_bf16 v20, v218, v59, v20
  v_dot2_f32_bf16 v21, v218, v243, v21
  v_dot2_f32_bf16 v22, v219, v59, v22
  v_dot2_f32_bf16 v23, v219, v243, v23
  v_dot2_f32_bf16 v24, v220, v59, v24
  v_dot2_f32_bf16 v25, v220, v243, v25
  v_dot2_f32_bf16 v26, v221, v59, v26
  v_dot2_f32_bf16 v27, v221, v243, v27
  v_dot2_f32_bf16 v28, v222, v67, v28
  v_dot2_f32_bf16 v29, v222, v251, v29
  v_dot2_f32_bf16 v30, v223, v67, v30
  v_dot2_f32_bf16 v31, v223, v251, v31
  v_dot2_f32_bf16 v32, v224, v67, v32
  v_dot2_f32_bf16 v33, v224, v251, v33
  v_dot2_f32_bf16 v34, v225, v67, v34
  v_dot2_f32_bf16 v35, v225, v251, v35
  v_dot2_f32_bf16 v36, v226, v67, v36
  v_dot2_f32_bf16 v37, v226, v251, v37
  v_dot2_f32_bf16 v38, v227, v67, v38
  v_dot2_f32_bf16 v39, v227, v251, v39
  v_dot2_f32_bf16 v40, v228, v67, v40
  v_dot2_f32_bf16 v41, v228, v251, v41
  v_dot2_f32_bf16 v42, v229, v67, v42
  v_dot2_f32_bf16 v43, v229, v251, v43
  v_dot2_f32_bf16 v44, v230, v67, v44
  v_dot2_f32_bf16 v45, v230, v251, v45
  v_dot2_f32_bf16 v46, v231, v67, v46
  v_dot2_f32_bf16 v47, v231, v251, v47
  v_cvt_pk_bf16_f32 v72, v8, v9
  v_cvt_pk_bf16_f32 v73, v10, v11
  v_cvt_pk_bf16_f32 v74, v12, v13
  v_cvt_pk_bf16_f32 v75, v14, v15
  v_cvt_pk_bf16_f32 v76, v16, v17
  v_cvt_pk_bf16_f32 v77, v18, v19
  v_cvt_pk_bf16_f32 v78, v20, v21
  v_cvt_pk_bf16_f32 v79, v22, v23
  v_cvt_pk_bf16_f32 v80, v24, v25
  v_cvt_pk_bf16_f32 v81, v26, v27
  v_cvt_pk_bf16_f32 v82, v28, v29
  v_cvt_pk_bf16_f32 v83, v30, v31
  v_cvt_pk_bf16_f32 v84, v32, v33
  v_cvt_pk_bf16_f32 v85, v34, v35
  v_cvt_pk_bf16_f32 v86, v36, v37
  v_cvt_pk_bf16_f32 v87, v38, v39
  v_cvt_pk_bf16_f32 v88, v40, v41
  v_cvt_pk_bf16_f32 v89, v42, v43
  v_cvt_pk_bf16_f32 v90, v44, v45
  v_cvt_pk_bf16_f32 v91, v46, v47
  v_lshlrev_b32 v3, 8, v3
  v_lshl_add_u32 v3, v5, 4, v3
  v_add_u32 v3, 122880, v3
  ds_write_b128 v3, v[72:75] offset:0
  ds_write_b128 v3, v[76:79] offset:256
  ds_write_b128 v3, v[80:83] offset:512
  ds_write_b128 v3, v[84:87] offset:768
  ds_write_b128 v3, v[88:91] offset:1024
  s_waitcnt lgkmcnt(0)
  s_barrier
  v_lshlrev_b32 v13, 4, v0
  v_add_u32 v13, 122880, v13
  ds_read_b128 v[20:23], v13 offset:0
  ds_read_b128 v[24:27], v13 offset:1024
  ds_read_b128 v[28:31], v13 offset:2048
  ds_read_b128 v[32:35], v13 offset:3072
  ds_read_b128 v[36:39], v13 offset:4096
  ds_read_b128 v[40:43], v13 offset:5120
  ds_read_b128 v[44:47], v13 offset:6144
  ds_read_b128 v[48:51], v13 offset:7168
  ds_read_b128 v[52:55], v13 offset:8192
  ds_read_b128 v[56:59], v13 offset:9216
  ds_read_b128 v[60:63], v13 offset:10240
  ds_read_b128 v[64:67], v13 offset:11264
  s_waitcnt lgkmcnt(4)
  ds_read_b128 v[68:71], v13 offset:12288
  ds_read_b128 v[72:75], v13 offset:13312
  ds_read_b128 v[76:79], v13 offset:14336
  ds_read_b128 v[80:83], v13 offset:15360
  ds_read_b128 v[84:87], v13 offset:16384
  ds_read_b128 v[88:91], v13 offset:17408
  ds_read_b128 v[92:95], v13 offset:18432
  ds_read_b128 v[96:99], v13 offset:19456
  s_mov_b32 s4, s20
  s_mov_b32 s5, s21
  s_mov_b32 s6, 819200
  s_mov_b32 s7, 0x20000
  s_mov_b32 s12, s36
  s_mov_b32 s13, s37
  s_mov_b32 s14, 5242880
  s_mov_b32 s15, 0x20000
  v_mul_u32_u24 v12, 2560, v6
  v_lshrrev_b32 v14, 4, v0
  v_lshl_add_u32 v12, v14, 3, v12
  s_lshl_b32 s46, s42, 5
  v_add_u32 v12, s46, v12
  s_mov_b32 s66, 0
  s_waitcnt lgkmcnt(0)
  v_lshrrev_b32 v13, 3, v0
  v_lshrrev_b32 v14, 2, v13
  v_lshlrev_b32 v14, 3, v14
  v_and_b32 v8, 3, v13
  v_add_u32 v8, v8, v14
  s_and_b32 s46, s42, 1
  s_lshl_b32 s46, s46, 2
  s_lshr_b32 s47, s42, 1
  s_lshl_b32 s47, s47, 4
  s_add_u32 s46, s46, s47
  v_add_u32 v8, s46, v8
  v_mul_u32_u24 v8, 1280, v8
  v_lshrrev_b32 v13, 1, v13
  v_bfe_u32 v14, v0, 1, 2
  v_xor_b32 v13, v13, v14
  v_lshlrev_b32 v13, 5, v13
  v_and_b32 v14, 1, v0
  v_lshlrev_b32 v14, 4, v14
  v_add3_u32 v8, v8, v13, v14
  v_lshrrev_b32 v13, 5, v0
  v_lshlrev_b32 v9, 11, v13
  v_bfe_u32 v13, v0, 2, 3
  v_lshl_add_u32 v9, v13, 7, v9
  v_lshrrev_b32 v13, 1, v13
  v_xor_b32 v13, s42, v13
  v_lshl_add_u32 v9, v13, 5, v9
  v_and_b32 v13, 3, v0
  v_lshl_add_u32 v9, v13, 3, v9
  v_add_u32 v10, 0x10000, v9
  v_add_u32 v11, 0x20000, v9
  s_add_u32 m0, s51, 0
  s_add_u32 s46, s66, 0
  buffer_load_dwordx4 v8, s[4:7], s46 offen  lds
  s_add_u32 m0, s51, 4096
  s_add_u32 s46, s66, 128
  buffer_load_dwordx4 v8, s[4:7], s46 offen  lds
  s_add_u32 m0, s51, 8192
  s_add_u32 s46, s66, 256
  buffer_load_dwordx4 v8, s[4:7], s46 offen  lds
  s_add_u32 m0, s51, 12288
  s_add_u32 s46, s66, 384
  buffer_load_dwordx4 v8, s[4:7], s46 offen  lds
  s_add_u32 m0, s51, 16384
  s_add_u32 s46, s66, 512
  buffer_load_dwordx4 v8, s[4:7], s46 offen  lds
  s_add_u32 m0, s51, 20480
  s_add_u32 s46, s66, 640
  buffer_load_dwordx4 v8, s[4:7], s46 offen  lds
  s_add_u32 m0, s51, 24576
  s_add_u32 s46, s66, 768
  buffer_load_dwordx4 v8, s[4:7], s46 offen  lds
  s_add_u32 m0, s51, 28672
  s_add_u32 s46, s66, 896
  buffer_load_dwordx4 v8, s[4:7], s46 offen  lds
  s_add_u32 m0, s51, 32768
  s_add_u32 s46, s66, 1024
  buffer_load_dwordx4 v8, s[4:7], s46 offen  lds
  s_add_u32 m0, s51, 36864
  s_add_u32 s46, s66, 1152
  buffer_load_dwordx4 v8, s[4:7], s46 offen  lds
  s_add_u32 m0, s51, 40960
  s_add_u32 s46, s66, 40960
  buffer_load_dwordx4 v8, s[4:7], s46 offen  lds
  s_add_u32 m0, s51, 45056
  s_add_u32 s46, s66, 41088
  buffer_load_dwordx4 v8, s[4:7], s46 offen  lds
  s_add_u32 m0, s51, 49152
  s_add_u32 s46, s66, 41216
  buffer_load_dwordx4 v8, s[4:7], s46 offen  lds
  s_add_u32 m0, s51, 53248
  s_add_u32 s46, s66, 41344
  buffer_load_dwordx4 v8, s[4:7], s46 offen  lds
  s_add_u32 m0, s51, 57344
  s_add_u32 s46, s66, 41472
  buffer_load_dwordx4 v8, s[4:7], s46 offen  lds
  s_add_u32 m0, s51, 61440
  s_add_u32 s46, s66, 41600
  buffer_load_dwordx4 v8, s[4:7], s46 offen  lds
  s_add_u32 m0, s51, 65536
  s_add_u32 s46, s66, 41728
  buffer_load_dwordx4 v8, s[4:7], s46 offen  lds
  s_add_u32 m0, s51, 69632
  s_add_u32 s46, s66, 41856
  buffer_load_dwordx4 v8, s[4:7], s46 offen  lds
  s_add_u32 m0, s51, 73728
  s_add_u32 s46, s66, 41984
  buffer_load_dwordx4 v8, s[4:7], s46 offen  lds
  s_add_u32 m0, s51, 77824
  s_add_u32 s46, s66, 42112
  buffer_load_dwordx4 v8, s[4:7], s46 offen  lds
  s_add_u32 m0, s51, 81920
  s_add_u32 s46, s66, 81920
  buffer_load_dwordx4 v8, s[4:7], s46 offen  lds
  s_add_u32 m0, s51, 86016
  s_add_u32 s46, s66, 82048
  buffer_load_dwordx4 v8, s[4:7], s46 offen  lds
  s_add_u32 m0, s51, 90112
  s_add_u32 s46, s66, 82176
  buffer_load_dwordx4 v8, s[4:7], s46 offen  lds
  s_add_u32 m0, s51, 94208
  s_add_u32 s46, s66, 82304
  buffer_load_dwordx4 v8, s[4:7], s46 offen  lds
  s_add_u32 m0, s51, 98304
  s_add_u32 s46, s66, 82432
  buffer_load_dwordx4 v8, s[4:7], s46 offen  lds
  s_waitcnt vmcnt(20)
  s_barrier
  s_add_u32 m0, s51, 102400
  s_add_u32 s46, s66, 82560
  buffer_load_dwordx4 v8, s[4:7], s46 offen  lds
  s_add_u32 m0, s51, 106496
  s_add_u32 s46, s66, 82688
  buffer_load_dwordx4 v8, s[4:7], s46 offen  lds
  s_add_u32 m0, s51, 110592
  s_add_u32 s46, s66, 82816
  buffer_load_dwordx4 v8, s[4:7], s46 offen  lds
  s_add_u32 m0, s51, 114688
  s_add_u32 s46, s66, 82944
  buffer_load_dwordx4 v8, s[4:7], s46 offen  lds
  s_add_u32 m0, s51, 118784
  s_add_u32 s46, s66, 83072
  buffer_load_dwordx4 v8, s[4:7], s46 offen  lds
  ds_read_b64_tr_b16 v[100:101], v9 offset:0
  ds_read_b64_tr_b16 v[102:103], v9 offset:1024
  ds_read_b64_tr_b16 v[104:105], v9 offset:4096
  ds_read_b64_tr_b16 v[106:107], v9 offset:5120
  ds_read_b64_tr_b16 v[108:109], v9 offset:8192
  ds_read_b64_tr_b16 v[110:111], v9 offset:9216
  ds_read_b64_tr_b16 v[112:113], v9 offset:12288
  ds_read_b64_tr_b16 v[114:115], v9 offset:13312
  ds_read_b64_tr_b16 v[116:117], v9 offset:16384
  ds_read_b64_tr_b16 v[118:119], v9 offset:17408
  s_waitcnt lgkmcnt(0)
  v_mfma_f32_16x16x32_bf16 v[140:143], v[100:103], v[20:23], 0
  v_mfma_f32_16x16x32_bf16 v[144:147], v[104:107], v[20:23], 0
  v_mfma_f32_16x16x32_bf16 v[148:151], v[108:111], v[20:23], 0
  v_mfma_f32_16x16x32_bf16 v[152:155], v[112:115], v[20:23], 0
  v_mfma_f32_16x16x32_bf16 v[156:159], v[116:119], v[20:23], 0
  s_waitcnt vmcnt(20)
  s_barrier
  s_add_u32 m0, s51, 0
  s_add_u32 s46, s66, 122880
  buffer_load_dwordx4 v8, s[4:7], s46 offen  lds
  s_add_u32 m0, s51, 4096
  s_add_u32 s46, s66, 123008
  buffer_load_dwordx4 v8, s[4:7], s46 offen  lds
  s_add_u32 m0, s51, 8192
  s_add_u32 s46, s66, 123136
  buffer_load_dwordx4 v8, s[4:7], s46 offen  lds
  s_add_u32 m0, s51, 12288
  s_add_u32 s46, s66, 123264
  buffer_load_dwordx4 v8, s[4:7], s46 offen  lds
  s_add_u32 m0, s51, 16384
  s_add_u32 s46, s66, 123392
  buffer_load_dwordx4 v8, s[4:7], s46 offen  lds
  ds_read_b64_tr_b16 v[120:121], v9 offset:20480
  ds_read_b64_tr_b16 v[122:123], v9 offset:21504
  ds_read_b64_tr_b16 v[124:125], v9 offset:24576
  ds_read_b64_tr_b16 v[126:127], v9 offset:25600
  ds_read_b64_tr_b16 v[128:129], v9 offset:28672
  ds_read_b64_tr_b16 v[130:131], v9 offset:29696
  ds_read_b64_tr_b16 v[132:133], v9 offset:32768
  ds_read_b64_tr_b16 v[134:135], v9 offset:33792
  ds_read_b64_tr_b16 v[136:137], v9 offset:36864
  ds_read_b64_tr_b16 v[138:139], v9 offset:37888
  s_waitcnt lgkmcnt(0)
  v_mfma_f32_16x16x32_bf16 v[160:163], v[120:123], v[20:23], 0
  v_mfma_f32_16x16x32_bf16 v[164:167], v[124:127], v[20:23], 0
  v_mfma_f32_16x16x32_bf16 v[168:171], v[128:131], v[20:23], 0
  v_mfma_f32_16x16x32_bf16 v[172:175], v[132:135], v[20:23], 0
  v_mfma_f32_16x16x32_bf16 v[176:179], v[136:139], v[20:23], 0
  s_waitcnt vmcnt(20)
  s_barrier
  s_add_u32 m0, s51, 20480
  s_add_u32 s46, s66, 123520
  buffer_load_dwordx4 v8, s[4:7], s46 offen  lds
  s_add_u32 m0, s51, 24576
  s_add_u32 s46, s66, 123648
  buffer_load_dwordx4 v8, s[4:7], s46 offen  lds
  s_add_u32 m0, s51, 28672
  s_add_u32 s46, s66, 123776
  buffer_load_dwordx4 v8, s[4:7], s46 offen  lds
  s_add_u32 m0, s51, 32768
  s_add_u32 s46, s66, 123904
  buffer_load_dwordx4 v8, s[4:7], s46 offen  lds
  s_add_u32 m0, s51, 36864
  s_add_u32 s46, s66, 124032
  buffer_load_dwordx4 v8, s[4:7], s46 offen  lds
  ds_read_b64_tr_b16 v[100:101], v9 offset:40960
  ds_read_b64_tr_b16 v[102:103], v9 offset:41984
  ds_read_b64_tr_b16 v[104:105], v9 offset:45056
  ds_read_b64_tr_b16 v[106:107], v9 offset:46080
  ds_read_b64_tr_b16 v[108:109], v9 offset:49152
  ds_read_b64_tr_b16 v[110:111], v9 offset:50176
  ds_read_b64_tr_b16 v[112:113], v9 offset:53248
  ds_read_b64_tr_b16 v[114:115], v9 offset:54272
  ds_read_b64_tr_b16 v[116:117], v9 offset:57344
  ds_read_b64_tr_b16 v[118:119], v9 offset:58368
  s_waitcnt lgkmcnt(0)
  v_mfma_f32_16x16x32_bf16 v[140:143], v[100:103], v[24:27], v[140:143]
  v_mfma_f32_16x16x32_bf16 v[144:147], v[104:107], v[24:27], v[144:147]
  v_mfma_f32_16x16x32_bf16 v[148:151], v[108:111], v[24:27], v[148:151]
  v_mfma_f32_16x16x32_bf16 v[152:155], v[112:115], v[24:27], v[152:155]
  v_mfma_f32_16x16x32_bf16 v[156:159], v[116:119], v[24:27], v[156:159]
  s_waitcnt vmcnt(20)
  s_barrier
  s_add_u32 m0, s51, 40960
  s_add_u32 s46, s66, 163840
  buffer_load_dwordx4 v8, s[4:7], s46 offen  lds
  s_add_u32 m0, s51, 45056
  s_add_u32 s46, s66, 163968
  buffer_load_dwordx4 v8, s[4:7], s46 offen  lds
  s_add_u32 m0, s51, 49152
  s_add_u32 s46, s66, 164096
  buffer_load_dwordx4 v8, s[4:7], s46 offen  lds
  s_add_u32 m0, s51, 53248
  s_add_u32 s46, s66, 164224
  buffer_load_dwordx4 v8, s[4:7], s46 offen  lds
  s_add_u32 m0, s51, 57344
  s_add_u32 s46, s66, 164352
  buffer_load_dwordx4 v8, s[4:7], s46 offen  lds
  ds_read_b64_tr_b16 v[120:121], v9 offset:61440
  ds_read_b64_tr_b16 v[122:123], v9 offset:62464
  ds_read_b64_tr_b16 v[124:125], v10 offset:0
  ds_read_b64_tr_b16 v[126:127], v10 offset:1024
  ds_read_b64_tr_b16 v[128:129], v10 offset:4096
  ds_read_b64_tr_b16 v[130:131], v10 offset:5120
  ds_read_b64_tr_b16 v[132:133], v10 offset:8192
  ds_read_b64_tr_b16 v[134:135], v10 offset:9216
  ds_read_b64_tr_b16 v[136:137], v10 offset:12288
  ds_read_b64_tr_b16 v[138:139], v10 offset:13312
  s_waitcnt lgkmcnt(0)
  v_mfma_f32_16x16x32_bf16 v[160:163], v[120:123], v[24:27], v[160:163]
  v_mfma_f32_16x16x32_bf16 v[164:167], v[124:127], v[24:27], v[164:167]
  v_mfma_f32_16x16x32_bf16 v[168:171], v[128:131], v[24:27], v[168:171]
  v_mfma_f32_16x16x32_bf16 v[172:175], v[132:135], v[24:27], v[172:175]
  v_mfma_f32_16x16x32_bf16 v[176:179], v[136:139], v[24:27], v[176:179]
  s_waitcnt vmcnt(20)
  s_barrier
  s_add_u32 m0, s51, 61440
  s_add_u32 s46, s66, 164480
  buffer_load_dwordx4 v8, s[4:7], s46 offen  lds
  s_add_u32 m0, s51, 65536
  s_add_u32 s46, s66, 164608
  buffer_load_dwordx4 v8, s[4:7], s46 offen  lds
  s_add_u32 m0, s51, 69632
  s_add_u32 s46, s66, 164736
  buffer_load_dwordx4 v8, s[4:7], s46 offen  lds
  s_add_u32 m0, s51, 73728
  s_add_u32 s46, s66, 164864
  buffer_load_dwordx4 v8, s[4:7], s46 offen  lds
  s_add_u32 m0, s51, 77824
  s_add_u32 s46, s66, 164992
  buffer_load_dwordx4 v8, s[4:7], s46 offen  lds
  ds_read_b64_tr_b16 v[100:101], v10 offset:16384
  ds_read_b64_tr_b16 v[102:103], v10 offset:17408
  ds_read_b64_tr_b16 v[104:105], v10 offset:20480
  ds_read_b64_tr_b16 v[106:107], v10 offset:21504
  ds_read_b64_tr_b16 v[108:109], v10 offset:24576
  ds_read_b64_tr_b16 v[110:111], v10 offset:25600
  ds_read_b64_tr_b16 v[112:113], v10 offset:28672
  ds_read_b64_tr_b16 v[114:115], v10 offset:29696
  ds_read_b64_tr_b16 v[116:117], v10 offset:32768
  ds_read_b64_tr_b16 v[118:119], v10 offset:33792
  s_waitcnt lgkmcnt(0)
  v_mfma_f32_16x16x32_bf16 v[140:143], v[100:103], v[28:31], v[140:143]
  v_mfma_f32_16x16x32_bf16 v[144:147], v[104:107], v[28:31], v[144:147]
  v_mfma_f32_16x16x32_bf16 v[148:151], v[108:111], v[28:31], v[148:151]
  v_mfma_f32_16x16x32_bf16 v[152:155], v[112:115], v[28:31], v[152:155]
  v_mfma_f32_16x16x32_bf16 v[156:159], v[116:119], v[28:31], v[156:159]
  s_waitcnt vmcnt(20)
  s_barrier
  s_add_u32 m0, s51, 81920
  s_add_u32 s46, s66, 204800
  buffer_load_dwordx4 v8, s[4:7], s46 offen  lds
  s_add_u32 m0, s51, 86016
  s_add_u32 s46, s66, 204928
  buffer_load_dwordx4 v8, s[4:7], s46 offen  lds
  s_add_u32 m0, s51, 90112
  s_add_u32 s46, s66, 205056
  buffer_load_dwordx4 v8, s[4:7], s46 offen  lds
  s_add_u32 m0, s51, 94208
  s_add_u32 s46, s66, 205184
  buffer_load_dwordx4 v8, s[4:7], s46 offen  lds
  s_add_u32 m0, s51, 98304
  s_add_u32 s46, s66, 205312
  buffer_load_dwordx4 v8, s[4:7], s46 offen  lds
  ds_read_b64_tr_b16 v[120:121], v10 offset:36864
  ds_read_b64_tr_b16 v[122:123], v10 offset:37888
  ds_read_b64_tr_b16 v[124:125], v10 offset:40960
  ds_read_b64_tr_b16 v[126:127], v10 offset:41984
  ds_read_b64_tr_b16 v[128:129], v10 offset:45056
  ds_read_b64_tr_b16 v[130:131], v10 offset:46080
  ds_read_b64_tr_b16 v[132:133], v10 offset:49152
  ds_read_b64_tr_b16 v[134:135], v10 offset:50176
  ds_read_b64_tr_b16 v[136:137], v10 offset:53248
  ds_read_b64_tr_b16 v[138:139], v10 offset:54272
  s_waitcnt lgkmcnt(0)
  v_mfma_f32_16x16x32_bf16 v[160:163], v[120:123], v[28:31], v[160:163]
  v_mfma_f32_16x16x32_bf16 v[164:167], v[124:127], v[28:31], v[164:167]
  v_mfma_f32_16x16x32_bf16 v[168:171], v[128:131], v[28:31], v[168:171]
  v_mfma_f32_16x16x32_bf16 v[172:175], v[132:135], v[28:31], v[172:175]
  v_mfma_f32_16x16x32_bf16 v[176:179], v[136:139], v[28:31], v[176:179]
  s_waitcnt vmcnt(20)
  s_barrier
  s_add_u32 m0, s51, 102400
  s_add_u32 s46, s66, 205440
  buffer_load_dwordx4 v8, s[4:7], s46 offen  lds
  s_add_u32 m0, s51, 106496
  s_add_u32 s46, s66, 205568
  buffer_load_dwordx4 v8, s[4:7], s46 offen  lds
  s_add_u32 m0, s51, 110592
  s_add_u32 s46, s66, 205696
  buffer_load_dwordx4 v8, s[4:7], s46 offen  lds
  s_add_u32 m0, s51, 114688
  s_add_u32 s46, s66, 205824
  buffer_load_dwordx4 v8, s[4:7], s46 offen  lds
  s_add_u32 m0, s51, 118784
  s_add_u32 s46, s66, 205952
  buffer_load_dwordx4 v8, s[4:7], s46 offen  lds
  ds_read_b64_tr_b16 v[100:101], v9 offset:0
  ds_read_b64_tr_b16 v[102:103], v9 offset:1024
  ds_read_b64_tr_b16 v[104:105], v9 offset:4096
  ds_read_b64_tr_b16 v[106:107], v9 offset:5120
  ds_read_b64_tr_b16 v[108:109], v9 offset:8192
  ds_read_b64_tr_b16 v[110:111], v9 offset:9216
  ds_read_b64_tr_b16 v[112:113], v9 offset:12288
  ds_read_b64_tr_b16 v[114:115], v9 offset:13312
  ds_read_b64_tr_b16 v[116:117], v9 offset:16384
  ds_read_b64_tr_b16 v[118:119], v9 offset:17408
  s_waitcnt lgkmcnt(0)
  v_mfma_f32_16x16x32_bf16 v[140:143], v[100:103], v[32:35], v[140:143]
  v_mfma_f32_16x16x32_bf16 v[144:147], v[104:107], v[32:35], v[144:147]
  v_mfma_f32_16x16x32_bf16 v[148:151], v[108:111], v[32:35], v[148:151]
  v_mfma_f32_16x16x32_bf16 v[152:155], v[112:115], v[32:35], v[152:155]
  v_mfma_f32_16x16x32_bf16 v[156:159], v[116:119], v[32:35], v[156:159]
  s_waitcnt vmcnt(20)
  s_barrier
  s_add_u32 m0, s51, 0
  s_add_u32 s46, s66, 245760
  buffer_load_dwordx4 v8, s[4:7], s46 offen  lds
  s_add_u32 m0, s51, 4096
  s_add_u32 s46, s66, 245888
  buffer_load_dwordx4 v8, s[4:7], s46 offen  lds
  s_add_u32 m0, s51, 8192
  s_add_u32 s46, s66, 246016
  buffer_load_dwordx4 v8, s[4:7], s46 offen  lds
  s_add_u32 m0, s51, 12288
  s_add_u32 s46, s66, 246144
  buffer_load_dwordx4 v8, s[4:7], s46 offen  lds
  s_add_u32 m0, s51, 16384
  s_add_u32 s46, s66, 246272
  buffer_load_dwordx4 v8, s[4:7], s46 offen  lds
  ds_read_b64_tr_b16 v[120:121], v9 offset:20480
  ds_read_b64_tr_b16 v[122:123], v9 offset:21504
  ds_read_b64_tr_b16 v[124:125], v9 offset:24576
  ds_read_b64_tr_b16 v[126:127], v9 offset:25600
  ds_read_b64_tr_b16 v[128:129], v9 offset:28672
  ds_read_b64_tr_b16 v[130:131], v9 offset:29696
  ds_read_b64_tr_b16 v[132:133], v9 offset:32768
  ds_read_b64_tr_b16 v[134:135], v9 offset:33792
  ds_read_b64_tr_b16 v[136:137], v9 offset:36864
  ds_read_b64_tr_b16 v[138:139], v9 offset:37888
  s_waitcnt lgkmcnt(0)
  v_mfma_f32_16x16x32_bf16 v[160:163], v[120:123], v[32:35], v[160:163]
  v_mfma_f32_16x16x32_bf16 v[164:167], v[124:127], v[32:35], v[164:167]
  v_mfma_f32_16x16x32_bf16 v[168:171], v[128:131], v[32:35], v[168:171]
  v_mfma_f32_16x16x32_bf16 v[172:175], v[132:135], v[32:35], v[172:175]
  v_mfma_f32_16x16x32_bf16 v[176:179], v[136:139], v[32:35], v[176:179]
  s_waitcnt vmcnt(20)
  s_barrier
  s_add_u32 m0, s51, 20480
  s_add_u32 s46, s66, 246400
  buffer_load_dwordx4 v8, s[4:7], s46 offen  lds
  s_add_u32 m0, s51, 24576
  s_add_u32 s46, s66, 246528
  buffer_load_dwordx4 v8, s[4:7], s46 offen  lds
  s_add_u32 m0, s51, 28672
  s_add_u32 s46, s66, 246656
  buffer_load_dwordx4 v8, s[4:7], s46 offen  lds
  s_add_u32 m0, s51, 32768
  s_add_u32 s46, s66, 246784
  buffer_load_dwordx4 v8, s[4:7], s46 offen  lds
  s_add_u32 m0, s51, 36864
  s_add_u32 s46, s66, 246912
  buffer_load_dwordx4 v8, s[4:7], s46 offen  lds
  ds_read_b64_tr_b16 v[100:101], v9 offset:40960
  ds_read_b64_tr_b16 v[102:103], v9 offset:41984
  ds_read_b64_tr_b16 v[104:105], v9 offset:45056
  ds_read_b64_tr_b16 v[106:107], v9 offset:46080
  ds_read_b64_tr_b16 v[108:109], v9 offset:49152
  ds_read_b64_tr_b16 v[110:111], v9 offset:50176
  ds_read_b64_tr_b16 v[112:113], v9 offset:53248
  ds_read_b64_tr_b16 v[114:115], v9 offset:54272
  ds_read_b64_tr_b16 v[116:117], v9 offset:57344
  ds_read_b64_tr_b16 v[118:119], v9 offset:58368
  s_waitcnt lgkmcnt(0)
  v_mfma_f32_16x16x32_bf16 v[140:143], v[100:103], v[36:39], v[140:143]
  v_mfma_f32_16x16x32_bf16 v[144:147], v[104:107], v[36:39], v[144:147]
  v_mfma_f32_16x16x32_bf16 v[148:151], v[108:111], v[36:39], v[148:151]
  v_mfma_f32_16x16x32_bf16 v[152:155], v[112:115], v[36:39], v[152:155]
  v_mfma_f32_16x16x32_bf16 v[156:159], v[116:119], v[36:39], v[156:159]
  s_waitcnt vmcnt(20)
  s_barrier
  s_add_u32 m0, s51, 40960
  s_add_u32 s46, s66, 286720
  buffer_load_dwordx4 v8, s[4:7], s46 offen  lds
  s_add_u32 m0, s51, 45056
  s_add_u32 s46, s66, 286848
  buffer_load_dwordx4 v8, s[4:7], s46 offen  lds
  s_add_u32 m0, s51, 49152
  s_add_u32 s46, s66, 286976
  buffer_load_dwordx4 v8, s[4:7], s46 offen  lds
  s_add_u32 m0, s51, 53248
  s_add_u32 s46, s66, 287104
  buffer_load_dwordx4 v8, s[4:7], s46 offen  lds
  s_add_u32 m0, s51, 57344
  s_add_u32 s46, s66, 287232
  buffer_load_dwordx4 v8, s[4:7], s46 offen  lds
  ds_read_b64_tr_b16 v[120:121], v9 offset:61440
  ds_read_b64_tr_b16 v[122:123], v9 offset:62464
  ds_read_b64_tr_b16 v[124:125], v10 offset:0
  ds_read_b64_tr_b16 v[126:127], v10 offset:1024
  ds_read_b64_tr_b16 v[128:129], v10 offset:4096
  ds_read_b64_tr_b16 v[130:131], v10 offset:5120
  ds_read_b64_tr_b16 v[132:133], v10 offset:8192
  ds_read_b64_tr_b16 v[134:135], v10 offset:9216
  ds_read_b64_tr_b16 v[136:137], v10 offset:12288
  ds_read_b64_tr_b16 v[138:139], v10 offset:13312
  s_waitcnt lgkmcnt(0)
  v_mfma_f32_16x16x32_bf16 v[160:163], v[120:123], v[36:39], v[160:163]
  v_mfma_f32_16x16x32_bf16 v[164:167], v[124:127], v[36:39], v[164:167]
  v_mfma_f32_16x16x32_bf16 v[168:171], v[128:131], v[36:39], v[168:171]
  v_mfma_f32_16x16x32_bf16 v[172:175], v[132:135], v[36:39], v[172:175]
  v_mfma_f32_16x16x32_bf16 v[176:179], v[136:139], v[36:39], v[176:179]
  s_waitcnt vmcnt(20)
  s_barrier
  s_add_u32 m0, s51, 61440
  s_add_u32 s46, s66, 287360
  buffer_load_dwordx4 v8, s[4:7], s46 offen  lds
  s_add_u32 m0, s51, 65536
  s_add_u32 s46, s66, 287488
  buffer_load_dwordx4 v8, s[4:7], s46 offen  lds
  s_add_u32 m0, s51, 69632
  s_add_u32 s46, s66, 287616
  buffer_load_dwordx4 v8, s[4:7], s46 offen  lds
  s_add_u32 m0, s51, 73728
  s_add_u32 s46, s66, 287744
  buffer_load_dwordx4 v8, s[4:7], s46 offen  lds
  s_add_u32 m0, s51, 77824
  s_add_u32 s46, s66, 287872
  buffer_load_dwordx4 v8, s[4:7], s46 offen  lds
  ds_read_b64_tr_b16 v[100:101], v10 offset:16384
  ds_read_b64_tr_b16 v[102:103], v10 offset:17408
  ds_read_b64_tr_b16 v[104:105], v10 offset:20480
  ds_read_b64_tr_b16 v[106:107], v10 offset:21504
  ds_read_b64_tr_b16 v[108:109], v10 offset:24576
  ds_read_b64_tr_b16 v[110:111], v10 offset:25600
  ds_read_b64_tr_b16 v[112:113], v10 offset:28672
  ds_read_b64_tr_b16 v[114:115], v10 offset:29696
  ds_read_b64_tr_b16 v[116:117], v10 offset:32768
  ds_read_b64_tr_b16 v[118:119], v10 offset:33792
  s_waitcnt lgkmcnt(0)
  v_mfma_f32_16x16x32_bf16 v[140:143], v[100:103], v[40:43], v[140:143]
  v_mfma_f32_16x16x32_bf16 v[144:147], v[104:107], v[40:43], v[144:147]
  v_mfma_f32_16x16x32_bf16 v[148:151], v[108:111], v[40:43], v[148:151]
  v_mfma_f32_16x16x32_bf16 v[152:155], v[112:115], v[40:43], v[152:155]
  v_mfma_f32_16x16x32_bf16 v[156:159], v[116:119], v[40:43], v[156:159]
  s_waitcnt vmcnt(20)
  s_barrier
  s_add_u32 m0, s51, 81920
  s_add_u32 s46, s66, 327680
  buffer_load_dwordx4 v8, s[4:7], s46 offen  lds
  s_add_u32 m0, s51, 86016
  s_add_u32 s46, s66, 327808
  buffer_load_dwordx4 v8, s[4:7], s46 offen  lds
  s_add_u32 m0, s51, 90112
  s_add_u32 s46, s66, 327936
  buffer_load_dwordx4 v8, s[4:7], s46 offen  lds
  s_add_u32 m0, s51, 94208
  s_add_u32 s46, s66, 328064
  buffer_load_dwordx4 v8, s[4:7], s46 offen  lds
  s_add_u32 m0, s51, 98304
  s_add_u32 s46, s66, 328192
  buffer_load_dwordx4 v8, s[4:7], s46 offen  lds
  ds_read_b64_tr_b16 v[120:121], v10 offset:36864
  ds_read_b64_tr_b16 v[122:123], v10 offset:37888
  ds_read_b64_tr_b16 v[124:125], v10 offset:40960
  ds_read_b64_tr_b16 v[126:127], v10 offset:41984
  ds_read_b64_tr_b16 v[128:129], v10 offset:45056
  ds_read_b64_tr_b16 v[130:131], v10 offset:46080
  ds_read_b64_tr_b16 v[132:133], v10 offset:49152
  ds_read_b64_tr_b16 v[134:135], v10 offset:50176
  ds_read_b64_tr_b16 v[136:137], v10 offset:53248
  ds_read_b64_tr_b16 v[138:139], v10 offset:54272
  s_waitcnt lgkmcnt(0)
  v_mfma_f32_16x16x32_bf16 v[160:163], v[120:123], v[40:43], v[160:163]
  v_mfma_f32_16x16x32_bf16 v[164:167], v[124:127], v[40:43], v[164:167]
  v_mfma_f32_16x16x32_bf16 v[168:171], v[128:131], v[40:43], v[168:171]
  v_mfma_f32_16x16x32_bf16 v[172:175], v[132:135], v[40:43], v[172:175]
  v_mfma_f32_16x16x32_bf16 v[176:179], v[136:139], v[40:43], v[176:179]
  s_waitcnt vmcnt(20)
  s_barrier
  s_add_u32 m0, s51, 102400
  s_add_u32 s46, s66, 328320
  buffer_load_dwordx4 v8, s[4:7], s46 offen  lds
  s_add_u32 m0, s51, 106496
  s_add_u32 s46, s66, 328448
  buffer_load_dwordx4 v8, s[4:7], s46 offen  lds
  s_add_u32 m0, s51, 110592
  s_add_u32 s46, s66, 328576
  buffer_load_dwordx4 v8, s[4:7], s46 offen  lds
  s_add_u32 m0, s51, 114688
  s_add_u32 s46, s66, 328704
  buffer_load_dwordx4 v8, s[4:7], s46 offen  lds
  s_add_u32 m0, s51, 118784
  s_add_u32 s46, s66, 328832
  buffer_load_dwordx4 v8, s[4:7], s46 offen  lds
  ds_read_b64_tr_b16 v[100:101], v9 offset:0
  ds_read_b64_tr_b16 v[102:103], v9 offset:1024
  ds_read_b64_tr_b16 v[104:105], v9 offset:4096
  ds_read_b64_tr_b16 v[106:107], v9 offset:5120
  ds_read_b64_tr_b16 v[108:109], v9 offset:8192
  ds_read_b64_tr_b16 v[110:111], v9 offset:9216
  ds_read_b64_tr_b16 v[112:113], v9 offset:12288
  ds_read_b64_tr_b16 v[114:115], v9 offset:13312
  ds_read_b64_tr_b16 v[116:117], v9 offset:16384
  ds_read_b64_tr_b16 v[118:119], v9 offset:17408
  s_waitcnt lgkmcnt(0)
  v_mfma_f32_16x16x32_bf16 v[140:143], v[100:103], v[44:47], v[140:143]
  v_mfma_f32_16x16x32_bf16 v[144:147], v[104:107], v[44:47], v[144:147]
  v_mfma_f32_16x16x32_bf16 v[148:151], v[108:111], v[44:47], v[148:151]
  v_mfma_f32_16x16x32_bf16 v[152:155], v[112:115], v[44:47], v[152:155]
  v_mfma_f32_16x16x32_bf16 v[156:159], v[116:119], v[44:47], v[156:159]
  s_waitcnt vmcnt(20)
  s_barrier
  s_add_u32 m0, s51, 0
  s_add_u32 s46, s66, 368640
  buffer_load_dwordx4 v8, s[4:7], s46 offen  lds
  s_add_u32 m0, s51, 4096
  s_add_u32 s46, s66, 368768
  buffer_load_dwordx4 v8, s[4:7], s46 offen  lds
  s_add_u32 m0, s51, 8192
  s_add_u32 s46, s66, 368896
  buffer_load_dwordx4 v8, s[4:7], s46 offen  lds
  s_add_u32 m0, s51, 12288
  s_add_u32 s46, s66, 369024
  buffer_load_dwordx4 v8, s[4:7], s46 offen  lds
  s_add_u32 m0, s51, 16384
  s_add_u32 s46, s66, 369152
  buffer_load_dwordx4 v8, s[4:7], s46 offen  lds
  ds_read_b64_tr_b16 v[120:121], v9 offset:20480
  ds_read_b64_tr_b16 v[122:123], v9 offset:21504
  ds_read_b64_tr_b16 v[124:125], v9 offset:24576
  ds_read_b64_tr_b16 v[126:127], v9 offset:25600
  ds_read_b64_tr_b16 v[128:129], v9 offset:28672
  ds_read_b64_tr_b16 v[130:131], v9 offset:29696
  ds_read_b64_tr_b16 v[132:133], v9 offset:32768
  ds_read_b64_tr_b16 v[134:135], v9 offset:33792
  ds_read_b64_tr_b16 v[136:137], v9 offset:36864
  ds_read_b64_tr_b16 v[138:139], v9 offset:37888
  s_waitcnt lgkmcnt(0)
  v_mfma_f32_16x16x32_bf16 v[160:163], v[120:123], v[44:47], v[160:163]
  v_mfma_f32_16x16x32_bf16 v[164:167], v[124:127], v[44:47], v[164:167]
  v_mfma_f32_16x16x32_bf16 v[168:171], v[128:131], v[44:47], v[168:171]
  v_mfma_f32_16x16x32_bf16 v[172:175], v[132:135], v[44:47], v[172:175]
  v_mfma_f32_16x16x32_bf16 v[176:179], v[136:139], v[44:47], v[176:179]
  s_waitcnt vmcnt(20)
  s_barrier
  s_add_u32 m0, s51, 20480
  s_add_u32 s46, s66, 369280
  buffer_load_dwordx4 v8, s[4:7], s46 offen  lds
  s_add_u32 m0, s51, 24576
  s_add_u32 s46, s66, 369408
  buffer_load_dwordx4 v8, s[4:7], s46 offen  lds
  s_add_u32 m0, s51, 28672
  s_add_u32 s46, s66, 369536
  buffer_load_dwordx4 v8, s[4:7], s46 offen  lds
  s_add_u32 m0, s51, 32768
  s_add_u32 s46, s66, 369664
  buffer_load_dwordx4 v8, s[4:7], s46 offen  lds
  s_add_u32 m0, s51, 36864
  s_add_u32 s46, s66, 369792
  buffer_load_dwordx4 v8, s[4:7], s46 offen  lds
  ds_read_b64_tr_b16 v[100:101], v9 offset:40960
  ds_read_b64_tr_b16 v[102:103], v9 offset:41984
  ds_read_b64_tr_b16 v[104:105], v9 offset:45056
  ds_read_b64_tr_b16 v[106:107], v9 offset:46080
  ds_read_b64_tr_b16 v[108:109], v9 offset:49152
  ds_read_b64_tr_b16 v[110:111], v9 offset:50176
  ds_read_b64_tr_b16 v[112:113], v9 offset:53248
  ds_read_b64_tr_b16 v[114:115], v9 offset:54272
  ds_read_b64_tr_b16 v[116:117], v9 offset:57344
  ds_read_b64_tr_b16 v[118:119], v9 offset:58368
  s_waitcnt lgkmcnt(0)
  v_mfma_f32_16x16x32_bf16 v[140:143], v[100:103], v[48:51], v[140:143]
  v_mfma_f32_16x16x32_bf16 v[144:147], v[104:107], v[48:51], v[144:147]
  v_mfma_f32_16x16x32_bf16 v[148:151], v[108:111], v[48:51], v[148:151]
  v_mfma_f32_16x16x32_bf16 v[152:155], v[112:115], v[48:51], v[152:155]
  v_mfma_f32_16x16x32_bf16 v[156:159], v[116:119], v[48:51], v[156:159]
  s_waitcnt vmcnt(20)
  s_barrier
  s_add_u32 m0, s51, 40960
  s_add_u32 s46, s66, 409600
  buffer_load_dwordx4 v8, s[4:7], s46 offen  lds
  s_add_u32 m0, s51, 45056
  s_add_u32 s46, s66, 409728
  buffer_load_dwordx4 v8, s[4:7], s46 offen  lds
  s_add_u32 m0, s51, 49152
  s_add_u32 s46, s66, 409856
  buffer_load_dwordx4 v8, s[4:7], s46 offen  lds
  s_add_u32 m0, s51, 53248
  s_add_u32 s46, s66, 409984
  buffer_load_dwordx4 v8, s[4:7], s46 offen  lds
  s_add_u32 m0, s51, 57344
  s_add_u32 s46, s66, 410112
  buffer_load_dwordx4 v8, s[4:7], s46 offen  lds
  ds_read_b64_tr_b16 v[120:121], v9 offset:61440
  ds_read_b64_tr_b16 v[122:123], v9 offset:62464
  ds_read_b64_tr_b16 v[124:125], v10 offset:0
  ds_read_b64_tr_b16 v[126:127], v10 offset:1024
  ds_read_b64_tr_b16 v[128:129], v10 offset:4096
  ds_read_b64_tr_b16 v[130:131], v10 offset:5120
  ds_read_b64_tr_b16 v[132:133], v10 offset:8192
  ds_read_b64_tr_b16 v[134:135], v10 offset:9216
  ds_read_b64_tr_b16 v[136:137], v10 offset:12288
  ds_read_b64_tr_b16 v[138:139], v10 offset:13312
  s_waitcnt lgkmcnt(0)
  v_mfma_f32_16x16x32_bf16 v[160:163], v[120:123], v[48:51], v[160:163]
  v_mfma_f32_16x16x32_bf16 v[164:167], v[124:127], v[48:51], v[164:167]
  v_mfma_f32_16x16x32_bf16 v[168:171], v[128:131], v[48:51], v[168:171]
  v_mfma_f32_16x16x32_bf16 v[172:175], v[132:135], v[48:51], v[172:175]
  v_mfma_f32_16x16x32_bf16 v[176:179], v[136:139], v[48:51], v[176:179]
  s_waitcnt vmcnt(20)
  s_barrier
  s_add_u32 m0, s51, 61440
  s_add_u32 s46, s66, 410240
  buffer_load_dwordx4 v8, s[4:7], s46 offen  lds
  s_add_u32 m0, s51, 65536
  s_add_u32 s46, s66, 410368
  buffer_load_dwordx4 v8, s[4:7], s46 offen  lds
  s_add_u32 m0, s51, 69632
  s_add_u32 s46, s66, 410496
  buffer_load_dwordx4 v8, s[4:7], s46 offen  lds
  s_add_u32 m0, s51, 73728
  s_add_u32 s46, s66, 410624
  buffer_load_dwordx4 v8, s[4:7], s46 offen  lds
  s_add_u32 m0, s51, 77824
  s_add_u32 s46, s66, 410752
  buffer_load_dwordx4 v8, s[4:7], s46 offen  lds
  ds_read_b64_tr_b16 v[100:101], v10 offset:16384
  ds_read_b64_tr_b16 v[102:103], v10 offset:17408
  ds_read_b64_tr_b16 v[104:105], v10 offset:20480
  ds_read_b64_tr_b16 v[106:107], v10 offset:21504
  ds_read_b64_tr_b16 v[108:109], v10 offset:24576
  ds_read_b64_tr_b16 v[110:111], v10 offset:25600
  ds_read_b64_tr_b16 v[112:113], v10 offset:28672
  ds_read_b64_tr_b16 v[114:115], v10 offset:29696
  ds_read_b64_tr_b16 v[116:117], v10 offset:32768
  ds_read_b64_tr_b16 v[118:119], v10 offset:33792
  s_waitcnt lgkmcnt(0)
  v_mfma_f32_16x16x32_bf16 v[140:143], v[100:103], v[52:55], v[140:143]
  v_mfma_f32_16x16x32_bf16 v[144:147], v[104:107], v[52:55], v[144:147]
  v_mfma_f32_16x16x32_bf16 v[148:151], v[108:111], v[52:55], v[148:151]
  v_mfma_f32_16x16x32_bf16 v[152:155], v[112:115], v[52:55], v[152:155]
  v_mfma_f32_16x16x32_bf16 v[156:159], v[116:119], v[52:55], v[156:159]
  s_waitcnt vmcnt(20)
  s_barrier
  s_add_u32 m0, s51, 81920
  s_add_u32 s46, s66, 450560
  buffer_load_dwordx4 v8, s[4:7], s46 offen  lds
  s_add_u32 m0, s51, 86016
  s_add_u32 s46, s66, 450688
  buffer_load_dwordx4 v8, s[4:7], s46 offen  lds
  s_add_u32 m0, s51, 90112
  s_add_u32 s46, s66, 450816
  buffer_load_dwordx4 v8, s[4:7], s46 offen  lds
  s_add_u32 m0, s51, 94208
  s_add_u32 s46, s66, 450944
  buffer_load_dwordx4 v8, s[4:7], s46 offen  lds
  s_add_u32 m0, s51, 98304
  s_add_u32 s46, s66, 451072
  buffer_load_dwordx4 v8, s[4:7], s46 offen  lds
  ds_read_b64_tr_b16 v[120:121], v10 offset:36864
  ds_read_b64_tr_b16 v[122:123], v10 offset:37888
  ds_read_b64_tr_b16 v[124:125], v10 offset:40960
  ds_read_b64_tr_b16 v[126:127], v10 offset:41984
  ds_read_b64_tr_b16 v[128:129], v10 offset:45056
  ds_read_b64_tr_b16 v[130:131], v10 offset:46080
  ds_read_b64_tr_b16 v[132:133], v10 offset:49152
  ds_read_b64_tr_b16 v[134:135], v10 offset:50176
  ds_read_b64_tr_b16 v[136:137], v10 offset:53248
  ds_read_b64_tr_b16 v[138:139], v10 offset:54272
  s_waitcnt lgkmcnt(0)
  v_mfma_f32_16x16x32_bf16 v[160:163], v[120:123], v[52:55], v[160:163]
  v_mfma_f32_16x16x32_bf16 v[164:167], v[124:127], v[52:55], v[164:167]
  v_mfma_f32_16x16x32_bf16 v[168:171], v[128:131], v[52:55], v[168:171]
  v_mfma_f32_16x16x32_bf16 v[172:175], v[132:135], v[52:55], v[172:175]
  v_mfma_f32_16x16x32_bf16 v[176:179], v[136:139], v[52:55], v[176:179]
  s_waitcnt vmcnt(20)
  s_barrier
  s_add_u32 m0, s51, 102400
  s_add_u32 s46, s66, 451200
  buffer_load_dwordx4 v8, s[4:7], s46 offen  lds
  s_add_u32 m0, s51, 106496
  s_add_u32 s46, s66, 451328
  buffer_load_dwordx4 v8, s[4:7], s46 offen  lds
  s_add_u32 m0, s51, 110592
  s_add_u32 s46, s66, 451456
  buffer_load_dwordx4 v8, s[4:7], s46 offen  lds
  s_add_u32 m0, s51, 114688
  s_add_u32 s46, s66, 451584
  buffer_load_dwordx4 v8, s[4:7], s46 offen  lds
  s_add_u32 m0, s51, 118784
  s_add_u32 s46, s66, 451712
  buffer_load_dwordx4 v8, s[4:7], s46 offen  lds
  ds_read_b64_tr_b16 v[100:101], v9 offset:0
  ds_read_b64_tr_b16 v[102:103], v9 offset:1024
  ds_read_b64_tr_b16 v[104:105], v9 offset:4096
  ds_read_b64_tr_b16 v[106:107], v9 offset:5120
  ds_read_b64_tr_b16 v[108:109], v9 offset:8192
  ds_read_b64_tr_b16 v[110:111], v9 offset:9216
  ds_read_b64_tr_b16 v[112:113], v9 offset:12288
  ds_read_b64_tr_b16 v[114:115], v9 offset:13312
  ds_read_b64_tr_b16 v[116:117], v9 offset:16384
  ds_read_b64_tr_b16 v[118:119], v9 offset:17408
  s_waitcnt lgkmcnt(0)
  v_mfma_f32_16x16x32_bf16 v[140:143], v[100:103], v[56:59], v[140:143]
  v_mfma_f32_16x16x32_bf16 v[144:147], v[104:107], v[56:59], v[144:147]
  v_mfma_f32_16x16x32_bf16 v[148:151], v[108:111], v[56:59], v[148:151]
  v_mfma_f32_16x16x32_bf16 v[152:155], v[112:115], v[56:59], v[152:155]
  v_mfma_f32_16x16x32_bf16 v[156:159], v[116:119], v[56:59], v[156:159]
  s_waitcnt vmcnt(20)
  s_barrier
  s_add_u32 m0, s51, 0
  s_add_u32 s46, s66, 491520
  buffer_load_dwordx4 v8, s[4:7], s46 offen  lds
  s_add_u32 m0, s51, 4096
  s_add_u32 s46, s66, 491648
  buffer_load_dwordx4 v8, s[4:7], s46 offen  lds
  s_add_u32 m0, s51, 8192
  s_add_u32 s46, s66, 491776
  buffer_load_dwordx4 v8, s[4:7], s46 offen  lds
  s_add_u32 m0, s51, 12288
  s_add_u32 s46, s66, 491904
  buffer_load_dwordx4 v8, s[4:7], s46 offen  lds
  s_add_u32 m0, s51, 16384
  s_add_u32 s46, s66, 492032
  buffer_load_dwordx4 v8, s[4:7], s46 offen  lds
  ds_read_b64_tr_b16 v[120:121], v9 offset:20480
  ds_read_b64_tr_b16 v[122:123], v9 offset:21504
  ds_read_b64_tr_b16 v[124:125], v9 offset:24576
  ds_read_b64_tr_b16 v[126:127], v9 offset:25600
  ds_read_b64_tr_b16 v[128:129], v9 offset:28672
  ds_read_b64_tr_b16 v[130:131], v9 offset:29696
  ds_read_b64_tr_b16 v[132:133], v9 offset:32768
  ds_read_b64_tr_b16 v[134:135], v9 offset:33792
  ds_read_b64_tr_b16 v[136:137], v9 offset:36864
  ds_read_b64_tr_b16 v[138:139], v9 offset:37888
  s_waitcnt lgkmcnt(0)
  v_mfma_f32_16x16x32_bf16 v[160:163], v[120:123], v[56:59], v[160:163]
  v_mfma_f32_16x16x32_bf16 v[164:167], v[124:127], v[56:59], v[164:167]
  v_mfma_f32_16x16x32_bf16 v[168:171], v[128:131], v[56:59], v[168:171]
  v_mfma_f32_16x16x32_bf16 v[172:175], v[132:135], v[56:59], v[172:175]
  v_mfma_f32_16x16x32_bf16 v[176:179], v[136:139], v[56:59], v[176:179]
  s_waitcnt vmcnt(20)
  s_barrier
  s_add_u32 m0, s51, 20480
  s_add_u32 s46, s66, 492160
  buffer_load_dwordx4 v8, s[4:7], s46 offen  lds
  s_add_u32 m0, s51, 24576
  s_add_u32 s46, s66, 492288
  buffer_load_dwordx4 v8, s[4:7], s46 offen  lds
  s_add_u32 m0, s51, 28672
  s_add_u32 s46, s66, 492416
  buffer_load_dwordx4 v8, s[4:7], s46 offen  lds
  s_add_u32 m0, s51, 32768
  s_add_u32 s46, s66, 492544
  buffer_load_dwordx4 v8, s[4:7], s46 offen  lds
  s_add_u32 m0, s51, 36864
  s_add_u32 s46, s66, 492672
  buffer_load_dwordx4 v8, s[4:7], s46 offen  lds
  ds_read_b64_tr_b16 v[100:101], v9 offset:40960
  ds_read_b64_tr_b16 v[102:103], v9 offset:41984
  ds_read_b64_tr_b16 v[104:105], v9 offset:45056
  ds_read_b64_tr_b16 v[106:107], v9 offset:46080
  ds_read_b64_tr_b16 v[108:109], v9 offset:49152
  ds_read_b64_tr_b16 v[110:111], v9 offset:50176
  ds_read_b64_tr_b16 v[112:113], v9 offset:53248
  ds_read_b64_tr_b16 v[114:115], v9 offset:54272
  ds_read_b64_tr_b16 v[116:117], v9 offset:57344
  ds_read_b64_tr_b16 v[118:119], v9 offset:58368
  s_waitcnt lgkmcnt(0)
  v_mfma_f32_16x16x32_bf16 v[140:143], v[100:103], v[60:63], v[140:143]
  v_mfma_f32_16x16x32_bf16 v[144:147], v[104:107], v[60:63], v[144:147]
  v_mfma_f32_16x16x32_bf16 v[148:151], v[108:111], v[60:63], v[148:151]
  v_mfma_f32_16x16x32_bf16 v[152:155], v[112:115], v[60:63], v[152:155]
  v_mfma_f32_16x16x32_bf16 v[156:159], v[116:119], v[60:63], v[156:159]
  s_waitcnt vmcnt(20)
  s_barrier
  s_add_u32 m0, s51, 40960
  s_add_u32 s46, s66, 532480
  buffer_load_dwordx4 v8, s[4:7], s46 offen  lds
  s_add_u32 m0, s51, 45056
  s_add_u32 s46, s66, 532608
  buffer_load_dwordx4 v8, s[4:7], s46 offen  lds
  s_add_u32 m0, s51, 49152
  s_add_u32 s46, s66, 532736
  buffer_load_dwordx4 v8, s[4:7], s46 offen  lds
  s_add_u32 m0, s51, 53248
  s_add_u32 s46, s66, 532864
  buffer_load_dwordx4 v8, s[4:7], s46 offen  lds
  s_add_u32 m0, s51, 57344
  s_add_u32 s46, s66, 532992
  buffer_load_dwordx4 v8, s[4:7], s46 offen  lds
  ds_read_b64_tr_b16 v[120:121], v9 offset:61440
  ds_read_b64_tr_b16 v[122:123], v9 offset:62464
  ds_read_b64_tr_b16 v[124:125], v10 offset:0
  ds_read_b64_tr_b16 v[126:127], v10 offset:1024
  ds_read_b64_tr_b16 v[128:129], v10 offset:4096
  ds_read_b64_tr_b16 v[130:131], v10 offset:5120
  ds_read_b64_tr_b16 v[132:133], v10 offset:8192
  ds_read_b64_tr_b16 v[134:135], v10 offset:9216
  ds_read_b64_tr_b16 v[136:137], v10 offset:12288
  ds_read_b64_tr_b16 v[138:139], v10 offset:13312
  s_waitcnt lgkmcnt(0)
  v_mfma_f32_16x16x32_bf16 v[160:163], v[120:123], v[60:63], v[160:163]
  v_mfma_f32_16x16x32_bf16 v[164:167], v[124:127], v[60:63], v[164:167]
  v_mfma_f32_16x16x32_bf16 v[168:171], v[128:131], v[60:63], v[168:171]
  v_mfma_f32_16x16x32_bf16 v[172:175], v[132:135], v[60:63], v[172:175]
  v_mfma_f32_16x16x32_bf16 v[176:179], v[136:139], v[60:63], v[176:179]
  s_waitcnt vmcnt(20)
  s_barrier
  s_add_u32 m0, s51, 61440
  s_add_u32 s46, s66, 533120
  buffer_load_dwordx4 v8, s[4:7], s46 offen  lds
  s_add_u32 m0, s51, 65536
  s_add_u32 s46, s66, 533248
  buffer_load_dwordx4 v8, s[4:7], s46 offen  lds
  s_add_u32 m0, s51, 69632
  s_add_u32 s46, s66, 533376
  buffer_load_dwordx4 v8, s[4:7], s46 offen  lds
  s_add_u32 m0, s51, 73728
  s_add_u32 s46, s66, 533504
  buffer_load_dwordx4 v8, s[4:7], s46 offen  lds
  s_add_u32 m0, s51, 77824
  s_add_u32 s46, s66, 533632
  buffer_load_dwordx4 v8, s[4:7], s46 offen  lds
  ds_read_b64_tr_b16 v[100:101], v10 offset:16384
  ds_read_b64_tr_b16 v[102:103], v10 offset:17408
  ds_read_b64_tr_b16 v[104:105], v10 offset:20480
  ds_read_b64_tr_b16 v[106:107], v10 offset:21504
  ds_read_b64_tr_b16 v[108:109], v10 offset:24576
  ds_read_b64_tr_b16 v[110:111], v10 offset:25600
  ds_read_b64_tr_b16 v[112:113], v10 offset:28672
  ds_read_b64_tr_b16 v[114:115], v10 offset:29696
  ds_read_b64_tr_b16 v[116:117], v10 offset:32768
  ds_read_b64_tr_b16 v[118:119], v10 offset:33792
  s_waitcnt lgkmcnt(0)
  v_mfma_f32_16x16x32_bf16 v[140:143], v[100:103], v[64:67], v[140:143]
  v_mfma_f32_16x16x32_bf16 v[144:147], v[104:107], v[64:67], v[144:147]
  v_mfma_f32_16x16x32_bf16 v[148:151], v[108:111], v[64:67], v[148:151]
  v_mfma_f32_16x16x32_bf16 v[152:155], v[112:115], v[64:67], v[152:155]
  v_mfma_f32_16x16x32_bf16 v[156:159], v[116:119], v[64:67], v[156:159]
  s_waitcnt vmcnt(20)
  s_barrier
  s_add_u32 m0, s51, 81920
  s_add_u32 s46, s66, 573440
  buffer_load_dwordx4 v8, s[4:7], s46 offen  lds
  s_add_u32 m0, s51, 86016
  s_add_u32 s46, s66, 573568
  buffer_load_dwordx4 v8, s[4:7], s46 offen  lds
  s_add_u32 m0, s51, 90112
  s_add_u32 s46, s66, 573696
  buffer_load_dwordx4 v8, s[4:7], s46 offen  lds
  s_add_u32 m0, s51, 94208
  s_add_u32 s46, s66, 573824
  buffer_load_dwordx4 v8, s[4:7], s46 offen  lds
  s_add_u32 m0, s51, 98304
  s_add_u32 s46, s66, 573952
  buffer_load_dwordx4 v8, s[4:7], s46 offen  lds
  ds_read_b64_tr_b16 v[120:121], v10 offset:36864
  ds_read_b64_tr_b16 v[122:123], v10 offset:37888
  ds_read_b64_tr_b16 v[124:125], v10 offset:40960
  ds_read_b64_tr_b16 v[126:127], v10 offset:41984
  ds_read_b64_tr_b16 v[128:129], v10 offset:45056
  ds_read_b64_tr_b16 v[130:131], v10 offset:46080
  ds_read_b64_tr_b16 v[132:133], v10 offset:49152
  ds_read_b64_tr_b16 v[134:135], v10 offset:50176
  ds_read_b64_tr_b16 v[136:137], v10 offset:53248
  ds_read_b64_tr_b16 v[138:139], v10 offset:54272
  s_waitcnt lgkmcnt(0)
  v_mfma_f32_16x16x32_bf16 v[160:163], v[120:123], v[64:67], v[160:163]
  v_mfma_f32_16x16x32_bf16 v[164:167], v[124:127], v[64:67], v[164:167]
  v_mfma_f32_16x16x32_bf16 v[168:171], v[128:131], v[64:67], v[168:171]
  v_mfma_f32_16x16x32_bf16 v[172:175], v[132:135], v[64:67], v[172:175]
  v_mfma_f32_16x16x32_bf16 v[176:179], v[136:139], v[64:67], v[176:179]
  s_waitcnt vmcnt(20)
  s_barrier
  s_add_u32 m0, s51, 102400
  s_add_u32 s46, s66, 574080
  buffer_load_dwordx4 v8, s[4:7], s46 offen  lds
  s_add_u32 m0, s51, 106496
  s_add_u32 s46, s66, 574208
  buffer_load_dwordx4 v8, s[4:7], s46 offen  lds
  s_add_u32 m0, s51, 110592
  s_add_u32 s46, s66, 574336
  buffer_load_dwordx4 v8, s[4:7], s46 offen  lds
  s_add_u32 m0, s51, 114688
  s_add_u32 s46, s66, 574464
  buffer_load_dwordx4 v8, s[4:7], s46 offen  lds
  s_add_u32 m0, s51, 118784
  s_add_u32 s46, s66, 574592
  buffer_load_dwordx4 v8, s[4:7], s46 offen  lds
  ds_read_b64_tr_b16 v[100:101], v9 offset:0
  ds_read_b64_tr_b16 v[102:103], v9 offset:1024
  ds_read_b64_tr_b16 v[104:105], v9 offset:4096
  ds_read_b64_tr_b16 v[106:107], v9 offset:5120
  ds_read_b64_tr_b16 v[108:109], v9 offset:8192
  ds_read_b64_tr_b16 v[110:111], v9 offset:9216
  ds_read_b64_tr_b16 v[112:113], v9 offset:12288
  ds_read_b64_tr_b16 v[114:115], v9 offset:13312
  ds_read_b64_tr_b16 v[116:117], v9 offset:16384
  ds_read_b64_tr_b16 v[118:119], v9 offset:17408
  s_waitcnt lgkmcnt(0)
  v_mfma_f32_16x16x32_bf16 v[140:143], v[100:103], v[68:71], v[140:143]
  v_mfma_f32_16x16x32_bf16 v[144:147], v[104:107], v[68:71], v[144:147]
  v_mfma_f32_16x16x32_bf16 v[148:151], v[108:111], v[68:71], v[148:151]
  v_mfma_f32_16x16x32_bf16 v[152:155], v[112:115], v[68:71], v[152:155]
  v_mfma_f32_16x16x32_bf16 v[156:159], v[116:119], v[68:71], v[156:159]
  s_waitcnt vmcnt(20)
  s_barrier
  s_add_u32 m0, s51, 0
  s_add_u32 s46, s66, 614400
  buffer_load_dwordx4 v8, s[4:7], s46 offen  lds
  s_add_u32 m0, s51, 4096
  s_add_u32 s46, s66, 614528
  buffer_load_dwordx4 v8, s[4:7], s46 offen  lds
  s_add_u32 m0, s51, 8192
  s_add_u32 s46, s66, 614656
  buffer_load_dwordx4 v8, s[4:7], s46 offen  lds
  s_add_u32 m0, s51, 12288
  s_add_u32 s46, s66, 614784
  buffer_load_dwordx4 v8, s[4:7], s46 offen  lds
  s_add_u32 m0, s51, 16384
  s_add_u32 s46, s66, 614912
  buffer_load_dwordx4 v8, s[4:7], s46 offen  lds
  ds_read_b64_tr_b16 v[120:121], v9 offset:20480
  ds_read_b64_tr_b16 v[122:123], v9 offset:21504
  ds_read_b64_tr_b16 v[124:125], v9 offset:24576
  ds_read_b64_tr_b16 v[126:127], v9 offset:25600
  ds_read_b64_tr_b16 v[128:129], v9 offset:28672
  ds_read_b64_tr_b16 v[130:131], v9 offset:29696
  ds_read_b64_tr_b16 v[132:133], v9 offset:32768
  ds_read_b64_tr_b16 v[134:135], v9 offset:33792
  ds_read_b64_tr_b16 v[136:137], v9 offset:36864
  ds_read_b64_tr_b16 v[138:139], v9 offset:37888
  s_waitcnt lgkmcnt(0)
  v_mfma_f32_16x16x32_bf16 v[160:163], v[120:123], v[68:71], v[160:163]
  v_mfma_f32_16x16x32_bf16 v[164:167], v[124:127], v[68:71], v[164:167]
  v_mfma_f32_16x16x32_bf16 v[168:171], v[128:131], v[68:71], v[168:171]
  v_mfma_f32_16x16x32_bf16 v[172:175], v[132:135], v[68:71], v[172:175]
  v_mfma_f32_16x16x32_bf16 v[176:179], v[136:139], v[68:71], v[176:179]
  s_waitcnt vmcnt(20)
  s_barrier
  s_add_u32 m0, s51, 20480
  s_add_u32 s46, s66, 615040
  buffer_load_dwordx4 v8, s[4:7], s46 offen  lds
  s_add_u32 m0, s51, 24576
  s_add_u32 s46, s66, 615168
  buffer_load_dwordx4 v8, s[4:7], s46 offen  lds
  s_add_u32 m0, s51, 28672
  s_add_u32 s46, s66, 615296
  buffer_load_dwordx4 v8, s[4:7], s46 offen  lds
  s_add_u32 m0, s51, 32768
  s_add_u32 s46, s66, 615424
  buffer_load_dwordx4 v8, s[4:7], s46 offen  lds
  s_add_u32 m0, s51, 36864
  s_add_u32 s46, s66, 615552
  buffer_load_dwordx4 v8, s[4:7], s46 offen  lds
  ds_read_b64_tr_b16 v[100:101], v9 offset:40960
  ds_read_b64_tr_b16 v[102:103], v9 offset:41984
  ds_read_b64_tr_b16 v[104:105], v9 offset:45056
  ds_read_b64_tr_b16 v[106:107], v9 offset:46080
  ds_read_b64_tr_b16 v[108:109], v9 offset:49152
  ds_read_b64_tr_b16 v[110:111], v9 offset:50176
  ds_read_b64_tr_b16 v[112:113], v9 offset:53248
  ds_read_b64_tr_b16 v[114:115], v9 offset:54272
  ds_read_b64_tr_b16 v[116:117], v9 offset:57344
  ds_read_b64_tr_b16 v[118:119], v9 offset:58368
  s_waitcnt lgkmcnt(0)
  v_mfma_f32_16x16x32_bf16 v[140:143], v[100:103], v[72:75], v[140:143]
  v_mfma_f32_16x16x32_bf16 v[144:147], v[104:107], v[72:75], v[144:147]
  v_mfma_f32_16x16x32_bf16 v[148:151], v[108:111], v[72:75], v[148:151]
  v_mfma_f32_16x16x32_bf16 v[152:155], v[112:115], v[72:75], v[152:155]
  v_mfma_f32_16x16x32_bf16 v[156:159], v[116:119], v[72:75], v[156:159]
  s_waitcnt vmcnt(20)
  s_barrier
  s_add_u32 m0, s51, 40960
  s_add_u32 s46, s66, 655360
  buffer_load_dwordx4 v8, s[4:7], s46 offen  lds
  s_add_u32 m0, s51, 45056
  s_add_u32 s46, s66, 655488
  buffer_load_dwordx4 v8, s[4:7], s46 offen  lds
  s_add_u32 m0, s51, 49152
  s_add_u32 s46, s66, 655616
  buffer_load_dwordx4 v8, s[4:7], s46 offen  lds
  s_add_u32 m0, s51, 53248
  s_add_u32 s46, s66, 655744
  buffer_load_dwordx4 v8, s[4:7], s46 offen  lds
  s_add_u32 m0, s51, 57344
  s_add_u32 s46, s66, 655872
  buffer_load_dwordx4 v8, s[4:7], s46 offen  lds
  ds_read_b64_tr_b16 v[120:121], v9 offset:61440
  ds_read_b64_tr_b16 v[122:123], v9 offset:62464
  ds_read_b64_tr_b16 v[124:125], v10 offset:0
  ds_read_b64_tr_b16 v[126:127], v10 offset:1024
  ds_read_b64_tr_b16 v[128:129], v10 offset:4096
  ds_read_b64_tr_b16 v[130:131], v10 offset:5120
  ds_read_b64_tr_b16 v[132:133], v10 offset:8192
  ds_read_b64_tr_b16 v[134:135], v10 offset:9216
  ds_read_b64_tr_b16 v[136:137], v10 offset:12288
  ds_read_b64_tr_b16 v[138:139], v10 offset:13312
  s_waitcnt lgkmcnt(0)
  v_mfma_f32_16x16x32_bf16 v[160:163], v[120:123], v[72:75], v[160:163]
  v_mfma_f32_16x16x32_bf16 v[164:167], v[124:127], v[72:75], v[164:167]
  v_mfma_f32_16x16x32_bf16 v[168:171], v[128:131], v[72:75], v[168:171]
  v_mfma_f32_16x16x32_bf16 v[172:175], v[132:135], v[72:75], v[172:175]
  v_mfma_f32_16x16x32_bf16 v[176:179], v[136:139], v[72:75], v[176:179]
  s_waitcnt vmcnt(20)
  s_barrier
  s_add_u32 m0, s51, 61440
  s_add_u32 s46, s66, 656000
  buffer_load_dwordx4 v8, s[4:7], s46 offen  lds
  s_add_u32 m0, s51, 65536
  s_add_u32 s46, s66, 656128
  buffer_load_dwordx4 v8, s[4:7], s46 offen  lds
  s_add_u32 m0, s51, 69632
  s_add_u32 s46, s66, 656256
  buffer_load_dwordx4 v8, s[4:7], s46 offen  lds
  s_add_u32 m0, s51, 73728
  s_add_u32 s46, s66, 656384
  buffer_load_dwordx4 v8, s[4:7], s46 offen  lds
  s_add_u32 m0, s51, 77824
  s_add_u32 s46, s66, 656512
  buffer_load_dwordx4 v8, s[4:7], s46 offen  lds
  ds_read_b64_tr_b16 v[100:101], v10 offset:16384
  ds_read_b64_tr_b16 v[102:103], v10 offset:17408
  ds_read_b64_tr_b16 v[104:105], v10 offset:20480
  ds_read_b64_tr_b16 v[106:107], v10 offset:21504
  ds_read_b64_tr_b16 v[108:109], v10 offset:24576
  ds_read_b64_tr_b16 v[110:111], v10 offset:25600
  ds_read_b64_tr_b16 v[112:113], v10 offset:28672
  ds_read_b64_tr_b16 v[114:115], v10 offset:29696
  ds_read_b64_tr_b16 v[116:117], v10 offset:32768
  ds_read_b64_tr_b16 v[118:119], v10 offset:33792
  s_waitcnt lgkmcnt(0)
  v_mfma_f32_16x16x32_bf16 v[140:143], v[100:103], v[76:79], v[140:143]
  v_mfma_f32_16x16x32_bf16 v[144:147], v[104:107], v[76:79], v[144:147]
  v_mfma_f32_16x16x32_bf16 v[148:151], v[108:111], v[76:79], v[148:151]
  v_mfma_f32_16x16x32_bf16 v[152:155], v[112:115], v[76:79], v[152:155]
  v_mfma_f32_16x16x32_bf16 v[156:159], v[116:119], v[76:79], v[156:159]
  s_waitcnt vmcnt(20)
  s_barrier
  s_add_u32 m0, s51, 81920
  s_add_u32 s46, s66, 696320
  buffer_load_dwordx4 v8, s[4:7], s46 offen  lds
  s_add_u32 m0, s51, 86016
  s_add_u32 s46, s66, 696448
  buffer_load_dwordx4 v8, s[4:7], s46 offen  lds
  s_add_u32 m0, s51, 90112
  s_add_u32 s46, s66, 696576
  buffer_load_dwordx4 v8, s[4:7], s46 offen  lds
  s_add_u32 m0, s51, 94208
  s_add_u32 s46, s66, 696704
  buffer_load_dwordx4 v8, s[4:7], s46 offen  lds
  s_add_u32 m0, s51, 98304
  s_add_u32 s46, s66, 696832
  buffer_load_dwordx4 v8, s[4:7], s46 offen  lds
  ds_read_b64_tr_b16 v[120:121], v10 offset:36864
  ds_read_b64_tr_b16 v[122:123], v10 offset:37888
  ds_read_b64_tr_b16 v[124:125], v10 offset:40960
  ds_read_b64_tr_b16 v[126:127], v10 offset:41984
  ds_read_b64_tr_b16 v[128:129], v10 offset:45056
  ds_read_b64_tr_b16 v[130:131], v10 offset:46080
  ds_read_b64_tr_b16 v[132:133], v10 offset:49152
  ds_read_b64_tr_b16 v[134:135], v10 offset:50176
  ds_read_b64_tr_b16 v[136:137], v10 offset:53248
  ds_read_b64_tr_b16 v[138:139], v10 offset:54272
  s_waitcnt lgkmcnt(0)
  v_mfma_f32_16x16x32_bf16 v[160:163], v[120:123], v[76:79], v[160:163]
  v_mfma_f32_16x16x32_bf16 v[164:167], v[124:127], v[76:79], v[164:167]
  v_mfma_f32_16x16x32_bf16 v[168:171], v[128:131], v[76:79], v[168:171]
  v_mfma_f32_16x16x32_bf16 v[172:175], v[132:135], v[76:79], v[172:175]
  v_mfma_f32_16x16x32_bf16 v[176:179], v[136:139], v[76:79], v[176:179]
  s_waitcnt vmcnt(20)
  s_barrier
  s_add_u32 m0, s51, 102400
  s_add_u32 s46, s66, 696960
  buffer_load_dwordx4 v8, s[4:7], s46 offen  lds
  s_add_u32 m0, s51, 106496
  s_add_u32 s46, s66, 697088
  buffer_load_dwordx4 v8, s[4:7], s46 offen  lds
  s_add_u32 m0, s51, 110592
  s_add_u32 s46, s66, 697216
  buffer_load_dwordx4 v8, s[4:7], s46 offen  lds
  s_add_u32 m0, s51, 114688
  s_add_u32 s46, s66, 697344
  buffer_load_dwordx4 v8, s[4:7], s46 offen  lds
  s_add_u32 m0, s51, 118784
  s_add_u32 s46, s66, 697472
  buffer_load_dwordx4 v8, s[4:7], s46 offen  lds
  ds_read_b64_tr_b16 v[100:101], v9 offset:0
  ds_read_b64_tr_b16 v[102:103], v9 offset:1024
  ds_read_b64_tr_b16 v[104:105], v9 offset:4096
  ds_read_b64_tr_b16 v[106:107], v9 offset:5120
  ds_read_b64_tr_b16 v[108:109], v9 offset:8192
  ds_read_b64_tr_b16 v[110:111], v9 offset:9216
  ds_read_b64_tr_b16 v[112:113], v9 offset:12288
  ds_read_b64_tr_b16 v[114:115], v9 offset:13312
  ds_read_b64_tr_b16 v[116:117], v9 offset:16384
  ds_read_b64_tr_b16 v[118:119], v9 offset:17408
  s_waitcnt lgkmcnt(0)
  v_mfma_f32_16x16x32_bf16 v[140:143], v[100:103], v[80:83], v[140:143]
  v_mfma_f32_16x16x32_bf16 v[144:147], v[104:107], v[80:83], v[144:147]
  v_mfma_f32_16x16x32_bf16 v[148:151], v[108:111], v[80:83], v[148:151]
  v_mfma_f32_16x16x32_bf16 v[152:155], v[112:115], v[80:83], v[152:155]
  v_mfma_f32_16x16x32_bf16 v[156:159], v[116:119], v[80:83], v[156:159]
  s_waitcnt vmcnt(20)
  s_barrier
  s_add_u32 m0, s51, 0
  s_add_u32 s46, s66, 737280
  buffer_load_dwordx4 v8, s[4:7], s46 offen  lds
  s_add_u32 m0, s51, 4096
  s_add_u32 s46, s66, 737408
  buffer_load_dwordx4 v8, s[4:7], s46 offen  lds
  s_add_u32 m0, s51, 8192
  s_add_u32 s46, s66, 737536
  buffer_load_dwordx4 v8, s[4:7], s46 offen  lds
  s_add_u32 m0, s51, 12288
  s_add_u32 s46, s66, 737664
  buffer_load_dwordx4 v8, s[4:7], s46 offen  lds
  s_add_u32 m0, s51, 16384
  s_add_u32 s46, s66, 737792
  buffer_load_dwordx4 v8, s[4:7], s46 offen  lds
  ds_read_b64_tr_b16 v[120:121], v9 offset:20480
  ds_read_b64_tr_b16 v[122:123], v9 offset:21504
  ds_read_b64_tr_b16 v[124:125], v9 offset:24576
  ds_read_b64_tr_b16 v[126:127], v9 offset:25600
  ds_read_b64_tr_b16 v[128:129], v9 offset:28672
  ds_read_b64_tr_b16 v[130:131], v9 offset:29696
  ds_read_b64_tr_b16 v[132:133], v9 offset:32768
  ds_read_b64_tr_b16 v[134:135], v9 offset:33792
  ds_read_b64_tr_b16 v[136:137], v9 offset:36864
  ds_read_b64_tr_b16 v[138:139], v9 offset:37888
  s_waitcnt lgkmcnt(0)
  v_mfma_f32_16x16x32_bf16 v[160:163], v[120:123], v[80:83], v[160:163]
  v_mfma_f32_16x16x32_bf16 v[164:167], v[124:127], v[80:83], v[164:167]
  v_mfma_f32_16x16x32_bf16 v[168:171], v[128:131], v[80:83], v[168:171]
  v_mfma_f32_16x16x32_bf16 v[172:175], v[132:135], v[80:83], v[172:175]
  v_mfma_f32_16x16x32_bf16 v[176:179], v[136:139], v[80:83], v[176:179]
  s_waitcnt vmcnt(20)
  s_barrier
  s_add_u32 m0, s51, 20480
  s_add_u32 s46, s66, 737920
  buffer_load_dwordx4 v8, s[4:7], s46 offen  lds
  s_add_u32 m0, s51, 24576
  s_add_u32 s46, s66, 738048
  buffer_load_dwordx4 v8, s[4:7], s46 offen  lds
  s_add_u32 m0, s51, 28672
  s_add_u32 s46, s66, 738176
  buffer_load_dwordx4 v8, s[4:7], s46 offen  lds
  s_add_u32 m0, s51, 32768
  s_add_u32 s46, s66, 738304
  buffer_load_dwordx4 v8, s[4:7], s46 offen  lds
  s_add_u32 m0, s51, 36864
  s_add_u32 s46, s66, 738432
  buffer_load_dwordx4 v8, s[4:7], s46 offen  lds
  ds_read_b64_tr_b16 v[100:101], v9 offset:40960
  ds_read_b64_tr_b16 v[102:103], v9 offset:41984
  ds_read_b64_tr_b16 v[104:105], v9 offset:45056
  ds_read_b64_tr_b16 v[106:107], v9 offset:46080
  ds_read_b64_tr_b16 v[108:109], v9 offset:49152
  ds_read_b64_tr_b16 v[110:111], v9 offset:50176
  ds_read_b64_tr_b16 v[112:113], v9 offset:53248
  ds_read_b64_tr_b16 v[114:115], v9 offset:54272
  ds_read_b64_tr_b16 v[116:117], v9 offset:57344
  ds_read_b64_tr_b16 v[118:119], v9 offset:58368
  s_waitcnt lgkmcnt(0)
  v_mfma_f32_16x16x32_bf16 v[140:143], v[100:103], v[84:87], v[140:143]
  v_mfma_f32_16x16x32_bf16 v[144:147], v[104:107], v[84:87], v[144:147]
  v_mfma_f32_16x16x32_bf16 v[148:151], v[108:111], v[84:87], v[148:151]
  v_mfma_f32_16x16x32_bf16 v[152:155], v[112:115], v[84:87], v[152:155]
  v_mfma_f32_16x16x32_bf16 v[156:159], v[116:119], v[84:87], v[156:159]
  s_waitcnt vmcnt(20)
  s_barrier
  s_add_u32 m0, s51, 40960
  s_add_u32 s46, s66, 778240
  buffer_load_dwordx4 v8, s[4:7], s46 offen  lds
  s_add_u32 m0, s51, 45056
  s_add_u32 s46, s66, 778368
  buffer_load_dwordx4 v8, s[4:7], s46 offen  lds
  s_add_u32 m0, s51, 49152
  s_add_u32 s46, s66, 778496
  buffer_load_dwordx4 v8, s[4:7], s46 offen  lds
  s_add_u32 m0, s51, 53248
  s_add_u32 s46, s66, 778624
  buffer_load_dwordx4 v8, s[4:7], s46 offen  lds
  s_add_u32 m0, s51, 57344
  s_add_u32 s46, s66, 778752
  buffer_load_dwordx4 v8, s[4:7], s46 offen  lds
  ds_read_b64_tr_b16 v[120:121], v9 offset:61440
  ds_read_b64_tr_b16 v[122:123], v9 offset:62464
  ds_read_b64_tr_b16 v[124:125], v10 offset:0
  ds_read_b64_tr_b16 v[126:127], v10 offset:1024
  ds_read_b64_tr_b16 v[128:129], v10 offset:4096
  ds_read_b64_tr_b16 v[130:131], v10 offset:5120
  ds_read_b64_tr_b16 v[132:133], v10 offset:8192
  ds_read_b64_tr_b16 v[134:135], v10 offset:9216
  ds_read_b64_tr_b16 v[136:137], v10 offset:12288
  ds_read_b64_tr_b16 v[138:139], v10 offset:13312
  s_waitcnt lgkmcnt(0)
  v_mfma_f32_16x16x32_bf16 v[160:163], v[120:123], v[84:87], v[160:163]
  v_mfma_f32_16x16x32_bf16 v[164:167], v[124:127], v[84:87], v[164:167]
  v_mfma_f32_16x16x32_bf16 v[168:171], v[128:131], v[84:87], v[168:171]
  v_mfma_f32_16x16x32_bf16 v[172:175], v[132:135], v[84:87], v[172:175]
  v_mfma_f32_16x16x32_bf16 v[176:179], v[136:139], v[84:87], v[176:179]
  s_waitcnt vmcnt(20)
  s_barrier
  s_add_u32 m0, s51, 61440
  s_add_u32 s46, s66, 778880
  buffer_load_dwordx4 v8, s[4:7], s46 offen  lds
  s_add_u32 m0, s51, 65536
  s_add_u32 s46, s66, 779008
  buffer_load_dwordx4 v8, s[4:7], s46 offen  lds
  s_add_u32 m0, s51, 69632
  s_add_u32 s46, s66, 779136
  buffer_load_dwordx4 v8, s[4:7], s46 offen  lds
  s_add_u32 m0, s51, 73728
  s_add_u32 s46, s66, 779264
  buffer_load_dwordx4 v8, s[4:7], s46 offen  lds
  s_add_u32 m0, s51, 77824
  s_add_u32 s46, s66, 779392
  buffer_load_dwordx4 v8, s[4:7], s46 offen  lds
  ds_read_b64_tr_b16 v[100:101], v10 offset:16384
  ds_read_b64_tr_b16 v[102:103], v10 offset:17408
  ds_read_b64_tr_b16 v[104:105], v10 offset:20480
  ds_read_b64_tr_b16 v[106:107], v10 offset:21504
  ds_read_b64_tr_b16 v[108:109], v10 offset:24576
  ds_read_b64_tr_b16 v[110:111], v10 offset:25600
  ds_read_b64_tr_b16 v[112:113], v10 offset:28672
  ds_read_b64_tr_b16 v[114:115], v10 offset:29696
  ds_read_b64_tr_b16 v[116:117], v10 offset:32768
  ds_read_b64_tr_b16 v[118:119], v10 offset:33792
  s_waitcnt lgkmcnt(0)
  v_mfma_f32_16x16x32_bf16 v[140:143], v[100:103], v[88:91], v[140:143]
  v_mfma_f32_16x16x32_bf16 v[144:147], v[104:107], v[88:91], v[144:147]
  v_mfma_f32_16x16x32_bf16 v[148:151], v[108:111], v[88:91], v[148:151]
  v_mfma_f32_16x16x32_bf16 v[152:155], v[112:115], v[88:91], v[152:155]
  v_mfma_f32_16x16x32_bf16 v[156:159], v[116:119], v[88:91], v[156:159]
  s_waitcnt vmcnt(20)
  s_barrier
  ds_read_b64_tr_b16 v[120:121], v10 offset:36864
  ds_read_b64_tr_b16 v[122:123], v10 offset:37888
  ds_read_b64_tr_b16 v[124:125], v10 offset:40960
  ds_read_b64_tr_b16 v[126:127], v10 offset:41984
  ds_read_b64_tr_b16 v[128:129], v10 offset:45056
  ds_read_b64_tr_b16 v[130:131], v10 offset:46080
  ds_read_b64_tr_b16 v[132:133], v10 offset:49152
  ds_read_b64_tr_b16 v[134:135], v10 offset:50176
  ds_read_b64_tr_b16 v[136:137], v10 offset:53248
  ds_read_b64_tr_b16 v[138:139], v10 offset:54272
  s_waitcnt lgkmcnt(0)
  v_mfma_f32_16x16x32_bf16 v[160:163], v[120:123], v[88:91], v[160:163]
  v_mfma_f32_16x16x32_bf16 v[164:167], v[124:127], v[88:91], v[164:167]
  v_mfma_f32_16x16x32_bf16 v[168:171], v[128:131], v[88:91], v[168:171]
  v_mfma_f32_16x16x32_bf16 v[172:175], v[132:135], v[88:91], v[172:175]
  v_mfma_f32_16x16x32_bf16 v[176:179], v[136:139], v[88:91], v[176:179]
  s_waitcnt vmcnt(15)
  s_barrier
  ds_read_b64_tr_b16 v[100:101], v9 offset:0
  ds_read_b64_tr_b16 v[102:103], v9 offset:1024
  ds_read_b64_tr_b16 v[104:105], v9 offset:4096
  ds_read_b64_tr_b16 v[106:107], v9 offset:5120
  ds_read_b64_tr_b16 v[108:109], v9 offset:8192
  ds_read_b64_tr_b16 v[110:111], v9 offset:9216
  ds_read_b64_tr_b16 v[112:113], v9 offset:12288
  ds_read_b64_tr_b16 v[114:115], v9 offset:13312
  ds_read_b64_tr_b16 v[116:117], v9 offset:16384
  ds_read_b64_tr_b16 v[118:119], v9 offset:17408
  s_waitcnt lgkmcnt(0)
  v_mfma_f32_16x16x32_bf16 v[140:143], v[100:103], v[92:95], v[140:143]
  v_mfma_f32_16x16x32_bf16 v[144:147], v[104:107], v[92:95], v[144:147]
  v_mfma_f32_16x16x32_bf16 v[148:151], v[108:111], v[92:95], v[148:151]
  v_mfma_f32_16x16x32_bf16 v[152:155], v[112:115], v[92:95], v[152:155]
  v_mfma_f32_16x16x32_bf16 v[156:159], v[116:119], v[92:95], v[156:159]
  s_waitcnt vmcnt(10)
  s_barrier
  ds_read_b64_tr_b16 v[120:121], v9 offset:20480
  ds_read_b64_tr_b16 v[122:123], v9 offset:21504
  ds_read_b64_tr_b16 v[124:125], v9 offset:24576
  ds_read_b64_tr_b16 v[126:127], v9 offset:25600
  ds_read_b64_tr_b16 v[128:129], v9 offset:28672
  ds_read_b64_tr_b16 v[130:131], v9 offset:29696
  ds_read_b64_tr_b16 v[132:133], v9 offset:32768
  ds_read_b64_tr_b16 v[134:135], v9 offset:33792
  ds_read_b64_tr_b16 v[136:137], v9 offset:36864
  ds_read_b64_tr_b16 v[138:139], v9 offset:37888
  s_waitcnt lgkmcnt(0)
  v_mfma_f32_16x16x32_bf16 v[160:163], v[120:123], v[92:95], v[160:163]
  v_mfma_f32_16x16x32_bf16 v[164:167], v[124:127], v[92:95], v[164:167]
  v_mfma_f32_16x16x32_bf16 v[168:171], v[128:131], v[92:95], v[168:171]
  v_mfma_f32_16x16x32_bf16 v[172:175], v[132:135], v[92:95], v[172:175]
  v_mfma_f32_16x16x32_bf16 v[176:179], v[136:139], v[92:95], v[176:179]
  s_waitcnt vmcnt(5)
  s_barrier
  ds_read_b64_tr_b16 v[100:101], v9 offset:40960
  ds_read_b64_tr_b16 v[102:103], v9 offset:41984
  ds_read_b64_tr_b16 v[104:105], v9 offset:45056
  ds_read_b64_tr_b16 v[106:107], v9 offset:46080
  ds_read_b64_tr_b16 v[108:109], v9 offset:49152
  ds_read_b64_tr_b16 v[110:111], v9 offset:50176
  ds_read_b64_tr_b16 v[112:113], v9 offset:53248
  ds_read_b64_tr_b16 v[114:115], v9 offset:54272
  ds_read_b64_tr_b16 v[116:117], v9 offset:57344
  ds_read_b64_tr_b16 v[118:119], v9 offset:58368
  s_waitcnt lgkmcnt(0)
  v_mfma_f32_16x16x32_bf16 v[140:143], v[100:103], v[96:99], v[140:143]
  v_mfma_f32_16x16x32_bf16 v[144:147], v[104:107], v[96:99], v[144:147]
  v_mfma_f32_16x16x32_bf16 v[148:151], v[108:111], v[96:99], v[148:151]
  v_mfma_f32_16x16x32_bf16 v[152:155], v[112:115], v[96:99], v[152:155]
  v_mfma_f32_16x16x32_bf16 v[156:159], v[116:119], v[96:99], v[156:159]
  s_waitcnt vmcnt(0)
  s_barrier
  ds_read_b64_tr_b16 v[120:121], v9 offset:61440
  ds_read_b64_tr_b16 v[122:123], v9 offset:62464
  ds_read_b64_tr_b16 v[124:125], v10 offset:0
  ds_read_b64_tr_b16 v[126:127], v10 offset:1024
  ds_read_b64_tr_b16 v[128:129], v10 offset:4096
  ds_read_b64_tr_b16 v[130:131], v10 offset:5120
  ds_read_b64_tr_b16 v[132:133], v10 offset:8192
  ds_read_b64_tr_b16 v[134:135], v10 offset:9216
  ds_read_b64_tr_b16 v[136:137], v10 offset:12288
  ds_read_b64_tr_b16 v[138:139], v10 offset:13312
  s_waitcnt lgkmcnt(0)
  v_mfma_f32_16x16x32_bf16 v[160:163], v[120:123], v[96:99], v[160:163]
  v_mfma_f32_16x16x32_bf16 v[164:167], v[124:127], v[96:99], v[164:167]
  v_mfma_f32_16x16x32_bf16 v[168:171], v[128:131], v[96:99], v[168:171]
  v_mfma_f32_16x16x32_bf16 v[172:175], v[132:135], v[96:99], v[172:175]
  v_mfma_f32_16x16x32_bf16 v[176:179], v[136:139], v[96:99], v[176:179]
  s_barrier
  v_cvt_pk_bf16_f32 v140, v140, v141
  v_cvt_pk_bf16_f32 v141, v142, v143
  buffer_store_dwordx2 v[140:141], v12, s[12:15], 0 offen offset:0
  v_cvt_pk_bf16_f32 v144, v144, v145
  v_cvt_pk_bf16_f32 v145, v146, v147
  buffer_store_dwordx2 v[144:145], v12, s[12:15], 0 offen offset:128
  v_cvt_pk_bf16_f32 v148, v148, v149
  v_cvt_pk_bf16_f32 v149, v150, v151
  buffer_store_dwordx2 v[148:149], v12, s[12:15], 0 offen offset:256
  v_cvt_pk_bf16_f32 v152, v152, v153
  v_cvt_pk_bf16_f32 v153, v154, v155
  buffer_store_dwordx2 v[152:153], v12, s[12:15], 0 offen offset:384
  v_cvt_pk_bf16_f32 v156, v156, v157
  v_cvt_pk_bf16_f32 v157, v158, v159
  buffer_store_dwordx2 v[156:157], v12, s[12:15], 0 offen offset:512
  v_cvt_pk_bf16_f32 v160, v160, v161
  v_cvt_pk_bf16_f32 v161, v162, v163
  buffer_store_dwordx2 v[160:161], v12, s[12:15], 0 offen offset:640
  v_cvt_pk_bf16_f32 v164, v164, v165
  v_cvt_pk_bf16_f32 v165, v166, v167
  buffer_store_dwordx2 v[164:165], v12, s[12:15], 0 offen offset:768
  v_cvt_pk_bf16_f32 v168, v168, v169
  v_cvt_pk_bf16_f32 v169, v170, v171
  buffer_store_dwordx2 v[168:169], v12, s[12:15], 0 offen offset:896
  v_cvt_pk_bf16_f32 v172, v172, v173
  v_cvt_pk_bf16_f32 v173, v174, v175
  buffer_store_dwordx2 v[172:173], v12, s[12:15], 0 offen offset:1024
  v_cvt_pk_bf16_f32 v176, v176, v177
  v_cvt_pk_bf16_f32 v177, v178, v179
  buffer_store_dwordx2 v[176:177], v12, s[12:15], 0 offen offset:1152
  s_endpgm
L_recur:
  s_cmp_lt_u32 s44, 8
  s_cbranch_scc1 L_score
  s_cmp_lt_u32 s44, 16
  s_cbranch_scc1 L_value
  s_cmp_lt_u32 s44, 28
  s_cbranch_scc1 rc_nowarm
  s_lshl_b32 s46, s44, 2
  s_add_u32 s46, s46, s43
  s_lshl_b32 s46, s46, 2
  s_add_u32 s46, s46, s42
  s_sub_u32 s46, s46, 448
  s_lshl_b32 s46, s46, 13
  v_lshlrev_b32 v1, 7, v0
  s_add_u32 s47, s46, 0
  buffer_load_dword v250, v1, s[12:15], s47 offen
  s_add_u32 s47, s46, 524288
  buffer_load_dword v250, v1, s[12:15], s47 offen
  s_add_u32 s47, s46, 1048576
  buffer_load_dword v250, v1, s[12:15], s47 offen
  s_add_u32 s47, s46, 1572864
  buffer_load_dword v250, v1, s[12:15], s47 offen
  s_add_u32 s47, s46, 2097152
  buffer_load_dword v250, v1, s[12:15], s47 offen
rc_nowarm:
  s_mov_b32 s50, 0
ss_13:
  v_and_b32 v3, 3, v0
  v_lshlrev_b32 v3, 2, v3
  global_load_dword v2, v3, s[38:39] sc1
  s_add_u32 s50, s50, 1
  s_cmp_gt_u32 s50, 131072
  s_cbranch_scc1 L_fail
  s_waitcnt vmcnt(0)
ss_13_in:
  v_readlane_b32 s46, v2, 0
  v_readlane_b32 s47, v2, 0
  v_readlane_b32 s48, v2, 0
  s_nop 0
  s_min_u32 s47, s47, s48
  s_cmp_lg_u32 s46, 0
  s_cselect_b32 s48, 7, 0
  s_add_u32 s46, s46, s2
  s_xor_b32 s49, s46, s43
  s_and_b32 s49, s49, s48
  s_cbranch_scc1 L_reroll
  s_cmp_lg_u32 s47, 0
  s_cbranch_scc1 ss_ok_14
  s_sleep 6
  s_branch ss_13
ss_ok_14:
  s_cmp_lt_u32 s44, 26
  s_cbranch_scc1 L_owner
  s_branch L_xowner
L_score:
  s_mov_b32 s4, s26
  s_mov_b32 s5, s27
  s_mov_b32 s6, 7864320
  s_mov_b32 s7, 0x20000
  s_mov_b32 s12, s28
  s_mov_b32 s13, s29
  s_mov_b32 s14, 7864320
  s_mov_b32 s15, 0x20000
  v_lshrrev_b32 v136, 3, v0
  v_lshrrev_b32 v137, 2, v136
  v_lshlrev_b32 v137, 3, v137
  v_and_b32 v64, 3, v136
  v_add_u32 v64, v64, v137
  s_and_b32 s46, s42, 1
  s_lshl_b32 s46, s46, 2
  s_lshr_b32 s47, s42, 1
  s_lshl_b32 s47, s47, 4
  s_add_u32 s46, s46, s47
  v_add_u32 v64, s46, v64
  v_mul_u32_u24 v64, 12288, v64
  v_lshrrev_b32 v136, 1, v136
  v_bfe_u32 v137, v0, 1, 2
  v_xor_b32 v136, v136, v137
  v_lshlrev_b32 v136, 5, v136
  v_and_b32 v137, 1, v0
  v_lshlrev_b32 v137, 4, v137
  v_add3_u32 v64, v64, v136, v137
  v_lshrrev_b32 v136, 5, v0
  v_lshlrev_b32 v65, 11, v136
  v_bfe_u32 v136, v0, 2, 3
  v_lshl_add_u32 v65, v136, 7, v65
  v_lshrrev_b32 v136, 1, v136
  v_xor_b32 v136, s42, v136
  v_lshl_add_u32 v65, v136, 5, v65
  v_and_b32 v136, 3, v0
  v_lshl_add_u32 v65, v136, 3, v65
  v_add_u32 v66, 0x10000, v65
  v_add_u32 v67, 0x20000, v65
  v_lshlrev_b32 v1, 4, v0
  v_add_u32 v2, s51, v1
  v_add_u32 v3, 0x10000, v2
  s_mul_i32 s62, s45, 384
  s_mov_b32 s24, 4096
  s_mov_b32 s25, 49152
  s_add_u32 m0, s51, 73728
  s_add_u32 s46, s62, 786432
  buffer_load_dwordx4 v64, s[12:15], s46 offen  lds
  s_add_u32 m0, s51, 77824
  s_add_u32 s46, s62, 1179648
  buffer_load_dwordx4 v64, s[12:15], s46 offen  lds
  s_add_u32 m0, s51, 81920
  s_add_u32 s46, s62, 786560
  buffer_load_dwordx4 v64, s[12:15], s46 offen  lds
  s_add_u32 m0, s51, 86016
  s_add_u32 s46, s62, 1179776
  buffer_load_dwordx4 v64, s[12:15], s46 offen  lds
  s_add_u32 m0, s51, 90112
  s_add_u32 s46, s62, 786688
  buffer_load_dwordx4 v64, s[12:15], s46 offen  lds
  s_add_u32 m0, s51, 94208
  s_add_u32 s46, s62, 1179904
  buffer_load_dwordx4 v64, s[12:15], s46 offen  lds
  s_add_u32 m0, s51, 98304
  s_add_u32 s46, s62, 1572864
  buffer_load_dwordx4 v64, s[12:15], s46 offen  lds
  s_add_u32 m0, s51, 102400
  s_add_u32 s46, s62, 1966080
  buffer_load_dwordx4 v64, s[12:15], s46 offen  lds
  s_add_u32 m0, s51, 106496
  s_add_u32 s46, s62, 1572992
  buffer_load_dwordx4 v64, s[12:15], s46 offen  lds
  s_add_u32 m0, s51, 110592
  s_add_u32 s46, s62, 1966208
  buffer_load_dwordx4 v64, s[12:15], s46 offen  lds
  s_add_u32 m0, s51, 114688
  s_add_u32 s46, s62, 1573120
  buffer_load_dwordx4 v64, s[12:15], s46 offen  lds
  s_add_u32 m0, s51, 118784
  s_add_u32 s46, s62, 1966336
  buffer_load_dwordx4 v64, s[12:15], s46 offen  lds
  s_add_u32 m0, s51, 122880
  s_add_u32 s46, s62, 2359296
  buffer_load_dwordx4 v64, s[12:15], s46 offen  lds
  s_add_u32 m0, s51, 126976
  s_add_u32 s46, s62, 2752512
  buffer_load_dwordx4 v64, s[12:15], s46 offen  lds
  s_add_u32 m0, s51, 131072
  s_add_u32 s46, s62, 2359424
  buffer_load_dwordx4 v64, s[12:15], s46 offen  lds
  s_add_u32 m0, s51, 135168
  s_add_u32 s46, s62, 2752640
  buffer_load_dwordx4 v64, s[12:15], s46 offen  lds
  s_add_u32 m0, s51, 139264
  s_add_u32 s46, s62, 2359552
  buffer_load_dwordx4 v64, s[12:15], s46 offen  lds
  s_add_u32 m0, s51, 143360
  s_add_u32 s46, s62, 2752768
  buffer_load_dwordx4 v64, s[12:15], s46 offen  lds
  s_add_u32 m0, s51, 0
  s_add_u32 s46, s62, 3145728
  buffer_load_dwordx4 v64, s[12:15], s46 offen  lds
  s_add_u32 m0, s51, 4096
  s_add_u32 s46, s62, 3538944
  buffer_load_dwordx4 v64, s[12:15], s46 offen  lds
  s_add_u32 m0, s51, 8192
  s_add_u32 s46, s62, 3145856
  buffer_load_dwordx4 v64, s[12:15], s46 offen  lds
  s_add_u32 m0, s51, 12288
  s_add_u32 s46, s62, 3539072
  buffer_load_dwordx4 v64, s[12:15], s46 offen  lds
  s_add_u32 m0, s51, 16384
  s_add_u32 s46, s62, 3145984
  buffer_load_dwordx4 v64, s[12:15], s46 offen  lds
  s_add_u32 m0, s51, 20480
  s_add_u32 s46, s62, 3539200
  buffer_load_dwordx4 v64, s[12:15], s46 offen  lds
  s_add_u32 m0, s51, 24576
  s_add_u32 s46, s62, 4718592
  buffer_load_dwordx4 v64, s[12:15], s46 offen  lds
  s_add_u32 m0, s51, 28672
  s_add_u32 s46, s62, 5111808
  buffer_load_dwordx4 v64, s[12:15], s46 offen  lds
  s_add_u32 m0, s51, 32768
  s_add_u32 s46, s62, 4718720
  buffer_load_dwordx4 v64, s[12:15], s46 offen  lds
  s_add_u32 m0, s51, 36864
  s_add_u32 s46, s62, 5111936
  buffer_load_dwordx4 v64, s[12:15], s46 offen  lds
  s_add_u32 m0, s51, 40960
  s_add_u32 s46, s62, 4718848
  buffer_load_dwordx4 v64, s[12:15], s46 offen  lds
  s_add_u32 m0, s51, 45056
  s_add_u32 s46, s62, 5112064
  buffer_load_dwordx4 v64, s[12:15], s46 offen  lds
  s_waitcnt vmcnt(24)
  s_barrier
  s_add_u32 m0, s51, 49152
  s_add_u32 s46, s62, 5505024
  buffer_load_dwordx4 v64, s[12:15], s46 offen  lds
  s_add_u32 m0, s51, 53248
  s_add_u32 s46, s62, 5898240
  buffer_load_dwordx4 v64, s[12:15], s46 offen  lds
  s_add_u32 m0, s51, 57344
  s_add_u32 s46, s62, 5505152
  buffer_load_dwordx4 v64, s[12:15], s46 offen  lds
  s_add_u32 m0, s51, 61440
  s_add_u32 s46, s62, 5898368
  buffer_load_dwordx4 v64, s[12:15], s46 offen  lds
  s_add_u32 m0, s51, 65536
  s_add_u32 s46, s62, 5505280
  buffer_load_dwordx4 v64, s[12:15], s46 offen  lds
  s_add_u32 m0, s51, 69632
  s_add_u32 s46, s62, 5898496
  buffer_load_dwordx4 v64, s[12:15], s46 offen  lds
  ds_read_b64_tr_b16 a[0:1], v66 offset:8192
  ds_read_b64_tr_b16 a[2:3], v66 offset:9216
  ds_read_b64_tr_b16 a[4:5], v66 offset:12288
  ds_read_b64_tr_b16 a[6:7], v66 offset:13312
  ds_read_b64_tr_b16 a[8:9], v66 offset:16384
  ds_read_b64_tr_b16 a[10:11], v66 offset:17408
  ds_read_b64_tr_b16 a[12:13], v66 offset:20480
  ds_read_b64_tr_b16 a[14:15], v66 offset:21504
  ds_read_b64_tr_b16 a[16:17], v66 offset:24576
  ds_read_b64_tr_b16 a[18:19], v66 offset:25600
  ds_read_b64_tr_b16 a[20:21], v66 offset:28672
  ds_read_b64_tr_b16 a[22:23], v66 offset:29696
  s_waitcnt lgkmcnt(0)
  s_waitcnt vmcnt(24)
  s_barrier
  s_add_u32 m0, s51, 73728
  s_add_u32 s46, s62, 6291456
  buffer_load_dwordx4 v64, s[12:15], s46 offen  lds
  s_add_u32 m0, s51, 77824
  s_add_u32 s46, s62, 6684672
  buffer_load_dwordx4 v64, s[12:15], s46 offen  lds
  s_add_u32 m0, s51, 81920
  s_add_u32 s46, s62, 6291584
  buffer_load_dwordx4 v64, s[12:15], s46 offen  lds
  s_add_u32 m0, s51, 86016
  s_add_u32 s46, s62, 6684800
  buffer_load_dwordx4 v64, s[12:15], s46 offen  lds
  s_add_u32 m0, s51, 90112
  s_add_u32 s46, s62, 6291712
  buffer_load_dwordx4 v64, s[12:15], s46 offen  lds
  s_add_u32 m0, s51, 94208
  s_add_u32 s46, s62, 6684928
  buffer_load_dwordx4 v64, s[12:15], s46 offen  lds
  ds_read_b64_tr_b16 a[24:25], v66 offset:32768
  ds_read_b64_tr_b16 a[26:27], v66 offset:33792
  ds_read_b64_tr_b16 a[28:29], v66 offset:36864
  ds_read_b64_tr_b16 a[30:31], v66 offset:37888
  ds_read_b64_tr_b16 a[32:33], v66 offset:40960
  ds_read_b64_tr_b16 a[34:35], v66 offset:41984
  ds_read_b64_tr_b16 a[36:37], v66 offset:45056
  ds_read_b64_tr_b16 a[38:39], v66 offset:46080
  ds_read_b64_tr_b16 a[40:41], v66 offset:49152
  ds_read_b64_tr_b16 a[42:43], v66 offset:50176
  ds_read_b64_tr_b16 a[44:45], v66 offset:53248
  ds_read_b64_tr_b16 a[46:47], v66 offset:54272
  s_waitcnt lgkmcnt(0)
  s_waitcnt vmcnt(24)
  s_barrier
  s_add_u32 m0, s51, 98304
  s_add_u32 s46, s62, 7077888
  buffer_load_dwordx4 v64, s[12:15], s46 offen  lds
  s_add_u32 m0, s51, 102400
  s_add_u32 s46, s62, 7471104
  buffer_load_dwordx4 v64, s[12:15], s46 offen  lds
  s_add_u32 m0, s51, 106496
  s_add_u32 s46, s62, 7078016
  buffer_load_dwordx4 v64, s[12:15], s46 offen  lds
  s_add_u32 m0, s51, 110592
  s_add_u32 s46, s62, 7471232
  buffer_load_dwordx4 v64, s[12:15], s46 offen  lds
  s_add_u32 m0, s51, 114688
  s_add_u32 s46, s62, 7078144
  buffer_load_dwordx4 v64, s[12:15], s46 offen  lds
  s_add_u32 m0, s51, 118784
  s_add_u32 s46, s62, 7471360
  buffer_load_dwordx4 v64, s[12:15], s46 offen  lds
  ds_read_b64_tr_b16 a[48:49], v66 offset:57344
  ds_read_b64_tr_b16 a[50:51], v66 offset:58368
  ds_read_b64_tr_b16 a[52:53], v66 offset:61440
  ds_read_b64_tr_b16 a[54:55], v66 offset:62464
  ds_read_b64_tr_b16 a[56:57], v67 offset:0
  ds_read_b64_tr_b16 a[58:59], v67 offset:1024
  ds_read_b64_tr_b16 a[60:61], v67 offset:4096
  ds_read_b64_tr_b16 a[62:63], v67 offset:5120
  ds_read_b64_tr_b16 a[64:65], v67 offset:8192
  ds_read_b64_tr_b16 a[66:67], v67 offset:9216
  ds_read_b64_tr_b16 a[68:69], v67 offset:12288
  ds_read_b64_tr_b16 a[70:71], v67 offset:13312
  s_waitcnt lgkmcnt(0)
  s_waitcnt vmcnt(24)
  s_barrier
  s_add_u32 m0, s51, 122880
  s_add_u32 s46, s62, 0
  buffer_load_dwordx4 v64, s[4:7], s46 offen  lds
  s_add_u32 m0, s51, 126976
  s_add_u32 s46, s62, 393216
  buffer_load_dwordx4 v64, s[4:7], s46 offen  lds
  s_add_u32 m0, s51, 131072
  s_add_u32 s46, s62, 128
  buffer_load_dwordx4 v64, s[4:7], s46 offen  lds
  s_add_u32 m0, s51, 135168
  s_add_u32 s46, s62, 393344
  buffer_load_dwordx4 v64, s[4:7], s46 offen  lds
  s_add_u32 m0, s51, 139264
  s_add_u32 s46, s62, 256
  buffer_load_dwordx4 v64, s[4:7], s46 offen  lds
  s_add_u32 m0, s51, 143360
  s_add_u32 s46, s62, 393472
  buffer_load_dwordx4 v64, s[4:7], s46 offen  lds
  ds_read_b64_tr_b16 a[72:73], v65 offset:0
  ds_read_b64_tr_b16 a[74:75], v65 offset:1024
  ds_read_b64_tr_b16 a[76:77], v65 offset:4096
  ds_read_b64_tr_b16 a[78:79], v65 offset:5120
  ds_read_b64_tr_b16 a[80:81], v65 offset:8192
  ds_read_b64_tr_b16 a[82:83], v65 offset:9216
  ds_read_b64_tr_b16 a[84:85], v65 offset:12288
  ds_read_b64_tr_b16 a[86:87], v65 offset:13312
  ds_read_b64_tr_b16 a[88:89], v65 offset:16384
  ds_read_b64_tr_b16 a[90:91], v65 offset:17408
  ds_read_b64_tr_b16 a[92:93], v65 offset:20480
  ds_read_b64_tr_b16 a[94:95], v65 offset:21504
  s_waitcnt lgkmcnt(0)
  s_waitcnt vmcnt(24)
  s_barrier
  s_add_u32 m0, s51, 0
  s_add_u32 s46, s62, 786432
  buffer_load_dwordx4 v64, s[4:7], s46 offen  lds
  s_add_u32 m0, s51, 4096
  s_add_u32 s46, s62, 1179648
  buffer_load_dwordx4 v64, s[4:7], s46 offen  lds
  s_add_u32 m0, s51, 8192
  s_add_u32 s46, s62, 786560
  buffer_load_dwordx4 v64, s[4:7], s46 offen  lds
  s_add_u32 m0, s51, 12288
  s_add_u32 s46, s62, 1179776
  buffer_load_dwordx4 v64, s[4:7], s46 offen  lds
  s_add_u32 m0, s51, 16384
  s_add_u32 s46, s62, 786688
  buffer_load_dwordx4 v64, s[4:7], s46 offen  lds
  s_add_u32 m0, s51, 20480
  s_add_u32 s46, s62, 1179904
  buffer_load_dwordx4 v64, s[4:7], s46 offen  lds
  ds_read_b64_tr_b16 a[96:97], v65 offset:24576
  ds_read_b64_tr_b16 a[98:99], v65 offset:25600
  ds_read_b64_tr_b16 a[100:101], v65 offset:28672
  ds_read_b64_tr_b16 a[102:103], v65 offset:29696
  ds_read_b64_tr_b16 a[104:105], v65 offset:32768
  ds_read_b64_tr_b16 a[106:107], v65 offset:33792
  ds_read_b64_tr_b16 a[108:109], v65 offset:36864
  ds_read_b64_tr_b16 a[110:111], v65 offset:37888
  ds_read_b64_tr_b16 a[112:113], v65 offset:40960
  ds_read_b64_tr_b16 a[114:115], v65 offset:41984
  ds_read_b64_tr_b16 a[116:117], v65 offset:45056
  ds_read_b64_tr_b16 a[118:119], v65 offset:46080
  s_waitcnt lgkmcnt(0)
  s_waitcnt vmcnt(24)
  s_barrier
  s_add_u32 m0, s51, 24576
  s_add_u32 s46, s62, 1572864
  buffer_load_dwordx4 v64, s[4:7], s46 offen  lds
  s_add_u32 m0, s51, 28672
  s_add_u32 s46, s62, 1966080
  buffer_load_dwordx4 v64, s[4:7], s46 offen  lds
  s_add_u32 m0, s51, 32768
  s_add_u32 s46, s62, 1572992
  buffer_load_dwordx4 v64, s[4:7], s46 offen  lds
  s_add_u32 m0, s51, 36864
  s_add_u32 s46, s62, 1966208
  buffer_load_dwordx4 v64, s[4:7], s46 offen  lds
  s_add_u32 m0, s51, 40960
  s_add_u32 s46, s62, 1573120
  buffer_load_dwordx4 v64, s[4:7], s46 offen  lds
  s_add_u32 m0, s51, 45056
  s_add_u32 s46, s62, 1966336
  buffer_load_dwordx4 v64, s[4:7], s46 offen  lds
  ds_read_b64_tr_b16 a[120:121], v65 offset:49152
  ds_read_b64_tr_b16 a[122:123], v65 offset:50176
  ds_read_b64_tr_b16 a[124:125], v65 offset:53248
  ds_read_b64_tr_b16 a[126:127], v65 offset:54272
  ds_read_b64_tr_b16 a[128:129], v65 offset:57344
  ds_read_b64_tr_b16 a[130:131], v65 offset:58368
  ds_read_b64_tr_b16 a[132:133], v65 offset:61440
  ds_read_b64_tr_b16 a[134:135], v65 offset:62464
  ds_read_b64_tr_b16 a[136:137], v66 offset:0
  ds_read_b64_tr_b16 a[138:139], v66 offset:1024
  ds_read_b64_tr_b16 a[140:141], v66 offset:4096
  ds_read_b64_tr_b16 a[142:143], v66 offset:5120
  s_waitcnt lgkmcnt(0)
  s_waitcnt vmcnt(24)
  s_barrier
  s_add_u32 m0, s51, 49152
  s_add_u32 s46, s62, 3145728
  buffer_load_dwordx4 v64, s[4:7], s46 offen  lds
  s_add_u32 m0, s51, 53248
  s_add_u32 s46, s62, 3538944
  buffer_load_dwordx4 v64, s[4:7], s46 offen  lds
  s_add_u32 m0, s51, 57344
  s_add_u32 s46, s62, 3145856
  buffer_load_dwordx4 v64, s[4:7], s46 offen  lds
  s_add_u32 m0, s51, 61440
  s_add_u32 s46, s62, 3539072
  buffer_load_dwordx4 v64, s[4:7], s46 offen  lds
  s_add_u32 m0, s51, 65536
  s_add_u32 s46, s62, 3145984
  buffer_load_dwordx4 v64, s[4:7], s46 offen  lds
  s_add_u32 m0, s51, 69632
  s_add_u32 s46, s62, 3539200
  buffer_load_dwordx4 v64, s[4:7], s46 offen  lds
  ds_read_b64_tr_b16 a[144:145], v66 offset:8192
  ds_read_b64_tr_b16 a[146:147], v66 offset:9216
  ds_read_b64_tr_b16 a[148:149], v66 offset:12288
  ds_read_b64_tr_b16 a[150:151], v66 offset:13312
  ds_read_b64_tr_b16 a[152:153], v66 offset:16384
  ds_read_b64_tr_b16 a[154:155], v66 offset:17408
  ds_read_b64_tr_b16 a[156:157], v66 offset:20480
  ds_read_b64_tr_b16 a[158:159], v66 offset:21504
  ds_read_b64_tr_b16 a[160:161], v66 offset:24576
  ds_read_b64_tr_b16 a[162:163], v66 offset:25600
  ds_read_b64_tr_b16 a[164:165], v66 offset:28672
  ds_read_b64_tr_b16 a[166:167], v66 offset:29696
  s_waitcnt lgkmcnt(0)
  s_waitcnt vmcnt(24)
  s_barrier
  s_add_u32 m0, s51, 73728
  s_add_u32 s46, s62, 3932160
  buffer_load_dwordx4 v64, s[4:7], s46 offen  lds
  s_add_u32 m0, s51, 77824
  s_add_u32 s46, s62, 4325376
  buffer_load_dwordx4 v64, s[4:7], s46 offen  lds
  s_add_u32 m0, s51, 81920
  s_add_u32 s46, s62, 3932288
  buffer_load_dwordx4 v64, s[4:7], s46 offen  lds
  s_add_u32 m0, s51, 86016
  s_add_u32 s46, s62, 4325504
  buffer_load_dwordx4 v64, s[4:7], s46 offen  lds
  s_add_u32 m0, s51, 90112
  s_add_u32 s46, s62, 3932416
  buffer_load_dwordx4 v64, s[4:7], s46 offen  lds
  s_add_u32 m0, s51, 94208
  s_add_u32 s46, s62, 4325632
  buffer_load_dwordx4 v64, s[4:7], s46 offen  lds
  ds_read_b64_tr_b16 a[168:169], v66 offset:32768
  ds_read_b64_tr_b16 a[170:171], v66 offset:33792
  ds_read_b64_tr_b16 a[172:173], v66 offset:36864
  ds_read_b64_tr_b16 a[174:175], v66 offset:37888
  ds_read_b64_tr_b16 a[176:177], v66 offset:40960
  ds_read_b64_tr_b16 a[178:179], v66 offset:41984
  ds_read_b64_tr_b16 a[180:181], v66 offset:45056
  ds_read_b64_tr_b16 a[182:183], v66 offset:46080
  ds_read_b64_tr_b16 a[184:185], v66 offset:49152
  ds_read_b64_tr_b16 a[186:187], v66 offset:50176
  ds_read_b64_tr_b16 a[188:189], v66 offset:53248
  ds_read_b64_tr_b16 a[190:191], v66 offset:54272
  s_waitcnt lgkmcnt(0)
  s_waitcnt vmcnt(24)
  s_barrier
  s_add_u32 m0, s51, 98304
  s_add_u32 s46, s62, 5505024
  buffer_load_dwordx4 v64, s[4:7], s46 offen  lds
  s_add_u32 m0, s51, 102400
  s_add_u32 s46, s62, 5898240
  buffer_load_dwordx4 v64, s[4:7], s46 offen  lds
  s_add_u32 m0, s51, 106496
  s_add_u32 s46, s62, 5505152
  buffer_load_dwordx4 v64, s[4:7], s46 offen  lds
  s_add_u32 m0, s51, 110592
  s_add_u32 s46, s62, 5898368
  buffer_load_dwordx4 v64, s[4:7], s46 offen  lds
  s_add_u32 m0, s51, 114688
  s_add_u32 s46, s62, 5505280
  buffer_load_dwordx4 v64, s[4:7], s46 offen  lds
  s_add_u32 m0, s51, 118784
  s_add_u32 s46, s62, 5898496
  buffer_load_dwordx4 v64, s[4:7], s46 offen  lds
  ds_read_b64_tr_b16 a[192:193], v66 offset:57344
  ds_read_b64_tr_b16 a[194:195], v66 offset:58368
  ds_read_b64_tr_b16 a[196:197], v66 offset:61440
  ds_read_b64_tr_b16 a[198:199], v66 offset:62464
  ds_read_b64_tr_b16 a[200:201], v67 offset:0
  ds_read_b64_tr_b16 a[202:203], v67 offset:1024
  ds_read_b64_tr_b16 a[204:205], v67 offset:4096
  ds_read_b64_tr_b16 a[206:207], v67 offset:5120
  ds_read_b64_tr_b16 a[208:209], v67 offset:8192
  ds_read_b64_tr_b16 a[210:211], v67 offset:9216
  ds_read_b64_tr_b16 a[212:213], v67 offset:12288
  ds_read_b64_tr_b16 a[214:215], v67 offset:13312
  s_waitcnt lgkmcnt(0)
  s_waitcnt vmcnt(24)
  s_barrier
  v_and_b32 v137, 3, v0
  v_lshlrev_b32 v137, 2, v137
  global_load_dword v136, v137, s[38:39] sc1
  s_add_u32 m0, s51, 122880
  s_add_u32 s46, s62, 6291456
  buffer_load_dwordx4 v64, s[4:7], s46 offen  lds
  s_add_u32 m0, s51, 126976
  s_add_u32 s46, s62, 6684672
  buffer_load_dwordx4 v64, s[4:7], s46 offen  lds
  s_add_u32 m0, s51, 131072
  s_add_u32 s46, s62, 6291584
  buffer_load_dwordx4 v64, s[4:7], s46 offen  lds
  s_add_u32 m0, s51, 135168
  s_add_u32 s46, s62, 6684800
  buffer_load_dwordx4 v64, s[4:7], s46 offen  lds
  s_add_u32 m0, s51, 139264
  s_add_u32 s46, s62, 6291712
  buffer_load_dwordx4 v64, s[4:7], s46 offen  lds
  s_add_u32 m0, s51, 143360
  s_add_u32 s46, s62, 6684928
  buffer_load_dwordx4 v64, s[4:7], s46 offen  lds
  ds_read_b64_tr_b16 a[216:217], v65 offset:0
  ds_read_b64_tr_b16 a[218:219], v65 offset:1024
  ds_read_b64_tr_b16 a[220:221], v65 offset:4096
  ds_read_b64_tr_b16 a[222:223], v65 offset:5120
  ds_read_b64_tr_b16 a[224:225], v65 offset:8192
  ds_read_b64_tr_b16 a[226:227], v65 offset:9216
  ds_read_b64_tr_b16 a[228:229], v65 offset:12288
  ds_read_b64_tr_b16 a[230:231], v65 offset:13312
  ds_read_b64_tr_b16 a[232:233], v65 offset:16384
  ds_read_b64_tr_b16 a[234:235], v65 offset:17408
  ds_read_b64_tr_b16 a[236:237], v65 offset:20480
  ds_read_b64_tr_b16 a[238:239], v65 offset:21504
  s_waitcnt lgkmcnt(0)
  s_waitcnt vmcnt(25)
  s_barrier
  s_add_u32 m0, s51, 0
  s_add_u32 s46, s62, 0
  buffer_load_dwordx4 v64, s[12:15], s46 offen  lds
  s_add_u32 m0, s51, 4096
  s_add_u32 s46, s62, 393216
  buffer_load_dwordx4 v64, s[12:15], s46 offen  lds
  s_add_u32 m0, s51, 8192
  s_add_u32 s46, s62, 128
  buffer_load_dwordx4 v64, s[12:15], s46 offen  lds
  s_add_u32 m0, s51, 12288
  s_add_u32 s46, s62, 393344
  buffer_load_dwordx4 v64, s[12:15], s46 offen  lds
  s_add_u32 m0, s51, 16384
  s_add_u32 s46, s62, 256
  buffer_load_dwordx4 v64, s[12:15], s46 offen  lds
  s_add_u32 m0, s51, 20480
  s_add_u32 s46, s62, 393472
  buffer_load_dwordx4 v64, s[12:15], s46 offen  lds
  ds_read_b64_tr_b16 a[240:241], v65 offset:24576
  ds_read_b64_tr_b16 a[242:243], v65 offset:25600
  ds_read_b64_tr_b16 a[244:245], v65 offset:28672
  ds_read_b64_tr_b16 a[246:247], v65 offset:29696
  ds_read_b64_tr_b16 a[248:249], v65 offset:32768
  ds_read_b64_tr_b16 a[250:251], v65 offset:33792
  ds_read_b64_tr_b16 a[252:253], v65 offset:36864
  ds_read_b64_tr_b16 a[254:255], v65 offset:37888
  ds_read_b64_tr_b16 v[152:153], v65 offset:40960
  ds_read_b64_tr_b16 v[154:155], v65 offset:41984
  ds_read_b64_tr_b16 v[156:157], v65 offset:45056
  ds_read_b64_tr_b16 v[158:159], v65 offset:46080
  s_waitcnt lgkmcnt(0)
  s_waitcnt vmcnt(25)
  s_barrier
  s_add_u32 m0, s51, 24576
  s_add_u32 s46, s62, 3932160
  buffer_load_dwordx4 v64, s[12:15], s46 offen  lds
  s_add_u32 m0, s51, 28672
  s_add_u32 s46, s62, 4325376
  buffer_load_dwordx4 v64, s[12:15], s46 offen  lds
  s_add_u32 m0, s51, 32768
  s_add_u32 s46, s62, 3932288
  buffer_load_dwordx4 v64, s[12:15], s46 offen  lds
  s_add_u32 m0, s51, 36864
  s_add_u32 s46, s62, 4325504
  buffer_load_dwordx4 v64, s[12:15], s46 offen  lds
  s_add_u32 m0, s51, 40960
  s_add_u32 s46, s62, 3932416
  buffer_load_dwordx4 v64, s[12:15], s46 offen  lds
  s_add_u32 m0, s51, 45056
  s_add_u32 s46, s62, 4325632
  buffer_load_dwordx4 v64, s[12:15], s46 offen  lds
  ds_read_b64_tr_b16 v[160:161], v65 offset:49152
  ds_read_b64_tr_b16 v[162:163], v65 offset:50176
  ds_read_b64_tr_b16 v[164:165], v65 offset:53248
  ds_read_b64_tr_b16 v[166:167], v65 offset:54272
  ds_read_b64_tr_b16 v[168:169], v65 offset:57344
  ds_read_b64_tr_b16 v[170:171], v65 offset:58368
  ds_read_b64_tr_b16 v[172:173], v65 offset:61440
  ds_read_b64_tr_b16 v[174:175], v65 offset:62464
  ds_read_b64_tr_b16 v[176:177], v66 offset:0
  ds_read_b64_tr_b16 v[178:179], v66 offset:1024
  ds_read_b64_tr_b16 v[180:181], v66 offset:4096
  ds_read_b64_tr_b16 v[182:183], v66 offset:5120
  s_waitcnt lgkmcnt(0)
  s_waitcnt vmcnt(25)
  s_barrier
  s_add_u32 m0, s51, 49152
  s_add_u32 s46, s62, 2359296
  buffer_load_dwordx4 v64, s[4:7], s46 offen  lds
  s_add_u32 m0, s51, 53248
  s_add_u32 s46, s62, 2752512
  buffer_load_dwordx4 v64, s[4:7], s46 offen  lds
  s_add_u32 m0, s51, 57344
  s_add_u32 s46, s62, 2359424
  buffer_load_dwordx4 v64, s[4:7], s46 offen  lds
  s_add_u32 m0, s51, 61440
  s_add_u32 s46, s62, 2752640
  buffer_load_dwordx4 v64, s[4:7], s46 offen  lds
  s_add_u32 m0, s51, 65536
  s_add_u32 s46, s62, 2359552
  buffer_load_dwordx4 v64, s[4:7], s46 offen  lds
  s_add_u32 m0, s51, 69632
  s_add_u32 s46, s62, 2752768
  buffer_load_dwordx4 v64, s[4:7], s46 offen  lds
  ds_read_b64_tr_b16 v[184:185], v66 offset:8192
  ds_read_b64_tr_b16 v[186:187], v66 offset:9216
  ds_read_b64_tr_b16 v[188:189], v66 offset:12288
  ds_read_b64_tr_b16 v[190:191], v66 offset:13312
  ds_read_b64_tr_b16 v[192:193], v66 offset:16384
  ds_read_b64_tr_b16 v[194:195], v66 offset:17408
  ds_read_b64_tr_b16 v[196:197], v66 offset:20480
  ds_read_b64_tr_b16 v[198:199], v66 offset:21504
  ds_read_b64_tr_b16 v[200:201], v66 offset:24576
  ds_read_b64_tr_b16 v[202:203], v66 offset:25600
  ds_read_b64_tr_b16 v[204:205], v66 offset:28672
  ds_read_b64_tr_b16 v[206:207], v66 offset:29696
  s_waitcnt lgkmcnt(0)
  s_waitcnt vmcnt(25)
  s_barrier
  s_add_u32 m0, s51, 73728
  s_add_u32 s46, s62, 4718592
  buffer_load_dwordx4 v64, s[4:7], s46 offen  lds
  s_add_u32 m0, s51, 77824
  s_add_u32 s46, s62, 5111808
  buffer_load_dwordx4 v64, s[4:7], s46 offen  lds
  s_add_u32 m0, s51, 81920
  s_add_u32 s46, s62, 4718720
  buffer_load_dwordx4 v64, s[4:7], s46 offen  lds
  s_add_u32 m0, s51, 86016
  s_add_u32 s46, s62, 5111936
  buffer_load_dwordx4 v64, s[4:7], s46 offen  lds
  s_add_u32 m0, s51, 90112
  s_add_u32 s46, s62, 4718848
  buffer_load_dwordx4 v64, s[4:7], s46 offen  lds
  s_add_u32 m0, s51, 94208
  s_add_u32 s46, s62, 5112064
  buffer_load_dwordx4 v64, s[4:7], s46 offen  lds
  ds_read_b64_tr_b16 v[208:209], v66 offset:32768
  ds_read_b64_tr_b16 v[210:211], v66 offset:33792
  ds_read_b64_tr_b16 v[212:213], v66 offset:36864
  ds_read_b64_tr_b16 v[214:215], v66 offset:37888
  ds_read_b64_tr_b16 v[216:217], v66 offset:40960
  ds_read_b64_tr_b16 v[218:219], v66 offset:41984
  ds_read_b64_tr_b16 v[220:221], v66 offset:45056
  ds_read_b64_tr_b16 v[222:223], v66 offset:46080
  ds_read_b64_tr_b16 v[224:225], v66 offset:49152
  ds_read_b64_tr_b16 v[226:227], v66 offset:50176
  ds_read_b64_tr_b16 v[228:229], v66 offset:53248
  ds_read_b64_tr_b16 v[230:231], v66 offset:54272
  s_waitcnt lgkmcnt(0)
  s_waitcnt vmcnt(24)
  s_barrier
  s_add_u32 m0, s51, 98304
  s_add_u32 s46, s62, 7077888
  buffer_load_dwordx4 v64, s[4:7], s46 offen  lds
  s_add_u32 m0, s51, 102400
  s_add_u32 s46, s62, 7471104
  buffer_load_dwordx4 v64, s[4:7], s46 offen  lds
  s_add_u32 m0, s51, 106496
  s_add_u32 s46, s62, 7078016
  buffer_load_dwordx4 v64, s[4:7], s46 offen  lds
  s_add_u32 m0, s51, 110592
  s_add_u32 s46, s62, 7471232
  buffer_load_dwordx4 v64, s[4:7], s46 offen  lds
  s_add_u32 m0, s51, 114688
  s_add_u32 s46, s62, 7078144
  buffer_load_dwordx4 v64, s[4:7], s46 offen  lds
  s_add_u32 m0, s51, 118784
  s_add_u32 s46, s62, 7471360
  buffer_load_dwordx4 v64, s[4:7], s46 offen  lds
  ds_read_b64_tr_b16 v[232:233], v66 offset:57344
  ds_read_b64_tr_b16 v[234:235], v66 offset:58368
  ds_read_b64_tr_b16 v[236:237], v66 offset:61440
  ds_read_b64_tr_b16 v[238:239], v66 offset:62464
  ds_read_b64_tr_b16 v[240:241], v67 offset:0
  ds_read_b64_tr_b16 v[242:243], v67 offset:1024
  ds_read_b64_tr_b16 v[244:245], v67 offset:4096
  ds_read_b64_tr_b16 v[246:247], v67 offset:5120
  ds_read_b64_tr_b16 v[248:249], v67 offset:8192
  ds_read_b64_tr_b16 v[250:251], v67 offset:9216
  ds_read_b64_tr_b16 v[252:253], v67 offset:12288
  ds_read_b64_tr_b16 v[254:255], v67 offset:13312
  s_waitcnt lgkmcnt(0)
  s_mov_b32 s50, 0
  s_branch ss_15_in
ss_15:
  v_and_b32 v137, 3, v0
  v_lshlrev_b32 v137, 2, v137
  global_load_dword v136, v137, s[38:39] sc1
  s_add_u32 s50, s50, 1
  s_cmp_gt_u32 s50, 131072
  s_cbranch_scc1 L_fail
  s_waitcnt vmcnt(0)
ss_15_in:
  v_readlane_b32 s46, v136, 0
  v_readlane_b32 s47, v136, 2
  v_readlane_b32 s48, v136, 1
  s_nop 0
  s_min_u32 s47, s47, s48
  s_cmp_lg_u32 s46, 0
  s_cselect_b32 s48, 7, 0
  s_add_u32 s46, s46, s2
  s_xor_b32 s49, s46, s43
  s_and_b32 s49, s49, s48
  s_cbranch_scc1 L_reroll
  s_cmp_lg_u32 s47, 0
  s_cbranch_scc1 ss_ok_16
  s_sleep 6
  s_branch ss_15
ss_ok_16:
  v_readlane_b32 s3, v136, 1
  s_nop 0
  s_and_b32 s3, s3, 0x2000
  s_lshr_b32 s46, s44, 4
  s_lshl_b32 s46, s46, 7
  s_lshl_b32 s47, s43, 4
  s_add_u32 s46, s46, s47
  s_and_b32 s47, s44, 15
  s_add_u32 s46, s46, s47
  s_lshl_b32 s46, s46, 7
  s_add_u32 s46, s46, s3
  s_add_u32 s46, s46, 13369344
  s_add_u32 s40, s8, s46
  s_addc_u32 s41, s9, 0
  s_sub_u32 s47, s44, 0
  s_lshl_b32 s46, s47, 11
  s_lshl_b32 s48, s43, 2
  s_add_u32 s46, s46, s48
  s_add_u32 s46, s46, s3
  s_add_u32 s46, s46, 13385728
  v_lshl_add_u32 v11, v0, 7, s46
  v_mov_b32 v136, 2146435072
  s_cmp_lt_u32 s47, 4
  s_cselect_b32 vcc_lo, 1023, 0
  s_mov_b32 vcc_hi, 0
  v_cndmask_b32 v11, v136, v11, vcc
  v_mov_b32 v7, 0x44444444
  v_mov_b32 v136, 0xeeeeeeee
  v_and_b32 v137, 2, v0
  v_cmp_ne_u32 vcc, 0, v137
  s_nop 1
  v_cndmask_b32 v7, v7, v136, vcc
  s_mov_b32 s68, 1037384597
  s_mov_b32 s70, 3494803967
  v_and_b32 v136, 15, v0
  v_lshrrev_b32 v138, 4, v0
  v_lshlrev_b32 v4, 4, v136
  v_lshl_add_u32 v4, v138, 2, v4
  s_lshl_b32 s46, s42, 8
  s_add_u32 s46, s46, 147456
  v_add_u32 v4, s46, v4
  v_lshlrev_b32 v5, 7, v138
  v_bfe_u32 v137, v0, 2, 2
  v_lshl_add_u32 v5, v137, 4, v5
  v_and_b32 v137, 1, v0
  v_lshl_add_u32 v5, v137, 3, v5
  v_add_u32 v5, 147456, v5
  v_add_u32 v13, 122880, v1
  v_add_u32 v149, 153600, v1
  v_bfe_u32 v140, v0, 1, 2
  v_lshl_add_u32 v140, v140, 2, v137
  v_bfe_u32 v137, v0, 3, 1
  v_lshl_add_u32 v140, v137, 1, v140
  v_cmp_eq_u32 s[18:19], 1, v137
  s_add_u32 s46, s3, 12582912
  s_lshr_b32 s47, s45, 4
  s_add_u32 s47, s47, 1
  s_lshl_b32 s47, s47, 14
  s_and_b32 s48, s45, 15
  s_lshl_b32 s48, s48, 9
  s_add_u32 s47, s47, s48
  s_add_u32 s47, s47, s46
  v_lshrrev_b32 v137, 1, v138
  v_and_b32 v139, 1, v138
  v_lshl_add_u32 v8, v137, 4, v140
  v_lshlrev_b32 v8, 4, v8
  v_lshl_add_u32 v8, v139, 3, v8
  v_add_u32 v8, s47, v8
  s_lshl_b32 s47, s45, 7
  s_and_b32 s48, s45, 1
  s_mul_i32 s48, s48, 120
  s_sub_u32 s47, s47, s48
  s_add_u32 s47, s47, s46
  s_add_u32 s47, s47, 51200
  v_lshlrev_b32 v9, 4, v140
  v_lshl_add_u32 v9, v139, 2, v9
  v_add_u32 v9, s47, v9
  v_lshl_add_u32 v9, v137, 30, v9
  v_lshlrev_b32 v14, 4, v136
  v_lshl_add_u32 v14, v139, 3, v14
  v_lshl_add_u32 v14, v137, 2, v14
  s_lshl_b32 s47, s45, 8
  s_add_u32 s47, s47, 65536
  v_add_u32 v14, s47, v14
  s_lshl_b32 s47, s42, 4
  v_add_u32 v136, s47, v136
  v_lshlrev_b32 v138, 2, v138
  v_sub_u32 v136, v136, v138
  v_cmp_gt_i32 s[72:73], 0, v136
  v_cmp_gt_i32 s[74:75], 1, v136
  v_cmp_gt_i32 s[76:77], 2, v136
  v_cmp_gt_i32 s[78:79], 3, v136
  v_cmp_gt_i32 s[80:81], 16, v136
  v_cmp_gt_i32 s[82:83], 17, v136
  v_cmp_gt_i32 s[84:85], 18, v136
  v_cmp_gt_i32 s[86:87], 19, v136
  s_lshl_b32 s46, s45, 7
  s_lshl_b32 s47, s42, 2
  s_add_u32 s47, s47, s46
  s_add_u32 s47, s47, 13676544
  s_xor_b32 s47, s47, s3
  v_mov_b32 v15, s47
  s_add_u32 s67, s46, 13639680
  s_xor_b32 s67, s67, s3
  s_mov_b32 s23, s45
  s_lshl_b32 s20, s42, 24
  s_add_u32 s20, s20, s3
  s_add_u32 s20, s20, 16777216
  s_xor_b32 s20, s20, 0
  s_lshl_b32 s26, s42, 11
  s_lshl_b32 s46, s42, 24
  s_sub_u32 s26, s26, s46
  s_cmp_eq_u32 s42, 2
  s_cselect_b32 s26, 2012217344, s26
  s_lshl_b32 s21, s42, 12
  s_add_u32 s21, s21, 122880
  s_mov_b32 s22, 12288
  s_mul_i32 s64, s42, 81920
  s_add_u32 s64, s64, s3
  s_add_u32 s64, s64, 14680064
  s_lshr_b32 s27, s45, 3
  s_lshl_b32 s27, s27, 14
  s_and_b32 s46, s45, 7
  s_lshl_b32 s46, s46, 10
  s_add_u32 s27, s27, s46
  s_mov_b32 s61, 0
  s_mov_b32 s52, 0
  s_mov_b32 s58, 0
  v_mov_b32 v150, -1
  v_mov_b32 v151, -1
  s_mov_b32 s65, 524288
  s_mov_b32 s100, 0
  s_add_u32 s46, s42, 3
  s_lshl_b32 s31, s46, 10
  s_cmp_ge_u32 s46, 8
  s_cselect_b32 s47, 40960, 0
  s_add_u32 s31, s31, s47
  s_cmp_ge_u32 s46, 10
  s_cselect_b32 s31, 2146435072, s31
  s_add_u32 s46, s42, 7
  s_lshl_b32 s32, s46, 10
  s_cmp_ge_u32 s46, 8
  s_cselect_b32 s47, 40960, 0
  s_add_u32 s32, s32, s47
  s_cmp_ge_u32 s46, 10
  s_cselect_b32 s32, 2146435072, s32
  s_waitcnt vmcnt(24)
  s_barrier
  ds_read_b64_tr_b16 v[40:41], v65 offset:0
  ds_read_b64_tr_b16 v[42:43], v65 offset:1024
  ds_read_b64_tr_b16 v[44:45], v65 offset:4096
  ds_read_b64_tr_b16 v[46:47], v65 offset:5120
  ds_read_b64_tr_b16 v[48:49], v65 offset:8192
  ds_read_b64_tr_b16 v[50:51], v65 offset:9216
  ds_read_b64_tr_b16 v[52:53], v65 offset:12288
  ds_read_b64_tr_b16 v[54:55], v65 offset:13312
  ds_read_b64_tr_b16 v[56:57], v65 offset:16384
  ds_read_b64_tr_b16 v[58:59], v65 offset:17408
  ds_read_b64_tr_b16 v[60:61], v65 offset:20480
  ds_read_b64_tr_b16 v[62:63], v65 offset:21504
  s_waitcnt lgkmcnt(0)
  s_waitcnt vmcnt(18)
  s_barrier
  ds_write_b128 v2, v[40:43] offset:0
  ds_write_b128 v2, v[44:47] offset:4096
  ds_write_b128 v2, v[48:51] offset:8192
  ds_write_b128 v2, v[52:55] offset:12288
  ds_write_b128 v2, v[56:59] offset:16384
  ds_write_b128 v2, v[60:63] offset:20480
  ds_read_b64_tr_b16 v[16:17], v65 offset:24576
  ds_read_b64_tr_b16 v[18:19], v65 offset:25600
  ds_read_b64_tr_b16 v[20:21], v65 offset:28672
  ds_read_b64_tr_b16 v[22:23], v65 offset:29696
  ds_read_b64_tr_b16 v[24:25], v65 offset:32768
  ds_read_b64_tr_b16 v[26:27], v65 offset:33792
  ds_read_b64_tr_b16 v[28:29], v65 offset:36864
  ds_read_b64_tr_b16 v[30:31], v65 offset:37888
  ds_read_b64_tr_b16 v[32:33], v65 offset:40960
  ds_read_b64_tr_b16 v[34:35], v65 offset:41984
  ds_read_b64_tr_b16 v[36:37], v65 offset:45056
  ds_read_b64_tr_b16 v[38:39], v65 offset:46080
  s_waitcnt lgkmcnt(0)
  s_waitcnt vmcnt(12)
  s_barrier
  ds_write_b128 v2, v[16:19] offset:24576
  ds_write_b128 v2, v[20:23] offset:28672
  ds_write_b128 v2, v[24:27] offset:32768
  ds_write_b128 v2, v[28:31] offset:36864
  ds_write_b128 v2, v[32:35] offset:40960
  ds_write_b128 v2, v[36:39] offset:45056
  ds_read_b64_tr_b16 v[40:41], v65 offset:49152
  ds_read_b64_tr_b16 v[42:43], v65 offset:50176
  ds_read_b64_tr_b16 v[44:45], v65 offset:53248
  ds_read_b64_tr_b16 v[46:47], v65 offset:54272
  ds_read_b64_tr_b16 v[48:49], v65 offset:57344
  ds_read_b64_tr_b16 v[50:51], v65 offset:58368
  ds_read_b64_tr_b16 v[52:53], v65 offset:61440
  ds_read_b64_tr_b16 v[54:55], v65 offset:62464
  ds_read_b64_tr_b16 v[56:57], v66 offset:0
  ds_read_b64_tr_b16 v[58:59], v66 offset:1024
  ds_read_b64_tr_b16 v[60:61], v66 offset:4096
  ds_read_b64_tr_b16 v[62:63], v66 offset:5120
  s_waitcnt lgkmcnt(0)
  s_waitcnt vmcnt(6)
  s_barrier
  ds_write_b128 v2, v[40:43] offset:49152
  ds_write_b128 v2, v[44:47] offset:53248
  ds_write_b128 v2, v[48:51] offset:57344
  ds_write_b128 v2, v[52:55] offset:61440
  ds_write_b128 v3, v[56:59] offset:0
  ds_write_b128 v3, v[60:63] offset:4096
  ds_read_b64_tr_b16 v[16:17], v66 offset:8192
  ds_read_b64_tr_b16 v[18:19], v66 offset:9216
  ds_read_b64_tr_b16 v[20:21], v66 offset:12288
  ds_read_b64_tr_b16 v[22:23], v66 offset:13312
  ds_read_b64_tr_b16 v[24:25], v66 offset:16384
  ds_read_b64_tr_b16 v[26:27], v66 offset:17408
  ds_read_b64_tr_b16 v[28:29], v66 offset:20480
  ds_read_b64_tr_b16 v[30:31], v66 offset:21504
  ds_read_b64_tr_b16 v[32:33], v66 offset:24576
  ds_read_b64_tr_b16 v[34:35], v66 offset:25600
  ds_read_b64_tr_b16 v[36:37], v66 offset:28672
  ds_read_b64_tr_b16 v[38:39], v66 offset:29696
  s_waitcnt lgkmcnt(0)
  s_waitcnt vmcnt(0)
  s_barrier
  ds_write_b128 v3, v[16:19] offset:8192
  ds_write_b128 v3, v[20:23] offset:12288
  ds_write_b128 v3, v[24:27] offset:16384
  ds_write_b128 v3, v[28:31] offset:20480
  ds_write_b128 v3, v[32:35] offset:24576
  ds_write_b128 v3, v[36:39] offset:28672
  ds_read_b64_tr_b16 v[40:41], v66 offset:32768
  ds_read_b64_tr_b16 v[42:43], v66 offset:33792
  ds_read_b64_tr_b16 v[44:45], v66 offset:36864
  ds_read_b64_tr_b16 v[46:47], v66 offset:37888
  ds_read_b64_tr_b16 v[48:49], v66 offset:40960
  ds_read_b64_tr_b16 v[50:51], v66 offset:41984
  ds_read_b64_tr_b16 v[52:53], v66 offset:45056
  ds_read_b64_tr_b16 v[54:55], v66 offset:46080
  ds_read_b64_tr_b16 v[56:57], v66 offset:49152
  ds_read_b64_tr_b16 v[58:59], v66 offset:50176
  ds_read_b64_tr_b16 v[60:61], v66 offset:53248
  ds_read_b64_tr_b16 v[62:63], v66 offset:54272
  s_waitcnt lgkmcnt(0)
  s_barrier
  ds_write_b128 v3, v[40:43] offset:32768
  ds_write_b128 v3, v[44:47] offset:36864
  ds_write_b128 v3, v[48:51] offset:40960
  ds_write_b128 v3, v[52:55] offset:45056
  ds_write_b128 v3, v[56:59] offset:49152
  ds_write_b128 v3, v[60:63] offset:53248
  s_waitcnt lgkmcnt(0)
  s_cmp_lg_u32 s42, 2
  s_cbranch_scc1 sc_k0
  s_mov_b32 s53, 1
  s_mov_b32 s50, 0
sw_loop_18:
  s_cmp_ge_u32 s61, s53
  s_cbranch_scc1 sw_done_17
  s_add_u32 s46, s67, 4096
  s_buffer_load_dword s72, s[8:11], s67 glc
  s_buffer_load_dword s73, s[8:11], s46 glc
  s_waitcnt lgkmcnt(0)
  s_add_u32 s72, s72, 1
  s_lshr_b32 s46, s73, 6
  s_add_u32 s73, s73, s46
  s_min_u32 s61, s72, s73
  s_add_u32 s50, s50, 1
  s_cmp_gt_u32 s50, 131072
  s_cbranch_scc1 L_fail
  s_branch sw_loop_18
sw_done_17:
sc_k0:
  s_barrier
  s_cmp_eq_u32 s42, 3
  s_cbranch_scc1 scs_loop
  s_mov_b32 m0, s21
  s_lshr_b32 s63, s23, 1
  s_lshl_b32 s63, s63, 14
  s_and_b32 s46, s23, 1
  s_lshl_b32 s46, s46, 12
  s_add_u32 s63, s63, s46
  s_add_u32 s63, s63, s20
  s_lshr_b32 s46, s63, 8
  s_and_b32 s46, s46, 0x2000
  s_xor_b32 s63, s63, s46
  buffer_load_dwordx4 v1, s[8:11], s63 offen offset:0 sc1 lds
  buffer_load_dwordx4 v1, s[8:11], s63 offen offset:1024 sc1 lds
  buffer_load_dwordx4 v1, s[8:11], s63 offen offset:2048 sc1 lds
  buffer_load_dwordx4 v1, s[8:11], s63 offen offset:3072 sc1 lds
  s_waitcnt vmcnt(0)
  s_branch sch_loop
scs_loop:
  s_add_u32 s53, s52, 1
  s_lshl_b32 s56, s58, 2
  s_add_u32 s56, s56, s43
  s_lshl_b32 s56, s56, 16
  s_add_u32 s56, s56, s3
  s_add_u32 s56, s56, 12582912
  v_add_u32 v12, s56, v1
  s_lshl_b32 s66, s58, 18
  s_mov_b64 s[16:17], -1
  s_mov_b32 s71, 0
  ds_read_b128 v[56:59], v2 offset:0
  ds_read_b128 v[60:63], v2 offset:4096
  ds_read_b128 v[64:67], v2 offset:8192
  ds_read_b128 v[68:71], v2 offset:12288
  ds_read_b128 v[72:75], v2 offset:16384
  ds_read_b128 v[76:79], v2 offset:20480
  ds_read_b128 v[80:83], v2 offset:49152
  ds_read_b128 v[84:87], v2 offset:53248
  v_mov_b32 v88, 0
  v_mov_b32 v89, 0
  v_mov_b32 v90, 0
  v_mov_b32 v91, 0
  v_mov_b32 v92, 0
  v_mov_b32 v93, 0
  v_mov_b32 v94, 0
  v_mov_b32 v95, 0
  v_mov_b32 v96, 0
  v_mov_b32 v97, 0
  v_mov_b32 v98, 0
  v_mov_b32 v99, 0
  v_mov_b32 v100, 0
  v_mov_b32 v101, 0
  v_mov_b32 v102, 0
  v_mov_b32 v103, 0
  v_mov_b32 v104, 0
  v_mov_b32 v105, 0
  v_mov_b32 v106, 0
  v_mov_b32 v107, 0
  v_mov_b32 v108, 0
  v_mov_b32 v109, 0
  v_mov_b32 v110, 0
  v_mov_b32 v111, 0
  s_cmp_lt_u32 s52, 1
  s_cselect_b32 s71, 1, 0
  s_sub_u32 s46, s53, s71
  v_mov_b32 v6, s46
  s_waitcnt lgkmcnt(0)
  s_mov_b32 s50, 0
scs_top:
  s_barrier
  buffer_load_dwordx4 v[16:19], v12, s[8:11], 0 offen offset:0 sc1
  s_add_u32 m0, s51, 153600
  s_barrier
  buffer_load_dwordx4 v[20:23], v12, s[8:11], 0 offen offset:1024 sc1
  s_barrier
  buffer_load_dwordx4 v[24:27], v12, s[8:11], 0 offen offset:2048 sc1
  s_barrier
  buffer_load_dwordx4 v12, s[8:11], s31 offen sc1 lds
  s_add_u32 m0, s51, 157696
  s_barrier
  buffer_load_dwordx4 v12, s[8:11], s32 offen sc1 lds
  s_waitcnt vmcnt(4)
scs_go0:
scs_go:
  v_smfmac_f32_16x16x64_bf16 v[88:91], v[16:19], a[192:199], v7
  v_smfmac_f32_16x16x64_bf16 v[92:95], v[16:19], a[200:207], v7
  v_smfmac_f32_16x16x64_bf16 v[96:99], v[16:19], a[208:215], v7
  v_smfmac_f32_16x16x64_bf16 v[100:103], v[16:19], v[56:63], v7
  v_smfmac_f32_16x16x64_bf16 v[104:107], v[16:19], v[64:71], v7
  ds_read_b128 v[56:59], v2 offset:57344
  v_smfmac_f32_16x16x64_bf16 v[108:111], v[16:19], v[72:79], v7
  s_waitcnt vmcnt(3)
  ds_read_b128 v[60:63], v2 offset:61440
  v_smfmac_f32_16x16x64_bf16 v[88:91], v[20:23], a[216:223], v7
  ds_read_b128 v[64:67], v3 offset:0
  v_smfmac_f32_16x16x64_bf16 v[92:95], v[20:23], a[224:231], v7
  ds_read_b128 v[68:71], v3 offset:4096
  v_smfmac_f32_16x16x64_bf16 v[96:99], v[20:23], a[232:239], v7
  s_waitcnt vmcnt(2)
  v_max3_u32 v136, v16, v20, v24
  v_smfmac_f32_16x16x64_bf16 v[100:103], v[20:23], a[0:7], v7
  ds_read_b128 v[72:75], v3 offset:8192
  v_cmp_eq_u32 vcc, -1, v136
  v_smfmac_f32_16x16x64_bf16 v[104:107], v[20:23], a[8:15], v7
  ds_read_b128 v[76:79], v3 offset:12288
  v_smfmac_f32_16x16x64_bf16 v[108:111], v[20:23], a[16:23], v7
  s_cbranch_vccnz scs_ha
  v_smfmac_f32_16x16x64_bf16 v[88:91], v[24:27], a[240:247], v7
  s_waitcnt vmcnt(1)
  s_barrier
  ds_read_b128 v[28:31], v149 offset:0
  v_smfmac_f32_16x16x64_bf16 v[92:95], v[24:27], a[248:255], v7
  ds_read_b128 v[32:35], v149 offset:1024
  v_smfmac_f32_16x16x64_bf16 v[96:99], v[24:27], v[152:159], v7
  ds_read_b128 v[36:39], v149 offset:2048
  v_smfmac_f32_16x16x64_bf16 v[100:103], v[24:27], a[24:31], v7
  ds_read_b128 v[40:43], v149 offset:3072
  v_smfmac_f32_16x16x64_bf16 v[104:107], v[24:27], a[32:39], v7
  v_smfmac_f32_16x16x64_bf16 v[108:111], v[24:27], a[40:47], v7
  s_waitcnt vmcnt(0)
  s_barrier
  s_waitcnt lgkmcnt(3)
  v_smfmac_f32_16x16x64_bf16 v[88:91], v[28:31], v[80:87], v7
  ds_read_b128 v[44:47], v149 offset:4096
  v_smfmac_f32_16x16x64_bf16 v[92:95], v[28:31], v[56:63], v7
  ds_read_b128 v[48:51], v149 offset:5120
  v_smfmac_f32_16x16x64_bf16 v[96:99], v[28:31], v[64:71], v7
  ds_read_b128 v[52:55], v149 offset:6144
  s_waitcnt lgkmcnt(3)
  v_smfmac_f32_16x16x64_bf16 v[88:91], v[32:35], v[160:167], v7
  ds_read_b128 v[80:83], v3 offset:32768
  v_smfmac_f32_16x16x64_bf16 v[92:95], v[32:35], v[168:175], v7
  ds_read_b128 v[84:87], v3 offset:36864
  v_smfmac_f32_16x16x64_bf16 v[96:99], v[32:35], v[176:183], v7
  ds_read_b128 v[56:59], v3 offset:16384
  v_smfmac_f32_16x16x64_bf16 v[88:91], v[36:39], v[184:191], v7
  s_waitcnt lgkmcnt(3)
  v_max3_u32 v136, v28, v32, v36
  v_smfmac_f32_16x16x64_bf16 v[92:95], v[36:39], v[192:199], v7
  ds_read_b128 v[60:63], v3 offset:20480
  v_max3_u32 v136, v136, v40, v44
  v_smfmac_f32_16x16x64_bf16 v[96:99], v[36:39], v[200:207], v7
  ds_read_b128 v[64:67], v3 offset:40960
  v_max3_u32 v136, v136, v48, v52
  v_smfmac_f32_16x16x64_bf16 v[88:91], v[44:47], v[208:215], v7
  ds_read_b128 v[68:71], v3 offset:45056
  v_cmp_eq_u32 vcc, -1, v136
  v_smfmac_f32_16x16x64_bf16 v[88:91], v[48:51], v[232:239], v7
  v_smfmac_f32_16x16x64_bf16 v[88:91], v[40:43], v[72:79], v7
  s_cbranch_vccnz scs_hb
  s_waitcnt lgkmcnt(3)
  v_smfmac_f32_16x16x64_bf16 v[88:91], v[52:55], v[80:87], v7
  ds_read_b128 v[72:75], v3 offset:24576
  ds_read_b128 v[16:19], v13 offset:8192
scs_join:
  v_smfmac_f32_16x16x64_bf16 v[92:95], v[44:47], v[216:223], v7
  ds_read_b128 v[76:79], v3 offset:28672
  ds_read_b128 v[20:23], v13 offset:10240
  v_smfmac_f32_16x16x64_bf16 v[92:95], v[48:51], v[240:247], v7
  ds_read_b128 v[80:83], v3 offset:49152
  s_waitcnt lgkmcnt(5)
  v_add_f32 v88, v88, v90
  v_smfmac_f32_16x16x64_bf16 v[92:95], v[40:43], v[56:63], v7
  ds_read_b128 v[84:87], v3 offset:53248
  v_add_f32 v89, v89, v91
  v_smfmac_f32_16x16x64_bf16 v[92:95], v[52:55], v[64:71], v7
  ds_read_b128 v[56:59], v2 offset:24576
  v_cmp_u_f32 vcc, v88, v89
  v_smfmac_f32_16x16x64_bf16 v[96:99], v[44:47], v[224:231], v7
  ds_read_b128 v[60:63], v2 offset:28672
  v_cvt_pk_bf16_f32 v136, v88, v89
  v_smfmac_f32_16x16x64_bf16 v[96:99], v[48:51], v[248:255], v7
  s_and_b64 vcc, vcc, s[16:17]
  s_cbranch_scc1 scs_redo
  s_waitcnt lgkmcnt(4)
  v_add_f32 v92, v92, v94
  v_smfmac_f32_16x16x64_bf16 v[96:99], v[40:43], v[72:79], v7
  ds_read_b128 v[64:67], v2 offset:32768
  s_waitcnt lgkmcnt(3)
  v_add_f32 v93, v93, v95
  v_smfmac_f32_16x16x64_bf16 v[96:99], v[52:55], v[80:87], v7
  ds_read_b128 v[68:71], v2 offset:36864
  v_cvt_pk_bf16_f32 v137, v92, v93
  v_smfmac_f32_16x16x64_bf16 v[100:103], v[28:31], a[48:55], v7
  ds_write2st64_b32 v4, v136, v137 offset0:0 offset1:4
  v_smfmac_f32_16x16x64_bf16 v[100:103], v[32:35], a[72:79], v7
  ds_read_b128 v[72:75], v2 offset:40960
  v_add_f32 v96, v96, v98
  v_smfmac_f32_16x16x64_bf16 v[100:103], v[40:43], a[96:103], v7
  ds_read_b128 v[76:79], v2 offset:45056
  s_waitcnt lgkmcnt(5)
  v_add_f32 v97, v97, v99
  v_smfmac_f32_16x16x64_bf16 v[100:103], v[36:39], v[56:63], v7
  ds_read_b128 v[24:27], v13 offset:9216
  v_cvt_pk_bf16_f32 v138, v96, v97
  v_smfmac_f32_16x16x64_bf16 v[100:103], v[44:47], a[120:127], v7
  ds_write_b32 v4, v138 offset:2048
  v_smfmac_f32_16x16x64_bf16 v[100:103], v[48:51], a[144:151], v7
  ds_read_b128 v[80:83], v13 offset:5120
  ds_read_b128 v[84:87], v13 offset:7168
  s_waitcnt lgkmcnt(6)
  v_smfmac_f32_16x16x64_bf16 v[104:107], v[36:39], v[64:71], v7
  ds_read_b128 v[56:59], v13 offset:0
  ds_read_b128 v[60:63], v13 offset:2048
  s_waitcnt lgkmcnt(6)
  v_smfmac_f32_16x16x64_bf16 v[108:111], v[36:39], v[72:79], v7
  ds_read_b128 v[64:67], v13 offset:1024
  ds_read_b128 v[68:71], v13 offset:3072
  v_smfmac_f32_16x16x64_bf16 v[100:103], v[52:55], a[168:175], v7
  s_waitcnt lgkmcnt(6)
  s_barrier
  v_smfmac_f32_16x16x64_bf16 v[104:107], v[28:31], a[56:63], v7
  ds_read_b64_tr_b16 v[112:113], v5 offset:0
  ds_read_b64_tr_b16 v[114:115], v5 offset:64
  v_smfmac_f32_16x16x64_bf16 v[104:107], v[32:35], a[80:87], v7
  ds_read_b64_tr_b16 v[116:117], v5 offset:512
  ds_read_b64_tr_b16 v[118:119], v5 offset:576
  v_smfmac_f32_16x16x64_bf16 v[104:107], v[40:43], a[104:111], v7
  ds_read_b64_tr_b16 v[120:121], v5 offset:1024
  ds_read_b64_tr_b16 v[122:123], v5 offset:1088
  buffer_store_dword v6, v11, s[8:11], 0 offen sc1
  v_smfmac_f32_16x16x64_bf16 v[104:107], v[44:47], a[128:135], v7
  ds_read_b64_tr_b16 v[124:125], v5 offset:1536
  ds_read_b64_tr_b16 v[126:127], v5 offset:1600
  v_smfmac_f32_16x16x64_bf16 v[104:107], v[48:51], a[152:159], v7
  ds_read_b64_tr_b16 v[128:129], v5 offset:2048
  ds_read_b64_tr_b16 v[130:131], v5 offset:2112
  v_smfmac_f32_16x16x64_bf16 v[104:107], v[52:55], a[176:183], v7
  ds_read_b64_tr_b16 v[132:133], v5 offset:2560
  ds_read_b64_tr_b16 v[134:135], v5 offset:2624
  v_smfmac_f32_16x16x64_bf16 v[108:111], v[28:31], a[64:71], v7
  ds_read_b128 v[72:75], v13 offset:4096
  v_add_f32 v100, v100, v102
  v_smfmac_f32_16x16x64_bf16 v[108:111], v[32:35], a[88:95], v7
  ds_read_b128 v[76:79], v13 offset:6144
  v_add_f32 v101, v101, v103
  v_smfmac_f32_16x16x64_bf16 v[108:111], v[40:43], a[112:119], v7
  ds_read_b128 v[36:39], v13 offset:11264
  v_cvt_pk_bf16_f32 v139, v100, v101
  v_smfmac_f32_16x16x64_bf16 v[108:111], v[44:47], a[136:143], v7
  v_add_f32 v104, v104, v106
  v_smfmac_f32_16x16x64_bf16 v[108:111], v[48:51], a[160:167], v7
  v_add_f32 v105, v105, v107
  v_smfmac_f32_16x16x64_bf16 v[108:111], v[52:55], a[184:191], v7
  s_waitcnt lgkmcnt(2)
  v_cvt_pk_bf16_f32 v140, v104, v105
  v_mfma_f32_16x16x32_bf16 v[88:91], v[56:59], v[112:115], 0
  ds_write2st64_b32 v4, v139, v140 offset0:12 offset1:16
  v_mfma_f32_16x16x32_bf16 v[92:95], v[60:63], v[112:115], 0
  v_add_f32 v108, v108, v110
  v_add_f32 v109, v109, v111
  v_mfma_f32_16x16x32_bf16 v[88:91], v[64:67], v[116:119], v[88:91]
  v_cvt_pk_bf16_f32 v141, v108, v109
  v_mfma_f32_16x16x32_bf16 v[92:95], v[68:71], v[116:119], v[92:95]
  ds_write_b32 v4, v141 offset:5120
  v_mfma_f32_16x16x32_bf16 v[88:91], v[72:75], v[120:123], v[88:91]
  s_waitcnt lgkmcnt(1)
  s_barrier
  v_mfma_f32_16x16x32_bf16 v[92:95], v[76:79], v[120:123], v[92:95]
  ds_read_b64_tr_b16 v[28:29], v5 offset:3072
  ds_read_b64_tr_b16 v[30:31], v5 offset:3136
  v_mfma_f32_16x16x32_bf16 v[88:91], v[80:83], v[124:127], v[88:91]
  ds_read_b64_tr_b16 v[32:33], v5 offset:3584
  ds_read_b64_tr_b16 v[34:35], v5 offset:3648
  v_mfma_f32_16x16x32_bf16 v[92:95], v[84:87], v[124:127], v[92:95]
  s_waitcnt lgkmcnt(4)
  s_barrier
  v_mfma_f32_16x16x32_bf16 v[88:91], v[16:19], v[128:131], v[88:91]
  ds_read_b64_tr_b16 v[40:41], v5 offset:4096
  ds_read_b64_tr_b16 v[42:43], v5 offset:4160
  v_mfma_f32_16x16x32_bf16 v[92:95], v[20:23], v[128:131], v[92:95]
  ds_read_b64_tr_b16 v[44:45], v5 offset:4608
  ds_read_b64_tr_b16 v[46:47], v5 offset:4672
  v_mfma_f32_16x16x32_bf16 v[88:91], v[24:27], v[132:135], v[88:91]
  ds_read_b64_tr_b16 v[48:49], v5 offset:5120
  ds_read_b64_tr_b16 v[50:51], v5 offset:5184
  v_mfma_f32_16x16x32_bf16 v[92:95], v[36:39], v[132:135], v[92:95]
  ds_read_b64_tr_b16 v[52:53], v5 offset:5632
  s_waitcnt lgkmcnt(7)
  v_mfma_f32_16x16x32_bf16 v[96:99], v[28:31], v[112:115], 0
  ds_read_b64_tr_b16 v[54:55], v5 offset:5696
  v_mfma_f32_16x16x32_bf16 v[96:99], v[32:35], v[116:119], v[96:99]
  s_waitcnt lgkmcnt(6)
  v_max3_f32 v142, v88, v89, v90
  v_max3_f32 v142, v142, v91, v92
  v_mfma_f32_16x16x32_bf16 v[96:99], v[40:43], v[120:123], v[96:99]
  s_waitcnt lgkmcnt(4)
  v_max3_f32 v142, v142, v93, v94
  v_max_f32 v142, v142, v95
  v_mfma_f32_16x16x32_bf16 v[96:99], v[44:47], v[124:127], v[96:99]
  s_waitcnt lgkmcnt(2)
  v_mov_b32 v143, v142
  v_cndmask_b32 v136, v88, v90, s[18:19]
  v_mfma_f32_16x16x32_bf16 v[96:99], v[48:51], v[128:131], v[96:99]
  s_waitcnt lgkmcnt(0)
  v_permlane32_swap_b32 v143, v142
  v_mfma_f32_16x16x32_bf16 v[96:99], v[52:55], v[132:135], v[96:99]
  s_barrier
  v_max_f32 v142, v142, v143
  v_cndmask_b32 v137, v89, v91, s[18:19]
  v_cndmask_b32 v138, v92, v94, s[18:19]
  v_cndmask_b32 v139, v93, v95, s[18:19]
  s_nop 2
  v_max3_f32 v142, v142, v96, v97
  v_max3_f32 v142, v142, v98, v99
  v_mov_b32 v143, v142
  v_cndmask_b32 v140, v96, v98, s[18:19]
  v_cndmask_b32 v141, v97, v99, s[18:19]
  v_permlane16_swap_b32 v143, v142
  v_max_f32 v142, v142, v143
  v_mul_f32 v142, s68, v142
  v_pk_fma_f32 v[136:137], v[136:137], s[68:69], v[142:143] op_sel_hi:[1,0,0] neg_lo:[0,0,1] neg_hi:[0,0,1]
  v_pk_fma_f32 v[138:139], v[138:139], s[68:69], v[142:143] op_sel_hi:[1,0,0] neg_lo:[0,0,1] neg_hi:[0,0,1]
  v_pk_fma_f32 v[140:141], v[140:141], s[68:69], v[142:143] op_sel_hi:[1,0,0] neg_lo:[0,0,1] neg_hi:[0,0,1]
  v_exp_f32 v136, v136
  v_exp_f32 v137, v137
  v_exp_f32 v138, v138
  v_exp_f32 v139, v139
  v_exp_f32 v140, v140
  v_pk_add_f32 v[144:145], v[136:137], v[138:139]
  v_add_f32 v142, v144, v145
  v_add_f32 v143, v144, v145
  v_exp_f32 v141, v141
  s_nop 0
  v_permlane32_swap_b32 v143, v142
  v_pk_add_f32 v[142:143], v[142:143], v[140:141]
  v_add_f32 v142, v142, v143
  s_nop 1
  v_add_f32_dpp v142, v142, v142 row_ror:8 row_mask:0xf bank_mask:0xf
  v_mov_b32 v143, v142
  s_nop 1
  v_permlane16_swap_b32 v143, v142
  v_add_f32 v142, v142, v143
  v_rcp_f32 v142, v142
  s_nop 0
  v_pk_mul_f32 v[136:137], v[136:137], v[142:143] op_sel_hi:[1,0]
  v_pk_mul_f32 v[138:139], v[138:139], v[142:143] op_sel_hi:[1,0]
  v_pk_mul_f32 v[140:141], v[140:141], v[142:143] op_sel_hi:[1,0]
  v_cvt_pk_bf16_f32 v146, v136, v137
  v_cvt_pk_bf16_f32 v147, v138, v139
  v_cvt_pk_bf16_f32 v148, v140, v141
  buffer_store_dwordx2 v[146:147], v8, s[8:11], s66 offen sc1
  buffer_store_dword v148, v9, s[8:11], s66 offen sc1
  s_cmp_eq_u32 s71, 0
  s_cbranch_scc1 scs_rung
  v_mov_b32 v6, s53
  buffer_store_dword v6, v11, s[8:11], 0 offen sc1
scs_rung:
  s_waitcnt vmcnt(0)
  buffer_store_dwordx2 v[150:151], v8, s[8:11], s65 offen sc1
  buffer_store_dword v150, v9, s[8:11], s65 offen sc1
  s_mov_b32 s65, s66
  v_add_u32 v13, s22, v13
  s_sub_u32 s22, 0, s22
  s_add_u32 s58, s58, 1
  s_cmp_eq_u32 s58, 3
  s_cselect_b32 s58, 0, s58
  s_mov_b32 s52, s53
  s_cmp_lt_u32 s52, 64
  s_cbranch_scc1 scs_loop
  s_endpgm
sch_loop:
  s_add_u32 s53, s52, 1
  s_lshl_b32 s56, s58, 2
  s_add_u32 s56, s56, s43
  s_lshl_b32 s56, s56, 16
  s_add_u32 s56, s56, s3
  s_add_u32 s56, s56, 12582912
  v_add_u32 v12, s56, v1
  s_lshl_b32 s66, s58, 18
  s_mov_b64 s[16:17], -1
  s_mov_b32 s71, 0
  ds_read_b128 v[56:59], v2 offset:0
  ds_read_b128 v[60:63], v2 offset:4096
  ds_read_b128 v[64:67], v2 offset:8192
  ds_read_b128 v[68:71], v2 offset:12288
  ds_read_b128 v[72:75], v2 offset:16384
  ds_read_b128 v[76:79], v2 offset:20480
  ds_read_b128 v[80:83], v2 offset:49152
  ds_read_b128 v[84:87], v2 offset:53248
  v_mov_b32 v88, 0
  v_mov_b32 v89, 0
  v_mov_b32 v90, 0
  v_mov_b32 v91, 0
  v_mov_b32 v92, 0
  v_mov_b32 v93, 0
  v_mov_b32 v94, 0
  v_mov_b32 v95, 0
  v_mov_b32 v96, 0
  v_mov_b32 v97, 0
  v_mov_b32 v98, 0
  v_mov_b32 v99, 0
  v_mov_b32 v100, 0
  v_mov_b32 v101, 0
  v_mov_b32 v102, 0
  v_mov_b32 v103, 0
  v_mov_b32 v104, 0
  v_mov_b32 v105, 0
  v_mov_b32 v106, 0
  v_mov_b32 v107, 0
  v_mov_b32 v108, 0
  v_mov_b32 v109, 0
  v_mov_b32 v110, 0
  v_mov_b32 v111, 0
  s_xor_b32 s28, s63, 0x2000
  s_add_u32 s28, s28, s26
  s_add_u32 s29, s28, 16777216
  s_add_u32 s30, s28, 33554432
  s_add_u32 s23, s23, 32
  s_cmp_ge_u32 s23, 1024
  s_cselect_b32 s46, 1024, 0
  s_sub_u32 s23, s23, s46
  s_lshr_b32 s63, s23, 1
  s_lshl_b32 s63, s63, 14
  s_and_b32 s46, s23, 1
  s_lshl_b32 s46, s46, 12
  s_add_u32 s63, s63, s46
  s_add_u32 s63, s63, s20
  s_lshr_b32 s46, s63, 8
  s_and_b32 s46, s46, 0x2000
  s_xor_b32 s63, s63, s46
  s_add_u32 s21, s21, s22
  s_waitcnt vmcnt(0) lgkmcnt(0)
  s_cmp_lg_u32 s42, 2
  s_cbranch_scc1 sc_nobell
  s_add_u32 s49, s52, 2
  s_mov_b32 s50, 0
sw_loop_20:
  s_cmp_ge_u32 s61, s49
  s_cbranch_scc1 sw_done_19
  s_add_u32 s46, s67, 4096
  s_buffer_load_dword s72, s[8:11], s67 glc
  s_buffer_load_dword s73, s[8:11], s46 glc
  s_waitcnt lgkmcnt(0)
  s_add_u32 s72, s72, 1
  s_lshr_b32 s46, s73, 6
  s_add_u32 s73, s73, s46
  s_min_u32 s61, s72, s73
  s_add_u32 s50, s50, 1
  s_cmp_gt_u32 s50, 131072
  s_cbranch_scc1 L_fail
  s_branch sw_loop_20
sw_done_19:
  s_mov_b32 s50, 0
  s_mov_b64 s[80:81], 0
  s_mov_b64 s[82:83], 0
  s_cmp_eq_u32 s53, 1
  s_cbranch_scc1 bell_x_22
bell_21:
  s_load_dwordx4 s[80:83], s[40:41], 0 glc
  s_min_u32 s46, s80, s81
  s_min_u32 s47, s82, s83
  s_min_u32 s46, s46, s47
  s_cmp_ge_u32 s46, s53
  s_cbranch_scc1 bell_x_22
  s_min_u32 s46, s80, s81
  s_min_u32 s47, s82, s83
  s_min_u32 s46, s46, s47
  s_cmp_ge_u32 s46, s53
  s_cbranch_scc1 bell_x_22
  s_min_u32 s46, s80, s81
  s_min_u32 s47, s82, s83
  s_min_u32 s46, s46, s47
  s_cmp_ge_u32 s46, s53
  s_cbranch_scc1 bell_x_22
  s_min_u32 s46, s80, s81
  s_min_u32 s47, s82, s83
  s_min_u32 s46, s46, s47
  s_cmp_ge_u32 s46, s53
  s_cbranch_scc1 bell_x_22
  s_min_u32 s46, s80, s81
  s_min_u32 s47, s82, s83
  s_min_u32 s46, s46, s47
  s_cmp_ge_u32 s46, s53
  s_cbranch_scc1 bell_x_22
  s_min_u32 s46, s80, s81
  s_min_u32 s47, s82, s83
  s_min_u32 s46, s46, s47
  s_cmp_ge_u32 s46, s53
  s_cbranch_scc1 bell_x_22
  s_min_u32 s46, s80, s81
  s_min_u32 s47, s82, s83
  s_min_u32 s46, s46, s47
  s_cmp_ge_u32 s46, s53
  s_cbranch_scc1 bell_x_22
  s_min_u32 s46, s80, s81
  s_min_u32 s47, s82, s83
  s_min_u32 s46, s46, s47
  s_cmp_ge_u32 s46, s53
  s_cbranch_scc1 bell_x_22
  s_add_u32 s50, s50, 1
  s_cmp_lt_u32 s50, 524288
  s_cbranch_scc1 bell_21
  s_branch L_fail
bell_x_22:
sc_nobell:
  s_mov_b32 s50, 0
sch_top:
  s_barrier
  buffer_load_dwordx4 v[16:19], v12, s[8:11], 0 offen offset:0 sc1
  s_add_u32 m0, s51, 153600
  s_barrier
  buffer_load_dwordx4 v[20:23], v12, s[8:11], 0 offen offset:1024 sc1
  s_barrier
  buffer_load_dwordx4 v[24:27], v12, s[8:11], 0 offen offset:2048 sc1
  s_barrier
  buffer_load_dwordx4 v12, s[8:11], s31 offen sc1 lds
  s_add_u32 m0, s51, 157696
  s_barrier
  buffer_load_dwordx4 v12, s[8:11], s32 offen sc1 lds
  s_waitcnt vmcnt(4)
sch_go0:
sch_go:
  v_smfmac_f32_16x16x64_bf16 v[88:91], v[16:19], a[192:199], v7
  v_smfmac_f32_16x16x64_bf16 v[92:95], v[16:19], a[200:207], v7
  v_smfmac_f32_16x16x64_bf16 v[96:99], v[16:19], a[208:215], v7
  v_smfmac_f32_16x16x64_bf16 v[100:103], v[16:19], v[56:63], v7
  v_smfmac_f32_16x16x64_bf16 v[104:107], v[16:19], v[64:71], v7
  ds_read_b128 v[56:59], v2 offset:57344
  v_smfmac_f32_16x16x64_bf16 v[108:111], v[16:19], v[72:79], v7
  s_waitcnt vmcnt(3)
  ds_read_b128 v[60:63], v2 offset:61440
  v_smfmac_f32_16x16x64_bf16 v[88:91], v[20:23], a[216:223], v7
  ds_read_b128 v[64:67], v3 offset:0
  v_smfmac_f32_16x16x64_bf16 v[92:95], v[20:23], a[224:231], v7
  ds_read_b128 v[68:71], v3 offset:4096
  v_smfmac_f32_16x16x64_bf16 v[96:99], v[20:23], a[232:239], v7
  s_waitcnt vmcnt(2)
  v_max3_u32 v136, v16, v20, v24
  v_smfmac_f32_16x16x64_bf16 v[100:103], v[20:23], a[0:7], v7
  ds_read_b128 v[72:75], v3 offset:8192
  v_cmp_eq_u32 vcc, -1, v136
  v_smfmac_f32_16x16x64_bf16 v[104:107], v[20:23], a[8:15], v7
  ds_read_b128 v[76:79], v3 offset:12288
  v_smfmac_f32_16x16x64_bf16 v[108:111], v[20:23], a[16:23], v7
  s_cbranch_vccnz sch_ha
  v_smfmac_f32_16x16x64_bf16 v[88:91], v[24:27], a[240:247], v7
  s_waitcnt vmcnt(1)
  s_barrier
  ds_read_b128 v[28:31], v149 offset:0
  v_smfmac_f32_16x16x64_bf16 v[92:95], v[24:27], a[248:255], v7
  ds_read_b128 v[32:35], v149 offset:1024
  v_smfmac_f32_16x16x64_bf16 v[96:99], v[24:27], v[152:159], v7
  ds_read_b128 v[36:39], v149 offset:2048
  v_smfmac_f32_16x16x64_bf16 v[100:103], v[24:27], a[24:31], v7
  ds_read_b128 v[40:43], v149 offset:3072
  v_smfmac_f32_16x16x64_bf16 v[104:107], v[24:27], a[32:39], v7
  v_smfmac_f32_16x16x64_bf16 v[108:111], v[24:27], a[40:47], v7
  s_waitcnt vmcnt(0)
  s_barrier
  s_waitcnt lgkmcnt(3)
  v_smfmac_f32_16x16x64_bf16 v[88:91], v[28:31], v[80:87], v7
  ds_read_b128 v[44:47], v149 offset:4096
  v_smfmac_f32_16x16x64_bf16 v[92:95], v[28:31], v[56:63], v7
  ds_read_b128 v[48:51], v149 offset:5120
  v_smfmac_f32_16x16x64_bf16 v[96:99], v[28:31], v[64:71], v7
  ds_read_b128 v[52:55], v149 offset:6144
  s_waitcnt lgkmcnt(3)
  v_smfmac_f32_16x16x64_bf16 v[88:91], v[32:35], v[160:167], v7
  ds_read_b128 v[80:83], v3 offset:32768
  v_smfmac_f32_16x16x64_bf16 v[92:95], v[32:35], v[168:175], v7
  ds_read_b128 v[84:87], v3 offset:36864
  v_smfmac_f32_16x16x64_bf16 v[96:99], v[32:35], v[176:183], v7
  ds_read_b128 v[56:59], v3 offset:16384
  v_smfmac_f32_16x16x64_bf16 v[88:91], v[36:39], v[184:191], v7
  s_waitcnt lgkmcnt(3)
  v_max3_u32 v136, v28, v32, v36
  v_smfmac_f32_16x16x64_bf16 v[92:95], v[36:39], v[192:199], v7
  ds_read_b128 v[60:63], v3 offset:20480
  v_max3_u32 v136, v136, v40, v44
  v_smfmac_f32_16x16x64_bf16 v[96:99], v[36:39], v[200:207], v7
  ds_read_b128 v[64:67], v3 offset:40960
  v_max3_u32 v136, v136, v48, v52
  v_smfmac_f32_16x16x64_bf16 v[88:91], v[44:47], v[208:215], v7
  ds_read_b128 v[68:71], v3 offset:45056
  v_cmp_eq_u32 vcc, -1, v136
  v_smfmac_f32_16x16x64_bf16 v[88:91], v[48:51], v[232:239], v7
  v_smfmac_f32_16x16x64_bf16 v[88:91], v[40:43], v[72:79], v7
  s_cbranch_vccnz sch_hb
  s_waitcnt lgkmcnt(3)
  v_smfmac_f32_16x16x64_bf16 v[88:91], v[52:55], v[80:87], v7
  ds_read_b128 v[72:75], v3 offset:24576
  s_mov_b32 m0, s21
sch_join:
  v_smfmac_f32_16x16x64_bf16 v[92:95], v[44:47], v[216:223], v7
  ds_read_b128 v[76:79], v3 offset:28672
  buffer_load_dwordx4 v[112:115], v1, s[8:11], s28 offen offset:0 sc1
  v_smfmac_f32_16x16x64_bf16 v[92:95], v[48:51], v[240:247], v7
  ds_read_b128 v[80:83], v3 offset:49152
  s_waitcnt lgkmcnt(3)
  v_add_f32 v88, v88, v90
  v_smfmac_f32_16x16x64_bf16 v[92:95], v[40:43], v[56:63], v7
  ds_read_b128 v[84:87], v3 offset:53248
  v_add_f32 v89, v89, v91
  v_smfmac_f32_16x16x64_bf16 v[92:95], v[52:55], v[64:71], v7
  ds_read_b128 v[56:59], v2 offset:24576
  buffer_load_dwordx4 v[116:119], v1, s[8:11], s28 offen offset:1024 sc1
  v_cmp_u_f32 vcc, v88, v89
  v_smfmac_f32_16x16x64_bf16 v[96:99], v[44:47], v[224:231], v7
  ds_read_b128 v[60:63], v2 offset:28672
  v_cvt_pk_bf16_f32 v136, v88, v89
  v_smfmac_f32_16x16x64_bf16 v[96:99], v[48:51], v[248:255], v7
  s_and_b64 vcc, vcc, s[16:17]
  s_cbranch_scc1 sch_redo
  s_waitcnt lgkmcnt(4)
  v_add_f32 v92, v92, v94
  v_smfmac_f32_16x16x64_bf16 v[96:99], v[40:43], v[72:79], v7
  ds_read_b128 v[64:67], v2 offset:32768
  buffer_load_dwordx4 v[120:123], v1, s[8:11], s29 offen offset:0 sc1
  s_waitcnt lgkmcnt(3)
  v_add_f32 v93, v93, v95
  v_smfmac_f32_16x16x64_bf16 v[96:99], v[52:55], v[80:87], v7
  ds_read_b128 v[68:71], v2 offset:36864
  v_cvt_pk_bf16_f32 v137, v92, v93
  v_smfmac_f32_16x16x64_bf16 v[100:103], v[28:31], a[48:55], v7
  ds_write2st64_b32 v4, v136, v137 offset0:0 offset1:4
  v_smfmac_f32_16x16x64_bf16 v[100:103], v[32:35], a[72:79], v7
  ds_read_b128 v[72:75], v2 offset:40960
  buffer_load_dwordx4 v[124:127], v1, s[8:11], s29 offen offset:1024 sc1
  v_add_f32 v96, v96, v98
  v_smfmac_f32_16x16x64_bf16 v[100:103], v[40:43], a[96:103], v7
  ds_read_b128 v[76:79], v2 offset:45056
  s_waitcnt lgkmcnt(5)
  v_add_f32 v97, v97, v99
  v_smfmac_f32_16x16x64_bf16 v[100:103], v[36:39], v[56:63], v7
  v_cvt_pk_bf16_f32 v138, v96, v97
  v_smfmac_f32_16x16x64_bf16 v[100:103], v[44:47], a[120:127], v7
  ds_write_b32 v4, v138 offset:2048
  buffer_load_dwordx4 v[128:131], v1, s[8:11], s30 offen offset:0 sc1
  v_smfmac_f32_16x16x64_bf16 v[100:103], v[48:51], a[144:151], v7
  s_waitcnt lgkmcnt(3)
  v_smfmac_f32_16x16x64_bf16 v[104:107], v[36:39], v[64:71], v7
  s_waitcnt lgkmcnt(1)
  v_smfmac_f32_16x16x64_bf16 v[108:111], v[36:39], v[72:79], v7
  buffer_load_dwordx4 v[132:135], v1, s[8:11], s30 offen offset:1024 sc1
  v_smfmac_f32_16x16x64_bf16 v[100:103], v[52:55], a[168:175], v7
  s_waitcnt lgkmcnt(0)
  s_barrier
  v_smfmac_f32_16x16x64_bf16 v[104:107], v[28:31], a[56:63], v7
  v_smfmac_f32_16x16x64_bf16 v[104:107], v[32:35], a[80:87], v7
  buffer_load_dwordx4 v1, s[8:11], s63 offen offset:0 sc1 lds
  v_add_f32 v100, v100, v102
  v_smfmac_f32_16x16x64_bf16 v[104:107], v[40:43], a[104:111], v7
  v_add_f32 v101, v101, v103
  v_smfmac_f32_16x16x64_bf16 v[104:107], v[44:47], a[128:135], v7
  v_cvt_pk_bf16_f32 v139, v100, v101
  v_smfmac_f32_16x16x64_bf16 v[104:107], v[48:51], a[152:159], v7
  buffer_load_dwordx4 v1, s[8:11], s63 offen offset:1024 sc1 lds
  v_smfmac_f32_16x16x64_bf16 v[104:107], v[52:55], a[176:183], v7
  v_smfmac_f32_16x16x64_bf16 v[108:111], v[28:31], a[64:71], v7
  v_smfmac_f32_16x16x64_bf16 v[108:111], v[32:35], a[88:95], v7
  buffer_load_dwordx4 v1, s[8:11], s63 offen offset:2048 sc1 lds
  v_add_f32 v104, v104, v106
  v_smfmac_f32_16x16x64_bf16 v[108:111], v[40:43], a[112:119], v7
  v_add_f32 v105, v105, v107
  v_smfmac_f32_16x16x64_bf16 v[108:111], v[44:47], a[136:143], v7
  v_cvt_pk_bf16_f32 v140, v104, v105
  v_smfmac_f32_16x16x64_bf16 v[108:111], v[48:51], a[160:167], v7
  ds_write2st64_b32 v4, v139, v140 offset0:12 offset1:16
  buffer_load_dwordx4 v1, s[8:11], s63 offen offset:3072 sc1 lds
  v_smfmac_f32_16x16x64_bf16 v[108:111], v[52:55], a[184:191], v7
  s_nop 7
  v_add_f32 v108, v108, v110
  v_add_f32 v109, v109, v111
  v_cvt_pk_bf16_f32 v141, v108, v109
  ds_write_b32 v4, v141 offset:5120
  s_waitcnt lgkmcnt(1)
  s_barrier
  s_waitcnt lgkmcnt(0)
  s_barrier
  s_barrier
  s_cmp_ge_u32 s42, 2
  s_cbranch_scc1 sc_nox
  ds_read_b128 v[56:59], v13 offset:0
  ds_read_b128 v[60:63], v13 offset:2048
  ds_read_b128 v[64:67], v13 offset:1024
  ds_read_b128 v[68:71], v13 offset:3072
  ds_read_b128 v[72:75], v13 offset:4096
  ds_read_b128 v[76:79], v13 offset:6144
  ds_read_b128 v[80:83], v13 offset:5120
  ds_read_b128 v[84:87], v13 offset:7168
  ds_read_b128 v[16:19], v13 offset:8192
  ds_read_b128 v[20:23], v13 offset:10240
  ds_read_b128 v[24:27], v13 offset:9216
  ds_read_b128 v[36:39], v13 offset:11264
  s_waitcnt vmcnt(4)
  s_waitcnt lgkmcnt(11)
  v_mfma_f32_16x16x32_bf16 v[88:91], v[56:59], v[112:115], 0
  ds_read_b64_tr_b16 v[28:29], v5 offset:3072
  s_waitcnt lgkmcnt(11)
  v_mfma_f32_16x16x32_bf16 v[92:95], v[60:63], v[112:115], 0
  ds_read_b64_tr_b16 v[30:31], v5 offset:3136
  s_waitcnt lgkmcnt(11)
  v_mfma_f32_16x16x32_bf16 v[88:91], v[64:67], v[116:119], v[88:91]
  ds_read_b64_tr_b16 v[32:33], v5 offset:3584
  s_waitcnt lgkmcnt(11)
  v_mfma_f32_16x16x32_bf16 v[92:95], v[68:71], v[116:119], v[92:95]
  ds_read_b64_tr_b16 v[34:35], v5 offset:3648
  s_waitcnt lgkmcnt(11)
  v_mfma_f32_16x16x32_bf16 v[88:91], v[72:75], v[120:123], v[88:91]
  ds_read_b64_tr_b16 v[40:41], v5 offset:4096
  s_waitcnt lgkmcnt(5)
  v_mfma_f32_16x16x32_bf16 v[92:95], v[76:79], v[120:123], v[92:95]
  ds_read_b64_tr_b16 v[42:43], v5 offset:4160
  v_mfma_f32_16x16x32_bf16 v[88:91], v[80:83], v[124:127], v[88:91]
  ds_read_b64_tr_b16 v[44:45], v5 offset:4608
  v_mfma_f32_16x16x32_bf16 v[92:95], v[84:87], v[124:127], v[92:95]
  ds_read_b64_tr_b16 v[46:47], v5 offset:4672
  v_mfma_f32_16x16x32_bf16 v[88:91], v[16:19], v[128:131], v[88:91]
  ds_read_b64_tr_b16 v[48:49], v5 offset:5120
  v_mfma_f32_16x16x32_bf16 v[92:95], v[20:23], v[128:131], v[92:95]
  ds_read_b64_tr_b16 v[50:51], v5 offset:5184
  v_mfma_f32_16x16x32_bf16 v[88:91], v[24:27], v[132:135], v[88:91]
  ds_read_b64_tr_b16 v[52:53], v5 offset:5632
  v_mfma_f32_16x16x32_bf16 v[92:95], v[36:39], v[132:135], v[92:95]
  ds_read_b64_tr_b16 v[54:55], v5 offset:5696
  s_waitcnt lgkmcnt(5)
  v_mfma_f32_16x16x32_bf16 v[96:99], v[28:31], v[112:115], 0
  v_mfma_f32_16x16x32_bf16 v[96:99], v[32:35], v[116:119], v[96:99]
  v_mfma_f32_16x16x32_bf16 v[96:99], v[40:43], v[120:123], v[96:99]
  s_waitcnt lgkmcnt(2)
  v_mfma_f32_16x16x32_bf16 v[96:99], v[44:47], v[124:127], v[96:99]
  v_mfma_f32_16x16x32_bf16 v[96:99], v[48:51], v[128:131], v[96:99]
  s_waitcnt lgkmcnt(0)
  v_mfma_f32_16x16x32_bf16 v[96:99], v[52:55], v[132:135], v[96:99]
  v_mov_b32 v143, s70
  v_cndmask_b32 v88, v88, v143, s[72:73]
  v_cndmask_b32 v89, v89, v143, s[74:75]
  v_cndmask_b32 v90, v90, v143, s[76:77]
  v_cndmask_b32 v91, v91, v143, s[78:79]
  v_cndmask_b32 v92, v92, v143, s[80:81]
  v_cndmask_b32 v93, v93, v143, s[82:83]
  v_cndmask_b32 v94, v94, v143, s[84:85]
  v_cndmask_b32 v95, v95, v143, s[86:87]
  s_mov_b32 vcc_lo, 0
  s_mov_b32 vcc_hi, -1
  v_cndmask_b32 v96, v96, v98, vcc
  v_cndmask_b32 v97, v97, v99, vcc
  v_max_f32 v142, v88, v89
  v_max3_f32 v142, v142, v90, v91
  v_max3_f32 v142, v142, v92, v93
  v_max3_f32 v142, v142, v94, v95
  v_max3_f32 v142, v142, v96, v97
  v_mov_b32 v143, v142
  s_nop 1
  v_permlane16_swap_b32 v143, v142
  v_max_f32 v142, v142, v143
  v_mov_b32 v143, v142
  s_nop 1
  v_permlane32_swap_b32 v143, v142
  v_max_f32 v142, v142, v143
  v_mul_f32 v142, s68, v142
  v_fma_f32 v88, v88, s68, -v142
  v_fma_f32 v89, v89, s68, -v142
  v_fma_f32 v90, v90, s68, -v142
  v_fma_f32 v91, v91, s68, -v142
  v_fma_f32 v92, v92, s68, -v142
  v_fma_f32 v93, v93, s68, -v142
  v_fma_f32 v94, v94, s68, -v142
  v_fma_f32 v95, v95, s68, -v142
  v_fma_f32 v96, v96, s68, -v142
  v_fma_f32 v97, v97, s68, -v142
  v_exp_f32 v88, v88
  v_exp_f32 v89, v89
  v_exp_f32 v90, v90
  v_exp_f32 v91, v91
  v_exp_f32 v92, v92
  v_exp_f32 v93, v93
  v_exp_f32 v94, v94
  v_exp_f32 v95, v95
  v_exp_f32 v96, v96
  v_exp_f32 v97, v97
  v_add_f32 v142, v88, v89
  v_add_f32 v142, v142, v90
  v_add_f32 v142, v142, v91
  v_add_f32 v142, v142, v92
  v_add_f32 v142, v142, v93
  v_add_f32 v142, v142, v94
  v_add_f32 v142, v142, v95
  v_add_f32 v142, v142, v96
  v_add_f32 v142, v142, v97
  v_mov_b32 v143, v142
  s_nop 1
  v_permlane16_swap_b32 v143, v142
  v_add_f32 v142, v142, v143
  v_mov_b32 v143, v142
  s_nop 1
  v_permlane32_swap_b32 v143, v142
  v_add_f32 v142, v142, v143
  v_rcp_f32 v142, v142
  s_nop 0
  v_mul_f32 v88, v88, v142
  v_mul_f32 v89, v89, v142
  v_mul_f32 v90, v90, v142
  v_mul_f32 v91, v91, v142
  v_mul_f32 v92, v92, v142
  v_mul_f32 v93, v93, v142
  v_mul_f32 v94, v94, v142
  v_mul_f32 v95, v95, v142
  v_mul_f32 v96, v96, v142
  v_mul_f32 v97, v97, v142
  v_cvt_pk_bf16_f32 v144, v88, v89
  v_cvt_pk_bf16_f32 v145, v90, v91
  v_cvt_pk_bf16_f32 v146, v92, v93
  v_cvt_pk_bf16_f32 v147, v94, v95
  v_cvt_pk_bf16_f32 v148, v96, v97
  s_mov_b32 s47, s64
  s_lshr_b32 s46, s47, 8
  s_and_b32 s46, s46, 0x2000
  s_xor_b32 s47, s47, s46
  s_add_u32 s46, s47, s27
  buffer_store_dwordx4 v[144:147], v1, s[8:11], s46 offen sc1
  buffer_store_dword v148, v14, s[8:11], s47 offen sc1
  s_add_u32 s64, s64, 262144
  s_cmp_ge_u32 s64, 16777216
  s_cselect_b32 s46, 2097152, 0
  s_sub_u32 s64, s64, s46
sc_nox:
  v_add_u32 v13, s22, v13
  s_sub_u32 s22, 0, s22
  s_add_u32 s58, s58, 1
  s_cmp_eq_u32 s58, 3
  s_cselect_b32 s58, 0, s58
  s_mov_b32 s52, s53
  s_cmp_lt_u32 s52, 64
  s_cbranch_scc1 sch_loop
  s_waitcnt vmcnt(0)
  s_cmp_ge_u32 s42, 2
  s_cbranch_scc1 L_end
  v_mov_b32 v136, s52
  s_mov_b64 exec, 1
  buffer_store_dword v136, v15, s[8:11], 0 offen sc1
  s_mov_b64 exec, -1
  s_endpgm
scs_ha:
  v_mov_b32 v6, s52
  s_mov_b32 s71, 1
  s_waitcnt lgkmcnt(0)
  buffer_load_dwordx4 v[16:19], v12, s[8:11], 0 offen offset:0 sc1
  buffer_load_dwordx4 v[20:23], v12, s[8:11], 0 offen offset:1024 sc1
  buffer_load_dwordx4 v[24:27], v12, s[8:11], 0 offen offset:2048 sc1
  s_add_u32 m0, s51, 153600
  s_nop 0
  buffer_load_dwordx4 v12, s[8:11], s31 offen sc1 lds
  s_add_u32 m0, s51, 157696
  s_nop 0
  buffer_load_dwordx4 v12, s[8:11], s32 offen sc1 lds
  ds_read_b128 v[56:59], v2 offset:0
  ds_read_b128 v[60:63], v2 offset:4096
  ds_read_b128 v[64:67], v2 offset:8192
  ds_read_b128 v[68:71], v2 offset:12288
  ds_read_b128 v[72:75], v2 offset:16384
  ds_read_b128 v[76:79], v2 offset:20480
  ds_read_b128 v[80:83], v2 offset:49152
  ds_read_b128 v[84:87], v2 offset:53248
  v_mov_b32 v88, 0
  v_mov_b32 v89, 0
  v_mov_b32 v90, 0
  v_mov_b32 v91, 0
  v_mov_b32 v92, 0
  v_mov_b32 v93, 0
  v_mov_b32 v94, 0
  v_mov_b32 v95, 0
  v_mov_b32 v96, 0
  v_mov_b32 v97, 0
  v_mov_b32 v98, 0
  v_mov_b32 v99, 0
  v_mov_b32 v100, 0
  v_mov_b32 v101, 0
  v_mov_b32 v102, 0
  v_mov_b32 v103, 0
  v_mov_b32 v104, 0
  v_mov_b32 v105, 0
  v_mov_b32 v106, 0
  v_mov_b32 v107, 0
  v_mov_b32 v108, 0
  v_mov_b32 v109, 0
  v_mov_b32 v110, 0
  v_mov_b32 v111, 0
  s_branch scs_wa
scs_ra:
  buffer_load_dwordx4 v[16:19], v12, s[8:11], 0 offen offset:0 sc1
  buffer_load_dwordx4 v[20:23], v12, s[8:11], 0 offen offset:1024 sc1
  buffer_load_dwordx4 v[24:27], v12, s[8:11], 0 offen offset:2048 sc1
  s_add_u32 m0, s51, 153600
  s_nop 0
  buffer_load_dwordx4 v12, s[8:11], s31 offen sc1 lds
  s_add_u32 m0, s51, 157696
  s_nop 0
  buffer_load_dwordx4 v12, s[8:11], s32 offen sc1 lds
  s_add_u32 s50, s50, 1
  s_cmp_gt_u32 s50, 131072
  s_cbranch_scc1 L_fail
scs_wa:
  s_waitcnt vmcnt(0)
  v_max3_u32 v136, v16, v20, v24
  v_cmp_eq_u32 vcc, -1, v136
  s_cbranch_vccnz scs_ra
  s_waitcnt lgkmcnt(0)
  s_branch scs_go
scs_hb:
  v_mov_b32 v6, s52
  s_mov_b32 s71, 1
  s_waitcnt lgkmcnt(0)
  s_barrier
  buffer_load_dwordx4 v[28:31], v12, s[8:11], s31 offen sc1
  buffer_load_dwordx4 v[32:35], v12, s[8:11], s32 offen sc1
  ds_read_b128 v[56:59], v2 offset:0
  ds_read_b128 v[60:63], v2 offset:4096
  ds_read_b128 v[64:67], v2 offset:8192
  ds_read_b128 v[68:71], v2 offset:12288
  ds_read_b128 v[72:75], v2 offset:16384
  ds_read_b128 v[76:79], v2 offset:20480
  ds_read_b128 v[80:83], v2 offset:49152
  ds_read_b128 v[84:87], v2 offset:53248
  v_mov_b32 v88, 0
  v_mov_b32 v89, 0
  v_mov_b32 v90, 0
  v_mov_b32 v91, 0
  v_mov_b32 v92, 0
  v_mov_b32 v93, 0
  v_mov_b32 v94, 0
  v_mov_b32 v95, 0
  v_mov_b32 v96, 0
  v_mov_b32 v97, 0
  v_mov_b32 v98, 0
  v_mov_b32 v99, 0
  v_mov_b32 v100, 0
  v_mov_b32 v101, 0
  v_mov_b32 v102, 0
  v_mov_b32 v103, 0
  v_mov_b32 v104, 0
  v_mov_b32 v105, 0
  v_mov_b32 v106, 0
  v_mov_b32 v107, 0
  v_mov_b32 v108, 0
  v_mov_b32 v109, 0
  v_mov_b32 v110, 0
  v_mov_b32 v111, 0
  s_branch scs_wb
scs_rb:
  buffer_load_dwordx4 v[28:31], v12, s[8:11], s31 offen sc1
  buffer_load_dwordx4 v[32:35], v12, s[8:11], s32 offen sc1
  s_add_u32 s50, s50, 1
  s_cmp_gt_u32 s50, 131072
  s_cbranch_scc1 L_fail
scs_wb:
  s_waitcnt vmcnt(0)
  v_max3_u32 v136, v28, v32, v32
  v_cmp_eq_u32 vcc, -1, v136
  s_cbranch_vccnz scs_rb
  v_add_u32 v136, s51, v149
  ds_write_b128 v136, v[28:31] offset:0
  ds_write_b128 v136, v[32:35] offset:4096
  s_add_u32 s50, s50, 1
  s_cmp_gt_u32 s50, 131072
  s_cbranch_scc1 L_fail
  s_waitcnt lgkmcnt(0)
  s_branch scs_go0
scs_redo:
  s_waitcnt lgkmcnt(0)
  s_mov_b32 s50, 0
scs_poll:
  buffer_load_dwordx4 v[16:19], v12, s[8:11], 0 offen offset:0 sc1
  buffer_load_dwordx4 v[20:23], v12, s[8:11], 0 offen offset:1024 sc1
  buffer_load_dwordx4 v[24:27], v12, s[8:11], 0 offen offset:2048 sc1
  buffer_load_dwordx4 v[28:31], v12, s[8:11], 0 offen offset:3072 sc1
  buffer_load_dwordx4 v[32:35], v12, s[8:11], s24 offen offset:0 sc1
  buffer_load_dwordx4 v[36:39], v12, s[8:11], s24 offen offset:1024 sc1
  buffer_load_dwordx4 v[40:43], v12, s[8:11], s24 offen offset:2048 sc1
  buffer_load_dwordx4 v[44:47], v12, s[8:11], s24 offen offset:3072 sc1
  buffer_load_dwordx4 v[48:51], v12, s[8:11], s25 offen offset:0 sc1
  buffer_load_dwordx4 v[52:55], v12, s[8:11], s25 offen offset:1024 sc1
  s_add_u32 s50, s50, 1
  s_cmp_gt_u32 s50, 131072
  s_cbranch_scc1 L_fail
  s_waitcnt vmcnt(0) lgkmcnt(0)
  v_max_u32 v136, v16, v17
  v_max3_u32 v136, v18, v19, v136
  v_max3_u32 v136, v20, v21, v136
  v_max3_u32 v136, v22, v23, v136
  v_max3_u32 v136, v24, v25, v136
  v_max3_u32 v136, v26, v27, v136
  v_max3_u32 v136, v28, v29, v136
  v_max3_u32 v136, v30, v31, v136
  v_max3_u32 v136, v32, v33, v136
  v_max3_u32 v136, v34, v35, v136
  v_max3_u32 v136, v36, v37, v136
  v_max3_u32 v136, v38, v39, v136
  v_max3_u32 v136, v40, v41, v136
  v_max3_u32 v136, v42, v43, v136
  v_max3_u32 v136, v44, v45, v136
  v_max3_u32 v136, v46, v47, v136
  v_max3_u32 v136, v48, v49, v136
  v_max3_u32 v136, v50, v51, v136
  v_max3_u32 v136, v52, v53, v136
  v_max3_u32 v136, v54, v55, v136
  v_cmp_eq_u32 vcc, -1, v136
  s_cbranch_vccnz scs_poll
  s_mov_b64 s[16:17], 0
  ds_read_b128 v[56:59], v2 offset:0
  ds_read_b128 v[60:63], v2 offset:4096
  ds_read_b128 v[64:67], v2 offset:8192
  ds_read_b128 v[68:71], v2 offset:12288
  ds_read_b128 v[72:75], v2 offset:16384
  ds_read_b128 v[76:79], v2 offset:20480
  ds_read_b128 v[80:83], v2 offset:49152
  ds_read_b128 v[84:87], v2 offset:53248
  v_mov_b32 v88, 0
  v_mov_b32 v89, 0
  v_mov_b32 v90, 0
  v_mov_b32 v91, 0
  v_mov_b32 v92, 0
  v_mov_b32 v93, 0
  v_mov_b32 v94, 0
  v_mov_b32 v95, 0
  v_mov_b32 v96, 0
  v_mov_b32 v97, 0
  v_mov_b32 v98, 0
  v_mov_b32 v99, 0
  v_mov_b32 v100, 0
  v_mov_b32 v101, 0
  v_mov_b32 v102, 0
  v_mov_b32 v103, 0
  v_mov_b32 v104, 0
  v_mov_b32 v105, 0
  v_mov_b32 v106, 0
  v_mov_b32 v107, 0
  v_mov_b32 v108, 0
  v_mov_b32 v109, 0
  v_mov_b32 v110, 0
  v_mov_b32 v111, 0
  s_waitcnt lgkmcnt(0)
  v_smfmac_f32_16x16x64_bf16 v[88:91], v[16:19], a[192:199], v7
  v_smfmac_f32_16x16x64_bf16 v[92:95], v[16:19], a[200:207], v7
  v_smfmac_f32_16x16x64_bf16 v[96:99], v[16:19], a[208:215], v7
  v_smfmac_f32_16x16x64_bf16 v[100:103], v[16:19], v[56:63], v7
  v_smfmac_f32_16x16x64_bf16 v[104:107], v[16:19], v[64:71], v7
  ds_read_b128 v[56:59], v2 offset:57344
  v_smfmac_f32_16x16x64_bf16 v[108:111], v[16:19], v[72:79], v7
  ds_read_b128 v[60:63], v2 offset:61440
  v_smfmac_f32_16x16x64_bf16 v[88:91], v[20:23], a[216:223], v7
  ds_read_b128 v[64:67], v3 offset:0
  v_smfmac_f32_16x16x64_bf16 v[92:95], v[20:23], a[224:231], v7
  ds_read_b128 v[68:71], v3 offset:4096
  v_smfmac_f32_16x16x64_bf16 v[96:99], v[20:23], a[232:239], v7
  v_smfmac_f32_16x16x64_bf16 v[100:103], v[20:23], a[0:7], v7
  ds_read_b128 v[72:75], v3 offset:8192
  v_smfmac_f32_16x16x64_bf16 v[104:107], v[20:23], a[8:15], v7
  ds_read_b128 v[76:79], v3 offset:12288
  v_smfmac_f32_16x16x64_bf16 v[108:111], v[20:23], a[16:23], v7
  v_smfmac_f32_16x16x64_bf16 v[88:91], v[24:27], a[240:247], v7
  v_smfmac_f32_16x16x64_bf16 v[92:95], v[24:27], a[248:255], v7
  v_smfmac_f32_16x16x64_bf16 v[96:99], v[24:27], v[152:159], v7
  v_smfmac_f32_16x16x64_bf16 v[100:103], v[24:27], a[24:31], v7
  v_smfmac_f32_16x16x64_bf16 v[104:107], v[24:27], a[32:39], v7
  v_smfmac_f32_16x16x64_bf16 v[108:111], v[24:27], a[40:47], v7
  v_smfmac_f32_16x16x64_bf16 v[88:91], v[28:31], v[80:87], v7
  s_waitcnt lgkmcnt(0)
  v_smfmac_f32_16x16x64_bf16 v[92:95], v[28:31], v[56:63], v7
  v_smfmac_f32_16x16x64_bf16 v[96:99], v[28:31], v[64:71], v7
  v_smfmac_f32_16x16x64_bf16 v[88:91], v[32:35], v[160:167], v7
  ds_read_b128 v[80:83], v3 offset:32768
  v_smfmac_f32_16x16x64_bf16 v[92:95], v[32:35], v[168:175], v7
  ds_read_b128 v[84:87], v3 offset:36864
  v_smfmac_f32_16x16x64_bf16 v[96:99], v[32:35], v[176:183], v7
  ds_read_b128 v[56:59], v3 offset:16384
  v_smfmac_f32_16x16x64_bf16 v[88:91], v[36:39], v[184:191], v7
  v_smfmac_f32_16x16x64_bf16 v[92:95], v[36:39], v[192:199], v7
  ds_read_b128 v[60:63], v3 offset:20480
  v_smfmac_f32_16x16x64_bf16 v[96:99], v[36:39], v[200:207], v7
  ds_read_b128 v[64:67], v3 offset:40960
  v_smfmac_f32_16x16x64_bf16 v[88:91], v[44:47], v[208:215], v7
  ds_read_b128 v[68:71], v3 offset:45056
  v_smfmac_f32_16x16x64_bf16 v[88:91], v[48:51], v[232:239], v7
  v_smfmac_f32_16x16x64_bf16 v[88:91], v[40:43], v[72:79], v7
  s_waitcnt lgkmcnt(3)
  v_smfmac_f32_16x16x64_bf16 v[88:91], v[52:55], v[80:87], v7
  ds_read_b128 v[72:75], v3 offset:24576
  ds_read_b128 v[16:19], v13 offset:8192
  s_waitcnt lgkmcnt(0)
  s_branch scs_join
sch_ha:
  s_waitcnt lgkmcnt(0)
  buffer_load_dwordx4 v[16:19], v12, s[8:11], 0 offen offset:0 sc1
  buffer_load_dwordx4 v[20:23], v12, s[8:11], 0 offen offset:1024 sc1
  buffer_load_dwordx4 v[24:27], v12, s[8:11], 0 offen offset:2048 sc1
  s_add_u32 m0, s51, 153600
  s_nop 0
  buffer_load_dwordx4 v12, s[8:11], s31 offen sc1 lds
  s_add_u32 m0, s51, 157696
  s_nop 0
  buffer_load_dwordx4 v12, s[8:11], s32 offen sc1 lds
  ds_read_b128 v[56:59], v2 offset:0
  ds_read_b128 v[60:63], v2 offset:4096
  ds_read_b128 v[64:67], v2 offset:8192
  ds_read_b128 v[68:71], v2 offset:12288
  ds_read_b128 v[72:75], v2 offset:16384
  ds_read_b128 v[76:79], v2 offset:20480
  ds_read_b128 v[80:83], v2 offset:49152
  ds_read_b128 v[84:87], v2 offset:53248
  v_mov_b32 v88, 0
  v_mov_b32 v89, 0
  v_mov_b32 v90, 0
  v_mov_b32 v91, 0
  v_mov_b32 v92, 0
  v_mov_b32 v93, 0
  v_mov_b32 v94, 0
  v_mov_b32 v95, 0
  v_mov_b32 v96, 0
  v_mov_b32 v97, 0
  v_mov_b32 v98, 0
  v_mov_b32 v99, 0
  v_mov_b32 v100, 0
  v_mov_b32 v101, 0
  v_mov_b32 v102, 0
  v_mov_b32 v103, 0
  v_mov_b32 v104, 0
  v_mov_b32 v105, 0
  v_mov_b32 v106, 0
  v_mov_b32 v107, 0
  v_mov_b32 v108, 0
  v_mov_b32 v109, 0
  v_mov_b32 v110, 0
  v_mov_b32 v111, 0
  s_branch sch_wa
sch_ra:
  buffer_load_dwordx4 v[16:19], v12, s[8:11], 0 offen offset:0 sc1
  buffer_load_dwordx4 v[20:23], v12, s[8:11], 0 offen offset:1024 sc1
  buffer_load_dwordx4 v[24:27], v12, s[8:11], 0 offen offset:2048 sc1
  s_add_u32 m0, s51, 153600
  s_nop 0
  buffer_load_dwordx4 v12, s[8:11], s31 offen sc1 lds
  s_add_u32 m0, s51, 157696
  s_nop 0
  buffer_load_dwordx4 v12, s[8:11], s32 offen sc1 lds
  s_add_u32 s50, s50, 1
  s_cmp_gt_u32 s50, 131072
  s_cbranch_scc1 L_fail
sch_wa:
  s_waitcnt vmcnt(0)
  v_max3_u32 v136, v16, v20, v24
  v_cmp_eq_u32 vcc, -1, v136
  s_cbranch_vccnz sch_ra
  s_waitcnt lgkmcnt(0)
  s_branch sch_go
sch_hb:
  s_waitcnt lgkmcnt(0)
  s_barrier
  buffer_load_dwordx4 v[28:31], v12, s[8:11], s31 offen sc1
  buffer_load_dwordx4 v[32:35], v12, s[8:11], s32 offen sc1
  ds_read_b128 v[56:59], v2 offset:0
  ds_read_b128 v[60:63], v2 offset:4096
  ds_read_b128 v[64:67], v2 offset:8192
  ds_read_b128 v[68:71], v2 offset:12288
  ds_read_b128 v[72:75], v2 offset:16384
  ds_read_b128 v[76:79], v2 offset:20480
  ds_read_b128 v[80:83], v2 offset:49152
  ds_read_b128 v[84:87], v2 offset:53248
  v_mov_b32 v88, 0
  v_mov_b32 v89, 0
  v_mov_b32 v90, 0
  v_mov_b32 v91, 0
  v_mov_b32 v92, 0
  v_mov_b32 v93, 0
  v_mov_b32 v94, 0
  v_mov_b32 v95, 0
  v_mov_b32 v96, 0
  v_mov_b32 v97, 0
  v_mov_b32 v98, 0
  v_mov_b32 v99, 0
  v_mov_b32 v100, 0
  v_mov_b32 v101, 0
  v_mov_b32 v102, 0
  v_mov_b32 v103, 0
  v_mov_b32 v104, 0
  v_mov_b32 v105, 0
  v_mov_b32 v106, 0
  v_mov_b32 v107, 0
  v_mov_b32 v108, 0
  v_mov_b32 v109, 0
  v_mov_b32 v110, 0
  v_mov_b32 v111, 0
  s_branch sch_wb
sch_rb:
  buffer_load_dwordx4 v[28:31], v12, s[8:11], s31 offen sc1
  buffer_load_dwordx4 v[32:35], v12, s[8:11], s32 offen sc1
  s_add_u32 s50, s50, 1
  s_cmp_gt_u32 s50, 131072
  s_cbranch_scc1 L_fail
sch_wb:
  s_waitcnt vmcnt(0)
  v_max3_u32 v136, v28, v32, v32
  v_cmp_eq_u32 vcc, -1, v136
  s_cbranch_vccnz sch_rb
  v_add_u32 v136, s51, v149
  ds_write_b128 v136, v[28:31] offset:0
  ds_write_b128 v136, v[32:35] offset:4096
  s_add_u32 s50, s50, 1
  s_cmp_gt_u32 s50, 131072
  s_cbranch_scc1 L_fail
  s_waitcnt lgkmcnt(0)
  s_branch sch_go0
sch_redo:
  s_waitcnt lgkmcnt(0)
  s_mov_b32 s50, 0
sch_poll:
  buffer_load_dwordx4 v[16:19], v12, s[8:11], 0 offen offset:0 sc1
  buffer_load_dwordx4 v[20:23], v12, s[8:11], 0 offen offset:1024 sc1
  buffer_load_dwordx4 v[24:27], v12, s[8:11], 0 offen offset:2048 sc1
  buffer_load_dwordx4 v[28:31], v12, s[8:11], 0 offen offset:3072 sc1
  buffer_load_dwordx4 v[32:35], v12, s[8:11], s24 offen offset:0 sc1
  buffer_load_dwordx4 v[36:39], v12, s[8:11], s24 offen offset:1024 sc1
  buffer_load_dwordx4 v[40:43], v12, s[8:11], s24 offen offset:2048 sc1
  buffer_load_dwordx4 v[44:47], v12, s[8:11], s24 offen offset:3072 sc1
  buffer_load_dwordx4 v[48:51], v12, s[8:11], s25 offen offset:0 sc1
  buffer_load_dwordx4 v[52:55], v12, s[8:11], s25 offen offset:1024 sc1
  s_add_u32 s50, s50, 1
  s_cmp_gt_u32 s50, 131072
  s_cbranch_scc1 L_fail
  s_waitcnt vmcnt(0) lgkmcnt(0)
  v_max_u32 v136, v16, v17
  v_max3_u32 v136, v18, v19, v136
  v_max3_u32 v136, v20, v21, v136
  v_max3_u32 v136, v22, v23, v136
  v_max3_u32 v136, v24, v25, v136
  v_max3_u32 v136, v26, v27, v136
  v_max3_u32 v136, v28, v29, v136
  v_max3_u32 v136, v30, v31, v136
  v_max3_u32 v136, v32, v33, v136
  v_max3_u32 v136, v34, v35, v136
  v_max3_u32 v136, v36, v37, v136
  v_max3_u32 v136, v38, v39, v136
  v_max3_u32 v136, v40, v41, v136
  v_max3_u32 v136, v42, v43, v136
  v_max3_u32 v136, v44, v45, v136
  v_max3_u32 v136, v46, v47, v136
  v_max3_u32 v136, v48, v49, v136
  v_max3_u32 v136, v50, v51, v136
  v_max3_u32 v136, v52, v53, v136
  v_max3_u32 v136, v54, v55, v136
  v_cmp_eq_u32 vcc, -1, v136
  s_cbranch_vccnz sch_poll
  s_mov_b64 s[16:17], 0
  ds_read_b128 v[56:59], v2 offset:0
  ds_read_b128 v[60:63], v2 offset:4096
  ds_read_b128 v[64:67], v2 offset:8192
  ds_read_b128 v[68:71], v2 offset:12288
  ds_read_b128 v[72:75], v2 offset:16384
  ds_read_b128 v[76:79], v2 offset:20480
  ds_read_b128 v[80:83], v2 offset:49152
  ds_read_b128 v[84:87], v2 offset:53248
  v_mov_b32 v88, 0
  v_mov_b32 v89, 0
  v_mov_b32 v90, 0
  v_mov_b32 v91, 0
  v_mov_b32 v92, 0
  v_mov_b32 v93, 0
  v_mov_b32 v94, 0
  v_mov_b32 v95, 0
  v_mov_b32 v96, 0
  v_mov_b32 v97, 0
  v_mov_b32 v98, 0
  v_mov_b32 v99, 0
  v_mov_b32 v100, 0
  v_mov_b32 v101, 0
  v_mov_b32 v102, 0
  v_mov_b32 v103, 0
  v_mov_b32 v104, 0
  v_mov_b32 v105, 0
  v_mov_b32 v106, 0
  v_mov_b32 v107, 0
  v_mov_b32 v108, 0
  v_mov_b32 v109, 0
  v_mov_b32 v110, 0
  v_mov_b32 v111, 0
  s_waitcnt lgkmcnt(0)
  v_smfmac_f32_16x16x64_bf16 v[88:91], v[16:19], a[192:199], v7
  v_smfmac_f32_16x16x64_bf16 v[92:95], v[16:19], a[200:207], v7
  v_smfmac_f32_16x16x64_bf16 v[96:99], v[16:19], a[208:215], v7
  v_smfmac_f32_16x16x64_bf16 v[100:103], v[16:19], v[56:63], v7
  v_smfmac_f32_16x16x64_bf16 v[104:107], v[16:19], v[64:71], v7
  ds_read_b128 v[56:59], v2 offset:57344
  v_smfmac_f32_16x16x64_bf16 v[108:111], v[16:19], v[72:79], v7
  ds_read_b128 v[60:63], v2 offset:61440
  v_smfmac_f32_16x16x64_bf16 v[88:91], v[20:23], a[216:223], v7
  ds_read_b128 v[64:67], v3 offset:0
  v_smfmac_f32_16x16x64_bf16 v[92:95], v[20:23], a[224:231], v7
  ds_read_b128 v[68:71], v3 offset:4096
  v_smfmac_f32_16x16x64_bf16 v[96:99], v[20:23], a[232:239], v7
  v_smfmac_f32_16x16x64_bf16 v[100:103], v[20:23], a[0:7], v7
  ds_read_b128 v[72:75], v3 offset:8192
  v_smfmac_f32_16x16x64_bf16 v[104:107], v[20:23], a[8:15], v7
  ds_read_b128 v[76:79], v3 offset:12288
  v_smfmac_f32_16x16x64_bf16 v[108:111], v[20:23], a[16:23], v7
  v_smfmac_f32_16x16x64_bf16 v[88:91], v[24:27], a[240:247], v7
  v_smfmac_f32_16x16x64_bf16 v[92:95], v[24:27], a[248:255], v7
  v_smfmac_f32_16x16x64_bf16 v[96:99], v[24:27], v[152:159], v7
  v_smfmac_f32_16x16x64_bf16 v[100:103], v[24:27], a[24:31], v7
  v_smfmac_f32_16x16x64_bf16 v[104:107], v[24:27], a[32:39], v7
  v_smfmac_f32_16x16x64_bf16 v[108:111], v[24:27], a[40:47], v7
  v_smfmac_f32_16x16x64_bf16 v[88:91], v[28:31], v[80:87], v7
  s_waitcnt lgkmcnt(0)
  v_smfmac_f32_16x16x64_bf16 v[92:95], v[28:31], v[56:63], v7
  v_smfmac_f32_16x16x64_bf16 v[96:99], v[28:31], v[64:71], v7
  v_smfmac_f32_16x16x64_bf16 v[88:91], v[32:35], v[160:167], v7
  ds_read_b128 v[80:83], v3 offset:32768
  v_smfmac_f32_16x16x64_bf16 v[92:95], v[32:35], v[168:175], v7
  ds_read_b128 v[84:87], v3 offset:36864
  v_smfmac_f32_16x16x64_bf16 v[96:99], v[32:35], v[176:183], v7
  ds_read_b128 v[56:59], v3 offset:16384
  v_smfmac_f32_16x16x64_bf16 v[88:91], v[36:39], v[184:191], v7
  v_smfmac_f32_16x16x64_bf16 v[92:95], v[36:39], v[192:199], v7
  ds_read_b128 v[60:63], v3 offset:20480
  v_smfmac_f32_16x16x64_bf16 v[96:99], v[36:39], v[200:207], v7
  ds_read_b128 v[64:67], v3 offset:40960
  v_smfmac_f32_16x16x64_bf16 v[88:91], v[44:47], v[208:215], v7
  ds_read_b128 v[68:71], v3 offset:45056
  v_smfmac_f32_16x16x64_bf16 v[88:91], v[48:51], v[232:239], v7
  v_smfmac_f32_16x16x64_bf16 v[88:91], v[40:43], v[72:79], v7
  s_waitcnt lgkmcnt(3)
  v_smfmac_f32_16x16x64_bf16 v[88:91], v[52:55], v[80:87], v7
  ds_read_b128 v[72:75], v3 offset:24576
  s_mov_b32 m0, s21
  s_waitcnt lgkmcnt(0)
  s_branch sch_join
L_value:
  s_mov_b32 s4, s30
  s_mov_b32 s5, s31
  s_mov_b32 s6, 7864320
  s_mov_b32 s7, 0x20000
  s_mov_b32 s12, s32
  s_mov_b32 s13, s33
  s_mov_b32 s14, 7864320
  s_mov_b32 s15, 0x20000
  v_lshrrev_b32 v148, 3, v0
  v_lshrrev_b32 v149, 2, v148
  v_lshlrev_b32 v149, 3, v149
  v_and_b32 v64, 3, v148
  v_add_u32 v64, v64, v149
  s_and_b32 s46, s42, 1
  s_lshl_b32 s46, s46, 2
  s_lshr_b32 s47, s42, 1
  s_lshl_b32 s47, s47, 4
  s_add_u32 s46, s46, s47
  v_add_u32 v64, s46, v64
  v_mul_u32_u24 v64, 12288, v64
  v_lshrrev_b32 v148, 1, v148
  v_bfe_u32 v149, v0, 1, 2
  v_xor_b32 v148, v148, v149
  v_lshlrev_b32 v148, 5, v148
  v_and_b32 v149, 1, v0
  v_lshlrev_b32 v149, 4, v149
  v_add3_u32 v64, v64, v148, v149
  v_lshrrev_b32 v148, 3, v0
  v_lshrrev_b32 v149, 2, v148
  v_lshlrev_b32 v149, 3, v149
  v_and_b32 v65, 3, v148
  v_add_u32 v65, v65, v149
  s_and_b32 s46, s42, 1
  s_lshl_b32 s46, s46, 2
  s_lshr_b32 s47, s42, 1
  s_lshl_b32 s47, s47, 4
  s_add_u32 s46, s46, s47
  v_add_u32 v65, s46, v65
  v_mul_u32_u24 v65, 1280, v65
  v_lshrrev_b32 v148, 1, v148
  v_bfe_u32 v149, v0, 1, 2
  v_xor_b32 v148, v148, v149
  v_lshlrev_b32 v148, 5, v148
  v_and_b32 v149, 1, v0
  v_lshlrev_b32 v149, 4, v149
  v_add3_u32 v65, v65, v148, v149
  v_lshrrev_b32 v148, 5, v0
  v_lshlrev_b32 v66, 11, v148
  v_bfe_u32 v148, v0, 2, 3
  v_lshl_add_u32 v66, v148, 7, v66
  v_lshrrev_b32 v148, 1, v148
  v_xor_b32 v148, s42, v148
  v_lshl_add_u32 v66, v148, 5, v66
  v_and_b32 v148, 3, v0
  v_lshl_add_u32 v66, v148, 3, v66
  v_add_u32 v67, 0x10000, v66
  v_add_u32 v68, 0x20000, v66
  v_lshlrev_b32 v1, 4, v0
  v_add_u32 v2, s51, v1
  v_add_u32 v3, 0x10000, v2
  s_mul_i32 s62, s45, 384
  s_mul_i32 s63, s45, 245760
  s_mov_b32 s24, 4096
  s_mov_b32 s25, 49152
  s_add_u32 m0, s51, 73728
  s_add_u32 s46, s62, 786432
  buffer_load_dwordx4 v64, s[4:7], s46 offen  lds
  s_add_u32 m0, s51, 77824
  s_add_u32 s46, s62, 1179648
  buffer_load_dwordx4 v64, s[4:7], s46 offen  lds
  s_add_u32 m0, s51, 81920
  s_add_u32 s46, s62, 786560
  buffer_load_dwordx4 v64, s[4:7], s46 offen  lds
  s_add_u32 m0, s51, 86016
  s_add_u32 s46, s62, 1179776
  buffer_load_dwordx4 v64, s[4:7], s46 offen  lds
  s_add_u32 m0, s51, 90112
  s_add_u32 s46, s62, 786688
  buffer_load_dwordx4 v64, s[4:7], s46 offen  lds
  s_add_u32 m0, s51, 94208
  s_add_u32 s46, s62, 1179904
  buffer_load_dwordx4 v64, s[4:7], s46 offen  lds
  s_add_u32 m0, s51, 98304
  s_add_u32 s46, s62, 1572864
  buffer_load_dwordx4 v64, s[4:7], s46 offen  lds
  s_add_u32 m0, s51, 102400
  s_add_u32 s46, s62, 1966080
  buffer_load_dwordx4 v64, s[4:7], s46 offen  lds
  s_add_u32 m0, s51, 106496
  s_add_u32 s46, s62, 1572992
  buffer_load_dwordx4 v64, s[4:7], s46 offen  lds
  s_add_u32 m0, s51, 110592
  s_add_u32 s46, s62, 1966208
  buffer_load_dwordx4 v64, s[4:7], s46 offen  lds
  s_add_u32 m0, s51, 114688
  s_add_u32 s46, s62, 1573120
  buffer_load_dwordx4 v64, s[4:7], s46 offen  lds
  s_add_u32 m0, s51, 118784
  s_add_u32 s46, s62, 1966336
  buffer_load_dwordx4 v64, s[4:7], s46 offen  lds
  s_add_u32 m0, s51, 122880
  s_add_u32 s46, s62, 2359296
  buffer_load_dwordx4 v64, s[4:7], s46 offen  lds
  s_add_u32 m0, s51, 126976
  s_add_u32 s46, s62, 2752512
  buffer_load_dwordx4 v64, s[4:7], s46 offen  lds
  s_add_u32 m0, s51, 131072
  s_add_u32 s46, s62, 2359424
  buffer_load_dwordx4 v64, s[4:7], s46 offen  lds
  s_add_u32 m0, s51, 135168
  s_add_u32 s46, s62, 2752640
  buffer_load_dwordx4 v64, s[4:7], s46 offen  lds
  s_add_u32 m0, s51, 139264
  s_add_u32 s46, s62, 2359552
  buffer_load_dwordx4 v64, s[4:7], s46 offen  lds
  s_add_u32 m0, s51, 143360
  s_add_u32 s46, s62, 2752768
  buffer_load_dwordx4 v64, s[4:7], s46 offen  lds
  s_add_u32 m0, s51, 0
  s_add_u32 s46, s62, 3932160
  buffer_load_dwordx4 v64, s[4:7], s46 offen  lds
  s_add_u32 m0, s51, 4096
  s_add_u32 s46, s62, 4325376
  buffer_load_dwordx4 v64, s[4:7], s46 offen  lds
  s_add_u32 m0, s51, 8192
  s_add_u32 s46, s62, 3932288
  buffer_load_dwordx4 v64, s[4:7], s46 offen  lds
  s_add_u32 m0, s51, 12288
  s_add_u32 s46, s62, 4325504
  buffer_load_dwordx4 v64, s[4:7], s46 offen  lds
  s_add_u32 m0, s51, 16384
  s_add_u32 s46, s62, 3932416
  buffer_load_dwordx4 v64, s[4:7], s46 offen  lds
  s_add_u32 m0, s51, 20480
  s_add_u32 s46, s62, 4325632
  buffer_load_dwordx4 v64, s[4:7], s46 offen  lds
  s_add_u32 m0, s51, 24576
  s_add_u32 s46, s62, 4718592
  buffer_load_dwordx4 v64, s[4:7], s46 offen  lds
  s_add_u32 m0, s51, 28672
  s_add_u32 s46, s62, 5111808
  buffer_load_dwordx4 v64, s[4:7], s46 offen  lds
  s_add_u32 m0, s51, 32768
  s_add_u32 s46, s62, 4718720
  buffer_load_dwordx4 v64, s[4:7], s46 offen  lds
  s_add_u32 m0, s51, 36864
  s_add_u32 s46, s62, 5111936
  buffer_load_dwordx4 v64, s[4:7], s46 offen  lds
  s_add_u32 m0, s51, 40960
  s_add_u32 s46, s62, 4718848
  buffer_load_dwordx4 v64, s[4:7], s46 offen  lds
  s_add_u32 m0, s51, 45056
  s_add_u32 s46, s62, 5112064
  buffer_load_dwordx4 v64, s[4:7], s46 offen  lds
  s_waitcnt vmcnt(24)
  s_barrier
  s_add_u32 m0, s51, 49152
  s_add_u32 s46, s62, 5505024
  buffer_load_dwordx4 v64, s[4:7], s46 offen  lds
  s_add_u32 m0, s51, 53248
  s_add_u32 s46, s62, 5898240
  buffer_load_dwordx4 v64, s[4:7], s46 offen  lds
  s_add_u32 m0, s51, 57344
  s_add_u32 s46, s62, 5505152
  buffer_load_dwordx4 v64, s[4:7], s46 offen  lds
  s_add_u32 m0, s51, 61440
  s_add_u32 s46, s62, 5898368
  buffer_load_dwordx4 v64, s[4:7], s46 offen  lds
  s_add_u32 m0, s51, 65536
  s_add_u32 s46, s62, 5505280
  buffer_load_dwordx4 v64, s[4:7], s46 offen  lds
  s_add_u32 m0, s51, 69632
  s_add_u32 s46, s62, 5898496
  buffer_load_dwordx4 v64, s[4:7], s46 offen  lds
  ds_read_b64_tr_b16 a[0:1], v67 offset:8192
  ds_read_b64_tr_b16 a[2:3], v67 offset:9216
  ds_read_b64_tr_b16 a[4:5], v67 offset:12288
  ds_read_b64_tr_b16 a[6:7], v67 offset:13312
  ds_read_b64_tr_b16 a[8:9], v67 offset:16384
  ds_read_b64_tr_b16 a[10:11], v67 offset:17408
  ds_read_b64_tr_b16 a[12:13], v67 offset:20480
  ds_read_b64_tr_b16 a[14:15], v67 offset:21504
  ds_read_b64_tr_b16 a[16:17], v67 offset:24576
  ds_read_b64_tr_b16 a[18:19], v67 offset:25600
  ds_read_b64_tr_b16 a[20:21], v67 offset:28672
  ds_read_b64_tr_b16 a[22:23], v67 offset:29696
  s_waitcnt lgkmcnt(0)
  s_waitcnt vmcnt(24)
  s_barrier
  s_add_u32 m0, s51, 73728
  s_add_u32 s46, s62, 7077888
  buffer_load_dwordx4 v64, s[4:7], s46 offen  lds
  s_add_u32 m0, s51, 77824
  s_add_u32 s46, s62, 7471104
  buffer_load_dwordx4 v64, s[4:7], s46 offen  lds
  s_add_u32 m0, s51, 81920
  s_add_u32 s46, s62, 7078016
  buffer_load_dwordx4 v64, s[4:7], s46 offen  lds
  s_add_u32 m0, s51, 86016
  s_add_u32 s46, s62, 7471232
  buffer_load_dwordx4 v64, s[4:7], s46 offen  lds
  s_add_u32 m0, s51, 90112
  s_add_u32 s46, s62, 7078144
  buffer_load_dwordx4 v64, s[4:7], s46 offen  lds
  s_add_u32 m0, s51, 94208
  s_add_u32 s46, s62, 7471360
  buffer_load_dwordx4 v64, s[4:7], s46 offen  lds
  ds_read_b64_tr_b16 a[24:25], v67 offset:32768
  ds_read_b64_tr_b16 a[26:27], v67 offset:33792
  ds_read_b64_tr_b16 a[28:29], v67 offset:36864
  ds_read_b64_tr_b16 a[30:31], v67 offset:37888
  ds_read_b64_tr_b16 a[32:33], v67 offset:40960
  ds_read_b64_tr_b16 a[34:35], v67 offset:41984
  ds_read_b64_tr_b16 a[36:37], v67 offset:45056
  ds_read_b64_tr_b16 a[38:39], v67 offset:46080
  ds_read_b64_tr_b16 a[40:41], v67 offset:49152
  ds_read_b64_tr_b16 a[42:43], v67 offset:50176
  ds_read_b64_tr_b16 a[44:45], v67 offset:53248
  ds_read_b64_tr_b16 a[46:47], v67 offset:54272
  s_waitcnt lgkmcnt(0)
  s_waitcnt vmcnt(24)
  s_barrier
  s_add_u32 m0, s51, 98304
  s_add_u32 s46, s63, 0
  buffer_load_dwordx4 v65, s[12:15], s46 offen  lds
  s_add_u32 m0, s51, 102400
  s_add_u32 s46, s63, 40960
  buffer_load_dwordx4 v65, s[12:15], s46 offen  lds
  s_add_u32 m0, s51, 106496
  s_add_u32 s46, s63, 81920
  buffer_load_dwordx4 v65, s[12:15], s46 offen  lds
  s_add_u32 m0, s51, 110592
  s_add_u32 s46, s63, 122880
  buffer_load_dwordx4 v65, s[12:15], s46 offen  lds
  s_add_u32 m0, s51, 114688
  s_add_u32 s46, s63, 163840
  buffer_load_dwordx4 v65, s[12:15], s46 offen  lds
  s_add_u32 m0, s51, 118784
  s_add_u32 s46, s63, 204800
  buffer_load_dwordx4 v65, s[12:15], s46 offen  lds
  ds_read_b64_tr_b16 a[48:49], v67 offset:57344
  ds_read_b64_tr_b16 a[50:51], v67 offset:58368
  ds_read_b64_tr_b16 a[52:53], v67 offset:61440
  ds_read_b64_tr_b16 a[54:55], v67 offset:62464
  ds_read_b64_tr_b16 a[56:57], v68 offset:0
  ds_read_b64_tr_b16 a[58:59], v68 offset:1024
  ds_read_b64_tr_b16 a[60:61], v68 offset:4096
  ds_read_b64_tr_b16 a[62:63], v68 offset:5120
  ds_read_b64_tr_b16 a[64:65], v68 offset:8192
  ds_read_b64_tr_b16 a[66:67], v68 offset:9216
  ds_read_b64_tr_b16 a[68:69], v68 offset:12288
  ds_read_b64_tr_b16 a[70:71], v68 offset:13312
  s_waitcnt lgkmcnt(0)
  s_waitcnt vmcnt(24)
  s_barrier
  s_add_u32 m0, s51, 122880
  s_add_u32 s46, s63, 128
  buffer_load_dwordx4 v65, s[12:15], s46 offen  lds
  s_add_u32 m0, s51, 126976
  s_add_u32 s46, s63, 41088
  buffer_load_dwordx4 v65, s[12:15], s46 offen  lds
  s_add_u32 m0, s51, 131072
  s_add_u32 s46, s63, 82048
  buffer_load_dwordx4 v65, s[12:15], s46 offen  lds
  s_add_u32 m0, s51, 135168
  s_add_u32 s46, s63, 123008
  buffer_load_dwordx4 v65, s[12:15], s46 offen  lds
  s_add_u32 m0, s51, 139264
  s_add_u32 s46, s63, 163968
  buffer_load_dwordx4 v65, s[12:15], s46 offen  lds
  s_add_u32 m0, s51, 143360
  s_add_u32 s46, s63, 204928
  buffer_load_dwordx4 v65, s[12:15], s46 offen  lds
  ds_read_b64_tr_b16 a[72:73], v66 offset:0
  ds_read_b64_tr_b16 a[74:75], v66 offset:1024
  ds_read_b64_tr_b16 a[76:77], v66 offset:4096
  ds_read_b64_tr_b16 a[78:79], v66 offset:5120
  ds_read_b64_tr_b16 a[80:81], v66 offset:8192
  ds_read_b64_tr_b16 a[82:83], v66 offset:9216
  ds_read_b64_tr_b16 a[84:85], v66 offset:12288
  ds_read_b64_tr_b16 a[86:87], v66 offset:13312
  ds_read_b64_tr_b16 a[88:89], v66 offset:16384
  ds_read_b64_tr_b16 a[90:91], v66 offset:17408
  ds_read_b64_tr_b16 a[92:93], v66 offset:20480
  ds_read_b64_tr_b16 a[94:95], v66 offset:21504
  s_waitcnt lgkmcnt(0)
  s_waitcnt vmcnt(24)
  s_barrier
  s_add_u32 m0, s51, 0
  s_add_u32 s46, s63, 256
  buffer_load_dwordx4 v65, s[12:15], s46 offen  lds
  s_add_u32 m0, s51, 4096
  s_add_u32 s46, s63, 41216
  buffer_load_dwordx4 v65, s[12:15], s46 offen  lds
  s_add_u32 m0, s51, 8192
  s_add_u32 s46, s63, 82176
  buffer_load_dwordx4 v65, s[12:15], s46 offen  lds
  s_add_u32 m0, s51, 12288
  s_add_u32 s46, s63, 123136
  buffer_load_dwordx4 v65, s[12:15], s46 offen  lds
  s_add_u32 m0, s51, 16384
  s_add_u32 s46, s63, 164096
  buffer_load_dwordx4 v65, s[12:15], s46 offen  lds
  s_add_u32 m0, s51, 20480
  s_add_u32 s46, s63, 205056
  buffer_load_dwordx4 v65, s[12:15], s46 offen  lds
  ds_read_b64_tr_b16 a[96:97], v66 offset:24576
  ds_read_b64_tr_b16 a[98:99], v66 offset:25600
  ds_read_b64_tr_b16 a[100:101], v66 offset:28672
  ds_read_b64_tr_b16 a[102:103], v66 offset:29696
  ds_read_b64_tr_b16 a[104:105], v66 offset:32768
  ds_read_b64_tr_b16 a[106:107], v66 offset:33792
  ds_read_b64_tr_b16 a[108:109], v66 offset:36864
  ds_read_b64_tr_b16 a[110:111], v66 offset:37888
  ds_read_b64_tr_b16 a[112:113], v66 offset:40960
  ds_read_b64_tr_b16 a[114:115], v66 offset:41984
  ds_read_b64_tr_b16 a[116:117], v66 offset:45056
  ds_read_b64_tr_b16 a[118:119], v66 offset:46080
  s_waitcnt lgkmcnt(0)
  s_waitcnt vmcnt(24)
  s_barrier
  s_add_u32 m0, s51, 24576
  s_add_u32 s46, s63, 512
  buffer_load_dwordx4 v65, s[12:15], s46 offen  lds
  s_add_u32 m0, s51, 28672
  s_add_u32 s46, s63, 41472
  buffer_load_dwordx4 v65, s[12:15], s46 offen  lds
  s_add_u32 m0, s51, 32768
  s_add_u32 s46, s63, 82432
  buffer_load_dwordx4 v65, s[12:15], s46 offen  lds
  s_add_u32 m0, s51, 36864
  s_add_u32 s46, s63, 123392
  buffer_load_dwordx4 v65, s[12:15], s46 offen  lds
  s_add_u32 m0, s51, 40960
  s_add_u32 s46, s63, 164352
  buffer_load_dwordx4 v65, s[12:15], s46 offen  lds
  s_add_u32 m0, s51, 45056
  s_add_u32 s46, s63, 205312
  buffer_load_dwordx4 v65, s[12:15], s46 offen  lds
  ds_read_b64_tr_b16 a[120:121], v66 offset:49152
  ds_read_b64_tr_b16 a[122:123], v66 offset:50176
  ds_read_b64_tr_b16 a[124:125], v66 offset:53248
  ds_read_b64_tr_b16 a[126:127], v66 offset:54272
  ds_read_b64_tr_b16 a[128:129], v66 offset:57344
  ds_read_b64_tr_b16 a[130:131], v66 offset:58368
  ds_read_b64_tr_b16 a[132:133], v66 offset:61440
  ds_read_b64_tr_b16 a[134:135], v66 offset:62464
  ds_read_b64_tr_b16 a[136:137], v67 offset:0
  ds_read_b64_tr_b16 a[138:139], v67 offset:1024
  ds_read_b64_tr_b16 a[140:141], v67 offset:4096
  ds_read_b64_tr_b16 a[142:143], v67 offset:5120
  s_waitcnt lgkmcnt(0)
  s_waitcnt vmcnt(24)
  s_barrier
  s_add_u32 m0, s51, 49152
  s_add_u32 s46, s63, 640
  buffer_load_dwordx4 v65, s[12:15], s46 offen  lds
  s_add_u32 m0, s51, 53248
  s_add_u32 s46, s63, 41600
  buffer_load_dwordx4 v65, s[12:15], s46 offen  lds
  s_add_u32 m0, s51, 57344
  s_add_u32 s46, s63, 82560
  buffer_load_dwordx4 v65, s[12:15], s46 offen  lds
  s_add_u32 m0, s51, 61440
  s_add_u32 s46, s63, 123520
  buffer_load_dwordx4 v65, s[12:15], s46 offen  lds
  s_add_u32 m0, s51, 65536
  s_add_u32 s46, s63, 164480
  buffer_load_dwordx4 v65, s[12:15], s46 offen  lds
  s_add_u32 m0, s51, 69632
  s_add_u32 s46, s63, 205440
  buffer_load_dwordx4 v65, s[12:15], s46 offen  lds
  ds_read_b64_tr_b16 a[144:145], v67 offset:8192
  ds_read_b64_tr_b16 a[146:147], v67 offset:9216
  ds_read_b64_tr_b16 a[148:149], v67 offset:12288
  ds_read_b64_tr_b16 a[150:151], v67 offset:13312
  ds_read_b64_tr_b16 a[152:153], v67 offset:16384
  ds_read_b64_tr_b16 a[154:155], v67 offset:17408
  ds_read_b64_tr_b16 a[156:157], v67 offset:20480
  ds_read_b64_tr_b16 a[158:159], v67 offset:21504
  ds_read_b64_tr_b16 a[160:161], v67 offset:24576
  ds_read_b64_tr_b16 a[162:163], v67 offset:25600
  ds_read_b64_tr_b16 a[164:165], v67 offset:28672
  ds_read_b64_tr_b16 a[166:167], v67 offset:29696
  s_waitcnt lgkmcnt(0)
  s_waitcnt vmcnt(24)
  s_barrier
  s_add_u32 m0, s51, 73728
  s_add_u32 s46, s63, 768
  buffer_load_dwordx4 v65, s[12:15], s46 offen  lds
  s_add_u32 m0, s51, 77824
  s_add_u32 s46, s63, 41728
  buffer_load_dwordx4 v65, s[12:15], s46 offen  lds
  s_add_u32 m0, s51, 81920
  s_add_u32 s46, s63, 82688
  buffer_load_dwordx4 v65, s[12:15], s46 offen  lds
  s_add_u32 m0, s51, 86016
  s_add_u32 s46, s63, 123648
  buffer_load_dwordx4 v65, s[12:15], s46 offen  lds
  s_add_u32 m0, s51, 90112
  s_add_u32 s46, s63, 164608
  buffer_load_dwordx4 v65, s[12:15], s46 offen  lds
  s_add_u32 m0, s51, 94208
  s_add_u32 s46, s63, 205568
  buffer_load_dwordx4 v65, s[12:15], s46 offen  lds
  ds_read_b64_tr_b16 a[168:169], v67 offset:32768
  ds_read_b64_tr_b16 a[170:171], v67 offset:33792
  ds_read_b64_tr_b16 a[172:173], v67 offset:36864
  ds_read_b64_tr_b16 a[174:175], v67 offset:37888
  ds_read_b64_tr_b16 a[176:177], v67 offset:40960
  ds_read_b64_tr_b16 a[178:179], v67 offset:41984
  ds_read_b64_tr_b16 a[180:181], v67 offset:45056
  ds_read_b64_tr_b16 a[182:183], v67 offset:46080
  ds_read_b64_tr_b16 a[184:185], v67 offset:49152
  ds_read_b64_tr_b16 a[186:187], v67 offset:50176
  ds_read_b64_tr_b16 a[188:189], v67 offset:53248
  ds_read_b64_tr_b16 a[190:191], v67 offset:54272
  s_waitcnt lgkmcnt(0)
  s_waitcnt vmcnt(24)
  s_barrier
  s_add_u32 m0, s51, 98304
  s_add_u32 s46, s63, 896
  buffer_load_dwordx4 v65, s[12:15], s46 offen  lds
  s_add_u32 m0, s51, 102400
  s_add_u32 s46, s63, 41856
  buffer_load_dwordx4 v65, s[12:15], s46 offen  lds
  s_add_u32 m0, s51, 106496
  s_add_u32 s46, s63, 82816
  buffer_load_dwordx4 v65, s[12:15], s46 offen  lds
  s_add_u32 m0, s51, 110592
  s_add_u32 s46, s63, 123776
  buffer_load_dwordx4 v65, s[12:15], s46 offen  lds
  s_add_u32 m0, s51, 114688
  s_add_u32 s46, s63, 164736
  buffer_load_dwordx4 v65, s[12:15], s46 offen  lds
  s_add_u32 m0, s51, 118784
  s_add_u32 s46, s63, 205696
  buffer_load_dwordx4 v65, s[12:15], s46 offen  lds
  ds_read_b64_tr_b16 a[192:193], v67 offset:57344
  ds_read_b64_tr_b16 a[194:195], v67 offset:58368
  ds_read_b64_tr_b16 a[196:197], v67 offset:61440
  ds_read_b64_tr_b16 a[198:199], v67 offset:62464
  ds_read_b64_tr_b16 a[200:201], v68 offset:0
  ds_read_b64_tr_b16 a[202:203], v68 offset:1024
  ds_read_b64_tr_b16 a[204:205], v68 offset:4096
  ds_read_b64_tr_b16 a[206:207], v68 offset:5120
  ds_read_b64_tr_b16 a[208:209], v68 offset:8192
  ds_read_b64_tr_b16 a[210:211], v68 offset:9216
  ds_read_b64_tr_b16 a[212:213], v68 offset:12288
  ds_read_b64_tr_b16 a[214:215], v68 offset:13312
  s_waitcnt lgkmcnt(0)
  s_waitcnt vmcnt(24)
  s_barrier
  v_and_b32 v149, 3, v0
  v_lshlrev_b32 v149, 2, v149
  global_load_dword v148, v149, s[38:39] sc1
  s_add_u32 m0, s51, 122880
  s_add_u32 s46, s63, 1152
  buffer_load_dwordx4 v65, s[12:15], s46 offen  lds
  s_add_u32 m0, s51, 126976
  s_add_u32 s46, s63, 42112
  buffer_load_dwordx4 v65, s[12:15], s46 offen  lds
  s_add_u32 m0, s51, 131072
  s_add_u32 s46, s63, 83072
  buffer_load_dwordx4 v65, s[12:15], s46 offen  lds
  s_add_u32 m0, s51, 135168
  s_add_u32 s46, s63, 124032
  buffer_load_dwordx4 v65, s[12:15], s46 offen  lds
  s_add_u32 m0, s51, 139264
  s_add_u32 s46, s63, 164992
  buffer_load_dwordx4 v65, s[12:15], s46 offen  lds
  s_add_u32 m0, s51, 143360
  s_add_u32 s46, s63, 205952
  buffer_load_dwordx4 v65, s[12:15], s46 offen  lds
  ds_read_b64_tr_b16 a[216:217], v66 offset:0
  ds_read_b64_tr_b16 a[218:219], v66 offset:1024
  ds_read_b64_tr_b16 a[220:221], v66 offset:4096
  ds_read_b64_tr_b16 a[222:223], v66 offset:5120
  ds_read_b64_tr_b16 a[224:225], v66 offset:8192
  ds_read_b64_tr_b16 a[226:227], v66 offset:9216
  ds_read_b64_tr_b16 a[228:229], v66 offset:12288
  ds_read_b64_tr_b16 a[230:231], v66 offset:13312
  ds_read_b64_tr_b16 a[232:233], v66 offset:16384
  ds_read_b64_tr_b16 a[234:235], v66 offset:17408
  ds_read_b64_tr_b16 a[236:237], v66 offset:20480
  ds_read_b64_tr_b16 a[238:239], v66 offset:21504
  s_waitcnt lgkmcnt(0)
  s_waitcnt vmcnt(25)
  s_barrier
  s_add_u32 m0, s51, 0
  s_add_u32 s46, s62, 0
  buffer_load_dwordx4 v64, s[4:7], s46 offen  lds
  s_add_u32 m0, s51, 4096
  s_add_u32 s46, s62, 393216
  buffer_load_dwordx4 v64, s[4:7], s46 offen  lds
  s_add_u32 m0, s51, 8192
  s_add_u32 s46, s62, 128
  buffer_load_dwordx4 v64, s[4:7], s46 offen  lds
  s_add_u32 m0, s51, 12288
  s_add_u32 s46, s62, 393344
  buffer_load_dwordx4 v64, s[4:7], s46 offen  lds
  s_add_u32 m0, s51, 16384
  s_add_u32 s46, s62, 256
  buffer_load_dwordx4 v64, s[4:7], s46 offen  lds
  s_add_u32 m0, s51, 20480
  s_add_u32 s46, s62, 393472
  buffer_load_dwordx4 v64, s[4:7], s46 offen  lds
  ds_read_b64_tr_b16 a[240:241], v66 offset:24576
  ds_read_b64_tr_b16 a[242:243], v66 offset:25600
  ds_read_b64_tr_b16 a[244:245], v66 offset:28672
  ds_read_b64_tr_b16 a[246:247], v66 offset:29696
  ds_read_b64_tr_b16 a[248:249], v66 offset:32768
  ds_read_b64_tr_b16 a[250:251], v66 offset:33792
  ds_read_b64_tr_b16 a[252:253], v66 offset:36864
  ds_read_b64_tr_b16 a[254:255], v66 offset:37888
  ds_read_b64_tr_b16 v[152:153], v66 offset:40960
  ds_read_b64_tr_b16 v[154:155], v66 offset:41984
  ds_read_b64_tr_b16 v[156:157], v66 offset:45056
  ds_read_b64_tr_b16 v[158:159], v66 offset:46080
  s_waitcnt lgkmcnt(0)
  s_waitcnt vmcnt(25)
  s_barrier
  s_add_u32 m0, s51, 24576
  s_add_u32 s46, s62, 3145728
  buffer_load_dwordx4 v64, s[4:7], s46 offen  lds
  s_add_u32 m0, s51, 28672
  s_add_u32 s46, s62, 3538944
  buffer_load_dwordx4 v64, s[4:7], s46 offen  lds
  s_add_u32 m0, s51, 32768
  s_add_u32 s46, s62, 3145856
  buffer_load_dwordx4 v64, s[4:7], s46 offen  lds
  s_add_u32 m0, s51, 36864
  s_add_u32 s46, s62, 3539072
  buffer_load_dwordx4 v64, s[4:7], s46 offen  lds
  s_add_u32 m0, s51, 40960
  s_add_u32 s46, s62, 3145984
  buffer_load_dwordx4 v64, s[4:7], s46 offen  lds
  s_add_u32 m0, s51, 45056
  s_add_u32 s46, s62, 3539200
  buffer_load_dwordx4 v64, s[4:7], s46 offen  lds
  ds_read_b64_tr_b16 v[160:161], v66 offset:49152
  ds_read_b64_tr_b16 v[162:163], v66 offset:50176
  ds_read_b64_tr_b16 v[164:165], v66 offset:53248
  ds_read_b64_tr_b16 v[166:167], v66 offset:54272
  ds_read_b64_tr_b16 v[168:169], v66 offset:57344
  ds_read_b64_tr_b16 v[170:171], v66 offset:58368
  ds_read_b64_tr_b16 v[172:173], v66 offset:61440
  ds_read_b64_tr_b16 v[174:175], v66 offset:62464
  ds_read_b64_tr_b16 v[176:177], v67 offset:0
  ds_read_b64_tr_b16 v[178:179], v67 offset:1024
  ds_read_b64_tr_b16 v[180:181], v67 offset:4096
  ds_read_b64_tr_b16 v[182:183], v67 offset:5120
  s_waitcnt lgkmcnt(0)
  s_waitcnt vmcnt(25)
  s_barrier
  s_add_u32 m0, s51, 49152
  s_add_u32 s46, s62, 6291456
  buffer_load_dwordx4 v64, s[4:7], s46 offen  lds
  s_add_u32 m0, s51, 53248
  s_add_u32 s46, s62, 6684672
  buffer_load_dwordx4 v64, s[4:7], s46 offen  lds
  s_add_u32 m0, s51, 57344
  s_add_u32 s46, s62, 6291584
  buffer_load_dwordx4 v64, s[4:7], s46 offen  lds
  s_add_u32 m0, s51, 61440
  s_add_u32 s46, s62, 6684800
  buffer_load_dwordx4 v64, s[4:7], s46 offen  lds
  s_add_u32 m0, s51, 65536
  s_add_u32 s46, s62, 6291712
  buffer_load_dwordx4 v64, s[4:7], s46 offen  lds
  s_add_u32 m0, s51, 69632
  s_add_u32 s46, s62, 6684928
  buffer_load_dwordx4 v64, s[4:7], s46 offen  lds
  ds_read_b64_tr_b16 v[184:185], v67 offset:8192
  ds_read_b64_tr_b16 v[186:187], v67 offset:9216
  ds_read_b64_tr_b16 v[188:189], v67 offset:12288
  ds_read_b64_tr_b16 v[190:191], v67 offset:13312
  ds_read_b64_tr_b16 v[192:193], v67 offset:16384
  ds_read_b64_tr_b16 v[194:195], v67 offset:17408
  ds_read_b64_tr_b16 v[196:197], v67 offset:20480
  ds_read_b64_tr_b16 v[198:199], v67 offset:21504
  ds_read_b64_tr_b16 v[200:201], v67 offset:24576
  ds_read_b64_tr_b16 v[202:203], v67 offset:25600
  ds_read_b64_tr_b16 v[204:205], v67 offset:28672
  ds_read_b64_tr_b16 v[206:207], v67 offset:29696
  s_waitcnt lgkmcnt(0)
  s_waitcnt vmcnt(25)
  s_barrier
  s_add_u32 m0, s51, 73728
  s_add_u32 s46, s63, 384
  buffer_load_dwordx4 v65, s[12:15], s46 offen  lds
  s_add_u32 m0, s51, 77824
  s_add_u32 s46, s63, 41344
  buffer_load_dwordx4 v65, s[12:15], s46 offen  lds
  s_add_u32 m0, s51, 81920
  s_add_u32 s46, s63, 82304
  buffer_load_dwordx4 v65, s[12:15], s46 offen  lds
  s_add_u32 m0, s51, 86016
  s_add_u32 s46, s63, 123264
  buffer_load_dwordx4 v65, s[12:15], s46 offen  lds
  s_add_u32 m0, s51, 90112
  s_add_u32 s46, s63, 164224
  buffer_load_dwordx4 v65, s[12:15], s46 offen  lds
  s_add_u32 m0, s51, 94208
  s_add_u32 s46, s63, 205184
  buffer_load_dwordx4 v65, s[12:15], s46 offen  lds
  ds_read_b64_tr_b16 v[208:209], v67 offset:32768
  ds_read_b64_tr_b16 v[210:211], v67 offset:33792
  ds_read_b64_tr_b16 v[212:213], v67 offset:36864
  ds_read_b64_tr_b16 v[214:215], v67 offset:37888
  ds_read_b64_tr_b16 v[216:217], v67 offset:40960
  ds_read_b64_tr_b16 v[218:219], v67 offset:41984
  ds_read_b64_tr_b16 v[220:221], v67 offset:45056
  ds_read_b64_tr_b16 v[222:223], v67 offset:46080
  ds_read_b64_tr_b16 v[224:225], v67 offset:49152
  ds_read_b64_tr_b16 v[226:227], v67 offset:50176
  ds_read_b64_tr_b16 v[228:229], v67 offset:53248
  ds_read_b64_tr_b16 v[230:231], v67 offset:54272
  s_waitcnt lgkmcnt(0)
  s_waitcnt vmcnt(24)
  s_barrier
  s_add_u32 m0, s51, 98304
  s_add_u32 s46, s63, 1024
  buffer_load_dwordx4 v65, s[12:15], s46 offen  lds
  s_add_u32 m0, s51, 102400
  s_add_u32 s46, s63, 41984
  buffer_load_dwordx4 v65, s[12:15], s46 offen  lds
  s_add_u32 m0, s51, 106496
  s_add_u32 s46, s63, 82944
  buffer_load_dwordx4 v65, s[12:15], s46 offen  lds
  s_add_u32 m0, s51, 110592
  s_add_u32 s46, s63, 123904
  buffer_load_dwordx4 v65, s[12:15], s46 offen  lds
  s_add_u32 m0, s51, 114688
  s_add_u32 s46, s63, 164864
  buffer_load_dwordx4 v65, s[12:15], s46 offen  lds
  s_add_u32 m0, s51, 118784
  s_add_u32 s46, s63, 205824
  buffer_load_dwordx4 v65, s[12:15], s46 offen  lds
  ds_read_b64_tr_b16 v[232:233], v67 offset:57344
  ds_read_b64_tr_b16 v[234:235], v67 offset:58368
  ds_read_b64_tr_b16 v[236:237], v67 offset:61440
  ds_read_b64_tr_b16 v[238:239], v67 offset:62464
  ds_read_b64_tr_b16 v[240:241], v68 offset:0
  ds_read_b64_tr_b16 v[242:243], v68 offset:1024
  ds_read_b64_tr_b16 v[244:245], v68 offset:4096
  ds_read_b64_tr_b16 v[246:247], v68 offset:5120
  ds_read_b64_tr_b16 v[248:249], v68 offset:8192
  ds_read_b64_tr_b16 v[250:251], v68 offset:9216
  ds_read_b64_tr_b16 v[252:253], v68 offset:12288
  ds_read_b64_tr_b16 v[254:255], v68 offset:13312
  s_waitcnt lgkmcnt(0)
  s_mov_b32 s50, 0
  s_branch ss_23_in
ss_23:
  v_and_b32 v149, 3, v0
  v_lshlrev_b32 v149, 2, v149
  global_load_dword v148, v149, s[38:39] sc1
  s_add_u32 s50, s50, 1
  s_cmp_gt_u32 s50, 131072
  s_cbranch_scc1 L_fail
  s_waitcnt vmcnt(0)
ss_23_in:
  v_readlane_b32 s46, v148, 0
  v_readlane_b32 s47, v148, 2
  v_readlane_b32 s48, v148, 1
  s_nop 0
  s_min_u32 s47, s47, s48
  s_cmp_lg_u32 s46, 0
  s_cselect_b32 s48, 7, 0
  s_add_u32 s46, s46, s2
  s_xor_b32 s49, s46, s43
  s_and_b32 s49, s49, s48
  s_cbranch_scc1 L_reroll
  s_cmp_lg_u32 s47, 0
  s_cbranch_scc1 ss_ok_24
  s_sleep 6
  s_branch ss_23
ss_ok_24:
  v_readlane_b32 s3, v148, 1
  s_nop 0
  s_and_b32 s3, s3, 0x2000
  s_add_u32 s46, s42, 1
  s_lshl_b32 s31, s46, 10
  s_cmp_ge_u32 s46, 8
  s_cselect_b32 s47, 40960, 0
  s_add_u32 s31, s31, s47
  s_cmp_ge_u32 s46, 10
  s_cselect_b32 s31, 2146435072, s31
  s_add_u32 s46, s42, 5
  s_lshl_b32 s32, s46, 10
  s_cmp_ge_u32 s46, 8
  s_cselect_b32 s47, 40960, 0
  s_add_u32 s32, s32, s47
  s_cmp_ge_u32 s46, 10
  s_cselect_b32 s32, 2146435072, s32
  s_add_u32 s46, s42, 9
  s_lshl_b32 s33, s46, 10
  s_cmp_ge_u32 s46, 8
  s_cselect_b32 s47, 40960, 0
  s_add_u32 s33, s33, s47
  s_cmp_ge_u32 s46, 10
  s_cselect_b32 s33, 2146435072, s33
  v_add_u32 v9, 126976, v1
  s_lshr_b32 s46, s44, 4
  s_lshl_b32 s46, s46, 7
  s_lshl_b32 s47, s43, 4
  s_add_u32 s46, s46, s47
  s_and_b32 s47, s44, 15
  s_add_u32 s46, s46, s47
  s_lshl_b32 s46, s46, 7
  s_add_u32 s46, s46, s3
  s_add_u32 s46, s46, 13369344
  s_add_u32 s40, s8, s46
  s_addc_u32 s41, s9, 0
  v_mov_b32 v7, 0x44444444
  v_mov_b32 v148, 0xeeeeeeee
  v_and_b32 v149, 2, v0
  v_cmp_ne_u32 vcc, 0, v149
  s_nop 1
  v_cndmask_b32 v7, v7, v148, vcc
  v_and_b32 v148, 15, v0
  v_lshrrev_b32 v149, 4, v0
  v_lshlrev_b32 v8, 4, v148
  v_lshrrev_b32 v150, 2, v148
  v_lshlrev_b32 v4, 6, v150
  v_and_b32 v150, 1, v148
  v_lshl_add_u32 v4, v150, 5, v4
  v_lshl_add_u32 v4, v149, 3, v4
  v_bfe_u32 v150, v148, 1, 1
  v_lshl_add_u32 v4, v150, 2, v4
  s_and_b32 s46, s42, 1
  s_lshl_b32 s46, s46, 7
  v_xor_b32 v4, s46, v4
  s_lshl_b32 s46, s42, 8
  s_add_u32 s46, s46, 122880
  v_add_u32 v4, s46, v4
  s_lshl_b32 s46, s45, 8
  s_lshl_b32 s47, s42, 14
  s_add_u32 s47, s47, s46
  v_lshl_add_u32 v8, v149, 16, v8
  v_add_u32 v8, s47, v8
  v_lshrrev_b32 v150, 1, v149
  v_lshl_add_u32 v13, v150, 30, v8
  v_mul_u32_u24 v150, 131064, v150
  v_sub_u32 v8, v8, v150
  v_lshlrev_b32 v5, 8, v149
  v_and_b32 v150, 1, v149
  v_lshl_add_u32 v5, v150, 7, v5
  v_lshl_add_u32 v5, v148, 3, v5
  v_xor_b32 v6, 0x80, v5
  v_add_u32 v5, 122880, v5
  v_add_u32 v6, 122880, v6
  s_lshl_b32 s46, s45, 7
  s_lshl_b32 s47, s42, 2
  s_add_u32 s47, s47, s46
  s_add_u32 s47, s47, 13672448
  s_xor_b32 s47, s47, s3
  v_mov_b32 v15, s47
  s_mov_b32 s52, 0
  s_mov_b32 s58, 0
  s_mov_b32 s54, 0
  s_mov_b32 s100, 0
  s_waitcnt vmcnt(24)
  s_barrier
  ds_read_b64_tr_b16 v[40:41], v66 offset:0
  ds_read_b64_tr_b16 v[42:43], v66 offset:1024
  ds_read_b64_tr_b16 v[44:45], v66 offset:4096
  ds_read_b64_tr_b16 v[46:47], v66 offset:5120
  ds_read_b64_tr_b16 v[48:49], v66 offset:8192
  ds_read_b64_tr_b16 v[50:51], v66 offset:9216
  ds_read_b64_tr_b16 v[52:53], v66 offset:12288
  ds_read_b64_tr_b16 v[54:55], v66 offset:13312
  ds_read_b64_tr_b16 v[56:57], v66 offset:16384
  ds_read_b64_tr_b16 v[58:59], v66 offset:17408
  ds_read_b64_tr_b16 v[60:61], v66 offset:20480
  ds_read_b64_tr_b16 v[62:63], v66 offset:21504
  s_waitcnt lgkmcnt(0)
  s_waitcnt vmcnt(18)
  s_barrier
  ds_write_b128 v2, v[40:43] offset:0
  ds_write_b128 v2, v[44:47] offset:4096
  ds_write_b128 v2, v[48:51] offset:8192
  ds_write_b128 v2, v[52:55] offset:12288
  ds_write_b128 v2, v[56:59] offset:16384
  ds_write_b128 v2, v[60:63] offset:20480
  ds_read_b64_tr_b16 v[16:17], v66 offset:24576
  ds_read_b64_tr_b16 v[18:19], v66 offset:25600
  ds_read_b64_tr_b16 v[20:21], v66 offset:28672
  ds_read_b64_tr_b16 v[22:23], v66 offset:29696
  ds_read_b64_tr_b16 v[24:25], v66 offset:32768
  ds_read_b64_tr_b16 v[26:27], v66 offset:33792
  ds_read_b64_tr_b16 v[28:29], v66 offset:36864
  ds_read_b64_tr_b16 v[30:31], v66 offset:37888
  ds_read_b64_tr_b16 v[32:33], v66 offset:40960
  ds_read_b64_tr_b16 v[34:35], v66 offset:41984
  ds_read_b64_tr_b16 v[36:37], v66 offset:45056
  ds_read_b64_tr_b16 v[38:39], v66 offset:46080
  s_waitcnt lgkmcnt(0)
  s_waitcnt vmcnt(12)
  s_barrier
  ds_write_b128 v2, v[16:19] offset:24576
  ds_write_b128 v2, v[20:23] offset:28672
  ds_write_b128 v2, v[24:27] offset:32768
  ds_write_b128 v2, v[28:31] offset:36864
  ds_write_b128 v2, v[32:35] offset:40960
  ds_write_b128 v2, v[36:39] offset:45056
  ds_read_b64_tr_b16 v[40:41], v66 offset:49152
  ds_read_b64_tr_b16 v[42:43], v66 offset:50176
  ds_read_b64_tr_b16 v[44:45], v66 offset:53248
  ds_read_b64_tr_b16 v[46:47], v66 offset:54272
  ds_read_b64_tr_b16 v[48:49], v66 offset:57344
  ds_read_b64_tr_b16 v[50:51], v66 offset:58368
  ds_read_b64_tr_b16 v[52:53], v66 offset:61440
  ds_read_b64_tr_b16 v[54:55], v66 offset:62464
  ds_read_b64_tr_b16 v[56:57], v67 offset:0
  ds_read_b64_tr_b16 v[58:59], v67 offset:1024
  ds_read_b64_tr_b16 v[60:61], v67 offset:4096
  ds_read_b64_tr_b16 v[62:63], v67 offset:5120
  s_waitcnt lgkmcnt(0)
  s_waitcnt vmcnt(6)
  s_barrier
  ds_write_b128 v2, v[40:43] offset:49152
  ds_write_b128 v2, v[44:47] offset:53248
  ds_write_b128 v2, v[48:51] offset:57344
  ds_write_b128 v2, v[52:55] offset:61440
  ds_write_b128 v3, v[56:59] offset:0
  ds_write_b128 v3, v[60:63] offset:4096
  ds_read_b64_tr_b16 v[16:17], v67 offset:8192
  ds_read_b64_tr_b16 v[18:19], v67 offset:9216
  ds_read_b64_tr_b16 v[20:21], v67 offset:12288
  ds_read_b64_tr_b16 v[22:23], v67 offset:13312
  ds_read_b64_tr_b16 v[24:25], v67 offset:16384
  ds_read_b64_tr_b16 v[26:27], v67 offset:17408
  ds_read_b64_tr_b16 v[28:29], v67 offset:20480
  ds_read_b64_tr_b16 v[30:31], v67 offset:21504
  ds_read_b64_tr_b16 v[32:33], v67 offset:24576
  ds_read_b64_tr_b16 v[34:35], v67 offset:25600
  ds_read_b64_tr_b16 v[36:37], v67 offset:28672
  ds_read_b64_tr_b16 v[38:39], v67 offset:29696
  s_waitcnt lgkmcnt(0)
  s_waitcnt vmcnt(0)
  s_barrier
  ds_write_b128 v3, v[16:19] offset:8192
  ds_write_b128 v3, v[20:23] offset:12288
  ds_write_b128 v3, v[24:27] offset:16384
  ds_write_b128 v3, v[28:31] offset:20480
  ds_write_b128 v3, v[32:35] offset:24576
  ds_write_b128 v3, v[36:39] offset:28672
  ds_read_b64_tr_b16 v[40:41], v67 offset:32768
  ds_read_b64_tr_b16 v[42:43], v67 offset:33792
  ds_read_b64_tr_b16 v[44:45], v67 offset:36864
  ds_read_b64_tr_b16 v[46:47], v67 offset:37888
  ds_read_b64_tr_b16 v[48:49], v67 offset:40960
  ds_read_b64_tr_b16 v[50:51], v67 offset:41984
  ds_read_b64_tr_b16 v[52:53], v67 offset:45056
  ds_read_b64_tr_b16 v[54:55], v67 offset:46080
  ds_read_b64_tr_b16 v[56:57], v67 offset:49152
  ds_read_b64_tr_b16 v[58:59], v67 offset:50176
  ds_read_b64_tr_b16 v[60:61], v67 offset:53248
  ds_read_b64_tr_b16 v[62:63], v67 offset:54272
  s_waitcnt lgkmcnt(0)
  s_barrier
  ds_write_b128 v3, v[40:43] offset:32768
  ds_write_b128 v3, v[44:47] offset:36864
  ds_write_b128 v3, v[48:51] offset:40960
  ds_write_b128 v3, v[52:55] offset:45056
  ds_write_b128 v3, v[56:59] offset:49152
  ds_write_b128 v3, v[60:63] offset:53248
  s_waitcnt lgkmcnt(0)
va_loop:
  s_add_u32 s53, s52, 1
  s_lshl_b32 s56, s58, 2
  s_add_u32 s56, s56, s43
  s_lshl_b32 s56, s56, 16
  s_add_u32 s56, s56, s3
  s_add_u32 s56, s56, 12582912
  s_lshl_b32 s72, s54, 21
  s_mul_i32 s46, s58, 655360
  s_add_u32 s72, s72, s46
  s_add_u32 s72, s72, s3
  s_add_u32 s72, s72, 4194304
  s_lshr_b32 s46, s72, 8
  s_and_b32 s46, s46, 0x2000
  s_xor_b32 s72, s72, s46
  s_add_u32 s73, s72, 131072
  s_add_u32 s74, s72, 262144
  s_add_u32 s75, s72, 393216
  s_add_u32 s76, s72, 524288
  v_add_u32 v11, s56, v1
  s_mov_b64 s[16:17], -1
  s_mov_b32 s71, 0
  ds_read_b128 v[56:59], v2 offset:0
  ds_read_b128 v[60:63], v2 offset:4096
  ds_read_b128 v[64:67], v2 offset:8192
  ds_read_b128 v[68:71], v2 offset:12288
  ds_read_b128 v[72:75], v2 offset:16384
  ds_read_b128 v[76:79], v2 offset:20480
  ds_read_b128 v[80:83], v2 offset:24576
  ds_read_b128 v[84:87], v2 offset:28672
  v_mov_b32 v88, 0
  v_mov_b32 v89, 0
  v_mov_b32 v90, 0
  v_mov_b32 v91, 0
  v_mov_b32 v92, 0
  v_mov_b32 v93, 0
  v_mov_b32 v94, 0
  v_mov_b32 v95, 0
  v_mov_b32 v96, 0
  v_mov_b32 v97, 0
  v_mov_b32 v98, 0
  v_mov_b32 v99, 0
  v_mov_b32 v100, 0
  v_mov_b32 v101, 0
  v_mov_b32 v102, 0
  v_mov_b32 v103, 0
  v_mov_b32 v104, 0
  v_mov_b32 v105, 0
  v_mov_b32 v106, 0
  v_mov_b32 v107, 0
  v_mov_b32 v108, 0
  v_mov_b32 v109, 0
  v_mov_b32 v110, 0
  v_mov_b32 v111, 0
  v_mov_b32 v112, 0
  v_mov_b32 v113, 0
  v_mov_b32 v114, 0
  v_mov_b32 v115, 0
  v_mov_b32 v128, 0
  v_mov_b32 v129, 0
  v_mov_b32 v130, 0
  v_mov_b32 v131, 0
  v_mov_b32 v132, 0
  v_mov_b32 v133, 0
  v_mov_b32 v134, 0
  v_mov_b32 v135, 0
  v_mov_b32 v136, 0
  v_mov_b32 v137, 0
  v_mov_b32 v138, 0
  v_mov_b32 v139, 0
  v_mov_b32 v140, 0
  v_mov_b32 v141, 0
  v_mov_b32 v142, 0
  v_mov_b32 v143, 0
  v_mov_b32 v144, 0
  v_mov_b32 v145, 0
  v_mov_b32 v146, 0
  v_mov_b32 v147, 0
  s_waitcnt lgkmcnt(0)
  s_cmp_lg_u32 s42, 3
  s_cbranch_scc1 va_nobell
  s_mov_b32 s50, 0
  s_mov_b64 s[80:81], 0
  s_mov_b64 s[82:83], 0
  s_cmp_eq_u32 s53, 1
  s_cbranch_scc1 bell_x_26
bell_25:
  s_load_dwordx4 s[80:83], s[40:41], 0 glc
  s_min_u32 s46, s80, s81
  s_min_u32 s47, s82, s83
  s_min_u32 s46, s46, s47
  s_cmp_ge_u32 s46, s53
  s_cbranch_scc1 bell_x_26
  s_min_u32 s46, s80, s81
  s_min_u32 s47, s82, s83
  s_min_u32 s46, s46, s47
  s_cmp_ge_u32 s46, s53
  s_cbranch_scc1 bell_x_26
  s_min_u32 s46, s80, s81
  s_min_u32 s47, s82, s83
  s_min_u32 s46, s46, s47
  s_cmp_ge_u32 s46, s53
  s_cbranch_scc1 bell_x_26
  s_min_u32 s46, s80, s81
  s_min_u32 s47, s82, s83
  s_min_u32 s46, s46, s47
  s_cmp_ge_u32 s46, s53
  s_cbranch_scc1 bell_x_26
  s_min_u32 s46, s80, s81
  s_min_u32 s47, s82, s83
  s_min_u32 s46, s46, s47
  s_cmp_ge_u32 s46, s53
  s_cbranch_scc1 bell_x_26
  s_min_u32 s46, s80, s81
  s_min_u32 s47, s82, s83
  s_min_u32 s46, s46, s47
  s_cmp_ge_u32 s46, s53
  s_cbranch_scc1 bell_x_26
  s_min_u32 s46, s80, s81
  s_min_u32 s47, s82, s83
  s_min_u32 s46, s46, s47
  s_cmp_ge_u32 s46, s53
  s_cbranch_scc1 bell_x_26
  s_min_u32 s46, s80, s81
  s_min_u32 s47, s82, s83
  s_min_u32 s46, s46, s47
  s_cmp_ge_u32 s46, s53
  s_cbranch_scc1 bell_x_26
  s_add_u32 s50, s50, 1
  s_cmp_lt_u32 s50, 524288
  s_cbranch_scc1 bell_25
  s_branch L_fail
bell_x_26:
va_nobell:
  s_mov_b32 s50, 0
va_top:
  s_add_u32 m0, s51, 126976
  s_barrier
  buffer_load_dwordx4 v11, s[8:11], s31 offen sc1 lds
  s_add_u32 m0, s51, 131072
  s_barrier
  buffer_load_dwordx4 v[16:19], v11, s[8:11], 0 offen offset:0 sc1
  s_barrier
  buffer_load_dwordx4 v11, s[8:11], s32 offen sc1 lds
  s_add_u32 m0, s51, 135168
  s_nop 0
  buffer_load_dwordx4 v11, s[8:11], s33 offen sc1 lds
  s_waitcnt vmcnt(3)
va_go0:
  s_barrier
  ds_read_b128 v[20:23], v9 offset:0
  ds_read_b128 v[24:27], v9 offset:1024
  s_waitcnt vmcnt(2)
va_go:
  v_smfmac_f32_16x16x64_bf16 v[104:107], v[16:19], v[56:63], v7
  ds_read_b128 v[28:31], v9 offset:2048
  v_smfmac_f32_16x16x64_bf16 v[108:111], v[16:19], v[64:71], v7
  ds_read_b128 v[32:35], v9 offset:3072
  v_smfmac_f32_16x16x64_bf16 v[112:115], v[16:19], v[72:79], v7
  ds_read_b128 v[56:59], v2 offset:49152
  s_waitcnt lgkmcnt(4)
  v_smfmac_f32_16x16x64_bf16 v[104:107], v[20:23], a[0:7], v7
  ds_read_b128 v[60:63], v2 offset:53248
  v_cmp_eq_u32 vcc, -1, v16
  v_smfmac_f32_16x16x64_bf16 v[108:111], v[20:23], a[8:15], v7
  ds_read_b128 v[64:67], v2 offset:32768
  v_smfmac_f32_16x16x64_bf16 v[112:115], v[20:23], a[16:23], v7
  s_cbranch_vccnz va_ha
  s_waitcnt lgkmcnt(4)
  v_smfmac_f32_16x16x64_bf16 v[104:107], v[24:27], a[24:31], v7
  s_waitcnt vmcnt(0)
  s_barrier
  ds_read_b128 v[36:39], v9 offset:4096
  v_smfmac_f32_16x16x64_bf16 v[108:111], v[24:27], a[32:39], v7
  ds_read_b128 v[40:43], v9 offset:5120
  v_smfmac_f32_16x16x64_bf16 v[112:115], v[24:27], a[40:47], v7
  ds_read_b128 v[44:47], v9 offset:6144
  v_smfmac_f32_16x16x64_bf16 v[104:107], v[28:31], a[48:55], v7
  ds_read_b128 v[48:51], v9 offset:7168
  s_waitcnt lgkmcnt(4)
  v_smfmac_f32_16x16x64_bf16 v[104:107], v[32:35], v[80:87], v7
  ds_read_b128 v[52:55], v9 offset:8192
  s_waitcnt lgkmcnt(4)
  v_smfmac_f32_16x16x64_bf16 v[104:107], v[36:39], a[72:79], v7
  ds_read_b128 v[68:71], v2 offset:36864
  s_waitcnt lgkmcnt(4)
  v_max3_u32 v12, v20, v24, v28
  v_smfmac_f32_16x16x64_bf16 v[104:107], v[40:43], a[96:103], v7
  s_waitcnt lgkmcnt(3)
  v_max3_u32 v12, v12, v32, v36
  v_smfmac_f32_16x16x64_bf16 v[104:107], v[44:47], a[120:127], v7
  s_waitcnt lgkmcnt(2)
  v_max3_u32 v12, v12, v40, v44
  v_smfmac_f32_16x16x64_bf16 v[104:107], v[48:51], v[56:63], v7
  s_waitcnt lgkmcnt(1)
  v_max3_u32 v12, v12, v48, v52
  v_smfmac_f32_16x16x64_bf16 v[104:107], v[52:55], a[144:151], v7
  ds_read_b128 v[72:75], v2 offset:57344
  v_cmp_eq_u32 vcc, -1, v12
  v_smfmac_f32_16x16x64_bf16 v[108:111], v[28:31], a[56:63], v7
  ds_read_b128 v[76:79], v2 offset:61440
  s_waitcnt lgkmcnt(2)
  v_smfmac_f32_16x16x64_bf16 v[108:111], v[32:35], v[64:71], v7
  s_cbranch_vccnz va_hb
  v_mov_b32 v16, 0
va_join:
  v_smfmac_f32_16x16x64_bf16 v[108:111], v[36:39], a[80:87], v7
  ds_read_b128 v[80:83], v2 offset:40960
  v_add_f32 v104, v104, v106
  v_smfmac_f32_16x16x64_bf16 v[108:111], v[40:43], a[104:111], v7
  ds_read_b128 v[84:87], v2 offset:45056
  v_add_f32 v105, v105, v107
  v_smfmac_f32_16x16x64_bf16 v[108:111], v[44:47], a[128:135], v7
  ds_read_b128 v[56:59], v3 offset:0
  s_waitcnt lgkmcnt(3)
  v_cvt_pk_bf16_f32 v106, v104, v105
  v_smfmac_f32_16x16x64_bf16 v[108:111], v[48:51], v[72:79], v7
  ds_write_b32 v4, v106 offset:0
  v_smfmac_f32_16x16x64_bf16 v[108:111], v[52:55], a[152:159], v7
  ds_read_b128 v[60:63], v3 offset:4096
  v_cmp_u_f32 vcc, v104, v105
  v_smfmac_f32_16x16x64_bf16 v[112:115], v[28:31], a[64:71], v7
  ds_read_b128 v[64:67], v3 offset:8192
  s_waitcnt lgkmcnt(4)
  v_smfmac_f32_16x16x64_bf16 v[112:115], v[32:35], v[80:87], v7
  s_and_b64 vcc, vcc, s[16:17]
  s_cbranch_scc1 va_redo
  v_add_f32 v108, v108, v110
  v_smfmac_f32_16x16x64_bf16 v[112:115], v[36:39], a[88:95], v7
  s_waitcnt lgkmcnt(2)
  s_barrier
  v_add_f32 v109, v109, v111
  v_smfmac_f32_16x16x64_bf16 v[112:115], v[40:43], a[112:119], v7
  ds_read_b64_tr_b16 v[116:117], v5 offset:0
  ds_read_b64_tr_b16 v[118:119], v6 offset:0
  v_smfmac_f32_16x16x64_bf16 v[112:115], v[44:47], a[136:143], v7
  ds_read_b128 v[68:71], v3 offset:12288
  s_waitcnt lgkmcnt(4)
  v_cvt_pk_bf16_f32 v110, v108, v109
  v_smfmac_f32_16x16x64_bf16 v[112:115], v[48:51], v[56:63], v7
  ds_write_b32 v4, v110 offset:1024
  v_smfmac_f32_16x16x64_bf16 v[112:115], v[52:55], a[160:167], v7
  ds_read_b128 v[72:75], v3 offset:32768
  s_waitcnt lgkmcnt(3)
  v_mov_b32 v17, 0
  v_smfmac_f32_16x16x64_bf16 v[128:131], v[116:119], a[168:175], v7
  ds_read_b128 v[76:79], v3 offset:36864
  v_mov_b32 v18, 0
  v_smfmac_f32_16x16x64_bf16 v[132:135], v[116:119], a[192:199], v7
  ds_read_b128 v[80:83], v3 offset:16384
  v_add_f32 v112, v112, v114
  v_smfmac_f32_16x16x64_bf16 v[136:139], v[116:119], a[216:223], v7
  s_waitcnt lgkmcnt(3)
  s_barrier
  v_add_f32 v113, v113, v115
  v_smfmac_f32_16x16x64_bf16 v[140:143], v[116:119], v[64:71], v7
  ds_read_b128 v[84:87], v3 offset:20480
  v_cvt_pk_bf16_f32 v114, v112, v113
  v_smfmac_f32_16x16x64_bf16 v[144:147], v[116:119], a[240:247], v7
  ds_write_b32 v4, v114 offset:2048
  v_smfmac_f32_16x16x64_bf16 v[88:91], v[116:119], v[160:167], v7
  ds_read_b64_tr_b16 v[120:121], v5 offset:1024
  ds_read_b64_tr_b16 v[122:123], v6 offset:1024
  v_smfmac_f32_16x16x64_bf16 v[92:95], v[116:119], v[184:191], v7
  ds_read_b128 v[56:59], v3 offset:24576
  v_mov_b32 v19, 0
  v_smfmac_f32_16x16x64_bf16 v[96:99], v[116:119], v[208:215], v7
  ds_read_b128 v[60:63], v3 offset:28672
  s_waitcnt lgkmcnt(6)
  v_smfmac_f32_16x16x64_bf16 v[100:103], v[116:119], v[72:79], v7
  s_waitcnt lgkmcnt(4)
  s_barrier
  v_smfmac_f32_16x16x64_bf16 v[16:19], v[116:119], v[232:239], v7
  ds_read_b64_tr_b16 v[124:125], v5 offset:2048
  ds_read_b64_tr_b16 v[126:127], v6 offset:2048
  s_waitcnt lgkmcnt(4)
  v_smfmac_f32_16x16x64_bf16 v[128:131], v[120:123], a[176:183], v7
  ds_read_b128 v[64:67], v3 offset:40960
  v_smfmac_f32_16x16x64_bf16 v[132:135], v[120:123], a[200:207], v7
  ds_read_b128 v[68:71], v3 offset:45056
  v_smfmac_f32_16x16x64_bf16 v[136:139], v[120:123], a[224:231], v7
  ds_read_b128 v[72:75], v3 offset:49152
  v_smfmac_f32_16x16x64_bf16 v[140:143], v[120:123], v[80:87], v7
  ds_read_b128 v[76:79], v3 offset:53248
  s_waitcnt lgkmcnt(4)
  v_smfmac_f32_16x16x64_bf16 v[128:131], v[124:127], a[184:191], v7
  v_smfmac_f32_16x16x64_bf16 v[132:135], v[124:127], a[208:215], v7
  v_smfmac_f32_16x16x64_bf16 v[136:139], v[124:127], a[232:239], v7
  v_add_f32 v128, v128, v130
  v_add_f32 v129, v129, v131
  v_cvt_pk_bf16_f32 v128, v128, v129
  v_smfmac_f32_16x16x64_bf16 v[140:143], v[124:127], v[56:63], v7
  v_add_f32 v132, v132, v134
  v_add_f32 v133, v133, v135
  v_cvt_pk_bf16_f32 v129, v132, v133
  v_smfmac_f32_16x16x64_bf16 v[144:147], v[120:123], a[248:255], v7
  v_add_f32 v136, v136, v138
  v_add_f32 v137, v137, v139
  v_permlane16_swap_b32 v128, v129
  v_smfmac_f32_16x16x64_bf16 v[144:147], v[124:127], v[152:159], v7
  buffer_store_dwordx2 v[128:129], v8, s[8:11], s72 offen sc1
  v_cvt_pk_bf16_f32 v136, v136, v137
  v_smfmac_f32_16x16x64_bf16 v[88:91], v[120:123], v[168:175], v7
  v_add_f32 v140, v140, v142
  v_add_f32 v141, v141, v143
  v_smfmac_f32_16x16x64_bf16 v[88:91], v[124:127], v[176:183], v7
  v_cvt_pk_bf16_f32 v137, v140, v141
  v_add_f32 v144, v144, v146
  v_smfmac_f32_16x16x64_bf16 v[92:95], v[120:123], v[192:199], v7
  v_add_f32 v145, v145, v147
  v_permlane16_swap_b32 v136, v137
  v_smfmac_f32_16x16x64_bf16 v[92:95], v[124:127], v[200:207], v7
  buffer_store_dwordx2 v[136:137], v8, s[8:11], s73 offen sc1
  v_cvt_pk_bf16_f32 v144, v144, v145
  v_add_f32 v88, v88, v90
  v_smfmac_f32_16x16x64_bf16 v[96:99], v[120:123], v[216:223], v7
  v_add_f32 v89, v89, v91
  v_cvt_pk_bf16_f32 v145, v88, v89
  v_smfmac_f32_16x16x64_bf16 v[96:99], v[124:127], v[224:231], v7
  s_waitcnt lgkmcnt(0)
  v_add_f32 v92, v92, v94
  v_add_f32 v93, v93, v95
  v_permlane16_swap_b32 v144, v145
  v_smfmac_f32_16x16x64_bf16 v[100:103], v[120:123], v[64:71], v7
  buffer_store_dwordx2 v[144:145], v8, s[8:11], s74 offen sc1
  v_cvt_pk_bf16_f32 v92, v92, v93
  v_smfmac_f32_16x16x64_bf16 v[100:103], v[124:127], v[72:79], v7
  v_add_f32 v96, v96, v98
  v_add_f32 v97, v97, v99
  v_cvt_pk_bf16_f32 v93, v96, v97
  v_smfmac_f32_16x16x64_bf16 v[16:19], v[120:123], v[240:247], v7
  v_smfmac_f32_16x16x64_bf16 v[16:19], v[124:127], v[248:255], v7
  v_add_f32 v100, v100, v102
  v_add_f32 v101, v101, v103
  v_permlane16_swap_b32 v92, v93
  buffer_store_dwordx2 v[92:93], v8, s[8:11], s75 offen sc1
  v_cvt_pk_bf16_f32 v100, v100, v101
  s_nop 2
  v_add_f32 v16, v16, v18
  v_add_f32 v17, v17, v19
  v_cvt_pk_bf16_f32 v101, v16, v17
  s_nop 1
  v_permlane16_swap_b32 v100, v101
  buffer_store_dwordx2 v[100:101], v8, s[8:11], s76 offen sc1
  s_add_u32 s58, s58, 1
  s_cmp_eq_u32 s58, 3
  s_cselect_b32 s58, 0, s58
  s_cmp_eq_u32 s58, 0
  s_addc_u32 s54, s54, 0
  s_cmp_eq_u32 s54, 3
  s_cselect_b32 s54, 0, s54
  s_mov_b32 s52, s53
  s_cmp_lt_u32 s52, 64
  s_cbranch_scc1 va_loop
  s_waitcnt vmcnt(0)
  v_mov_b32 v148, s52
  s_mov_b64 exec, 1
  buffer_store_dword v148, v15, s[8:11], 0 offen sc1
  s_mov_b64 exec, -1
  s_endpgm
va_ha:
  s_waitcnt lgkmcnt(0)
  buffer_load_dwordx4 v[16:19], v11, s[8:11], 0 offen offset:0 sc1
  ds_read_b128 v[56:59], v2 offset:0
  ds_read_b128 v[60:63], v2 offset:4096
  ds_read_b128 v[64:67], v2 offset:8192
  ds_read_b128 v[68:71], v2 offset:12288
  ds_read_b128 v[72:75], v2 offset:16384
  ds_read_b128 v[76:79], v2 offset:20480
  ds_read_b128 v[80:83], v2 offset:24576
  ds_read_b128 v[84:87], v2 offset:28672
  v_mov_b32 v88, 0
  v_mov_b32 v89, 0
  v_mov_b32 v90, 0
  v_mov_b32 v91, 0
  v_mov_b32 v92, 0
  v_mov_b32 v93, 0
  v_mov_b32 v94, 0
  v_mov_b32 v95, 0
  v_mov_b32 v96, 0
  v_mov_b32 v97, 0
  v_mov_b32 v98, 0
  v_mov_b32 v99, 0
  v_mov_b32 v100, 0
  v_mov_b32 v101, 0
  v_mov_b32 v102, 0
  v_mov_b32 v103, 0
  v_mov_b32 v104, 0
  v_mov_b32 v105, 0
  v_mov_b32 v106, 0
  v_mov_b32 v107, 0
  v_mov_b32 v108, 0
  v_mov_b32 v109, 0
  v_mov_b32 v110, 0
  v_mov_b32 v111, 0
  v_mov_b32 v112, 0
  v_mov_b32 v113, 0
  v_mov_b32 v114, 0
  v_mov_b32 v115, 0
  v_mov_b32 v128, 0
  v_mov_b32 v129, 0
  v_mov_b32 v130, 0
  v_mov_b32 v131, 0
  v_mov_b32 v132, 0
  v_mov_b32 v133, 0
  v_mov_b32 v134, 0
  v_mov_b32 v135, 0
  v_mov_b32 v136, 0
  v_mov_b32 v137, 0
  v_mov_b32 v138, 0
  v_mov_b32 v139, 0
  v_mov_b32 v140, 0
  v_mov_b32 v141, 0
  v_mov_b32 v142, 0
  v_mov_b32 v143, 0
  v_mov_b32 v144, 0
  v_mov_b32 v145, 0
  v_mov_b32 v146, 0
  v_mov_b32 v147, 0
  s_branch va_wa
va_ra:
  buffer_load_dwordx4 v[16:19], v11, s[8:11], 0 offen offset:0 sc1
  s_add_u32 s50, s50, 1
  s_cmp_gt_u32 s50, 131072
  s_cbranch_scc1 L_fail
va_wa:
  s_waitcnt vmcnt(0)
  v_cmp_eq_u32 vcc, -1, v16
  s_cbranch_vccnz va_ra
  s_waitcnt lgkmcnt(0)
  s_branch va_go
va_hb:
  s_waitcnt lgkmcnt(0)
  s_barrier
  buffer_load_dwordx4 v[20:23], v11, s[8:11], s31 offen sc1
  buffer_load_dwordx4 v[24:27], v11, s[8:11], s32 offen sc1
  buffer_load_dwordx4 v[28:31], v11, s[8:11], s33 offen sc1
  ds_read_b128 v[56:59], v2 offset:0
  ds_read_b128 v[60:63], v2 offset:4096
  ds_read_b128 v[64:67], v2 offset:8192
  ds_read_b128 v[68:71], v2 offset:12288
  ds_read_b128 v[72:75], v2 offset:16384
  ds_read_b128 v[76:79], v2 offset:20480
  ds_read_b128 v[80:83], v2 offset:24576
  ds_read_b128 v[84:87], v2 offset:28672
  v_mov_b32 v88, 0
  v_mov_b32 v89, 0
  v_mov_b32 v90, 0
  v_mov_b32 v91, 0
  v_mov_b32 v92, 0
  v_mov_b32 v93, 0
  v_mov_b32 v94, 0
  v_mov_b32 v95, 0
  v_mov_b32 v96, 0
  v_mov_b32 v97, 0
  v_mov_b32 v98, 0
  v_mov_b32 v99, 0
  v_mov_b32 v100, 0
  v_mov_b32 v101, 0
  v_mov_b32 v102, 0
  v_mov_b32 v103, 0
  v_mov_b32 v104, 0
  v_mov_b32 v105, 0
  v_mov_b32 v106, 0
  v_mov_b32 v107, 0
  v_mov_b32 v108, 0
  v_mov_b32 v109, 0
  v_mov_b32 v110, 0
  v_mov_b32 v111, 0
  v_mov_b32 v112, 0
  v_mov_b32 v113, 0
  v_mov_b32 v114, 0
  v_mov_b32 v115, 0
  v_mov_b32 v128, 0
  v_mov_b32 v129, 0
  v_mov_b32 v130, 0
  v_mov_b32 v131, 0
  v_mov_b32 v132, 0
  v_mov_b32 v133, 0
  v_mov_b32 v134, 0
  v_mov_b32 v135, 0
  v_mov_b32 v136, 0
  v_mov_b32 v137, 0
  v_mov_b32 v138, 0
  v_mov_b32 v139, 0
  v_mov_b32 v140, 0
  v_mov_b32 v141, 0
  v_mov_b32 v142, 0
  v_mov_b32 v143, 0
  v_mov_b32 v144, 0
  v_mov_b32 v145, 0
  v_mov_b32 v146, 0
  v_mov_b32 v147, 0
  s_branch va_wb
va_rb:
  buffer_load_dwordx4 v[20:23], v11, s[8:11], s31 offen sc1
  buffer_load_dwordx4 v[24:27], v11, s[8:11], s32 offen sc1
  buffer_load_dwordx4 v[28:31], v11, s[8:11], s33 offen sc1
  s_add_u32 s50, s50, 1
  s_cmp_gt_u32 s50, 131072
  s_cbranch_scc1 L_fail
va_wb:
  s_waitcnt vmcnt(0)
  v_max3_u32 v12, v20, v24, v28
  v_cmp_eq_u32 vcc, -1, v12
  s_cbranch_vccnz va_rb
  v_add_u32 v12, s51, v9
  ds_write_b128 v12, v[20:23] offset:0
  ds_write_b128 v12, v[24:27] offset:4096
  ds_write_b128 v12, v[28:31] offset:8192
  s_add_u32 s50, s50, 1
  s_cmp_gt_u32 s50, 131072
  s_cbranch_scc1 L_fail
  s_waitcnt lgkmcnt(0)
  s_branch va_go0
va_redo:
  s_waitcnt lgkmcnt(0)
  s_mov_b32 s50, 0
va_poll:
  buffer_load_dwordx4 v[16:19], v11, s[8:11], 0 offen offset:0 sc1
  buffer_load_dwordx4 v[20:23], v11, s[8:11], 0 offen offset:1024 sc1
  buffer_load_dwordx4 v[24:27], v11, s[8:11], 0 offen offset:2048 sc1
  buffer_load_dwordx4 v[28:31], v11, s[8:11], 0 offen offset:3072 sc1
  buffer_load_dwordx4 v[32:35], v11, s[8:11], s24 offen offset:0 sc1
  buffer_load_dwordx4 v[36:39], v11, s[8:11], s24 offen offset:1024 sc1
  buffer_load_dwordx4 v[40:43], v11, s[8:11], s24 offen offset:2048 sc1
  buffer_load_dwordx4 v[44:47], v11, s[8:11], s24 offen offset:3072 sc1
  buffer_load_dwordx4 v[48:51], v11, s[8:11], s25 offen offset:0 sc1
  buffer_load_dwordx4 v[52:55], v11, s[8:11], s25 offen offset:1024 sc1
  s_add_u32 s50, s50, 1
  s_cmp_gt_u32 s50, 131072
  s_cbranch_scc1 L_fail
  s_waitcnt vmcnt(0) lgkmcnt(0)
  v_max_u32 v12, v16, v17
  v_max3_u32 v12, v18, v19, v12
  v_max3_u32 v12, v20, v21, v12
  v_max3_u32 v12, v22, v23, v12
  v_max3_u32 v12, v24, v25, v12
  v_max3_u32 v12, v26, v27, v12
  v_max3_u32 v12, v28, v29, v12
  v_max3_u32 v12, v30, v31, v12
  v_max3_u32 v12, v32, v33, v12
  v_max3_u32 v12, v34, v35, v12
  v_max3_u32 v12, v36, v37, v12
  v_max3_u32 v12, v38, v39, v12
  v_max3_u32 v12, v40, v41, v12
  v_max3_u32 v12, v42, v43, v12
  v_max3_u32 v12, v44, v45, v12
  v_max3_u32 v12, v46, v47, v12
  v_max3_u32 v12, v48, v49, v12
  v_max3_u32 v12, v50, v51, v12
  v_max3_u32 v12, v52, v53, v12
  v_max3_u32 v12, v54, v55, v12
  v_cmp_eq_u32 vcc, -1, v12
  s_cbranch_vccnz va_poll
  s_mov_b64 s[16:17], 0
  ds_read_b128 v[56:59], v2 offset:0
  ds_read_b128 v[60:63], v2 offset:4096
  ds_read_b128 v[64:67], v2 offset:8192
  ds_read_b128 v[68:71], v2 offset:12288
  ds_read_b128 v[72:75], v2 offset:16384
  ds_read_b128 v[76:79], v2 offset:20480
  ds_read_b128 v[80:83], v2 offset:24576
  ds_read_b128 v[84:87], v2 offset:28672
  v_mov_b32 v88, 0
  v_mov_b32 v89, 0
  v_mov_b32 v90, 0
  v_mov_b32 v91, 0
  v_mov_b32 v92, 0
  v_mov_b32 v93, 0
  v_mov_b32 v94, 0
  v_mov_b32 v95, 0
  v_mov_b32 v96, 0
  v_mov_b32 v97, 0
  v_mov_b32 v98, 0
  v_mov_b32 v99, 0
  v_mov_b32 v100, 0
  v_mov_b32 v101, 0
  v_mov_b32 v102, 0
  v_mov_b32 v103, 0
  v_mov_b32 v104, 0
  v_mov_b32 v105, 0
  v_mov_b32 v106, 0
  v_mov_b32 v107, 0
  v_mov_b32 v108, 0
  v_mov_b32 v109, 0
  v_mov_b32 v110, 0
  v_mov_b32 v111, 0
  v_mov_b32 v112, 0
  v_mov_b32 v113, 0
  v_mov_b32 v114, 0
  v_mov_b32 v115, 0
  v_mov_b32 v128, 0
  v_mov_b32 v129, 0
  v_mov_b32 v130, 0
  v_mov_b32 v131, 0
  v_mov_b32 v132, 0
  v_mov_b32 v133, 0
  v_mov_b32 v134, 0
  v_mov_b32 v135, 0
  v_mov_b32 v136, 0
  v_mov_b32 v137, 0
  v_mov_b32 v138, 0
  v_mov_b32 v139, 0
  v_mov_b32 v140, 0
  v_mov_b32 v141, 0
  v_mov_b32 v142, 0
  v_mov_b32 v143, 0
  v_mov_b32 v144, 0
  v_mov_b32 v145, 0
  v_mov_b32 v146, 0
  v_mov_b32 v147, 0
  s_waitcnt lgkmcnt(0)
  v_smfmac_f32_16x16x64_bf16 v[104:107], v[16:19], v[56:63], v7
  v_smfmac_f32_16x16x64_bf16 v[108:111], v[16:19], v[64:71], v7
  v_smfmac_f32_16x16x64_bf16 v[112:115], v[16:19], v[72:79], v7
  ds_read_b128 v[56:59], v2 offset:49152
  v_smfmac_f32_16x16x64_bf16 v[104:107], v[20:23], a[0:7], v7
  ds_read_b128 v[60:63], v2 offset:53248
  v_smfmac_f32_16x16x64_bf16 v[108:111], v[20:23], a[8:15], v7
  ds_read_b128 v[64:67], v2 offset:32768
  v_smfmac_f32_16x16x64_bf16 v[112:115], v[20:23], a[16:23], v7
  v_smfmac_f32_16x16x64_bf16 v[104:107], v[24:27], a[24:31], v7
  v_smfmac_f32_16x16x64_bf16 v[108:111], v[24:27], a[32:39], v7
  v_smfmac_f32_16x16x64_bf16 v[112:115], v[24:27], a[40:47], v7
  v_smfmac_f32_16x16x64_bf16 v[104:107], v[28:31], a[48:55], v7
  v_smfmac_f32_16x16x64_bf16 v[104:107], v[32:35], v[80:87], v7
  v_smfmac_f32_16x16x64_bf16 v[104:107], v[36:39], a[72:79], v7
  ds_read_b128 v[68:71], v2 offset:36864
  v_smfmac_f32_16x16x64_bf16 v[104:107], v[40:43], a[96:103], v7
  v_smfmac_f32_16x16x64_bf16 v[104:107], v[44:47], a[120:127], v7
  s_waitcnt lgkmcnt(1)
  v_smfmac_f32_16x16x64_bf16 v[104:107], v[48:51], v[56:63], v7
  v_smfmac_f32_16x16x64_bf16 v[104:107], v[52:55], a[144:151], v7
  ds_read_b128 v[72:75], v2 offset:57344
  v_smfmac_f32_16x16x64_bf16 v[108:111], v[28:31], a[56:63], v7
  ds_read_b128 v[76:79], v2 offset:61440
  s_waitcnt lgkmcnt(2)
  v_smfmac_f32_16x16x64_bf16 v[108:111], v[32:35], v[64:71], v7
  v_mov_b32 v16, 0
  s_waitcnt lgkmcnt(0)
  s_branch va_join
L_owner:
  s_cmp_ge_u32 s42, 2
  s_cbranch_scc1 L_end
  s_mul_i32 s62, s43, 10
  s_add_u32 s62, s62, s44
  s_sub_u32 s62, s62, 16
  s_mov_b32 s12, s24
  s_mov_b32 s13, s25
  s_mov_b32 s14, 10240
  s_mov_b32 s15, 0x20000
  v_mov_b32 v20, -1
  v_mov_b32 v24, 0
  v_mov_b32 v21, -1
  v_mov_b32 v25, 0
  v_mov_b32 v22, -1
  v_mov_b32 v26, 0
  v_mov_b32 v23, -1
  v_mov_b32 v27, 0
  s_lshl_b32 s48, s42, 13
  s_lshl_b32 s46, s62, 8
  s_cmp_ge_u32 s62, 32
  s_cselect_b32 s47, 40960, 0
  s_add_u32 s46, s46, s47
  s_add_u32 s46, s46, s48
  s_add_u32 s46, s46, 12582912
  v_and_b32 v13, 15, v0
  v_lshlrev_b32 v13, 4, v13
  v_lshrrev_b32 v12, 4, v0
  v_lshl_add_u32 v13, v12, 16, v13
  buffer_store_dwordx4 v[20:23], v13, s[8:11], s46 offen sc1
  s_add_u32 s46, s46, 262144
  buffer_store_dwordx4 v[20:23], v13, s[8:11], s46 offen sc1
  s_add_u32 s46, s46, 262144
  buffer_store_dwordx4 v[20:23], v13, s[8:11], s46 offen sc1
  s_add_u32 s46, s46, 262144
  s_lshl_b32 s46, s62, 9
  s_cmp_ge_u32 s62, 16
  s_cselect_b32 s47, 8192, 0
  s_add_u32 s46, s46, s47
  s_cmp_ge_u32 s62, 32
  s_cselect_b32 s47, 10240, 0
  s_add_u32 s46, s46, s47
  s_add_u32 s46, s46, s48
  s_add_u32 s46, s46, 12599296
  v_lshlrev_b32 v13, 3, v0
  buffer_store_dwordx2 v[20:21], v13, s[8:11], s46 offen sc1
  s_add_u32 s46, s46, 262144
  buffer_store_dwordx2 v[20:21], v13, s[8:11], s46 offen sc1
  s_add_u32 s46, s46, 262144
  buffer_store_dwordx2 v[20:21], v13, s[8:11], s46 offen sc1
  s_add_u32 s46, s46, 262144
  v_min_u32 v13, 19, v0
  s_mul_i32 s46, s62, 20
  v_add_u32 v13, s46, v13
  v_lshrrev_b32 v12, 7, v13
  v_lshlrev_b32 v12, 14, v12
  v_bfe_u32 v14, v13, 1, 6
  v_lshl_add_u32 v12, v14, 7, v12
  v_and_b32 v13, 1, v13
  v_lshl_add_u32 v13, v13, 4, v12
  s_add_u32 s46, s48, 13631488
  buffer_store_dwordx4 v[24:27], v13, s[8:11], s46 offen sc1
  s_and_b32 s46, s62, 31
  s_lshl_b32 s46, s46, 8
  s_add_u32 s46, s46, s48
  s_add_u32 s46, s46, 13369344
  v_and_b32 v13, 1, v0
  v_lshlrev_b32 v13, 7, v13
  v_bfe_u32 v12, v0, 1, 1
  v_lshl_add_u32 v13, v12, 14, v13
  buffer_store_dwordx4 v[24:27], v13, s[8:11], s46 offen sc1
  v_mov_b32 v13, 192
  v_mov_b32 v14, 1
  s_waitcnt vmcnt(0)
  s_mov_b64 exec, 1
  global_atomic_add v12, v13, v14, s[38:39] sc0 sc1
  s_waitcnt vmcnt(0)
  v_readfirstlane_b32 s46, v12
  s_nop 0
  s_cmp_lg_u32 s46, 79
  s_cbranch_scc1 ow_notlast
  v_mov_b32 v13, 8
  global_store_dword v13, v14, s[38:39] sc1
ow_notlast:
  s_mov_b64 exec, -1
  s_mov_b32 s50, 0
ss_27:
  v_and_b32 v11, 3, v0
  v_lshlrev_b32 v11, 2, v11
  global_load_dword v10, v11, s[38:39] sc1
  s_add_u32 s50, s50, 1
  s_cmp_gt_u32 s50, 131072
  s_cbranch_scc1 L_fail
  s_waitcnt vmcnt(0)
ss_27_in:
  v_readlane_b32 s46, v10, 0
  v_readlane_b32 s47, v10, 2
  v_readlane_b32 s48, v10, 1
  s_nop 0
  s_min_u32 s47, s47, s48
  s_cmp_lg_u32 s46, 0
  s_cselect_b32 s48, 7, 0
  s_add_u32 s46, s46, s2
  s_xor_b32 s49, s46, s43
  s_and_b32 s49, s49, s48
  s_cbranch_scc1 L_reroll
  s_cmp_lg_u32 s47, 0
  s_cbranch_scc1 ss_ok_28
  s_sleep 6
  s_branch ss_27
ss_ok_28:
  v_readlane_b32 s3, v10, 1
  s_nop 0
  s_and_b32 s3, s3, 0x2000
  s_lshr_b32 s46, s44, 4
  s_lshl_b32 s46, s46, 7
  s_lshl_b32 s47, s43, 4
  s_add_u32 s46, s46, s47
  s_and_b32 s47, s44, 15
  s_add_u32 s46, s46, s47
  s_lshl_b32 s46, s46, 7
  s_add_u32 s46, s46, s3
  s_add_u32 s46, s46, 13369344
  s_add_u32 s40, s8, s46
  s_addc_u32 s41, s9, 0
  s_sub_u32 s47, s44, 16
  s_lshl_b32 s46, s47, 11
  s_lshl_b32 s48, s43, 2
  s_add_u32 s46, s46, s48
  s_add_u32 s46, s46, s3
  s_add_u32 s46, s46, 13369344
  v_lshl_add_u32 v7, v0, 7, s46
  v_mov_b32 v10, 2146435072
  s_cmp_lt_u32 s47, 4
  s_cselect_b32 vcc_lo, 65535, 0
  s_mov_b32 vcc_hi, 0
  v_cndmask_b32 v7, v10, v7, vcc
  s_cmp_eq_u32 s42, 0
  s_cbranch_scc1 ow_main
  s_and_b32 s63, s62, 3
  s_lshl_b32 s63, s63, 7
  s_lshl_b32 s46, s43, 11
  s_add_u32 s63, s63, s46
  s_add_u32 s63, s63, 13688832
  s_xor_b32 s63, s63, s3
  s_mul_i32 s64, s43, 768
  s_cmp_ge_u32 s44, 21
  s_cselect_b32 s47, 128, 0
  s_add_u32 s64, s64, s47
  s_add_u32 s64, s64, 13660160
  s_xor_b32 s64, s64, s3
  v_mov_b32 v14, 2146435072
  s_lshl_b32 s46, s43, 11
  s_add_u32 s46, s46, s3
  s_add_u32 s46, s46, 13387008
  v_lshl_add_u32 v19, v0, 7, s46
  s_lshl_b32 s46, s43, 7
  s_add_u32 s46, s46, 13663232
  s_xor_b32 s46, s46, s3
  v_writelane_b32 v19, s46, 6
  s_cmp_eq_u32 s44, 20
  s_cselect_b32 vcc_lo, 127, 0
  s_mov_b32 vcc_hi, 0
  v_cndmask_b32 v19, v14, v19, vcc
  s_mov_b32 s53, 1
  s_mov_b32 s60, 0
  s_mov_b32 s61, 0
  s_lshl_b32 s66, s62, 16
  s_add_u32 s66, s66, 117440512
  s_mov_b32 s50, 0
sw_loop_30:
  s_cmp_ge_u32 s61, s53
  s_cbranch_scc1 sw_done_29
  s_add_u32 s46, s64, 0
  s_buffer_load_dword s32, s[8:11], s46 glc
  s_add_u32 s46, s64, 256
  s_buffer_load_dword s33, s[8:11], s46 glc
  s_add_u32 s46, s64, 512
  s_buffer_load_dword s34, s[8:11], s46 glc
  s_waitcnt lgkmcnt(0)
  s_min_u32 s61, s32, s33
  s_min_u32 s61, s61, s34
  s_add_u32 s50, s50, 1
  s_cmp_gt_u32 s50, 131072
  s_cbranch_scc1 L_fail
  s_branch sw_loop_30
sw_done_29:
  s_barrier
  s_mov_b32 s50, 0
sw_loop_32:
  s_cmp_ge_u32 s60, s53
  s_cbranch_scc1 sw_done_31
  s_add_u32 s46, s63, 0
  s_buffer_load_dwordx8 s[16:23], s[8:11], s46 glc
  s_add_u32 s46, s63, 512
  s_buffer_load_dwordx8 s[24:31], s[8:11], s46 glc
  s_add_u32 s46, s63, 1024
  s_buffer_load_dwordx8 s[72:79], s[8:11], s46 glc
  s_add_u32 s46, s63, 1536
  s_buffer_load_dwordx8 s[84:91], s[8:11], s46 glc
  s_waitcnt lgkmcnt(0)
  s_min_u32 s60, s16, s17
  s_min_u32 s60, s60, s18
  s_min_u32 s60, s60, s19
  s_min_u32 s60, s60, s20
  s_min_u32 s60, s60, s21
  s_min_u32 s60, s60, s22
  s_min_u32 s60, s60, s23
  s_min_u32 s60, s60, s24
  s_min_u32 s60, s60, s25
  s_min_u32 s60, s60, s26
  s_min_u32 s60, s60, s27
  s_min_u32 s60, s60, s28
  s_min_u32 s60, s60, s29
  s_min_u32 s60, s60, s30
  s_min_u32 s60, s60, s31
  s_min_u32 s60, s60, s72
  s_min_u32 s60, s60, s73
  s_min_u32 s60, s60, s74
  s_min_u32 s60, s60, s75
  s_min_u32 s60, s60, s76
  s_min_u32 s60, s60, s77
  s_min_u32 s60, s60, s78
  s_min_u32 s60, s60, s79
  s_min_u32 s60, s60, s84
  s_min_u32 s60, s60, s85
  s_min_u32 s60, s60, s86
  s_min_u32 s60, s60, s87
  s_min_u32 s60, s60, s88
  s_min_u32 s60, s60, s89
  s_min_u32 s60, s60, s90
  s_min_u32 s60, s60, s91
  s_add_u32 s50, s50, 1
  s_cmp_gt_u32 s50, 131072
  s_cbranch_scc1 L_fail
  s_branch sw_loop_32
sw_done_31:
  s_barrier
ow_listen:
  s_add_u32 s65, s53, 1
  s_mov_b32 s50, 0
sw_loop_34:
  s_cmp_ge_u32 s60, s65
  s_cbranch_scc1 sw_done_33
  s_add_u32 s46, s63, 0
  s_buffer_load_dwordx8 s[16:23], s[8:11], s46 glc
  s_add_u32 s46, s63, 512
  s_buffer_load_dwordx8 s[24:31], s[8:11], s46 glc
  s_add_u32 s46, s63, 1024
  s_buffer_load_dwordx8 s[72:79], s[8:11], s46 glc
  s_add_u32 s46, s63, 1536
  s_buffer_load_dwordx8 s[84:91], s[8:11], s46 glc
sw_done_33:
  s_mov_b32 s50, 0
sw_loop_36:
  s_cmp_ge_u32 s61, s65
  s_cbranch_scc1 sw_done_35
  s_add_u32 s46, s64, 0
  s_buffer_load_dword s32, s[8:11], s46 glc
  s_add_u32 s46, s64, 256
  s_buffer_load_dword s33, s[8:11], s46 glc
  s_add_u32 s46, s64, 512
  s_buffer_load_dword s34, s[8:11], s46 glc
sw_done_35:
  s_mov_b32 s50, 0
  s_mov_b64 s[80:81], 0
  s_mov_b64 s[82:83], 0
bell_37:
  s_load_dwordx4 s[80:83], s[40:41], 0 glc
  s_min_u32 s46, s80, s81
  s_min_u32 s47, s82, s83
  s_min_u32 s46, s46, s47
  s_cmp_ge_u32 s46, s53
  s_cbranch_scc1 bell_x_38
  s_min_u32 s46, s80, s81
  s_min_u32 s47, s82, s83
  s_min_u32 s46, s46, s47
  s_cmp_ge_u32 s46, s53
  s_cbranch_scc1 bell_x_38
  s_min_u32 s46, s80, s81
  s_min_u32 s47, s82, s83
  s_min_u32 s46, s46, s47
  s_cmp_ge_u32 s46, s53
  s_cbranch_scc1 bell_x_38
  s_min_u32 s46, s80, s81
  s_min_u32 s47, s82, s83
  s_min_u32 s46, s46, s47
  s_cmp_ge_u32 s46, s53
  s_cbranch_scc1 bell_x_38
  s_min_u32 s46, s80, s81
  s_min_u32 s47, s82, s83
  s_min_u32 s46, s46, s47
  s_cmp_ge_u32 s46, s53
  s_cbranch_scc1 bell_x_38
  s_min_u32 s46, s80, s81
  s_min_u32 s47, s82, s83
  s_min_u32 s46, s46, s47
  s_cmp_ge_u32 s46, s53
  s_cbranch_scc1 bell_x_38
  s_min_u32 s46, s80, s81
  s_min_u32 s47, s82, s83
  s_min_u32 s46, s46, s47
  s_cmp_ge_u32 s46, s53
  s_cbranch_scc1 bell_x_38
  s_min_u32 s46, s80, s81
  s_min_u32 s47, s82, s83
  s_min_u32 s46, s46, s47
  s_cmp_ge_u32 s46, s53
  s_cbranch_scc1 bell_x_38
  s_add_u32 s50, s50, 1
  s_cmp_lt_u32 s50, 524288
  s_cbranch_scc1 bell_37
  s_branch L_fail
bell_x_38:
  s_barrier
  s_waitcnt lgkmcnt(0)
  s_mov_b32 s50, 0
sw_loop_40:
  s_cmp_ge_u32 s60, s65
  s_cbranch_scc1 sw_done_39
  s_waitcnt lgkmcnt(0)
  s_min_u32 s60, s16, s17
  s_min_u32 s60, s60, s18
  s_min_u32 s60, s60, s19
  s_min_u32 s60, s60, s20
  s_min_u32 s60, s60, s21
  s_min_u32 s60, s60, s22
  s_min_u32 s60, s60, s23
  s_min_u32 s60, s60, s24
  s_min_u32 s60, s60, s25
  s_min_u32 s60, s60, s26
  s_min_u32 s60, s60, s27
  s_min_u32 s60, s60, s28
  s_min_u32 s60, s60, s29
  s_min_u32 s60, s60, s30
  s_min_u32 s60, s60, s31
  s_min_u32 s60, s60, s72
  s_min_u32 s60, s60, s73
  s_min_u32 s60, s60, s74
  s_min_u32 s60, s60, s75
  s_min_u32 s60, s60, s76
  s_min_u32 s60, s60, s77
  s_min_u32 s60, s60, s78
  s_min_u32 s60, s60, s79
  s_min_u32 s60, s60, s84
  s_min_u32 s60, s60, s85
  s_min_u32 s60, s60, s86
  s_min_u32 s60, s60, s87
  s_min_u32 s60, s60, s88
  s_min_u32 s60, s60, s89
  s_min_u32 s60, s60, s90
  s_min_u32 s60, s60, s91
sw_done_39:
  s_mov_b32 s50, 0
sw_loop_42:
  s_cmp_ge_u32 s61, s65
  s_cbranch_scc1 sw_done_41
  s_waitcnt lgkmcnt(0)
  s_min_u32 s61, s32, s33
  s_min_u32 s61, s61, s34
sw_done_41:
  s_mov_b32 s50, 0
sw_loop_44:
  s_cmp_ge_u32 s60, s65
  s_cbranch_scc1 sw_done_43
  s_add_u32 s46, s63, 0
  s_buffer_load_dwordx8 s[16:23], s[8:11], s46 glc
  s_add_u32 s46, s63, 512
  s_buffer_load_dwordx8 s[24:31], s[8:11], s46 glc
  s_add_u32 s46, s63, 1024
  s_buffer_load_dwordx8 s[72:79], s[8:11], s46 glc
  s_add_u32 s46, s63, 1536
  s_buffer_load_dwordx8 s[84:91], s[8:11], s46 glc
  s_waitcnt lgkmcnt(0)
  s_min_u32 s60, s16, s17
  s_min_u32 s60, s60, s18
  s_min_u32 s60, s60, s19
  s_min_u32 s60, s60, s20
  s_min_u32 s60, s60, s21
  s_min_u32 s60, s60, s22
  s_min_u32 s60, s60, s23
  s_min_u32 s60, s60, s24
  s_min_u32 s60, s60, s25
  s_min_u32 s60, s60, s26
  s_min_u32 s60, s60, s27
  s_min_u32 s60, s60, s28
  s_min_u32 s60, s60, s29
  s_min_u32 s60, s60, s30
  s_min_u32 s60, s60, s31
  s_min_u32 s60, s60, s72
  s_min_u32 s60, s60, s73
  s_min_u32 s60, s60, s74
  s_min_u32 s60, s60, s75
  s_min_u32 s60, s60, s76
  s_min_u32 s60, s60, s77
  s_min_u32 s60, s60, s78
  s_min_u32 s60, s60, s79
  s_min_u32 s60, s60, s84
  s_min_u32 s60, s60, s85
  s_min_u32 s60, s60, s86
  s_min_u32 s60, s60, s87
  s_min_u32 s60, s60, s88
  s_min_u32 s60, s60, s89
  s_min_u32 s60, s60, s90
  s_min_u32 s60, s60, s91
  s_add_u32 s50, s50, 1
  s_cmp_gt_u32 s50, 131072
  s_cbranch_scc1 L_fail
  s_branch sw_loop_44
sw_done_43:
  s_mov_b32 s50, 0
sw_loop_46:
  s_cmp_ge_u32 s61, s65
  s_cbranch_scc1 sw_done_45
  s_add_u32 s46, s64, 0
  s_buffer_load_dword s32, s[8:11], s46 glc
  s_add_u32 s46, s64, 256
  s_buffer_load_dword s33, s[8:11], s46 glc
  s_add_u32 s46, s64, 512
  s_buffer_load_dword s34, s[8:11], s46 glc
  s_waitcnt lgkmcnt(0)
  s_min_u32 s61, s32, s33
  s_min_u32 s61, s61, s34
  s_add_u32 s50, s50, 1
  s_cmp_gt_u32 s50, 131072
  s_cbranch_scc1 L_fail
  s_branch sw_loop_46
sw_done_45:
  s_sub_u32 s46, s53, 1
  v_mov_b32 v12, s46
  s_barrier
  buffer_store_dword v12, v19, s[8:11], 0 offen sc1
  s_mov_b32 s53, s65
  s_cmp_lt_u32 s53, 64
  s_cbranch_scc1 ow_listen
  s_endpgm
ow_main:
  v_mov_b32 v5, 0x44444444
  v_mov_b32 v10, 0xeeeeeeee
  v_and_b32 v11, 2, v0
  v_cmp_ne_u32 vcc, 0, v11
  s_nop 1
  v_cndmask_b32 v5, v5, v10, vcc
  v_lshlrev_b32 v1, 4, v0
  v_and_b32 v10, 15, v0
  v_lshrrev_b32 v11, 4, v0
  v_lshlrev_b32 v2, 3, v10
  v_lshl_add_u32 v2, v11, 8, v2
  v_and_b32 v13, 1, v10
  v_lshl_add_u32 v12, v11, 1, v13
  v_mov_b32 v4, 0x05040100
  v_mov_b32 v14, 0x03020706
  v_cmp_eq_u32 vcc, 1, v13
  s_nop 1
  v_cndmask_b32 v4, v4, v14, vcc
  v_and_b32 v13, 3, v10
  v_lshl_add_u32 v3, v11, 2, v13
  v_lshlrev_b32 v3, 4, v3
  v_lshrrev_b32 v13, 2, v10
  v_lshl_add_u32 v3, v13, 2, v3
  s_lshl_b32 s46, s62, 8
  s_cmp_ge_u32 s62, 32
  s_cselect_b32 s47, 40960, 0
  s_add_u32 s46, s46, s47
  s_add_u32 s46, s46, s3
  s_add_u32 s46, s46, 12582912
  v_add_u32 v3, s46, v3
  v_mul_u32_u24 v12, 1280, v12
  v_and_b32 v13, 14, v10
  v_lshl_add_u32 v12, v13, 1, v12
  s_lshl_b32 s46, s62, 5
  buffer_load_dword v15, v12, s[12:15], s46 offen
  s_lshl_b32 s63, s62, 16
  s_add_u32 s63, s63, s3
  s_add_u32 s63, s63, 117440512
  s_mov_b32 s61, 0
  s_mov_b32 s52, 0
  s_mov_b32 s58, 0
  s_mov_b32 s54, 0
  s_mov_b32 s100, 0
  s_waitcnt vmcnt(0)
  s_barrier
  v_min_u32 v15, -2, v15
  s_mov_b32 s46, 0
  buffer_store_dword v15, v3, s[8:11], s46 offen sc1
  s_mov_b32 s46, 65536
  buffer_store_dword v15, v3, s[8:11], s46 offen sc1
  s_mov_b32 s46, 131072
  buffer_store_dword v15, v3, s[8:11], s46 offen sc1
  s_mov_b32 s46, 196608
  buffer_store_dword v15, v3, s[8:11], s46 offen sc1
  v_mov_b32 v16, 1
  buffer_store_dword v16, v7, s[8:11], 0 offen sc1
  s_barrier
  s_mov_b32 s65, s63
  s_lshr_b32 s46, s65, 8
  s_and_b32 s46, s46, 0x2000
  s_xor_b32 s65, s65, s46
  s_add_u32 s63, s63, 2621440
  s_cmp_ge_u32 s63, 201326592
  s_cselect_b32 s46, 83886080, 0
  s_sub_u32 s63, s63, s46
  s_add_u32 s46, s65, 0
  s_xor_b32 s46, s46, 0x2000
  buffer_load_dwordx4 a[0:3], v1, s[8:11], s46 offen offset:0 sc1
  buffer_load_dwordx4 a[4:7], v1, s[8:11], s46 offen offset:1024 sc1
  buffer_load_dwordx4 a[8:11], v1, s[8:11], s46 offen offset:2048 sc1
  buffer_load_dwordx4 a[12:15], v1, s[8:11], s46 offen offset:3072 sc1
  s_add_u32 s46, s65, 4096
  s_xor_b32 s46, s46, 0x2000
  buffer_load_dwordx4 a[16:19], v1, s[8:11], s46 offen offset:0 sc1
  buffer_load_dwordx4 a[20:23], v1, s[8:11], s46 offen offset:1024 sc1
  buffer_load_dwordx4 a[24:27], v1, s[8:11], s46 offen offset:2048 sc1
  buffer_load_dwordx4 a[28:31], v1, s[8:11], s46 offen offset:3072 sc1
  s_add_u32 s46, s65, 16384
  buffer_load_dwordx4 a[32:35], v1, s[8:11], s46 offen offset:0 sc1
  buffer_load_dwordx4 a[36:39], v1, s[8:11], s46 offen offset:1024 sc1
  buffer_load_dwordx4 a[40:43], v1, s[8:11], s46 offen offset:2048 sc1
  buffer_load_dwordx4 a[44:47], v1, s[8:11], s46 offen offset:3072 sc1
  s_add_u32 s46, s65, 20480
  buffer_load_dwordx4 a[48:51], v1, s[8:11], s46 offen offset:0 sc1
  buffer_load_dwordx4 a[52:55], v1, s[8:11], s46 offen offset:1024 sc1
  buffer_load_dwordx4 a[56:59], v1, s[8:11], s46 offen offset:2048 sc1
  buffer_load_dwordx4 a[60:63], v1, s[8:11], s46 offen offset:3072 sc1
  s_add_u32 s46, s65, 32768
  buffer_load_dwordx4 a[64:67], v1, s[8:11], s46 offen offset:0 sc1
  buffer_load_dwordx4 a[68:71], v1, s[8:11], s46 offen offset:1024 sc1
  buffer_load_dwordx4 a[72:75], v1, s[8:11], s46 offen offset:2048 sc1
  buffer_load_dwordx4 a[76:79], v1, s[8:11], s46 offen offset:3072 sc1
  s_add_u32 s46, s65, 36864
  buffer_load_dwordx4 a[80:83], v1, s[8:11], s46 offen offset:0 sc1
  buffer_load_dwordx4 a[84:87], v1, s[8:11], s46 offen offset:1024 sc1
  buffer_load_dwordx4 a[88:91], v1, s[8:11], s46 offen offset:2048 sc1
  buffer_load_dwordx4 a[92:95], v1, s[8:11], s46 offen offset:3072 sc1
  s_add_u32 s46, s65, 49152
  buffer_load_dwordx4 a[96:99], v1, s[8:11], s46 offen offset:0 sc1
  buffer_load_dwordx4 a[100:103], v1, s[8:11], s46 offen offset:1024 sc1
  buffer_load_dwordx4 a[104:107], v1, s[8:11], s46 offen offset:2048 sc1
  buffer_load_dwordx4 a[108:111], v1, s[8:11], s46 offen offset:3072 sc1
  s_add_u32 s46, s65, 53248
  buffer_load_dwordx4 a[112:115], v1, s[8:11], s46 offen offset:0 sc1
  buffer_load_dwordx4 a[116:119], v1, s[8:11], s46 offen offset:1024 sc1
  buffer_load_dwordx4 a[120:123], v1, s[8:11], s46 offen offset:2048 sc1
  buffer_load_dwordx4 a[124:127], v1, s[8:11], s46 offen offset:3072 sc1
ow_loop:
  s_add_u32 s53, s52, 1
  s_lshl_b32 s56, s58, 2
  s_add_u32 s56, s56, s43
  s_lshl_b32 s56, s56, 16
  s_add_u32 s56, s56, s3
  s_add_u32 s56, s56, 12582912
  s_add_u32 s66, s58, 1
  s_cmp_eq_u32 s66, 3
  s_cselect_b32 s66, 0, s66
  s_lshl_b32 s72, s54, 21
  s_mul_i32 s46, s58, 655360
  s_add_u32 s72, s72, s46
  s_add_u32 s72, s72, s3
  s_add_u32 s72, s72, 4194304
  s_lshr_b32 s46, s72, 8
  s_and_b32 s46, s46, 0x2000
  s_xor_b32 s72, s72, s46
  s_lshl_b32 s46, s62, 14
  s_add_u32 s72, s72, s46
  s_add_u32 s73, s72, 4096
  s_and_b32 s46, s43, 3
  s_lshl_b32 s46, s46, 16
  s_sub_u32 s56, s56, s46
  s_add_u32 s74, s56, 16384
  s_add_u32 s75, s56, 20480
  s_add_u32 s76, s56, 32768
  s_add_u32 s77, s56, 36864
  s_add_u32 s78, s56, 51200
  s_lshl_b32 s80, s66, 18
  s_add_u32 s81, s80, 65536
  s_add_u32 s82, s80, 131072
  s_add_u32 s83, s80, 196608
  s_cmp_ge_u32 s52, 1
  s_addc_u32 s64, s52, 1
  v_mov_b32 v16, s64
  s_mov_b64 s[16:17], -1
  s_mov_b32 s71, 0
  v_mov_b32 v20, 0
  v_mov_b32 v21, 0
  v_mov_b32 v22, 0
  v_mov_b32 v23, 0
  s_waitcnt vmcnt(0)
  s_barrier
  buffer_load_dwordx4 v[24:27], v1, s[8:11], s72 offen offset:0 sc1
  buffer_load_dwordx4 v[28:31], v1, s[8:11], s72 offen offset:1024 sc1
  buffer_load_dwordx4 v[32:35], v1, s[8:11], s72 offen offset:2048 sc1
  buffer_load_dwordx4 v[36:39], v1, s[8:11], s72 offen offset:3072 sc1
  buffer_load_dwordx4 v[40:43], v1, s[8:11], s73 offen offset:0 sc1
  buffer_load_dwordx4 v[44:47], v1, s[8:11], s73 offen offset:1024 sc1
  buffer_load_dwordx4 v[48:51], v1, s[8:11], s73 offen offset:2048 sc1
  buffer_load_dwordx4 v[52:55], v1, s[8:11], s73 offen offset:3072 sc1
  buffer_load_dwordx4 v[72:75], v1, s[8:11], s74 offen offset:0 sc1
  buffer_load_dwordx4 v[76:79], v1, s[8:11], s74 offen offset:1024 sc1
  buffer_load_dwordx4 v[80:83], v1, s[8:11], s74 offen offset:2048 sc1
  buffer_load_dwordx4 v[84:87], v1, s[8:11], s74 offen offset:3072 sc1
  buffer_load_dwordx4 v[88:91], v1, s[8:11], s75 offen offset:0 sc1
  buffer_load_dwordx4 v[92:95], v1, s[8:11], s75 offen offset:1024 sc1
  buffer_load_dwordx4 v[96:99], v1, s[8:11], s75 offen offset:2048 sc1
  buffer_load_dwordx4 v[100:103], v1, s[8:11], s75 offen offset:3072 sc1
  buffer_load_dwordx4 v[104:107], v1, s[8:11], s76 offen offset:0 sc1
  buffer_load_dwordx4 v[108:111], v1, s[8:11], s76 offen offset:1024 sc1
  buffer_load_dwordx4 v[112:115], v1, s[8:11], s76 offen offset:2048 sc1
  buffer_load_dwordx4 v[116:119], v1, s[8:11], s76 offen offset:3072 sc1
  buffer_load_dwordx4 v[120:123], v1, s[8:11], s77 offen offset:0 sc1
  buffer_load_dwordx4 v[124:127], v1, s[8:11], s77 offen offset:1024 sc1
  buffer_load_dwordx4 v[128:131], v1, s[8:11], s77 offen offset:2048 sc1
  buffer_load_dwordx4 v[132:135], v1, s[8:11], s77 offen offset:3072 sc1
  buffer_load_dwordx4 v[56:59], v1, s[8:11], s78 offen offset:0 sc1
  buffer_load_dwordx4 v[60:63], v1, s[8:11], s78 offen offset:1024 sc1
  buffer_load_dwordx4 v[64:67], v1, s[8:11], s78 offen offset:2048 sc1
  buffer_load_dwordx4 v[68:71], v1, s[8:11], s78 offen offset:3072 sc1
ow_go:
  s_waitcnt vmcnt(21)
  buffer_store_dword v16, v7, s[8:11], 0 offen sc1
  s_waitcnt vmcnt(20)
  v_smfmac_f32_16x16x64_bf16 v[20:23], v[72:75], a[0:7], v5
  s_waitcnt vmcnt(19)
  v_smfmac_f32_16x16x64_bf16 v[20:23], v[76:79], a[8:15], v5
  s_waitcnt vmcnt(18)
  v_smfmac_f32_16x16x64_bf16 v[20:23], v[80:83], a[16:23], v5
  s_waitcnt vmcnt(17)
  v_smfmac_f32_16x16x64_bf16 v[20:23], v[84:87], a[24:31], v5
  s_waitcnt vmcnt(16)
  v_smfmac_f32_16x16x64_bf16 v[20:23], v[88:91], a[32:39], v5
  s_waitcnt vmcnt(15)
  v_smfmac_f32_16x16x64_bf16 v[20:23], v[92:95], a[40:47], v5
  s_waitcnt vmcnt(14)
  v_smfmac_f32_16x16x64_bf16 v[20:23], v[96:99], a[48:55], v5
  s_waitcnt vmcnt(13)
  v_smfmac_f32_16x16x64_bf16 v[20:23], v[100:103], a[56:63], v5
  s_waitcnt vmcnt(12)
  v_smfmac_f32_16x16x64_bf16 v[20:23], v[104:107], a[64:71], v5
  s_waitcnt vmcnt(11)
  v_smfmac_f32_16x16x64_bf16 v[20:23], v[108:111], a[72:79], v5
  s_waitcnt vmcnt(10)
  v_smfmac_f32_16x16x64_bf16 v[20:23], v[112:115], a[80:87], v5
  s_waitcnt vmcnt(9)
  v_smfmac_f32_16x16x64_bf16 v[20:23], v[116:119], a[88:95], v5
  s_waitcnt vmcnt(8)
  v_smfmac_f32_16x16x64_bf16 v[20:23], v[120:123], a[96:103], v5
  s_waitcnt vmcnt(7)
  v_smfmac_f32_16x16x64_bf16 v[20:23], v[124:127], a[104:111], v5
  s_waitcnt vmcnt(6)
  v_smfmac_f32_16x16x64_bf16 v[20:23], v[128:131], a[112:119], v5
  s_waitcnt vmcnt(5)
  v_smfmac_f32_16x16x64_bf16 v[20:23], v[132:135], a[120:127], v5
  s_waitcnt vmcnt(4)
  v_smfmac_f32_16x16x64_bf16 v[20:23], v[56:59], v[24:31], v5
  s_waitcnt vmcnt(3)
  v_smfmac_f32_16x16x64_bf16 v[20:23], v[60:63], v[32:39], v5
  s_waitcnt vmcnt(2)
  v_smfmac_f32_16x16x64_bf16 v[20:23], v[64:67], v[40:47], v5
  s_waitcnt vmcnt(1)
  v_smfmac_f32_16x16x64_bf16 v[20:23], v[68:71], v[48:55], v5
  s_nop 7
  v_pk_add_f32 v[20:21], v[20:21], v[22:23]
  v_cmp_u_f32 vcc, v20, v21
  v_cvt_pk_bf16_f32 v10, v20, v21
  s_nop 1
  v_mov_b32_dpp v11, v10 quad_perm:[1,0,3,2] row_mask:0xf bank_mask:0xf
  v_perm_b32 v10, v11, v10, v4
  s_and_b64 vcc, vcc, s[16:17]
  s_cbranch_scc1 ow_redo
  buffer_store_dword v10, v3, s[8:11], s80 offen sc1
  buffer_store_dword v10, v3, s[8:11], s81 offen sc1
  buffer_store_dword v10, v3, s[8:11], s82 offen sc1
  buffer_store_dword v10, v3, s[8:11], s83 offen sc1
  s_barrier
  s_add_u32 s49, s52, 2
  s_cmp_ge_u32 s52, 1
  s_cbranch_scc1 ow_rung
  v_mov_b32 v16, s49
  buffer_store_dword v16, v7, s[8:11], 0 offen sc1
ow_rung:
  s_waitcnt vmcnt(0)
  s_mov_b32 s65, s63
  s_lshr_b32 s46, s65, 8
  s_and_b32 s46, s46, 0x2000
  s_xor_b32 s65, s65, s46
  s_add_u32 s63, s63, 2621440
  s_cmp_ge_u32 s63, 201326592
  s_cselect_b32 s46, 83886080, 0
  s_sub_u32 s63, s63, s46
  s_add_u32 s46, s65, 0
  s_xor_b32 s46, s46, 0x2000
  buffer_load_dwordx4 a[0:3], v1, s[8:11], s46 offen offset:0 sc1
  buffer_load_dwordx4 a[4:7], v1, s[8:11], s46 offen offset:1024 sc1
  buffer_load_dwordx4 a[8:11], v1, s[8:11], s46 offen offset:2048 sc1
  buffer_load_dwordx4 a[12:15], v1, s[8:11], s46 offen offset:3072 sc1
  s_add_u32 s46, s65, 4096
  s_xor_b32 s46, s46, 0x2000
  buffer_load_dwordx4 a[16:19], v1, s[8:11], s46 offen offset:0 sc1
  buffer_load_dwordx4 a[20:23], v1, s[8:11], s46 offen offset:1024 sc1
  buffer_load_dwordx4 a[24:27], v1, s[8:11], s46 offen offset:2048 sc1
  buffer_load_dwordx4 a[28:31], v1, s[8:11], s46 offen offset:3072 sc1
  s_add_u32 s46, s65, 16384
  buffer_load_dwordx4 a[32:35], v1, s[8:11], s46 offen offset:0 sc1
  buffer_load_dwordx4 a[36:39], v1, s[8:11], s46 offen offset:1024 sc1
  buffer_load_dwordx4 a[40:43], v1, s[8:11], s46 offen offset:2048 sc1
  buffer_load_dwordx4 a[44:47], v1, s[8:11], s46 offen offset:3072 sc1
  s_add_u32 s46, s65, 20480
  buffer_load_dwordx4 a[48:51], v1, s[8:11], s46 offen offset:0 sc1
  buffer_load_dwordx4 a[52:55], v1, s[8:11], s46 offen offset:1024 sc1
  buffer_load_dwordx4 a[56:59], v1, s[8:11], s46 offen offset:2048 sc1
  buffer_load_dwordx4 a[60:63], v1, s[8:11], s46 offen offset:3072 sc1
  s_add_u32 s46, s65, 32768
  buffer_load_dwordx4 a[64:67], v1, s[8:11], s46 offen offset:0 sc1
  buffer_load_dwordx4 a[68:71], v1, s[8:11], s46 offen offset:1024 sc1
  buffer_load_dwordx4 a[72:75], v1, s[8:11], s46 offen offset:2048 sc1
  buffer_load_dwordx4 a[76:79], v1, s[8:11], s46 offen offset:3072 sc1
  s_add_u32 s46, s65, 36864
  buffer_load_dwordx4 a[80:83], v1, s[8:11], s46 offen offset:0 sc1
  buffer_load_dwordx4 a[84:87], v1, s[8:11], s46 offen offset:1024 sc1
  buffer_load_dwordx4 a[88:91], v1, s[8:11], s46 offen offset:2048 sc1
  buffer_load_dwordx4 a[92:95], v1, s[8:11], s46 offen offset:3072 sc1
  s_add_u32 s46, s65, 49152
  buffer_load_dwordx4 a[96:99], v1, s[8:11], s46 offen offset:0 sc1
  buffer_load_dwordx4 a[100:103], v1, s[8:11], s46 offen offset:1024 sc1
  buffer_load_dwordx4 a[104:107], v1, s[8:11], s46 offen offset:2048 sc1
  buffer_load_dwordx4 a[108:111], v1, s[8:11], s46 offen offset:3072 sc1
  s_add_u32 s46, s65, 53248
  buffer_load_dwordx4 a[112:115], v1, s[8:11], s46 offen offset:0 sc1
  buffer_load_dwordx4 a[116:119], v1, s[8:11], s46 offen offset:1024 sc1
  buffer_load_dwordx4 a[120:123], v1, s[8:11], s46 offen offset:2048 sc1
  buffer_load_dwordx4 a[124:127], v1, s[8:11], s46 offen offset:3072 sc1
  v_mov_b32 v11, -1
  s_lshl_b32 s47, s58, 18
  s_add_u32 s46, s47, 0
  buffer_store_dword v11, v3, s[8:11], s46 offen sc1
  s_add_u32 s46, s47, 65536
  buffer_store_dword v11, v3, s[8:11], s46 offen sc1
  s_add_u32 s46, s47, 131072
  buffer_store_dword v11, v3, s[8:11], s46 offen sc1
  s_add_u32 s46, s47, 196608
  buffer_store_dword v11, v3, s[8:11], s46 offen sc1
  s_mov_b32 s58, s66
  s_cmp_eq_u32 s58, 0
  s_addc_u32 s54, s54, 0
  s_cmp_eq_u32 s54, 3
  s_cselect_b32 s54, 0, s54
  s_mov_b32 s52, s53
  s_cmp_lt_u32 s52, 63
  s_cbranch_scc1 ow_loop
  s_endpgm
ow_redo:
  s_mov_b32 s50, 0
ow_poll:
  buffer_load_dwordx4 v[24:27], v1, s[8:11], s72 offen offset:0 sc1
  buffer_load_dwordx4 v[28:31], v1, s[8:11], s72 offen offset:1024 sc1
  buffer_load_dwordx4 v[32:35], v1, s[8:11], s72 offen offset:2048 sc1
  buffer_load_dwordx4 v[36:39], v1, s[8:11], s72 offen offset:3072 sc1
  buffer_load_dwordx4 v[40:43], v1, s[8:11], s73 offen offset:0 sc1
  buffer_load_dwordx4 v[44:47], v1, s[8:11], s73 offen offset:1024 sc1
  buffer_load_dwordx4 v[48:51], v1, s[8:11], s73 offen offset:2048 sc1
  buffer_load_dwordx4 v[52:55], v1, s[8:11], s73 offen offset:3072 sc1
  buffer_load_dwordx4 v[72:75], v1, s[8:11], s74 offen offset:0 sc1
  buffer_load_dwordx4 v[76:79], v1, s[8:11], s74 offen offset:1024 sc1
  buffer_load_dwordx4 v[80:83], v1, s[8:11], s74 offen offset:2048 sc1
  buffer_load_dwordx4 v[84:87], v1, s[8:11], s74 offen offset:3072 sc1
  buffer_load_dwordx4 v[88:91], v1, s[8:11], s75 offen offset:0 sc1
  buffer_load_dwordx4 v[92:95], v1, s[8:11], s75 offen offset:1024 sc1
  buffer_load_dwordx4 v[96:99], v1, s[8:11], s75 offen offset:2048 sc1
  buffer_load_dwordx4 v[100:103], v1, s[8:11], s75 offen offset:3072 sc1
  buffer_load_dwordx4 v[104:107], v1, s[8:11], s76 offen offset:0 sc1
  buffer_load_dwordx4 v[108:111], v1, s[8:11], s76 offen offset:1024 sc1
  buffer_load_dwordx4 v[112:115], v1, s[8:11], s76 offen offset:2048 sc1
  buffer_load_dwordx4 v[116:119], v1, s[8:11], s76 offen offset:3072 sc1
  buffer_load_dwordx4 v[120:123], v1, s[8:11], s77 offen offset:0 sc1
  buffer_load_dwordx4 v[124:127], v1, s[8:11], s77 offen offset:1024 sc1
  buffer_load_dwordx4 v[128:131], v1, s[8:11], s77 offen offset:2048 sc1
  buffer_load_dwordx4 v[132:135], v1, s[8:11], s77 offen offset:3072 sc1
  buffer_load_dwordx4 v[56:59], v1, s[8:11], s78 offen offset:0 sc1
  buffer_load_dwordx4 v[60:63], v1, s[8:11], s78 offen offset:1024 sc1
  buffer_load_dwordx4 v[64:67], v1, s[8:11], s78 offen offset:2048 sc1
  buffer_load_dwordx4 v[68:71], v1, s[8:11], s78 offen offset:3072 sc1
  s_add_u32 s71, s71, 1
  s_cmp_le_u32 s71, 2
  s_cbranch_scc1 ow_again
  s_add_u32 s50, s50, 1
  s_cmp_gt_u32 s50, 131072
  s_cbranch_scc1 L_fail
  s_waitcnt vmcnt(0)
  v_max_u32 v8, v24, v25
  v_max3_u32 v8, v26, v27, v8
  v_max3_u32 v8, v28, v29, v8
  v_max3_u32 v8, v30, v31, v8
  v_max3_u32 v8, v32, v33, v8
  v_max3_u32 v8, v34, v35, v8
  v_max3_u32 v8, v36, v37, v8
  v_max3_u32 v8, v38, v39, v8
  v_max3_u32 v8, v40, v41, v8
  v_max3_u32 v8, v42, v43, v8
  v_max3_u32 v8, v44, v45, v8
  v_max3_u32 v8, v46, v47, v8
  v_max3_u32 v8, v48, v49, v8
  v_max3_u32 v8, v50, v51, v8
  v_max3_u32 v8, v52, v53, v8
  v_max3_u32 v8, v54, v55, v8
  v_max3_u32 v8, v56, v57, v8
  v_max3_u32 v8, v58, v59, v8
  v_max3_u32 v8, v60, v61, v8
  v_max3_u32 v8, v62, v63, v8
  v_max3_u32 v8, v64, v65, v8
  v_max3_u32 v8, v66, v67, v8
  v_max3_u32 v8, v68, v69, v8
  v_max3_u32 v8, v70, v71, v8
  v_max3_u32 v8, v72, v73, v8
  v_max3_u32 v8, v74, v75, v8
  v_max3_u32 v8, v76, v77, v8
  v_max3_u32 v8, v78, v79, v8
  v_max3_u32 v8, v80, v81, v8
  v_max3_u32 v8, v82, v83, v8
  v_max3_u32 v8, v84, v85, v8
  v_max3_u32 v8, v86, v87, v8
  v_max3_u32 v8, v88, v89, v8
  v_max3_u32 v8, v90, v91, v8
  v_max3_u32 v8, v92, v93, v8
  v_max3_u32 v8, v94, v95, v8
  v_max3_u32 v8, v96, v97, v8
  v_max3_u32 v8, v98, v99, v8
  v_max3_u32 v8, v100, v101, v8
  v_max3_u32 v8, v102, v103, v8
  v_max3_u32 v8, v104, v105, v8
  v_max3_u32 v8, v106, v107, v8
  v_max3_u32 v8, v108, v109, v8
  v_max3_u32 v8, v110, v111, v8
  v_max3_u32 v8, v112, v113, v8
  v_max3_u32 v8, v114, v115, v8
  v_max3_u32 v8, v116, v117, v8
  v_max3_u32 v8, v118, v119, v8
  v_max3_u32 v8, v120, v121, v8
  v_max3_u32 v8, v122, v123, v8
  v_max3_u32 v8, v124, v125, v8
  v_max3_u32 v8, v126, v127, v8
  v_max3_u32 v8, v128, v129, v8
  v_max3_u32 v8, v130, v131, v8
  v_max3_u32 v8, v132, v133, v8
  v_max3_u32 v8, v134, v135, v8
  v_cmp_eq_u32 vcc, -1, v8
  s_cbranch_vccnz ow_poll
  s_mov_b64 s[16:17], 0
ow_again:
  v_mov_b32 v20, 0
  v_mov_b32 v21, 0
  v_mov_b32 v22, 0
  v_mov_b32 v23, 0
  s_branch ow_go
L_xowner:
  s_mov_b32 s12, s36
  s_mov_b32 s13, s37
  s_mov_b32 s14, 5242880
  s_mov_b32 s15, 0x20000
  s_mov_b32 s50, 0
ss_47:
  v_and_b32 v11, 3, v0
  v_lshlrev_b32 v11, 2, v11
  global_load_dword v10, v11, s[38:39] sc1
  s_add_u32 s50, s50, 1
  s_cmp_gt_u32 s50, 131072
  s_cbranch_scc1 L_fail
  s_waitcnt vmcnt(0)
ss_47_in:
  v_readlane_b32 s46, v10, 0
  v_readlane_b32 s47, v10, 1
  v_readlane_b32 s48, v10, 0
  s_nop 0
  s_min_u32 s47, s47, s48
  s_cmp_lg_u32 s46, 0
  s_cselect_b32 s48, 7, 0
  s_add_u32 s46, s46, s2
  s_xor_b32 s49, s46, s43
  s_and_b32 s49, s49, s48
  s_cbranch_scc1 L_reroll
  s_cmp_lg_u32 s47, 0
  s_cbranch_scc1 ss_ok_48
  s_sleep 6
  s_branch ss_47
ss_ok_48:
  v_readlane_b32 s3, v10, 1
  s_nop 0
  s_and_b32 s3, s3, 0x2000
  s_lshr_b32 s46, s44, 4
  s_lshl_b32 s46, s46, 7
  s_lshl_b32 s47, s43, 4
  s_add_u32 s46, s46, s47
  s_and_b32 s47, s44, 15
  s_add_u32 s46, s46, s47
  s_lshl_b32 s46, s46, 7
  s_add_u32 s46, s46, s3
  s_add_u32 s46, s46, 13369344
  s_add_u32 s40, s8, s46
  s_addc_u32 s41, s9, 0
  s_sub_u32 s48, s44, 26
  s_and_b32 s46, s48, 1
  s_mul_i32 s46, s46, 5
  s_mul_i32 s62, s43, 10
  s_add_u32 s62, s62, s46
  s_lshr_b32 s52, s48, 1
  v_lshlrev_b32 v1, 4, v0
  v_and_b32 v10, 7, v0
  v_lshlrev_b32 v10, 7, v10
  v_add_u32 v10, s51, v10
  v_bfe_u32 v11, v0, 3, 2
  v_lshl_add_u32 v2, v11, 2, v10
  v_add_u32 v3, 13672448, v2
  v_bfe_u32 v11, v0, 3, 1
  v_lshl_add_u32 v4, v11, 2, v10
  v_add_u32 v4, 13676544, v4
  v_cmp_lt_u32 vcc, 31, v0
  s_nop 1
  v_cndmask_b32 v3, v3, v4, vcc
  v_xor_b32 v3, s3, v3
  s_lshl_b32 s55, s42, 9
  s_lshl_b32 s46, s43, 11
  s_add_u32 s55, s55, s46
  s_add_u32 s55, s55, 13688832
  s_xor_b32 s55, s55, s3
  s_mul_i32 s46, s43, 6
  s_add_u32 s46, s46, s48
  s_lshl_b32 s46, s46, 7
  s_add_u32 s46, s46, 13660160
  s_xor_b32 s46, s46, s3
  v_mov_b32 v15, s46
  v_mov_b32 v11, 2146435072
  s_cmp_eq_u32 s42, 0
  s_cselect_b64 vcc, 1, 0
  v_cndmask_b32 v15, v11, v15, vcc
  s_mul_i32 s46, s42, 10240
  v_add_u32 v5, s46, v1
  v_add_u32 v6, s51, v1
  s_mul_i32 s63, s52, 40
  s_add_u32 s63, s63, s62
  s_lshl_b32 s63, s63, 16
  s_lshl_b32 s46, s42, 14
  s_add_u32 s63, s63, s46
  s_add_u32 s63, s63, s3
  s_add_u32 s63, s63, 117440512
  s_lshr_b32 s46, 1, s42
  s_and_b32 s46, s46, 1
  s_lshl_b32 s46, s46, 13
  s_xor_b32 s63, s63, s46
  s_lshl_b32 s65, s52, 18
  s_add_u32 s65, s65, s3
  s_add_u32 s65, s65, 14680064
  s_lshl_b32 s67, s62, 14
  s_lshl_b32 s46, s42, 11
  s_add_u32 s67, s67, s46
  s_mov_b32 s58, s52
  s_mul_i32 s66, s52, 81920
  v_and_b32 v10, 15, v0
  v_mul_u32_u24 v10, 2560, v10
  v_lshrrev_b32 v11, 4, v0
  v_lshl_add_u32 v10, v11, 3, v10
  s_add_u32 s46, s42, 0
  s_cmp_ge_u32 s46, 5
  s_cselect_b32 s47, 40800, 0
  s_add_u32 s48, s46, s62
  s_lshl_b32 s48, s48, 5
  s_add_u32 s47, s47, s48
  s_add_u32 s47, s47, 1280
  s_cmp_ge_u32 s46, 10
  s_cselect_b32 s47, 2146435072, s47
  v_add_u32 v7, s47, v10
  s_add_u32 s46, s42, 4
  s_cmp_ge_u32 s46, 5
  s_cselect_b32 s47, 40800, 0
  s_add_u32 s48, s46, s62
  s_lshl_b32 s48, s48, 5
  s_add_u32 s47, s47, s48
  s_add_u32 s47, s47, 1280
  s_cmp_ge_u32 s46, 10
  s_cselect_b32 s47, 2146435072, s47
  v_add_u32 v8, s47, v10
  s_add_u32 s46, s42, 8
  s_cmp_ge_u32 s46, 5
  s_cselect_b32 s47, 40800, 0
  s_add_u32 s48, s46, s62
  s_lshl_b32 s48, s48, 5
  s_add_u32 s47, s47, s48
  s_add_u32 s47, s47, 1280
  s_cmp_ge_u32 s46, 10
  s_cselect_b32 s47, 2146435072, s47
  v_add_u32 v9, s47, v10
  v_mov_b32 v224, -1
  v_mov_b32 v225, -1
  v_mov_b32 v226, -1
  v_mov_b32 v227, -1
  s_cmp_lg_u32 s42, 0
  s_cbranch_scc1 xo_clr
  s_mov_b32 s54, 0
xo_clr0:
  s_lshl_b32 s64, s54, 21
  s_mul_i32 s46, s58, 655360
  s_add_u32 s64, s64, s46
  s_add_u32 s64, s64, s3
  s_add_u32 s64, s64, 4194304
  s_lshr_b32 s46, s64, 8
  s_and_b32 s46, s46, 0x2000
  s_xor_b32 s64, s64, s46
  s_add_u32 s64, s64, s67
  s_add_u32 s46, s64, 0
  buffer_store_dwordx4 v[224:227], v1, s[8:11], s46 offen offset:0 sc1
  buffer_store_dwordx4 v[224:227], v1, s[8:11], s46 offen offset:1024 sc1
  buffer_store_dwordx4 v[224:227], v1, s[8:11], s46 offen offset:2048 sc1
  buffer_store_dwordx4 v[224:227], v1, s[8:11], s46 offen offset:3072 sc1
  s_add_u32 s46, s64, 4096
  buffer_store_dwordx4 v[224:227], v1, s[8:11], s46 offen offset:0 sc1
  buffer_store_dwordx4 v[224:227], v1, s[8:11], s46 offen offset:1024 sc1
  buffer_store_dwordx4 v[224:227], v1, s[8:11], s46 offen offset:2048 sc1
  buffer_store_dwordx4 v[224:227], v1, s[8:11], s46 offen offset:3072 sc1
  s_add_u32 s46, s64, 16384
  buffer_store_dwordx4 v[224:227], v1, s[8:11], s46 offen offset:0 sc1
  buffer_store_dwordx4 v[224:227], v1, s[8:11], s46 offen offset:1024 sc1
  buffer_store_dwordx4 v[224:227], v1, s[8:11], s46 offen offset:2048 sc1
  buffer_store_dwordx4 v[224:227], v1, s[8:11], s46 offen offset:3072 sc1
  s_add_u32 s46, s64, 20480
  buffer_store_dwordx4 v[224:227], v1, s[8:11], s46 offen offset:0 sc1
  buffer_store_dwordx4 v[224:227], v1, s[8:11], s46 offen offset:1024 sc1
  buffer_store_dwordx4 v[224:227], v1, s[8:11], s46 offen offset:2048 sc1
  buffer_store_dwordx4 v[224:227], v1, s[8:11], s46 offen offset:3072 sc1
  s_add_u32 s46, s64, 32768
  buffer_store_dwordx4 v[224:227], v1, s[8:11], s46 offen offset:0 sc1
  buffer_store_dwordx4 v[224:227], v1, s[8:11], s46 offen offset:1024 sc1
  buffer_store_dwordx4 v[224:227], v1, s[8:11], s46 offen offset:2048 sc1
  buffer_store_dwordx4 v[224:227], v1, s[8:11], s46 offen offset:3072 sc1
  s_add_u32 s46, s64, 36864
  buffer_store_dwordx4 v[224:227], v1, s[8:11], s46 offen offset:0 sc1
  buffer_store_dwordx4 v[224:227], v1, s[8:11], s46 offen offset:1024 sc1
  buffer_store_dwordx4 v[224:227], v1, s[8:11], s46 offen offset:2048 sc1
  buffer_store_dwordx4 v[224:227], v1, s[8:11], s46 offen offset:3072 sc1
  s_add_u32 s46, s64, 49152
  buffer_store_dwordx4 v[224:227], v1, s[8:11], s46 offen offset:0 sc1
  buffer_store_dwordx4 v[224:227], v1, s[8:11], s46 offen offset:1024 sc1
  buffer_store_dwordx4 v[224:227], v1, s[8:11], s46 offen offset:2048 sc1
  buffer_store_dwordx4 v[224:227], v1, s[8:11], s46 offen offset:3072 sc1
  s_add_u32 s46, s64, 53248
  buffer_store_dwordx4 v[224:227], v1, s[8:11], s46 offen offset:0 sc1
  buffer_store_dwordx4 v[224:227], v1, s[8:11], s46 offen offset:1024 sc1
  buffer_store_dwordx4 v[224:227], v1, s[8:11], s46 offen offset:2048 sc1
  buffer_store_dwordx4 v[224:227], v1, s[8:11], s46 offen offset:3072 sc1
  s_add_u32 s46, s64, 65536
  buffer_store_dwordx4 v[224:227], v1, s[8:11], s46 offen offset:0 sc1
  buffer_store_dwordx4 v[224:227], v1, s[8:11], s46 offen offset:1024 sc1
  buffer_store_dwordx4 v[224:227], v1, s[8:11], s46 offen offset:2048 sc1
  buffer_store_dwordx4 v[224:227], v1, s[8:11], s46 offen offset:3072 sc1
  s_add_u32 s46, s64, 69632
  buffer_store_dwordx4 v[224:227], v1, s[8:11], s46 offen offset:0 sc1
  buffer_store_dwordx4 v[224:227], v1, s[8:11], s46 offen offset:1024 sc1
  buffer_store_dwordx4 v[224:227], v1, s[8:11], s46 offen offset:2048 sc1
  buffer_store_dwordx4 v[224:227], v1, s[8:11], s46 offen offset:3072 sc1
  s_waitcnt vmcnt(20)
  s_add_u32 s54, s54, 1
  s_cmp_lt_u32 s54, 3
  s_cbranch_scc1 xo_clr0
xo_clr:
  s_mov_b32 s50, 0
ss_49:
  v_and_b32 v11, 3, v0
  v_lshlrev_b32 v11, 2, v11
  global_load_dword v10, v11, s[38:39] sc1
  s_add_u32 s50, s50, 1
  s_cmp_gt_u32 s50, 131072
  s_cbranch_scc1 L_fail
  s_waitcnt vmcnt(0)
ss_49_in:
  v_readlane_b32 s46, v10, 0
  v_readlane_b32 s47, v10, 2
  v_readlane_b32 s48, v10, 1
  s_nop 0
  s_min_u32 s47, s47, s48
  s_cmp_lg_u32 s46, 0
  s_cselect_b32 s48, 7, 0
  s_add_u32 s46, s46, s2
  s_xor_b32 s49, s46, s43
  s_and_b32 s49, s49, s48
  s_cbranch_scc1 L_reroll
  s_cmp_lg_u32 s47, 0
  s_cbranch_scc1 ss_ok_50
  s_sleep 6
  s_branch ss_49
ss_ok_50:
  v_readlane_b32 s3, v10, 1
  s_nop 0
  s_and_b32 s3, s3, 0x2000
  s_add_u32 s46, s52, 6
  v_mov_b32 v10, s46
  s_waitcnt vmcnt(0)
  buffer_store_dword v10, v15, s[8:11], 0 offen sc1
  s_mov_b32 s60, 0
  s_mov_b32 s61, 0
  s_mov_b32 s54, 0
xo_loop:
  s_add_u32 s53, s52, 1
  s_mov_b32 s50, 0
sw_loop_52:
  s_cmp_ge_u32 s60, s53
  s_cbranch_scc1 sw_done_51
  s_add_u32 s46, s55, 0
  s_buffer_load_dwordx8 s[16:23], s[8:11], s46 glc
  s_add_u32 s46, s55, 128
  s_buffer_load_dwordx8 s[24:31], s[8:11], s46 glc
  s_add_u32 s46, s55, 256
  s_buffer_load_dwordx8 s[72:79], s[8:11], s46 glc
  s_add_u32 s46, s55, 384
  s_buffer_load_dwordx8 s[84:91], s[8:11], s46 glc
  s_waitcnt lgkmcnt(0)
  s_min_u32 s60, s16, s17
  s_min_u32 s60, s60, s18
  s_min_u32 s60, s60, s19
  s_min_u32 s60, s60, s20
  s_min_u32 s60, s60, s21
  s_min_u32 s60, s60, s22
  s_min_u32 s60, s60, s23
  s_min_u32 s60, s60, s24
  s_min_u32 s60, s60, s25
  s_min_u32 s60, s60, s26
  s_min_u32 s60, s60, s27
  s_min_u32 s60, s60, s28
  s_min_u32 s60, s60, s29
  s_min_u32 s60, s60, s30
  s_min_u32 s60, s60, s31
  s_min_u32 s60, s60, s72
  s_min_u32 s60, s60, s73
  s_min_u32 s60, s60, s74
  s_min_u32 s60, s60, s75
  s_min_u32 s60, s60, s76
  s_min_u32 s60, s60, s77
  s_min_u32 s60, s60, s78
  s_min_u32 s60, s60, s79
  s_min_u32 s60, s60, s84
  s_min_u32 s60, s60, s85
  s_min_u32 s60, s60, s86
  s_min_u32 s60, s60, s87
  s_min_u32 s60, s60, s88
  s_min_u32 s60, s60, s89
  s_min_u32 s60, s60, s90
  s_min_u32 s60, s60, s91
  s_add_u32 s50, s50, 1
  s_cmp_gt_u32 s50, 131072
  s_cbranch_scc1 L_fail
  s_cmp_ge_u32 s60, s53
  s_cbranch_scc1 sw_done_51
  s_sleep 40
  s_branch sw_loop_52
sw_done_51:
  s_add_u32 s46, s63, 0
  s_lshr_b32 s47, s46, 8
  s_and_b32 s47, s47, 0x2000
  s_xor_b32 s46, s46, s47
  buffer_load_dwordx4 a[0:3], v1, s[8:11], s46 offen offset:0 sc1
  buffer_load_dwordx4 a[4:7], v1, s[8:11], s46 offen offset:1024 sc1
  buffer_load_dwordx4 a[8:11], v1, s[8:11], s46 offen offset:2048 sc1
  buffer_load_dwordx4 a[12:15], v1, s[8:11], s46 offen offset:3072 sc1
  s_add_u32 s46, s46, 4096
  buffer_load_dwordx4 a[16:19], v1, s[8:11], s46 offen offset:0 sc1
  buffer_load_dwordx4 a[20:23], v1, s[8:11], s46 offen offset:1024 sc1
  buffer_load_dwordx4 a[24:27], v1, s[8:11], s46 offen offset:2048 sc1
  buffer_load_dwordx4 a[28:31], v1, s[8:11], s46 offen offset:3072 sc1
  s_add_u32 s46, s63, 65536
  s_lshr_b32 s47, s46, 8
  s_and_b32 s47, s47, 0x2000
  s_xor_b32 s46, s46, s47
  buffer_load_dwordx4 a[32:35], v1, s[8:11], s46 offen offset:0 sc1
  buffer_load_dwordx4 a[36:39], v1, s[8:11], s46 offen offset:1024 sc1
  buffer_load_dwordx4 a[40:43], v1, s[8:11], s46 offen offset:2048 sc1
  buffer_load_dwordx4 a[44:47], v1, s[8:11], s46 offen offset:3072 sc1
  s_add_u32 s46, s46, 4096
  buffer_load_dwordx4 a[48:51], v1, s[8:11], s46 offen offset:0 sc1
  buffer_load_dwordx4 a[52:55], v1, s[8:11], s46 offen offset:1024 sc1
  buffer_load_dwordx4 a[56:59], v1, s[8:11], s46 offen offset:2048 sc1
  buffer_load_dwordx4 a[60:63], v1, s[8:11], s46 offen offset:3072 sc1
  s_add_u32 s46, s63, 131072
  s_lshr_b32 s47, s46, 8
  s_and_b32 s47, s47, 0x2000
  s_xor_b32 s46, s46, s47
  buffer_load_dwordx4 a[64:67], v1, s[8:11], s46 offen offset:0 sc1
  buffer_load_dwordx4 a[68:71], v1, s[8:11], s46 offen offset:1024 sc1
  buffer_load_dwordx4 a[72:75], v1, s[8:11], s46 offen offset:2048 sc1
  buffer_load_dwordx4 a[76:79], v1, s[8:11], s46 offen offset:3072 sc1
  s_add_u32 s46, s46, 4096
  buffer_load_dwordx4 a[80:83], v1, s[8:11], s46 offen offset:0 sc1
  buffer_load_dwordx4 a[84:87], v1, s[8:11], s46 offen offset:1024 sc1
  buffer_load_dwordx4 a[88:91], v1, s[8:11], s46 offen offset:2048 sc1
  buffer_load_dwordx4 a[92:95], v1, s[8:11], s46 offen offset:3072 sc1
  s_add_u32 s46, s63, 196608
  s_lshr_b32 s47, s46, 8
  s_and_b32 s47, s47, 0x2000
  s_xor_b32 s46, s46, s47
  buffer_load_dwordx4 a[96:99], v1, s[8:11], s46 offen offset:0 sc1
  buffer_load_dwordx4 a[100:103], v1, s[8:11], s46 offen offset:1024 sc1
  buffer_load_dwordx4 a[104:107], v1, s[8:11], s46 offen offset:2048 sc1
  buffer_load_dwordx4 a[108:111], v1, s[8:11], s46 offen offset:3072 sc1
  s_add_u32 s46, s46, 4096
  buffer_load_dwordx4 a[112:115], v1, s[8:11], s46 offen offset:0 sc1
  buffer_load_dwordx4 a[116:119], v1, s[8:11], s46 offen offset:1024 sc1
  buffer_load_dwordx4 a[120:123], v1, s[8:11], s46 offen offset:2048 sc1
  buffer_load_dwordx4 a[124:127], v1, s[8:11], s46 offen offset:3072 sc1
  s_add_u32 s46, s63, 262144
  s_lshr_b32 s47, s46, 8
  s_and_b32 s47, s47, 0x2000
  s_xor_b32 s46, s46, s47
  buffer_load_dwordx4 a[128:131], v1, s[8:11], s46 offen offset:0 sc1
  buffer_load_dwordx4 a[132:135], v1, s[8:11], s46 offen offset:1024 sc1
  buffer_load_dwordx4 a[136:139], v1, s[8:11], s46 offen offset:2048 sc1
  buffer_load_dwordx4 a[140:143], v1, s[8:11], s46 offen offset:3072 sc1
  s_add_u32 s46, s46, 4096
  buffer_load_dwordx4 a[144:147], v1, s[8:11], s46 offen offset:0 sc1
  buffer_load_dwordx4 a[148:151], v1, s[8:11], s46 offen offset:1024 sc1
  buffer_load_dwordx4 a[152:155], v1, s[8:11], s46 offen offset:2048 sc1
  buffer_load_dwordx4 a[156:159], v1, s[8:11], s46 offen offset:3072 sc1
  s_waitcnt vmcnt(24)
  s_cmp_ge_u32 s52, 62
  s_cbranch_scc1 xo_last
  s_cmp_lg_u32 s42, 0
  s_cbranch_scc1 xo_go
  s_mov_b32 s50, 0
box_53:
  s_load_dword s80, s[40:41], 0 glc
  s_add_u32 s50, s50, 1
  s_cmp_gt_u32 s50, 131072
  s_cbranch_scc1 L_fail
  s_waitcnt lgkmcnt(0)
  s_cmp_lt_u32 s80, s53
  s_cbranch_scc1 box_53
  s_branch xo_go
xo_last:
  s_mov_b32 s53, 64
  s_mov_b32 s61, 0
  s_cmp_ge_u32 s61, s53
  s_cbranch_scc1 wf_done_55
  s_mov_b32 s50, 0
wf_loop_56:
  buffer_load_dword v10, v3, s[8:11], 0 offen sc1
  s_add_u32 s50, s50, 1
  s_cmp_gt_u32 s50, 131072
  s_cbranch_scc1 L_fail
  s_waitcnt vmcnt(0)
  v_min_u32_dpp v10, v10, v10 row_ror:8 row_mask:0xf bank_mask:0xf
  s_nop 1
  v_min_u32_dpp v10, v10, v10 row_ror:4 row_mask:0xf bank_mask:0xf
  s_nop 1
  v_min_u32_dpp v10, v10, v10 row_ror:2 row_mask:0xf bank_mask:0xf
  s_nop 1
  v_min_u32_dpp v10, v10, v10 row_ror:1 row_mask:0xf bank_mask:0xf
  v_mov_b32 v11, v10
  s_nop 1
  v_permlane16_swap_b32 v11, v10
  v_min_u32 v10, v10, v11
  v_mov_b32 v11, v10
  s_nop 1
  v_permlane32_swap_b32 v11, v10
  v_min_u32 v10, v10, v11
  s_nop 0
  v_readfirstlane_b32 s61, v10
  s_nop 0
  s_cmp_ge_u32 s61, s53
  s_cbranch_scc1 wf_done_55
  s_sleep 2
  s_branch wf_loop_56
wf_done_55:
xo_go:
  s_barrier
  s_lshl_b32 s64, s54, 21
  s_mul_i32 s46, s58, 655360
  s_add_u32 s64, s64, s46
  s_add_u32 s64, s64, s3
  s_add_u32 s64, s64, 4194304
  s_lshr_b32 s46, s64, 8
  s_and_b32 s46, s46, 0x2000
  s_xor_b32 s64, s64, s46
  s_add_u32 s64, s64, s67
  s_mov_b32 s49, s65
  s_lshr_b32 s46, s49, 8
  s_and_b32 s46, s46, 0x2000
  s_xor_b32 s49, s49, s46
  s_lshl_b32 s47, s42, 14
  s_add_u32 s47, s47, s49
  s_lshl_b32 s48, s42, 11
  s_add_u32 s48, s48, s49
  s_add_u32 s46, s47, 0
  buffer_load_dwordx4 v[56:59], v1, s[8:11], s46 offen sc1
  s_add_u32 s46, s47, 81920
  buffer_load_dwordx4 v[60:63], v1, s[8:11], s46 offen sc1
  s_add_u32 s46, s47, 1024
  buffer_load_dwordx4 v[64:67], v1, s[8:11], s46 offen sc1
  s_add_u32 s46, s47, 82944
  buffer_load_dwordx4 v[68:71], v1, s[8:11], s46 offen sc1
  s_add_u32 s46, s47, 2048
  buffer_load_dwordx4 v[72:75], v1, s[8:11], s46 offen sc1
  s_add_u32 s46, s47, 83968
  buffer_load_dwordx4 v[76:79], v1, s[8:11], s46 offen sc1
  s_add_u32 s46, s47, 3072
  buffer_load_dwordx4 v[80:83], v1, s[8:11], s46 offen sc1
  s_add_u32 s46, s47, 84992
  buffer_load_dwordx4 v[84:87], v1, s[8:11], s46 offen sc1
  s_add_u32 s46, s47, 4096
  buffer_load_dwordx4 v[88:91], v1, s[8:11], s46 offen sc1
  s_add_u32 s46, s47, 86016
  buffer_load_dwordx4 v[92:95], v1, s[8:11], s46 offen sc1
  s_add_u32 s46, s47, 5120
  buffer_load_dwordx4 v[96:99], v1, s[8:11], s46 offen sc1
  s_add_u32 s46, s47, 87040
  buffer_load_dwordx4 v[100:103], v1, s[8:11], s46 offen sc1
  s_add_u32 s46, s47, 6144
  buffer_load_dwordx4 v[104:107], v1, s[8:11], s46 offen sc1
  s_add_u32 s46, s47, 88064
  buffer_load_dwordx4 v[108:111], v1, s[8:11], s46 offen sc1
  s_add_u32 s46, s47, 7168
  buffer_load_dwordx4 v[112:115], v1, s[8:11], s46 offen sc1
  s_add_u32 s46, s47, 89088
  buffer_load_dwordx4 v[116:119], v1, s[8:11], s46 offen sc1
  s_add_u32 s46, s48, 65536
  buffer_load_dwordx4 v[120:123], v1, s[8:11], s46 offen sc1
  s_add_u32 s46, s48, 147456
  buffer_load_dwordx4 v[124:127], v1, s[8:11], s46 offen sc1
  s_add_u32 s46, s48, 66560
  buffer_load_dwordx4 v[128:131], v1, s[8:11], s46 offen sc1
  s_add_u32 s46, s48, 148480
  buffer_load_dwordx4 v[132:135], v1, s[8:11], s46 offen sc1
  s_add_u32 s46, s64, 0
  buffer_load_dwordx4 v[16:19], v1, s[8:11], s46 offen offset:0 sc1
  buffer_load_dwordx4 v[20:23], v1, s[8:11], s46 offen offset:1024 sc1
  s_add_u32 s46, s64, 16384
  buffer_load_dwordx4 v[24:27], v1, s[8:11], s46 offen offset:0 sc1
  buffer_load_dwordx4 v[28:31], v1, s[8:11], s46 offen offset:1024 sc1
  s_add_u32 s46, s64, 32768
  buffer_load_dwordx4 v[32:35], v1, s[8:11], s46 offen offset:0 sc1
  buffer_load_dwordx4 v[36:39], v1, s[8:11], s46 offen offset:1024 sc1
  s_add_u32 s46, s64, 49152
  buffer_load_dwordx4 v[40:43], v1, s[8:11], s46 offen offset:0 sc1
  buffer_load_dwordx4 v[44:47], v1, s[8:11], s46 offen offset:1024 sc1
  s_add_u32 s46, s64, 65536
  buffer_load_dwordx4 v[48:51], v1, s[8:11], s46 offen offset:0 sc1
  buffer_load_dwordx4 v[52:55], v1, s[8:11], s46 offen offset:1024 sc1
  s_waitcnt vmcnt(29)
  v_mfma_f32_16x16x32_bf16 v[136:139], a[0:3], v[56:59], 0
  v_mfma_f32_16x16x32_bf16 v[140:143], a[32:35], v[56:59], 0
  v_mfma_f32_16x16x32_bf16 v[144:147], a[64:67], v[56:59], 0
  v_mfma_f32_16x16x32_bf16 v[148:151], a[96:99], v[56:59], 0
  v_mfma_f32_16x16x32_bf16 v[152:155], a[128:131], v[56:59], 0
  s_waitcnt vmcnt(28)
  v_mfma_f32_16x16x32_bf16 v[156:159], a[0:3], v[60:63], 0
  v_mfma_f32_16x16x32_bf16 v[160:163], a[32:35], v[60:63], 0
  v_mfma_f32_16x16x32_bf16 v[164:167], a[64:67], v[60:63], 0
  v_mfma_f32_16x16x32_bf16 v[168:171], a[96:99], v[60:63], 0
  v_mfma_f32_16x16x32_bf16 v[172:175], a[128:131], v[60:63], 0
  s_waitcnt vmcnt(27)
  v_mfma_f32_16x16x32_bf16 v[136:139], a[4:7], v[64:67], v[136:139]
  v_mfma_f32_16x16x32_bf16 v[140:143], a[36:39], v[64:67], v[140:143]
  v_mfma_f32_16x16x32_bf16 v[144:147], a[68:71], v[64:67], v[144:147]
  v_mfma_f32_16x16x32_bf16 v[148:151], a[100:103], v[64:67], v[148:151]
  v_mfma_f32_16x16x32_bf16 v[152:155], a[132:135], v[64:67], v[152:155]
  s_waitcnt vmcnt(26)
  v_mfma_f32_16x16x32_bf16 v[156:159], a[4:7], v[68:71], v[156:159]
  v_mfma_f32_16x16x32_bf16 v[160:163], a[36:39], v[68:71], v[160:163]
  v_mfma_f32_16x16x32_bf16 v[164:167], a[68:71], v[68:71], v[164:167]
  v_mfma_f32_16x16x32_bf16 v[168:171], a[100:103], v[68:71], v[168:171]
  v_mfma_f32_16x16x32_bf16 v[172:175], a[132:135], v[68:71], v[172:175]
  s_waitcnt vmcnt(25)
  v_mfma_f32_16x16x32_bf16 v[136:139], a[8:11], v[72:75], v[136:139]
  v_mfma_f32_16x16x32_bf16 v[140:143], a[40:43], v[72:75], v[140:143]
  v_mfma_f32_16x16x32_bf16 v[144:147], a[72:75], v[72:75], v[144:147]
  v_mfma_f32_16x16x32_bf16 v[148:151], a[104:107], v[72:75], v[148:151]
  v_mfma_f32_16x16x32_bf16 v[152:155], a[136:139], v[72:75], v[152:155]
  s_waitcnt vmcnt(24)
  v_mfma_f32_16x16x32_bf16 v[156:159], a[8:11], v[76:79], v[156:159]
  v_mfma_f32_16x16x32_bf16 v[160:163], a[40:43], v[76:79], v[160:163]
  v_mfma_f32_16x16x32_bf16 v[164:167], a[72:75], v[76:79], v[164:167]
  v_mfma_f32_16x16x32_bf16 v[168:171], a[104:107], v[76:79], v[168:171]
  v_mfma_f32_16x16x32_bf16 v[172:175], a[136:139], v[76:79], v[172:175]
  s_waitcnt vmcnt(23)
  v_mfma_f32_16x16x32_bf16 v[136:139], a[12:15], v[80:83], v[136:139]
  v_mfma_f32_16x16x32_bf16 v[140:143], a[44:47], v[80:83], v[140:143]
  v_mfma_f32_16x16x32_bf16 v[144:147], a[76:79], v[80:83], v[144:147]
  v_mfma_f32_16x16x32_bf16 v[148:151], a[108:111], v[80:83], v[148:151]
  v_mfma_f32_16x16x32_bf16 v[152:155], a[140:143], v[80:83], v[152:155]
  s_waitcnt vmcnt(22)
  v_mfma_f32_16x16x32_bf16 v[156:159], a[12:15], v[84:87], v[156:159]
  v_mfma_f32_16x16x32_bf16 v[160:163], a[44:47], v[84:87], v[160:163]
  v_mfma_f32_16x16x32_bf16 v[164:167], a[76:79], v[84:87], v[164:167]
  v_mfma_f32_16x16x32_bf16 v[168:171], a[108:111], v[84:87], v[168:171]
  v_mfma_f32_16x16x32_bf16 v[172:175], a[140:143], v[84:87], v[172:175]
  s_waitcnt vmcnt(21)
  v_mfma_f32_16x16x32_bf16 v[136:139], a[16:19], v[88:91], v[136:139]
  v_mfma_f32_16x16x32_bf16 v[140:143], a[48:51], v[88:91], v[140:143]
  v_mfma_f32_16x16x32_bf16 v[144:147], a[80:83], v[88:91], v[144:147]
  v_mfma_f32_16x16x32_bf16 v[148:151], a[112:115], v[88:91], v[148:151]
  v_mfma_f32_16x16x32_bf16 v[152:155], a[144:147], v[88:91], v[152:155]
  s_waitcnt vmcnt(20)
  v_mfma_f32_16x16x32_bf16 v[156:159], a[16:19], v[92:95], v[156:159]
  v_mfma_f32_16x16x32_bf16 v[160:163], a[48:51], v[92:95], v[160:163]
  v_mfma_f32_16x16x32_bf16 v[164:167], a[80:83], v[92:95], v[164:167]
  v_mfma_f32_16x16x32_bf16 v[168:171], a[112:115], v[92:95], v[168:171]
  v_mfma_f32_16x16x32_bf16 v[172:175], a[144:147], v[92:95], v[172:175]
  s_waitcnt vmcnt(19)
  v_mfma_f32_16x16x32_bf16 v[136:139], a[20:23], v[96:99], v[136:139]
  v_mfma_f32_16x16x32_bf16 v[140:143], a[52:55], v[96:99], v[140:143]
  v_mfma_f32_16x16x32_bf16 v[144:147], a[84:87], v[96:99], v[144:147]
  v_mfma_f32_16x16x32_bf16 v[148:151], a[116:119], v[96:99], v[148:151]
  v_mfma_f32_16x16x32_bf16 v[152:155], a[148:151], v[96:99], v[152:155]
  s_waitcnt vmcnt(18)
  v_mfma_f32_16x16x32_bf16 v[156:159], a[20:23], v[100:103], v[156:159]
  v_mfma_f32_16x16x32_bf16 v[160:163], a[52:55], v[100:103], v[160:163]
  v_mfma_f32_16x16x32_bf16 v[164:167], a[84:87], v[100:103], v[164:167]
  v_mfma_f32_16x16x32_bf16 v[168:171], a[116:119], v[100:103], v[168:171]
  v_mfma_f32_16x16x32_bf16 v[172:175], a[148:151], v[100:103], v[172:175]
  s_waitcnt vmcnt(17)
  v_mfma_f32_16x16x32_bf16 v[136:139], a[24:27], v[104:107], v[136:139]
  v_mfma_f32_16x16x32_bf16 v[140:143], a[56:59], v[104:107], v[140:143]
  v_mfma_f32_16x16x32_bf16 v[144:147], a[88:91], v[104:107], v[144:147]
  v_mfma_f32_16x16x32_bf16 v[148:151], a[120:123], v[104:107], v[148:151]
  v_mfma_f32_16x16x32_bf16 v[152:155], a[152:155], v[104:107], v[152:155]
  s_waitcnt vmcnt(16)
  v_mfma_f32_16x16x32_bf16 v[156:159], a[24:27], v[108:111], v[156:159]
  v_mfma_f32_16x16x32_bf16 v[160:163], a[56:59], v[108:111], v[160:163]
  v_mfma_f32_16x16x32_bf16 v[164:167], a[88:91], v[108:111], v[164:167]
  v_mfma_f32_16x16x32_bf16 v[168:171], a[120:123], v[108:111], v[168:171]
  v_mfma_f32_16x16x32_bf16 v[172:175], a[152:155], v[108:111], v[172:175]
  s_waitcnt vmcnt(15)
  v_mfma_f32_16x16x32_bf16 v[136:139], a[28:31], v[112:115], v[136:139]
  v_mfma_f32_16x16x32_bf16 v[140:143], a[60:63], v[112:115], v[140:143]
  v_mfma_f32_16x16x32_bf16 v[144:147], a[92:95], v[112:115], v[144:147]
  v_mfma_f32_16x16x32_bf16 v[148:151], a[124:127], v[112:115], v[148:151]
  v_mfma_f32_16x16x32_bf16 v[152:155], a[156:159], v[112:115], v[152:155]
  s_waitcnt vmcnt(14)
  v_mfma_f32_16x16x32_bf16 v[156:159], a[28:31], v[116:119], v[156:159]
  v_mfma_f32_16x16x32_bf16 v[160:163], a[60:63], v[116:119], v[160:163]
  v_mfma_f32_16x16x32_bf16 v[164:167], a[92:95], v[116:119], v[164:167]
  v_mfma_f32_16x16x32_bf16 v[168:171], a[124:127], v[116:119], v[168:171]
  v_mfma_f32_16x16x32_bf16 v[172:175], a[156:159], v[116:119], v[172:175]
  s_waitcnt vmcnt(8)
  v_mfma_f32_16x16x32_bf16 v[136:139], v[16:19], v[120:123], v[136:139]
  v_mfma_f32_16x16x32_bf16 v[156:159], v[16:19], v[124:127], v[156:159]
  v_mfma_f32_16x16x32_bf16 v[136:139], v[20:23], v[128:131], v[136:139]
  v_mfma_f32_16x16x32_bf16 v[156:159], v[20:23], v[132:135], v[156:159]
  s_waitcnt vmcnt(6)
  v_mfma_f32_16x16x32_bf16 v[140:143], v[24:27], v[120:123], v[140:143]
  v_mfma_f32_16x16x32_bf16 v[160:163], v[24:27], v[124:127], v[160:163]
  v_mfma_f32_16x16x32_bf16 v[140:143], v[28:31], v[128:131], v[140:143]
  v_mfma_f32_16x16x32_bf16 v[160:163], v[28:31], v[132:135], v[160:163]
  s_waitcnt vmcnt(4)
  v_mfma_f32_16x16x32_bf16 v[144:147], v[32:35], v[120:123], v[144:147]
  v_mfma_f32_16x16x32_bf16 v[164:167], v[32:35], v[124:127], v[164:167]
  v_mfma_f32_16x16x32_bf16 v[144:147], v[36:39], v[128:131], v[144:147]
  v_mfma_f32_16x16x32_bf16 v[164:167], v[36:39], v[132:135], v[164:167]
  s_waitcnt vmcnt(2)
  v_mfma_f32_16x16x32_bf16 v[148:151], v[40:43], v[120:123], v[148:151]
  v_mfma_f32_16x16x32_bf16 v[168:171], v[40:43], v[124:127], v[168:171]
  v_mfma_f32_16x16x32_bf16 v[148:151], v[44:47], v[128:131], v[148:151]
  v_mfma_f32_16x16x32_bf16 v[168:171], v[44:47], v[132:135], v[168:171]
  s_waitcnt vmcnt(0)
  v_mfma_f32_16x16x32_bf16 v[152:155], v[48:51], v[120:123], v[152:155]
  v_mfma_f32_16x16x32_bf16 v[172:175], v[48:51], v[124:127], v[172:175]
  v_mfma_f32_16x16x32_bf16 v[152:155], v[52:55], v[128:131], v[152:155]
  v_mfma_f32_16x16x32_bf16 v[172:175], v[52:55], v[132:135], v[172:175]
  s_cmp_ge_u32 s52, 55
  s_cbranch_scc1 xo_nop
  s_add_u32 s46, s64, 0
  buffer_store_dwordx4 v[224:227], v1, s[8:11], s46 offen offset:0 sc1
  buffer_store_dwordx4 v[224:227], v1, s[8:11], s46 offen offset:1024 sc1
  s_add_u32 s46, s64, 16384
  buffer_store_dwordx4 v[224:227], v1, s[8:11], s46 offen offset:0 sc1
  buffer_store_dwordx4 v[224:227], v1, s[8:11], s46 offen offset:1024 sc1
  s_add_u32 s46, s64, 32768
  buffer_store_dwordx4 v[224:227], v1, s[8:11], s46 offen offset:0 sc1
  buffer_store_dwordx4 v[224:227], v1, s[8:11], s46 offen offset:1024 sc1
  s_add_u32 s46, s64, 49152
  buffer_store_dwordx4 v[224:227], v1, s[8:11], s46 offen offset:0 sc1
  buffer_store_dwordx4 v[224:227], v1, s[8:11], s46 offen offset:1024 sc1
  s_add_u32 s46, s64, 65536
  buffer_store_dwordx4 v[224:227], v1, s[8:11], s46 offen offset:0 sc1
  buffer_store_dwordx4 v[224:227], v1, s[8:11], s46 offen offset:1024 sc1
xo_nop:
  ds_write_b128 v5, v[136:139] offset:0
  ds_write_b128 v5, v[140:143] offset:1024
  ds_write_b128 v5, v[144:147] offset:2048
  ds_write_b128 v5, v[148:151] offset:3072
  s_nop 0
  ds_write_b128 v5, v[152:155] offset:4096
  ds_write_b128 v5, v[156:159] offset:5120
  ds_write_b128 v5, v[160:163] offset:6144
  ds_write_b128 v5, v[164:167] offset:7168
  ds_write_b128 v5, v[168:171] offset:8192
  ds_write_b128 v5, v[172:175] offset:9216
  s_waitcnt lgkmcnt(0)
  s_barrier
  ds_read_b128 v[176:179], v6 offset:0
  ds_read_b128 v[180:183], v6 offset:10240
  ds_read_b128 v[184:187], v6 offset:20480
  ds_read_b128 v[188:191], v6 offset:30720
  ds_read_b128 v[192:195], v6 offset:4096
  ds_read_b128 v[196:199], v6 offset:14336
  ds_read_b128 v[200:203], v6 offset:24576
  ds_read_b128 v[204:207], v6 offset:34816
  ds_read_b128 v[208:211], v6 offset:8192
  ds_read_b128 v[212:215], v6 offset:18432
  ds_read_b128 v[216:219], v6 offset:28672
  ds_read_b128 v[220:223], v6 offset:38912
  s_waitcnt lgkmcnt(8)
  v_add_f32 v176, v176, v180
  v_add_f32 v184, v184, v188
  v_add_f32 v176, v176, v184
  v_add_f32 v177, v177, v181
  v_add_f32 v185, v185, v189
  v_add_f32 v177, v177, v185
  v_add_f32 v178, v178, v182
  v_add_f32 v186, v186, v190
  v_add_f32 v178, v178, v186
  v_add_f32 v179, v179, v183
  v_add_f32 v187, v187, v191
  v_add_f32 v179, v179, v187
  v_cvt_pk_bf16_f32 v176, v176, v177
  v_cvt_pk_bf16_f32 v177, v178, v179
  buffer_store_dwordx2 v[176:177], v7, s[12:15], s66 offen
  s_waitcnt lgkmcnt(4)
  v_add_f32 v192, v192, v196
  v_add_f32 v200, v200, v204
  v_add_f32 v192, v192, v200
  v_add_f32 v193, v193, v197
  v_add_f32 v201, v201, v205
  v_add_f32 v193, v193, v201
  v_add_f32 v194, v194, v198
  v_add_f32 v202, v202, v206
  v_add_f32 v194, v194, v202
  v_add_f32 v195, v195, v199
  v_add_f32 v203, v203, v207
  v_add_f32 v195, v195, v203
  v_cvt_pk_bf16_f32 v192, v192, v193
  v_cvt_pk_bf16_f32 v193, v194, v195
  buffer_store_dwordx2 v[192:193], v8, s[12:15], s66 offen
  s_waitcnt lgkmcnt(0)
  v_add_f32 v208, v208, v212
  v_add_f32 v216, v216, v220
  v_add_f32 v208, v208, v216
  v_add_f32 v209, v209, v213
  v_add_f32 v217, v217, v221
  v_add_f32 v209, v209, v217
  v_add_f32 v210, v210, v214
  v_add_f32 v218, v218, v222
  v_add_f32 v210, v210, v218
  v_add_f32 v211, v211, v215
  v_add_f32 v219, v219, v223
  v_add_f32 v211, v211, v219
  v_cvt_pk_bf16_f32 v208, v208, v209
  v_cvt_pk_bf16_f32 v209, v210, v211
  buffer_store_dwordx2 v[208:209], v9, s[12:15], s66 offen
  s_cmp_ge_u32 s52, 61
  s_cbranch_scc1 xo_end
  s_add_u32 s46, s52, 9
  v_mov_b32 v10, s46
  s_waitcnt vmcnt(0)
  s_barrier
  buffer_store_dword v10, v15, s[8:11], 0 offen sc1
  s_add_u32 s54, s54, 1
  s_cmp_eq_u32 s54, 3
  s_cselect_b32 s54, 0, s54
  s_add_u32 s63, s63, 7864320
  s_cmp_ge_u32 s63, 201326592
  s_cselect_b32 s46, 83886080, 0
  s_sub_u32 s63, s63, s46
  s_add_u32 s65, s65, 786432
  s_cmp_ge_u32 s65, 16777216
  s_cselect_b32 s46, 2097152, 0
  s_sub_u32 s65, s65, s46
  s_add_u32 s66, s66, 245760
  s_add_u32 s52, s52, 3
  s_cmp_lt_u32 s52, 64
  s_cbranch_scc1 xo_loop
xo_end:
  s_endpgm
L_end:
  s_endpgm
L_fail:
  s_mov_b32 s4, s38
  s_mov_b32 s5, s39
  s_mov_b32 s6, 256
  s_mov_b32 s7, 0x20000
  s_lshl_b32 s46, s43, 8
  s_or_b32 s46, s46, s44
  s_or_b32 s46, s46, 0x10000
  v_mov_b32 v1, 32
  v_mov_b32 v2, s46
  s_mov_b64 exec, 1
  buffer_store_dword v2, v1, s[4:7], 0 offen sc1
  s_waitcnt vmcnt(0)
  s_endpgm
.section .rodata,"a"
.p2align 6
.amdhsa_kernel concat_heads__sliding_local_dilated__memory_aug_recurrent_mem_tr__prompt_kernel
  .amdhsa_next_free_vgpr 512
  .amdhsa_next_free_sgpr 102
  .amdhsa_accum_offset 256
  .amdhsa_group_segment_fixed_size 0
  .amdhsa_kernarg_size 104
  .amdhsa_user_sgpr_count 2
  .amdhsa_user_sgpr_kernarg_segment_ptr 1
  .amdhsa_system_sgpr_workgroup_id_x 1
.end_amdhsa_kernel
```
